```python
import torch

def _softmax(x, axis=-1):
    return torch.softmax(x, dim=axis)
def _gelu(x):
    return torch.nn.functional.gelu(x, approximate="tanh")
def _silu(x):
    return torch.nn.functional.silu(x)
def _sigmoid(x):
    return torch.sigmoid(x)
def _layernorm(x, axis=-1, eps=1e-5):
    m = x.mean(dim=axis, keepdim=True)
    v = x.var(dim=axis, keepdim=True, unbiased=False)
    return (x - m) / torch.sqrt(v + eps)
def _scatter_add(tgt, idx, src, axis=0):
    return tgt.clone().index_add_(axis, idx, src)
def _segment_sum(src, seg, n):
    out = torch.zeros((n,) + src.shape[1:], dtype=src.dtype)
    return out.index_add_(0, seg, src)
def _pad(x, pw):
    flat = tuple(v for pair in reversed(pw) for v in pair)
    return torch.nn.functional.pad(x, flat)

kernel_name = 'recurrent_scan__compressed_kv_cla__swiglu_ffn__prompt'

def setup_inputs():

    _w = (lambda a: (lambda t: t.to(torch.bfloat16) if t.is_floating_point() else t)(torch.as_tensor(a)))
    def _A_setup():
        B, H, Sq, Sk, D, M = 1, 16, 2048, 2048, 256, 448
        Dc = 4 * D
        return {
            "x": _w((lambda *s: torch.randn(*s, dtype=torch.bfloat16) * 0.05)(B, Sq, M)),
            "c_kv": _w((lambda *s: torch.randn(*s, dtype=torch.bfloat16) * 0.2)(B, Sk, Dc)),
            "w_q": _w((lambda *s: torch.randn(*s, dtype=torch.bfloat16) * 3.2)(M, H, D) * (M ** -0.5)),
            "w_uk": _w((lambda *s: torch.randn(*s, dtype=torch.bfloat16) * 3.2)(Dc, H, D) * (Dc ** -0.5)),
            "w_uv": _w((lambda *s: torch.randn(*s, dtype=torch.bfloat16) * 0.2)(Dc, H, D) * (Dc ** -0.5)),
            "w_o": _w((lambda *s: torch.randn(*s, dtype=torch.bfloat16) * 0.2)(H, D, M) * ((H * D) ** -0.5)),
        }
    _A_in = _A_setup()

    def _B_setup():
        B, S, D, F = 1, 2048, 448, 1792
        return {
            "x": _w((lambda *s: torch.randn(*s, dtype=torch.bfloat16) * 0.05)(B, S, D)),
            "w_gate": _w((lambda *s: torch.randn(*s, dtype=torch.bfloat16) * 0.1)(D, F)),
            "w_up": _w((lambda *s: torch.randn(*s, dtype=torch.bfloat16) * 0.1)(D, F)),
            "w_down": _w((lambda *s: torch.randn(*s, dtype=torch.bfloat16) * 0.1)(F, D)),
        }
    _B_in = _B_setup()

    return {
        "A_x": _A_in["x"],
        "A_c_kv": _A_in["c_kv"],
        "A_w_q": _A_in["w_q"],
        "A_w_uk": _A_in["w_uk"],
        "A_w_uv": _A_in["w_uv"],
        "A_w_o": _A_in["w_o"],
        "B_x": _B_in["x"],
        "B_w_gate": _B_in["w_gate"],
        "B_w_up": _B_in["w_up"],
        "B_w_down": _B_in["w_down"],
    }

def reference(A_x, A_c_kv, A_w_q, A_w_uk, A_w_uv, A_w_o, B_x, B_w_gate, B_w_up, B_w_down):
    def _A_ref(x, c_kv, w_q, w_uk, w_uv, w_o):
        B, Sq, M = x.shape[0], x.shape[1], x.shape[2]
        Sk = c_kv.shape[1]
        H, D = w_q.shape[1], w_q.shape[2]
        q = torch.einsum("bqm,mhd->bhqd", x, w_q)
        k = torch.einsum("bkc,chd->bhkd", c_kv, w_uk)
        v = torch.einsum("bkc,chd->bhkd", c_kv, w_uv)
        scores = torch.einsum("bhqd,bhkd->bhqk", q, k) * (D ** -0.5)
        off = Sk - Sq
        qi = torch.arange(Sq)[:, None]
        kj = torch.arange(Sk)[None, :]
        cmask = kj <= (qi + off)
        scores = torch.where(cmask[None, None], scores, -1e9)
        p = _softmax(scores, axis=-1)
        ctx = torch.einsum("bhqk,bhkd->bhqd", p, v)
        return torch.einsum("bhqd,hdm->bqm", ctx, w_o)

    def _B_ref(x, w_gate, w_up, w_down):
        g = _silu(x @ w_gate)
        u = x @ w_up
        return (g * u) @ w_down

    x = A_x
    xn = _layernorm(x, axis=-1)
    s = _A_ref(xn, A_c_kv, A_w_q, A_w_uk, A_w_uv, A_w_o)
    g = _silu(_B_ref(xn, B_w_gate, B_w_up, B_w_down))
    return x + s * g
```

```asm
; @launch kernel=main_kernel grid=(256,1,1) block=(256,1,1) lds=163840
.amdgcn_target "amdgcn-amd-amdhsa--gfx950"
.text
.globl main_kernel
.p2align 8
.type main_kernel,@function
main_kernel:
    s_cmp_ge_u32 s2, 256
    s_cbranch_scc1 .Lmain_kernel_done_1
    s_load_dwordx4 s[60:63], s[0:1], 0
    s_load_dwordx4 s[36:39], s[0:1], 24
    s_load_dwordx4 s[56:59], s[0:1], 88
    s_load_dwordx2 s[68:69], s[0:1], 16
    s_load_dwordx4 s[72:75], s[0:1], 56
    s_load_dwordx2 s[70:71], s[0:1], 40
    s_load_dwordx2 s[100:101], s[0:1], 72
    s_getpc_b64 s[52:53]
.Lmain_kernel_pc_2:
    s_sub_u32 s52, s52, .Lmain_kernel_pc_2-main_kernel
    s_subb_u32 s53, s53, 0
    s_and_b32 s53, s53, 0xffff
    s_mov_b32 s54, .Ltext_end-main_kernel
    s_mov_b32 s55, 0x00020000
    s_and_b32 s30, s2, 56
    s_lshl_b32 s30, s30, 12
    v_lshlrev_b32 v254, 7, v0
    buffer_load_dword v254, v254, s[52:55], s30 offen
    v_and_b32 v1, 63, v0
    v_lshrrev_b32 v2, 6, v0
    s_nop 0
    v_readfirstlane_b32 s20, v2
    s_lshr_b32 s41, s2, 4
    s_and_b32 s23, s41, 7
    s_lshr_b32 s25, s41, 3
    s_xor_b32 s25, s25, 1
    s_bfe_u32 s31, s2, 0x10003
    s_and_b32 s24, s2, 7
    s_lshl_b32 s24, s24, 1
    s_add_u32 s24, s24, s31
    s_lshl_b32 s43, s24, 4
    s_add_u32 s43, s43, s41
    s_lshr_b32 s21, s20, 1
    s_and_b32 s22, s20, 1
    v_lshrrev_b32 v31, 3, v1
    v_and_b32 v3, 7, v1
    v_lshrrev_b32 v4, 4, v1
    s_mul_i32 s30, s20, 131072
    v_mul_u32_u24 v6, 2048, v31
    v_add_u32 v6, s30, v6
    v_add_u32 v5, 0, v4
    v_xor_b32 v5, v5, v3
    v_lshl_add_u32 v5, v5, 4, v6
    v_add_u32 v16, 0, v5
    v_add_u32 v18, 30720, v5
    v_add_u32 v20, 65536, v5
    v_add_u32 v22, 96256, v5
    v_add_u32 v5, 4, v4
    v_xor_b32 v5, v5, v3
    v_lshl_add_u32 v5, v5, 4, v6
    v_add_u32 v17, 15360, v5
    v_add_u32 v19, 46080, v5
    v_add_u32 v21, 80896, v5
    v_add_u32 v23, 111616, v5
    s_lshl_b32 s42, s20, 7
    v_and_b32 v3, 7, v1
    v_mul_u32_u24 v6, 8192, v31
    v_add_u32 v6, s42, v6
    v_and_b32 v5, 2, v31
    v_xor_b32 v5, v5, v3
    v_lshl_add_u32 v24, v5, 4, v6
    v_xor_b32 v5, 4, v5
    v_lshl_add_u32 v25, v5, 4, v6
    v_add_u32 v25, 64512, v25
    v_add_u32 v26, 129024, v24
    v_add_u32 v27, 129024, v25
    s_waitcnt lgkmcnt(0)
    s_mov_b32 s8, s62
    s_and_b32 s9, s63, 0xffff
    s_mov_b32 s10, 4194304
    s_mov_b32 s11, 0x00020000
    s_cmp_eq_u32 s25, 0
    s_cselect_b32 s36, s36, s38
    s_cselect_b32 s37, s37, s39
    s_mov_b32 s12, s36
    s_and_b32 s13, s37, 0xffff
    s_mov_b32 s14, 8388608
    s_mov_b32 s15, 0x00020000
    s_lshl_b32 s26, s23, 19
    s_lshl_b32 s27, s24, 9
    s_lshl_b32 s28, s20, 12
    s_lshl_b32 s76, s20, 12
    s_lshl_b32 s35, s20, 13
    s_add_u32 s35, s35, 65536
    s_mov_b32 s33, s35
    s_mov_b32 s64, s60
    s_and_b32 s65, s61, 0xffff
    s_mov_b32 s66, 1835008
    s_mov_b32 s67, 0x00020000
    s_lshl_b32 s62, s43, 2
    s_add_u32 s62, s62, s20
    s_mul_i32 s63, s62, 1792
    v_mov_b32 v148, 0
    v_mov_b32 v149, 0
    v_mov_b32 v150, 0
    v_mov_b32 v151, 0
    v_mov_b32 v152, 0
    v_mov_b32 v153, 0
    v_mov_b32 v154, 0
    v_mov_b32 v155, 0
    v_lshlrev_b32 v156, 4, v1
    s_mov_b32 exec_hi, 0x00ffffff
    buffer_load_dwordx4 v[148:151], v156, s[64:67], s63 offen
    buffer_load_dwordx4 v[152:155], v156, s[64:67], s63 offen offset:896
    s_mov_b32 exec_hi, -1
    s_add_u32 m0, s28, 0
    s_nop 0
    buffer_load_dwordx4 v24, s[12:15], s27 offen offset:0 nt lds
    buffer_load_dwordx4 v25, s[12:15], s27 offen offset:1024 nt lds
    buffer_load_dwordx4 v26, s[12:15], s27 offen offset:2048 nt lds
    buffer_load_dwordx4 v27, s[12:15], s27 offen offset:3072 nt lds
    s_add_u32 s27, s27, 262144
    s_add_u32 m0, s33, 0
    s_nop 0
    buffer_load_dwordx4 v16, s[8:11], s26 offen offset:0 lds
    buffer_load_dwordx4 v17, s[8:11], s26 offen offset:1024 lds
    buffer_load_dwordx4 v18, s[8:11], s26 offen offset:2048 lds
    buffer_load_dwordx4 v19, s[8:11], s26 offen offset:3072 lds
    s_add_u32 m0, s33, 4096
    s_nop 0
    buffer_load_dwordx4 v20, s[8:11], s26 offen offset:0 lds
    buffer_load_dwordx4 v21, s[8:11], s26 offen offset:1024 lds
    buffer_load_dwordx4 v22, s[8:11], s26 offen offset:2048 lds
    buffer_load_dwordx4 v23, s[8:11], s26 offen offset:3072 lds
    s_add_u32 s26, s26, 128
    s_add_u32 m0, s28, 16384
    s_nop 0
    buffer_load_dwordx4 v24, s[12:15], s27 offen offset:0 nt lds
    buffer_load_dwordx4 v25, s[12:15], s27 offen offset:1024 nt lds
    buffer_load_dwordx4 v26, s[12:15], s27 offen offset:2048 nt lds
    buffer_load_dwordx4 v27, s[12:15], s27 offen offset:3072 nt lds
    s_add_u32 s27, s27, 262144
    s_add_u32 s33, s33, 65536
    s_add_u32 m0, s33, -32768
    s_nop 0
    buffer_load_dwordx4 v16, s[8:11], s26 offen offset:0 lds
    buffer_load_dwordx4 v17, s[8:11], s26 offen offset:1024 lds
    buffer_load_dwordx4 v18, s[8:11], s26 offen offset:2048 lds
    buffer_load_dwordx4 v19, s[8:11], s26 offen offset:3072 lds
    s_add_u32 m0, s33, -28672
    s_nop 0
    buffer_load_dwordx4 v20, s[8:11], s26 offen offset:0 lds
    buffer_load_dwordx4 v21, s[8:11], s26 offen offset:1024 lds
    buffer_load_dwordx4 v22, s[8:11], s26 offen offset:2048 lds
    buffer_load_dwordx4 v23, s[8:11], s26 offen offset:3072 lds
    s_add_u32 s26, s26, 128
    s_lshl_b32 s30, s2, 2
    s_add_u32 s30, s30, s20
    v_lshlrev_b32 v2, 6, v1
    s_lshl_b32 s31, s30, 12
    v_and_b32 v2, 15, v1
    v_lshrrev_b32 v3, 4, v1
    v_bfe_u32 v4, v1, 1, 3
    s_lshl_b32 s30, s21, 14
    s_add_u32 s30, s30, 65536
    v_add_u32 v5, 0, v3
    v_xor_b32 v5, v5, v4
    v_lshlrev_b32 v5, 4, v5
    v_lshl_add_u32 v5, v2, 7, v5
    v_add_u32 v28, s30, v5
    v_mov_b32 v8, v28
    v_add_u32 v5, 4, v3
    v_xor_b32 v5, v5, v4
    v_lshlrev_b32 v5, 4, v5
    v_lshl_add_u32 v5, v2, 7, v5
    v_add_u32 v29, s30, v5
    v_mov_b32 v9, v29
    v_and_b32 v5, 3, v2
    v_lshlrev_b32 v5, 6, v5
    v_lshl_add_u32 v15, v3, 4, v5
    v_lshrrev_b32 v5, 2, v2
    v_mul_u32_u24 v5, 4608, v5
    s_lshl_b32 s30, s24, 8
    v_xor_b32 v5, s30, v5
    v_add_u32 v15, v15, v5
    v_lshlrev_b32 v14, 4, v1
    v_bfe_u32 v2, v1, 2, 2
    v_and_b32 v5, 3, v1
    v_lshl_add_u32 v6, v3, 3, v2
    v_lshlrev_b32 v6, 7, v6
    v_lshl_add_u32 v6, v5, 3, v6
    s_lshl_b32 s30, s22, 13
    v_add_u32 v6, s30, v6
    v_lshrrev_b32 v7, 1, v2
    v_and_b32 v5, 1, v3
    v_lshl_add_u32 v7, v5, 1, v7
    v_xor_b32 v5, 0, v7
    v_lshl_add_u32 v10, v5, 5, v6
    v_xor_b32 v5, 1, v7
    v_lshl_add_u32 v11, v5, 5, v6
    v_xor_b32 v5, 2, v7
    v_lshl_add_u32 v12, v5, 5, v6
    v_xor_b32 v5, 3, v7
    v_lshl_add_u32 v13, v5, 5, v6
    s_mov_b32 s16, s58
    s_and_b32 s17, s59, 0xffff
    s_mov_b32 s18, 134217728
    s_mov_b32 s19, 0x00020000
    v_lshlrev_b32 v2, 4, v0
    v_mov_b32 v4, 0
    v_mov_b32 v5, 0
    v_mov_b32 v6, 0
    v_mov_b32 v7, 0
    s_lshl_b32 s30, s43, 12
    s_add_u32 s30, s30, 33554432
    buffer_store_dwordx4 v[4:7], v2, s[16:19], s30 offen sc1
    s_lshl_b32 s3, s43, 10
    s_add_u32 s3, s3, 34603008
    v_and_b32 v2, 0x3f0, v2
    buffer_store_dwordx4 v[4:7], v2, s[16:19], s3 offen sc1
    v_add_u32 v0, s76, v14
    s_mov_b32 s48, s56
    s_and_b32 s49, s57, 0xffff
    s_mov_b32 s50, 256
    s_mov_b32 s51, 0x00020000
    s_mov_b64 s[56:57], s[60:61]
    s_mov_b32 s34, 0
    s_mov_b32 s29, 1
    s_cmp_eq_u32 s20, 0
    s_cselect_b32 s7, 3, 0
    s_cmp_ge_u32 s20, 2
    s_cbranch_scc1 .Lmain_kernel_t2_4
    s_cmp_lg_u32 s20, 0
    s_cbranch_scc1 .Lmain_kernel_t1_3
    s_mov_b64 s[46:47], s[68:69]
    s_mul_i32 s30, s41, 229376
    s_lshl_b32 s31, s24, 9
    s_add_u32 s30, s30, s31
    s_mov_b32 s98, 221696
    s_mov_b32 s42, 2
    s_mov_b32 s32, 8192
    s_mov_b32 s44, 49152
    s_mov_b32 s78, -11
    s_branch .Lmain_kernel_tj_5
.Lmain_kernel_t1_3:
    s_cmp_eq_u32 s25, 0
    s_cselect_b64 s[46:47], s[72:73], s[74:75]
    s_mul_i32 s30, s23, 200704
    s_min_u32 s31, s24, 13
    s_lshl_b32 s31, s31, 8
    s_add_u32 s30, s30, s31
    s_mov_b32 s98, 197376
    s_mov_b32 s42, 1
    s_mov_b32 s32, 3584
    s_mov_b32 s44, 43008
    s_mov_b32 s78, -6
    s_branch .Lmain_kernel_tj_5
.Lmain_kernel_t2_4:
    s_mov_b32 s98, 14336
    s_cmp_eq_u32 s20, 2
    s_cselect_b64 s[46:47], s[70:71], s[100:101]
    s_cselect_b32 s98, s98, 6272
    s_cselect_b32 s78, -11, -13
    s_mul_i32 s30, s43, s98
    s_mov_b32 s42, 0
    s_mov_b32 s32, 128
    s_mov_b32 s44, 3072
.Lmain_kernel_tj_5:
    s_add_u32 s96, s46, s30
    s_addc_u32 s97, s47, 0
    s_and_b32 s97, s97, 0xffff
    s_mov_b32 s99, 0x00020000
    s_mul_i32 s78, s44, s78
    v_mul_u32_u24 v2, 24, v1
    v_lshrrev_b32 v2, 6, v2
    v_lshrrev_b32 v3, s42, v2
    v_mul_u32_u24 v250, s32, v3
    v_lshlrev_b32 v3, s42, v3
    v_sub_u32 v2, v2, v3
    v_lshl_add_u32 v250, v2, 7, v250
    s_waitcnt vmcnt(27)
    v_lshlrev_b32 v158, 16, v148
    v_and_b32 v159, 0xffff0000, v148
    v_lshlrev_b32 v160, 16, v149
    v_and_b32 v161, 0xffff0000, v149
    v_lshlrev_b32 v162, 16, v150
    v_and_b32 v163, 0xffff0000, v150
    v_lshlrev_b32 v164, 16, v151
    v_and_b32 v165, 0xffff0000, v151
    s_waitcnt vmcnt(26)
    v_lshlrev_b32 v166, 16, v152
    v_and_b32 v167, 0xffff0000, v152
    v_lshlrev_b32 v168, 16, v153
    v_and_b32 v169, 0xffff0000, v153
    v_lshlrev_b32 v170, 16, v154
    v_and_b32 v171, 0xffff0000, v154
    v_lshlrev_b32 v172, 16, v155
    v_and_b32 v173, 0xffff0000, v155
    v_add_f32 v174, v158, v159
    v_add_f32 v175, v166, v167
    v_add_f32 v174, v174, v160
    v_add_f32 v175, v175, v168
    v_add_f32 v174, v174, v161
    v_add_f32 v175, v175, v169
    v_add_f32 v174, v174, v162
    v_add_f32 v175, v175, v170
    v_add_f32 v174, v174, v163
    v_add_f32 v175, v175, v171
    v_add_f32 v174, v174, v164
    v_add_f32 v175, v175, v172
    v_add_f32 v174, v174, v165
    v_add_f32 v175, v175, v173
    s_nop 0
    v_add_f32_dpp v174, v174, v174 quad_perm:[1,0,3,2] row_mask:0xf bank_mask:0xf
    v_add_f32_dpp v175, v175, v175 quad_perm:[1,0,3,2] row_mask:0xf bank_mask:0xf
    s_nop 0
    v_add_f32_dpp v174, v174, v174 quad_perm:[2,3,0,1] row_mask:0xf bank_mask:0xf
    v_add_f32_dpp v175, v175, v175 quad_perm:[2,3,0,1] row_mask:0xf bank_mask:0xf
    s_nop 0
    v_add_f32_dpp v174, v174, v174 row_half_mirror row_mask:0xf bank_mask:0xf
    v_add_f32_dpp v175, v175, v175 row_half_mirror row_mask:0xf bank_mask:0xf
    s_nop 0
    v_add_f32_dpp v174, v174, v174 row_mirror row_mask:0xf bank_mask:0xf
    v_add_f32_dpp v175, v175, v175 row_mirror row_mask:0xf bank_mask:0xf
    v_mov_b32 v176, v174
    v_mov_b32 v177, v175
    s_nop 0
    v_permlane16_swap_b32 v174, v176
    v_permlane16_swap_b32 v175, v177
    v_add_f32 v174, v174, v176
    v_add_f32 v175, v175, v177
    v_mov_b32 v176, v174
    v_mov_b32 v177, v175
    s_nop 0
    v_permlane32_swap_b32 v174, v176
    v_permlane32_swap_b32 v175, v177
    v_add_f32 v174, v174, v176
    v_add_f32 v175, v175, v177
    v_mul_f32 v174, 991054117, v174
    v_mov_b32 v194, 0
    v_mul_f32 v175, 991054117, v175
    v_mov_b32 v195, 0
    s_mov_b32 exec_hi, 0x00ffffff
    v_sub_f32 v178, v158, v174
    v_sub_f32 v186, v166, v175
    v_fmac_f32 v194, v178, v178
    v_fmac_f32 v195, v186, v186
    s_mov_b32 exec_hi, -1
    s_mov_b32 exec_hi, 0x00ffffff
    v_sub_f32 v179, v159, v174
    v_sub_f32 v187, v167, v175
    v_fmac_f32 v194, v179, v179
    v_fmac_f32 v195, v187, v187
    s_mov_b32 exec_hi, -1
    s_waitcnt vmcnt(14)
    s_barrier
    ds_read_b128 v[32:35], v8 offset:0
    ds_read_b64_tr_b16 v[68:69], v10 offset:0
    ds_read_b64_tr_b16 v[70:71], v10 offset:512
    ds_read_b64_tr_b16 v[72:73], v11 offset:0
    ds_read_b64_tr_b16 v[74:75], v11 offset:512
    ds_read_b64_tr_b16 v[76:77], v12 offset:0
    ds_read_b64_tr_b16 v[78:79], v12 offset:512
    ds_read_b64_tr_b16 v[80:81], v13 offset:0
    ds_read_b64_tr_b16 v[82:83], v13 offset:512
    ds_read_b64_tr_b16 v[84:85], v10 offset:4096
    ds_read_b64_tr_b16 v[86:87], v10 offset:4608
    ds_read_b64_tr_b16 v[88:89], v11 offset:4096
    ds_read_b64_tr_b16 v[90:91], v11 offset:4608
    ds_read_b64_tr_b16 v[92:93], v12 offset:4096
    ds_read_b64_tr_b16 v[94:95], v12 offset:4608
    ds_read_b64_tr_b16 v[96:97], v13 offset:4096
    ds_read_b64_tr_b16 v[98:99], v13 offset:4608
    ds_read_b128 v[36:39], v8 offset:2048
    ds_read_b128 v[40:43], v8 offset:4096
    ds_read_b128 v[44:47], v8 offset:6144
    ds_read_b128 v[48:51], v8 offset:8192
    ds_read_b128 v[52:55], v8 offset:10240
    ds_read_b128 v[56:59], v8 offset:12288
    ds_read_b128 v[60:63], v8 offset:14336
    s_cmp_lg_u32 s25, 0
    s_cbranch_scc1 .Lmain_kernel_vpath_6
    s_waitcnt lgkmcnt(15)
    v_mfma_f32_16x16x32_bf16 a[0:3], v[68:71], v[32:35], 0
    s_waitcnt vmcnt(10) lgkmcnt(0)
    v_mfma_f32_16x16x32_bf16 a[4:7], v[72:75], v[32:35], 0
    s_barrier
    v_mfma_f32_16x16x32_bf16 a[16:19], v[76:79], v[32:35], 0
    ds_read_b64_tr_b16 v[100:101], v10 offset:16384
    v_mfma_f32_16x16x32_bf16 a[20:23], v[80:83], v[32:35], 0
    s_add_u32 m0, s28, 32768
    ds_read_b128 v[64:67], v9 offset:14336
    v_mfma_f32_16x16x32_bf16 a[32:35], v[84:87], v[32:35], 0
    buffer_load_dwordx4 v24, s[12:15], s27 offen offset:0 nt lds
    v_mfma_f32_16x16x32_bf16 a[36:39], v[88:91], v[32:35], 0
    ds_read_b64_tr_b16 v[102:103], v10 offset:16896
    v_mfma_f32_16x16x32_bf16 a[48:51], v[92:95], v[32:35], 0
    v_mfma_f32_16x16x32_bf16 a[52:55], v[96:99], v[32:35], 0
    ds_read_b128 v[32:35], v9 offset:0
    buffer_load_dwordx4 v25, s[12:15], s27 offen offset:1024 nt lds
    v_mfma_f32_16x16x32_bf16 a[8:11], v[68:71], v[36:39], 0
    ds_read_b64_tr_b16 v[104:105], v11 offset:16384
    v_mfma_f32_16x16x32_bf16 a[12:15], v[72:75], v[36:39], 0
    s_mov_b32 exec_hi, 0x00ffffff
    v_sub_f32 v180, v160, v174
    v_sub_f32 v188, v168, v175
    v_fmac_f32 v194, v180, v180
    v_fmac_f32 v195, v188, v188
    s_mov_b32 exec_hi, -1
    v_mfma_f32_16x16x32_bf16 a[24:27], v[76:79], v[36:39], 0
    buffer_load_dwordx4 v26, s[12:15], s27 offen offset:2048 nt lds
    v_mfma_f32_16x16x32_bf16 a[28:31], v[80:83], v[36:39], 0
    ds_read_b64_tr_b16 v[106:107], v11 offset:16896
    v_mfma_f32_16x16x32_bf16 a[40:43], v[84:87], v[36:39], 0
    s_mov_b32 exec_hi, 0x00ffffff
    v_sub_f32 v181, v161, v174
    v_sub_f32 v189, v169, v175
    v_fmac_f32 v194, v181, v181
    v_fmac_f32 v195, v189, v189
    s_mov_b32 exec_hi, -1
    v_mfma_f32_16x16x32_bf16 a[44:47], v[88:91], v[36:39], 0
    buffer_load_dwordx4 v27, s[12:15], s27 offen offset:3072 nt lds
    s_mov_b32 exec_hi, 0x00ffffff
    v_sub_f32 v182, v162, v174
    v_sub_f32 v190, v170, v175
    v_fmac_f32 v194, v182, v182
    v_fmac_f32 v195, v190, v190
    s_mov_b32 exec_hi, -1
    v_mfma_f32_16x16x32_bf16 a[56:59], v[92:95], v[36:39], 0
    s_add_u32 s27, s27, 262144
    ds_read_b64_tr_b16 v[108:109], v12 offset:16384
    v_mfma_f32_16x16x32_bf16 a[60:63], v[96:99], v[36:39], 0
    s_add_u32 m0, s28, 49152
    ds_read_b128 v[36:39], v9 offset:2048
    v_mfma_f32_16x16x32_bf16 a[64:67], v[68:71], v[40:43], 0
    buffer_load_dwordx4 v24, s[12:15], s27 offen offset:0 nt lds
    v_mfma_f32_16x16x32_bf16 a[68:71], v[72:75], v[40:43], 0
    ds_read_b64_tr_b16 v[110:111], v12 offset:16896
    v_mfma_f32_16x16x32_bf16 a[80:83], v[76:79], v[40:43], 0
    s_mov_b32 exec_hi, 0x00ffffff
    v_sub_f32 v183, v163, v174
    v_sub_f32 v191, v171, v175
    v_fmac_f32 v194, v183, v183
    v_fmac_f32 v195, v191, v191
    s_mov_b32 exec_hi, -1
    v_mfma_f32_16x16x32_bf16 a[84:87], v[80:83], v[40:43], 0
    buffer_load_dwordx4 v25, s[12:15], s27 offen offset:1024 nt lds
    v_mfma_f32_16x16x32_bf16 a[96:99], v[84:87], v[40:43], 0
    ds_read_b64_tr_b16 v[112:113], v13 offset:16384
    v_mfma_f32_16x16x32_bf16 a[100:103], v[88:91], v[40:43], 0
    s_mov_b32 exec_hi, 0x00ffffff
    v_sub_f32 v184, v164, v174
    v_sub_f32 v192, v172, v175
    v_fmac_f32 v194, v184, v184
    v_fmac_f32 v195, v192, v192
    s_mov_b32 exec_hi, -1
    v_mfma_f32_16x16x32_bf16 a[112:115], v[92:95], v[40:43], 0
    buffer_load_dwordx4 v26, s[12:15], s27 offen offset:2048 nt lds
    v_mfma_f32_16x16x32_bf16 a[116:119], v[96:99], v[40:43], 0
    ds_read_b64_tr_b16 v[114:115], v13 offset:16896
    ds_read_b128 v[40:43], v9 offset:4096
    v_mfma_f32_16x16x32_bf16 a[72:75], v[68:71], v[44:47], 0
    s_mov_b32 exec_hi, 0x00ffffff
    v_sub_f32 v185, v165, v174
    v_sub_f32 v193, v173, v175
    v_fmac_f32 v194, v185, v185
    v_fmac_f32 v195, v193, v193
    s_mov_b32 exec_hi, -1
    v_mfma_f32_16x16x32_bf16 a[76:79], v[72:75], v[44:47], 0
    buffer_load_dwordx4 v27, s[12:15], s27 offen offset:3072 nt lds
    v_add_f32_dpp v194, v194, v194 quad_perm:[1,0,3,2] row_mask:0xf bank_mask:0xf
    v_mfma_f32_16x16x32_bf16 a[88:91], v[76:79], v[44:47], 0
    s_add_u32 s27, s27, 262144
    ds_read_b64_tr_b16 v[116:117], v10 offset:20480
    v_add_f32_dpp v195, v195, v195 quad_perm:[1,0,3,2] row_mask:0xf bank_mask:0xf
    v_mfma_f32_16x16x32_bf16 a[92:95], v[80:83], v[44:47], 0
    s_add_u32 m0, s33, 0
    v_add_f32_dpp v194, v194, v194 quad_perm:[2,3,0,1] row_mask:0xf bank_mask:0xf
    v_add_f32_dpp v195, v195, v195 quad_perm:[2,3,0,1] row_mask:0xf bank_mask:0xf
    v_mfma_f32_16x16x32_bf16 a[104:107], v[84:87], v[44:47], 0
    buffer_load_dwordx4 v16, s[8:11], s26 offen offset:0 lds
    v_add_f32_dpp v194, v194, v194 row_half_mirror row_mask:0xf bank_mask:0xf
    v_mfma_f32_16x16x32_bf16 a[108:111], v[88:91], v[44:47], 0
    ds_read_b64_tr_b16 v[118:119], v10 offset:20992
    v_add_f32_dpp v195, v195, v195 row_half_mirror row_mask:0xf bank_mask:0xf
    v_mfma_f32_16x16x32_bf16 a[120:123], v[92:95], v[44:47], 0
    v_add_f32_dpp v194, v194, v194 row_mirror row_mask:0xf bank_mask:0xf
    v_add_f32_dpp v195, v195, v195 row_mirror row_mask:0xf bank_mask:0xf
    v_mfma_f32_16x16x32_bf16 a[124:127], v[96:99], v[44:47], 0
    ds_read_b128 v[44:47], v9 offset:6144
    buffer_load_dwordx4 v17, s[8:11], s26 offen offset:1024 lds
    v_mfma_f32_16x16x32_bf16 a[128:131], v[68:71], v[48:51], 0
    ds_read_b64_tr_b16 v[120:121], v11 offset:20480
    v_mov_b32 v176, v194
    v_mfma_f32_16x16x32_bf16 a[132:135], v[72:75], v[48:51], 0
    v_mov_b32 v177, v195
    v_permlane16_swap_b32 v194, v176
    v_mfma_f32_16x16x32_bf16 a[144:147], v[76:79], v[48:51], 0
    buffer_load_dwordx4 v18, s[8:11], s26 offen offset:2048 lds
    v_permlane16_swap_b32 v195, v177
    v_mfma_f32_16x16x32_bf16 a[148:151], v[80:83], v[48:51], 0
    ds_read_b64_tr_b16 v[122:123], v11 offset:20992
    v_add_f32 v194, v194, v176
    v_mfma_f32_16x16x32_bf16 a[160:163], v[84:87], v[48:51], 0
    v_add_f32 v195, v195, v177
    v_mov_b32 v176, v194
    v_mfma_f32_16x16x32_bf16 a[164:167], v[88:91], v[48:51], 0
    buffer_load_dwordx4 v19, s[8:11], s26 offen offset:3072 lds
    v_mov_b32 v177, v195
    v_mfma_f32_16x16x32_bf16 a[176:179], v[92:95], v[48:51], 0
    ds_read_b64_tr_b16 v[124:125], v12 offset:20480
    v_permlane32_swap_b32 v194, v176
    v_mfma_f32_16x16x32_bf16 a[180:183], v[96:99], v[48:51], 0
    s_add_u32 m0, s28, 0
    ds_read_b128 v[48:51], v9 offset:8192
    v_permlane32_swap_b32 v195, v177
    v_mfma_f32_16x16x32_bf16 a[136:139], v[68:71], v[52:55], 0
    buffer_load_dwordx4 v24, s[12:15], s27 offen offset:0 nt lds
    v_add_f32 v194, v194, v176
    v_mfma_f32_16x16x32_bf16 a[140:143], v[72:75], v[52:55], 0
    ds_read_b64_tr_b16 v[126:127], v12 offset:20992
    v_add_f32 v195, v195, v177
    v_mfma_f32_16x16x32_bf16 a[152:155], v[76:79], v[52:55], 0
    v_cvt_pk_bf16_f32 v174, v174, v174
    v_lshlrev_b32 v174, 16, v174
    v_mfma_f32_16x16x32_bf16 a[156:159], v[80:83], v[52:55], 0
    buffer_load_dwordx4 v25, s[12:15], s27 offen offset:1024 nt lds
    v_mul_f32 v194, 991054117, v194
    v_mfma_f32_16x16x32_bf16 a[168:171], v[84:87], v[52:55], 0
    ds_read_b64_tr_b16 v[128:129], v13 offset:20480
    v_cvt_pk_bf16_f32 v194, v194, v194
    v_mfma_f32_16x16x32_bf16 a[172:175], v[88:91], v[52:55], 0
    v_lshlrev_b32 v194, 16, v194
    v_add_f32 v194, 925353388, v194
    v_mfma_f32_16x16x32_bf16 a[184:187], v[92:95], v[52:55], 0
    buffer_load_dwordx4 v26, s[12:15], s27 offen offset:2048 nt lds
    v_cvt_pk_bf16_f32 v194, v194, v194
    v_lshlrev_b32 v194, 16, v194
    v_mfma_f32_16x16x32_bf16 a[188:191], v[96:99], v[52:55], 0
    ds_read_b64_tr_b16 v[130:131], v13 offset:20992
    ds_read_b128 v[52:55], v9 offset:10240
    v_sqrt_f32 v194, v194
    v_mfma_f32_16x16x32_bf16 a[192:195], v[68:71], v[56:59], 0
    v_cvt_pk_bf16_f32 v194, v194, v194
    v_lshlrev_b32 v194, 16, v194
    v_mfma_f32_16x16x32_bf16 a[196:199], v[72:75], v[56:59], 0
    buffer_load_dwordx4 v27, s[12:15], s27 offen offset:3072 nt lds
    v_rcp_f32 v194, v194
    v_mfma_f32_16x16x32_bf16 a[208:211], v[76:79], v[56:59], 0
    s_add_u32 s27, s27, 262144
    v_cvt_pk_bf16_f32 v175, v175, v175
    v_lshlrev_b32 v175, 16, v175
    v_mfma_f32_16x16x32_bf16 a[212:215], v[80:83], v[56:59], 0
    s_add_u32 m0, s33, 4096
    v_mul_f32 v195, 991054117, v195
    v_mfma_f32_16x16x32_bf16 a[224:227], v[84:87], v[56:59], 0
    s_add_u32 s33, s35, s34
    buffer_load_dwordx4 v20, s[8:11], s26 offen offset:0 lds
    v_cvt_pk_bf16_f32 v195, v195, v195
    v_mfma_f32_16x16x32_bf16 a[228:231], v[88:91], v[56:59], 0
    s_add_u32 s34, s34, 32768
    v_lshlrev_b32 v195, 16, v195
    v_add_f32 v195, 925353388, v195
    v_mfma_f32_16x16x32_bf16 a[240:243], v[92:95], v[56:59], 0
    v_cvt_pk_bf16_f32 v195, v195, v195
    v_lshlrev_b32 v195, 16, v195
    v_sqrt_f32 v195, v195
    v_mfma_f32_16x16x32_bf16 a[244:247], v[96:99], v[56:59], 0
    s_cmp_eq_u32 s34, 98304
    ds_read_b128 v[56:59], v9 offset:12288
    buffer_load_dwordx4 v21, s[8:11], s26 offen offset:1024 lds
    v_mfma_f32_16x16x32_bf16 a[200:203], v[68:71], v[60:63], 0
    s_cselect_b32 s34, 0, s34
    v_cvt_pk_bf16_f32 v195, v195, v195
    v_lshlrev_b32 v195, 16, v195
    v_mfma_f32_16x16x32_bf16 a[204:207], v[72:75], v[60:63], 0
    v_rcp_f32 v195, v195
    v_mfma_f32_16x16x32_bf16 a[216:219], v[76:79], v[60:63], 0
    buffer_load_dwordx4 v22, s[8:11], s26 offen offset:2048 lds
    v_add_u32 v8, s34, v28
    v_mfma_f32_16x16x32_bf16 a[220:223], v[80:83], v[60:63], 0
    v_add_u32 v9, s34, v29
    v_sub_f32 v178, v158, v174
    v_mfma_f32_16x16x32_bf16 a[232:235], v[84:87], v[60:63], 0
    v_xor_b32 v10, 0x8000, v10
    v_sub_f32 v179, v159, v174
    v_sub_f32 v180, v160, v174
    v_mfma_f32_16x16x32_bf16 a[236:239], v[88:91], v[60:63], 0
    buffer_load_dwordx4 v23, s[8:11], s26 offen offset:3072 lds
    v_xor_b32 v11, 0x8000, v11
    v_sub_f32 v181, v161, v174
    v_sub_f32 v182, v162, v174
    v_mfma_f32_16x16x32_bf16 a[248:251], v[92:95], v[60:63], 0
    s_waitcnt lgkmcnt(15)
    s_add_u32 s26, s26, 128
    v_xor_b32 v12, 0x8000, v12
    v_sub_f32 v183, v163, v174
    v_mfma_f32_16x16x32_bf16 a[252:255], v[96:99], v[60:63], 0
    v_xor_b32 v13, 0x8000, v13
    v_sub_f32 v184, v164, v174
    v_sub_f32 v185, v165, v174
    v_cvt_pk_bf16_f32 v158, v178, v179
    v_mfma_f32_16x16x32_bf16 a[0:3], v[100:103], v[32:35], a[0:3]
    s_waitcnt vmcnt(16) lgkmcnt(0)
    v_cvt_pk_bf16_f32 v159, v180, v181
    v_mfma_f32_16x16x32_bf16 a[4:7], v[104:107], v[32:35], a[4:7]
    s_barrier
    v_mfma_f32_16x16x32_bf16 a[16:19], v[108:111], v[32:35], a[16:19]
    ds_read_b64_tr_b16 v[68:69], v10 offset:0
    v_cvt_pk_bf16_f32 v160, v182, v183
    v_mfma_f32_16x16x32_bf16 a[20:23], v[112:115], v[32:35], a[20:23]
    s_add_u32 m0, s28, 16384
    ds_read_b128 v[60:63], v8 offset:14336
    v_cvt_pk_bf16_f32 v161, v184, v185
    v_mfma_f32_16x16x32_bf16 a[32:35], v[116:119], v[32:35], a[32:35]
    buffer_load_dwordx4 v24, s[12:15], s27 offen offset:0 nt lds
    v_lshlrev_b32 v178, 16, v158
    v_mfma_f32_16x16x32_bf16 a[36:39], v[120:123], v[32:35], a[36:39]
    ds_read_b64_tr_b16 v[70:71], v10 offset:512
    v_and_b32 v179, 0xffff0000, v158
    v_mfma_f32_16x16x32_bf16 a[48:51], v[124:127], v[32:35], a[48:51]
    v_lshlrev_b32 v180, 16, v159
    v_and_b32 v181, 0xffff0000, v159
    v_mfma_f32_16x16x32_bf16 a[52:55], v[128:131], v[32:35], a[52:55]
    ds_read_b128 v[32:35], v8 offset:0
    v_lshlrev_b32 v182, 16, v160
    v_mfma_f32_16x16x32_bf16 a[8:11], v[100:103], v[36:39], a[8:11]
    ds_read_b64_tr_b16 v[72:73], v11 offset:0
    v_and_b32 v183, 0xffff0000, v160
    v_mfma_f32_16x16x32_bf16 a[12:15], v[104:107], v[36:39], a[12:15]
    v_lshlrev_b32 v184, 16, v161
    v_mfma_f32_16x16x32_bf16 a[24:27], v[108:111], v[36:39], a[24:27]
    v_and_b32 v185, 0xffff0000, v161
    v_mfma_f32_16x16x32_bf16 a[28:31], v[112:115], v[36:39], a[28:31]
    ds_read_b64_tr_b16 v[74:75], v11 offset:512
    buffer_load_dwordx4 v25, s[12:15], s27 offen offset:1024 nt lds
    v_mfma_f32_16x16x32_bf16 a[40:43], v[116:119], v[36:39], a[40:43]
    v_mul_f32 v178, v178, v194
    v_mul_f32 v179, v179, v194
    v_mfma_f32_16x16x32_bf16 a[44:47], v[120:123], v[36:39], a[44:47]
    v_mul_f32 v180, v180, v194
    v_mfma_f32_16x16x32_bf16 a[56:59], v[124:127], v[36:39], a[56:59]
    ds_read_b64_tr_b16 v[76:77], v12 offset:0
    v_mul_f32 v181, v181, v194
    v_mfma_f32_16x16x32_bf16 a[60:63], v[128:131], v[36:39], a[60:63]
    ds_read_b128 v[36:39], v8 offset:2048
    v_mul_f32 v182, v182, v194
    v_mfma_f32_16x16x32_bf16 a[64:67], v[100:103], v[40:43], a[64:67]
    v_mul_f32 v183, v183, v194
    v_mfma_f32_16x16x32_bf16 a[68:71], v[104:107], v[40:43], a[68:71]
    ds_read_b64_tr_b16 v[78:79], v12 offset:512
    v_mul_f32 v184, v184, v194
    v_mfma_f32_16x16x32_bf16 a[80:83], v[108:111], v[40:43], a[80:83]
    buffer_load_dwordx4 v26, s[12:15], s27 offen offset:2048 nt lds
    v_mul_f32 v185, v185, v194
    v_mfma_f32_16x16x32_bf16 a[84:87], v[112:115], v[40:43], a[84:87]
    v_cvt_pk_bf16_f32 v148, v178, v179
    v_mfma_f32_16x16x32_bf16 a[96:99], v[116:119], v[40:43], a[96:99]
    ds_read_b64_tr_b16 v[80:81], v13 offset:0
    v_cvt_pk_bf16_f32 v149, v180, v181
    v_mfma_f32_16x16x32_bf16 a[100:103], v[120:123], v[40:43], a[100:103]
    v_cvt_pk_bf16_f32 v150, v182, v183
    v_mfma_f32_16x16x32_bf16 a[112:115], v[124:127], v[40:43], a[112:115]
    v_cvt_pk_bf16_f32 v151, v184, v185
    v_mfma_f32_16x16x32_bf16 a[116:119], v[128:131], v[40:43], a[116:119]
    ds_read_b64_tr_b16 v[82:83], v13 offset:512
    ds_read_b128 v[40:43], v8 offset:4096
    v_mfma_f32_16x16x32_bf16 a[72:75], v[100:103], v[44:47], a[72:75]
    v_sub_f32 v186, v166, v175
    v_sub_f32 v187, v167, v175
    v_mfma_f32_16x16x32_bf16 a[76:79], v[104:107], v[44:47], a[76:79]
    buffer_load_dwordx4 v27, s[12:15], s27 offen offset:3072 nt lds
    v_sub_f32 v188, v168, v175
    v_mfma_f32_16x16x32_bf16 a[88:91], v[108:111], v[44:47], a[88:91]
    s_add_u32 s27, s27, 262144
    ds_read_b64_tr_b16 v[84:85], v10 offset:4096
    v_sub_f32 v189, v169, v175
    v_mfma_f32_16x16x32_bf16 a[92:95], v[112:115], v[44:47], a[92:95]
    s_xor_b32 s28, s28, 0x8000
    v_sub_f32 v190, v170, v175
    v_mfma_f32_16x16x32_bf16 a[104:107], v[116:119], v[44:47], a[104:107]
    v_sub_f32 v191, v171, v175
    v_mfma_f32_16x16x32_bf16 a[108:111], v[120:123], v[44:47], a[108:111]
    ds_read_b64_tr_b16 v[86:87], v10 offset:4608
    v_sub_f32 v192, v172, v175
    v_mfma_f32_16x16x32_bf16 a[120:123], v[124:127], v[44:47], a[120:123]
    v_sub_f32 v193, v173, v175
    v_mfma_f32_16x16x32_bf16 a[124:127], v[128:131], v[44:47], a[124:127]
    s_add_u32 m0, s33, 0
    ds_read_b128 v[44:47], v8 offset:6144
    v_cvt_pk_bf16_f32 v166, v186, v187
    v_mfma_f32_16x16x32_bf16 a[128:131], v[100:103], v[48:51], a[128:131]
    ds_read_b64_tr_b16 v[88:89], v11 offset:4096
    buffer_load_dwordx4 v16, s[8:11], s26 offen offset:0 lds
    v_mfma_f32_16x16x32_bf16 a[132:135], v[104:107], v[48:51], a[132:135]
    v_cvt_pk_bf16_f32 v167, v188, v189
    v_cvt_pk_bf16_f32 v168, v190, v191
    v_mfma_f32_16x16x32_bf16 a[144:147], v[108:111], v[48:51], a[144:147]
    v_cvt_pk_bf16_f32 v169, v192, v193
    v_mfma_f32_16x16x32_bf16 a[148:151], v[112:115], v[48:51], a[148:151]
    ds_read_b64_tr_b16 v[90:91], v11 offset:4608
    v_lshlrev_b32 v186, 16, v166
    v_mfma_f32_16x16x32_bf16 a[160:163], v[116:119], v[48:51], a[160:163]
    v_and_b32 v187, 0xffff0000, v166
    v_mfma_f32_16x16x32_bf16 a[164:167], v[120:123], v[48:51], a[164:167]
    v_lshlrev_b32 v188, 16, v167
    v_mfma_f32_16x16x32_bf16 a[176:179], v[124:127], v[48:51], a[176:179]
    ds_read_b64_tr_b16 v[92:93], v12 offset:4096
    v_and_b32 v189, 0xffff0000, v167
    v_mfma_f32_16x16x32_bf16 a[180:183], v[128:131], v[48:51], a[180:183]
    ds_read_b128 v[48:51], v8 offset:8192
    buffer_load_dwordx4 v17, s[8:11], s26 offen offset:1024 lds
    v_mfma_f32_16x16x32_bf16 a[136:139], v[100:103], v[52:55], a[136:139]
    v_lshlrev_b32 v190, 16, v168
    v_and_b32 v191, 0xffff0000, v168
    v_mfma_f32_16x16x32_bf16 a[140:143], v[104:107], v[52:55], a[140:143]
    ds_read_b64_tr_b16 v[94:95], v12 offset:4608
    v_lshlrev_b32 v192, 16, v169
    v_mfma_f32_16x16x32_bf16 a[152:155], v[108:111], v[52:55], a[152:155]
    v_and_b32 v193, 0xffff0000, v169
    v_mfma_f32_16x16x32_bf16 a[156:159], v[112:115], v[52:55], a[156:159]
    v_mul_f32 v186, v186, v195
    v_mfma_f32_16x16x32_bf16 a[168:171], v[116:119], v[52:55], a[168:171]
    ds_read_b64_tr_b16 v[96:97], v13 offset:4096
    v_mul_f32 v187, v187, v195
    v_mfma_f32_16x16x32_bf16 a[172:175], v[120:123], v[52:55], a[172:175]
    v_mul_f32 v188, v188, v195
    v_mfma_f32_16x16x32_bf16 a[184:187], v[124:127], v[52:55], a[184:187]
    buffer_load_dwordx4 v18, s[8:11], s26 offen offset:2048 lds
    v_mul_f32 v189, v189, v195
    v_mfma_f32_16x16x32_bf16 a[188:191], v[128:131], v[52:55], a[188:191]
    ds_read_b64_tr_b16 v[98:99], v13 offset:4608
    ds_read_b128 v[52:55], v8 offset:10240
    v_mfma_f32_16x16x32_bf16 a[192:195], v[100:103], v[56:59], a[192:195]
    v_mul_f32 v190, v190, v195
    v_mul_f32 v191, v191, v195
    v_mfma_f32_16x16x32_bf16 a[196:199], v[104:107], v[56:59], a[196:199]
    v_mul_f32 v192, v192, v195
    v_mfma_f32_16x16x32_bf16 a[208:211], v[108:111], v[56:59], a[208:211]
    v_mul_f32 v193, v193, v195
    v_mfma_f32_16x16x32_bf16 a[212:215], v[112:115], v[56:59], a[212:215]
    v_cvt_pk_bf16_f32 v152, v186, v187
    v_mfma_f32_16x16x32_bf16 a[224:227], v[116:119], v[56:59], a[224:227]
    v_cvt_pk_bf16_f32 v153, v188, v189
    v_mfma_f32_16x16x32_bf16 a[228:231], v[120:123], v[56:59], a[228:231]
    buffer_load_dwordx4 v19, s[8:11], s26 offen offset:3072 lds
    v_cvt_pk_bf16_f32 v154, v190, v191
    v_mfma_f32_16x16x32_bf16 a[240:243], v[124:127], v[56:59], a[240:243]
    v_cvt_pk_bf16_f32 v155, v192, v193
    v_mfma_f32_16x16x32_bf16 a[244:247], v[128:131], v[56:59], a[244:247]
    s_add_u32 s64, s58, 37748736
    s_addc_u32 s65, s59, 0
    ds_read_b128 v[56:59], v8 offset:12288
    v_mfma_f32_16x16x32_bf16 a[200:203], v[100:103], v[64:67], a[200:203]
    v_mfma_f32_16x16x32_bf16 a[204:207], v[104:107], v[64:67], a[204:207]
    s_and_b32 s65, s65, 0xffff
    v_mfma_f32_16x16x32_bf16 a[216:219], v[108:111], v[64:67], a[216:219]
    s_mov_b32 s66, 1835008
    v_mfma_f32_16x16x32_bf16 a[220:223], v[112:115], v[64:67], a[220:223]
    s_mov_b32 s67, 0x00020000
    v_mfma_f32_16x16x32_bf16 a[232:235], v[116:119], v[64:67], a[232:235]
    s_mov_b32 exec_hi, 0x00ffffff
    buffer_store_dwordx4 v[148:151], v156, s[64:67], s63 offen sc1
    buffer_store_dwordx4 v[152:155], v156, s[64:67], s63 offen offset:896 sc1
    s_mov_b32 exec_hi, -1
    v_mfma_f32_16x16x32_bf16 a[236:239], v[120:123], v[64:67], a[236:239]
    v_mfma_f32_16x16x32_bf16 a[248:251], v[124:127], v[64:67], a[248:251]
    s_waitcnt lgkmcnt(15)
    v_mfma_f32_16x16x32_bf16 a[252:255], v[128:131], v[64:67], a[252:255]
.p2align 6
.Lmain_kernel_loop_8:
    v_mfma_f32_16x16x32_bf16 a[0:3], v[68:71], v[32:35], a[0:3]
    s_waitcnt vmcnt(17) lgkmcnt(0)
    v_mfma_f32_16x16x32_bf16 a[4:7], v[72:75], v[32:35], a[4:7]
    s_barrier
    v_mfma_f32_16x16x32_bf16 a[16:19], v[76:79], v[32:35], a[16:19]
    ds_read_b64_tr_b16 v[100:101], v10 offset:16384
    buffer_load_dword v255, v250, s[96:99], s78 offen
    v_mfma_f32_16x16x32_bf16 a[20:23], v[80:83], v[32:35], a[20:23]
    s_add_u32 m0, s28, 0
    ds_read_b128 v[64:67], v9 offset:14336
    v_mfma_f32_16x16x32_bf16 a[32:35], v[84:87], v[32:35], a[32:35]
    buffer_load_dwordx4 v24, s[12:15], s27 offen offset:0 nt lds
    v_mfma_f32_16x16x32_bf16 a[36:39], v[88:91], v[32:35], a[36:39]
    ds_read_b64_tr_b16 v[102:103], v10 offset:16896
    v_mfma_f32_16x16x32_bf16 a[48:51], v[92:95], v[32:35], a[48:51]
    v_mfma_f32_16x16x32_bf16 a[52:55], v[96:99], v[32:35], a[52:55]
    ds_read_b128 v[32:35], v9 offset:0
    v_mfma_f32_16x16x32_bf16 a[8:11], v[68:71], v[36:39], a[8:11]
    ds_read_b64_tr_b16 v[104:105], v11 offset:16384
    v_mfma_f32_16x16x32_bf16 a[12:15], v[72:75], v[36:39], a[12:15]
    s_add_u32 s78, s78, s44
    s_cmp_eq_u32 s29, s7
    v_mfma_f32_16x16x32_bf16 a[24:27], v[76:79], v[36:39], a[24:27]
    s_cbranch_scc1 .Lmain_kernel_sd_9
.Lmain_kernel_sdr_10:
    v_mfma_f32_16x16x32_bf16 a[28:31], v[80:83], v[36:39], a[28:31]
    ds_read_b64_tr_b16 v[106:107], v11 offset:16896
    buffer_load_dwordx4 v25, s[12:15], s27 offen offset:1024 nt lds
    v_mfma_f32_16x16x32_bf16 a[40:43], v[84:87], v[36:39], a[40:43]
    v_mfma_f32_16x16x32_bf16 a[44:47], v[88:91], v[36:39], a[44:47]
    v_mfma_f32_16x16x32_bf16 a[56:59], v[92:95], v[36:39], a[56:59]
    ds_read_b64_tr_b16 v[108:109], v12 offset:16384
    v_mfma_f32_16x16x32_bf16 a[60:63], v[96:99], v[36:39], a[60:63]
    ds_read_b128 v[36:39], v9 offset:2048
    v_mfma_f32_16x16x32_bf16 a[64:67], v[68:71], v[40:43], a[64:67]
    v_mfma_f32_16x16x32_bf16 a[68:71], v[72:75], v[40:43], a[68:71]
    ds_read_b64_tr_b16 v[110:111], v12 offset:16896
    v_mfma_f32_16x16x32_bf16 a[80:83], v[76:79], v[40:43], a[80:83]
    buffer_load_dwordx4 v26, s[12:15], s27 offen offset:2048 nt lds
    v_mfma_f32_16x16x32_bf16 a[84:87], v[80:83], v[40:43], a[84:87]
    v_mfma_f32_16x16x32_bf16 a[96:99], v[84:87], v[40:43], a[96:99]
    ds_read_b64_tr_b16 v[112:113], v13 offset:16384
    v_mfma_f32_16x16x32_bf16 a[100:103], v[88:91], v[40:43], a[100:103]
    v_mfma_f32_16x16x32_bf16 a[112:115], v[92:95], v[40:43], a[112:115]
    v_mfma_f32_16x16x32_bf16 a[116:119], v[96:99], v[40:43], a[116:119]
    ds_read_b64_tr_b16 v[114:115], v13 offset:16896
    ds_read_b128 v[40:43], v9 offset:4096
    v_mfma_f32_16x16x32_bf16 a[72:75], v[68:71], v[44:47], a[72:75]
    v_mfma_f32_16x16x32_bf16 a[76:79], v[72:75], v[44:47], a[76:79]
    buffer_load_dwordx4 v27, s[12:15], s27 offen offset:3072 nt lds
    v_mfma_f32_16x16x32_bf16 a[88:91], v[76:79], v[44:47], a[88:91]
    s_add_u32 s27, s27, 262144
    ds_read_b64_tr_b16 v[116:117], v10 offset:20480
    v_mfma_f32_16x16x32_bf16 a[92:95], v[80:83], v[44:47], a[92:95]
    v_mfma_f32_16x16x32_bf16 a[104:107], v[84:87], v[44:47], a[104:107]
    v_mfma_f32_16x16x32_bf16 a[108:111], v[88:91], v[44:47], a[108:111]
    ds_read_b64_tr_b16 v[118:119], v10 offset:20992
    v_mfma_f32_16x16x32_bf16 a[120:123], v[92:95], v[44:47], a[120:123]
    v_mfma_f32_16x16x32_bf16 a[124:127], v[96:99], v[44:47], a[124:127]
    s_add_u32 m0, s33, 4096
    ds_read_b128 v[44:47], v9 offset:6144
    v_mfma_f32_16x16x32_bf16 a[128:131], v[68:71], v[48:51], a[128:131]
    ds_read_b64_tr_b16 v[120:121], v11 offset:20480
    buffer_load_dwordx4 v20, s[8:11], s26 offen offset:0 lds
    v_mfma_f32_16x16x32_bf16 a[132:135], v[72:75], v[48:51], a[132:135]
    v_mfma_f32_16x16x32_bf16 a[144:147], v[76:79], v[48:51], a[144:147]
    v_mfma_f32_16x16x32_bf16 a[148:151], v[80:83], v[48:51], a[148:151]
    ds_read_b64_tr_b16 v[122:123], v11 offset:20992
    v_mfma_f32_16x16x32_bf16 a[160:163], v[84:87], v[48:51], a[160:163]
    v_mfma_f32_16x16x32_bf16 a[164:167], v[88:91], v[48:51], a[164:167]
    v_mfma_f32_16x16x32_bf16 a[176:179], v[92:95], v[48:51], a[176:179]
    ds_read_b64_tr_b16 v[124:125], v12 offset:20480
    v_mfma_f32_16x16x32_bf16 a[180:183], v[96:99], v[48:51], a[180:183]
    ds_read_b128 v[48:51], v9 offset:8192
    buffer_load_dwordx4 v21, s[8:11], s26 offen offset:1024 lds
    v_mfma_f32_16x16x32_bf16 a[136:139], v[68:71], v[52:55], a[136:139]
    s_add_u32 s33, s35, s34
    v_mfma_f32_16x16x32_bf16 a[140:143], v[72:75], v[52:55], a[140:143]
    ds_read_b64_tr_b16 v[126:127], v12 offset:20992
    v_mfma_f32_16x16x32_bf16 a[152:155], v[76:79], v[52:55], a[152:155]
    v_mfma_f32_16x16x32_bf16 a[156:159], v[80:83], v[52:55], a[156:159]
    v_mfma_f32_16x16x32_bf16 a[168:171], v[84:87], v[52:55], a[168:171]
    s_add_u32 s34, s34, 32768
    ds_read_b64_tr_b16 v[128:129], v13 offset:20480
    v_mfma_f32_16x16x32_bf16 a[172:175], v[88:91], v[52:55], a[172:175]
    v_mfma_f32_16x16x32_bf16 a[184:187], v[92:95], v[52:55], a[184:187]
    buffer_load_dwordx4 v22, s[8:11], s26 offen offset:2048 lds
    v_mfma_f32_16x16x32_bf16 a[188:191], v[96:99], v[52:55], a[188:191]
    ds_read_b64_tr_b16 v[130:131], v13 offset:20992
    ds_read_b128 v[52:55], v9 offset:10240
    v_mfma_f32_16x16x32_bf16 a[192:195], v[68:71], v[56:59], a[192:195]
    s_cmp_eq_u32 s34, 98304
    s_cselect_b32 s34, 0, s34
    v_mfma_f32_16x16x32_bf16 a[196:199], v[72:75], v[56:59], a[196:199]
    v_mfma_f32_16x16x32_bf16 a[208:211], v[76:79], v[56:59], a[208:211]
    v_mfma_f32_16x16x32_bf16 a[212:215], v[80:83], v[56:59], a[212:215]
    v_mfma_f32_16x16x32_bf16 a[224:227], v[84:87], v[56:59], a[224:227]
    v_mfma_f32_16x16x32_bf16 a[228:231], v[88:91], v[56:59], a[228:231]
    buffer_load_dwordx4 v23, s[8:11], s26 offen offset:3072 lds
    v_mfma_f32_16x16x32_bf16 a[240:243], v[92:95], v[56:59], a[240:243]
    s_add_u32 s26, s26, 128
    v_mfma_f32_16x16x32_bf16 a[244:247], v[96:99], v[56:59], a[244:247]
    ds_read_b128 v[56:59], v9 offset:12288
    v_mfma_f32_16x16x32_bf16 a[200:203], v[68:71], v[60:63], a[200:203]
    v_add_u32 v8, s34, v28
    v_mfma_f32_16x16x32_bf16 a[204:207], v[72:75], v[60:63], a[204:207]
    v_add_u32 v9, s34, v29
    v_mfma_f32_16x16x32_bf16 a[216:219], v[76:79], v[60:63], a[216:219]
    v_xor_b32 v10, 0x8000, v10
    v_mfma_f32_16x16x32_bf16 a[220:223], v[80:83], v[60:63], a[220:223]
    v_mfma_f32_16x16x32_bf16 a[232:235], v[84:87], v[60:63], a[232:235]
    v_xor_b32 v11, 0x8000, v11
    v_mfma_f32_16x16x32_bf16 a[236:239], v[88:91], v[60:63], a[236:239]
    v_xor_b32 v12, 0x8000, v12
    v_mfma_f32_16x16x32_bf16 a[248:251], v[92:95], v[60:63], a[248:251]
    s_waitcnt lgkmcnt(15)
    v_xor_b32 v13, 0x8000, v13
    v_mfma_f32_16x16x32_bf16 a[252:255], v[96:99], v[60:63], a[252:255]
    v_mfma_f32_16x16x32_bf16 a[0:3], v[100:103], v[32:35], a[0:3]
    s_waitcnt vmcnt(17) lgkmcnt(0)
    v_mfma_f32_16x16x32_bf16 a[4:7], v[104:107], v[32:35], a[4:7]
    s_barrier
    v_mfma_f32_16x16x32_bf16 a[16:19], v[108:111], v[32:35], a[16:19]
    ds_read_b64_tr_b16 v[68:69], v10 offset:0
    v_mfma_f32_16x16x32_bf16 a[20:23], v[112:115], v[32:35], a[20:23]
    s_add_u32 m0, s28, 16384
    ds_read_b128 v[60:63], v8 offset:14336
    v_mfma_f32_16x16x32_bf16 a[32:35], v[116:119], v[32:35], a[32:35]
    buffer_load_dwordx4 v24, s[12:15], s27 offen offset:0 nt lds
    v_mfma_f32_16x16x32_bf16 a[36:39], v[120:123], v[32:35], a[36:39]
    ds_read_b64_tr_b16 v[70:71], v10 offset:512
    v_mfma_f32_16x16x32_bf16 a[48:51], v[124:127], v[32:35], a[48:51]
    v_mfma_f32_16x16x32_bf16 a[52:55], v[128:131], v[32:35], a[52:55]
    ds_read_b128 v[32:35], v8 offset:0
    v_mfma_f32_16x16x32_bf16 a[8:11], v[100:103], v[36:39], a[8:11]
    ds_read_b64_tr_b16 v[72:73], v11 offset:0
    v_mfma_f32_16x16x32_bf16 a[12:15], v[104:107], v[36:39], a[12:15]
    v_mfma_f32_16x16x32_bf16 a[24:27], v[108:111], v[36:39], a[24:27]
    v_mfma_f32_16x16x32_bf16 a[28:31], v[112:115], v[36:39], a[28:31]
    ds_read_b64_tr_b16 v[74:75], v11 offset:512
    buffer_load_dwordx4 v25, s[12:15], s27 offen offset:1024 nt lds
    v_mfma_f32_16x16x32_bf16 a[40:43], v[116:119], v[36:39], a[40:43]
    v_mfma_f32_16x16x32_bf16 a[44:47], v[120:123], v[36:39], a[44:47]
    v_mfma_f32_16x16x32_bf16 a[56:59], v[124:127], v[36:39], a[56:59]
    ds_read_b64_tr_b16 v[76:77], v12 offset:0
    v_mfma_f32_16x16x32_bf16 a[60:63], v[128:131], v[36:39], a[60:63]
    ds_read_b128 v[36:39], v8 offset:2048
    v_mfma_f32_16x16x32_bf16 a[64:67], v[100:103], v[40:43], a[64:67]
    v_mfma_f32_16x16x32_bf16 a[68:71], v[104:107], v[40:43], a[68:71]
    ds_read_b64_tr_b16 v[78:79], v12 offset:512
    v_mfma_f32_16x16x32_bf16 a[80:83], v[108:111], v[40:43], a[80:83]
    buffer_load_dwordx4 v26, s[12:15], s27 offen offset:2048 nt lds
    v_mfma_f32_16x16x32_bf16 a[84:87], v[112:115], v[40:43], a[84:87]
    v_mfma_f32_16x16x32_bf16 a[96:99], v[116:119], v[40:43], a[96:99]
    ds_read_b64_tr_b16 v[80:81], v13 offset:0
    v_mfma_f32_16x16x32_bf16 a[100:103], v[120:123], v[40:43], a[100:103]
    v_mfma_f32_16x16x32_bf16 a[112:115], v[124:127], v[40:43], a[112:115]
    v_mfma_f32_16x16x32_bf16 a[116:119], v[128:131], v[40:43], a[116:119]
    ds_read_b64_tr_b16 v[82:83], v13 offset:512
    ds_read_b128 v[40:43], v8 offset:4096
    v_mfma_f32_16x16x32_bf16 a[72:75], v[100:103], v[44:47], a[72:75]
    v_mfma_f32_16x16x32_bf16 a[76:79], v[104:107], v[44:47], a[76:79]
    buffer_load_dwordx4 v27, s[12:15], s27 offen offset:3072 nt lds
    v_mfma_f32_16x16x32_bf16 a[88:91], v[108:111], v[44:47], a[88:91]
    s_add_u32 s27, s27, 262144
    ds_read_b64_tr_b16 v[84:85], v10 offset:4096
    v_mfma_f32_16x16x32_bf16 a[92:95], v[112:115], v[44:47], a[92:95]
    s_xor_b32 s28, s28, 0x8000
    v_mfma_f32_16x16x32_bf16 a[104:107], v[116:119], v[44:47], a[104:107]
    v_mfma_f32_16x16x32_bf16 a[108:111], v[120:123], v[44:47], a[108:111]
    ds_read_b64_tr_b16 v[86:87], v10 offset:4608
    v_mfma_f32_16x16x32_bf16 a[120:123], v[124:127], v[44:47], a[120:123]
    v_mfma_f32_16x16x32_bf16 a[124:127], v[128:131], v[44:47], a[124:127]
    s_add_u32 m0, s33, 0
    ds_read_b128 v[44:47], v8 offset:6144
    v_mfma_f32_16x16x32_bf16 a[128:131], v[100:103], v[48:51], a[128:131]
    ds_read_b64_tr_b16 v[88:89], v11 offset:4096
    buffer_load_dwordx4 v16, s[8:11], s26 offen offset:0 lds
    v_mfma_f32_16x16x32_bf16 a[132:135], v[104:107], v[48:51], a[132:135]
    v_mfma_f32_16x16x32_bf16 a[144:147], v[108:111], v[48:51], a[144:147]
    v_mfma_f32_16x16x32_bf16 a[148:151], v[112:115], v[48:51], a[148:151]
    ds_read_b64_tr_b16 v[90:91], v11 offset:4608
    v_mfma_f32_16x16x32_bf16 a[160:163], v[116:119], v[48:51], a[160:163]
    v_mfma_f32_16x16x32_bf16 a[164:167], v[120:123], v[48:51], a[164:167]
    v_mfma_f32_16x16x32_bf16 a[176:179], v[124:127], v[48:51], a[176:179]
    ds_read_b64_tr_b16 v[92:93], v12 offset:4096
    v_mfma_f32_16x16x32_bf16 a[180:183], v[128:131], v[48:51], a[180:183]
    ds_read_b128 v[48:51], v8 offset:8192
    buffer_load_dwordx4 v17, s[8:11], s26 offen offset:1024 lds
    v_mfma_f32_16x16x32_bf16 a[136:139], v[100:103], v[52:55], a[136:139]
    v_mfma_f32_16x16x32_bf16 a[140:143], v[104:107], v[52:55], a[140:143]
    ds_read_b64_tr_b16 v[94:95], v12 offset:4608
    v_mfma_f32_16x16x32_bf16 a[152:155], v[108:111], v[52:55], a[152:155]
    v_mfma_f32_16x16x32_bf16 a[156:159], v[112:115], v[52:55], a[156:159]
    v_mfma_f32_16x16x32_bf16 a[168:171], v[116:119], v[52:55], a[168:171]
    ds_read_b64_tr_b16 v[96:97], v13 offset:4096
    v_mfma_f32_16x16x32_bf16 a[172:175], v[120:123], v[52:55], a[172:175]
    v_mfma_f32_16x16x32_bf16 a[184:187], v[124:127], v[52:55], a[184:187]
    buffer_load_dwordx4 v18, s[8:11], s26 offen offset:2048 lds
    v_mfma_f32_16x16x32_bf16 a[188:191], v[128:131], v[52:55], a[188:191]
    ds_read_b64_tr_b16 v[98:99], v13 offset:4608
    ds_read_b128 v[52:55], v8 offset:10240
    v_mfma_f32_16x16x32_bf16 a[192:195], v[100:103], v[56:59], a[192:195]
    v_mfma_f32_16x16x32_bf16 a[196:199], v[104:107], v[56:59], a[196:199]
    v_mfma_f32_16x16x32_bf16 a[208:211], v[108:111], v[56:59], a[208:211]
    v_mfma_f32_16x16x32_bf16 a[212:215], v[112:115], v[56:59], a[212:215]
    v_mfma_f32_16x16x32_bf16 a[224:227], v[116:119], v[56:59], a[224:227]
    v_mfma_f32_16x16x32_bf16 a[228:231], v[120:123], v[56:59], a[228:231]
    buffer_load_dwordx4 v19, s[8:11], s26 offen offset:3072 lds
    v_mfma_f32_16x16x32_bf16 a[240:243], v[124:127], v[56:59], a[240:243]
    v_mfma_f32_16x16x32_bf16 a[244:247], v[128:131], v[56:59], a[244:247]
    ds_read_b128 v[56:59], v8 offset:12288
    v_mfma_f32_16x16x32_bf16 a[200:203], v[100:103], v[64:67], a[200:203]
    v_mfma_f32_16x16x32_bf16 a[204:207], v[104:107], v[64:67], a[204:207]
    v_mfma_f32_16x16x32_bf16 a[216:219], v[108:111], v[64:67], a[216:219]
    s_add_u32 s29, s29, 1
    v_mfma_f32_16x16x32_bf16 a[220:223], v[112:115], v[64:67], a[220:223]
    v_mfma_f32_16x16x32_bf16 a[232:235], v[116:119], v[64:67], a[232:235]
    v_mfma_f32_16x16x32_bf16 a[236:239], v[120:123], v[64:67], a[236:239]
    s_cmp_lt_u32 s29, 12
    v_mfma_f32_16x16x32_bf16 a[248:251], v[124:127], v[64:67], a[248:251]
    s_waitcnt lgkmcnt(15)
    v_mfma_f32_16x16x32_bf16 a[252:255], v[128:131], v[64:67], a[252:255]
    s_cbranch_scc1 .Lmain_kernel_loop_8
    v_mfma_f32_16x16x32_bf16 a[0:3], v[68:71], v[32:35], a[0:3]
    s_waitcnt vmcnt(16) lgkmcnt(0)
    v_mfma_f32_16x16x32_bf16 a[4:7], v[72:75], v[32:35], a[4:7]
    s_barrier
    v_mfma_f32_16x16x32_bf16 a[16:19], v[76:79], v[32:35], a[16:19]
    ds_read_b64_tr_b16 v[100:101], v10 offset:16384
    buffer_load_dword v255, v250, s[96:99], s78 offen
    v_mfma_f32_16x16x32_bf16 a[20:23], v[80:83], v[32:35], a[20:23]
    s_add_u32 m0, s28, 0
    ds_read_b128 v[64:67], v9 offset:14336
    v_mfma_f32_16x16x32_bf16 a[32:35], v[84:87], v[32:35], a[32:35]
    buffer_load_dwordx4 v24, s[12:15], s27 offen offset:0 nt lds
    v_mfma_f32_16x16x32_bf16 a[36:39], v[88:91], v[32:35], a[36:39]
    ds_read_b64_tr_b16 v[102:103], v10 offset:16896
    v_mfma_f32_16x16x32_bf16 a[48:51], v[92:95], v[32:35], a[48:51]
    v_lshrrev_b32 v30, 2, v14
    v_mfma_f32_16x16x32_bf16 a[52:55], v[96:99], v[32:35], a[52:55]
    ds_read_b128 v[32:35], v9 offset:0
    v_mfma_f32_16x16x32_bf16 a[8:11], v[68:71], v[36:39], a[8:11]
    ds_read_b64_tr_b16 v[104:105], v11 offset:16384
    v_mfma_f32_16x16x32_bf16 a[12:15], v[72:75], v[36:39], a[12:15]
    s_add_u32 s78, s78, s44
    v_mfma_f32_16x16x32_bf16 a[24:27], v[76:79], v[36:39], a[24:27]
    v_mfma_f32_16x16x32_bf16 a[28:31], v[80:83], v[36:39], a[28:31]
    ds_read_b64_tr_b16 v[106:107], v11 offset:16896
    buffer_load_dwordx4 v25, s[12:15], s27 offen offset:1024 nt lds
    v_mfma_f32_16x16x32_bf16 a[40:43], v[84:87], v[36:39], a[40:43]
    v_mfma_f32_16x16x32_bf16 a[44:47], v[88:91], v[36:39], a[44:47]
    buffer_load_dword v30, v30, s[48:51], 0 offen sc1
    v_mfma_f32_16x16x32_bf16 a[56:59], v[92:95], v[36:39], a[56:59]
    ds_read_b64_tr_b16 v[108:109], v12 offset:16384
    v_mfma_f32_16x16x32_bf16 a[60:63], v[96:99], v[36:39], a[60:63]
    ds_read_b128 v[36:39], v9 offset:2048
    v_mfma_f32_16x16x32_bf16 a[64:67], v[68:71], v[40:43], a[64:67]
    v_mfma_f32_16x16x32_bf16 a[68:71], v[72:75], v[40:43], a[68:71]
    ds_read_b64_tr_b16 v[110:111], v12 offset:16896
    v_mfma_f32_16x16x32_bf16 a[80:83], v[76:79], v[40:43], a[80:83]
    buffer_load_dwordx4 v26, s[12:15], s27 offen offset:2048 nt lds
    v_mfma_f32_16x16x32_bf16 a[84:87], v[80:83], v[40:43], a[84:87]
    v_mfma_f32_16x16x32_bf16 a[96:99], v[84:87], v[40:43], a[96:99]
    ds_read_b64_tr_b16 v[112:113], v13 offset:16384
    v_mfma_f32_16x16x32_bf16 a[100:103], v[88:91], v[40:43], a[100:103]
    s_lshl_b32 s42, s24, 20
    v_mfma_f32_16x16x32_bf16 a[112:115], v[92:95], v[40:43], a[112:115]
    s_add_u32 s30, s41, 1
    v_mfma_f32_16x16x32_bf16 a[116:119], v[96:99], v[40:43], a[116:119]
    s_lshl_b32 s30, s30, 16
    ds_read_b64_tr_b16 v[114:115], v13 offset:16896
    ds_read_b128 v[40:43], v9 offset:4096
    v_mfma_f32_16x16x32_bf16 a[72:75], v[68:71], v[44:47], a[72:75]
    s_add_u32 s61, s42, s30
    v_mfma_f32_16x16x32_bf16 a[76:79], v[72:75], v[44:47], a[76:79]
    s_sub_u32 s31, s61, 589824
    buffer_load_dwordx4 v27, s[12:15], s27 offen offset:3072 nt lds
    v_mfma_f32_16x16x32_bf16 a[88:91], v[76:79], v[44:47], a[88:91]
    s_add_u32 s27, s27, 262144
    s_mov_b32 s38, 0
    ds_read_b64_tr_b16 v[116:117], v10 offset:20480
    v_mfma_f32_16x16x32_bf16 a[92:95], v[80:83], v[44:47], a[92:95]
    s_xor_b32 s30, s43, 15
    v_mfma_f32_16x16x32_bf16 a[104:107], v[84:87], v[44:47], a[104:107]
    s_lshl_b32 s6, s43, 16
    v_mfma_f32_16x16x32_bf16 a[108:111], v[88:91], v[44:47], a[108:111]
    s_add_u32 s6, s6, 117440512
    ds_read_b64_tr_b16 v[118:119], v10 offset:20992
    v_mfma_f32_16x16x32_bf16 a[120:123], v[92:95], v[44:47], a[120:123]
    v_mfma_f32_16x16x32_bf16 a[124:127], v[96:99], v[44:47], a[124:127]
    s_add_u32 m0, s33, 4096
    s_cmp_ge_u32 s41, 9
    ds_read_b128 v[44:47], v9 offset:6144
    v_mfma_f32_16x16x32_bf16 a[128:131], v[68:71], v[48:51], a[128:131]
    s_cselect_b32 s36, 2, 0
    ds_read_b64_tr_b16 v[120:121], v11 offset:20480
    buffer_load_dwordx4 v20, s[8:11], s26 offen offset:0 lds
    v_mfma_f32_16x16x32_bf16 a[132:135], v[72:75], v[48:51], a[132:135]
    s_cselect_b32 s37, 8, s41
    s_cselect_b32 s39, s31, s42
    s_cselect_b32 s46, s30, s43
    v_mfma_f32_16x16x32_bf16 a[144:147], v[76:79], v[48:51], a[144:147]
    s_cselect_b32 s6, s6, 1073741824
    v_mfma_f32_16x16x32_bf16 a[148:151], v[80:83], v[48:51], a[148:151]
    ds_read_b64_tr_b16 v[122:123], v11 offset:20992
    v_mfma_f32_16x16x32_bf16 a[160:163], v[84:87], v[48:51], a[160:163]
    s_sub_u32 s30, 7, s41
    v_mfma_f32_16x16x32_bf16 a[164:167], v[88:91], v[48:51], a[164:167]
    s_lshl_b32 s30, s30, 16
    v_mfma_f32_16x16x32_bf16 a[176:179], v[92:95], v[48:51], a[176:179]
    s_add_u32 s5, s42, s30
    ds_read_b64_tr_b16 v[124:125], v12 offset:20480
    v_mfma_f32_16x16x32_bf16 a[180:183], v[96:99], v[48:51], a[180:183]
    ds_read_b128 v[48:51], v9 offset:8192
    buffer_load_dwordx4 v21, s[8:11], s26 offen offset:1024 lds
    v_mfma_f32_16x16x32_bf16 a[136:139], v[68:71], v[52:55], a[136:139]
    s_add_u32 s33, s35, s34
    s_cmp_le_u32 s41, 6
    s_cselect_b32 s36, 1, s36
    v_mfma_f32_16x16x32_bf16 a[140:143], v[72:75], v[52:55], a[140:143]
    s_cselect_b32 s62, s42, 1073741824
    ds_read_b64_tr_b16 v[126:127], v12 offset:20992
    v_mfma_f32_16x16x32_bf16 a[152:155], v[76:79], v[52:55], a[152:155]
    v_mfma_f32_16x16x32_bf16 a[156:159], v[80:83], v[52:55], a[156:159]
    s_mov_b32 s60, s39
    v_mfma_f32_16x16x32_bf16 a[168:171], v[84:87], v[52:55], a[168:171]
    s_add_u32 s34, s34, 32768
    s_mov_b32 s63, s61
    ds_read_b64_tr_b16 v[128:129], v13 offset:20480
    v_mfma_f32_16x16x32_bf16 a[172:175], v[88:91], v[52:55], a[172:175]
    s_mov_b32 s4, s62
    v_mfma_f32_16x16x32_bf16 a[184:187], v[92:95], v[52:55], a[184:187]
    s_lshl_b32 s30, s20, 14
    buffer_load_dwordx4 v22, s[8:11], s26 offen offset:2048 lds
    v_mfma_f32_16x16x32_bf16 a[188:191], v[96:99], v[52:55], a[188:191]
    s_add_u32 s6, s6, s30
    ds_read_b64_tr_b16 v[130:131], v13 offset:20992
    ds_read_b128 v[52:55], v9 offset:10240
    v_mfma_f32_16x16x32_bf16 a[192:195], v[68:71], v[56:59], a[192:195]
    s_cmp_eq_u32 s34, 98304
    s_cselect_b32 s34, 0, s34
    v_mfma_f32_16x16x32_bf16 a[196:199], v[72:75], v[56:59], a[196:199]
    s_lshl_b32 s46, s46, 2
    s_add_u32 s46, s46, s20
    v_mfma_f32_16x16x32_bf16 a[208:211], v[76:79], v[56:59], a[208:211]
    s_lshl_b32 s47, s46, 10
    v_mfma_f32_16x16x32_bf16 a[212:215], v[80:83], v[56:59], a[212:215]
    s_add_u32 s47, s47, 33554432
    v_mfma_f32_16x16x32_bf16 a[224:227], v[84:87], v[56:59], a[224:227]
    s_lshl_b32 s46, s46, 14
    v_mfma_f32_16x16x32_bf16 a[228:231], v[88:91], v[56:59], a[228:231]
    s_add_u32 s46, s46, 100663296
    buffer_load_dwordx4 v23, s[8:11], s26 offen offset:3072 lds
    v_mfma_f32_16x16x32_bf16 a[240:243], v[92:95], v[56:59], a[240:243]
    s_add_u32 s26, s26, 128
    s_mul_i32 s7, s41, 1835008
    v_mfma_f32_16x16x32_bf16 a[244:247], v[96:99], v[56:59], a[244:247]
    s_lshl_b32 s30, s20, 14
    ds_read_b128 v[56:59], v9 offset:12288
    v_mfma_f32_16x16x32_bf16 a[200:203], v[68:71], v[60:63], a[200:203]
    s_add_u32 s7, s7, s30
    v_add_u32 v8, s34, v28
    v_mfma_f32_16x16x32_bf16 a[204:207], v[72:75], v[60:63], a[204:207]
    s_add_u32 s7, s7, 69206016
    v_add_u32 v9, s34, v29
    v_mfma_f32_16x16x32_bf16 a[216:219], v[76:79], v[60:63], a[216:219]
    s_add_u32 s64, s58, 16777216
    s_addc_u32 s65, s59, 0
    v_xor_b32 v10, 0x8000, v10
    v_mfma_f32_16x16x32_bf16 a[220:223], v[80:83], v[60:63], a[220:223]
    v_mfma_f32_16x16x32_bf16 a[232:235], v[84:87], v[60:63], a[232:235]
    s_and_b32 s65, s65, 0xffff
    v_xor_b32 v11, 0x8000, v11
    v_mfma_f32_16x16x32_bf16 a[236:239], v[88:91], v[60:63], a[236:239]
    s_mov_b32 s66, 16777216
    v_xor_b32 v12, 0x8000, v12
    v_mfma_f32_16x16x32_bf16 a[248:251], v[92:95], v[60:63], a[248:251]
    s_waitcnt lgkmcnt(15)
    s_mov_b32 s67, 0x00020000
    v_xor_b32 v13, 0x8000, v13
    v_mfma_f32_16x16x32_bf16 a[252:255], v[96:99], v[60:63], a[252:255]
    v_mfma_f32_16x16x32_bf16 a[0:3], v[100:103], v[32:35], a[0:3]
    s_waitcnt vmcnt(17) lgkmcnt(0)
    v_mfma_f32_16x16x32_bf16 a[4:7], v[104:107], v[32:35], a[4:7]
    s_barrier
    v_mfma_f32_16x16x32_bf16 a[16:19], v[108:111], v[32:35], a[16:19]
    ds_read_b64_tr_b16 v[68:69], v10 offset:0
    buffer_load_dword v255, v250, s[96:99], s78 offen
    v_mfma_f32_16x16x32_bf16 a[20:23], v[112:115], v[32:35], a[20:23]
    s_add_u32 m0, s28, 16384
    ds_read_b128 v[60:63], v8 offset:14336
    v_mfma_f32_16x16x32_bf16 a[32:35], v[116:119], v[32:35], a[32:35]
    buffer_load_dwordx4 v24, s[12:15], s27 offen offset:0 nt lds
    v_mfma_f32_16x16x32_bf16 a[36:39], v[120:123], v[32:35], a[36:39]
    ds_read_b64_tr_b16 v[70:71], v10 offset:512
    v_mfma_f32_16x16x32_bf16 a[48:51], v[124:127], v[32:35], a[48:51]
    v_mfma_f32_16x16x32_bf16 a[52:55], v[128:131], v[32:35], a[52:55]
    ds_read_b128 v[32:35], v8 offset:0
    v_mfma_f32_16x16x32_bf16 a[8:11], v[100:103], v[36:39], a[8:11]
    ds_read_b64_tr_b16 v[72:73], v11 offset:0
    v_mfma_f32_16x16x32_bf16 a[12:15], v[104:107], v[36:39], a[12:15]
    s_add_u32 s78, s78, s44
    v_mfma_f32_16x16x32_bf16 a[24:27], v[108:111], v[36:39], a[24:27]
    v_mfma_f32_16x16x32_bf16 a[28:31], v[112:115], v[36:39], a[28:31]
    ds_read_b64_tr_b16 v[74:75], v11 offset:512
    buffer_load_dwordx4 v25, s[12:15], s27 offen offset:1024 nt lds
    v_mfma_f32_16x16x32_bf16 a[40:43], v[116:119], v[36:39], a[40:43]
    v_mfma_f32_16x16x32_bf16 a[44:47], v[120:123], v[36:39], a[44:47]
    v_mfma_f32_16x16x32_bf16 a[56:59], v[124:127], v[36:39], a[56:59]
    ds_read_b64_tr_b16 v[76:77], v12 offset:0
    v_mfma_f32_16x16x32_bf16 a[60:63], v[128:131], v[36:39], a[60:63]
    ds_read_b128 v[36:39], v8 offset:2048
    v_mfma_f32_16x16x32_bf16 a[64:67], v[100:103], v[40:43], a[64:67]
    v_mfma_f32_16x16x32_bf16 a[68:71], v[104:107], v[40:43], a[68:71]
    ds_read_b64_tr_b16 v[78:79], v12 offset:512
    v_mfma_f32_16x16x32_bf16 a[80:83], v[108:111], v[40:43], a[80:83]
    buffer_load_dwordx4 v26, s[12:15], s27 offen offset:2048 nt lds
    v_mfma_f32_16x16x32_bf16 a[84:87], v[112:115], v[40:43], a[84:87]
    v_mfma_f32_16x16x32_bf16 a[96:99], v[116:119], v[40:43], a[96:99]
    ds_read_b64_tr_b16 v[80:81], v13 offset:0
    v_mfma_f32_16x16x32_bf16 a[100:103], v[120:123], v[40:43], a[100:103]
    v_mfma_f32_16x16x32_bf16 a[112:115], v[124:127], v[40:43], a[112:115]
    v_mfma_f32_16x16x32_bf16 a[116:119], v[128:131], v[40:43], a[116:119]
    ds_read_b64_tr_b16 v[82:83], v13 offset:512
    ds_read_b128 v[40:43], v8 offset:4096
    v_mfma_f32_16x16x32_bf16 a[72:75], v[100:103], v[44:47], a[72:75]
    v_mfma_f32_16x16x32_bf16 a[76:79], v[104:107], v[44:47], a[76:79]
    buffer_load_dwordx4 v27, s[12:15], s27 offen offset:3072 nt lds
    v_mfma_f32_16x16x32_bf16 a[88:91], v[108:111], v[44:47], a[88:91]
    s_add_u32 s27, s27, 262144
    ds_read_b64_tr_b16 v[84:85], v10 offset:4096
    v_mfma_f32_16x16x32_bf16 a[92:95], v[112:115], v[44:47], a[92:95]
    s_xor_b32 s28, s28, 0x8000
    v_mfma_f32_16x16x32_bf16 a[104:107], v[116:119], v[44:47], a[104:107]
    v_mfma_f32_16x16x32_bf16 a[108:111], v[120:123], v[44:47], a[108:111]
    ds_read_b64_tr_b16 v[86:87], v10 offset:4608
    v_mfma_f32_16x16x32_bf16 a[120:123], v[124:127], v[44:47], a[120:123]
    s_getpc_b64 s[52:53]
.Lmain_kernel_pc_11:
    s_sub_u32 s52, s52, .Lmain_kernel_pc_11-main_kernel
    s_subb_u32 s53, s53, 0
    v_mfma_f32_16x16x32_bf16 a[124:127], v[128:131], v[44:47], a[124:127]
    s_add_u32 m0, s33, 0
    ds_read_b128 v[44:47], v8 offset:6144
    v_mfma_f32_16x16x32_bf16 a[128:131], v[100:103], v[48:51], a[128:131]
    ds_read_b64_tr_b16 v[88:89], v11 offset:4096
    buffer_load_dwordx4 v16, s[8:11], s26 offen offset:0 lds
    v_mfma_f32_16x16x32_bf16 a[132:135], v[104:107], v[48:51], a[132:135]
    v_mfma_f32_16x16x32_bf16 a[144:147], v[108:111], v[48:51], a[144:147]
    v_mfma_f32_16x16x32_bf16 a[148:151], v[112:115], v[48:51], a[148:151]
    ds_read_b64_tr_b16 v[90:91], v11 offset:4608
    v_mfma_f32_16x16x32_bf16 a[160:163], v[116:119], v[48:51], a[160:163]
    v_mfma_f32_16x16x32_bf16 a[164:167], v[120:123], v[48:51], a[164:167]
    v_mfma_f32_16x16x32_bf16 a[176:179], v[124:127], v[48:51], a[176:179]
    ds_read_b64_tr_b16 v[92:93], v12 offset:4096
    v_mfma_f32_16x16x32_bf16 a[180:183], v[128:131], v[48:51], a[180:183]
    ds_read_b128 v[48:51], v8 offset:8192
    buffer_load_dwordx4 v17, s[8:11], s26 offen offset:1024 lds
    v_mfma_f32_16x16x32_bf16 a[136:139], v[100:103], v[52:55], a[136:139]
    s_and_b32 s53, s53, 0xffff
    v_mfma_f32_16x16x32_bf16 a[140:143], v[104:107], v[52:55], a[140:143]
    ds_read_b64_tr_b16 v[94:95], v12 offset:4608
    v_mfma_f32_16x16x32_bf16 a[152:155], v[108:111], v[52:55], a[152:155]
    v_mfma_f32_16x16x32_bf16 a[156:159], v[112:115], v[52:55], a[156:159]
    s_mov_b32 s54, .Ltext_end-main_kernel
    v_mfma_f32_16x16x32_bf16 a[168:171], v[116:119], v[52:55], a[168:171]
    ds_read_b64_tr_b16 v[96:97], v13 offset:4096
    v_mfma_f32_16x16x32_bf16 a[172:175], v[120:123], v[52:55], a[172:175]
    s_mov_b32 s55, 0x00020000
    v_mfma_f32_16x16x32_bf16 a[184:187], v[124:127], v[52:55], a[184:187]
    buffer_load_dwordx4 v18, s[8:11], s26 offen offset:2048 lds
    v_mfma_f32_16x16x32_bf16 a[188:191], v[128:131], v[52:55], a[188:191]
    ds_read_b64_tr_b16 v[98:99], v13 offset:4608
    ds_read_b128 v[52:55], v8 offset:10240
    v_mfma_f32_16x16x32_bf16 a[192:195], v[100:103], v[56:59], a[192:195]
    s_and_b32 s30, s2, 56
    v_mfma_f32_16x16x32_bf16 a[196:199], v[104:107], v[56:59], a[196:199]
    v_mfma_f32_16x16x32_bf16 a[208:211], v[108:111], v[56:59], a[208:211]
    s_lshl_b32 s30, s30, 12
    v_mfma_f32_16x16x32_bf16 a[212:215], v[112:115], v[56:59], a[212:215]
    v_mfma_f32_16x16x32_bf16 a[224:227], v[116:119], v[56:59], a[224:227]
    v_mfma_f32_16x16x32_bf16 a[228:231], v[120:123], v[56:59], a[228:231]
    buffer_load_dwordx4 v19, s[8:11], s26 offen offset:3072 lds
    v_lshlrev_b32 v254, 3, v14
    v_mfma_f32_16x16x32_bf16 a[240:243], v[124:127], v[56:59], a[240:243]
    v_mfma_f32_16x16x32_bf16 a[244:247], v[128:131], v[56:59], a[244:247]
    ds_read_b128 v[56:59], v8 offset:12288
    v_mfma_f32_16x16x32_bf16 a[200:203], v[100:103], v[64:67], a[200:203]
    s_lshl_b32 s31, s20, 13
    v_mfma_f32_16x16x32_bf16 a[204:207], v[104:107], v[64:67], a[204:207]
    v_mfma_f32_16x16x32_bf16 a[216:219], v[108:111], v[64:67], a[216:219]
    v_add_u32 v254, s31, v254
    v_mfma_f32_16x16x32_bf16 a[220:223], v[112:115], v[64:67], a[220:223]
    v_mfma_f32_16x16x32_bf16 a[232:235], v[116:119], v[64:67], a[232:235]
    v_mfma_f32_16x16x32_bf16 a[236:239], v[120:123], v[64:67], a[236:239]
    buffer_load_dword v254, v254, s[52:55], s30 offen
    v_mfma_f32_16x16x32_bf16 a[248:251], v[124:127], v[64:67], a[248:251]
    s_waitcnt lgkmcnt(15)
    v_mfma_f32_16x16x32_bf16 a[252:255], v[128:131], v[64:67], a[252:255]
    v_mfma_f32_16x16x32_bf16 a[0:3], v[68:71], v[32:35], a[0:3]
    s_waitcnt vmcnt(18) lgkmcnt(0)
    v_mfma_f32_16x16x32_bf16 a[4:7], v[72:75], v[32:35], a[4:7]
    s_barrier
    v_mfma_f32_16x16x32_bf16 a[16:19], v[76:79], v[32:35], a[16:19]
    ds_read_b64_tr_b16 v[100:101], v10 offset:16384
    buffer_load_dword v255, v250, s[96:99], s78 offen
    v_mfma_f32_16x16x32_bf16 a[20:23], v[80:83], v[32:35], a[20:23]
    s_add_u32 m0, s28, 0
    s_cmp_eq_u32 s21, 0
    ds_read_b128 v[64:67], v9 offset:14336
    v_mfma_f32_16x16x32_bf16 a[32:35], v[84:87], v[32:35], a[32:35]
    s_cselect_b32 s52, s72, s74
    s_cselect_b32 s53, s73, s75
    buffer_load_dwordx4 v24, s[12:15], s27 offen offset:0 nt lds
    v_mfma_f32_16x16x32_bf16 a[36:39], v[88:91], v[32:35], a[36:39]
    ds_read_b64_tr_b16 v[102:103], v10 offset:16896
    v_mfma_f32_16x16x32_bf16 a[48:51], v[92:95], v[32:35], a[48:51]
    v_mfma_f32_16x16x32_bf16 a[52:55], v[96:99], v[32:35], a[52:55]
    ds_read_b128 v[32:35], v9 offset:0
    v_mfma_f32_16x16x32_bf16 a[8:11], v[68:71], v[36:39], a[8:11]
    ds_read_b64_tr_b16 v[104:105], v11 offset:16384
    v_mfma_f32_16x16x32_bf16 a[12:15], v[72:75], v[36:39], a[12:15]
    s_add_u32 s78, s78, s44
    v_mfma_f32_16x16x32_bf16 a[24:27], v[76:79], v[36:39], a[24:27]
    s_and_b32 s53, s53, 0xffff
    v_mfma_f32_16x16x32_bf16 a[28:31], v[80:83], v[36:39], a[28:31]
    ds_read_b64_tr_b16 v[106:107], v11 offset:16896
    buffer_load_dwordx4 v25, s[12:15], s27 offen offset:1024 nt lds
    v_mfma_f32_16x16x32_bf16 a[40:43], v[84:87], v[36:39], a[40:43]
    v_mfma_f32_16x16x32_bf16 a[44:47], v[88:91], v[36:39], a[44:47]
    s_cmp_lt_u32 s24, 14
    s_cselect_b32 s54, 1605632, 0
    v_mfma_f32_16x16x32_bf16 a[56:59], v[92:95], v[36:39], a[56:59]
    ds_read_b64_tr_b16 v[108:109], v12 offset:16384
    v_mfma_f32_16x16x32_bf16 a[60:63], v[96:99], v[36:39], a[60:63]
    ds_read_b128 v[36:39], v9 offset:2048
    v_mfma_f32_16x16x32_bf16 a[64:67], v[68:71], v[40:43], a[64:67]
    v_mfma_f32_16x16x32_bf16 a[68:71], v[72:75], v[40:43], a[68:71]
    ds_read_b64_tr_b16 v[110:111], v12 offset:16896
    v_mfma_f32_16x16x32_bf16 a[80:83], v[76:79], v[40:43], a[80:83]
    buffer_load_dwordx4 v26, s[12:15], s27 offen offset:2048 nt lds
    v_mfma_f32_16x16x32_bf16 a[84:87], v[80:83], v[40:43], a[84:87]
    s_mov_b32 s55, 0x00020000
    v_mfma_f32_16x16x32_bf16 a[96:99], v[84:87], v[40:43], a[96:99]
    ds_read_b64_tr_b16 v[112:113], v13 offset:16384
    v_mfma_f32_16x16x32_bf16 a[100:103], v[88:91], v[40:43], a[100:103]
    v_mfma_f32_16x16x32_bf16 a[112:115], v[92:95], v[40:43], a[112:115]
    s_lshl_b32 s77, s24, 8
    v_mfma_f32_16x16x32_bf16 a[116:119], v[96:99], v[40:43], a[116:119]
    ds_read_b64_tr_b16 v[114:115], v13 offset:16896
    ds_read_b128 v[40:43], v9 offset:4096
    v_mfma_f32_16x16x32_bf16 a[72:75], v[68:71], v[44:47], a[72:75]
    v_mfma_f32_16x16x32_bf16 a[76:79], v[72:75], v[44:47], a[76:79]
    s_lshl_b32 s42, s22, 7
    buffer_load_dwordx4 v27, s[12:15], s27 offen offset:3072 nt lds
    v_mfma_f32_16x16x32_bf16 a[88:91], v[76:79], v[44:47], a[88:91]
    s_add_u32 s27, s27, 262144
    ds_read_b64_tr_b16 v[116:117], v10 offset:20480
    v_mfma_f32_16x16x32_bf16 a[92:95], v[80:83], v[44:47], a[92:95]
    v_mfma_f32_16x16x32_bf16 a[104:107], v[84:87], v[44:47], a[104:107]
    v_and_b32 v3, 7, v1
    v_mfma_f32_16x16x32_bf16 a[108:111], v[88:91], v[44:47], a[108:111]
    ds_read_b64_tr_b16 v[118:119], v10 offset:20992
    v_mfma_f32_16x16x32_bf16 a[120:123], v[92:95], v[44:47], a[120:123]
    v_mfma_f32_16x16x32_bf16 a[124:127], v[96:99], v[44:47], a[124:127]
    s_add_u32 m0, s33, 4096
    ds_read_b128 v[44:47], v9 offset:6144
    v_mul_u32_u24 v6, 3584, v31
    v_mfma_f32_16x16x32_bf16 a[128:131], v[68:71], v[48:51], a[128:131]
    ds_read_b64_tr_b16 v[120:121], v11 offset:20480
    buffer_load_dwordx4 v20, s[8:11], s26 offen offset:0 lds
    v_mfma_f32_16x16x32_bf16 a[132:135], v[72:75], v[48:51], a[132:135]
    v_mfma_f32_16x16x32_bf16 a[144:147], v[76:79], v[48:51], a[144:147]
    v_add_u32 v6, s42, v6
    v_mfma_f32_16x16x32_bf16 a[148:151], v[80:83], v[48:51], a[148:151]
    ds_read_b64_tr_b16 v[122:123], v11 offset:20992
    v_mfma_f32_16x16x32_bf16 a[160:163], v[84:87], v[48:51], a[160:163]
    v_mfma_f32_16x16x32_bf16 a[164:167], v[88:91], v[48:51], a[164:167]
    v_and_b32 v5, 2, v31
    v_mfma_f32_16x16x32_bf16 a[176:179], v[92:95], v[48:51], a[176:179]
    ds_read_b64_tr_b16 v[124:125], v12 offset:20480
    v_mfma_f32_16x16x32_bf16 a[180:183], v[96:99], v[48:51], a[180:183]
    ds_read_b128 v[48:51], v9 offset:8192
    buffer_load_dwordx4 v21, s[8:11], s26 offen offset:1024 lds
    v_mfma_f32_16x16x32_bf16 a[136:139], v[68:71], v[52:55], a[136:139]
    s_add_u32 s33, s35, s34
    v_xor_b32 v5, v5, v3
    v_mfma_f32_16x16x32_bf16 a[140:143], v[72:75], v[52:55], a[140:143]
    ds_read_b64_tr_b16 v[126:127], v12 offset:20992
    v_mfma_f32_16x16x32_bf16 a[152:155], v[76:79], v[52:55], a[152:155]
    v_mfma_f32_16x16x32_bf16 a[156:159], v[80:83], v[52:55], a[156:159]
    v_lshl_add_u32 v16, v5, 4, v6
    v_mfma_f32_16x16x32_bf16 a[168:171], v[84:87], v[52:55], a[168:171]
    s_add_u32 s34, s34, 32768
    ds_read_b64_tr_b16 v[128:129], v13 offset:20480
    v_mfma_f32_16x16x32_bf16 a[172:175], v[88:91], v[52:55], a[172:175]
    v_mfma_f32_16x16x32_bf16 a[184:187], v[92:95], v[52:55], a[184:187]
    buffer_load_dwordx4 v22, s[8:11], s26 offen offset:2048 lds
    v_xor_b32 v5, 4, v5
    v_mfma_f32_16x16x32_bf16 a[188:191], v[96:99], v[52:55], a[188:191]
    ds_read_b64_tr_b16 v[130:131], v13 offset:20992
    ds_read_b128 v[52:55], v9 offset:10240
    v_mfma_f32_16x16x32_bf16 a[192:195], v[68:71], v[56:59], a[192:195]
    s_cmp_eq_u32 s34, 98304
    s_cselect_b32 s34, 0, s34
    v_mfma_f32_16x16x32_bf16 a[196:199], v[72:75], v[56:59], a[196:199]
    v_lshl_add_u32 v17, v5, 4, v6
    v_mfma_f32_16x16x32_bf16 a[208:211], v[76:79], v[56:59], a[208:211]
    v_mfma_f32_16x16x32_bf16 a[212:215], v[80:83], v[56:59], a[212:215]
    v_mfma_f32_16x16x32_bf16 a[224:227], v[84:87], v[56:59], a[224:227]
    v_add_u32 v17, 27648, v17
    v_mfma_f32_16x16x32_bf16 a[228:231], v[88:91], v[56:59], a[228:231]
    buffer_load_dwordx4 v23, s[8:11], s26 offen offset:3072 lds
    v_mfma_f32_16x16x32_bf16 a[240:243], v[92:95], v[56:59], a[240:243]
    s_add_u32 s26, s26, 128
    v_mfma_f32_16x16x32_bf16 a[244:247], v[96:99], v[56:59], a[244:247]
    ds_read_b128 v[56:59], v9 offset:12288
    v_add_u32 v18, 55296, v16
    v_mfma_f32_16x16x32_bf16 a[200:203], v[68:71], v[60:63], a[200:203]
    v_add_u32 v8, s34, v28
    v_mfma_f32_16x16x32_bf16 a[204:207], v[72:75], v[60:63], a[204:207]
    v_add_u32 v9, s34, v29
    v_mfma_f32_16x16x32_bf16 a[216:219], v[76:79], v[60:63], a[216:219]
    v_xor_b32 v10, 0x8000, v10
    v_add_u32 v19, 55296, v17
    v_mfma_f32_16x16x32_bf16 a[220:223], v[80:83], v[60:63], a[220:223]
    v_mfma_f32_16x16x32_bf16 a[232:235], v[84:87], v[60:63], a[232:235]
    v_xor_b32 v11, 0x8000, v11
    v_mfma_f32_16x16x32_bf16 a[236:239], v[88:91], v[60:63], a[236:239]
    v_xor_b32 v12, 0x8000, v12
    v_mfma_f32_16x16x32_bf16 a[248:251], v[92:95], v[60:63], a[248:251]
    s_waitcnt lgkmcnt(15)
    v_xor_b32 v13, 0x8000, v13
    v_mfma_f32_16x16x32_bf16 a[252:255], v[96:99], v[60:63], a[252:255]
    v_mfma_f32_16x16x32_bf16 a[0:3], v[100:103], v[32:35], a[0:3]
    s_waitcnt vmcnt(19) lgkmcnt(0)
    v_mfma_f32_16x16x32_bf16 a[4:7], v[104:107], v[32:35], a[4:7]
    s_barrier
    v_mfma_f32_16x16x32_bf16 a[16:19], v[108:111], v[32:35], a[16:19]
    ds_read_b64_tr_b16 v[68:69], v10 offset:0
    buffer_load_dword v255, v250, s[96:99], s78 offen
    v_mfma_f32_16x16x32_bf16 a[20:23], v[112:115], v[32:35], a[20:23]
    s_add_u32 m0, s28, 16384
    ds_read_b128 v[60:63], v8 offset:14336
    v_and_b32 v30, 16843009, v30
    v_mfma_f32_16x16x32_bf16 a[32:35], v[116:119], v[32:35], a[32:35]
    buffer_load_dwordx4 v24, s[12:15], s27 offen offset:0 nt lds
    v_cmp_ne_u32 vcc, 16843009, v30
    v_mfma_f32_16x16x32_bf16 a[36:39], v[120:123], v[32:35], a[36:39]
    ds_read_b64_tr_b16 v[70:71], v10 offset:512
    v_mfma_f32_16x16x32_bf16 a[48:51], v[124:127], v[32:35], a[48:51]
    s_cbranch_vccnz .Lmain_kernel_spin_13
.Lmain_kernel_pok_12:
    v_mfma_f32_16x16x32_bf16 a[52:55], v[128:131], v[32:35], a[52:55]
    ds_read_b128 v[32:35], v8 offset:0
    v_mfma_f32_16x16x32_bf16 a[8:11], v[100:103], v[36:39], a[8:11]
    ds_read_b64_tr_b16 v[72:73], v11 offset:0
    v_mfma_f32_16x16x32_bf16 a[12:15], v[104:107], v[36:39], a[12:15]
    s_add_u32 s78, s78, s44
    v_mfma_f32_16x16x32_bf16 a[24:27], v[108:111], v[36:39], a[24:27]
    s_mul_i32 s26, s41, 114688
    v_mfma_f32_16x16x32_bf16 a[28:31], v[112:115], v[36:39], a[28:31]
    ds_read_b64_tr_b16 v[74:75], v11 offset:512
    buffer_load_dwordx4 v25, s[12:15], s27 offen offset:1024 nt lds
    v_mfma_f32_16x16x32_bf16 a[40:43], v[116:119], v[36:39], a[40:43]
    v_mfma_f32_16x16x32_bf16 a[44:47], v[120:123], v[36:39], a[44:47]
    s_add_u32 s26, s26, 37748736
    v_mfma_f32_16x16x32_bf16 a[56:59], v[124:127], v[36:39], a[56:59]
    ds_read_b64_tr_b16 v[76:77], v12 offset:0
    v_mfma_f32_16x16x32_bf16 a[60:63], v[128:131], v[36:39], a[60:63]
    ds_read_b128 v[36:39], v8 offset:2048
    v_mfma_f32_16x16x32_bf16 a[64:67], v[100:103], v[40:43], a[64:67]
    v_and_b32 v3, 7, v1
    v_mfma_f32_16x16x32_bf16 a[68:71], v[104:107], v[40:43], a[68:71]
    ds_read_b64_tr_b16 v[78:79], v12 offset:512
    v_mfma_f32_16x16x32_bf16 a[80:83], v[108:111], v[40:43], a[80:83]
    buffer_load_dwordx4 v26, s[12:15], s27 offen offset:2048 nt lds
    v_mfma_f32_16x16x32_bf16 a[84:87], v[112:115], v[40:43], a[84:87]
    v_lshrrev_b32 v4, 4, v1
    v_mfma_f32_16x16x32_bf16 a[96:99], v[116:119], v[40:43], a[96:99]
    ds_read_b64_tr_b16 v[80:81], v13 offset:0
    v_mfma_f32_16x16x32_bf16 a[100:103], v[120:123], v[40:43], a[100:103]
    v_mfma_f32_16x16x32_bf16 a[112:115], v[124:127], v[40:43], a[112:115]
    s_mul_i32 s30, s20, 28672
    v_mfma_f32_16x16x32_bf16 a[116:119], v[128:131], v[40:43], a[116:119]
    ds_read_b64_tr_b16 v[82:83], v13 offset:512
    ds_read_b128 v[40:43], v8 offset:4096
    v_mfma_f32_16x16x32_bf16 a[72:75], v[100:103], v[44:47], a[72:75]
    v_mfma_f32_16x16x32_bf16 a[76:79], v[104:107], v[44:47], a[76:79]
    buffer_load_dwordx4 v27, s[12:15], s27 offen offset:3072 nt lds
    v_mul_u32_u24 v6, 896, v31
    v_mfma_f32_16x16x32_bf16 a[88:91], v[108:111], v[44:47], a[88:91]
    s_add_u32 s27, s27, 262144
    ds_read_b64_tr_b16 v[84:85], v10 offset:4096
    v_mfma_f32_16x16x32_bf16 a[92:95], v[112:115], v[44:47], a[92:95]
    v_mfma_f32_16x16x32_bf16 a[104:107], v[116:119], v[44:47], a[104:107]
    v_add_u32 v6, s30, v6
    v_mfma_f32_16x16x32_bf16 a[108:111], v[120:123], v[44:47], a[108:111]
    ds_read_b64_tr_b16 v[86:87], v10 offset:4608
    v_mfma_f32_16x16x32_bf16 a[120:123], v[124:127], v[44:47], a[120:123]
    v_mfma_f32_16x16x32_bf16 a[124:127], v[128:131], v[44:47], a[124:127]
    s_add_u32 m0, s76, 98304
    ds_read_b128 v[44:47], v8 offset:6144
    v_add_u32 v5, 0, v4
    v_mfma_f32_16x16x32_bf16 a[128:131], v[100:103], v[48:51], a[128:131]
    ds_read_b64_tr_b16 v[88:89], v11 offset:4096
    buffer_load_dwordx4 v16, s[52:55], s77 offen offset:0 lds
    v_mfma_f32_16x16x32_bf16 a[132:135], v[104:107], v[48:51], a[132:135]
    v_mfma_f32_16x16x32_bf16 a[144:147], v[108:111], v[48:51], a[144:147]
    v_xor_b32 v5, v5, v3
    v_mfma_f32_16x16x32_bf16 a[148:151], v[112:115], v[48:51], a[148:151]
    ds_read_b64_tr_b16 v[90:91], v11 offset:4608
    v_mfma_f32_16x16x32_bf16 a[160:163], v[116:119], v[48:51], a[160:163]
    v_mfma_f32_16x16x32_bf16 a[164:167], v[120:123], v[48:51], a[164:167]
    v_lshl_add_u32 v5, v5, 4, v6
    v_mfma_f32_16x16x32_bf16 a[176:179], v[124:127], v[48:51], a[176:179]
    ds_read_b64_tr_b16 v[92:93], v12 offset:4096
    v_mfma_f32_16x16x32_bf16 a[180:183], v[128:131], v[48:51], a[180:183]
    ds_read_b128 v[48:51], v8 offset:8192
    buffer_load_dwordx4 v17, s[52:55], s77 offen offset:1024 lds
    v_mfma_f32_16x16x32_bf16 a[136:139], v[100:103], v[52:55], a[136:139]
    v_add_u32 v20, 0, v5
    v_mfma_f32_16x16x32_bf16 a[140:143], v[104:107], v[52:55], a[140:143]
    ds_read_b64_tr_b16 v[94:95], v12 offset:4608
    v_mfma_f32_16x16x32_bf16 a[152:155], v[108:111], v[52:55], a[152:155]
    v_mfma_f32_16x16x32_bf16 a[156:159], v[112:115], v[52:55], a[156:159]
    v_add_u32 v22, 12288, v5
    v_mfma_f32_16x16x32_bf16 a[168:171], v[116:119], v[52:55], a[168:171]
    ds_read_b64_tr_b16 v[96:97], v13 offset:4096
    v_mfma_f32_16x16x32_bf16 a[172:175], v[120:123], v[52:55], a[172:175]
    v_mfma_f32_16x16x32_bf16 a[184:187], v[124:127], v[52:55], a[184:187]
    buffer_load_dwordx4 v18, s[52:55], s77 offen offset:2048 lds
    v_add_u32 v5, 4, v4
    v_mfma_f32_16x16x32_bf16 a[188:191], v[128:131], v[52:55], a[188:191]
    ds_read_b64_tr_b16 v[98:99], v13 offset:4608
    ds_read_b128 v[52:55], v8 offset:10240
    v_mfma_f32_16x16x32_bf16 a[192:195], v[100:103], v[56:59], a[192:195]
    v_mfma_f32_16x16x32_bf16 a[196:199], v[104:107], v[56:59], a[196:199]
    v_xor_b32 v5, v5, v3
    v_mfma_f32_16x16x32_bf16 a[208:211], v[108:111], v[56:59], a[208:211]
    v_mfma_f32_16x16x32_bf16 a[212:215], v[112:115], v[56:59], a[212:215]
    v_mfma_f32_16x16x32_bf16 a[224:227], v[116:119], v[56:59], a[224:227]
    v_lshl_add_u32 v5, v5, 4, v6
    v_mfma_f32_16x16x32_bf16 a[228:231], v[120:123], v[56:59], a[228:231]
    buffer_load_dwordx4 v19, s[52:55], s77 offen offset:3072 lds
    v_mfma_f32_16x16x32_bf16 a[240:243], v[124:127], v[56:59], a[240:243]
    s_add_u32 s77, s77, 114688
    v_mfma_f32_16x16x32_bf16 a[244:247], v[128:131], v[56:59], a[244:247]
    ds_read_b128 v[56:59], v8 offset:12288
    v_add_u32 v21, 6144, v5
    v_mfma_f32_16x16x32_bf16 a[200:203], v[100:103], v[64:67], a[200:203]
    v_mfma_f32_16x16x32_bf16 a[204:207], v[104:107], v[64:67], a[204:207]
    v_mfma_f32_16x16x32_bf16 a[216:219], v[108:111], v[64:67], a[216:219]
    v_add_u32 v23, 18432, v5
    v_mfma_f32_16x16x32_bf16 a[220:223], v[112:115], v[64:67], a[220:223]
    v_mfma_f32_16x16x32_bf16 a[232:235], v[116:119], v[64:67], a[232:235]
    v_mfma_f32_16x16x32_bf16 a[236:239], v[120:123], v[64:67], a[236:239]
    v_mfma_f32_16x16x32_bf16 a[248:251], v[124:127], v[64:67], a[248:251]
    s_waitcnt lgkmcnt(15)
    v_mfma_f32_16x16x32_bf16 a[252:255], v[128:131], v[64:67], a[252:255]
    v_mfma_f32_16x16x32_bf16 a[0:3], v[68:71], v[32:35], a[0:3]
    s_waitcnt vmcnt(23) lgkmcnt(0)
    v_mfma_f32_16x16x32_bf16 a[4:7], v[72:75], v[32:35], a[4:7]
    s_barrier
    v_mfma_f32_16x16x32_bf16 a[16:19], v[76:79], v[32:35], a[16:19]
    s_load_dwordx2 s[28:29], s[0:1], 80
    ds_read_b64_tr_b16 v[100:101], v10 offset:16384
    buffer_load_dword v255, v250, s[96:99], s78 offen
    v_mfma_f32_16x16x32_bf16 a[20:23], v[80:83], v[32:35], a[20:23]
    s_add_u32 m0, s76, 0
    ds_read_b128 v[64:67], v9 offset:14336
    v_mfma_f32_16x16x32_bf16 a[32:35], v[84:87], v[32:35], a[32:35]
    buffer_load_dwordx4 v20, s[16:19], s26 offen offset:0 sc1 lds
    v_mfma_f32_16x16x32_bf16 a[36:39], v[88:91], v[32:35], a[36:39]
    ds_read_b64_tr_b16 v[102:103], v10 offset:16896
    v_mfma_f32_16x16x32_bf16 a[48:51], v[92:95], v[32:35], a[48:51]
    v_mfma_f32_16x16x32_bf16 a[52:55], v[96:99], v[32:35], a[52:55]
    ds_read_b128 v[32:35], v9 offset:0
    v_mfma_f32_16x16x32_bf16 a[8:11], v[68:71], v[36:39], a[8:11]
    ds_read_b64_tr_b16 v[104:105], v11 offset:16384
    v_mfma_f32_16x16x32_bf16 a[12:15], v[72:75], v[36:39], a[12:15]
    s_add_u32 s78, s78, s44
    v_mfma_f32_16x16x32_bf16 a[24:27], v[76:79], v[36:39], a[24:27]
    v_mfma_f32_16x16x32_bf16 a[28:31], v[80:83], v[36:39], a[28:31]
    ds_read_b64_tr_b16 v[106:107], v11 offset:16896
    buffer_load_dwordx4 v21, s[16:19], s26 offen offset:1024 sc1 lds
    v_mfma_f32_16x16x32_bf16 a[40:43], v[84:87], v[36:39], a[40:43]
    v_mfma_f32_16x16x32_bf16 a[44:47], v[88:91], v[36:39], a[44:47]
    v_mfma_f32_16x16x32_bf16 a[56:59], v[92:95], v[36:39], a[56:59]
    ds_read_b64_tr_b16 v[108:109], v12 offset:16384
    v_mfma_f32_16x16x32_bf16 a[60:63], v[96:99], v[36:39], a[60:63]
    ds_read_b128 v[36:39], v9 offset:2048
    v_mfma_f32_16x16x32_bf16 a[64:67], v[68:71], v[40:43], a[64:67]
    v_mfma_f32_16x16x32_bf16 a[68:71], v[72:75], v[40:43], a[68:71]
    ds_read_b64_tr_b16 v[110:111], v12 offset:16896
    v_mfma_f32_16x16x32_bf16 a[80:83], v[76:79], v[40:43], a[80:83]
    buffer_load_dwordx4 v22, s[16:19], s26 offen offset:2048 sc1 lds
    v_mfma_f32_16x16x32_bf16 a[84:87], v[80:83], v[40:43], a[84:87]
    v_mfma_f32_16x16x32_bf16 a[96:99], v[84:87], v[40:43], a[96:99]
    ds_read_b64_tr_b16 v[112:113], v13 offset:16384
    v_mfma_f32_16x16x32_bf16 a[100:103], v[88:91], v[40:43], a[100:103]
    v_mfma_f32_16x16x32_bf16 a[112:115], v[92:95], v[40:43], a[112:115]
    v_mfma_f32_16x16x32_bf16 a[116:119], v[96:99], v[40:43], a[116:119]
    ds_read_b64_tr_b16 v[114:115], v13 offset:16896
    ds_read_b128 v[40:43], v9 offset:4096
    v_mfma_f32_16x16x32_bf16 a[72:75], v[68:71], v[44:47], a[72:75]
    v_mfma_f32_16x16x32_bf16 a[76:79], v[72:75], v[44:47], a[76:79]
    buffer_load_dwordx4 v23, s[16:19], s26 offen offset:3072 sc1 lds
    v_mfma_f32_16x16x32_bf16 a[88:91], v[76:79], v[44:47], a[88:91]
    s_add_u32 s26, s26, 128
    ds_read_b64_tr_b16 v[116:117], v10 offset:20480
    v_mfma_f32_16x16x32_bf16 a[92:95], v[80:83], v[44:47], a[92:95]
    v_mfma_f32_16x16x32_bf16 a[104:107], v[84:87], v[44:47], a[104:107]
    v_mfma_f32_16x16x32_bf16 a[108:111], v[88:91], v[44:47], a[108:111]
    ds_read_b64_tr_b16 v[118:119], v10 offset:20992
    v_mfma_f32_16x16x32_bf16 a[120:123], v[92:95], v[44:47], a[120:123]
    v_mfma_f32_16x16x32_bf16 a[124:127], v[96:99], v[44:47], a[124:127]
    s_add_u32 m0, s76, 114688
    ds_read_b128 v[44:47], v9 offset:6144
    v_mfma_f32_16x16x32_bf16 a[128:131], v[68:71], v[48:51], a[128:131]
    ds_read_b64_tr_b16 v[120:121], v11 offset:20480
    buffer_load_dwordx4 v16, s[52:55], s77 offen offset:0 lds
    v_mfma_f32_16x16x32_bf16 a[132:135], v[72:75], v[48:51], a[132:135]
    v_mfma_f32_16x16x32_bf16 a[144:147], v[76:79], v[48:51], a[144:147]
    v_mfma_f32_16x16x32_bf16 a[148:151], v[80:83], v[48:51], a[148:151]
    ds_read_b64_tr_b16 v[122:123], v11 offset:20992
    v_mfma_f32_16x16x32_bf16 a[160:163], v[84:87], v[48:51], a[160:163]
    v_mfma_f32_16x16x32_bf16 a[164:167], v[88:91], v[48:51], a[164:167]
    v_mfma_f32_16x16x32_bf16 a[176:179], v[92:95], v[48:51], a[176:179]
    ds_read_b64_tr_b16 v[124:125], v12 offset:20480
    v_mfma_f32_16x16x32_bf16 a[180:183], v[96:99], v[48:51], a[180:183]
    ds_read_b128 v[48:51], v9 offset:8192
    buffer_load_dwordx4 v17, s[52:55], s77 offen offset:1024 lds
    v_mfma_f32_16x16x32_bf16 a[136:139], v[68:71], v[52:55], a[136:139]
    s_add_u32 s33, s35, s34
    v_mfma_f32_16x16x32_bf16 a[140:143], v[72:75], v[52:55], a[140:143]
    ds_read_b64_tr_b16 v[126:127], v12 offset:20992
    v_mfma_f32_16x16x32_bf16 a[152:155], v[76:79], v[52:55], a[152:155]
    v_mfma_f32_16x16x32_bf16 a[156:159], v[80:83], v[52:55], a[156:159]
    v_mfma_f32_16x16x32_bf16 a[168:171], v[84:87], v[52:55], a[168:171]
    s_add_u32 s34, s34, 32768
    ds_read_b64_tr_b16 v[128:129], v13 offset:20480
    v_mfma_f32_16x16x32_bf16 a[172:175], v[88:91], v[52:55], a[172:175]
    v_mfma_f32_16x16x32_bf16 a[184:187], v[92:95], v[52:55], a[184:187]
    buffer_load_dwordx4 v18, s[52:55], s77 offen offset:2048 lds
    v_mfma_f32_16x16x32_bf16 a[188:191], v[96:99], v[52:55], a[188:191]
    ds_read_b64_tr_b16 v[130:131], v13 offset:20992
    ds_read_b128 v[52:55], v9 offset:10240
    v_mfma_f32_16x16x32_bf16 a[192:195], v[68:71], v[56:59], a[192:195]
    s_cmp_eq_u32 s34, 98304
    s_cselect_b32 s34, 0, s34
    v_mfma_f32_16x16x32_bf16 a[196:199], v[72:75], v[56:59], a[196:199]
    v_mfma_f32_16x16x32_bf16 a[208:211], v[76:79], v[56:59], a[208:211]
    v_mfma_f32_16x16x32_bf16 a[212:215], v[80:83], v[56:59], a[212:215]
    v_mfma_f32_16x16x32_bf16 a[224:227], v[84:87], v[56:59], a[224:227]
    v_mfma_f32_16x16x32_bf16 a[228:231], v[88:91], v[56:59], a[228:231]
    buffer_load_dwordx4 v19, s[52:55], s77 offen offset:3072 lds
    v_mfma_f32_16x16x32_bf16 a[240:243], v[92:95], v[56:59], a[240:243]
    s_add_u32 s77, s77, 114688
    v_mfma_f32_16x16x32_bf16 a[244:247], v[96:99], v[56:59], a[244:247]
    ds_read_b128 v[56:59], v9 offset:12288
    v_mfma_f32_16x16x32_bf16 a[200:203], v[68:71], v[60:63], a[200:203]
    v_add_u32 v8, s34, v28
    v_mfma_f32_16x16x32_bf16 a[204:207], v[72:75], v[60:63], a[204:207]
    v_add_u32 v9, s34, v29
    v_mfma_f32_16x16x32_bf16 a[216:219], v[76:79], v[60:63], a[216:219]
    v_xor_b32 v10, 0x8000, v10
    v_mfma_f32_16x16x32_bf16 a[220:223], v[80:83], v[60:63], a[220:223]
    v_mfma_f32_16x16x32_bf16 a[232:235], v[84:87], v[60:63], a[232:235]
    v_xor_b32 v11, 0x8000, v11
    v_mfma_f32_16x16x32_bf16 a[236:239], v[88:91], v[60:63], a[236:239]
    v_xor_b32 v12, 0x8000, v12
    v_mfma_f32_16x16x32_bf16 a[248:251], v[92:95], v[60:63], a[248:251]
    s_waitcnt lgkmcnt(0)
    v_xor_b32 v13, 0x8000, v13
    v_mfma_f32_16x16x32_bf16 a[252:255], v[96:99], v[60:63], a[252:255]
    v_mfma_f32_16x16x32_bf16 a[0:3], v[100:103], v[32:35], a[0:3]
    s_waitcnt vmcnt(18)
    v_mfma_f32_16x16x32_bf16 a[4:7], v[104:107], v[32:35], a[4:7]
    s_barrier
    v_mfma_f32_16x16x32_bf16 a[16:19], v[108:111], v[32:35], a[16:19]
    s_lshl_b32 s30, s21, 14
    ds_read_b64_tr_b16 v[68:69], v10 offset:0
    v_mfma_f32_16x16x32_bf16 a[20:23], v[112:115], v[32:35], a[20:23]
    s_add_u32 m0, s76, 16384
    ds_read_b128 v[60:63], v8 offset:14336
    v_mfma_f32_16x16x32_bf16 a[32:35], v[116:119], v[32:35], a[32:35]
    buffer_load_dwordx4 v20, s[16:19], s26 offen offset:0 sc1 lds
    v_mfma_f32_16x16x32_bf16 a[36:39], v[120:123], v[32:35], a[36:39]
    ds_read_b64_tr_b16 v[70:71], v10 offset:512
    v_mfma_f32_16x16x32_bf16 a[48:51], v[124:127], v[32:35], a[48:51]
    s_add_u32 s30, s30, 65536
    v_mfma_f32_16x16x32_bf16 a[52:55], v[128:131], v[32:35], a[52:55]
    ds_read_b128 v[32:35], v8 offset:0
    v_mfma_f32_16x16x32_bf16 a[8:11], v[100:103], v[36:39], a[8:11]
    ds_read_b64_tr_b16 v[72:73], v11 offset:0
    v_mfma_f32_16x16x32_bf16 a[12:15], v[104:107], v[36:39], a[12:15]
    v_mfma_f32_16x16x32_bf16 a[24:27], v[108:111], v[36:39], a[24:27]
    v_subrev_u32 v28, s30, v28
    v_mfma_f32_16x16x32_bf16 a[28:31], v[112:115], v[36:39], a[28:31]
    ds_read_b64_tr_b16 v[74:75], v11 offset:512
    buffer_load_dwordx4 v21, s[16:19], s26 offen offset:1024 sc1 lds
    v_mfma_f32_16x16x32_bf16 a[40:43], v[116:119], v[36:39], a[40:43]
    v_mfma_f32_16x16x32_bf16 a[44:47], v[120:123], v[36:39], a[44:47]
    v_mfma_f32_16x16x32_bf16 a[56:59], v[124:127], v[36:39], a[56:59]
    ds_read_b64_tr_b16 v[76:77], v12 offset:0
    v_subrev_u32 v29, s30, v29
    v_mfma_f32_16x16x32_bf16 a[60:63], v[128:131], v[36:39], a[60:63]
    ds_read_b128 v[36:39], v8 offset:2048
    v_mfma_f32_16x16x32_bf16 a[64:67], v[100:103], v[40:43], a[64:67]
    v_mfma_f32_16x16x32_bf16 a[68:71], v[104:107], v[40:43], a[68:71]
    ds_read_b64_tr_b16 v[78:79], v12 offset:512
    v_mfma_f32_16x16x32_bf16 a[80:83], v[108:111], v[40:43], a[80:83]
    s_lshl_b32 s30, s21, 12
    buffer_load_dwordx4 v22, s[16:19], s26 offen offset:2048 sc1 lds
    v_mfma_f32_16x16x32_bf16 a[84:87], v[112:115], v[40:43], a[84:87]
    v_mfma_f32_16x16x32_bf16 a[96:99], v[116:119], v[40:43], a[96:99]
    ds_read_b64_tr_b16 v[80:81], v13 offset:0
    v_mfma_f32_16x16x32_bf16 a[100:103], v[120:123], v[40:43], a[100:103]
    v_mfma_f32_16x16x32_bf16 a[112:115], v[124:127], v[40:43], a[112:115]
    v_mfma_f32_16x16x32_bf16 a[116:119], v[128:131], v[40:43], a[116:119]
    s_lshl_b32 s31, s22, 13
    ds_read_b64_tr_b16 v[82:83], v13 offset:512
    ds_read_b128 v[40:43], v8 offset:4096
    v_mfma_f32_16x16x32_bf16 a[72:75], v[100:103], v[44:47], a[72:75]
    v_mfma_f32_16x16x32_bf16 a[76:79], v[104:107], v[44:47], a[76:79]
    buffer_load_dwordx4 v23, s[16:19], s26 offen offset:3072 sc1 lds
    v_mfma_f32_16x16x32_bf16 a[88:91], v[108:111], v[44:47], a[88:91]
    s_add_u32 s26, s26, 128
    ds_read_b64_tr_b16 v[84:85], v10 offset:4096
    v_mfma_f32_16x16x32_bf16 a[92:95], v[112:115], v[44:47], a[92:95]
    s_sub_u32 s30, s30, s31
    v_mfma_f32_16x16x32_bf16 a[104:107], v[116:119], v[44:47], a[104:107]
    v_mfma_f32_16x16x32_bf16 a[108:111], v[120:123], v[44:47], a[108:111]
    ds_read_b64_tr_b16 v[86:87], v10 offset:4608
    v_mfma_f32_16x16x32_bf16 a[120:123], v[124:127], v[44:47], a[120:123]
    v_mfma_f32_16x16x32_bf16 a[124:127], v[128:131], v[44:47], a[124:127]
    s_add_u32 m0, s76, 131072
    s_add_u32 s30, s30, 32768
    ds_read_b128 v[44:47], v8 offset:6144
    v_mfma_f32_16x16x32_bf16 a[128:131], v[100:103], v[48:51], a[128:131]
    ds_read_b64_tr_b16 v[88:89], v11 offset:4096
    buffer_load_dwordx4 v16, s[52:55], s77 offen offset:0 lds
    v_mfma_f32_16x16x32_bf16 a[132:135], v[104:107], v[48:51], a[132:135]
    v_mfma_f32_16x16x32_bf16 a[144:147], v[108:111], v[48:51], a[144:147]
    v_mfma_f32_16x16x32_bf16 a[148:151], v[112:115], v[48:51], a[148:151]
    s_cmp_lg_u32 s22, 0
    s_cselect_b64 vcc, -1, 0
    ds_read_b64_tr_b16 v[90:91], v11 offset:4608
    v_mfma_f32_16x16x32_bf16 a[160:163], v[116:119], v[48:51], a[160:163]
    v_mfma_f32_16x16x32_bf16 a[164:167], v[120:123], v[48:51], a[164:167]
    v_mfma_f32_16x16x32_bf16 a[176:179], v[124:127], v[48:51], a[176:179]
    ds_read_b64_tr_b16 v[92:93], v12 offset:4096
    v_mfma_f32_16x16x32_bf16 a[180:183], v[128:131], v[48:51], a[180:183]
    ds_read_b128 v[48:51], v8 offset:8192
    buffer_load_dwordx4 v17, s[52:55], s77 offen offset:1024 lds
    v_mfma_f32_16x16x32_bf16 a[136:139], v[100:103], v[52:55], a[136:139]
    v_mfma_f32_16x16x32_bf16 a[140:143], v[104:107], v[52:55], a[140:143]
    ds_read_b64_tr_b16 v[94:95], v12 offset:4608
    v_mfma_f32_16x16x32_bf16 a[152:155], v[108:111], v[52:55], a[152:155]
    v_mfma_f32_16x16x32_bf16 a[156:159], v[112:115], v[52:55], a[156:159]
    v_mfma_f32_16x16x32_bf16 a[168:171], v[116:119], v[52:55], a[168:171]
    ds_read_b64_tr_b16 v[96:97], v13 offset:4096
    v_cndmask_b32 v30, v10, v12, vcc
    v_mfma_f32_16x16x32_bf16 a[172:175], v[120:123], v[52:55], a[172:175]
    v_mfma_f32_16x16x32_bf16 a[184:187], v[124:127], v[52:55], a[184:187]
    buffer_load_dwordx4 v18, s[52:55], s77 offen offset:2048 lds
    v_mfma_f32_16x16x32_bf16 a[188:191], v[128:131], v[52:55], a[188:191]
    ds_read_b64_tr_b16 v[98:99], v13 offset:4608
    ds_read_b128 v[52:55], v8 offset:10240
    v_mfma_f32_16x16x32_bf16 a[192:195], v[100:103], v[56:59], a[192:195]
    v_add_u32 v30, s30, v30
    v_mfma_f32_16x16x32_bf16 a[196:199], v[104:107], v[56:59], a[196:199]
    v_mfma_f32_16x16x32_bf16 a[208:211], v[108:111], v[56:59], a[208:211]
    v_mfma_f32_16x16x32_bf16 a[212:215], v[112:115], v[56:59], a[212:215]
    v_mfma_f32_16x16x32_bf16 a[224:227], v[116:119], v[56:59], a[224:227]
    v_cndmask_b32 v31, v11, v13, vcc
    v_mfma_f32_16x16x32_bf16 a[228:231], v[120:123], v[56:59], a[228:231]
    buffer_load_dwordx4 v19, s[52:55], s77 offen offset:3072 lds
    v_mfma_f32_16x16x32_bf16 a[240:243], v[124:127], v[56:59], a[240:243]
    s_add_u32 s77, s77, 114688
    v_mfma_f32_16x16x32_bf16 a[244:247], v[128:131], v[56:59], a[244:247]
    ds_read_b128 v[56:59], v8 offset:12288
    v_mfma_f32_16x16x32_bf16 a[200:203], v[100:103], v[64:67], a[200:203]
    v_add_u32 v31, s30, v31
    v_mfma_f32_16x16x32_bf16 a[204:207], v[104:107], v[64:67], a[204:207]
    v_mfma_f32_16x16x32_bf16 a[216:219], v[108:111], v[64:67], a[216:219]
    v_mfma_f32_16x16x32_bf16 a[220:223], v[112:115], v[64:67], a[220:223]
    v_mfma_f32_16x16x32_bf16 a[232:235], v[116:119], v[64:67], a[232:235]
    v_mfma_f32_16x16x32_bf16 a[236:239], v[120:123], v[64:67], a[236:239]
    v_mfma_f32_16x16x32_bf16 a[248:251], v[124:127], v[64:67], a[248:251]
    s_waitcnt lgkmcnt(15)
    v_mfma_f32_16x16x32_bf16 a[252:255], v[128:131], v[64:67], a[252:255]
    v_mfma_f32_16x16x32_bf16 a[0:3], v[68:71], v[32:35], a[0:3]
    s_waitcnt vmcnt(21) lgkmcnt(0)
    v_mfma_f32_16x16x32_bf16 a[4:7], v[72:75], v[32:35], a[4:7]
    s_barrier
    v_mfma_f32_16x16x32_bf16 a[16:19], v[76:79], v[32:35], a[16:19]
    s_lshl_b32 s30, s24, 6
    ds_read_b64_tr_b16 v[100:101], v10 offset:16384
    v_mfma_f32_16x16x32_bf16 a[20:23], v[80:83], v[32:35], a[20:23]
    s_add_u32 m0, s76, 32768
    ds_read_b128 v[64:67], v9 offset:14336
    v_mfma_f32_16x16x32_bf16 a[32:35], v[84:87], v[32:35], a[32:35]
    s_lshl_b32 s31, s23, 3
    buffer_load_dwordx4 v20, s[16:19], s26 offen offset:0 sc1 lds
    v_mfma_f32_16x16x32_bf16 a[36:39], v[88:91], v[32:35], a[36:39]
    ds_read_b64_tr_b16 v[102:103], v10 offset:16896
    v_mfma_f32_16x16x32_bf16 a[48:51], v[92:95], v[32:35], a[48:51]
    s_add_u32 s30, s30, s31
    v_mfma_f32_16x16x32_bf16 a[52:55], v[96:99], v[32:35], a[52:55]
    ds_read_b128 v[32:35], v9 offset:0
    v_mfma_f32_16x16x32_bf16 a[8:11], v[68:71], v[36:39], a[8:11]
    s_lshl_b32 s31, s21, 2
    ds_read_b64_tr_b16 v[104:105], v11 offset:16384
    v_mfma_f32_16x16x32_bf16 a[12:15], v[72:75], v[36:39], a[12:15]
    v_mfma_f32_16x16x32_bf16 a[24:27], v[76:79], v[36:39], a[24:27]
    s_add_u32 s30, s30, s31
    v_mfma_f32_16x16x32_bf16 a[28:31], v[80:83], v[36:39], a[28:31]
    ds_read_b64_tr_b16 v[106:107], v11 offset:16896
    buffer_load_dwordx4 v21, s[16:19], s26 offen offset:1024 sc1 lds
    v_mfma_f32_16x16x32_bf16 a[40:43], v[84:87], v[36:39], a[40:43]
    s_lshl_b32 s32, s30, 14
    v_mfma_f32_16x16x32_bf16 a[44:47], v[88:91], v[36:39], a[44:47]
    v_mfma_f32_16x16x32_bf16 a[56:59], v[92:95], v[36:39], a[56:59]
    s_lshl_b32 s31, s22, 13
    ds_read_b64_tr_b16 v[108:109], v12 offset:16384
    v_mfma_f32_16x16x32_bf16 a[60:63], v[96:99], v[36:39], a[60:63]
    ds_read_b128 v[36:39], v9 offset:2048
    v_mfma_f32_16x16x32_bf16 a[64:67], v[68:71], v[40:43], a[64:67]
    s_add_u32 s32, s32, s31
    v_mfma_f32_16x16x32_bf16 a[68:71], v[72:75], v[40:43], a[68:71]
    ds_read_b64_tr_b16 v[110:111], v12 offset:16896
    v_mfma_f32_16x16x32_bf16 a[80:83], v[76:79], v[40:43], a[80:83]
    s_lshl_b32 s31, s25, 24
    buffer_load_dwordx4 v22, s[16:19], s26 offen offset:2048 sc1 lds
    v_mfma_f32_16x16x32_bf16 a[84:87], v[80:83], v[40:43], a[84:87]
    v_mfma_f32_16x16x32_bf16 a[96:99], v[84:87], v[40:43], a[96:99]
    s_add_u32 s32, s32, s31
    ds_read_b64_tr_b16 v[112:113], v13 offset:16384
    v_mfma_f32_16x16x32_bf16 a[100:103], v[88:91], v[40:43], a[100:103]
    v_mfma_f32_16x16x32_bf16 a[112:115], v[92:95], v[40:43], a[112:115]
    s_mov_b32 s12, s68
    v_mfma_f32_16x16x32_bf16 a[116:119], v[96:99], v[40:43], a[116:119]
    ds_read_b64_tr_b16 v[114:115], v13 offset:16896
    ds_read_b128 v[40:43], v9 offset:4096
    v_mfma_f32_16x16x32_bf16 a[72:75], v[68:71], v[44:47], a[72:75]
    s_and_b32 s13, s69, 0xffff
    v_mfma_f32_16x16x32_bf16 a[76:79], v[72:75], v[44:47], a[76:79]
    buffer_load_dwordx4 v23, s[16:19], s26 offen offset:3072 sc1 lds
    v_mfma_f32_16x16x32_bf16 a[88:91], v[76:79], v[44:47], a[88:91]
    s_add_u32 s26, s26, 128
    s_mov_b32 s14, 3670016
    ds_read_b64_tr_b16 v[116:117], v10 offset:20480
    v_mfma_f32_16x16x32_bf16 a[92:95], v[80:83], v[44:47], a[92:95]
    v_mfma_f32_16x16x32_bf16 a[104:107], v[84:87], v[44:47], a[104:107]
    s_lshl_b32 s27, s24, 9
    v_mfma_f32_16x16x32_bf16 a[108:111], v[88:91], v[44:47], a[108:111]
    ds_read_b64_tr_b16 v[118:119], v10 offset:20992
    v_mfma_f32_16x16x32_bf16 a[120:123], v[92:95], v[44:47], a[120:123]
    s_mov_b32 s8, s70
    v_mfma_f32_16x16x32_bf16 a[124:127], v[96:99], v[44:47], a[124:127]
    s_add_u32 m0, s76, 147456
    ds_read_b128 v[44:47], v9 offset:6144
    v_mfma_f32_16x16x32_bf16 a[128:131], v[68:71], v[48:51], a[128:131]
    s_and_b32 s9, s71, 0xffff
    ds_read_b64_tr_b16 v[120:121], v11 offset:20480
    buffer_load_dwordx4 v16, s[52:55], s77 offen offset:0 lds
    v_mfma_f32_16x16x32_bf16 a[132:135], v[72:75], v[48:51], a[132:135]
    v_mfma_f32_16x16x32_bf16 a[144:147], v[76:79], v[48:51], a[144:147]
    s_mov_b32 s10, 3670016
    v_mfma_f32_16x16x32_bf16 a[148:151], v[80:83], v[48:51], a[148:151]
    ds_read_b64_tr_b16 v[122:123], v11 offset:20992
    v_mfma_f32_16x16x32_bf16 a[160:163], v[84:87], v[48:51], a[160:163]
    s_mul_i32 s33, s24, 229376
    v_mfma_f32_16x16x32_bf16 a[164:167], v[88:91], v[48:51], a[164:167]
    v_mfma_f32_16x16x32_bf16 a[176:179], v[92:95], v[48:51], a[176:179]
    s_mul_i32 s34, s41, 1835008
    ds_read_b64_tr_b16 v[124:125], v12 offset:20480
    v_mfma_f32_16x16x32_bf16 a[180:183], v[96:99], v[48:51], a[180:183]
    ds_read_b128 v[48:51], v9 offset:8192
    buffer_load_dwordx4 v17, s[52:55], s77 offen offset:1024 lds
    v_mfma_f32_16x16x32_bf16 a[136:139], v[68:71], v[52:55], a[136:139]
    s_lshl_b32 s30, s21, 16
    v_mfma_f32_16x16x32_bf16 a[140:143], v[72:75], v[52:55], a[140:143]
    ds_read_b64_tr_b16 v[126:127], v12 offset:20992
    v_mfma_f32_16x16x32_bf16 a[152:155], v[76:79], v[52:55], a[152:155]
    s_add_u32 s34, s34, s30
    v_mfma_f32_16x16x32_bf16 a[156:159], v[80:83], v[52:55], a[156:159]
    v_mfma_f32_16x16x32_bf16 a[168:171], v[84:87], v[52:55], a[168:171]
    s_lshl_b32 s30, s22, 17
    ds_read_b64_tr_b16 v[128:129], v13 offset:20480
    v_mfma_f32_16x16x32_bf16 a[172:175], v[88:91], v[52:55], a[172:175]
    v_mfma_f32_16x16x32_bf16 a[184:187], v[92:95], v[52:55], a[184:187]
    s_add_u32 s34, s34, s30
    buffer_load_dwordx4 v18, s[52:55], s77 offen offset:2048 lds
    v_mfma_f32_16x16x32_bf16 a[188:191], v[96:99], v[52:55], a[188:191]
    ds_read_b64_tr_b16 v[130:131], v13 offset:20992
    ds_read_b128 v[52:55], v9 offset:10240
    v_mfma_f32_16x16x32_bf16 a[192:195], v[68:71], v[56:59], a[192:195]
    s_add_u32 s34, s34, 39845888
    v_mfma_f32_16x16x32_bf16 a[196:199], v[72:75], v[56:59], a[196:199]
    v_mfma_f32_16x16x32_bf16 a[208:211], v[76:79], v[56:59], a[208:211]
    s_cmp_lt_u32 s24, 14
    s_cselect_b32 s34, s34, 1073741824
    v_mfma_f32_16x16x32_bf16 a[212:215], v[80:83], v[56:59], a[212:215]
    v_mfma_f32_16x16x32_bf16 a[224:227], v[84:87], v[56:59], a[224:227]
    v_mfma_f32_16x16x32_bf16 a[228:231], v[88:91], v[56:59], a[228:231]
    buffer_load_dwordx4 v19, s[52:55], s77 offen offset:3072 lds
    v_mfma_f32_16x16x32_bf16 a[240:243], v[92:95], v[56:59], a[240:243]
    s_add_u32 s77, s77, 114688
    s_mov_b32 s44, 1035512379
    v_mfma_f32_16x16x32_bf16 a[244:247], v[96:99], v[56:59], a[244:247]
    ds_read_b128 v[56:59], v9 offset:12288
    v_mfma_f32_16x16x32_bf16 a[200:203], v[68:71], v[60:63], a[200:203]
    s_mov_b32 s45, 1035512379
    v_mfma_f32_16x16x32_bf16 a[204:207], v[72:75], v[60:63], a[204:207]
    v_mfma_f32_16x16x32_bf16 a[216:219], v[76:79], v[60:63], a[216:219]
    s_mov_b32 s40, 3216550459
    v_mfma_f32_16x16x32_bf16 a[220:223], v[80:83], v[60:63], a[220:223]
    v_mfma_f32_16x16x32_bf16 a[232:235], v[84:87], v[60:63], a[232:235]
    v_mfma_f32_16x16x32_bf16 a[236:239], v[88:91], v[60:63], a[236:239]
    v_mfma_f32_16x16x32_bf16 a[248:251], v[92:95], v[60:63], a[248:251]
    s_waitcnt lgkmcnt(15)
    v_mfma_f32_16x16x32_bf16 a[252:255], v[96:99], v[60:63], a[252:255]
    v_mfma_f32_16x16x32_bf16 a[0:3], v[100:103], v[32:35], a[0:3]
    s_waitcnt vmcnt(20) lgkmcnt(0)
    v_mfma_f32_16x16x32_bf16 a[4:7], v[104:107], v[32:35], a[4:7]
    s_barrier
    v_mfma_f32_16x16x32_bf16 a[16:19], v[108:111], v[32:35], a[16:19]
    ds_read_b64_tr_b16 v[68:69], v30 offset:32768
    v_add_u32 v8, 65536, v30
    v_mfma_f32_16x16x32_bf16 a[20:23], v[112:115], v[32:35], a[20:23]
    s_add_u32 m0, s76, 49152
    ds_read_b128 v[60:63], v28 offset:14336
    v_mfma_f32_16x16x32_bf16 a[32:35], v[116:119], v[32:35], a[32:35]
    buffer_load_dwordx4 v20, s[16:19], s26 offen offset:0 sc1 lds
    v_mfma_f32_16x16x32_bf16 a[36:39], v[120:123], v[32:35], a[36:39]
    ds_read_b64_tr_b16 v[70:71], v30 offset:33280
    v_mfma_f32_16x16x32_bf16 a[48:51], v[124:127], v[32:35], a[48:51]
    v_add_u32 v9, 65536, v31
    v_mfma_f32_16x16x32_bf16 a[52:55], v[128:131], v[32:35], a[52:55]
    ds_read_b128 v[32:35], v28 offset:0
    v_mfma_f32_16x16x32_bf16 a[8:11], v[100:103], v[36:39], a[8:11]
    ds_read_b64_tr_b16 v[72:73], v31 offset:32768
    v_mfma_f32_16x16x32_bf16 a[12:15], v[104:107], v[36:39], a[12:15]
    buffer_load_dwordx4 v21, s[16:19], s26 offen offset:1024 sc1 lds
    v_mfma_f32_16x16x32_bf16 a[24:27], v[108:111], v[36:39], a[24:27]
    v_mfma_f32_16x16x32_bf16 a[28:31], v[112:115], v[36:39], a[28:31]
    ds_read_b64_tr_b16 v[74:75], v31 offset:33280
    v_mfma_f32_16x16x32_bf16 a[40:43], v[116:119], v[36:39], a[40:43]
    v_mfma_f32_16x16x32_bf16 a[44:47], v[120:123], v[36:39], a[44:47]
    v_mfma_f32_16x16x32_bf16 a[56:59], v[124:127], v[36:39], a[56:59]
    ds_read_b64_tr_b16 v[76:77], v30 offset:40960
    buffer_load_dwordx4 v22, s[16:19], s26 offen offset:2048 sc1 lds
    v_mfma_f32_16x16x32_bf16 a[60:63], v[128:131], v[36:39], a[60:63]
    ds_read_b128 v[36:39], v28 offset:2048
    v_mfma_f32_16x16x32_bf16 a[64:67], v[100:103], v[40:43], a[64:67]
    v_mfma_f32_16x16x32_bf16 a[68:71], v[104:107], v[40:43], a[68:71]
    ds_read_b64_tr_b16 v[78:79], v30 offset:41472
    v_mfma_f32_16x16x32_bf16 a[80:83], v[108:111], v[40:43], a[80:83]
    v_accvgpr_read_b32 v232, a0
    v_mfma_f32_16x16x32_bf16 a[84:87], v[112:115], v[40:43], a[84:87]
    buffer_load_dwordx4 v23, s[16:19], s26 offen offset:3072 sc1 lds
    v_accvgpr_read_b32 v233, a1
    v_mfma_f32_16x16x32_bf16 a[96:99], v[116:119], v[40:43], a[96:99]
    s_add_u32 s26, s26, 128
    ds_read_b64_tr_b16 v[80:81], v31 offset:40960
    v_mfma_f32_16x16x32_bf16 a[100:103], v[120:123], v[40:43], a[100:103]
    v_accvgpr_read_b32 v234, a2
    v_mfma_f32_16x16x32_bf16 a[112:115], v[124:127], v[40:43], a[112:115]
    v_accvgpr_read_b32 v235, a3
    v_mfma_f32_16x16x32_bf16 a[116:119], v[128:131], v[40:43], a[116:119]
    s_add_u32 m0, s76, 65536
    ds_read_b64_tr_b16 v[82:83], v31 offset:41472
    ds_read_b128 v[40:43], v28 offset:4096
    v_mfma_f32_16x16x32_bf16 a[72:75], v[100:103], v[44:47], a[72:75]
    buffer_load_dwordx4 v16, s[52:55], s77 offen offset:0 lds
    v_accvgpr_read_b32 v236, a4
    v_mfma_f32_16x16x32_bf16 a[76:79], v[104:107], v[44:47], a[76:79]
    v_mfma_f32_16x16x32_bf16 a[88:91], v[108:111], v[44:47], a[88:91]
    v_accvgpr_read_b32 v237, a5
    v_mfma_f32_16x16x32_bf16 a[92:95], v[112:115], v[44:47], a[92:95]
    v_accvgpr_read_b32 v238, a6
    v_mfma_f32_16x16x32_bf16 a[104:107], v[116:119], v[44:47], a[104:107]
    v_mfma_f32_16x16x32_bf16 a[108:111], v[120:123], v[44:47], a[108:111]
    buffer_load_dwordx4 v17, s[52:55], s77 offen offset:1024 lds
    v_accvgpr_read_b32 v239, a7
    v_mfma_f32_16x16x32_bf16 a[120:123], v[124:127], v[44:47], a[120:123]
    v_mfma_f32_16x16x32_bf16 a[124:127], v[128:131], v[44:47], a[124:127]
    ds_read_b128 v[44:47], v28 offset:6144
    v_cvt_pk_bf16_f32 v232, v232, v233
    v_mfma_f32_16x16x32_bf16 a[128:131], v[100:103], v[48:51], a[128:131]
    v_cvt_pk_bf16_f32 v233, v234, v235
    v_mfma_f32_16x16x32_bf16 a[132:135], v[104:107], v[48:51], a[132:135]
    v_mfma_f32_16x16x32_bf16 a[144:147], v[108:111], v[48:51], a[144:147]
    buffer_load_dwordx4 v18, s[52:55], s77 offen offset:2048 lds
    v_cvt_pk_bf16_f32 v234, v236, v237
    v_mfma_f32_16x16x32_bf16 a[148:151], v[112:115], v[48:51], a[148:151]
    v_mfma_f32_16x16x32_bf16 a[160:163], v[116:119], v[48:51], a[160:163]
    v_cvt_pk_bf16_f32 v235, v238, v239
    v_mfma_f32_16x16x32_bf16 a[164:167], v[120:123], v[48:51], a[164:167]
    buffer_store_dwordx4 v[232:235], v14, s[16:19], s32 offen offset:0 sc1
    v_mfma_f32_16x16x32_bf16 a[176:179], v[124:127], v[48:51], a[176:179]
    v_mfma_f32_16x16x32_bf16 a[180:183], v[128:131], v[48:51], a[180:183]
    ds_read_b128 v[48:51], v28 offset:8192
    buffer_load_dwordx4 v19, s[52:55], s77 offen offset:3072 lds
    v_mfma_f32_16x16x32_bf16 a[136:139], v[100:103], v[52:55], a[136:139]
    s_add_u32 s77, s77, 114688
    v_mfma_f32_16x16x32_bf16 a[140:143], v[104:107], v[52:55], a[140:143]
    v_accvgpr_read_b32 v240, a8
    v_mfma_f32_16x16x32_bf16 a[152:155], v[108:111], v[52:55], a[152:155]
    v_accvgpr_read_b32 v241, a9
    v_mfma_f32_16x16x32_bf16 a[156:159], v[112:115], v[52:55], a[156:159]
    s_add_u32 m0, s76, 81920
    v_mfma_f32_16x16x32_bf16 a[168:171], v[116:119], v[52:55], a[168:171]
    buffer_load_dwordx4 v16, s[52:55], s77 offen offset:0 lds
    v_accvgpr_read_b32 v242, a10
    v_mfma_f32_16x16x32_bf16 a[172:175], v[120:123], v[52:55], a[172:175]
    v_accvgpr_read_b32 v243, a11
    v_mfma_f32_16x16x32_bf16 a[184:187], v[124:127], v[52:55], a[184:187]
    v_mfma_f32_16x16x32_bf16 a[188:191], v[128:131], v[52:55], a[188:191]
    ds_read_b128 v[52:55], v28 offset:10240
    v_accvgpr_read_b32 v244, a12
    v_mfma_f32_16x16x32_bf16 a[192:195], v[100:103], v[56:59], a[192:195]
    v_mfma_f32_16x16x32_bf16 a[196:199], v[104:107], v[56:59], a[196:199]
    buffer_load_dwordx4 v17, s[52:55], s77 offen offset:1024 lds
    v_accvgpr_read_b32 v245, a13
    v_mfma_f32_16x16x32_bf16 a[208:211], v[108:111], v[56:59], a[208:211]
    v_accvgpr_read_b32 v246, a14
    v_mfma_f32_16x16x32_bf16 a[212:215], v[112:115], v[56:59], a[212:215]
    v_mfma_f32_16x16x32_bf16 a[224:227], v[116:119], v[56:59], a[224:227]
    v_accvgpr_read_b32 v247, a15
    v_mfma_f32_16x16x32_bf16 a[228:231], v[120:123], v[56:59], a[228:231]
    v_mfma_f32_16x16x32_bf16 a[240:243], v[124:127], v[56:59], a[240:243]
    buffer_load_dwordx4 v18, s[52:55], s77 offen offset:2048 lds
    v_cvt_pk_bf16_f32 v240, v240, v241
    v_mfma_f32_16x16x32_bf16 a[244:247], v[128:131], v[56:59], a[244:247]
    ds_read_b128 v[56:59], v28 offset:12288
    v_cvt_pk_bf16_f32 v241, v242, v243
    v_mfma_f32_16x16x32_bf16 a[200:203], v[100:103], v[64:67], a[200:203]
    v_mfma_f32_16x16x32_bf16 a[204:207], v[104:107], v[64:67], a[204:207]
    v_cvt_pk_bf16_f32 v242, v244, v245
    v_mfma_f32_16x16x32_bf16 a[216:219], v[108:111], v[64:67], a[216:219]
    v_mfma_f32_16x16x32_bf16 a[220:223], v[112:115], v[64:67], a[220:223]
    buffer_load_dwordx4 v19, s[52:55], s77 offen offset:3072 lds
    v_cvt_pk_bf16_f32 v243, v246, v247
    v_mfma_f32_16x16x32_bf16 a[232:235], v[116:119], v[64:67], a[232:235]
    s_add_u32 s77, s77, 114688
    buffer_store_dwordx4 v[240:243], v14, s[16:19], s32 offen offset:1024 sc1
    v_mfma_f32_16x16x32_bf16 a[236:239], v[120:123], v[64:67], a[236:239]
    v_mfma_f32_16x16x32_bf16 a[248:251], v[124:127], v[64:67], a[248:251]
    v_mfma_f32_16x16x32_bf16 a[252:255], v[128:131], v[64:67], a[252:255]
    s_waitcnt lgkmcnt(1)
    s_branch .Lmain_kernel_t2_7
.Lmain_kernel_vpath_6:
    s_waitcnt lgkmcnt(15)
    v_mfma_f32_16x16x32_bf16 a[0:3], v[32:35], v[68:71], 0
    s_waitcnt vmcnt(10) lgkmcnt(0)
    v_mfma_f32_16x16x32_bf16 a[8:11], v[32:35], v[72:75], 0
    s_barrier
    v_mfma_f32_16x16x32_bf16 a[16:19], v[32:35], v[76:79], 0
    ds_read_b64_tr_b16 v[100:101], v10 offset:16384
    v_mfma_f32_16x16x32_bf16 a[24:27], v[32:35], v[80:83], 0
    s_add_u32 m0, s28, 32768
    ds_read_b128 v[64:67], v9 offset:14336
    v_mfma_f32_16x16x32_bf16 a[32:35], v[32:35], v[84:87], 0
    buffer_load_dwordx4 v24, s[12:15], s27 offen offset:0 nt lds
    v_mfma_f32_16x16x32_bf16 a[40:43], v[32:35], v[88:91], 0
    ds_read_b64_tr_b16 v[102:103], v10 offset:16896
    v_mfma_f32_16x16x32_bf16 a[48:51], v[32:35], v[92:95], 0
    v_mfma_f32_16x16x32_bf16 a[56:59], v[32:35], v[96:99], 0
    ds_read_b128 v[32:35], v9 offset:0
    buffer_load_dwordx4 v25, s[12:15], s27 offen offset:1024 nt lds
    v_mfma_f32_16x16x32_bf16 a[4:7], v[36:39], v[68:71], 0
    ds_read_b64_tr_b16 v[104:105], v11 offset:16384
    v_mfma_f32_16x16x32_bf16 a[12:15], v[36:39], v[72:75], 0
    s_mov_b32 exec_hi, 0x00ffffff
    v_sub_f32 v180, v160, v174
    v_sub_f32 v188, v168, v175
    v_fmac_f32 v194, v180, v180
    v_fmac_f32 v195, v188, v188
    s_mov_b32 exec_hi, -1
    v_mfma_f32_16x16x32_bf16 a[20:23], v[36:39], v[76:79], 0
    buffer_load_dwordx4 v26, s[12:15], s27 offen offset:2048 nt lds
    v_mfma_f32_16x16x32_bf16 a[28:31], v[36:39], v[80:83], 0
    ds_read_b64_tr_b16 v[106:107], v11 offset:16896
    v_mfma_f32_16x16x32_bf16 a[36:39], v[36:39], v[84:87], 0
    s_mov_b32 exec_hi, 0x00ffffff
    v_sub_f32 v181, v161, v174
    v_sub_f32 v189, v169, v175
    v_fmac_f32 v194, v181, v181
    v_fmac_f32 v195, v189, v189
    s_mov_b32 exec_hi, -1
    v_mfma_f32_16x16x32_bf16 a[44:47], v[36:39], v[88:91], 0
    buffer_load_dwordx4 v27, s[12:15], s27 offen offset:3072 nt lds
    s_mov_b32 exec_hi, 0x00ffffff
    v_sub_f32 v182, v162, v174
    v_sub_f32 v190, v170, v175
    v_fmac_f32 v194, v182, v182
    v_fmac_f32 v195, v190, v190
    s_mov_b32 exec_hi, -1
    v_mfma_f32_16x16x32_bf16 a[52:55], v[36:39], v[92:95], 0
    s_add_u32 s27, s27, 262144
    ds_read_b64_tr_b16 v[108:109], v12 offset:16384
    v_mfma_f32_16x16x32_bf16 a[60:63], v[36:39], v[96:99], 0
    s_add_u32 m0, s28, 49152
    ds_read_b128 v[36:39], v9 offset:2048
    v_mfma_f32_16x16x32_bf16 a[64:67], v[40:43], v[68:71], 0
    buffer_load_dwordx4 v24, s[12:15], s27 offen offset:0 nt lds
    v_mfma_f32_16x16x32_bf16 a[72:75], v[40:43], v[72:75], 0
    ds_read_b64_tr_b16 v[110:111], v12 offset:16896
    v_mfma_f32_16x16x32_bf16 a[80:83], v[40:43], v[76:79], 0
    s_mov_b32 exec_hi, 0x00ffffff
    v_sub_f32 v183, v163, v174
    v_sub_f32 v191, v171, v175
    v_fmac_f32 v194, v183, v183
    v_fmac_f32 v195, v191, v191
    s_mov_b32 exec_hi, -1
    v_mfma_f32_16x16x32_bf16 a[88:91], v[40:43], v[80:83], 0
    buffer_load_dwordx4 v25, s[12:15], s27 offen offset:1024 nt lds
    v_mfma_f32_16x16x32_bf16 a[96:99], v[40:43], v[84:87], 0
    ds_read_b64_tr_b16 v[112:113], v13 offset:16384
    v_mfma_f32_16x16x32_bf16 a[104:107], v[40:43], v[88:91], 0
    s_mov_b32 exec_hi, 0x00ffffff
    v_sub_f32 v184, v164, v174
    v_sub_f32 v192, v172, v175
    v_fmac_f32 v194, v184, v184
    v_fmac_f32 v195, v192, v192
    s_mov_b32 exec_hi, -1
    v_mfma_f32_16x16x32_bf16 a[112:115], v[40:43], v[92:95], 0
    buffer_load_dwordx4 v26, s[12:15], s27 offen offset:2048 nt lds
    v_mfma_f32_16x16x32_bf16 a[120:123], v[40:43], v[96:99], 0
    ds_read_b64_tr_b16 v[114:115], v13 offset:16896
    ds_read_b128 v[40:43], v9 offset:4096
    v_mfma_f32_16x16x32_bf16 a[68:71], v[44:47], v[68:71], 0
    s_mov_b32 exec_hi, 0x00ffffff
    v_sub_f32 v185, v165, v174
    v_sub_f32 v193, v173, v175
    v_fmac_f32 v194, v185, v185
    v_fmac_f32 v195, v193, v193
    s_mov_b32 exec_hi, -1
    v_mfma_f32_16x16x32_bf16 a[76:79], v[44:47], v[72:75], 0
    buffer_load_dwordx4 v27, s[12:15], s27 offen offset:3072 nt lds
    v_add_f32_dpp v194, v194, v194 quad_perm:[1,0,3,2] row_mask:0xf bank_mask:0xf
    v_mfma_f32_16x16x32_bf16 a[84:87], v[44:47], v[76:79], 0
    s_add_u32 s27, s27, 262144
    ds_read_b64_tr_b16 v[116:117], v10 offset:20480
    v_add_f32_dpp v195, v195, v195 quad_perm:[1,0,3,2] row_mask:0xf bank_mask:0xf
    v_mfma_f32_16x16x32_bf16 a[92:95], v[44:47], v[80:83], 0
    s_add_u32 m0, s33, 0
    v_add_f32_dpp v194, v194, v194 quad_perm:[2,3,0,1] row_mask:0xf bank_mask:0xf
    v_add_f32_dpp v195, v195, v195 quad_perm:[2,3,0,1] row_mask:0xf bank_mask:0xf
    v_mfma_f32_16x16x32_bf16 a[100:103], v[44:47], v[84:87], 0
    buffer_load_dwordx4 v16, s[8:11], s26 offen offset:0 lds
    v_add_f32_dpp v194, v194, v194 row_half_mirror row_mask:0xf bank_mask:0xf
    v_mfma_f32_16x16x32_bf16 a[108:111], v[44:47], v[88:91], 0
    ds_read_b64_tr_b16 v[118:119], v10 offset:20992
    v_add_f32_dpp v195, v195, v195 row_half_mirror row_mask:0xf bank_mask:0xf
    v_mfma_f32_16x16x32_bf16 a[116:119], v[44:47], v[92:95], 0
    v_add_f32_dpp v194, v194, v194 row_mirror row_mask:0xf bank_mask:0xf
    v_add_f32_dpp v195, v195, v195 row_mirror row_mask:0xf bank_mask:0xf
    v_mfma_f32_16x16x32_bf16 a[124:127], v[44:47], v[96:99], 0
    ds_read_b128 v[44:47], v9 offset:6144
    buffer_load_dwordx4 v17, s[8:11], s26 offen offset:1024 lds
    v_mfma_f32_16x16x32_bf16 a[128:131], v[48:51], v[68:71], 0
    ds_read_b64_tr_b16 v[120:121], v11 offset:20480
    v_mov_b32 v176, v194
    v_mfma_f32_16x16x32_bf16 a[136:139], v[48:51], v[72:75], 0
    v_mov_b32 v177, v195
    v_permlane16_swap_b32 v194, v176
    v_mfma_f32_16x16x32_bf16 a[144:147], v[48:51], v[76:79], 0
    buffer_load_dwordx4 v18, s[8:11], s26 offen offset:2048 lds
    v_permlane16_swap_b32 v195, v177
    v_mfma_f32_16x16x32_bf16 a[152:155], v[48:51], v[80:83], 0
    ds_read_b64_tr_b16 v[122:123], v11 offset:20992
    v_add_f32 v194, v194, v176
    v_mfma_f32_16x16x32_bf16 a[160:163], v[48:51], v[84:87], 0
    v_add_f32 v195, v195, v177
    v_mov_b32 v176, v194
    v_mfma_f32_16x16x32_bf16 a[168:171], v[48:51], v[88:91], 0
    buffer_load_dwordx4 v19, s[8:11], s26 offen offset:3072 lds
    v_mov_b32 v177, v195
    v_mfma_f32_16x16x32_bf16 a[176:179], v[48:51], v[92:95], 0
    ds_read_b64_tr_b16 v[124:125], v12 offset:20480
    v_permlane32_swap_b32 v194, v176
    v_mfma_f32_16x16x32_bf16 a[184:187], v[48:51], v[96:99], 0
    s_add_u32 m0, s28, 0
    ds_read_b128 v[48:51], v9 offset:8192
    v_permlane32_swap_b32 v195, v177
    v_mfma_f32_16x16x32_bf16 a[132:135], v[52:55], v[68:71], 0
    buffer_load_dwordx4 v24, s[12:15], s27 offen offset:0 nt lds
    v_add_f32 v194, v194, v176
    v_mfma_f32_16x16x32_bf16 a[140:143], v[52:55], v[72:75], 0
    ds_read_b64_tr_b16 v[126:127], v12 offset:20992
    v_add_f32 v195, v195, v177
    v_mfma_f32_16x16x32_bf16 a[148:151], v[52:55], v[76:79], 0
    v_cvt_pk_bf16_f32 v174, v174, v174
    v_lshlrev_b32 v174, 16, v174
    v_mfma_f32_16x16x32_bf16 a[156:159], v[52:55], v[80:83], 0
    buffer_load_dwordx4 v25, s[12:15], s27 offen offset:1024 nt lds
    v_mul_f32 v194, 991054117, v194
    v_mfma_f32_16x16x32_bf16 a[164:167], v[52:55], v[84:87], 0
    ds_read_b64_tr_b16 v[128:129], v13 offset:20480
    v_cvt_pk_bf16_f32 v194, v194, v194
    v_mfma_f32_16x16x32_bf16 a[172:175], v[52:55], v[88:91], 0
    v_lshlrev_b32 v194, 16, v194
    v_add_f32 v194, 925353388, v194
    v_mfma_f32_16x16x32_bf16 a[180:183], v[52:55], v[92:95], 0
    buffer_load_dwordx4 v26, s[12:15], s27 offen offset:2048 nt lds
    v_cvt_pk_bf16_f32 v194, v194, v194
    v_lshlrev_b32 v194, 16, v194
    v_mfma_f32_16x16x32_bf16 a[188:191], v[52:55], v[96:99], 0
    ds_read_b64_tr_b16 v[130:131], v13 offset:20992
    ds_read_b128 v[52:55], v9 offset:10240
    v_sqrt_f32 v194, v194
    v_mfma_f32_16x16x32_bf16 a[192:195], v[56:59], v[68:71], 0
    v_cvt_pk_bf16_f32 v194, v194, v194
    v_lshlrev_b32 v194, 16, v194
    v_mfma_f32_16x16x32_bf16 a[200:203], v[56:59], v[72:75], 0
    buffer_load_dwordx4 v27, s[12:15], s27 offen offset:3072 nt lds
    v_rcp_f32 v194, v194
    v_mfma_f32_16x16x32_bf16 a[208:211], v[56:59], v[76:79], 0
    s_add_u32 s27, s27, 262144
    v_cvt_pk_bf16_f32 v175, v175, v175
    v_lshlrev_b32 v175, 16, v175
    v_mfma_f32_16x16x32_bf16 a[216:219], v[56:59], v[80:83], 0
    s_add_u32 m0, s33, 4096
    v_mul_f32 v195, 991054117, v195
    v_mfma_f32_16x16x32_bf16 a[224:227], v[56:59], v[84:87], 0
    s_add_u32 s33, s35, s34
    buffer_load_dwordx4 v20, s[8:11], s26 offen offset:0 lds
    v_cvt_pk_bf16_f32 v195, v195, v195
    v_mfma_f32_16x16x32_bf16 a[232:235], v[56:59], v[88:91], 0
    s_add_u32 s34, s34, 32768
    v_lshlrev_b32 v195, 16, v195
    v_add_f32 v195, 925353388, v195
    v_mfma_f32_16x16x32_bf16 a[240:243], v[56:59], v[92:95], 0
    v_cvt_pk_bf16_f32 v195, v195, v195
    v_lshlrev_b32 v195, 16, v195
    v_sqrt_f32 v195, v195
    v_mfma_f32_16x16x32_bf16 a[248:251], v[56:59], v[96:99], 0
    s_cmp_eq_u32 s34, 98304
    ds_read_b128 v[56:59], v9 offset:12288
    buffer_load_dwordx4 v21, s[8:11], s26 offen offset:1024 lds
    v_mfma_f32_16x16x32_bf16 a[196:199], v[60:63], v[68:71], 0
    s_cselect_b32 s34, 0, s34
    v_cvt_pk_bf16_f32 v195, v195, v195
    v_lshlrev_b32 v195, 16, v195
    v_mfma_f32_16x16x32_bf16 a[204:207], v[60:63], v[72:75], 0
    v_rcp_f32 v195, v195
    v_mfma_f32_16x16x32_bf16 a[212:215], v[60:63], v[76:79], 0
    buffer_load_dwordx4 v22, s[8:11], s26 offen offset:2048 lds
    v_add_u32 v8, s34, v28
    v_mfma_f32_16x16x32_bf16 a[220:223], v[60:63], v[80:83], 0
    v_add_u32 v9, s34, v29
    v_sub_f32 v178, v158, v174
    v_mfma_f32_16x16x32_bf16 a[228:231], v[60:63], v[84:87], 0
    v_xor_b32 v10, 0x8000, v10
    v_sub_f32 v179, v159, v174
    v_sub_f32 v180, v160, v174
    v_mfma_f32_16x16x32_bf16 a[236:239], v[60:63], v[88:91], 0
    buffer_load_dwordx4 v23, s[8:11], s26 offen offset:3072 lds
    v_xor_b32 v11, 0x8000, v11
    v_sub_f32 v181, v161, v174
    v_sub_f32 v182, v162, v174
    v_mfma_f32_16x16x32_bf16 a[244:247], v[60:63], v[92:95], 0
    s_waitcnt lgkmcnt(15)
    s_add_u32 s26, s26, 128
    v_xor_b32 v12, 0x8000, v12
    v_sub_f32 v183, v163, v174
    v_mfma_f32_16x16x32_bf16 a[252:255], v[60:63], v[96:99], 0
    v_xor_b32 v13, 0x8000, v13
    v_sub_f32 v184, v164, v174
    v_sub_f32 v185, v165, v174
    v_cvt_pk_bf16_f32 v158, v178, v179
    v_mfma_f32_16x16x32_bf16 a[0:3], v[32:35], v[100:103], a[0:3]
    s_waitcnt vmcnt(16) lgkmcnt(0)
    v_cvt_pk_bf16_f32 v159, v180, v181
    v_mfma_f32_16x16x32_bf16 a[8:11], v[32:35], v[104:107], a[8:11]
    s_barrier
    v_mfma_f32_16x16x32_bf16 a[16:19], v[32:35], v[108:111], a[16:19]
    ds_read_b64_tr_b16 v[68:69], v10 offset:0
    v_cvt_pk_bf16_f32 v160, v182, v183
    v_mfma_f32_16x16x32_bf16 a[24:27], v[32:35], v[112:115], a[24:27]
    s_add_u32 m0, s28, 16384
    ds_read_b128 v[60:63], v8 offset:14336
    v_cvt_pk_bf16_f32 v161, v184, v185
    v_mfma_f32_16x16x32_bf16 a[32:35], v[32:35], v[116:119], a[32:35]
    buffer_load_dwordx4 v24, s[12:15], s27 offen offset:0 nt lds
    v_lshlrev_b32 v178, 16, v158
    v_mfma_f32_16x16x32_bf16 a[40:43], v[32:35], v[120:123], a[40:43]
    ds_read_b64_tr_b16 v[70:71], v10 offset:512
    v_and_b32 v179, 0xffff0000, v158
    v_mfma_f32_16x16x32_bf16 a[48:51], v[32:35], v[124:127], a[48:51]
    v_lshlrev_b32 v180, 16, v159
    v_and_b32 v181, 0xffff0000, v159
    v_mfma_f32_16x16x32_bf16 a[56:59], v[32:35], v[128:131], a[56:59]
    ds_read_b128 v[32:35], v8 offset:0
    v_lshlrev_b32 v182, 16, v160
    v_mfma_f32_16x16x32_bf16 a[4:7], v[36:39], v[100:103], a[4:7]
    ds_read_b64_tr_b16 v[72:73], v11 offset:0
    v_and_b32 v183, 0xffff0000, v160
    v_mfma_f32_16x16x32_bf16 a[12:15], v[36:39], v[104:107], a[12:15]
    v_lshlrev_b32 v184, 16, v161
    v_mfma_f32_16x16x32_bf16 a[20:23], v[36:39], v[108:111], a[20:23]
    v_and_b32 v185, 0xffff0000, v161
    v_mfma_f32_16x16x32_bf16 a[28:31], v[36:39], v[112:115], a[28:31]
    ds_read_b64_tr_b16 v[74:75], v11 offset:512
    buffer_load_dwordx4 v25, s[12:15], s27 offen offset:1024 nt lds
    v_mfma_f32_16x16x32_bf16 a[36:39], v[36:39], v[116:119], a[36:39]
    v_mul_f32 v178, v178, v194
    v_mul_f32 v179, v179, v194
    v_mfma_f32_16x16x32_bf16 a[44:47], v[36:39], v[120:123], a[44:47]
    v_mul_f32 v180, v180, v194
    v_mfma_f32_16x16x32_bf16 a[52:55], v[36:39], v[124:127], a[52:55]
    ds_read_b64_tr_b16 v[76:77], v12 offset:0
    v_mul_f32 v181, v181, v194
    v_mfma_f32_16x16x32_bf16 a[60:63], v[36:39], v[128:131], a[60:63]
    ds_read_b128 v[36:39], v8 offset:2048
    v_mul_f32 v182, v182, v194
    v_mfma_f32_16x16x32_bf16 a[64:67], v[40:43], v[100:103], a[64:67]
    v_mul_f32 v183, v183, v194
    v_mfma_f32_16x16x32_bf16 a[72:75], v[40:43], v[104:107], a[72:75]
    ds_read_b64_tr_b16 v[78:79], v12 offset:512
    v_mul_f32 v184, v184, v194
    v_mfma_f32_16x16x32_bf16 a[80:83], v[40:43], v[108:111], a[80:83]
    buffer_load_dwordx4 v26, s[12:15], s27 offen offset:2048 nt lds
    v_mul_f32 v185, v185, v194
    v_mfma_f32_16x16x32_bf16 a[88:91], v[40:43], v[112:115], a[88:91]
    v_cvt_pk_bf16_f32 v148, v178, v179
    v_mfma_f32_16x16x32_bf16 a[96:99], v[40:43], v[116:119], a[96:99]
    ds_read_b64_tr_b16 v[80:81], v13 offset:0
    v_cvt_pk_bf16_f32 v149, v180, v181
    v_mfma_f32_16x16x32_bf16 a[104:107], v[40:43], v[120:123], a[104:107]
    v_cvt_pk_bf16_f32 v150, v182, v183
    v_mfma_f32_16x16x32_bf16 a[112:115], v[40:43], v[124:127], a[112:115]
    v_cvt_pk_bf16_f32 v151, v184, v185
    v_mfma_f32_16x16x32_bf16 a[120:123], v[40:43], v[128:131], a[120:123]
    ds_read_b64_tr_b16 v[82:83], v13 offset:512
    ds_read_b128 v[40:43], v8 offset:4096
    v_mfma_f32_16x16x32_bf16 a[68:71], v[44:47], v[100:103], a[68:71]
    v_sub_f32 v186, v166, v175
    v_sub_f32 v187, v167, v175
    v_mfma_f32_16x16x32_bf16 a[76:79], v[44:47], v[104:107], a[76:79]
    buffer_load_dwordx4 v27, s[12:15], s27 offen offset:3072 nt lds
    v_sub_f32 v188, v168, v175
    v_mfma_f32_16x16x32_bf16 a[84:87], v[44:47], v[108:111], a[84:87]
    s_add_u32 s27, s27, 262144
    ds_read_b64_tr_b16 v[84:85], v10 offset:4096
    v_sub_f32 v189, v169, v175
    v_mfma_f32_16x16x32_bf16 a[92:95], v[44:47], v[112:115], a[92:95]
    s_xor_b32 s28, s28, 0x8000
    v_sub_f32 v190, v170, v175
    v_mfma_f32_16x16x32_bf16 a[100:103], v[44:47], v[116:119], a[100:103]
    v_sub_f32 v191, v171, v175
    v_mfma_f32_16x16x32_bf16 a[108:111], v[44:47], v[120:123], a[108:111]
    ds_read_b64_tr_b16 v[86:87], v10 offset:4608
    v_sub_f32 v192, v172, v175
    v_mfma_f32_16x16x32_bf16 a[116:119], v[44:47], v[124:127], a[116:119]
    v_sub_f32 v193, v173, v175
    v_mfma_f32_16x16x32_bf16 a[124:127], v[44:47], v[128:131], a[124:127]
    s_add_u32 m0, s33, 0
    ds_read_b128 v[44:47], v8 offset:6144
    v_cvt_pk_bf16_f32 v166, v186, v187
    v_mfma_f32_16x16x32_bf16 a[128:131], v[48:51], v[100:103], a[128:131]
    ds_read_b64_tr_b16 v[88:89], v11 offset:4096
    buffer_load_dwordx4 v16, s[8:11], s26 offen offset:0 lds
    v_mfma_f32_16x16x32_bf16 a[136:139], v[48:51], v[104:107], a[136:139]
    v_cvt_pk_bf16_f32 v167, v188, v189
    v_cvt_pk_bf16_f32 v168, v190, v191
    v_mfma_f32_16x16x32_bf16 a[144:147], v[48:51], v[108:111], a[144:147]
    v_cvt_pk_bf16_f32 v169, v192, v193
    v_mfma_f32_16x16x32_bf16 a[152:155], v[48:51], v[112:115], a[152:155]
    ds_read_b64_tr_b16 v[90:91], v11 offset:4608
    v_lshlrev_b32 v186, 16, v166
    v_mfma_f32_16x16x32_bf16 a[160:163], v[48:51], v[116:119], a[160:163]
    v_and_b32 v187, 0xffff0000, v166
    v_mfma_f32_16x16x32_bf16 a[168:171], v[48:51], v[120:123], a[168:171]
    v_lshlrev_b32 v188, 16, v167
    v_mfma_f32_16x16x32_bf16 a[176:179], v[48:51], v[124:127], a[176:179]
    ds_read_b64_tr_b16 v[92:93], v12 offset:4096
    v_and_b32 v189, 0xffff0000, v167
    v_mfma_f32_16x16x32_bf16 a[184:187], v[48:51], v[128:131], a[184:187]
    ds_read_b128 v[48:51], v8 offset:8192
    buffer_load_dwordx4 v17, s[8:11], s26 offen offset:1024 lds
    v_mfma_f32_16x16x32_bf16 a[132:135], v[52:55], v[100:103], a[132:135]
    v_lshlrev_b32 v190, 16, v168
    v_and_b32 v191, 0xffff0000, v168
    v_mfma_f32_16x16x32_bf16 a[140:143], v[52:55], v[104:107], a[140:143]
    ds_read_b64_tr_b16 v[94:95], v12 offset:4608
    v_lshlrev_b32 v192, 16, v169
    v_mfma_f32_16x16x32_bf16 a[148:151], v[52:55], v[108:111], a[148:151]
    v_and_b32 v193, 0xffff0000, v169
    v_mfma_f32_16x16x32_bf16 a[156:159], v[52:55], v[112:115], a[156:159]
    v_mul_f32 v186, v186, v195
    v_mfma_f32_16x16x32_bf16 a[164:167], v[52:55], v[116:119], a[164:167]
    ds_read_b64_tr_b16 v[96:97], v13 offset:4096
    v_mul_f32 v187, v187, v195
    v_mfma_f32_16x16x32_bf16 a[172:175], v[52:55], v[120:123], a[172:175]
    v_mul_f32 v188, v188, v195
    v_mfma_f32_16x16x32_bf16 a[180:183], v[52:55], v[124:127], a[180:183]
    buffer_load_dwordx4 v18, s[8:11], s26 offen offset:2048 lds
    v_mul_f32 v189, v189, v195
    v_mfma_f32_16x16x32_bf16 a[188:191], v[52:55], v[128:131], a[188:191]
    ds_read_b64_tr_b16 v[98:99], v13 offset:4608
    ds_read_b128 v[52:55], v8 offset:10240
    v_mfma_f32_16x16x32_bf16 a[192:195], v[56:59], v[100:103], a[192:195]
    v_mul_f32 v190, v190, v195
    v_mul_f32 v191, v191, v195
    v_mfma_f32_16x16x32_bf16 a[200:203], v[56:59], v[104:107], a[200:203]
    v_mul_f32 v192, v192, v195
    v_mfma_f32_16x16x32_bf16 a[208:211], v[56:59], v[108:111], a[208:211]
    v_mul_f32 v193, v193, v195
    v_mfma_f32_16x16x32_bf16 a[216:219], v[56:59], v[112:115], a[216:219]
    v_cvt_pk_bf16_f32 v152, v186, v187
    v_mfma_f32_16x16x32_bf16 a[224:227], v[56:59], v[116:119], a[224:227]
    v_cvt_pk_bf16_f32 v153, v188, v189
    v_mfma_f32_16x16x32_bf16 a[232:235], v[56:59], v[120:123], a[232:235]
    buffer_load_dwordx4 v19, s[8:11], s26 offen offset:3072 lds
    v_cvt_pk_bf16_f32 v154, v190, v191
    v_mfma_f32_16x16x32_bf16 a[240:243], v[56:59], v[124:127], a[240:243]
    v_cvt_pk_bf16_f32 v155, v192, v193
    v_mfma_f32_16x16x32_bf16 a[248:251], v[56:59], v[128:131], a[248:251]
    s_add_u32 s64, s58, 37748736
    s_addc_u32 s65, s59, 0
    ds_read_b128 v[56:59], v8 offset:12288
    v_mfma_f32_16x16x32_bf16 a[196:199], v[64:67], v[100:103], a[196:199]
    v_mfma_f32_16x16x32_bf16 a[204:207], v[64:67], v[104:107], a[204:207]
    s_and_b32 s65, s65, 0xffff
    v_mfma_f32_16x16x32_bf16 a[212:215], v[64:67], v[108:111], a[212:215]
    s_mov_b32 s66, 1835008
    v_mfma_f32_16x16x32_bf16 a[220:223], v[64:67], v[112:115], a[220:223]
    s_mov_b32 s67, 0x00020000
    v_mfma_f32_16x16x32_bf16 a[228:231], v[64:67], v[116:119], a[228:231]
    s_mov_b32 exec_hi, 0x00ffffff
    buffer_store_dwordx4 v[148:151], v156, s[64:67], s63 offen sc1
    buffer_store_dwordx4 v[152:155], v156, s[64:67], s63 offen offset:896 sc1
    s_mov_b32 exec_hi, -1
    v_mfma_f32_16x16x32_bf16 a[236:239], v[64:67], v[120:123], a[236:239]
    v_mfma_f32_16x16x32_bf16 a[244:247], v[64:67], v[124:127], a[244:247]
    s_waitcnt lgkmcnt(15)
    v_mfma_f32_16x16x32_bf16 a[252:255], v[64:67], v[128:131], a[252:255]
.p2align 6
.Lmain_kernel_loop_15:
    v_mfma_f32_16x16x32_bf16 a[0:3], v[32:35], v[68:71], a[0:3]
    s_waitcnt vmcnt(17) lgkmcnt(0)
    v_mfma_f32_16x16x32_bf16 a[8:11], v[32:35], v[72:75], a[8:11]
    s_barrier
    v_mfma_f32_16x16x32_bf16 a[16:19], v[32:35], v[76:79], a[16:19]
    ds_read_b64_tr_b16 v[100:101], v10 offset:16384
    buffer_load_dword v255, v250, s[96:99], s78 offen
    v_mfma_f32_16x16x32_bf16 a[24:27], v[32:35], v[80:83], a[24:27]
    s_add_u32 m0, s28, 0
    ds_read_b128 v[64:67], v9 offset:14336
    v_mfma_f32_16x16x32_bf16 a[32:35], v[32:35], v[84:87], a[32:35]
    buffer_load_dwordx4 v24, s[12:15], s27 offen offset:0 nt lds
    v_mfma_f32_16x16x32_bf16 a[40:43], v[32:35], v[88:91], a[40:43]
    ds_read_b64_tr_b16 v[102:103], v10 offset:16896
    v_mfma_f32_16x16x32_bf16 a[48:51], v[32:35], v[92:95], a[48:51]
    v_mfma_f32_16x16x32_bf16 a[56:59], v[32:35], v[96:99], a[56:59]
    ds_read_b128 v[32:35], v9 offset:0
    v_mfma_f32_16x16x32_bf16 a[4:7], v[36:39], v[68:71], a[4:7]
    ds_read_b64_tr_b16 v[104:105], v11 offset:16384
    v_mfma_f32_16x16x32_bf16 a[12:15], v[36:39], v[72:75], a[12:15]
    s_add_u32 s78, s78, s44
    s_cmp_eq_u32 s29, s7
    v_mfma_f32_16x16x32_bf16 a[20:23], v[36:39], v[76:79], a[20:23]
    s_cbranch_scc1 .Lmain_kernel_sd_16
.Lmain_kernel_sdr_17:
    v_mfma_f32_16x16x32_bf16 a[28:31], v[36:39], v[80:83], a[28:31]
    ds_read_b64_tr_b16 v[106:107], v11 offset:16896
    buffer_load_dwordx4 v25, s[12:15], s27 offen offset:1024 nt lds
    v_mfma_f32_16x16x32_bf16 a[36:39], v[36:39], v[84:87], a[36:39]
    v_mfma_f32_16x16x32_bf16 a[44:47], v[36:39], v[88:91], a[44:47]
    v_mfma_f32_16x16x32_bf16 a[52:55], v[36:39], v[92:95], a[52:55]
    ds_read_b64_tr_b16 v[108:109], v12 offset:16384
    v_mfma_f32_16x16x32_bf16 a[60:63], v[36:39], v[96:99], a[60:63]
    ds_read_b128 v[36:39], v9 offset:2048
    v_mfma_f32_16x16x32_bf16 a[64:67], v[40:43], v[68:71], a[64:67]
    v_mfma_f32_16x16x32_bf16 a[72:75], v[40:43], v[72:75], a[72:75]
    ds_read_b64_tr_b16 v[110:111], v12 offset:16896
    v_mfma_f32_16x16x32_bf16 a[80:83], v[40:43], v[76:79], a[80:83]
    buffer_load_dwordx4 v26, s[12:15], s27 offen offset:2048 nt lds
    v_mfma_f32_16x16x32_bf16 a[88:91], v[40:43], v[80:83], a[88:91]
    v_mfma_f32_16x16x32_bf16 a[96:99], v[40:43], v[84:87], a[96:99]
    ds_read_b64_tr_b16 v[112:113], v13 offset:16384
    v_mfma_f32_16x16x32_bf16 a[104:107], v[40:43], v[88:91], a[104:107]
    v_mfma_f32_16x16x32_bf16 a[112:115], v[40:43], v[92:95], a[112:115]
    v_mfma_f32_16x16x32_bf16 a[120:123], v[40:43], v[96:99], a[120:123]
    ds_read_b64_tr_b16 v[114:115], v13 offset:16896
    ds_read_b128 v[40:43], v9 offset:4096
    v_mfma_f32_16x16x32_bf16 a[68:71], v[44:47], v[68:71], a[68:71]
    v_mfma_f32_16x16x32_bf16 a[76:79], v[44:47], v[72:75], a[76:79]
    buffer_load_dwordx4 v27, s[12:15], s27 offen offset:3072 nt lds
    v_mfma_f32_16x16x32_bf16 a[84:87], v[44:47], v[76:79], a[84:87]
    s_add_u32 s27, s27, 262144
    ds_read_b64_tr_b16 v[116:117], v10 offset:20480
    v_mfma_f32_16x16x32_bf16 a[92:95], v[44:47], v[80:83], a[92:95]
    v_mfma_f32_16x16x32_bf16 a[100:103], v[44:47], v[84:87], a[100:103]
    v_mfma_f32_16x16x32_bf16 a[108:111], v[44:47], v[88:91], a[108:111]
    ds_read_b64_tr_b16 v[118:119], v10 offset:20992
    v_mfma_f32_16x16x32_bf16 a[116:119], v[44:47], v[92:95], a[116:119]
    v_mfma_f32_16x16x32_bf16 a[124:127], v[44:47], v[96:99], a[124:127]
    s_add_u32 m0, s33, 4096
    ds_read_b128 v[44:47], v9 offset:6144
    v_mfma_f32_16x16x32_bf16 a[128:131], v[48:51], v[68:71], a[128:131]
    ds_read_b64_tr_b16 v[120:121], v11 offset:20480
    buffer_load_dwordx4 v20, s[8:11], s26 offen offset:0 lds
    v_mfma_f32_16x16x32_bf16 a[136:139], v[48:51], v[72:75], a[136:139]
    v_mfma_f32_16x16x32_bf16 a[144:147], v[48:51], v[76:79], a[144:147]
    v_mfma_f32_16x16x32_bf16 a[152:155], v[48:51], v[80:83], a[152:155]
    ds_read_b64_tr_b16 v[122:123], v11 offset:20992
    v_mfma_f32_16x16x32_bf16 a[160:163], v[48:51], v[84:87], a[160:163]
    v_mfma_f32_16x16x32_bf16 a[168:171], v[48:51], v[88:91], a[168:171]
    v_mfma_f32_16x16x32_bf16 a[176:179], v[48:51], v[92:95], a[176:179]
    ds_read_b64_tr_b16 v[124:125], v12 offset:20480
    v_mfma_f32_16x16x32_bf16 a[184:187], v[48:51], v[96:99], a[184:187]
    ds_read_b128 v[48:51], v9 offset:8192
    buffer_load_dwordx4 v21, s[8:11], s26 offen offset:1024 lds
    v_mfma_f32_16x16x32_bf16 a[132:135], v[52:55], v[68:71], a[132:135]
    s_add_u32 s33, s35, s34
    v_mfma_f32_16x16x32_bf16 a[140:143], v[52:55], v[72:75], a[140:143]
    ds_read_b64_tr_b16 v[126:127], v12 offset:20992
    v_mfma_f32_16x16x32_bf16 a[148:151], v[52:55], v[76:79], a[148:151]
    v_mfma_f32_16x16x32_bf16 a[156:159], v[52:55], v[80:83], a[156:159]
    v_mfma_f32_16x16x32_bf16 a[164:167], v[52:55], v[84:87], a[164:167]
    s_add_u32 s34, s34, 32768
    ds_read_b64_tr_b16 v[128:129], v13 offset:20480
    v_mfma_f32_16x16x32_bf16 a[172:175], v[52:55], v[88:91], a[172:175]
    v_mfma_f32_16x16x32_bf16 a[180:183], v[52:55], v[92:95], a[180:183]
    buffer_load_dwordx4 v22, s[8:11], s26 offen offset:2048 lds
    v_mfma_f32_16x16x32_bf16 a[188:191], v[52:55], v[96:99], a[188:191]
    ds_read_b64_tr_b16 v[130:131], v13 offset:20992
    ds_read_b128 v[52:55], v9 offset:10240
    v_mfma_f32_16x16x32_bf16 a[192:195], v[56:59], v[68:71], a[192:195]
    s_cmp_eq_u32 s34, 98304
    s_cselect_b32 s34, 0, s34
    v_mfma_f32_16x16x32_bf16 a[200:203], v[56:59], v[72:75], a[200:203]
    v_mfma_f32_16x16x32_bf16 a[208:211], v[56:59], v[76:79], a[208:211]
    v_mfma_f32_16x16x32_bf16 a[216:219], v[56:59], v[80:83], a[216:219]
    v_mfma_f32_16x16x32_bf16 a[224:227], v[56:59], v[84:87], a[224:227]
    v_mfma_f32_16x16x32_bf16 a[232:235], v[56:59], v[88:91], a[232:235]
    buffer_load_dwordx4 v23, s[8:11], s26 offen offset:3072 lds
    v_mfma_f32_16x16x32_bf16 a[240:243], v[56:59], v[92:95], a[240:243]
    s_add_u32 s26, s26, 128
    v_mfma_f32_16x16x32_bf16 a[248:251], v[56:59], v[96:99], a[248:251]
    ds_read_b128 v[56:59], v9 offset:12288
    v_mfma_f32_16x16x32_bf16 a[196:199], v[60:63], v[68:71], a[196:199]
    v_add_u32 v8, s34, v28
    v_mfma_f32_16x16x32_bf16 a[204:207], v[60:63], v[72:75], a[204:207]
    v_add_u32 v9, s34, v29
    v_mfma_f32_16x16x32_bf16 a[212:215], v[60:63], v[76:79], a[212:215]
    v_xor_b32 v10, 0x8000, v10
    v_mfma_f32_16x16x32_bf16 a[220:223], v[60:63], v[80:83], a[220:223]
    v_mfma_f32_16x16x32_bf16 a[228:231], v[60:63], v[84:87], a[228:231]
    v_xor_b32 v11, 0x8000, v11
    v_mfma_f32_16x16x32_bf16 a[236:239], v[60:63], v[88:91], a[236:239]
    v_xor_b32 v12, 0x8000, v12
    v_mfma_f32_16x16x32_bf16 a[244:247], v[60:63], v[92:95], a[244:247]
    s_waitcnt lgkmcnt(15)
    v_xor_b32 v13, 0x8000, v13
    v_mfma_f32_16x16x32_bf16 a[252:255], v[60:63], v[96:99], a[252:255]
    v_mfma_f32_16x16x32_bf16 a[0:3], v[32:35], v[100:103], a[0:3]
    s_waitcnt vmcnt(17) lgkmcnt(0)
    v_mfma_f32_16x16x32_bf16 a[8:11], v[32:35], v[104:107], a[8:11]
    s_barrier
    v_mfma_f32_16x16x32_bf16 a[16:19], v[32:35], v[108:111], a[16:19]
    ds_read_b64_tr_b16 v[68:69], v10 offset:0
    v_mfma_f32_16x16x32_bf16 a[24:27], v[32:35], v[112:115], a[24:27]
    s_add_u32 m0, s28, 16384
    ds_read_b128 v[60:63], v8 offset:14336
    v_mfma_f32_16x16x32_bf16 a[32:35], v[32:35], v[116:119], a[32:35]
    buffer_load_dwordx4 v24, s[12:15], s27 offen offset:0 nt lds
    v_mfma_f32_16x16x32_bf16 a[40:43], v[32:35], v[120:123], a[40:43]
    ds_read_b64_tr_b16 v[70:71], v10 offset:512
    v_mfma_f32_16x16x32_bf16 a[48:51], v[32:35], v[124:127], a[48:51]
    v_mfma_f32_16x16x32_bf16 a[56:59], v[32:35], v[128:131], a[56:59]
    ds_read_b128 v[32:35], v8 offset:0
    v_mfma_f32_16x16x32_bf16 a[4:7], v[36:39], v[100:103], a[4:7]
    ds_read_b64_tr_b16 v[72:73], v11 offset:0
    v_mfma_f32_16x16x32_bf16 a[12:15], v[36:39], v[104:107], a[12:15]
    v_mfma_f32_16x16x32_bf16 a[20:23], v[36:39], v[108:111], a[20:23]
    v_mfma_f32_16x16x32_bf16 a[28:31], v[36:39], v[112:115], a[28:31]
    ds_read_b64_tr_b16 v[74:75], v11 offset:512
    buffer_load_dwordx4 v25, s[12:15], s27 offen offset:1024 nt lds
    v_mfma_f32_16x16x32_bf16 a[36:39], v[36:39], v[116:119], a[36:39]
    v_mfma_f32_16x16x32_bf16 a[44:47], v[36:39], v[120:123], a[44:47]
    v_mfma_f32_16x16x32_bf16 a[52:55], v[36:39], v[124:127], a[52:55]
    ds_read_b64_tr_b16 v[76:77], v12 offset:0
    v_mfma_f32_16x16x32_bf16 a[60:63], v[36:39], v[128:131], a[60:63]
    ds_read_b128 v[36:39], v8 offset:2048
    v_mfma_f32_16x16x32_bf16 a[64:67], v[40:43], v[100:103], a[64:67]
    v_mfma_f32_16x16x32_bf16 a[72:75], v[40:43], v[104:107], a[72:75]
    ds_read_b64_tr_b16 v[78:79], v12 offset:512
    v_mfma_f32_16x16x32_bf16 a[80:83], v[40:43], v[108:111], a[80:83]
    buffer_load_dwordx4 v26, s[12:15], s27 offen offset:2048 nt lds
    v_mfma_f32_16x16x32_bf16 a[88:91], v[40:43], v[112:115], a[88:91]
    v_mfma_f32_16x16x32_bf16 a[96:99], v[40:43], v[116:119], a[96:99]
    ds_read_b64_tr_b16 v[80:81], v13 offset:0
    v_mfma_f32_16x16x32_bf16 a[104:107], v[40:43], v[120:123], a[104:107]
    v_mfma_f32_16x16x32_bf16 a[112:115], v[40:43], v[124:127], a[112:115]
    v_mfma_f32_16x16x32_bf16 a[120:123], v[40:43], v[128:131], a[120:123]
    ds_read_b64_tr_b16 v[82:83], v13 offset:512
    ds_read_b128 v[40:43], v8 offset:4096
    v_mfma_f32_16x16x32_bf16 a[68:71], v[44:47], v[100:103], a[68:71]
    v_mfma_f32_16x16x32_bf16 a[76:79], v[44:47], v[104:107], a[76:79]
    buffer_load_dwordx4 v27, s[12:15], s27 offen offset:3072 nt lds
    v_mfma_f32_16x16x32_bf16 a[84:87], v[44:47], v[108:111], a[84:87]
    s_add_u32 s27, s27, 262144
    ds_read_b64_tr_b16 v[84:85], v10 offset:4096
    v_mfma_f32_16x16x32_bf16 a[92:95], v[44:47], v[112:115], a[92:95]
    s_xor_b32 s28, s28, 0x8000
    v_mfma_f32_16x16x32_bf16 a[100:103], v[44:47], v[116:119], a[100:103]
    v_mfma_f32_16x16x32_bf16 a[108:111], v[44:47], v[120:123], a[108:111]
    ds_read_b64_tr_b16 v[86:87], v10 offset:4608
    v_mfma_f32_16x16x32_bf16 a[116:119], v[44:47], v[124:127], a[116:119]
    v_mfma_f32_16x16x32_bf16 a[124:127], v[44:47], v[128:131], a[124:127]
    s_add_u32 m0, s33, 0
    ds_read_b128 v[44:47], v8 offset:6144
    v_mfma_f32_16x16x32_bf16 a[128:131], v[48:51], v[100:103], a[128:131]
    ds_read_b64_tr_b16 v[88:89], v11 offset:4096
    buffer_load_dwordx4 v16, s[8:11], s26 offen offset:0 lds
    v_mfma_f32_16x16x32_bf16 a[136:139], v[48:51], v[104:107], a[136:139]
    v_mfma_f32_16x16x32_bf16 a[144:147], v[48:51], v[108:111], a[144:147]
    v_mfma_f32_16x16x32_bf16 a[152:155], v[48:51], v[112:115], a[152:155]
    ds_read_b64_tr_b16 v[90:91], v11 offset:4608
    v_mfma_f32_16x16x32_bf16 a[160:163], v[48:51], v[116:119], a[160:163]
    v_mfma_f32_16x16x32_bf16 a[168:171], v[48:51], v[120:123], a[168:171]
    v_mfma_f32_16x16x32_bf16 a[176:179], v[48:51], v[124:127], a[176:179]
    ds_read_b64_tr_b16 v[92:93], v12 offset:4096
    v_mfma_f32_16x16x32_bf16 a[184:187], v[48:51], v[128:131], a[184:187]
    ds_read_b128 v[48:51], v8 offset:8192
    buffer_load_dwordx4 v17, s[8:11], s26 offen offset:1024 lds
    v_mfma_f32_16x16x32_bf16 a[132:135], v[52:55], v[100:103], a[132:135]
    v_mfma_f32_16x16x32_bf16 a[140:143], v[52:55], v[104:107], a[140:143]
    ds_read_b64_tr_b16 v[94:95], v12 offset:4608
    v_mfma_f32_16x16x32_bf16 a[148:151], v[52:55], v[108:111], a[148:151]
    v_mfma_f32_16x16x32_bf16 a[156:159], v[52:55], v[112:115], a[156:159]
    v_mfma_f32_16x16x32_bf16 a[164:167], v[52:55], v[116:119], a[164:167]
    ds_read_b64_tr_b16 v[96:97], v13 offset:4096
    v_mfma_f32_16x16x32_bf16 a[172:175], v[52:55], v[120:123], a[172:175]
    v_mfma_f32_16x16x32_bf16 a[180:183], v[52:55], v[124:127], a[180:183]
    buffer_load_dwordx4 v18, s[8:11], s26 offen offset:2048 lds
    v_mfma_f32_16x16x32_bf16 a[188:191], v[52:55], v[128:131], a[188:191]
    ds_read_b64_tr_b16 v[98:99], v13 offset:4608
    ds_read_b128 v[52:55], v8 offset:10240
    v_mfma_f32_16x16x32_bf16 a[192:195], v[56:59], v[100:103], a[192:195]
    v_mfma_f32_16x16x32_bf16 a[200:203], v[56:59], v[104:107], a[200:203]
    v_mfma_f32_16x16x32_bf16 a[208:211], v[56:59], v[108:111], a[208:211]
    v_mfma_f32_16x16x32_bf16 a[216:219], v[56:59], v[112:115], a[216:219]
    v_mfma_f32_16x16x32_bf16 a[224:227], v[56:59], v[116:119], a[224:227]
    v_mfma_f32_16x16x32_bf16 a[232:235], v[56:59], v[120:123], a[232:235]
    buffer_load_dwordx4 v19, s[8:11], s26 offen offset:3072 lds
    v_mfma_f32_16x16x32_bf16 a[240:243], v[56:59], v[124:127], a[240:243]
    v_mfma_f32_16x16x32_bf16 a[248:251], v[56:59], v[128:131], a[248:251]
    ds_read_b128 v[56:59], v8 offset:12288
    v_mfma_f32_16x16x32_bf16 a[196:199], v[64:67], v[100:103], a[196:199]
    v_mfma_f32_16x16x32_bf16 a[204:207], v[64:67], v[104:107], a[204:207]
    v_mfma_f32_16x16x32_bf16 a[212:215], v[64:67], v[108:111], a[212:215]
    s_add_u32 s29, s29, 1
    v_mfma_f32_16x16x32_bf16 a[220:223], v[64:67], v[112:115], a[220:223]
    v_mfma_f32_16x16x32_bf16 a[228:231], v[64:67], v[116:119], a[228:231]
    v_mfma_f32_16x16x32_bf16 a[236:239], v[64:67], v[120:123], a[236:239]
    s_cmp_lt_u32 s29, 12
    v_mfma_f32_16x16x32_bf16 a[244:247], v[64:67], v[124:127], a[244:247]
    s_waitcnt lgkmcnt(15)
    v_mfma_f32_16x16x32_bf16 a[252:255], v[64:67], v[128:131], a[252:255]
    s_cbranch_scc1 .Lmain_kernel_loop_15
    v_mfma_f32_16x16x32_bf16 a[0:3], v[32:35], v[68:71], a[0:3]
    s_waitcnt vmcnt(16) lgkmcnt(0)
    v_mfma_f32_16x16x32_bf16 a[8:11], v[32:35], v[72:75], a[8:11]
    s_barrier
    v_mfma_f32_16x16x32_bf16 a[16:19], v[32:35], v[76:79], a[16:19]
    ds_read_b64_tr_b16 v[100:101], v10 offset:16384
    buffer_load_dword v255, v250, s[96:99], s78 offen
    v_mfma_f32_16x16x32_bf16 a[24:27], v[32:35], v[80:83], a[24:27]
    s_add_u32 m0, s28, 0
    ds_read_b128 v[64:67], v9 offset:14336
    v_mfma_f32_16x16x32_bf16 a[32:35], v[32:35], v[84:87], a[32:35]
    buffer_load_dwordx4 v24, s[12:15], s27 offen offset:0 nt lds
    v_mfma_f32_16x16x32_bf16 a[40:43], v[32:35], v[88:91], a[40:43]
    ds_read_b64_tr_b16 v[102:103], v10 offset:16896
    v_mfma_f32_16x16x32_bf16 a[48:51], v[32:35], v[92:95], a[48:51]
    v_lshrrev_b32 v30, 2, v14
    v_mfma_f32_16x16x32_bf16 a[56:59], v[32:35], v[96:99], a[56:59]
    ds_read_b128 v[32:35], v9 offset:0
    v_mfma_f32_16x16x32_bf16 a[4:7], v[36:39], v[68:71], a[4:7]
    ds_read_b64_tr_b16 v[104:105], v11 offset:16384
    v_mfma_f32_16x16x32_bf16 a[12:15], v[36:39], v[72:75], a[12:15]
    s_add_u32 s78, s78, s44
    v_mfma_f32_16x16x32_bf16 a[20:23], v[36:39], v[76:79], a[20:23]
    v_mfma_f32_16x16x32_bf16 a[28:31], v[36:39], v[80:83], a[28:31]
    ds_read_b64_tr_b16 v[106:107], v11 offset:16896
    buffer_load_dwordx4 v25, s[12:15], s27 offen offset:1024 nt lds
    v_mfma_f32_16x16x32_bf16 a[36:39], v[36:39], v[84:87], a[36:39]
    v_mfma_f32_16x16x32_bf16 a[44:47], v[36:39], v[88:91], a[44:47]
    buffer_load_dword v30, v30, s[48:51], 0 offen sc1
    v_mfma_f32_16x16x32_bf16 a[52:55], v[36:39], v[92:95], a[52:55]
    ds_read_b64_tr_b16 v[108:109], v12 offset:16384
    v_mfma_f32_16x16x32_bf16 a[60:63], v[36:39], v[96:99], a[60:63]
    ds_read_b128 v[36:39], v9 offset:2048
    v_mfma_f32_16x16x32_bf16 a[64:67], v[40:43], v[68:71], a[64:67]
    v_mfma_f32_16x16x32_bf16 a[72:75], v[40:43], v[72:75], a[72:75]
    ds_read_b64_tr_b16 v[110:111], v12 offset:16896
    v_mfma_f32_16x16x32_bf16 a[80:83], v[40:43], v[76:79], a[80:83]
    buffer_load_dwordx4 v26, s[12:15], s27 offen offset:2048 nt lds
    v_mfma_f32_16x16x32_bf16 a[88:91], v[40:43], v[80:83], a[88:91]
    v_mfma_f32_16x16x32_bf16 a[96:99], v[40:43], v[84:87], a[96:99]
    ds_read_b64_tr_b16 v[112:113], v13 offset:16384
    v_mfma_f32_16x16x32_bf16 a[104:107], v[40:43], v[88:91], a[104:107]
    s_lshl_b32 s42, s24, 20
    v_mfma_f32_16x16x32_bf16 a[112:115], v[40:43], v[92:95], a[112:115]
    s_add_u32 s30, s41, 1
    v_mfma_f32_16x16x32_bf16 a[120:123], v[40:43], v[96:99], a[120:123]
    s_lshl_b32 s30, s30, 16
    ds_read_b64_tr_b16 v[114:115], v13 offset:16896
    ds_read_b128 v[40:43], v9 offset:4096
    v_mfma_f32_16x16x32_bf16 a[68:71], v[44:47], v[68:71], a[68:71]
    s_add_u32 s61, s42, s30
    v_mfma_f32_16x16x32_bf16 a[76:79], v[44:47], v[72:75], a[76:79]
    s_sub_u32 s31, s61, 589824
    buffer_load_dwordx4 v27, s[12:15], s27 offen offset:3072 nt lds
    v_mfma_f32_16x16x32_bf16 a[84:87], v[44:47], v[76:79], a[84:87]
    s_add_u32 s27, s27, 262144
    s_mov_b32 s38, 0
    ds_read_b64_tr_b16 v[116:117], v10 offset:20480
    v_mfma_f32_16x16x32_bf16 a[92:95], v[44:47], v[80:83], a[92:95]
    s_xor_b32 s30, s43, 15
    v_mfma_f32_16x16x32_bf16 a[100:103], v[44:47], v[84:87], a[100:103]
    s_lshl_b32 s6, s43, 16
    v_mfma_f32_16x16x32_bf16 a[108:111], v[44:47], v[88:91], a[108:111]
    s_add_u32 s6, s6, 117440512
    ds_read_b64_tr_b16 v[118:119], v10 offset:20992
    v_mfma_f32_16x16x32_bf16 a[116:119], v[44:47], v[92:95], a[116:119]
    v_mfma_f32_16x16x32_bf16 a[124:127], v[44:47], v[96:99], a[124:127]
    s_add_u32 m0, s33, 4096
    s_cmp_ge_u32 s41, 9
    ds_read_b128 v[44:47], v9 offset:6144
    v_mfma_f32_16x16x32_bf16 a[128:131], v[48:51], v[68:71], a[128:131]
    s_cselect_b32 s36, 2, 0
    ds_read_b64_tr_b16 v[120:121], v11 offset:20480
    buffer_load_dwordx4 v20, s[8:11], s26 offen offset:0 lds
    v_mfma_f32_16x16x32_bf16 a[136:139], v[48:51], v[72:75], a[136:139]
    s_cselect_b32 s37, 8, s41
    s_cselect_b32 s39, s31, s42
    s_cselect_b32 s46, s30, s43
    v_mfma_f32_16x16x32_bf16 a[144:147], v[48:51], v[76:79], a[144:147]
    s_cselect_b32 s6, s6, 1073741824
    v_mfma_f32_16x16x32_bf16 a[152:155], v[48:51], v[80:83], a[152:155]
    ds_read_b64_tr_b16 v[122:123], v11 offset:20992
    v_mfma_f32_16x16x32_bf16 a[160:163], v[48:51], v[84:87], a[160:163]
    s_sub_u32 s30, 7, s41
    v_mfma_f32_16x16x32_bf16 a[168:171], v[48:51], v[88:91], a[168:171]
    s_lshl_b32 s30, s30, 16
    v_mfma_f32_16x16x32_bf16 a[176:179], v[48:51], v[92:95], a[176:179]
    s_add_u32 s5, s42, s30
    ds_read_b64_tr_b16 v[124:125], v12 offset:20480
    v_mfma_f32_16x16x32_bf16 a[184:187], v[48:51], v[96:99], a[184:187]
    ds_read_b128 v[48:51], v9 offset:8192
    buffer_load_dwordx4 v21, s[8:11], s26 offen offset:1024 lds
    v_mfma_f32_16x16x32_bf16 a[132:135], v[52:55], v[68:71], a[132:135]
    s_add_u32 s33, s35, s34
    s_cmp_le_u32 s41, 6
    s_cselect_b32 s36, 1, s36
    v_mfma_f32_16x16x32_bf16 a[140:143], v[52:55], v[72:75], a[140:143]
    s_cselect_b32 s62, s42, 1073741824
    ds_read_b64_tr_b16 v[126:127], v12 offset:20992
    v_mfma_f32_16x16x32_bf16 a[148:151], v[52:55], v[76:79], a[148:151]
    v_mfma_f32_16x16x32_bf16 a[156:159], v[52:55], v[80:83], a[156:159]
    s_mov_b32 s60, s39
    v_mfma_f32_16x16x32_bf16 a[164:167], v[52:55], v[84:87], a[164:167]
    s_add_u32 s34, s34, 32768
    s_mov_b32 s63, s61
    ds_read_b64_tr_b16 v[128:129], v13 offset:20480
    v_mfma_f32_16x16x32_bf16 a[172:175], v[52:55], v[88:91], a[172:175]
    s_mov_b32 s4, s62
    v_mfma_f32_16x16x32_bf16 a[180:183], v[52:55], v[92:95], a[180:183]
    s_lshl_b32 s30, s20, 14
    buffer_load_dwordx4 v22, s[8:11], s26 offen offset:2048 lds
    v_mfma_f32_16x16x32_bf16 a[188:191], v[52:55], v[96:99], a[188:191]
    s_add_u32 s6, s6, s30
    ds_read_b64_tr_b16 v[130:131], v13 offset:20992
    ds_read_b128 v[52:55], v9 offset:10240
    v_mfma_f32_16x16x32_bf16 a[192:195], v[56:59], v[68:71], a[192:195]
    s_cmp_eq_u32 s34, 98304
    s_cselect_b32 s34, 0, s34
    v_mfma_f32_16x16x32_bf16 a[200:203], v[56:59], v[72:75], a[200:203]
    s_lshl_b32 s46, s46, 2
    s_add_u32 s46, s46, s20
    v_mfma_f32_16x16x32_bf16 a[208:211], v[56:59], v[76:79], a[208:211]
    s_lshl_b32 s47, s46, 10
    v_mfma_f32_16x16x32_bf16 a[216:219], v[56:59], v[80:83], a[216:219]
    s_add_u32 s47, s47, 33554432
    v_mfma_f32_16x16x32_bf16 a[224:227], v[56:59], v[84:87], a[224:227]
    s_lshl_b32 s46, s46, 14
    v_mfma_f32_16x16x32_bf16 a[232:235], v[56:59], v[88:91], a[232:235]
    s_add_u32 s46, s46, 100663296
    buffer_load_dwordx4 v23, s[8:11], s26 offen offset:3072 lds
    v_mfma_f32_16x16x32_bf16 a[240:243], v[56:59], v[92:95], a[240:243]
    s_add_u32 s26, s26, 128
    s_mul_i32 s7, s41, 1835008
    v_mfma_f32_16x16x32_bf16 a[248:251], v[56:59], v[96:99], a[248:251]
    s_lshl_b32 s30, s20, 14
    ds_read_b128 v[56:59], v9 offset:12288
    v_mfma_f32_16x16x32_bf16 a[196:199], v[60:63], v[68:71], a[196:199]
    s_add_u32 s7, s7, s30
    v_add_u32 v8, s34, v28
    v_mfma_f32_16x16x32_bf16 a[204:207], v[60:63], v[72:75], a[204:207]
    s_add_u32 s7, s7, 69206016
    v_add_u32 v9, s34, v29
    v_mfma_f32_16x16x32_bf16 a[212:215], v[60:63], v[76:79], a[212:215]
    s_add_u32 s64, s58, 16777216
    s_addc_u32 s65, s59, 0
    v_xor_b32 v10, 0x8000, v10
    v_mfma_f32_16x16x32_bf16 a[220:223], v[60:63], v[80:83], a[220:223]
    v_mfma_f32_16x16x32_bf16 a[228:231], v[60:63], v[84:87], a[228:231]
    s_and_b32 s65, s65, 0xffff
    v_xor_b32 v11, 0x8000, v11
    v_mfma_f32_16x16x32_bf16 a[236:239], v[60:63], v[88:91], a[236:239]
    s_mov_b32 s66, 16777216
    v_xor_b32 v12, 0x8000, v12
    v_mfma_f32_16x16x32_bf16 a[244:247], v[60:63], v[92:95], a[244:247]
    s_waitcnt lgkmcnt(15)
    s_mov_b32 s67, 0x00020000
    v_xor_b32 v13, 0x8000, v13
    v_mfma_f32_16x16x32_bf16 a[252:255], v[60:63], v[96:99], a[252:255]
    v_mfma_f32_16x16x32_bf16 a[0:3], v[32:35], v[100:103], a[0:3]
    s_waitcnt vmcnt(17) lgkmcnt(0)
    v_mfma_f32_16x16x32_bf16 a[8:11], v[32:35], v[104:107], a[8:11]
    s_barrier
    v_mfma_f32_16x16x32_bf16 a[16:19], v[32:35], v[108:111], a[16:19]
    ds_read_b64_tr_b16 v[68:69], v10 offset:0
    buffer_load_dword v255, v250, s[96:99], s78 offen
    v_mfma_f32_16x16x32_bf16 a[24:27], v[32:35], v[112:115], a[24:27]
    s_add_u32 m0, s28, 16384
    ds_read_b128 v[60:63], v8 offset:14336
    v_mfma_f32_16x16x32_bf16 a[32:35], v[32:35], v[116:119], a[32:35]
    buffer_load_dwordx4 v24, s[12:15], s27 offen offset:0 nt lds
    v_mfma_f32_16x16x32_bf16 a[40:43], v[32:35], v[120:123], a[40:43]
    ds_read_b64_tr_b16 v[70:71], v10 offset:512
    v_mfma_f32_16x16x32_bf16 a[48:51], v[32:35], v[124:127], a[48:51]
    v_mfma_f32_16x16x32_bf16 a[56:59], v[32:35], v[128:131], a[56:59]
    ds_read_b128 v[32:35], v8 offset:0
    v_mfma_f32_16x16x32_bf16 a[4:7], v[36:39], v[100:103], a[4:7]
    ds_read_b64_tr_b16 v[72:73], v11 offset:0
    v_mfma_f32_16x16x32_bf16 a[12:15], v[36:39], v[104:107], a[12:15]
    s_add_u32 s78, s78, s44
    v_mfma_f32_16x16x32_bf16 a[20:23], v[36:39], v[108:111], a[20:23]
    v_mfma_f32_16x16x32_bf16 a[28:31], v[36:39], v[112:115], a[28:31]
    ds_read_b64_tr_b16 v[74:75], v11 offset:512
    buffer_load_dwordx4 v25, s[12:15], s27 offen offset:1024 nt lds
    v_mfma_f32_16x16x32_bf16 a[36:39], v[36:39], v[116:119], a[36:39]
    v_mfma_f32_16x16x32_bf16 a[44:47], v[36:39], v[120:123], a[44:47]
    v_mfma_f32_16x16x32_bf16 a[52:55], v[36:39], v[124:127], a[52:55]
    ds_read_b64_tr_b16 v[76:77], v12 offset:0
    v_mfma_f32_16x16x32_bf16 a[60:63], v[36:39], v[128:131], a[60:63]
    ds_read_b128 v[36:39], v8 offset:2048
    v_mfma_f32_16x16x32_bf16 a[64:67], v[40:43], v[100:103], a[64:67]
    v_mfma_f32_16x16x32_bf16 a[72:75], v[40:43], v[104:107], a[72:75]
    ds_read_b64_tr_b16 v[78:79], v12 offset:512
    v_mfma_f32_16x16x32_bf16 a[80:83], v[40:43], v[108:111], a[80:83]
    buffer_load_dwordx4 v26, s[12:15], s27 offen offset:2048 nt lds
    v_mfma_f32_16x16x32_bf16 a[88:91], v[40:43], v[112:115], a[88:91]
    v_mfma_f32_16x16x32_bf16 a[96:99], v[40:43], v[116:119], a[96:99]
    ds_read_b64_tr_b16 v[80:81], v13 offset:0
    v_mfma_f32_16x16x32_bf16 a[104:107], v[40:43], v[120:123], a[104:107]
    v_mfma_f32_16x16x32_bf16 a[112:115], v[40:43], v[124:127], a[112:115]
    v_mfma_f32_16x16x32_bf16 a[120:123], v[40:43], v[128:131], a[120:123]
    ds_read_b64_tr_b16 v[82:83], v13 offset:512
    ds_read_b128 v[40:43], v8 offset:4096
    v_mfma_f32_16x16x32_bf16 a[68:71], v[44:47], v[100:103], a[68:71]
    v_mfma_f32_16x16x32_bf16 a[76:79], v[44:47], v[104:107], a[76:79]
    buffer_load_dwordx4 v27, s[12:15], s27 offen offset:3072 nt lds
    v_mfma_f32_16x16x32_bf16 a[84:87], v[44:47], v[108:111], a[84:87]
    s_add_u32 s27, s27, 262144
    ds_read_b64_tr_b16 v[84:85], v10 offset:4096
    v_mfma_f32_16x16x32_bf16 a[92:95], v[44:47], v[112:115], a[92:95]
    s_xor_b32 s28, s28, 0x8000
    v_mfma_f32_16x16x32_bf16 a[100:103], v[44:47], v[116:119], a[100:103]
    v_mfma_f32_16x16x32_bf16 a[108:111], v[44:47], v[120:123], a[108:111]
    ds_read_b64_tr_b16 v[86:87], v10 offset:4608
    v_mfma_f32_16x16x32_bf16 a[116:119], v[44:47], v[124:127], a[116:119]
    s_getpc_b64 s[52:53]
.Lmain_kernel_pc_18:
    s_sub_u32 s52, s52, .Lmain_kernel_pc_18-main_kernel
    s_subb_u32 s53, s53, 0
    v_mfma_f32_16x16x32_bf16 a[124:127], v[44:47], v[128:131], a[124:127]
    s_add_u32 m0, s33, 0
    ds_read_b128 v[44:47], v8 offset:6144
    v_mfma_f32_16x16x32_bf16 a[128:131], v[48:51], v[100:103], a[128:131]
    ds_read_b64_tr_b16 v[88:89], v11 offset:4096
    buffer_load_dwordx4 v16, s[8:11], s26 offen offset:0 lds
    v_mfma_f32_16x16x32_bf16 a[136:139], v[48:51], v[104:107], a[136:139]
    v_mfma_f32_16x16x32_bf16 a[144:147], v[48:51], v[108:111], a[144:147]
    v_mfma_f32_16x16x32_bf16 a[152:155], v[48:51], v[112:115], a[152:155]
    ds_read_b64_tr_b16 v[90:91], v11 offset:4608
    v_mfma_f32_16x16x32_bf16 a[160:163], v[48:51], v[116:119], a[160:163]
    v_mfma_f32_16x16x32_bf16 a[168:171], v[48:51], v[120:123], a[168:171]
    v_mfma_f32_16x16x32_bf16 a[176:179], v[48:51], v[124:127], a[176:179]
    ds_read_b64_tr_b16 v[92:93], v12 offset:4096
    v_mfma_f32_16x16x32_bf16 a[184:187], v[48:51], v[128:131], a[184:187]
    ds_read_b128 v[48:51], v8 offset:8192
    buffer_load_dwordx4 v17, s[8:11], s26 offen offset:1024 lds
    v_mfma_f32_16x16x32_bf16 a[132:135], v[52:55], v[100:103], a[132:135]
    s_and_b32 s53, s53, 0xffff
    v_mfma_f32_16x16x32_bf16 a[140:143], v[52:55], v[104:107], a[140:143]
    ds_read_b64_tr_b16 v[94:95], v12 offset:4608
    v_mfma_f32_16x16x32_bf16 a[148:151], v[52:55], v[108:111], a[148:151]
    v_mfma_f32_16x16x32_bf16 a[156:159], v[52:55], v[112:115], a[156:159]
    s_mov_b32 s54, .Ltext_end-main_kernel
    v_mfma_f32_16x16x32_bf16 a[164:167], v[52:55], v[116:119], a[164:167]
    ds_read_b64_tr_b16 v[96:97], v13 offset:4096
    v_mfma_f32_16x16x32_bf16 a[172:175], v[52:55], v[120:123], a[172:175]
    s_mov_b32 s55, 0x00020000
    v_mfma_f32_16x16x32_bf16 a[180:183], v[52:55], v[124:127], a[180:183]
    buffer_load_dwordx4 v18, s[8:11], s26 offen offset:2048 lds
    v_mfma_f32_16x16x32_bf16 a[188:191], v[52:55], v[128:131], a[188:191]
    ds_read_b64_tr_b16 v[98:99], v13 offset:4608
    ds_read_b128 v[52:55], v8 offset:10240
    v_mfma_f32_16x16x32_bf16 a[192:195], v[56:59], v[100:103], a[192:195]
    s_and_b32 s30, s2, 56
    v_mfma_f32_16x16x32_bf16 a[200:203], v[56:59], v[104:107], a[200:203]
    v_mfma_f32_16x16x32_bf16 a[208:211], v[56:59], v[108:111], a[208:211]
    s_lshl_b32 s30, s30, 12
    v_mfma_f32_16x16x32_bf16 a[216:219], v[56:59], v[112:115], a[216:219]
    v_mfma_f32_16x16x32_bf16 a[224:227], v[56:59], v[116:119], a[224:227]
    v_mfma_f32_16x16x32_bf16 a[232:235], v[56:59], v[120:123], a[232:235]
    buffer_load_dwordx4 v19, s[8:11], s26 offen offset:3072 lds
    v_lshlrev_b32 v254, 3, v14
    v_mfma_f32_16x16x32_bf16 a[240:243], v[56:59], v[124:127], a[240:243]
    v_mfma_f32_16x16x32_bf16 a[248:251], v[56:59], v[128:131], a[248:251]
    ds_read_b128 v[56:59], v8 offset:12288
    v_mfma_f32_16x16x32_bf16 a[196:199], v[64:67], v[100:103], a[196:199]
    s_lshl_b32 s31, s20, 13
    v_mfma_f32_16x16x32_bf16 a[204:207], v[64:67], v[104:107], a[204:207]
    v_mfma_f32_16x16x32_bf16 a[212:215], v[64:67], v[108:111], a[212:215]
    v_add_u32 v254, s31, v254
    v_mfma_f32_16x16x32_bf16 a[220:223], v[64:67], v[112:115], a[220:223]
    v_mfma_f32_16x16x32_bf16 a[228:231], v[64:67], v[116:119], a[228:231]
    v_mfma_f32_16x16x32_bf16 a[236:239], v[64:67], v[120:123], a[236:239]
    buffer_load_dword v254, v254, s[52:55], s30 offen
    v_mfma_f32_16x16x32_bf16 a[244:247], v[64:67], v[124:127], a[244:247]
    s_waitcnt lgkmcnt(15)
    v_mfma_f32_16x16x32_bf16 a[252:255], v[64:67], v[128:131], a[252:255]
    v_mfma_f32_16x16x32_bf16 a[0:3], v[32:35], v[68:71], a[0:3]
    s_waitcnt vmcnt(18) lgkmcnt(0)
    v_mfma_f32_16x16x32_bf16 a[8:11], v[32:35], v[72:75], a[8:11]
    s_barrier
    v_mfma_f32_16x16x32_bf16 a[16:19], v[32:35], v[76:79], a[16:19]
    ds_read_b64_tr_b16 v[100:101], v10 offset:16384
    buffer_load_dword v255, v250, s[96:99], s78 offen
    v_mfma_f32_16x16x32_bf16 a[24:27], v[32:35], v[80:83], a[24:27]
    s_add_u32 m0, s28, 0
    s_cmp_eq_u32 s21, 0
    ds_read_b128 v[64:67], v9 offset:14336
    v_mfma_f32_16x16x32_bf16 a[32:35], v[32:35], v[84:87], a[32:35]
    s_cselect_b32 s52, s72, s74
    s_cselect_b32 s53, s73, s75
    buffer_load_dwordx4 v24, s[12:15], s27 offen offset:0 nt lds
    v_mfma_f32_16x16x32_bf16 a[40:43], v[32:35], v[88:91], a[40:43]
    ds_read_b64_tr_b16 v[102:103], v10 offset:16896
    v_mfma_f32_16x16x32_bf16 a[48:51], v[32:35], v[92:95], a[48:51]
    v_mfma_f32_16x16x32_bf16 a[56:59], v[32:35], v[96:99], a[56:59]
    ds_read_b128 v[32:35], v9 offset:0
    v_mfma_f32_16x16x32_bf16 a[4:7], v[36:39], v[68:71], a[4:7]
    ds_read_b64_tr_b16 v[104:105], v11 offset:16384
    v_mfma_f32_16x16x32_bf16 a[12:15], v[36:39], v[72:75], a[12:15]
    s_add_u32 s78, s78, s44
    v_mfma_f32_16x16x32_bf16 a[20:23], v[36:39], v[76:79], a[20:23]
    s_and_b32 s53, s53, 0xffff
    v_mfma_f32_16x16x32_bf16 a[28:31], v[36:39], v[80:83], a[28:31]
    ds_read_b64_tr_b16 v[106:107], v11 offset:16896
    buffer_load_dwordx4 v25, s[12:15], s27 offen offset:1024 nt lds
    v_mfma_f32_16x16x32_bf16 a[36:39], v[36:39], v[84:87], a[36:39]
    v_mfma_f32_16x16x32_bf16 a[44:47], v[36:39], v[88:91], a[44:47]
    s_cmp_lt_u32 s24, 14
    s_cselect_b32 s54, 1605632, 0
    v_mfma_f32_16x16x32_bf16 a[52:55], v[36:39], v[92:95], a[52:55]
    ds_read_b64_tr_b16 v[108:109], v12 offset:16384
    v_mfma_f32_16x16x32_bf16 a[60:63], v[36:39], v[96:99], a[60:63]
    ds_read_b128 v[36:39], v9 offset:2048
    v_mfma_f32_16x16x32_bf16 a[64:67], v[40:43], v[68:71], a[64:67]
    v_mfma_f32_16x16x32_bf16 a[72:75], v[40:43], v[72:75], a[72:75]
    ds_read_b64_tr_b16 v[110:111], v12 offset:16896
    v_mfma_f32_16x16x32_bf16 a[80:83], v[40:43], v[76:79], a[80:83]
    buffer_load_dwordx4 v26, s[12:15], s27 offen offset:2048 nt lds
    v_mfma_f32_16x16x32_bf16 a[88:91], v[40:43], v[80:83], a[88:91]
    s_mov_b32 s55, 0x00020000
    v_mfma_f32_16x16x32_bf16 a[96:99], v[40:43], v[84:87], a[96:99]
    ds_read_b64_tr_b16 v[112:113], v13 offset:16384
    v_mfma_f32_16x16x32_bf16 a[104:107], v[40:43], v[88:91], a[104:107]
    v_mfma_f32_16x16x32_bf16 a[112:115], v[40:43], v[92:95], a[112:115]
    s_lshl_b32 s77, s24, 8
    v_mfma_f32_16x16x32_bf16 a[120:123], v[40:43], v[96:99], a[120:123]
    ds_read_b64_tr_b16 v[114:115], v13 offset:16896
    ds_read_b128 v[40:43], v9 offset:4096
    v_mfma_f32_16x16x32_bf16 a[68:71], v[44:47], v[68:71], a[68:71]
    v_mfma_f32_16x16x32_bf16 a[76:79], v[44:47], v[72:75], a[76:79]
    s_lshl_b32 s42, s22, 7
    buffer_load_dwordx4 v27, s[12:15], s27 offen offset:3072 nt lds
    v_mfma_f32_16x16x32_bf16 a[84:87], v[44:47], v[76:79], a[84:87]
    s_add_u32 s27, s27, 262144
    ds_read_b64_tr_b16 v[116:117], v10 offset:20480
    v_mfma_f32_16x16x32_bf16 a[92:95], v[44:47], v[80:83], a[92:95]
    v_mfma_f32_16x16x32_bf16 a[100:103], v[44:47], v[84:87], a[100:103]
    v_and_b32 v3, 7, v1
    v_mfma_f32_16x16x32_bf16 a[108:111], v[44:47], v[88:91], a[108:111]
    ds_read_b64_tr_b16 v[118:119], v10 offset:20992
    v_mfma_f32_16x16x32_bf16 a[116:119], v[44:47], v[92:95], a[116:119]
    v_mfma_f32_16x16x32_bf16 a[124:127], v[44:47], v[96:99], a[124:127]
    s_add_u32 m0, s33, 4096
    ds_read_b128 v[44:47], v9 offset:6144
    v_mul_u32_u24 v6, 3584, v31
    v_mfma_f32_16x16x32_bf16 a[128:131], v[48:51], v[68:71], a[128:131]
    ds_read_b64_tr_b16 v[120:121], v11 offset:20480
    buffer_load_dwordx4 v20, s[8:11], s26 offen offset:0 lds
    v_mfma_f32_16x16x32_bf16 a[136:139], v[48:51], v[72:75], a[136:139]
    v_mfma_f32_16x16x32_bf16 a[144:147], v[48:51], v[76:79], a[144:147]
    v_add_u32 v6, s42, v6
    v_mfma_f32_16x16x32_bf16 a[152:155], v[48:51], v[80:83], a[152:155]
    ds_read_b64_tr_b16 v[122:123], v11 offset:20992
    v_mfma_f32_16x16x32_bf16 a[160:163], v[48:51], v[84:87], a[160:163]
    v_mfma_f32_16x16x32_bf16 a[168:171], v[48:51], v[88:91], a[168:171]
    v_and_b32 v5, 2, v31
    v_mfma_f32_16x16x32_bf16 a[176:179], v[48:51], v[92:95], a[176:179]
    ds_read_b64_tr_b16 v[124:125], v12 offset:20480
    v_mfma_f32_16x16x32_bf16 a[184:187], v[48:51], v[96:99], a[184:187]
    ds_read_b128 v[48:51], v9 offset:8192
    buffer_load_dwordx4 v21, s[8:11], s26 offen offset:1024 lds
    v_mfma_f32_16x16x32_bf16 a[132:135], v[52:55], v[68:71], a[132:135]
    s_add_u32 s33, s35, s34
    v_xor_b32 v5, v5, v3
    v_mfma_f32_16x16x32_bf16 a[140:143], v[52:55], v[72:75], a[140:143]
    ds_read_b64_tr_b16 v[126:127], v12 offset:20992
    v_mfma_f32_16x16x32_bf16 a[148:151], v[52:55], v[76:79], a[148:151]
    v_mfma_f32_16x16x32_bf16 a[156:159], v[52:55], v[80:83], a[156:159]
    v_lshl_add_u32 v16, v5, 4, v6
    v_mfma_f32_16x16x32_bf16 a[164:167], v[52:55], v[84:87], a[164:167]
    s_add_u32 s34, s34, 32768
    ds_read_b64_tr_b16 v[128:129], v13 offset:20480
    v_mfma_f32_16x16x32_bf16 a[172:175], v[52:55], v[88:91], a[172:175]
    v_mfma_f32_16x16x32_bf16 a[180:183], v[52:55], v[92:95], a[180:183]
    buffer_load_dwordx4 v22, s[8:11], s26 offen offset:2048 lds
    v_xor_b32 v5, 4, v5
    v_mfma_f32_16x16x32_bf16 a[188:191], v[52:55], v[96:99], a[188:191]
    ds_read_b64_tr_b16 v[130:131], v13 offset:20992
    ds_read_b128 v[52:55], v9 offset:10240
    v_mfma_f32_16x16x32_bf16 a[192:195], v[56:59], v[68:71], a[192:195]
    s_cmp_eq_u32 s34, 98304
    s_cselect_b32 s34, 0, s34
    v_mfma_f32_16x16x32_bf16 a[200:203], v[56:59], v[72:75], a[200:203]
    v_lshl_add_u32 v17, v5, 4, v6
    v_mfma_f32_16x16x32_bf16 a[208:211], v[56:59], v[76:79], a[208:211]
    v_mfma_f32_16x16x32_bf16 a[216:219], v[56:59], v[80:83], a[216:219]
    v_mfma_f32_16x16x32_bf16 a[224:227], v[56:59], v[84:87], a[224:227]
    v_add_u32 v17, 27648, v17
    v_mfma_f32_16x16x32_bf16 a[232:235], v[56:59], v[88:91], a[232:235]
    buffer_load_dwordx4 v23, s[8:11], s26 offen offset:3072 lds
    v_mfma_f32_16x16x32_bf16 a[240:243], v[56:59], v[92:95], a[240:243]
    s_add_u32 s26, s26, 128
    v_mfma_f32_16x16x32_bf16 a[248:251], v[56:59], v[96:99], a[248:251]
    ds_read_b128 v[56:59], v9 offset:12288
    v_add_u32 v18, 55296, v16
    v_mfma_f32_16x16x32_bf16 a[196:199], v[60:63], v[68:71], a[196:199]
    v_add_u32 v8, s34, v28
    v_mfma_f32_16x16x32_bf16 a[204:207], v[60:63], v[72:75], a[204:207]
    v_add_u32 v9, s34, v29
    v_mfma_f32_16x16x32_bf16 a[212:215], v[60:63], v[76:79], a[212:215]
    v_xor_b32 v10, 0x8000, v10
    v_add_u32 v19, 55296, v17
    v_mfma_f32_16x16x32_bf16 a[220:223], v[60:63], v[80:83], a[220:223]
    v_mfma_f32_16x16x32_bf16 a[228:231], v[60:63], v[84:87], a[228:231]
    v_xor_b32 v11, 0x8000, v11
    v_mfma_f32_16x16x32_bf16 a[236:239], v[60:63], v[88:91], a[236:239]
    v_xor_b32 v12, 0x8000, v12
    v_mfma_f32_16x16x32_bf16 a[244:247], v[60:63], v[92:95], a[244:247]
    s_waitcnt lgkmcnt(15)
    v_xor_b32 v13, 0x8000, v13
    v_mfma_f32_16x16x32_bf16 a[252:255], v[60:63], v[96:99], a[252:255]
    v_mfma_f32_16x16x32_bf16 a[0:3], v[32:35], v[100:103], a[0:3]
    s_waitcnt vmcnt(19) lgkmcnt(0)
    v_mfma_f32_16x16x32_bf16 a[8:11], v[32:35], v[104:107], a[8:11]
    s_barrier
    v_mfma_f32_16x16x32_bf16 a[16:19], v[32:35], v[108:111], a[16:19]
    ds_read_b64_tr_b16 v[68:69], v10 offset:0
    buffer_load_dword v255, v250, s[96:99], s78 offen
    v_mfma_f32_16x16x32_bf16 a[24:27], v[32:35], v[112:115], a[24:27]
    s_add_u32 m0, s28, 16384
    ds_read_b128 v[60:63], v8 offset:14336
    v_and_b32 v30, 16843009, v30
    v_mfma_f32_16x16x32_bf16 a[32:35], v[32:35], v[116:119], a[32:35]
    buffer_load_dwordx4 v24, s[12:15], s27 offen offset:0 nt lds
    v_cmp_ne_u32 vcc, 16843009, v30
    v_mfma_f32_16x16x32_bf16 a[40:43], v[32:35], v[120:123], a[40:43]
    ds_read_b64_tr_b16 v[70:71], v10 offset:512
    v_mfma_f32_16x16x32_bf16 a[48:51], v[32:35], v[124:127], a[48:51]
    s_cbranch_vccnz .Lmain_kernel_spin_20
.Lmain_kernel_pok_19:
    v_mfma_f32_16x16x32_bf16 a[56:59], v[32:35], v[128:131], a[56:59]
    ds_read_b128 v[32:35], v8 offset:0
    v_mfma_f32_16x16x32_bf16 a[4:7], v[36:39], v[100:103], a[4:7]
    ds_read_b64_tr_b16 v[72:73], v11 offset:0
    v_mfma_f32_16x16x32_bf16 a[12:15], v[36:39], v[104:107], a[12:15]
    s_add_u32 s78, s78, s44
    v_mfma_f32_16x16x32_bf16 a[20:23], v[36:39], v[108:111], a[20:23]
    s_mul_i32 s26, s41, 114688
    v_mfma_f32_16x16x32_bf16 a[28:31], v[36:39], v[112:115], a[28:31]
    ds_read_b64_tr_b16 v[74:75], v11 offset:512
    buffer_load_dwordx4 v25, s[12:15], s27 offen offset:1024 nt lds
    v_mfma_f32_16x16x32_bf16 a[36:39], v[36:39], v[116:119], a[36:39]
    v_mfma_f32_16x16x32_bf16 a[44:47], v[36:39], v[120:123], a[44:47]
    s_add_u32 s26, s26, 37748736
    v_mfma_f32_16x16x32_bf16 a[52:55], v[36:39], v[124:127], a[52:55]
    ds_read_b64_tr_b16 v[76:77], v12 offset:0
    v_mfma_f32_16x16x32_bf16 a[60:63], v[36:39], v[128:131], a[60:63]
    ds_read_b128 v[36:39], v8 offset:2048
    v_mfma_f32_16x16x32_bf16 a[64:67], v[40:43], v[100:103], a[64:67]
    v_and_b32 v3, 7, v1
    v_mfma_f32_16x16x32_bf16 a[72:75], v[40:43], v[104:107], a[72:75]
    ds_read_b64_tr_b16 v[78:79], v12 offset:512
    v_mfma_f32_16x16x32_bf16 a[80:83], v[40:43], v[108:111], a[80:83]
    buffer_load_dwordx4 v26, s[12:15], s27 offen offset:2048 nt lds
    v_mfma_f32_16x16x32_bf16 a[88:91], v[40:43], v[112:115], a[88:91]
    v_lshrrev_b32 v4, 4, v1
    v_mfma_f32_16x16x32_bf16 a[96:99], v[40:43], v[116:119], a[96:99]
    ds_read_b64_tr_b16 v[80:81], v13 offset:0
    v_mfma_f32_16x16x32_bf16 a[104:107], v[40:43], v[120:123], a[104:107]
    v_mfma_f32_16x16x32_bf16 a[112:115], v[40:43], v[124:127], a[112:115]
    s_mul_i32 s30, s20, 28672
    v_mfma_f32_16x16x32_bf16 a[120:123], v[40:43], v[128:131], a[120:123]
    ds_read_b64_tr_b16 v[82:83], v13 offset:512
    ds_read_b128 v[40:43], v8 offset:4096
    v_mfma_f32_16x16x32_bf16 a[68:71], v[44:47], v[100:103], a[68:71]
    v_mfma_f32_16x16x32_bf16 a[76:79], v[44:47], v[104:107], a[76:79]
    buffer_load_dwordx4 v27, s[12:15], s27 offen offset:3072 nt lds
    v_mul_u32_u24 v6, 896, v31
    v_mfma_f32_16x16x32_bf16 a[84:87], v[44:47], v[108:111], a[84:87]
    s_add_u32 s27, s27, 262144
    ds_read_b64_tr_b16 v[84:85], v10 offset:4096
    v_mfma_f32_16x16x32_bf16 a[92:95], v[44:47], v[112:115], a[92:95]
    v_mfma_f32_16x16x32_bf16 a[100:103], v[44:47], v[116:119], a[100:103]
    v_add_u32 v6, s30, v6
    v_mfma_f32_16x16x32_bf16 a[108:111], v[44:47], v[120:123], a[108:111]
    ds_read_b64_tr_b16 v[86:87], v10 offset:4608
    v_mfma_f32_16x16x32_bf16 a[116:119], v[44:47], v[124:127], a[116:119]
    v_mfma_f32_16x16x32_bf16 a[124:127], v[44:47], v[128:131], a[124:127]
    s_add_u32 m0, s76, 98304
    ds_read_b128 v[44:47], v8 offset:6144
    v_add_u32 v5, 0, v4
    v_mfma_f32_16x16x32_bf16 a[128:131], v[48:51], v[100:103], a[128:131]
    ds_read_b64_tr_b16 v[88:89], v11 offset:4096
    buffer_load_dwordx4 v16, s[52:55], s77 offen offset:0 lds
    v_mfma_f32_16x16x32_bf16 a[136:139], v[48:51], v[104:107], a[136:139]
    v_mfma_f32_16x16x32_bf16 a[144:147], v[48:51], v[108:111], a[144:147]
    v_xor_b32 v5, v5, v3
    v_mfma_f32_16x16x32_bf16 a[152:155], v[48:51], v[112:115], a[152:155]
    ds_read_b64_tr_b16 v[90:91], v11 offset:4608
    v_mfma_f32_16x16x32_bf16 a[160:163], v[48:51], v[116:119], a[160:163]
    v_mfma_f32_16x16x32_bf16 a[168:171], v[48:51], v[120:123], a[168:171]
    v_lshl_add_u32 v5, v5, 4, v6
    v_mfma_f32_16x16x32_bf16 a[176:179], v[48:51], v[124:127], a[176:179]
    ds_read_b64_tr_b16 v[92:93], v12 offset:4096
    v_mfma_f32_16x16x32_bf16 a[184:187], v[48:51], v[128:131], a[184:187]
    ds_read_b128 v[48:51], v8 offset:8192
    buffer_load_dwordx4 v17, s[52:55], s77 offen offset:1024 lds
    v_mfma_f32_16x16x32_bf16 a[132:135], v[52:55], v[100:103], a[132:135]
    v_add_u32 v20, 0, v5
    v_mfma_f32_16x16x32_bf16 a[140:143], v[52:55], v[104:107], a[140:143]
    ds_read_b64_tr_b16 v[94:95], v12 offset:4608
    v_mfma_f32_16x16x32_bf16 a[148:151], v[52:55], v[108:111], a[148:151]
    v_mfma_f32_16x16x32_bf16 a[156:159], v[52:55], v[112:115], a[156:159]
    v_add_u32 v22, 12288, v5
    v_mfma_f32_16x16x32_bf16 a[164:167], v[52:55], v[116:119], a[164:167]
    ds_read_b64_tr_b16 v[96:97], v13 offset:4096
    v_mfma_f32_16x16x32_bf16 a[172:175], v[52:55], v[120:123], a[172:175]
    v_mfma_f32_16x16x32_bf16 a[180:183], v[52:55], v[124:127], a[180:183]
    buffer_load_dwordx4 v18, s[52:55], s77 offen offset:2048 lds
    v_add_u32 v5, 4, v4
    v_mfma_f32_16x16x32_bf16 a[188:191], v[52:55], v[128:131], a[188:191]
    ds_read_b64_tr_b16 v[98:99], v13 offset:4608
    ds_read_b128 v[52:55], v8 offset:10240
    v_mfma_f32_16x16x32_bf16 a[192:195], v[56:59], v[100:103], a[192:195]
    v_mfma_f32_16x16x32_bf16 a[200:203], v[56:59], v[104:107], a[200:203]
    v_xor_b32 v5, v5, v3
    v_mfma_f32_16x16x32_bf16 a[208:211], v[56:59], v[108:111], a[208:211]
    v_mfma_f32_16x16x32_bf16 a[216:219], v[56:59], v[112:115], a[216:219]
    v_mfma_f32_16x16x32_bf16 a[224:227], v[56:59], v[116:119], a[224:227]
    v_lshl_add_u32 v5, v5, 4, v6
    v_mfma_f32_16x16x32_bf16 a[232:235], v[56:59], v[120:123], a[232:235]
    buffer_load_dwordx4 v19, s[52:55], s77 offen offset:3072 lds
    v_mfma_f32_16x16x32_bf16 a[240:243], v[56:59], v[124:127], a[240:243]
    s_add_u32 s77, s77, 114688
    v_mfma_f32_16x16x32_bf16 a[248:251], v[56:59], v[128:131], a[248:251]
    ds_read_b128 v[56:59], v8 offset:12288
    v_add_u32 v21, 6144, v5
    v_mfma_f32_16x16x32_bf16 a[196:199], v[64:67], v[100:103], a[196:199]
    v_mfma_f32_16x16x32_bf16 a[204:207], v[64:67], v[104:107], a[204:207]
    v_mfma_f32_16x16x32_bf16 a[212:215], v[64:67], v[108:111], a[212:215]
    v_add_u32 v23, 18432, v5
    v_mfma_f32_16x16x32_bf16 a[220:223], v[64:67], v[112:115], a[220:223]
    v_mfma_f32_16x16x32_bf16 a[228:231], v[64:67], v[116:119], a[228:231]
    v_mfma_f32_16x16x32_bf16 a[236:239], v[64:67], v[120:123], a[236:239]
    v_mfma_f32_16x16x32_bf16 a[244:247], v[64:67], v[124:127], a[244:247]
    s_waitcnt lgkmcnt(15)
    v_mfma_f32_16x16x32_bf16 a[252:255], v[64:67], v[128:131], a[252:255]
    v_mfma_f32_16x16x32_bf16 a[0:3], v[32:35], v[68:71], a[0:3]
    s_waitcnt vmcnt(23) lgkmcnt(0)
    v_mfma_f32_16x16x32_bf16 a[8:11], v[32:35], v[72:75], a[8:11]
    s_barrier
    v_mfma_f32_16x16x32_bf16 a[16:19], v[32:35], v[76:79], a[16:19]
    s_load_dwordx2 s[28:29], s[0:1], 80
    ds_read_b64_tr_b16 v[100:101], v10 offset:16384
    buffer_load_dword v255, v250, s[96:99], s78 offen
    v_mfma_f32_16x16x32_bf16 a[24:27], v[32:35], v[80:83], a[24:27]
    s_add_u32 m0, s76, 0
    ds_read_b128 v[64:67], v9 offset:14336
    v_mfma_f32_16x16x32_bf16 a[32:35], v[32:35], v[84:87], a[32:35]
    buffer_load_dwordx4 v20, s[16:19], s26 offen offset:0 sc1 lds
    v_mfma_f32_16x16x32_bf16 a[40:43], v[32:35], v[88:91], a[40:43]
    ds_read_b64_tr_b16 v[102:103], v10 offset:16896
    v_mfma_f32_16x16x32_bf16 a[48:51], v[32:35], v[92:95], a[48:51]
    v_mfma_f32_16x16x32_bf16 a[56:59], v[32:35], v[96:99], a[56:59]
    ds_read_b128 v[32:35], v9 offset:0
    v_mfma_f32_16x16x32_bf16 a[4:7], v[36:39], v[68:71], a[4:7]
    ds_read_b64_tr_b16 v[104:105], v11 offset:16384
    v_mfma_f32_16x16x32_bf16 a[12:15], v[36:39], v[72:75], a[12:15]
    s_add_u32 s78, s78, s44
    v_mfma_f32_16x16x32_bf16 a[20:23], v[36:39], v[76:79], a[20:23]
    v_mfma_f32_16x16x32_bf16 a[28:31], v[36:39], v[80:83], a[28:31]
    ds_read_b64_tr_b16 v[106:107], v11 offset:16896
    buffer_load_dwordx4 v21, s[16:19], s26 offen offset:1024 sc1 lds
    v_mfma_f32_16x16x32_bf16 a[36:39], v[36:39], v[84:87], a[36:39]
    v_mfma_f32_16x16x32_bf16 a[44:47], v[36:39], v[88:91], a[44:47]
    v_mfma_f32_16x16x32_bf16 a[52:55], v[36:39], v[92:95], a[52:55]
    ds_read_b64_tr_b16 v[108:109], v12 offset:16384
    v_mfma_f32_16x16x32_bf16 a[60:63], v[36:39], v[96:99], a[60:63]
    ds_read_b128 v[36:39], v9 offset:2048
    v_mfma_f32_16x16x32_bf16 a[64:67], v[40:43], v[68:71], a[64:67]
    v_mfma_f32_16x16x32_bf16 a[72:75], v[40:43], v[72:75], a[72:75]
    ds_read_b64_tr_b16 v[110:111], v12 offset:16896
    v_mfma_f32_16x16x32_bf16 a[80:83], v[40:43], v[76:79], a[80:83]
    buffer_load_dwordx4 v22, s[16:19], s26 offen offset:2048 sc1 lds
    v_mfma_f32_16x16x32_bf16 a[88:91], v[40:43], v[80:83], a[88:91]
    v_mfma_f32_16x16x32_bf16 a[96:99], v[40:43], v[84:87], a[96:99]
    ds_read_b64_tr_b16 v[112:113], v13 offset:16384
    v_mfma_f32_16x16x32_bf16 a[104:107], v[40:43], v[88:91], a[104:107]
    v_mfma_f32_16x16x32_bf16 a[112:115], v[40:43], v[92:95], a[112:115]
    v_mfma_f32_16x16x32_bf16 a[120:123], v[40:43], v[96:99], a[120:123]
    ds_read_b64_tr_b16 v[114:115], v13 offset:16896
    ds_read_b128 v[40:43], v9 offset:4096
    v_mfma_f32_16x16x32_bf16 a[68:71], v[44:47], v[68:71], a[68:71]
    v_mfma_f32_16x16x32_bf16 a[76:79], v[44:47], v[72:75], a[76:79]
    buffer_load_dwordx4 v23, s[16:19], s26 offen offset:3072 sc1 lds
    v_mfma_f32_16x16x32_bf16 a[84:87], v[44:47], v[76:79], a[84:87]
    s_add_u32 s26, s26, 128
    ds_read_b64_tr_b16 v[116:117], v10 offset:20480
    v_mfma_f32_16x16x32_bf16 a[92:95], v[44:47], v[80:83], a[92:95]
    v_mfma_f32_16x16x32_bf16 a[100:103], v[44:47], v[84:87], a[100:103]
    v_mfma_f32_16x16x32_bf16 a[108:111], v[44:47], v[88:91], a[108:111]
    ds_read_b64_tr_b16 v[118:119], v10 offset:20992
    v_mfma_f32_16x16x32_bf16 a[116:119], v[44:47], v[92:95], a[116:119]
    v_mfma_f32_16x16x32_bf16 a[124:127], v[44:47], v[96:99], a[124:127]
    s_add_u32 m0, s76, 114688
    ds_read_b128 v[44:47], v9 offset:6144
    v_mfma_f32_16x16x32_bf16 a[128:131], v[48:51], v[68:71], a[128:131]
    ds_read_b64_tr_b16 v[120:121], v11 offset:20480
    buffer_load_dwordx4 v16, s[52:55], s77 offen offset:0 lds
    v_mfma_f32_16x16x32_bf16 a[136:139], v[48:51], v[72:75], a[136:139]
    v_mfma_f32_16x16x32_bf16 a[144:147], v[48:51], v[76:79], a[144:147]
    v_mfma_f32_16x16x32_bf16 a[152:155], v[48:51], v[80:83], a[152:155]
    ds_read_b64_tr_b16 v[122:123], v11 offset:20992
    v_mfma_f32_16x16x32_bf16 a[160:163], v[48:51], v[84:87], a[160:163]
    v_mfma_f32_16x16x32_bf16 a[168:171], v[48:51], v[88:91], a[168:171]
    v_mfma_f32_16x16x32_bf16 a[176:179], v[48:51], v[92:95], a[176:179]
    ds_read_b64_tr_b16 v[124:125], v12 offset:20480
    v_mfma_f32_16x16x32_bf16 a[184:187], v[48:51], v[96:99], a[184:187]
    ds_read_b128 v[48:51], v9 offset:8192
    buffer_load_dwordx4 v17, s[52:55], s77 offen offset:1024 lds
    v_mfma_f32_16x16x32_bf16 a[132:135], v[52:55], v[68:71], a[132:135]
    s_add_u32 s33, s35, s34
    v_mfma_f32_16x16x32_bf16 a[140:143], v[52:55], v[72:75], a[140:143]
    ds_read_b64_tr_b16 v[126:127], v12 offset:20992
    v_mfma_f32_16x16x32_bf16 a[148:151], v[52:55], v[76:79], a[148:151]
    v_mfma_f32_16x16x32_bf16 a[156:159], v[52:55], v[80:83], a[156:159]
    v_mfma_f32_16x16x32_bf16 a[164:167], v[52:55], v[84:87], a[164:167]
    s_add_u32 s34, s34, 32768
    ds_read_b64_tr_b16 v[128:129], v13 offset:20480
    v_mfma_f32_16x16x32_bf16 a[172:175], v[52:55], v[88:91], a[172:175]
    v_mfma_f32_16x16x32_bf16 a[180:183], v[52:55], v[92:95], a[180:183]
    buffer_load_dwordx4 v18, s[52:55], s77 offen offset:2048 lds
    v_mfma_f32_16x16x32_bf16 a[188:191], v[52:55], v[96:99], a[188:191]
    ds_read_b64_tr_b16 v[130:131], v13 offset:20992
    ds_read_b128 v[52:55], v9 offset:10240
    v_mfma_f32_16x16x32_bf16 a[192:195], v[56:59], v[68:71], a[192:195]
    s_cmp_eq_u32 s34, 98304
    s_cselect_b32 s34, 0, s34
    v_mfma_f32_16x16x32_bf16 a[200:203], v[56:59], v[72:75], a[200:203]
    v_mfma_f32_16x16x32_bf16 a[208:211], v[56:59], v[76:79], a[208:211]
    v_mfma_f32_16x16x32_bf16 a[216:219], v[56:59], v[80:83], a[216:219]
    v_mfma_f32_16x16x32_bf16 a[224:227], v[56:59], v[84:87], a[224:227]
    v_mfma_f32_16x16x32_bf16 a[232:235], v[56:59], v[88:91], a[232:235]
    buffer_load_dwordx4 v19, s[52:55], s77 offen offset:3072 lds
    v_mfma_f32_16x16x32_bf16 a[240:243], v[56:59], v[92:95], a[240:243]
    s_add_u32 s77, s77, 114688
    v_mfma_f32_16x16x32_bf16 a[248:251], v[56:59], v[96:99], a[248:251]
    ds_read_b128 v[56:59], v9 offset:12288
    v_mfma_f32_16x16x32_bf16 a[196:199], v[60:63], v[68:71], a[196:199]
    v_add_u32 v8, s34, v28
    v_mfma_f32_16x16x32_bf16 a[204:207], v[60:63], v[72:75], a[204:207]
    v_add_u32 v9, s34, v29
    v_mfma_f32_16x16x32_bf16 a[212:215], v[60:63], v[76:79], a[212:215]
    v_xor_b32 v10, 0x8000, v10
    v_mfma_f32_16x16x32_bf16 a[220:223], v[60:63], v[80:83], a[220:223]
    v_mfma_f32_16x16x32_bf16 a[228:231], v[60:63], v[84:87], a[228:231]
    v_xor_b32 v11, 0x8000, v11
    v_mfma_f32_16x16x32_bf16 a[236:239], v[60:63], v[88:91], a[236:239]
    v_xor_b32 v12, 0x8000, v12
    v_mfma_f32_16x16x32_bf16 a[244:247], v[60:63], v[92:95], a[244:247]
    s_waitcnt lgkmcnt(0)
    v_xor_b32 v13, 0x8000, v13
    v_mfma_f32_16x16x32_bf16 a[252:255], v[60:63], v[96:99], a[252:255]
    v_mfma_f32_16x16x32_bf16 a[0:3], v[32:35], v[100:103], a[0:3]
    s_waitcnt vmcnt(18)
    v_mfma_f32_16x16x32_bf16 a[8:11], v[32:35], v[104:107], a[8:11]
    s_barrier
    v_mfma_f32_16x16x32_bf16 a[16:19], v[32:35], v[108:111], a[16:19]
    s_lshl_b32 s30, s21, 14
    ds_read_b64_tr_b16 v[68:69], v10 offset:0
    v_mfma_f32_16x16x32_bf16 a[24:27], v[32:35], v[112:115], a[24:27]
    s_add_u32 m0, s76, 16384
    ds_read_b128 v[60:63], v8 offset:14336
    v_mfma_f32_16x16x32_bf16 a[32:35], v[32:35], v[116:119], a[32:35]
    buffer_load_dwordx4 v20, s[16:19], s26 offen offset:0 sc1 lds
    v_mfma_f32_16x16x32_bf16 a[40:43], v[32:35], v[120:123], a[40:43]
    ds_read_b64_tr_b16 v[70:71], v10 offset:512
    v_mfma_f32_16x16x32_bf16 a[48:51], v[32:35], v[124:127], a[48:51]
    s_add_u32 s30, s30, 65536
    v_mfma_f32_16x16x32_bf16 a[56:59], v[32:35], v[128:131], a[56:59]
    ds_read_b128 v[32:35], v8 offset:0
    v_mfma_f32_16x16x32_bf16 a[4:7], v[36:39], v[100:103], a[4:7]
    ds_read_b64_tr_b16 v[72:73], v11 offset:0
    v_mfma_f32_16x16x32_bf16 a[12:15], v[36:39], v[104:107], a[12:15]
    v_mfma_f32_16x16x32_bf16 a[20:23], v[36:39], v[108:111], a[20:23]
    v_subrev_u32 v28, s30, v28
    v_mfma_f32_16x16x32_bf16 a[28:31], v[36:39], v[112:115], a[28:31]
    ds_read_b64_tr_b16 v[74:75], v11 offset:512
    buffer_load_dwordx4 v21, s[16:19], s26 offen offset:1024 sc1 lds
    v_mfma_f32_16x16x32_bf16 a[36:39], v[36:39], v[116:119], a[36:39]
    v_mfma_f32_16x16x32_bf16 a[44:47], v[36:39], v[120:123], a[44:47]
    v_mfma_f32_16x16x32_bf16 a[52:55], v[36:39], v[124:127], a[52:55]
    ds_read_b64_tr_b16 v[76:77], v12 offset:0
    v_subrev_u32 v29, s30, v29
    v_mfma_f32_16x16x32_bf16 a[60:63], v[36:39], v[128:131], a[60:63]
    ds_read_b128 v[36:39], v8 offset:2048
    v_mfma_f32_16x16x32_bf16 a[64:67], v[40:43], v[100:103], a[64:67]
    v_mfma_f32_16x16x32_bf16 a[72:75], v[40:43], v[104:107], a[72:75]
    ds_read_b64_tr_b16 v[78:79], v12 offset:512
    v_mfma_f32_16x16x32_bf16 a[80:83], v[40:43], v[108:111], a[80:83]
    s_lshl_b32 s30, s21, 12
    buffer_load_dwordx4 v22, s[16:19], s26 offen offset:2048 sc1 lds
    v_mfma_f32_16x16x32_bf16 a[88:91], v[40:43], v[112:115], a[88:91]
    v_mfma_f32_16x16x32_bf16 a[96:99], v[40:43], v[116:119], a[96:99]
    ds_read_b64_tr_b16 v[80:81], v13 offset:0
    v_mfma_f32_16x16x32_bf16 a[104:107], v[40:43], v[120:123], a[104:107]
    v_mfma_f32_16x16x32_bf16 a[112:115], v[40:43], v[124:127], a[112:115]
    v_mfma_f32_16x16x32_bf16 a[120:123], v[40:43], v[128:131], a[120:123]
    s_lshl_b32 s31, s22, 13
    ds_read_b64_tr_b16 v[82:83], v13 offset:512
    ds_read_b128 v[40:43], v8 offset:4096
    v_mfma_f32_16x16x32_bf16 a[68:71], v[44:47], v[100:103], a[68:71]
    v_mfma_f32_16x16x32_bf16 a[76:79], v[44:47], v[104:107], a[76:79]
    buffer_load_dwordx4 v23, s[16:19], s26 offen offset:3072 sc1 lds
    v_mfma_f32_16x16x32_bf16 a[84:87], v[44:47], v[108:111], a[84:87]
    s_add_u32 s26, s26, 128
    ds_read_b64_tr_b16 v[84:85], v10 offset:4096
    v_mfma_f32_16x16x32_bf16 a[92:95], v[44:47], v[112:115], a[92:95]
    s_sub_u32 s30, s30, s31
    v_mfma_f32_16x16x32_bf16 a[100:103], v[44:47], v[116:119], a[100:103]
    v_mfma_f32_16x16x32_bf16 a[108:111], v[44:47], v[120:123], a[108:111]
    ds_read_b64_tr_b16 v[86:87], v10 offset:4608
    v_mfma_f32_16x16x32_bf16 a[116:119], v[44:47], v[124:127], a[116:119]
    v_mfma_f32_16x16x32_bf16 a[124:127], v[44:47], v[128:131], a[124:127]
    s_add_u32 m0, s76, 131072
    s_add_u32 s30, s30, 32768
    ds_read_b128 v[44:47], v8 offset:6144
    v_mfma_f32_16x16x32_bf16 a[128:131], v[48:51], v[100:103], a[128:131]
    ds_read_b64_tr_b16 v[88:89], v11 offset:4096
    buffer_load_dwordx4 v16, s[52:55], s77 offen offset:0 lds
    v_mfma_f32_16x16x32_bf16 a[136:139], v[48:51], v[104:107], a[136:139]
    v_mfma_f32_16x16x32_bf16 a[144:147], v[48:51], v[108:111], a[144:147]
    v_mfma_f32_16x16x32_bf16 a[152:155], v[48:51], v[112:115], a[152:155]
    s_cmp_lg_u32 s22, 0
    s_cselect_b64 vcc, -1, 0
    ds_read_b64_tr_b16 v[90:91], v11 offset:4608
    v_mfma_f32_16x16x32_bf16 a[160:163], v[48:51], v[116:119], a[160:163]
    v_mfma_f32_16x16x32_bf16 a[168:171], v[48:51], v[120:123], a[168:171]
    v_mfma_f32_16x16x32_bf16 a[176:179], v[48:51], v[124:127], a[176:179]
    ds_read_b64_tr_b16 v[92:93], v12 offset:4096
    v_mfma_f32_16x16x32_bf16 a[184:187], v[48:51], v[128:131], a[184:187]
    ds_read_b128 v[48:51], v8 offset:8192
    buffer_load_dwordx4 v17, s[52:55], s77 offen offset:1024 lds
    v_mfma_f32_16x16x32_bf16 a[132:135], v[52:55], v[100:103], a[132:135]
    v_mfma_f32_16x16x32_bf16 a[140:143], v[52:55], v[104:107], a[140:143]
    ds_read_b64_tr_b16 v[94:95], v12 offset:4608
    v_mfma_f32_16x16x32_bf16 a[148:151], v[52:55], v[108:111], a[148:151]
    v_mfma_f32_16x16x32_bf16 a[156:159], v[52:55], v[112:115], a[156:159]
    v_mfma_f32_16x16x32_bf16 a[164:167], v[52:55], v[116:119], a[164:167]
    ds_read_b64_tr_b16 v[96:97], v13 offset:4096
    v_cndmask_b32 v30, v10, v12, vcc
    v_mfma_f32_16x16x32_bf16 a[172:175], v[52:55], v[120:123], a[172:175]
    v_mfma_f32_16x16x32_bf16 a[180:183], v[52:55], v[124:127], a[180:183]
    buffer_load_dwordx4 v18, s[52:55], s77 offen offset:2048 lds
    v_mfma_f32_16x16x32_bf16 a[188:191], v[52:55], v[128:131], a[188:191]
    ds_read_b64_tr_b16 v[98:99], v13 offset:4608
    ds_read_b128 v[52:55], v8 offset:10240
    v_mfma_f32_16x16x32_bf16 a[192:195], v[56:59], v[100:103], a[192:195]
    v_add_u32 v30, s30, v30
    v_mfma_f32_16x16x32_bf16 a[200:203], v[56:59], v[104:107], a[200:203]
    v_mfma_f32_16x16x32_bf16 a[208:211], v[56:59], v[108:111], a[208:211]
    v_mfma_f32_16x16x32_bf16 a[216:219], v[56:59], v[112:115], a[216:219]
    v_mfma_f32_16x16x32_bf16 a[224:227], v[56:59], v[116:119], a[224:227]
    v_cndmask_b32 v31, v11, v13, vcc
    v_mfma_f32_16x16x32_bf16 a[232:235], v[56:59], v[120:123], a[232:235]
    buffer_load_dwordx4 v19, s[52:55], s77 offen offset:3072 lds
    v_mfma_f32_16x16x32_bf16 a[240:243], v[56:59], v[124:127], a[240:243]
    s_add_u32 s77, s77, 114688
    v_mfma_f32_16x16x32_bf16 a[248:251], v[56:59], v[128:131], a[248:251]
    ds_read_b128 v[56:59], v8 offset:12288
    v_mfma_f32_16x16x32_bf16 a[196:199], v[64:67], v[100:103], a[196:199]
    v_add_u32 v31, s30, v31
    v_mfma_f32_16x16x32_bf16 a[204:207], v[64:67], v[104:107], a[204:207]
    v_mfma_f32_16x16x32_bf16 a[212:215], v[64:67], v[108:111], a[212:215]
    v_mfma_f32_16x16x32_bf16 a[220:223], v[64:67], v[112:115], a[220:223]
    v_mfma_f32_16x16x32_bf16 a[228:231], v[64:67], v[116:119], a[228:231]
    v_mfma_f32_16x16x32_bf16 a[236:239], v[64:67], v[120:123], a[236:239]
    v_mfma_f32_16x16x32_bf16 a[244:247], v[64:67], v[124:127], a[244:247]
    s_waitcnt lgkmcnt(15)
    v_mfma_f32_16x16x32_bf16 a[252:255], v[64:67], v[128:131], a[252:255]
    v_mfma_f32_16x16x32_bf16 a[0:3], v[32:35], v[68:71], a[0:3]
    s_waitcnt vmcnt(21) lgkmcnt(0)
    v_mfma_f32_16x16x32_bf16 a[8:11], v[32:35], v[72:75], a[8:11]
    s_barrier
    v_mfma_f32_16x16x32_bf16 a[16:19], v[32:35], v[76:79], a[16:19]
    s_lshl_b32 s30, s24, 6
    ds_read_b64_tr_b16 v[100:101], v10 offset:16384
    v_mfma_f32_16x16x32_bf16 a[24:27], v[32:35], v[80:83], a[24:27]
    s_add_u32 m0, s76, 32768
    ds_read_b128 v[64:67], v9 offset:14336
    v_mfma_f32_16x16x32_bf16 a[32:35], v[32:35], v[84:87], a[32:35]
    s_lshl_b32 s31, s23, 3
    buffer_load_dwordx4 v20, s[16:19], s26 offen offset:0 sc1 lds
    v_mfma_f32_16x16x32_bf16 a[40:43], v[32:35], v[88:91], a[40:43]
    ds_read_b64_tr_b16 v[102:103], v10 offset:16896
    v_mfma_f32_16x16x32_bf16 a[48:51], v[32:35], v[92:95], a[48:51]
    s_add_u32 s30, s30, s31
    v_mfma_f32_16x16x32_bf16 a[56:59], v[32:35], v[96:99], a[56:59]
    ds_read_b128 v[32:35], v9 offset:0
    v_mfma_f32_16x16x32_bf16 a[4:7], v[36:39], v[68:71], a[4:7]
    s_lshl_b32 s31, s21, 2
    ds_read_b64_tr_b16 v[104:105], v11 offset:16384
    v_mfma_f32_16x16x32_bf16 a[12:15], v[36:39], v[72:75], a[12:15]
    v_mfma_f32_16x16x32_bf16 a[20:23], v[36:39], v[76:79], a[20:23]
    s_add_u32 s30, s30, s31
    v_mfma_f32_16x16x32_bf16 a[28:31], v[36:39], v[80:83], a[28:31]
    ds_read_b64_tr_b16 v[106:107], v11 offset:16896
    buffer_load_dwordx4 v21, s[16:19], s26 offen offset:1024 sc1 lds
    v_mfma_f32_16x16x32_bf16 a[36:39], v[36:39], v[84:87], a[36:39]
    s_lshl_b32 s32, s30, 14
    v_mfma_f32_16x16x32_bf16 a[44:47], v[36:39], v[88:91], a[44:47]
    v_mfma_f32_16x16x32_bf16 a[52:55], v[36:39], v[92:95], a[52:55]
    s_lshl_b32 s31, s22, 13
    ds_read_b64_tr_b16 v[108:109], v12 offset:16384
    v_mfma_f32_16x16x32_bf16 a[60:63], v[36:39], v[96:99], a[60:63]
    ds_read_b128 v[36:39], v9 offset:2048
    v_mfma_f32_16x16x32_bf16 a[64:67], v[40:43], v[68:71], a[64:67]
    s_add_u32 s32, s32, s31
    v_mfma_f32_16x16x32_bf16 a[72:75], v[40:43], v[72:75], a[72:75]
    ds_read_b64_tr_b16 v[110:111], v12 offset:16896
    v_mfma_f32_16x16x32_bf16 a[80:83], v[40:43], v[76:79], a[80:83]
    s_lshl_b32 s31, s25, 24
    buffer_load_dwordx4 v22, s[16:19], s26 offen offset:2048 sc1 lds
    v_mfma_f32_16x16x32_bf16 a[88:91], v[40:43], v[80:83], a[88:91]
    v_mfma_f32_16x16x32_bf16 a[96:99], v[40:43], v[84:87], a[96:99]
    s_add_u32 s32, s32, s31
    ds_read_b64_tr_b16 v[112:113], v13 offset:16384
    v_mfma_f32_16x16x32_bf16 a[104:107], v[40:43], v[88:91], a[104:107]
    v_mfma_f32_16x16x32_bf16 a[112:115], v[40:43], v[92:95], a[112:115]
    s_mov_b32 s12, s68
    v_mfma_f32_16x16x32_bf16 a[120:123], v[40:43], v[96:99], a[120:123]
    ds_read_b64_tr_b16 v[114:115], v13 offset:16896
    ds_read_b128 v[40:43], v9 offset:4096
    v_mfma_f32_16x16x32_bf16 a[68:71], v[44:47], v[68:71], a[68:71]
    s_and_b32 s13, s69, 0xffff
    v_mfma_f32_16x16x32_bf16 a[76:79], v[44:47], v[72:75], a[76:79]
    buffer_load_dwordx4 v23, s[16:19], s26 offen offset:3072 sc1 lds
    v_mfma_f32_16x16x32_bf16 a[84:87], v[44:47], v[76:79], a[84:87]
    s_add_u32 s26, s26, 128
    s_mov_b32 s14, 3670016
    ds_read_b64_tr_b16 v[116:117], v10 offset:20480
    v_mfma_f32_16x16x32_bf16 a[92:95], v[44:47], v[80:83], a[92:95]
    v_mfma_f32_16x16x32_bf16 a[100:103], v[44:47], v[84:87], a[100:103]
    s_lshl_b32 s27, s24, 9
    v_mfma_f32_16x16x32_bf16 a[108:111], v[44:47], v[88:91], a[108:111]
    ds_read_b64_tr_b16 v[118:119], v10 offset:20992
    v_mfma_f32_16x16x32_bf16 a[116:119], v[44:47], v[92:95], a[116:119]
    s_mov_b32 s8, s70
    v_mfma_f32_16x16x32_bf16 a[124:127], v[44:47], v[96:99], a[124:127]
    s_add_u32 m0, s76, 147456
    ds_read_b128 v[44:47], v9 offset:6144
    v_mfma_f32_16x16x32_bf16 a[128:131], v[48:51], v[68:71], a[128:131]
    s_and_b32 s9, s71, 0xffff
    ds_read_b64_tr_b16 v[120:121], v11 offset:20480
    buffer_load_dwordx4 v16, s[52:55], s77 offen offset:0 lds
    v_mfma_f32_16x16x32_bf16 a[136:139], v[48:51], v[72:75], a[136:139]
    v_mfma_f32_16x16x32_bf16 a[144:147], v[48:51], v[76:79], a[144:147]
    s_mov_b32 s10, 3670016
    v_mfma_f32_16x16x32_bf16 a[152:155], v[48:51], v[80:83], a[152:155]
    ds_read_b64_tr_b16 v[122:123], v11 offset:20992
    v_mfma_f32_16x16x32_bf16 a[160:163], v[48:51], v[84:87], a[160:163]
    s_mul_i32 s33, s24, 229376
    v_mfma_f32_16x16x32_bf16 a[168:171], v[48:51], v[88:91], a[168:171]
    v_mfma_f32_16x16x32_bf16 a[176:179], v[48:51], v[92:95], a[176:179]
    s_mul_i32 s34, s41, 1835008
    ds_read_b64_tr_b16 v[124:125], v12 offset:20480
    v_mfma_f32_16x16x32_bf16 a[184:187], v[48:51], v[96:99], a[184:187]
    ds_read_b128 v[48:51], v9 offset:8192
    buffer_load_dwordx4 v17, s[52:55], s77 offen offset:1024 lds
    v_mfma_f32_16x16x32_bf16 a[132:135], v[52:55], v[68:71], a[132:135]
    s_lshl_b32 s30, s21, 16
    v_mfma_f32_16x16x32_bf16 a[140:143], v[52:55], v[72:75], a[140:143]
    ds_read_b64_tr_b16 v[126:127], v12 offset:20992
    v_mfma_f32_16x16x32_bf16 a[148:151], v[52:55], v[76:79], a[148:151]
    s_add_u32 s34, s34, s30
    v_mfma_f32_16x16x32_bf16 a[156:159], v[52:55], v[80:83], a[156:159]
    v_mfma_f32_16x16x32_bf16 a[164:167], v[52:55], v[84:87], a[164:167]
    s_lshl_b32 s30, s22, 17
    ds_read_b64_tr_b16 v[128:129], v13 offset:20480
    v_mfma_f32_16x16x32_bf16 a[172:175], v[52:55], v[88:91], a[172:175]
    v_mfma_f32_16x16x32_bf16 a[180:183], v[52:55], v[92:95], a[180:183]
    s_add_u32 s34, s34, s30
    buffer_load_dwordx4 v18, s[52:55], s77 offen offset:2048 lds
    v_mfma_f32_16x16x32_bf16 a[188:191], v[52:55], v[96:99], a[188:191]
    ds_read_b64_tr_b16 v[130:131], v13 offset:20992
    ds_read_b128 v[52:55], v9 offset:10240
    v_mfma_f32_16x16x32_bf16 a[192:195], v[56:59], v[68:71], a[192:195]
    s_add_u32 s34, s34, 39845888
    v_mfma_f32_16x16x32_bf16 a[200:203], v[56:59], v[72:75], a[200:203]
    v_mfma_f32_16x16x32_bf16 a[208:211], v[56:59], v[76:79], a[208:211]
    s_cmp_lt_u32 s24, 14
    s_cselect_b32 s34, s34, 1073741824
    v_mfma_f32_16x16x32_bf16 a[216:219], v[56:59], v[80:83], a[216:219]
    v_mfma_f32_16x16x32_bf16 a[224:227], v[56:59], v[84:87], a[224:227]
    v_mfma_f32_16x16x32_bf16 a[232:235], v[56:59], v[88:91], a[232:235]
    buffer_load_dwordx4 v19, s[52:55], s77 offen offset:3072 lds
    v_mfma_f32_16x16x32_bf16 a[240:243], v[56:59], v[92:95], a[240:243]
    s_add_u32 s77, s77, 114688
    s_mov_b32 s44, 1035512379
    v_mfma_f32_16x16x32_bf16 a[248:251], v[56:59], v[96:99], a[248:251]
    ds_read_b128 v[56:59], v9 offset:12288
    v_mfma_f32_16x16x32_bf16 a[196:199], v[60:63], v[68:71], a[196:199]
    s_mov_b32 s45, 1035512379
    v_mfma_f32_16x16x32_bf16 a[204:207], v[60:63], v[72:75], a[204:207]
    v_mfma_f32_16x16x32_bf16 a[212:215], v[60:63], v[76:79], a[212:215]
    s_mov_b32 s40, 3216550459
    v_mfma_f32_16x16x32_bf16 a[220:223], v[60:63], v[80:83], a[220:223]
    v_mfma_f32_16x16x32_bf16 a[228:231], v[60:63], v[84:87], a[228:231]
    v_mfma_f32_16x16x32_bf16 a[236:239], v[60:63], v[88:91], a[236:239]
    v_mfma_f32_16x16x32_bf16 a[244:247], v[60:63], v[92:95], a[244:247]
    s_waitcnt lgkmcnt(15)
    v_mfma_f32_16x16x32_bf16 a[252:255], v[60:63], v[96:99], a[252:255]
    v_mfma_f32_16x16x32_bf16 a[0:3], v[32:35], v[100:103], a[0:3]
    s_waitcnt vmcnt(20) lgkmcnt(0)
    v_mfma_f32_16x16x32_bf16 a[8:11], v[32:35], v[104:107], a[8:11]
    s_barrier
    v_mfma_f32_16x16x32_bf16 a[16:19], v[32:35], v[108:111], a[16:19]
    ds_read_b64_tr_b16 v[68:69], v30 offset:32768
    v_add_u32 v8, 65536, v30
    v_mfma_f32_16x16x32_bf16 a[24:27], v[32:35], v[112:115], a[24:27]
    s_add_u32 m0, s76, 49152
    ds_read_b128 v[60:63], v28 offset:14336
    v_mfma_f32_16x16x32_bf16 a[32:35], v[32:35], v[116:119], a[32:35]
    buffer_load_dwordx4 v20, s[16:19], s26 offen offset:0 sc1 lds
    v_mfma_f32_16x16x32_bf16 a[40:43], v[32:35], v[120:123], a[40:43]
    ds_read_b64_tr_b16 v[70:71], v30 offset:33280
    v_mfma_f32_16x16x32_bf16 a[48:51], v[32:35], v[124:127], a[48:51]
    v_add_u32 v9, 65536, v31
    v_mfma_f32_16x16x32_bf16 a[56:59], v[32:35], v[128:131], a[56:59]
    ds_read_b128 v[32:35], v28 offset:0
    v_mfma_f32_16x16x32_bf16 a[4:7], v[36:39], v[100:103], a[4:7]
    ds_read_b64_tr_b16 v[72:73], v31 offset:32768
    v_mfma_f32_16x16x32_bf16 a[12:15], v[36:39], v[104:107], a[12:15]
    buffer_load_dwordx4 v21, s[16:19], s26 offen offset:1024 sc1 lds
    v_mfma_f32_16x16x32_bf16 a[20:23], v[36:39], v[108:111], a[20:23]
    v_mfma_f32_16x16x32_bf16 a[28:31], v[36:39], v[112:115], a[28:31]
    ds_read_b64_tr_b16 v[74:75], v31 offset:33280
    v_mfma_f32_16x16x32_bf16 a[36:39], v[36:39], v[116:119], a[36:39]
    v_mfma_f32_16x16x32_bf16 a[44:47], v[36:39], v[120:123], a[44:47]
    v_mfma_f32_16x16x32_bf16 a[52:55], v[36:39], v[124:127], a[52:55]
    ds_read_b64_tr_b16 v[76:77], v30 offset:40960
    buffer_load_dwordx4 v22, s[16:19], s26 offen offset:2048 sc1 lds
    v_mfma_f32_16x16x32_bf16 a[60:63], v[36:39], v[128:131], a[60:63]
    ds_read_b128 v[36:39], v28 offset:2048
    v_mfma_f32_16x16x32_bf16 a[64:67], v[40:43], v[100:103], a[64:67]
    v_mfma_f32_16x16x32_bf16 a[72:75], v[40:43], v[104:107], a[72:75]
    ds_read_b64_tr_b16 v[78:79], v30 offset:41472
    v_mfma_f32_16x16x32_bf16 a[80:83], v[40:43], v[108:111], a[80:83]
    v_accvgpr_read_b32 v232, a0
    v_mfma_f32_16x16x32_bf16 a[88:91], v[40:43], v[112:115], a[88:91]
    buffer_load_dwordx4 v23, s[16:19], s26 offen offset:3072 sc1 lds
    v_accvgpr_read_b32 v233, a1
    v_mfma_f32_16x16x32_bf16 a[96:99], v[40:43], v[116:119], a[96:99]
    s_add_u32 s26, s26, 128
    ds_read_b64_tr_b16 v[80:81], v31 offset:40960
    v_mfma_f32_16x16x32_bf16 a[104:107], v[40:43], v[120:123], a[104:107]
    v_accvgpr_read_b32 v234, a2
    v_mfma_f32_16x16x32_bf16 a[112:115], v[40:43], v[124:127], a[112:115]
    v_accvgpr_read_b32 v235, a3
    v_mfma_f32_16x16x32_bf16 a[120:123], v[40:43], v[128:131], a[120:123]
    s_add_u32 m0, s76, 65536
    ds_read_b64_tr_b16 v[82:83], v31 offset:41472
    ds_read_b128 v[40:43], v28 offset:4096
    v_mfma_f32_16x16x32_bf16 a[68:71], v[44:47], v[100:103], a[68:71]
    buffer_load_dwordx4 v16, s[52:55], s77 offen offset:0 lds
    v_accvgpr_read_b32 v236, a4
    v_mfma_f32_16x16x32_bf16 a[76:79], v[44:47], v[104:107], a[76:79]
    v_mfma_f32_16x16x32_bf16 a[84:87], v[44:47], v[108:111], a[84:87]
    v_accvgpr_read_b32 v237, a5
    v_mfma_f32_16x16x32_bf16 a[92:95], v[44:47], v[112:115], a[92:95]
    v_accvgpr_read_b32 v238, a6
    v_mfma_f32_16x16x32_bf16 a[100:103], v[44:47], v[116:119], a[100:103]
    v_mfma_f32_16x16x32_bf16 a[108:111], v[44:47], v[120:123], a[108:111]
    buffer_load_dwordx4 v17, s[52:55], s77 offen offset:1024 lds
    v_accvgpr_read_b32 v239, a7
    v_mfma_f32_16x16x32_bf16 a[116:119], v[44:47], v[124:127], a[116:119]
    v_mfma_f32_16x16x32_bf16 a[124:127], v[44:47], v[128:131], a[124:127]
    ds_read_b128 v[44:47], v28 offset:6144
    v_cvt_pk_bf16_f32 v232, v232, v233
    v_mfma_f32_16x16x32_bf16 a[128:131], v[48:51], v[100:103], a[128:131]
    v_cvt_pk_bf16_f32 v233, v234, v235
    v_mfma_f32_16x16x32_bf16 a[136:139], v[48:51], v[104:107], a[136:139]
    v_mfma_f32_16x16x32_bf16 a[144:147], v[48:51], v[108:111], a[144:147]
    buffer_load_dwordx4 v18, s[52:55], s77 offen offset:2048 lds
    v_cvt_pk_bf16_f32 v234, v236, v237
    v_mfma_f32_16x16x32_bf16 a[152:155], v[48:51], v[112:115], a[152:155]
    v_mfma_f32_16x16x32_bf16 a[160:163], v[48:51], v[116:119], a[160:163]
    v_cvt_pk_bf16_f32 v235, v238, v239
    v_mfma_f32_16x16x32_bf16 a[168:171], v[48:51], v[120:123], a[168:171]
    buffer_store_dwordx4 v[232:235], v14, s[16:19], s32 offen offset:0 sc1
    v_mfma_f32_16x16x32_bf16 a[176:179], v[48:51], v[124:127], a[176:179]
    v_mfma_f32_16x16x32_bf16 a[184:187], v[48:51], v[128:131], a[184:187]
    ds_read_b128 v[48:51], v28 offset:8192
    buffer_load_dwordx4 v19, s[52:55], s77 offen offset:3072 lds
    v_mfma_f32_16x16x32_bf16 a[132:135], v[52:55], v[100:103], a[132:135]
    s_add_u32 s77, s77, 114688
    v_mfma_f32_16x16x32_bf16 a[140:143], v[52:55], v[104:107], a[140:143]
    v_accvgpr_read_b32 v240, a8
    v_mfma_f32_16x16x32_bf16 a[148:151], v[52:55], v[108:111], a[148:151]
    v_accvgpr_read_b32 v241, a9
    v_mfma_f32_16x16x32_bf16 a[156:159], v[52:55], v[112:115], a[156:159]
    s_add_u32 m0, s76, 81920
    v_mfma_f32_16x16x32_bf16 a[164:167], v[52:55], v[116:119], a[164:167]
    buffer_load_dwordx4 v16, s[52:55], s77 offen offset:0 lds
    v_accvgpr_read_b32 v242, a10
    v_mfma_f32_16x16x32_bf16 a[172:175], v[52:55], v[120:123], a[172:175]
    v_accvgpr_read_b32 v243, a11
    v_mfma_f32_16x16x32_bf16 a[180:183], v[52:55], v[124:127], a[180:183]
    v_mfma_f32_16x16x32_bf16 a[188:191], v[52:55], v[128:131], a[188:191]
    ds_read_b128 v[52:55], v28 offset:10240
    v_accvgpr_read_b32 v244, a12
    v_mfma_f32_16x16x32_bf16 a[192:195], v[56:59], v[100:103], a[192:195]
    v_mfma_f32_16x16x32_bf16 a[200:203], v[56:59], v[104:107], a[200:203]
    buffer_load_dwordx4 v17, s[52:55], s77 offen offset:1024 lds
    v_accvgpr_read_b32 v245, a13
    v_mfma_f32_16x16x32_bf16 a[208:211], v[56:59], v[108:111], a[208:211]
    v_accvgpr_read_b32 v246, a14
    v_mfma_f32_16x16x32_bf16 a[216:219], v[56:59], v[112:115], a[216:219]
    v_mfma_f32_16x16x32_bf16 a[224:227], v[56:59], v[116:119], a[224:227]
    v_accvgpr_read_b32 v247, a15
    v_mfma_f32_16x16x32_bf16 a[232:235], v[56:59], v[120:123], a[232:235]
    v_mfma_f32_16x16x32_bf16 a[240:243], v[56:59], v[124:127], a[240:243]
    buffer_load_dwordx4 v18, s[52:55], s77 offen offset:2048 lds
    v_cvt_pk_bf16_f32 v240, v240, v241
    v_mfma_f32_16x16x32_bf16 a[248:251], v[56:59], v[128:131], a[248:251]
    ds_read_b128 v[56:59], v28 offset:12288
    v_cvt_pk_bf16_f32 v241, v242, v243
    v_mfma_f32_16x16x32_bf16 a[196:199], v[64:67], v[100:103], a[196:199]
    v_mfma_f32_16x16x32_bf16 a[204:207], v[64:67], v[104:107], a[204:207]
    v_cvt_pk_bf16_f32 v242, v244, v245
    v_mfma_f32_16x16x32_bf16 a[212:215], v[64:67], v[108:111], a[212:215]
    v_mfma_f32_16x16x32_bf16 a[220:223], v[64:67], v[112:115], a[220:223]
    buffer_load_dwordx4 v19, s[52:55], s77 offen offset:3072 lds
    v_cvt_pk_bf16_f32 v243, v246, v247
    v_mfma_f32_16x16x32_bf16 a[228:231], v[64:67], v[116:119], a[228:231]
    s_add_u32 s77, s77, 114688
    buffer_store_dwordx4 v[240:243], v14, s[16:19], s32 offen offset:1024 sc1
    v_mfma_f32_16x16x32_bf16 a[236:239], v[64:67], v[120:123], a[236:239]
    v_mfma_f32_16x16x32_bf16 a[244:247], v[64:67], v[124:127], a[244:247]
    v_mfma_f32_16x16x32_bf16 a[252:255], v[64:67], v[128:131], a[252:255]
    s_waitcnt lgkmcnt(1)
.Lmain_kernel_t2_7:
    v_mfma_f32_16x16x32_bf16 v[128:131], v[68:71], v[32:35], 0
    s_waitcnt vmcnt(30)
    v_mfma_f32_16x16x32_bf16 v[132:135], v[72:75], v[32:35], 0
    s_barrier
    v_mfma_f32_16x16x32_bf16 v[136:139], v[76:79], v[32:35], 0
    s_add_u32 m0, s76, 98304
    ds_read_b128 v[64:67], v29 offset:14336
    v_mfma_f32_16x16x32_bf16 v[140:143], v[80:83], v[32:35], 0
    ds_read_b128 v[32:35], v29 offset:0
    v_mov_b32 v124, v250
    v_mfma_f32_16x16x32_bf16 v[144:147], v[68:71], v[36:39], 0
    v_accvgpr_read_b32 v100, a16
    v_accvgpr_read_b32 v101, a17
    v_mfma_f32_16x16x32_bf16 v[148:151], v[72:75], v[36:39], 0
    ds_read_b64_tr_b16 v[84:85], v30 offset:49152
    v_accvgpr_read_b32 v102, a18
    v_mfma_f32_16x16x32_bf16 v[152:155], v[76:79], v[36:39], 0
    buffer_load_dwordx4 v16, s[52:55], s77 offen offset:0 lds
    v_accvgpr_read_b32 v103, a19
    v_mfma_f32_16x16x32_bf16 v[156:159], v[80:83], v[36:39], 0
    ds_read_b128 v[36:39], v29 offset:2048
    ds_read_b64_tr_b16 v[86:87], v30 offset:49664
    v_mfma_f32_16x16x32_bf16 v[160:163], v[68:71], v[40:43], 0
    v_accvgpr_read_b32 v104, a20
    v_accvgpr_read_b32 v105, a21
    v_mfma_f32_16x16x32_bf16 v[164:167], v[72:75], v[40:43], 0
    ds_read_b64_tr_b16 v[88:89], v31 offset:49152
    v_accvgpr_read_b32 v106, a22
    v_mfma_f32_16x16x32_bf16 v[168:171], v[76:79], v[40:43], 0
    v_accvgpr_read_b32 v107, a23
    v_mfma_f32_16x16x32_bf16 v[172:175], v[80:83], v[40:43], 0
    ds_read_b128 v[40:43], v29 offset:4096
    ds_read_b64_tr_b16 v[90:91], v31 offset:49664
    v_mfma_f32_16x16x32_bf16 v[176:179], v[68:71], v[44:47], 0
    buffer_load_dwordx4 v17, s[52:55], s77 offen offset:1024 lds
    v_cvt_pk_bf16_f32 v100, v100, v101
    v_mfma_f32_16x16x32_bf16 v[180:183], v[72:75], v[44:47], 0
    ds_read_b64_tr_b16 v[92:93], v30 offset:57344
    v_cvt_pk_bf16_f32 v101, v102, v103
    v_mfma_f32_16x16x32_bf16 v[184:187], v[76:79], v[44:47], 0
    v_cvt_pk_bf16_f32 v102, v104, v105
    v_cvt_pk_bf16_f32 v103, v106, v107
    v_mfma_f32_16x16x32_bf16 v[188:191], v[80:83], v[44:47], 0
    ds_read_b128 v[44:47], v29 offset:6144
    ds_read_b64_tr_b16 v[94:95], v30 offset:57856
    v_mfma_f32_16x16x32_bf16 v[192:195], v[68:71], v[48:51], 0
    buffer_load_dwordx4 v18, s[52:55], s77 offen offset:2048 lds
    v_mfma_f32_16x16x32_bf16 v[196:199], v[72:75], v[48:51], 0
    ds_read_b64_tr_b16 v[96:97], v31 offset:57344
    v_mfma_f32_16x16x32_bf16 v[200:203], v[76:79], v[48:51], 0
    buffer_store_dwordx4 v[100:103], v14, s[16:19], s32 offen offset:2048 sc1
    v_mfma_f32_16x16x32_bf16 v[204:207], v[80:83], v[48:51], 0
    s_waitcnt lgkmcnt(12)
    ds_read_b128 v[48:51], v29 offset:8192
    ds_read_b64_tr_b16 v[98:99], v31 offset:57856
    v_mfma_f32_16x16x32_bf16 v[208:211], v[68:71], v[52:55], 0
    v_accvgpr_read_b32 v108, a152
    v_accvgpr_read_b32 v109, a153
    v_mfma_f32_16x16x32_bf16 v[212:215], v[72:75], v[52:55], 0
    buffer_load_dwordx4 v19, s[52:55], s77 offen offset:3072 lds
    v_accvgpr_read_b32 v110, a154
    v_mfma_f32_16x16x32_bf16 v[216:219], v[76:79], v[52:55], 0
    v_accvgpr_read_b32 v111, a155
    v_accvgpr_read_b32 v112, a156
    v_mfma_f32_16x16x32_bf16 v[220:223], v[80:83], v[52:55], 0
    ds_read_b128 v[52:55], v29 offset:10240
    v_accvgpr_read_b32 v113, a157
    v_mfma_f32_16x16x32_bf16 v[224:227], v[68:71], v[56:59], 0
    v_accvgpr_read_b32 v114, a158
    v_accvgpr_read_b32 v115, a159
    v_mfma_f32_16x16x32_bf16 v[228:231], v[72:75], v[56:59], 0
    v_cvt_pk_bf16_f32 v108, v108, v109
    v_mfma_f32_16x16x32_bf16 v[232:235], v[76:79], v[56:59], 0
    s_add_u32 s77, s77, 114688
    v_cvt_pk_bf16_f32 v109, v110, v111
    v_mfma_f32_16x16x32_bf16 v[236:239], v[80:83], v[56:59], 0
    ds_read_b128 v[56:59], v29 offset:12288
    v_cvt_pk_bf16_f32 v110, v112, v113
    v_mfma_f32_16x16x32_bf16 v[240:243], v[68:71], v[60:63], 0
    v_cvt_pk_bf16_f32 v111, v114, v115
    v_mfma_f32_16x16x32_bf16 v[244:247], v[72:75], v[60:63], 0
    v_accvgpr_write_b32 a152, v108
    v_mfma_f32_16x16x32_bf16 v[248:251], v[76:79], v[60:63], 0
    v_accvgpr_write_b32 a153, v109
    v_mfma_f32_16x16x32_bf16 v[252:255], v[80:83], v[60:63], 0
    s_waitcnt lgkmcnt(1)
    v_accvgpr_write_b32 a154, v110
    v_mfma_f32_16x16x32_bf16 v[128:131], v[84:87], v[32:35], v[128:131]
    s_waitcnt vmcnt(27)
    v_lshrrev_b32 v6, 3, v1
    v_accvgpr_write_b32 a155, v111
    v_mfma_f32_16x16x32_bf16 v[132:135], v[88:91], v[32:35], v[132:135]
    s_barrier
    v_mfma_f32_16x16x32_bf16 v[136:139], v[92:95], v[32:35], v[136:139]
    s_add_u32 m0, s76, 114688
    ds_read_b128 v[60:63], v28 offset:30720
    v_accvgpr_read_b32 v116, a24
    v_mfma_f32_16x16x32_bf16 v[140:143], v[96:99], v[32:35], v[140:143]
    ds_read_b128 v[32:35], v28 offset:16384
    v_accvgpr_read_b32 v117, a25
    v_mfma_f32_16x16x32_bf16 v[144:147], v[84:87], v[36:39], v[144:147]
    v_accvgpr_read_b32 v118, a26
    v_accvgpr_read_b32 v119, a27
    v_mfma_f32_16x16x32_bf16 v[148:151], v[88:91], v[36:39], v[148:151]
    ds_read_b64_tr_b16 v[68:69], v8 offset:0
    v_accvgpr_read_b32 v120, a28
    v_mfma_f32_16x16x32_bf16 v[152:155], v[92:95], v[36:39], v[152:155]
    buffer_load_dwordx4 v16, s[52:55], s77 offen offset:0 lds
    v_accvgpr_read_b32 v121, a29
    v_mfma_f32_16x16x32_bf16 v[156:159], v[96:99], v[36:39], v[156:159]
    ds_read_b128 v[36:39], v28 offset:18432
    ds_read_b64_tr_b16 v[70:71], v8 offset:512
    v_mfma_f32_16x16x32_bf16 v[160:163], v[84:87], v[40:43], v[160:163]
    v_accvgpr_read_b32 v122, a30
    v_accvgpr_read_b32 v123, a31
    v_mfma_f32_16x16x32_bf16 v[164:167], v[88:91], v[40:43], v[164:167]
    ds_read_b64_tr_b16 v[72:73], v9 offset:0
    v_cvt_pk_bf16_f32 v116, v116, v117
    v_mfma_f32_16x16x32_bf16 v[168:171], v[92:95], v[40:43], v[168:171]
    v_cvt_pk_bf16_f32 v117, v118, v119
    v_mfma_f32_16x16x32_bf16 v[172:175], v[96:99], v[40:43], v[172:175]
    ds_read_b128 v[40:43], v28 offset:20480
    ds_read_b64_tr_b16 v[74:75], v9 offset:512
    v_mfma_f32_16x16x32_bf16 v[176:179], v[84:87], v[44:47], v[176:179]
    buffer_load_dwordx4 v17, s[52:55], s77 offen offset:1024 lds
    v_cvt_pk_bf16_f32 v118, v120, v121
    v_mfma_f32_16x16x32_bf16 v[180:183], v[88:91], v[44:47], v[180:183]
    ds_read_b64_tr_b16 v[76:77], v8 offset:8192
    v_cvt_pk_bf16_f32 v119, v122, v123
    v_mfma_f32_16x16x32_bf16 v[184:187], v[92:95], v[44:47], v[184:187]
    buffer_store_dwordx4 v[116:119], v14, s[16:19], s32 offen offset:3072 sc1
    v_mfma_f32_16x16x32_bf16 v[188:191], v[96:99], v[44:47], v[188:191]
    s_add_u32 s32, s32, 4096
    ds_read_b128 v[44:47], v28 offset:22528
    ds_read_b64_tr_b16 v[78:79], v8 offset:8704
    v_mfma_f32_16x16x32_bf16 v[192:195], v[84:87], v[48:51], v[192:195]
    buffer_load_dwordx4 v18, s[52:55], s77 offen offset:2048 lds
    v_accvgpr_read_b32 v100, a160
    v_mfma_f32_16x16x32_bf16 v[196:199], v[88:91], v[48:51], v[196:199]
    ds_read_b64_tr_b16 v[80:81], v9 offset:8192
    v_accvgpr_read_b32 v101, a161
    v_mfma_f32_16x16x32_bf16 v[200:203], v[92:95], v[48:51], v[200:203]
    v_accvgpr_read_b32 v102, a162
    v_mfma_f32_16x16x32_bf16 v[204:207], v[96:99], v[48:51], v[204:207]
    s_waitcnt lgkmcnt(12)
    ds_read_b128 v[48:51], v28 offset:24576
    ds_read_b64_tr_b16 v[82:83], v9 offset:8704
    v_mfma_f32_16x16x32_bf16 v[208:211], v[84:87], v[52:55], v[208:211]
    v_and_b32 v7, 6, v6
    v_accvgpr_read_b32 v103, a163
    v_mfma_f32_16x16x32_bf16 v[212:215], v[88:91], v[52:55], v[212:215]
    buffer_load_dwordx4 v19, s[52:55], s77 offen offset:3072 lds
    v_accvgpr_read_b32 v104, a164
    v_mfma_f32_16x16x32_bf16 v[216:219], v[92:95], v[52:55], v[216:219]
    v_accvgpr_read_b32 v105, a165
    v_accvgpr_read_b32 v106, a166
    v_mfma_f32_16x16x32_bf16 v[220:223], v[96:99], v[52:55], v[220:223]
    ds_read_b128 v[52:55], v28 offset:26624
    v_accvgpr_read_b32 v107, a167
    v_mfma_f32_16x16x32_bf16 v[224:227], v[84:87], v[56:59], v[224:227]
    v_cvt_pk_bf16_f32 v100, v100, v101
    v_mfma_f32_16x16x32_bf16 v[228:231], v[88:91], v[56:59], v[228:231]
    v_cvt_pk_bf16_f32 v101, v102, v103
    v_mfma_f32_16x16x32_bf16 v[232:235], v[92:95], v[56:59], v[232:235]
    s_add_u32 s77, s77, 114688
    v_cvt_pk_bf16_f32 v102, v104, v105
    v_mfma_f32_16x16x32_bf16 v[236:239], v[96:99], v[56:59], v[236:239]
    ds_read_b128 v[56:59], v28 offset:28672
    v_cvt_pk_bf16_f32 v103, v106, v107
    v_mfma_f32_16x16x32_bf16 v[240:243], v[84:87], v[64:67], v[240:243]
    v_accvgpr_write_b32 a160, v100
    v_mfma_f32_16x16x32_bf16 v[244:247], v[88:91], v[64:67], v[244:247]
    v_accvgpr_write_b32 a161, v101
    v_mfma_f32_16x16x32_bf16 v[248:251], v[92:95], v[64:67], v[248:251]
    v_accvgpr_write_b32 a162, v102
    v_mfma_f32_16x16x32_bf16 v[252:255], v[96:99], v[64:67], v[252:255]
    s_waitcnt lgkmcnt(1)
    v_accvgpr_write_b32 a163, v103
    v_mfma_f32_16x16x32_bf16 v[128:131], v[68:71], v[32:35], v[128:131]
    s_waitcnt vmcnt(24)
    v_accvgpr_read_b32 v108, a32
    v_mfma_f32_16x16x32_bf16 v[132:135], v[72:75], v[32:35], v[132:135]
    s_barrier
    v_mfma_f32_16x16x32_bf16 v[136:139], v[76:79], v[32:35], v[136:139]
    s_add_u32 m0, s76, 131072
    ds_read_b128 v[64:67], v29 offset:30720
    v_accvgpr_read_b32 v109, a33
    v_mfma_f32_16x16x32_bf16 v[140:143], v[80:83], v[32:35], v[140:143]
    ds_read_b128 v[32:35], v29 offset:16384
    v_accvgpr_read_b32 v110, a34
    v_mfma_f32_16x16x32_bf16 v[144:147], v[68:71], v[36:39], v[144:147]
    v_accvgpr_read_b32 v111, a35
    v_accvgpr_read_b32 v112, a36
    v_mfma_f32_16x16x32_bf16 v[148:151], v[72:75], v[36:39], v[148:151]
    ds_read_b64_tr_b16 v[84:85], v8 offset:16384
    buffer_load_dwordx4 v16, s[52:55], s77 offen offset:0 lds
    v_mfma_f32_16x16x32_bf16 v[152:155], v[76:79], v[36:39], v[152:155]
    v_accvgpr_read_b32 v113, a37
    v_accvgpr_read_b32 v114, a38
    v_mfma_f32_16x16x32_bf16 v[156:159], v[80:83], v[36:39], v[156:159]
    ds_read_b128 v[36:39], v29 offset:18432
    ds_read_b64_tr_b16 v[86:87], v8 offset:16896
    v_mfma_f32_16x16x32_bf16 v[160:163], v[68:71], v[40:43], v[160:163]
    buffer_load_dwordx4 v17, s[52:55], s77 offen offset:1024 lds
    v_mul_u32_u24 v6, 896, v6
    v_mfma_f32_16x16x32_bf16 v[164:167], v[72:75], v[40:43], v[164:167]
    ds_read_b64_tr_b16 v[88:89], v9 offset:16384
    v_accvgpr_read_b32 v115, a39
    v_mfma_f32_16x16x32_bf16 v[168:171], v[76:79], v[40:43], v[168:171]
    v_cvt_pk_bf16_f32 v108, v108, v109
    v_cvt_pk_bf16_f32 v109, v110, v111
    v_mfma_f32_16x16x32_bf16 v[172:175], v[80:83], v[40:43], v[172:175]
    ds_read_b128 v[40:43], v29 offset:20480
    ds_read_b64_tr_b16 v[90:91], v9 offset:16896
    v_mfma_f32_16x16x32_bf16 v[176:179], v[68:71], v[44:47], v[176:179]
    buffer_load_dwordx4 v18, s[52:55], s77 offen offset:2048 lds
    v_cvt_pk_bf16_f32 v110, v112, v113
    v_mfma_f32_16x16x32_bf16 v[180:183], v[72:75], v[44:47], v[180:183]
    ds_read_b64_tr_b16 v[92:93], v8 offset:24576
    v_cvt_pk_bf16_f32 v111, v114, v115
    v_mfma_f32_16x16x32_bf16 v[184:187], v[76:79], v[44:47], v[184:187]
    buffer_load_dwordx4 v19, s[52:55], s77 offen offset:3072 lds
    v_mfma_f32_16x16x32_bf16 v[188:191], v[80:83], v[44:47], v[188:191]
    ds_read_b128 v[44:47], v29 offset:22528
    ds_read_b64_tr_b16 v[94:95], v8 offset:25088
    v_mfma_f32_16x16x32_bf16 v[192:195], v[68:71], v[48:51], v[192:195]
    buffer_store_dwordx4 v[108:111], v14, s[16:19], s32 offen offset:0 sc1
    v_mfma_f32_16x16x32_bf16 v[196:199], v[72:75], v[48:51], v[196:199]
    ds_read_b64_tr_b16 v[96:97], v9 offset:24576
    v_accvgpr_read_b32 v116, a168
    v_mfma_f32_16x16x32_bf16 v[200:203], v[76:79], v[48:51], v[200:203]
    s_add_u32 s77, s77, 114688
    v_accvgpr_read_b32 v117, a169
    v_accvgpr_read_b32 v118, a170
    v_mfma_f32_16x16x32_bf16 v[204:207], v[80:83], v[48:51], v[204:207]
    s_waitcnt lgkmcnt(12)
    ds_read_b128 v[48:51], v29 offset:24576
    ds_read_b64_tr_b16 v[98:99], v9 offset:25088
    v_mfma_f32_16x16x32_bf16 v[208:211], v[68:71], v[52:55], v[208:211]
    v_accvgpr_read_b32 v119, a171
    v_accvgpr_read_b32 v120, a172
    v_mfma_f32_16x16x32_bf16 v[212:215], v[72:75], v[52:55], v[212:215]
    s_add_u32 m0, s76, 0
    v_accvgpr_read_b32 v121, a173
    v_accvgpr_read_b32 v122, a174
    v_mfma_f32_16x16x32_bf16 v[216:219], v[76:79], v[52:55], v[216:219]
    v_accvgpr_read_b32 v123, a175
    v_mfma_f32_16x16x32_bf16 v[220:223], v[80:83], v[52:55], v[220:223]
    ds_read_b128 v[52:55], v29 offset:26624
    v_cvt_pk_bf16_f32 v116, v116, v117
    v_mfma_f32_16x16x32_bf16 v[224:227], v[68:71], v[56:59], v[224:227]
    buffer_load_dwordx4 v20, s[16:19], s26 offen offset:0 sc1 lds
    v_cvt_pk_bf16_f32 v117, v118, v119
    v_mfma_f32_16x16x32_bf16 v[228:231], v[72:75], v[56:59], v[228:231]
    v_cvt_pk_bf16_f32 v118, v120, v121
    v_cvt_pk_bf16_f32 v119, v122, v123
    v_mfma_f32_16x16x32_bf16 v[232:235], v[76:79], v[56:59], v[232:235]
    v_accvgpr_write_b32 a168, v116
    v_accvgpr_write_b32 a169, v117
    v_mfma_f32_16x16x32_bf16 v[236:239], v[80:83], v[56:59], v[236:239]
    ds_read_b128 v[56:59], v29 offset:28672
    buffer_load_dwordx4 v21, s[16:19], s26 offen offset:1024 sc1 lds
    v_mfma_f32_16x16x32_bf16 v[240:243], v[68:71], v[60:63], v[240:243]
    v_accvgpr_write_b32 a170, v118
    v_accvgpr_write_b32 a171, v119
    v_mfma_f32_16x16x32_bf16 v[244:247], v[72:75], v[60:63], v[244:247]
    v_xor_b32 v7, v7, v1
    v_accvgpr_read_b32 v100, a40
    v_mfma_f32_16x16x32_bf16 v[248:251], v[76:79], v[60:63], v[248:251]
    v_accvgpr_read_b32 v101, a41
    v_mfma_f32_16x16x32_bf16 v[252:255], v[80:83], v[60:63], v[252:255]
    s_waitcnt lgkmcnt(1)
    v_accvgpr_read_b32 v102, a42
    v_mfma_f32_16x16x32_bf16 v[128:131], v[84:87], v[32:35], v[128:131]
    s_waitcnt vmcnt(22)
    v_accvgpr_read_b32 v103, a43
    v_mfma_f32_16x16x32_bf16 v[132:135], v[88:91], v[32:35], v[132:135]
    s_barrier
    v_mfma_f32_16x16x32_bf16 v[136:139], v[92:95], v[32:35], v[136:139]
    s_add_u32 m0, s76, 147456
    ds_read_b128 v[60:63], v28 offset:47104
    v_accvgpr_read_b32 v104, a44
    v_mfma_f32_16x16x32_bf16 v[140:143], v[96:99], v[32:35], v[140:143]
    ds_read_b128 v[32:35], v28 offset:32768
    v_accvgpr_read_b32 v105, a45
    v_mfma_f32_16x16x32_bf16 v[144:147], v[84:87], v[36:39], v[144:147]
    buffer_load_dwordx4 v16, s[52:55], s77 offen offset:0 lds
    v_accvgpr_read_b32 v106, a46
    v_mfma_f32_16x16x32_bf16 v[148:151], v[88:91], v[36:39], v[148:151]
    ds_read_b64_tr_b16 v[68:69], v30 offset:0
    v_accvgpr_read_b32 v107, a47
    v_mfma_f32_16x16x32_bf16 v[152:155], v[92:95], v[36:39], v[152:155]
    v_cvt_pk_bf16_f32 v100, v100, v101
    v_cvt_pk_bf16_f32 v101, v102, v103
    v_mfma_f32_16x16x32_bf16 v[156:159], v[96:99], v[36:39], v[156:159]
    ds_read_b128 v[36:39], v28 offset:34816
    ds_read_b64_tr_b16 v[70:71], v30 offset:512
    v_mfma_f32_16x16x32_bf16 v[160:163], v[84:87], v[40:43], v[160:163]
    buffer_load_dwordx4 v17, s[52:55], s77 offen offset:1024 lds
    v_cvt_pk_bf16_f32 v102, v104, v105
    v_mfma_f32_16x16x32_bf16 v[164:167], v[88:91], v[40:43], v[164:167]
    ds_read_b64_tr_b16 v[72:73], v31 offset:0
    v_cvt_pk_bf16_f32 v103, v106, v107
    v_mfma_f32_16x16x32_bf16 v[168:171], v[92:95], v[40:43], v[168:171]
    buffer_load_dwordx4 v18, s[52:55], s77 offen offset:2048 lds
    v_mfma_f32_16x16x32_bf16 v[172:175], v[96:99], v[40:43], v[172:175]
    ds_read_b128 v[40:43], v28 offset:36864
    ds_read_b64_tr_b16 v[74:75], v31 offset:512
    v_mfma_f32_16x16x32_bf16 v[176:179], v[84:87], v[44:47], v[176:179]
    buffer_store_dwordx4 v[100:103], v14, s[16:19], s32 offen offset:1024 sc1
    v_mfma_f32_16x16x32_bf16 v[180:183], v[88:91], v[44:47], v[180:183]
    ds_read_b64_tr_b16 v[76:77], v30 offset:8192
    buffer_load_dwordx4 v19, s[52:55], s77 offen offset:3072 lds
    v_mfma_f32_16x16x32_bf16 v[184:187], v[92:95], v[44:47], v[184:187]
    v_accvgpr_read_b32 v108, a48
    v_accvgpr_read_b32 v109, a49
    v_mfma_f32_16x16x32_bf16 v[188:191], v[96:99], v[44:47], v[188:191]
    ds_read_b128 v[44:47], v28 offset:38912
    ds_read_b64_tr_b16 v[78:79], v30 offset:8704
    v_mfma_f32_16x16x32_bf16 v[192:195], v[84:87], v[48:51], v[192:195]
    s_add_u32 s77, s77, 114688
    v_accvgpr_read_b32 v110, a50
    v_accvgpr_read_b32 v111, a51
    v_mfma_f32_16x16x32_bf16 v[196:199], v[88:91], v[48:51], v[196:199]
    ds_read_b64_tr_b16 v[80:81], v31 offset:8192
    v_and_b32 v7, 7, v7
    v_mfma_f32_16x16x32_bf16 v[200:203], v[92:95], v[48:51], v[200:203]
    v_accvgpr_read_b32 v112, a52
    v_accvgpr_read_b32 v113, a53
    v_mfma_f32_16x16x32_bf16 v[204:207], v[96:99], v[48:51], v[204:207]
    s_waitcnt lgkmcnt(12)
    ds_read_b128 v[48:51], v28 offset:40960
    ds_read_b64_tr_b16 v[82:83], v31 offset:8704
    v_mfma_f32_16x16x32_bf16 v[208:211], v[84:87], v[52:55], v[208:211]
    s_add_u32 m0, s76, 0
    v_accvgpr_read_b32 v114, a54
    v_accvgpr_read_b32 v115, a55
    v_mfma_f32_16x16x32_bf16 v[212:215], v[88:91], v[52:55], v[212:215]
    v_cvt_pk_bf16_f32 v108, v108, v109
    v_cvt_pk_bf16_f32 v109, v110, v111
    v_mfma_f32_16x16x32_bf16 v[216:219], v[92:95], v[52:55], v[216:219]
    buffer_load_dwordx4 v22, s[16:19], s26 offen offset:2048 sc1 lds
    v_cvt_pk_bf16_f32 v110, v112, v113
    v_mfma_f32_16x16x32_bf16 v[220:223], v[96:99], v[52:55], v[220:223]
    ds_read_b128 v[52:55], v28 offset:43008
    v_cvt_pk_bf16_f32 v111, v114, v115
    v_mfma_f32_16x16x32_bf16 v[224:227], v[84:87], v[56:59], v[224:227]
    buffer_store_dwordx4 v[108:111], v14, s[16:19], s32 offen offset:2048 sc1
    v_mfma_f32_16x16x32_bf16 v[228:231], v[88:91], v[56:59], v[228:231]
    buffer_load_dwordx4 v23, s[16:19], s26 offen offset:3072 sc1 lds
    v_accvgpr_read_b32 v116, a176
    v_mfma_f32_16x16x32_bf16 v[232:235], v[92:95], v[56:59], v[232:235]
    v_accvgpr_read_b32 v117, a177
    v_mfma_f32_16x16x32_bf16 v[236:239], v[96:99], v[56:59], v[236:239]
    ds_read_b128 v[56:59], v28 offset:45056
    v_accvgpr_read_b32 v118, a178
    v_mfma_f32_16x16x32_bf16 v[240:243], v[84:87], v[64:67], v[240:243]
    s_add_u32 s26, s26, 128
    v_accvgpr_read_b32 v119, a179
    v_mfma_f32_16x16x32_bf16 v[244:247], v[88:91], v[64:67], v[244:247]
    v_accvgpr_read_b32 v120, a180
    v_mfma_f32_16x16x32_bf16 v[248:251], v[92:95], v[64:67], v[248:251]
    v_accvgpr_read_b32 v121, a181
    v_mfma_f32_16x16x32_bf16 v[252:255], v[96:99], v[64:67], v[252:255]
    s_waitcnt lgkmcnt(1)
    v_accvgpr_read_b32 v122, a182
    v_mfma_f32_16x16x32_bf16 v[128:131], v[68:71], v[32:35], v[128:131]
    s_waitcnt vmcnt(26)
    v_accvgpr_read_b32 v123, a183
    v_mfma_f32_16x16x32_bf16 v[132:135], v[72:75], v[32:35], v[132:135]
    s_barrier
    v_mfma_f32_16x16x32_bf16 v[136:139], v[76:79], v[32:35], v[136:139]
    s_add_u32 m0, s76, 65536
    ds_read_b128 v[64:67], v29 offset:47104
    v_cvt_pk_bf16_f32 v116, v116, v117
    v_mfma_f32_16x16x32_bf16 v[140:143], v[80:83], v[32:35], v[140:143]
    ds_read_b128 v[32:35], v29 offset:32768
    v_cvt_pk_bf16_f32 v117, v118, v119
    v_mfma_f32_16x16x32_bf16 v[144:147], v[68:71], v[36:39], v[144:147]
    v_cvt_pk_bf16_f32 v118, v120, v121
    v_cvt_pk_bf16_f32 v119, v122, v123
    v_mfma_f32_16x16x32_bf16 v[148:151], v[72:75], v[36:39], v[148:151]
    ds_read_b64_tr_b16 v[84:85], v30 offset:16384
    buffer_load_dwordx4 v16, s[52:55], s77 offen offset:0 lds
    v_mfma_f32_16x16x32_bf16 v[152:155], v[76:79], v[36:39], v[152:155]
    v_lshl_add_u32 v6, v7, 4, v6
    v_accvgpr_write_b32 a176, v116
    v_mfma_f32_16x16x32_bf16 v[156:159], v[80:83], v[36:39], v[156:159]
    ds_read_b128 v[36:39], v29 offset:34816
    ds_read_b64_tr_b16 v[86:87], v30 offset:16896
    v_mfma_f32_16x16x32_bf16 v[160:163], v[68:71], v[40:43], v[160:163]
    buffer_load_dwordx4 v17, s[52:55], s77 offen offset:1024 lds
    v_accvgpr_write_b32 a177, v117
    v_mfma_f32_16x16x32_bf16 v[164:167], v[72:75], v[40:43], v[164:167]
    ds_read_b64_tr_b16 v[88:89], v31 offset:16384
    v_accvgpr_write_b32 a178, v118
    v_mfma_f32_16x16x32_bf16 v[168:171], v[76:79], v[40:43], v[168:171]
    v_accvgpr_write_b32 a179, v119
    v_accvgpr_read_b32 v100, a56
    v_mfma_f32_16x16x32_bf16 v[172:175], v[80:83], v[40:43], v[172:175]
    ds_read_b128 v[40:43], v29 offset:36864
    ds_read_b64_tr_b16 v[90:91], v31 offset:16896
    v_mfma_f32_16x16x32_bf16 v[176:179], v[68:71], v[44:47], v[176:179]
    buffer_load_dwordx4 v18, s[52:55], s77 offen offset:2048 lds
    v_accvgpr_read_b32 v101, a57
    v_mfma_f32_16x16x32_bf16 v[180:183], v[72:75], v[44:47], v[180:183]
    ds_read_b64_tr_b16 v[92:93], v30 offset:24576
    v_accvgpr_read_b32 v102, a58
    v_mfma_f32_16x16x32_bf16 v[184:187], v[76:79], v[44:47], v[184:187]
    buffer_load_dwordx4 v19, s[52:55], s77 offen offset:3072 lds
    v_accvgpr_read_b32 v103, a59
    v_mfma_f32_16x16x32_bf16 v[188:191], v[80:83], v[44:47], v[188:191]
    ds_read_b128 v[44:47], v29 offset:38912
    ds_read_b64_tr_b16 v[94:95], v30 offset:25088
    v_mfma_f32_16x16x32_bf16 v[192:195], v[68:71], v[48:51], v[192:195]
    v_accvgpr_read_b32 v104, a60
    v_accvgpr_read_b32 v105, a61
    v_mfma_f32_16x16x32_bf16 v[196:199], v[72:75], v[48:51], v[196:199]
    ds_read_b64_tr_b16 v[96:97], v31 offset:24576
    v_accvgpr_read_b32 v106, a62
    v_mfma_f32_16x16x32_bf16 v[200:203], v[76:79], v[48:51], v[200:203]
    s_add_u32 s77, s77, 114688
    v_accvgpr_read_b32 v107, a63
    v_mfma_f32_16x16x32_bf16 v[204:207], v[80:83], v[48:51], v[204:207]
    s_waitcnt lgkmcnt(12)
    ds_read_b128 v[48:51], v29 offset:40960
    ds_read_b64_tr_b16 v[98:99], v31 offset:25088
    v_mfma_f32_16x16x32_bf16 v[208:211], v[68:71], v[52:55], v[208:211]
    v_cvt_pk_bf16_f32 v100, v100, v101
    v_cvt_pk_bf16_f32 v101, v102, v103
    v_mfma_f32_16x16x32_bf16 v[212:215], v[72:75], v[52:55], v[212:215]
    s_add_u32 m0, s76, 16384
    v_cvt_pk_bf16_f32 v102, v104, v105
    v_cvt_pk_bf16_f32 v103, v106, v107
    v_mfma_f32_16x16x32_bf16 v[216:219], v[76:79], v[52:55], v[216:219]
    buffer_store_dwordx4 v[100:103], v14, s[16:19], s32 offen offset:3072 sc1
    v_mfma_f32_16x16x32_bf16 v[220:223], v[80:83], v[52:55], v[220:223]
    s_add_u32 s32, s32, 12288
    ds_read_b128 v[52:55], v29 offset:43008
    v_mfma_f32_16x16x32_bf16 v[224:227], v[68:71], v[56:59], v[224:227]
    buffer_load_dwordx4 v20, s[16:19], s26 offen offset:0 sc1 lds
    v_accvgpr_read_b32 v108, a184
    v_mfma_f32_16x16x32_bf16 v[228:231], v[72:75], v[56:59], v[228:231]
    v_accvgpr_read_b32 v109, a185
    v_accvgpr_read_b32 v110, a186
    v_mfma_f32_16x16x32_bf16 v[232:235], v[76:79], v[56:59], v[232:235]
    s_mul_i32 s30, s20, 28672
    v_accvgpr_read_b32 v111, a187
    v_mfma_f32_16x16x32_bf16 v[236:239], v[80:83], v[56:59], v[236:239]
    ds_read_b128 v[56:59], v29 offset:45056
    buffer_load_dwordx4 v21, s[16:19], s26 offen offset:1024 sc1 lds
    v_mfma_f32_16x16x32_bf16 v[240:243], v[68:71], v[60:63], v[240:243]
    v_accvgpr_read_b32 v112, a188
    v_accvgpr_read_b32 v113, a189
    v_mfma_f32_16x16x32_bf16 v[244:247], v[72:75], v[60:63], v[244:247]
    v_accvgpr_read_b32 v114, a190
    v_mfma_f32_16x16x32_bf16 v[248:251], v[76:79], v[60:63], v[248:251]
    v_accvgpr_read_b32 v115, a191
    v_mfma_f32_16x16x32_bf16 v[252:255], v[80:83], v[60:63], v[252:255]
    s_waitcnt lgkmcnt(1)
    v_cvt_pk_bf16_f32 v108, v108, v109
    v_mfma_f32_16x16x32_bf16 v[128:131], v[84:87], v[32:35], v[128:131]
    s_waitcnt vmcnt(27)
    v_cvt_pk_bf16_f32 v109, v110, v111
    v_mfma_f32_16x16x32_bf16 v[132:135], v[88:91], v[32:35], v[132:135]
    s_barrier
    v_mfma_f32_16x16x32_bf16 v[136:139], v[92:95], v[32:35], v[136:139]
    s_add_u32 m0, s76, 81920
    ds_read_b128 v[60:63], v28 offset:63488
    v_cvt_pk_bf16_f32 v110, v112, v113
    v_mfma_f32_16x16x32_bf16 v[140:143], v[96:99], v[32:35], v[140:143]
    ds_read_b128 v[32:35], v28 offset:49152
    v_cvt_pk_bf16_f32 v111, v114, v115
    v_mfma_f32_16x16x32_bf16 v[144:147], v[84:87], v[36:39], v[144:147]
    buffer_load_dwordx4 v16, s[52:55], s77 offen offset:0 lds
    v_accvgpr_write_b32 a184, v108
    v_mfma_f32_16x16x32_bf16 v[148:151], v[88:91], v[36:39], v[148:151]
    ds_read_b64_tr_b16 v[68:69], v30 offset:32768
    v_accvgpr_write_b32 a185, v109
    v_mfma_f32_16x16x32_bf16 v[152:155], v[92:95], v[36:39], v[152:155]
    v_accvgpr_write_b32 a186, v110
    v_accvgpr_write_b32 a187, v111
    v_mfma_f32_16x16x32_bf16 v[156:159], v[96:99], v[36:39], v[156:159]
    ds_read_b128 v[36:39], v28 offset:51200
    ds_read_b64_tr_b16 v[70:71], v30 offset:33280
    v_mfma_f32_16x16x32_bf16 v[160:163], v[84:87], v[40:43], v[160:163]
    buffer_load_dwordx4 v17, s[52:55], s77 offen offset:1024 lds
    v_accvgpr_read_b32 v116, a64
    v_mfma_f32_16x16x32_bf16 v[164:167], v[88:91], v[40:43], v[164:167]
    ds_read_b64_tr_b16 v[72:73], v31 offset:32768
    v_accvgpr_read_b32 v117, a65
    v_mfma_f32_16x16x32_bf16 v[168:171], v[92:95], v[40:43], v[168:171]
    buffer_load_dwordx4 v18, s[52:55], s77 offen offset:2048 lds
    v_accvgpr_read_b32 v118, a66
    v_mfma_f32_16x16x32_bf16 v[172:175], v[96:99], v[40:43], v[172:175]
    ds_read_b128 v[40:43], v28 offset:53248
    ds_read_b64_tr_b16 v[74:75], v31 offset:33280
    v_mfma_f32_16x16x32_bf16 v[176:179], v[84:87], v[44:47], v[176:179]
    v_accvgpr_read_b32 v119, a67
    v_accvgpr_read_b32 v120, a68
    v_mfma_f32_16x16x32_bf16 v[180:183], v[88:91], v[44:47], v[180:183]
    ds_read_b64_tr_b16 v[76:77], v30 offset:40960
    buffer_load_dwordx4 v19, s[52:55], s77 offen offset:3072 lds
    v_mfma_f32_16x16x32_bf16 v[184:187], v[92:95], v[44:47], v[184:187]
    v_accvgpr_read_b32 v121, a69
    v_accvgpr_read_b32 v122, a70
    v_mfma_f32_16x16x32_bf16 v[188:191], v[96:99], v[44:47], v[188:191]
    ds_read_b128 v[44:47], v28 offset:55296
    ds_read_b64_tr_b16 v[78:79], v30 offset:41472
    v_mfma_f32_16x16x32_bf16 v[192:195], v[84:87], v[48:51], v[192:195]
    s_add_u32 s77, s77, 114688
    v_add_u32 v10, s30, v6
    v_accvgpr_read_b32 v123, a71
    v_mfma_f32_16x16x32_bf16 v[196:199], v[88:91], v[48:51], v[196:199]
    ds_read_b64_tr_b16 v[80:81], v31 offset:40960
    v_cvt_pk_bf16_f32 v116, v116, v117
    v_mfma_f32_16x16x32_bf16 v[200:203], v[92:95], v[48:51], v[200:203]
    v_cvt_pk_bf16_f32 v117, v118, v119
    v_cvt_pk_bf16_f32 v118, v120, v121
    v_mfma_f32_16x16x32_bf16 v[204:207], v[96:99], v[48:51], v[204:207]
    s_waitcnt lgkmcnt(12)
    ds_read_b128 v[48:51], v28 offset:57344
    ds_read_b64_tr_b16 v[82:83], v31 offset:41472
    v_mfma_f32_16x16x32_bf16 v[208:211], v[84:87], v[52:55], v[208:211]
    s_add_u32 m0, s76, 16384
    v_cvt_pk_bf16_f32 v119, v122, v123
    v_mfma_f32_16x16x32_bf16 v[212:215], v[88:91], v[52:55], v[212:215]
    buffer_store_dwordx4 v[116:119], v14, s[16:19], s32 offen offset:0 sc1
    v_mfma_f32_16x16x32_bf16 v[216:219], v[92:95], v[52:55], v[216:219]
    buffer_load_dwordx4 v22, s[16:19], s26 offen offset:2048 sc1 lds
    v_accvgpr_read_b32 v100, a192
    v_mfma_f32_16x16x32_bf16 v[220:223], v[96:99], v[52:55], v[220:223]
    ds_read_b128 v[52:55], v28 offset:59392
    v_accvgpr_read_b32 v101, a193
    v_mfma_f32_16x16x32_bf16 v[224:227], v[84:87], v[56:59], v[224:227]
    v_accvgpr_read_b32 v102, a194
    v_accvgpr_read_b32 v103, a195
    v_mfma_f32_16x16x32_bf16 v[228:231], v[88:91], v[56:59], v[228:231]
    buffer_load_dwordx4 v23, s[16:19], s26 offen offset:3072 sc1 lds
    v_accvgpr_read_b32 v104, a196
    v_mfma_f32_16x16x32_bf16 v[232:235], v[92:95], v[56:59], v[232:235]
    v_accvgpr_read_b32 v105, a197
    v_mfma_f32_16x16x32_bf16 v[236:239], v[96:99], v[56:59], v[236:239]
    ds_read_b128 v[56:59], v28 offset:61440
    v_accvgpr_read_b32 v106, a198
    v_mfma_f32_16x16x32_bf16 v[240:243], v[84:87], v[64:67], v[240:243]
    s_add_u32 s26, s26, 128
    v_accvgpr_read_b32 v107, a199
    v_mfma_f32_16x16x32_bf16 v[244:247], v[88:91], v[64:67], v[244:247]
    v_cvt_pk_bf16_f32 v100, v100, v101
    v_mfma_f32_16x16x32_bf16 v[248:251], v[92:95], v[64:67], v[248:251]
    v_cvt_pk_bf16_f32 v101, v102, v103
    v_mfma_f32_16x16x32_bf16 v[252:255], v[96:99], v[64:67], v[252:255]
    s_waitcnt lgkmcnt(1)
    v_cvt_pk_bf16_f32 v102, v104, v105
    v_mfma_f32_16x16x32_bf16 v[128:131], v[68:71], v[32:35], v[128:131]
    s_waitcnt vmcnt(29)
    v_cvt_pk_bf16_f32 v103, v106, v107
    v_mfma_f32_16x16x32_bf16 v[132:135], v[72:75], v[32:35], v[132:135]
    s_barrier
    v_mfma_f32_16x16x32_bf16 v[136:139], v[76:79], v[32:35], v[136:139]
    s_add_u32 m0, s76, 98304
    ds_read_b128 v[64:67], v29 offset:63488
    v_accvgpr_write_b32 a192, v100
    v_mfma_f32_16x16x32_bf16 v[140:143], v[80:83], v[32:35], v[140:143]
    ds_read_b128 v[32:35], v29 offset:49152
    v_add_u32 v11, 6144, v10
    v_mfma_f32_16x16x32_bf16 v[144:147], v[68:71], v[36:39], v[144:147]
    v_accvgpr_write_b32 a193, v101
    v_accvgpr_write_b32 a194, v102
    v_mfma_f32_16x16x32_bf16 v[148:151], v[72:75], v[36:39], v[148:151]
    ds_read_b64_tr_b16 v[84:85], v30 offset:49152
    buffer_load_dwordx4 v16, s[52:55], s77 offen offset:0 lds
    v_mfma_f32_16x16x32_bf16 v[152:155], v[76:79], v[36:39], v[152:155]
    v_accvgpr_write_b32 a195, v103
    v_accvgpr_read_b32 v108, a72
    v_mfma_f32_16x16x32_bf16 v[156:159], v[80:83], v[36:39], v[156:159]
    ds_read_b128 v[36:39], v29 offset:51200
    ds_read_b64_tr_b16 v[86:87], v30 offset:49664
    v_mfma_f32_16x16x32_bf16 v[160:163], v[68:71], v[40:43], v[160:163]
    buffer_load_dwordx4 v17, s[52:55], s77 offen offset:1024 lds
    v_accvgpr_read_b32 v109, a73
    v_mfma_f32_16x16x32_bf16 v[164:167], v[72:75], v[40:43], v[164:167]
    ds_read_b64_tr_b16 v[88:89], v31 offset:49152
    v_accvgpr_read_b32 v110, a74
    v_mfma_f32_16x16x32_bf16 v[168:171], v[76:79], v[40:43], v[168:171]
    v_accvgpr_read_b32 v111, a75
    v_accvgpr_read_b32 v112, a76
    v_mfma_f32_16x16x32_bf16 v[172:175], v[80:83], v[40:43], v[172:175]
    ds_read_b128 v[40:43], v29 offset:53248
    ds_read_b64_tr_b16 v[90:91], v31 offset:49664
    v_mfma_f32_16x16x32_bf16 v[176:179], v[68:71], v[44:47], v[176:179]
    buffer_load_dwordx4 v18, s[52:55], s77 offen offset:2048 lds
    v_accvgpr_read_b32 v113, a77
    v_mfma_f32_16x16x32_bf16 v[180:183], v[72:75], v[44:47], v[180:183]
    ds_read_b64_tr_b16 v[92:93], v30 offset:57344
    v_accvgpr_read_b32 v114, a78
    v_mfma_f32_16x16x32_bf16 v[184:187], v[76:79], v[44:47], v[184:187]
    buffer_load_dwordx4 v19, s[52:55], s77 offen offset:3072 lds
    v_accvgpr_read_b32 v115, a79
    v_mfma_f32_16x16x32_bf16 v[188:191], v[80:83], v[44:47], v[188:191]
    ds_read_b128 v[44:47], v29 offset:55296
    ds_read_b64_tr_b16 v[94:95], v30 offset:57856
    v_mfma_f32_16x16x32_bf16 v[192:195], v[68:71], v[48:51], v[192:195]
    v_cvt_pk_bf16_f32 v108, v108, v109
    v_cvt_pk_bf16_f32 v109, v110, v111
    v_mfma_f32_16x16x32_bf16 v[196:199], v[72:75], v[48:51], v[196:199]
    ds_read_b64_tr_b16 v[96:97], v31 offset:57344
    v_cvt_pk_bf16_f32 v110, v112, v113
    v_mfma_f32_16x16x32_bf16 v[200:203], v[76:79], v[48:51], v[200:203]
    s_add_u32 s77, s77, 114688
    v_cvt_pk_bf16_f32 v111, v114, v115
    v_mfma_f32_16x16x32_bf16 v[204:207], v[80:83], v[48:51], v[204:207]
    s_waitcnt lgkmcnt(12)
    ds_read_b128 v[48:51], v29 offset:57344
    ds_read_b64_tr_b16 v[98:99], v31 offset:57856
    v_mfma_f32_16x16x32_bf16 v[208:211], v[68:71], v[52:55], v[208:211]
    buffer_store_dwordx4 v[108:111], v14, s[16:19], s32 offen offset:1024 sc1
    v_mfma_f32_16x16x32_bf16 v[212:215], v[72:75], v[52:55], v[212:215]
    s_add_u32 m0, s76, 32768
    v_accvgpr_read_b32 v116, a200
    v_accvgpr_read_b32 v117, a201
    v_mfma_f32_16x16x32_bf16 v[216:219], v[76:79], v[52:55], v[216:219]
    v_accvgpr_read_b32 v118, a202
    v_accvgpr_read_b32 v119, a203
    v_mfma_f32_16x16x32_bf16 v[220:223], v[80:83], v[52:55], v[220:223]
    ds_read_b128 v[52:55], v29 offset:59392
    v_accvgpr_read_b32 v120, a204
    v_mfma_f32_16x16x32_bf16 v[224:227], v[68:71], v[56:59], v[224:227]
    buffer_load_dwordx4 v20, s[16:19], s26 offen offset:0 sc1 lds
    v_add_u32 v12, 12288, v10
    v_mfma_f32_16x16x32_bf16 v[228:231], v[72:75], v[56:59], v[228:231]
    v_accvgpr_read_b32 v121, a205
    v_accvgpr_read_b32 v122, a206
    v_mfma_f32_16x16x32_bf16 v[232:235], v[76:79], v[56:59], v[232:235]
    v_accvgpr_read_b32 v123, a207
    v_mfma_f32_16x16x32_bf16 v[236:239], v[80:83], v[56:59], v[236:239]
    ds_read_b128 v[56:59], v29 offset:61440
    buffer_load_dwordx4 v21, s[16:19], s26 offen offset:1024 sc1 lds
    v_mfma_f32_16x16x32_bf16 v[240:243], v[68:71], v[60:63], v[240:243]
    v_cvt_pk_bf16_f32 v116, v116, v117
    v_cvt_pk_bf16_f32 v117, v118, v119
    v_mfma_f32_16x16x32_bf16 v[244:247], v[72:75], v[60:63], v[244:247]
    v_cvt_pk_bf16_f32 v118, v120, v121
    v_mfma_f32_16x16x32_bf16 v[248:251], v[76:79], v[60:63], v[248:251]
    v_cvt_pk_bf16_f32 v119, v122, v123
    v_mfma_f32_16x16x32_bf16 v[252:255], v[80:83], v[60:63], v[252:255]
    s_waitcnt lgkmcnt(1)
    v_accvgpr_write_b32 a200, v116
    v_mfma_f32_16x16x32_bf16 v[128:131], v[84:87], v[32:35], v[128:131]
    s_waitcnt vmcnt(21)
    v_accvgpr_write_b32 a201, v117
    v_mfma_f32_16x16x32_bf16 v[132:135], v[88:91], v[32:35], v[132:135]
    s_barrier
    v_mfma_f32_16x16x32_bf16 v[136:139], v[92:95], v[32:35], v[136:139]
    s_add_u32 m0, s76, 114688
    ds_read_b128 v[60:63], v28 offset:14336
    v_accvgpr_write_b32 a202, v118
    v_mfma_f32_16x16x32_bf16 v[140:143], v[96:99], v[32:35], v[140:143]
    ds_read_b128 v[32:35], v28 offset:0
    v_accvgpr_write_b32 a203, v119
    v_mfma_f32_16x16x32_bf16 v[144:147], v[84:87], v[36:39], v[144:147]
    buffer_load_dwordx4 v16, s[52:55], s77 offen offset:0 lds
    v_accvgpr_read_b32 v100, a80
    v_mfma_f32_16x16x32_bf16 v[148:151], v[88:91], v[36:39], v[148:151]
    ds_read_b64_tr_b16 v[68:69], v8 offset:0
    v_accvgpr_read_b32 v101, a81
    v_mfma_f32_16x16x32_bf16 v[152:155], v[92:95], v[36:39], v[152:155]
    v_accvgpr_read_b32 v102, a82
    v_accvgpr_read_b32 v103, a83
    v_mfma_f32_16x16x32_bf16 v[156:159], v[96:99], v[36:39], v[156:159]
    ds_read_b128 v[36:39], v28 offset:2048
    ds_read_b64_tr_b16 v[70:71], v8 offset:512
    v_mfma_f32_16x16x32_bf16 v[160:163], v[84:87], v[40:43], v[160:163]
    buffer_load_dwordx4 v17, s[52:55], s77 offen offset:1024 lds
    v_accvgpr_read_b32 v104, a84
    v_mfma_f32_16x16x32_bf16 v[164:167], v[88:91], v[40:43], v[164:167]
    ds_read_b64_tr_b16 v[72:73], v9 offset:0
    v_accvgpr_read_b32 v105, a85
    v_mfma_f32_16x16x32_bf16 v[168:171], v[92:95], v[40:43], v[168:171]
    buffer_load_dwordx4 v18, s[52:55], s77 offen offset:2048 lds
    v_accvgpr_read_b32 v106, a86
    v_mfma_f32_16x16x32_bf16 v[172:175], v[96:99], v[40:43], v[172:175]
    ds_read_b128 v[40:43], v28 offset:4096
    ds_read_b64_tr_b16 v[74:75], v9 offset:512
    v_mfma_f32_16x16x32_bf16 v[176:179], v[84:87], v[44:47], v[176:179]
    v_add_u32 v13, 18432, v10
    v_accvgpr_read_b32 v107, a87
    v_mfma_f32_16x16x32_bf16 v[180:183], v[88:91], v[44:47], v[180:183]
    ds_read_b64_tr_b16 v[76:77], v8 offset:8192
    buffer_load_dwordx4 v19, s[52:55], s77 offen offset:3072 lds
    v_mfma_f32_16x16x32_bf16 v[184:187], v[92:95], v[44:47], v[184:187]
    v_cvt_pk_bf16_f32 v100, v100, v101
    v_cvt_pk_bf16_f32 v101, v102, v103
    v_mfma_f32_16x16x32_bf16 v[188:191], v[96:99], v[44:47], v[188:191]
    ds_read_b128 v[44:47], v28 offset:6144
    ds_read_b64_tr_b16 v[78:79], v8 offset:8704
    v_mfma_f32_16x16x32_bf16 v[192:195], v[84:87], v[48:51], v[192:195]
    s_add_u32 s77, s77, 114688
    v_cvt_pk_bf16_f32 v102, v104, v105
    v_cvt_pk_bf16_f32 v103, v106, v107
    v_mfma_f32_16x16x32_bf16 v[196:199], v[88:91], v[48:51], v[196:199]
    ds_read_b64_tr_b16 v[80:81], v9 offset:8192
    v_mfma_f32_16x16x32_bf16 v[200:203], v[92:95], v[48:51], v[200:203]
    buffer_store_dwordx4 v[100:103], v14, s[16:19], s32 offen offset:2048 sc1
    v_mfma_f32_16x16x32_bf16 v[204:207], v[96:99], v[48:51], v[204:207]
    s_waitcnt lgkmcnt(12)
    ds_read_b128 v[48:51], v28 offset:8192
    ds_read_b64_tr_b16 v[82:83], v9 offset:8704
    v_mfma_f32_16x16x32_bf16 v[208:211], v[84:87], v[52:55], v[208:211]
    s_add_u32 m0, s76, 32768
    v_accvgpr_read_b32 v108, a88
    v_accvgpr_read_b32 v109, a89
    v_mfma_f32_16x16x32_bf16 v[212:215], v[88:91], v[52:55], v[212:215]
    v_accvgpr_read_b32 v110, a90
    v_accvgpr_read_b32 v111, a91
    v_mfma_f32_16x16x32_bf16 v[216:219], v[92:95], v[52:55], v[216:219]
    buffer_load_dwordx4 v22, s[16:19], s26 offen offset:2048 sc1 lds
    v_accvgpr_read_b32 v112, a92
    v_mfma_f32_16x16x32_bf16 v[220:223], v[96:99], v[52:55], v[220:223]
    ds_read_b128 v[52:55], v28 offset:10240
    v_accvgpr_read_b32 v113, a93
    v_mfma_f32_16x16x32_bf16 v[224:227], v[84:87], v[56:59], v[224:227]
    v_accvgpr_read_b32 v114, a94
    v_accvgpr_read_b32 v115, a95
    v_mfma_f32_16x16x32_bf16 v[228:231], v[88:91], v[56:59], v[228:231]
    buffer_load_dwordx4 v23, s[16:19], s26 offen offset:3072 sc1 lds
    v_cvt_pk_bf16_f32 v108, v108, v109
    v_mfma_f32_16x16x32_bf16 v[232:235], v[92:95], v[56:59], v[232:235]
    v_cvt_pk_bf16_f32 v109, v110, v111
    v_cvt_pk_bf16_f32 v110, v112, v113
    v_mfma_f32_16x16x32_bf16 v[236:239], v[96:99], v[56:59], v[236:239]
    ds_read_b128 v[56:59], v28 offset:12288
    v_cvt_pk_bf16_f32 v111, v114, v115
    v_mfma_f32_16x16x32_bf16 v[240:243], v[84:87], v[64:67], v[240:243]
    s_add_u32 s26, s26, -768
    buffer_store_dwordx4 v[108:111], v14, s[16:19], s32 offen offset:3072 sc1
    v_mfma_f32_16x16x32_bf16 v[244:247], v[88:91], v[64:67], v[244:247]
    v_mfma_f32_16x16x32_bf16 v[248:251], v[92:95], v[64:67], v[248:251]
    s_add_u32 s32, s32, 4096
    v_mfma_f32_16x16x32_bf16 v[252:255], v[96:99], v[64:67], v[252:255]
    s_waitcnt lgkmcnt(1)
    v_accvgpr_read_b32 v116, a208
    v_mfma_f32_16x16x32_bf16 v[128:131], v[68:71], v[32:35], v[128:131]
    v_accvgpr_read_b32 v117, a209
    v_mfma_f32_16x16x32_bf16 v[132:135], v[72:75], v[32:35], v[132:135]
    s_barrier
    v_mfma_f32_16x16x32_bf16 v[136:139], v[76:79], v[32:35], v[136:139]
    s_add_u32 m0, s76, 131072
    ds_read_b128 v[64:67], v29 offset:14336
    v_add_u32 v16, 0x10000, v14
    v_mfma_f32_16x16x32_bf16 v[140:143], v[80:83], v[32:35], v[140:143]
    ds_read_b128 v[32:35], v29 offset:0
    v_accvgpr_read_b32 v118, a210
    v_mfma_f32_16x16x32_bf16 v[144:147], v[68:71], v[36:39], v[144:147]
    v_accvgpr_read_b32 v119, a211
    v_accvgpr_read_b32 v120, a212
    v_mfma_f32_16x16x32_bf16 v[148:151], v[72:75], v[36:39], v[148:151]
    ds_read_b64_tr_b16 v[84:85], v8 offset:16384
    buffer_load_dwordx4 v24, s[12:15], s27 offen offset:0 lds
    v_mfma_f32_16x16x32_bf16 v[152:155], v[76:79], v[36:39], v[152:155]
    v_accvgpr_read_b32 v121, a213
    v_accvgpr_read_b32 v122, a214
    v_mfma_f32_16x16x32_bf16 v[156:159], v[80:83], v[36:39], v[156:159]
    ds_read_b128 v[36:39], v29 offset:2048
    ds_read_b64_tr_b16 v[86:87], v8 offset:16896
    v_mfma_f32_16x16x32_bf16 v[160:163], v[68:71], v[40:43], v[160:163]
    buffer_load_dwordx4 v25, s[12:15], s27 offen offset:1024 lds
    v_accvgpr_read_b32 v123, a215
    v_mfma_f32_16x16x32_bf16 v[164:167], v[72:75], v[40:43], v[164:167]
    ds_read_b64_tr_b16 v[88:89], v9 offset:16384
    v_cvt_pk_bf16_f32 v116, v116, v117
    v_mfma_f32_16x16x32_bf16 v[168:171], v[76:79], v[40:43], v[168:171]
    v_cvt_pk_bf16_f32 v117, v118, v119
    v_cvt_pk_bf16_f32 v118, v120, v121
    v_mfma_f32_16x16x32_bf16 v[172:175], v[80:83], v[40:43], v[172:175]
    ds_read_b128 v[40:43], v29 offset:4096
    ds_read_b64_tr_b16 v[90:91], v9 offset:16896
    v_mfma_f32_16x16x32_bf16 v[176:179], v[68:71], v[44:47], v[176:179]
    buffer_load_dwordx4 v26, s[12:15], s27 offen offset:2048 lds
    v_cvt_pk_bf16_f32 v119, v122, v123
    v_mfma_f32_16x16x32_bf16 v[180:183], v[72:75], v[44:47], v[180:183]
    ds_read_b64_tr_b16 v[92:93], v8 offset:24576
    v_accvgpr_write_b32 a208, v116
    v_mfma_f32_16x16x32_bf16 v[184:187], v[76:79], v[44:47], v[184:187]
    buffer_load_dwordx4 v27, s[12:15], s27 offen offset:3072 lds
    v_accvgpr_write_b32 a209, v117
    v_mfma_f32_16x16x32_bf16 v[188:191], v[80:83], v[44:47], v[188:191]
    ds_read_b128 v[44:47], v29 offset:6144
    ds_read_b64_tr_b16 v[94:95], v8 offset:25088
    v_mfma_f32_16x16x32_bf16 v[192:195], v[68:71], v[48:51], v[192:195]
    v_mov_b32 v18, 4048155338
    v_accvgpr_write_b32 a210, v118
    v_mfma_f32_16x16x32_bf16 v[196:199], v[72:75], v[48:51], v[196:199]
    ds_read_b64_tr_b16 v[96:97], v9 offset:24576
    v_accvgpr_write_b32 a211, v119
    v_mfma_f32_16x16x32_bf16 v[200:203], v[76:79], v[48:51], v[200:203]
    s_add_u32 s27, s27, 262144
    v_accvgpr_read_b32 v100, a96
    v_accvgpr_read_b32 v101, a97
    v_mfma_f32_16x16x32_bf16 v[204:207], v[80:83], v[48:51], v[204:207]
    s_waitcnt lgkmcnt(12)
    ds_read_b128 v[48:51], v29 offset:8192
    ds_read_b64_tr_b16 v[98:99], v9 offset:25088
    v_mfma_f32_16x16x32_bf16 v[208:211], v[68:71], v[52:55], v[208:211]
    v_accvgpr_read_b32 v102, a98
    v_accvgpr_read_b32 v103, a99
    v_mfma_f32_16x16x32_bf16 v[212:215], v[72:75], v[52:55], v[212:215]
    s_add_u32 m0, s76, 49152
    v_accvgpr_read_b32 v104, a100
    v_accvgpr_read_b32 v105, a101
    v_mfma_f32_16x16x32_bf16 v[216:219], v[76:79], v[52:55], v[216:219]
    v_accvgpr_read_b32 v106, a102
    v_accvgpr_read_b32 v107, a103
    v_mfma_f32_16x16x32_bf16 v[220:223], v[80:83], v[52:55], v[220:223]
    ds_read_b128 v[52:55], v29 offset:10240
    v_cvt_pk_bf16_f32 v100, v100, v101
    v_mfma_f32_16x16x32_bf16 v[224:227], v[68:71], v[56:59], v[224:227]
    buffer_load_dwordx4 v20, s[16:19], s26 offen offset:0 sc1 lds
    v_cvt_pk_bf16_f32 v101, v102, v103
    v_mfma_f32_16x16x32_bf16 v[228:231], v[72:75], v[56:59], v[228:231]
    v_cvt_pk_bf16_f32 v102, v104, v105
    v_mfma_f32_16x16x32_bf16 v[232:235], v[76:79], v[56:59], v[232:235]
    v_cvt_pk_bf16_f32 v103, v106, v107
    v_mfma_f32_16x16x32_bf16 v[236:239], v[80:83], v[56:59], v[236:239]
    ds_read_b128 v[56:59], v29 offset:12288
    buffer_load_dwordx4 v21, s[16:19], s26 offen offset:1024 sc1 lds
    v_mfma_f32_16x16x32_bf16 v[240:243], v[68:71], v[60:63], v[240:243]
    buffer_store_dwordx4 v[100:103], v14, s[16:19], s32 offen offset:0 sc1
    v_mfma_f32_16x16x32_bf16 v[244:247], v[72:75], v[60:63], v[244:247]
    v_accvgpr_read_b32 v108, a216
    v_mfma_f32_16x16x32_bf16 v[248:251], v[76:79], v[60:63], v[248:251]
    v_accvgpr_read_b32 v109, a217
    v_mfma_f32_16x16x32_bf16 v[252:255], v[80:83], v[60:63], v[252:255]
    s_waitcnt lgkmcnt(1)
    v_accvgpr_read_b32 v110, a218
    v_mfma_f32_16x16x32_bf16 v[128:131], v[84:87], v[32:35], v[128:131]
    s_waitcnt vmcnt(22)
    v_and_b32 v6, 15, v1
    v_accvgpr_read_b32 v111, a219
    v_mfma_f32_16x16x32_bf16 v[132:135], v[88:91], v[32:35], v[132:135]
    s_barrier
    v_mfma_f32_16x16x32_bf16 v[136:139], v[92:95], v[32:35], v[136:139]
    s_add_u32 m0, s76, 147456
    ds_read_b128 v[60:63], v28 offset:30720
    v_accvgpr_read_b32 v112, a220
    v_mfma_f32_16x16x32_bf16 v[140:143], v[96:99], v[32:35], v[140:143]
    ds_read_b128 v[32:35], v28 offset:16384
    v_accvgpr_read_b32 v113, a221
    v_mfma_f32_16x16x32_bf16 v[144:147], v[84:87], v[36:39], v[144:147]
    buffer_load_dwordx4 v24, s[12:15], s27 offen offset:0 lds
    v_accvgpr_read_b32 v114, a222
    v_mfma_f32_16x16x32_bf16 v[148:151], v[88:91], v[36:39], v[148:151]
    ds_read_b64_tr_b16 v[68:69], v30 offset:0
    v_accvgpr_read_b32 v115, a223
    v_mfma_f32_16x16x32_bf16 v[152:155], v[92:95], v[36:39], v[152:155]
    v_cvt_pk_bf16_f32 v108, v108, v109
    v_cvt_pk_bf16_f32 v109, v110, v111
    v_mfma_f32_16x16x32_bf16 v[156:159], v[96:99], v[36:39], v[156:159]
    ds_read_b128 v[36:39], v28 offset:18432
    ds_read_b64_tr_b16 v[70:71], v30 offset:512
    v_mfma_f32_16x16x32_bf16 v[160:163], v[84:87], v[40:43], v[160:163]
    buffer_load_dwordx4 v25, s[12:15], s27 offen offset:1024 lds
    v_cvt_pk_bf16_f32 v110, v112, v113
    v_mfma_f32_16x16x32_bf16 v[164:167], v[88:91], v[40:43], v[164:167]
    ds_read_b64_tr_b16 v[72:73], v31 offset:0
    v_cvt_pk_bf16_f32 v111, v114, v115
    v_mfma_f32_16x16x32_bf16 v[168:171], v[92:95], v[40:43], v[168:171]
    buffer_load_dwordx4 v26, s[12:15], s27 offen offset:2048 lds
    v_accvgpr_write_b32 a216, v108
    v_mfma_f32_16x16x32_bf16 v[172:175], v[96:99], v[40:43], v[172:175]
    ds_read_b128 v[40:43], v28 offset:20480
    ds_read_b64_tr_b16 v[74:75], v31 offset:512
    v_mfma_f32_16x16x32_bf16 v[176:179], v[84:87], v[44:47], v[176:179]
    v_accvgpr_write_b32 a217, v109
    v_accvgpr_write_b32 a218, v110
    v_mfma_f32_16x16x32_bf16 v[180:183], v[88:91], v[44:47], v[180:183]
    ds_read_b64_tr_b16 v[76:77], v30 offset:8192
    buffer_load_dwordx4 v27, s[12:15], s27 offen offset:3072 lds
    v_mfma_f32_16x16x32_bf16 v[184:187], v[92:95], v[44:47], v[184:187]
    v_accvgpr_write_b32 a219, v111
    v_accvgpr_read_b32 v116, a104
    v_mfma_f32_16x16x32_bf16 v[188:191], v[96:99], v[44:47], v[188:191]
    ds_read_b128 v[44:47], v28 offset:22528
    ds_read_b64_tr_b16 v[78:79], v30 offset:8704
    v_mfma_f32_16x16x32_bf16 v[192:195], v[84:87], v[48:51], v[192:195]
    s_add_u32 s27, s27, 262144
    v_lshrrev_b32 v7, 4, v1
    v_accvgpr_read_b32 v117, a105
    v_mfma_f32_16x16x32_bf16 v[196:199], v[88:91], v[48:51], v[196:199]
    ds_read_b64_tr_b16 v[80:81], v31 offset:8192
    v_accvgpr_read_b32 v118, a106
    v_mfma_f32_16x16x32_bf16 v[200:203], v[92:95], v[48:51], v[200:203]
    v_accvgpr_read_b32 v119, a107
    v_accvgpr_read_b32 v120, a108
    v_mfma_f32_16x16x32_bf16 v[204:207], v[96:99], v[48:51], v[204:207]
    s_waitcnt lgkmcnt(12)
    ds_read_b128 v[48:51], v28 offset:24576
    ds_read_b64_tr_b16 v[82:83], v31 offset:8704
    v_mfma_f32_16x16x32_bf16 v[208:211], v[84:87], v[52:55], v[208:211]
    s_add_u32 m0, s76, 49152
    v_accvgpr_read_b32 v121, a109
    v_accvgpr_read_b32 v122, a110
    v_mfma_f32_16x16x32_bf16 v[212:215], v[88:91], v[52:55], v[212:215]
    v_accvgpr_read_b32 v123, a111
    v_mfma_f32_16x16x32_bf16 v[216:219], v[92:95], v[52:55], v[216:219]
    buffer_load_dwordx4 v22, s[16:19], s26 offen offset:2048 sc1 lds
    v_cvt_pk_bf16_f32 v116, v116, v117
    v_mfma_f32_16x16x32_bf16 v[220:223], v[96:99], v[52:55], v[220:223]
    ds_read_b128 v[52:55], v28 offset:26624
    v_cvt_pk_bf16_f32 v117, v118, v119
    v_mfma_f32_16x16x32_bf16 v[224:227], v[84:87], v[56:59], v[224:227]
    v_cvt_pk_bf16_f32 v118, v120, v121
    v_cvt_pk_bf16_f32 v119, v122, v123
    v_mfma_f32_16x16x32_bf16 v[228:231], v[88:91], v[56:59], v[228:231]
    buffer_load_dwordx4 v23, s[16:19], s26 offen offset:3072 sc1 lds
    v_mfma_f32_16x16x32_bf16 v[232:235], v[92:95], v[56:59], v[232:235]
    buffer_store_dwordx4 v[116:119], v14, s[16:19], s32 offen offset:1024 sc1
    v_mfma_f32_16x16x32_bf16 v[236:239], v[96:99], v[56:59], v[236:239]
    ds_read_b128 v[56:59], v28 offset:28672
    v_accvgpr_read_b32 v100, a224
    v_mfma_f32_16x16x32_bf16 v[240:243], v[84:87], v[64:67], v[240:243]
    s_add_u32 s26, s26, 128
    v_accvgpr_read_b32 v101, a225
    v_accvgpr_read_b32 v102, a226
    v_mfma_f32_16x16x32_bf16 v[244:247], v[88:91], v[64:67], v[244:247]
    v_accvgpr_read_b32 v103, a227
    v_mfma_f32_16x16x32_bf16 v[248:251], v[92:95], v[64:67], v[248:251]
    v_accvgpr_read_b32 v104, a228
    v_mfma_f32_16x16x32_bf16 v[252:255], v[96:99], v[64:67], v[252:255]
    s_waitcnt lgkmcnt(1)
    v_accvgpr_read_b32 v105, a229
    v_mfma_f32_16x16x32_bf16 v[128:131], v[68:71], v[32:35], v[128:131]
    v_lshlrev_b32 v7, 2, v7
    v_accvgpr_read_b32 v106, a230
    v_mfma_f32_16x16x32_bf16 v[132:135], v[72:75], v[32:35], v[132:135]
    s_barrier
    v_mfma_f32_16x16x32_bf16 v[136:139], v[76:79], v[32:35], v[136:139]
    s_add_u32 m0, s76, 65536
    ds_read_b128 v[64:67], v29 offset:30720
    v_accvgpr_read_b32 v107, a231
    v_mfma_f32_16x16x32_bf16 v[140:143], v[80:83], v[32:35], v[140:143]
    ds_read_b128 v[32:35], v29 offset:16384
    v_cvt_pk_bf16_f32 v100, v100, v101
    v_mfma_f32_16x16x32_bf16 v[144:147], v[68:71], v[36:39], v[144:147]
    v_cvt_pk_bf16_f32 v101, v102, v103
    v_cvt_pk_bf16_f32 v102, v104, v105
    v_mfma_f32_16x16x32_bf16 v[148:151], v[72:75], v[36:39], v[148:151]
    ds_read_b64_tr_b16 v[84:85], v30 offset:16384
    buffer_load_dwordx4 v24, s[12:15], s27 offen offset:0 lds
    v_mfma_f32_16x16x32_bf16 v[152:155], v[76:79], v[36:39], v[152:155]
    v_cvt_pk_bf16_f32 v103, v106, v107
    v_accvgpr_write_b32 a224, v100
    v_mfma_f32_16x16x32_bf16 v[156:159], v[80:83], v[36:39], v[156:159]
    ds_read_b128 v[36:39], v29 offset:18432
    ds_read_b64_tr_b16 v[86:87], v30 offset:16896
    v_mfma_f32_16x16x32_bf16 v[160:163], v[68:71], v[40:43], v[160:163]
    buffer_load_dwordx4 v25, s[12:15], s27 offen offset:1024 lds
    v_accvgpr_write_b32 a225, v101
    v_mfma_f32_16x16x32_bf16 v[164:167], v[72:75], v[40:43], v[164:167]
    ds_read_b64_tr_b16 v[88:89], v31 offset:16384
    v_accvgpr_write_b32 a226, v102
    v_mfma_f32_16x16x32_bf16 v[168:171], v[76:79], v[40:43], v[168:171]
    v_accvgpr_write_b32 a227, v103
    v_accvgpr_read_b32 v108, a112
    v_mfma_f32_16x16x32_bf16 v[172:175], v[80:83], v[40:43], v[172:175]
    ds_read_b128 v[40:43], v29 offset:20480
    ds_read_b64_tr_b16 v[90:91], v31 offset:16896
    v_mfma_f32_16x16x32_bf16 v[176:179], v[68:71], v[44:47], v[176:179]
    buffer_load_dwordx4 v26, s[12:15], s27 offen offset:2048 lds
    v_accvgpr_read_b32 v109, a113
    v_mfma_f32_16x16x32_bf16 v[180:183], v[72:75], v[44:47], v[180:183]
    ds_read_b64_tr_b16 v[92:93], v30 offset:24576
    v_accvgpr_read_b32 v110, a114
    v_mfma_f32_16x16x32_bf16 v[184:187], v[76:79], v[44:47], v[184:187]
    buffer_load_dwordx4 v27, s[12:15], s27 offen offset:3072 lds
    v_accvgpr_read_b32 v111, a115
    v_mfma_f32_16x16x32_bf16 v[188:191], v[80:83], v[44:47], v[188:191]
    ds_read_b128 v[44:47], v29 offset:22528
    ds_read_b64_tr_b16 v[94:95], v30 offset:25088
    v_mfma_f32_16x16x32_bf16 v[192:195], v[68:71], v[48:51], v[192:195]
    v_sub_u32 v6, v6, v7
    v_accvgpr_read_b32 v112, a116
    v_mfma_f32_16x16x32_bf16 v[196:199], v[72:75], v[48:51], v[196:199]
    ds_read_b64_tr_b16 v[96:97], v31 offset:24576
    v_accvgpr_read_b32 v113, a117
    v_mfma_f32_16x16x32_bf16 v[200:203], v[76:79], v[48:51], v[200:203]
    s_add_u32 s27, s27, 262144
    v_accvgpr_read_b32 v114, a118
    v_accvgpr_read_b32 v115, a119
    v_mfma_f32_16x16x32_bf16 v[204:207], v[80:83], v[48:51], v[204:207]
    s_waitcnt lgkmcnt(12)
    ds_read_b128 v[48:51], v29 offset:24576
    ds_read_b64_tr_b16 v[98:99], v31 offset:25088
    v_mfma_f32_16x16x32_bf16 v[208:211], v[68:71], v[52:55], v[208:211]
    v_cvt_pk_bf16_f32 v108, v108, v109
    v_cvt_pk_bf16_f32 v109, v110, v111
    v_mfma_f32_16x16x32_bf16 v[212:215], v[72:75], v[52:55], v[212:215]
    s_add_u32 m0, s76, 0
    v_cvt_pk_bf16_f32 v110, v112, v113
    v_cvt_pk_bf16_f32 v111, v114, v115
    v_mfma_f32_16x16x32_bf16 v[216:219], v[76:79], v[52:55], v[216:219]
    buffer_store_dwordx4 v[108:111], v14, s[16:19], s32 offen offset:2048 sc1
    v_mfma_f32_16x16x32_bf16 v[220:223], v[80:83], v[52:55], v[220:223]
    ds_read_b128 v[52:55], v29 offset:26624
    v_mfma_f32_16x16x32_bf16 v[224:227], v[68:71], v[56:59], v[224:227]
    buffer_load_dwordx4 v20, s[16:19], s26 offen offset:0 sc1 lds
    v_accvgpr_read_b32 v116, a232
    v_mfma_f32_16x16x32_bf16 v[228:231], v[72:75], v[56:59], v[228:231]
    v_accvgpr_read_b32 v117, a233
    v_mfma_f32_16x16x32_bf16 v[232:235], v[76:79], v[56:59], v[232:235]
    v_accvgpr_read_b32 v118, a234
    v_mfma_f32_16x16x32_bf16 v[236:239], v[80:83], v[56:59], v[236:239]
    ds_read_b128 v[56:59], v29 offset:28672
    buffer_load_dwordx4 v21, s[16:19], s26 offen offset:1024 sc1 lds
    v_mfma_f32_16x16x32_bf16 v[240:243], v[68:71], v[60:63], v[240:243]
    v_accvgpr_read_b32 v119, a235
    v_accvgpr_read_b32 v120, a236
    v_mfma_f32_16x16x32_bf16 v[244:247], v[72:75], v[60:63], v[244:247]
    v_accvgpr_read_b32 v121, a237
    v_mfma_f32_16x16x32_bf16 v[248:251], v[76:79], v[60:63], v[248:251]
    v_accvgpr_read_b32 v122, a238
    v_mfma_f32_16x16x32_bf16 v[252:255], v[80:83], v[60:63], v[252:255]
    s_waitcnt lgkmcnt(1)
    v_accvgpr_read_b32 v123, a239
    v_mfma_f32_16x16x32_bf16 v[128:131], v[84:87], v[32:35], v[128:131]
    s_waitcnt vmcnt(22)
    s_lshl_b32 s30, s20, 4
    v_cvt_pk_bf16_f32 v116, v116, v117
    v_mfma_f32_16x16x32_bf16 v[132:135], v[88:91], v[32:35], v[132:135]
    s_barrier
    v_mfma_f32_16x16x32_bf16 v[136:139], v[92:95], v[32:35], v[136:139]
    s_add_u32 m0, s76, 81920
    ds_read_b128 v[60:63], v28 offset:47104
    v_cvt_pk_bf16_f32 v117, v118, v119
    v_mfma_f32_16x16x32_bf16 v[140:143], v[96:99], v[32:35], v[140:143]
    ds_read_b128 v[32:35], v28 offset:32768
    v_cvt_pk_bf16_f32 v118, v120, v121
    v_mfma_f32_16x16x32_bf16 v[144:147], v[84:87], v[36:39], v[144:147]
    buffer_load_dwordx4 v24, s[12:15], s27 offen offset:0 lds
    v_cvt_pk_bf16_f32 v119, v122, v123
    v_mfma_f32_16x16x32_bf16 v[148:151], v[88:91], v[36:39], v[148:151]
    ds_read_b64_tr_b16 v[68:69], v30 offset:32768
    v_accvgpr_write_b32 a232, v116
    v_mfma_f32_16x16x32_bf16 v[152:155], v[92:95], v[36:39], v[152:155]
    v_accvgpr_write_b32 a233, v117
    v_accvgpr_write_b32 a234, v118
    v_mfma_f32_16x16x32_bf16 v[156:159], v[96:99], v[36:39], v[156:159]
    ds_read_b128 v[36:39], v28 offset:34816
    ds_read_b64_tr_b16 v[70:71], v30 offset:33280
    v_mfma_f32_16x16x32_bf16 v[160:163], v[84:87], v[40:43], v[160:163]
    buffer_load_dwordx4 v25, s[12:15], s27 offen offset:1024 lds
    v_accvgpr_write_b32 a235, v119
    v_mfma_f32_16x16x32_bf16 v[164:167], v[88:91], v[40:43], v[164:167]
    ds_read_b64_tr_b16 v[72:73], v31 offset:32768
    v_accvgpr_read_b32 v100, a120
    v_mfma_f32_16x16x32_bf16 v[168:171], v[92:95], v[40:43], v[168:171]
    buffer_load_dwordx4 v26, s[12:15], s27 offen offset:2048 lds
    v_accvgpr_read_b32 v101, a121
    v_mfma_f32_16x16x32_bf16 v[172:175], v[96:99], v[40:43], v[172:175]
    ds_read_b128 v[40:43], v28 offset:36864
    ds_read_b64_tr_b16 v[74:75], v31 offset:33280
    v_mfma_f32_16x16x32_bf16 v[176:179], v[84:87], v[44:47], v[176:179]
    v_accvgpr_read_b32 v102, a122
    v_accvgpr_read_b32 v103, a123
    v_mfma_f32_16x16x32_bf16 v[180:183], v[88:91], v[44:47], v[180:183]
    ds_read_b64_tr_b16 v[76:77], v30 offset:40960
    buffer_load_dwordx4 v27, s[12:15], s27 offen offset:3072 lds
    v_mfma_f32_16x16x32_bf16 v[184:187], v[92:95], v[44:47], v[184:187]
    v_accvgpr_read_b32 v104, a124
    v_accvgpr_read_b32 v105, a125
    v_mfma_f32_16x16x32_bf16 v[188:191], v[96:99], v[44:47], v[188:191]
    ds_read_b128 v[44:47], v28 offset:38912
    ds_read_b64_tr_b16 v[78:79], v30 offset:41472
    v_mfma_f32_16x16x32_bf16 v[192:195], v[84:87], v[48:51], v[192:195]
    s_add_u32 s27, s27, 262144
    v_add_u32 v17, s30, v6
    v_accvgpr_read_b32 v106, a126
    v_mfma_f32_16x16x32_bf16 v[196:199], v[88:91], v[48:51], v[196:199]
    ds_read_b64_tr_b16 v[80:81], v31 offset:40960
    v_accvgpr_read_b32 v107, a127
    v_mfma_f32_16x16x32_bf16 v[200:203], v[92:95], v[48:51], v[200:203]
    v_cvt_pk_bf16_f32 v100, v100, v101
    v_cvt_pk_bf16_f32 v101, v102, v103
    v_mfma_f32_16x16x32_bf16 v[204:207], v[96:99], v[48:51], v[204:207]
    s_waitcnt lgkmcnt(12)
    ds_read_b128 v[48:51], v28 offset:40960
    ds_read_b64_tr_b16 v[82:83], v31 offset:41472
    v_mfma_f32_16x16x32_bf16 v[208:211], v[84:87], v[52:55], v[208:211]
    s_add_u32 m0, s76, 0
    v_cvt_pk_bf16_f32 v102, v104, v105
    v_cvt_pk_bf16_f32 v103, v106, v107
    v_mfma_f32_16x16x32_bf16 v[212:215], v[88:91], v[52:55], v[212:215]
    buffer_store_dwordx4 v[100:103], v14, s[16:19], s32 offen offset:3072 sc1
    v_mfma_f32_16x16x32_bf16 v[216:219], v[92:95], v[52:55], v[216:219]
    s_add_u32 s32, s32, 12288
    buffer_load_dwordx4 v22, s[16:19], s26 offen offset:2048 sc1 lds
    v_accvgpr_read_b32 v108, a240
    v_mfma_f32_16x16x32_bf16 v[220:223], v[96:99], v[52:55], v[220:223]
    ds_read_b128 v[52:55], v28 offset:43008
    v_accvgpr_read_b32 v109, a241
    v_mfma_f32_16x16x32_bf16 v[224:227], v[84:87], v[56:59], v[224:227]
    v_accvgpr_read_b32 v110, a242
    v_mfma_f32_16x16x32_bf16 v[228:231], v[88:91], v[56:59], v[228:231]
    buffer_load_dwordx4 v23, s[16:19], s26 offen offset:3072 sc1 lds
    v_accvgpr_read_b32 v111, a243
    v_mfma_f32_16x16x32_bf16 v[232:235], v[92:95], v[56:59], v[232:235]
    v_accvgpr_read_b32 v112, a244
    v_mfma_f32_16x16x32_bf16 v[236:239], v[96:99], v[56:59], v[236:239]
    ds_read_b128 v[56:59], v28 offset:45056
    v_accvgpr_read_b32 v113, a245
    v_mfma_f32_16x16x32_bf16 v[240:243], v[84:87], v[64:67], v[240:243]
    s_add_u32 s26, s26, 128
    v_accvgpr_read_b32 v114, a246
    v_mfma_f32_16x16x32_bf16 v[244:247], v[88:91], v[64:67], v[244:247]
    v_accvgpr_read_b32 v115, a247
    v_mfma_f32_16x16x32_bf16 v[248:251], v[92:95], v[64:67], v[248:251]
    v_cvt_pk_bf16_f32 v108, v108, v109
    v_mfma_f32_16x16x32_bf16 v[252:255], v[96:99], v[64:67], v[252:255]
    s_waitcnt lgkmcnt(1)
    v_cvt_pk_bf16_f32 v109, v110, v111
    v_mfma_f32_16x16x32_bf16 v[128:131], v[68:71], v[32:35], v[128:131]
    s_lshl_b32 s30, s22, 14
    v_cvt_pk_bf16_f32 v110, v112, v113
    v_mfma_f32_16x16x32_bf16 v[132:135], v[72:75], v[32:35], v[132:135]
    s_barrier
    v_mfma_f32_16x16x32_bf16 v[136:139], v[76:79], v[32:35], v[136:139]
    s_add_u32 m0, s76, 98304
    ds_read_b128 v[64:67], v29 offset:47104
    v_cvt_pk_bf16_f32 v111, v114, v115
    v_mfma_f32_16x16x32_bf16 v[140:143], v[80:83], v[32:35], v[140:143]
    ds_read_b128 v[32:35], v29 offset:32768
    v_accvgpr_write_b32 a240, v108
    v_mfma_f32_16x16x32_bf16 v[144:147], v[68:71], v[36:39], v[144:147]
    v_accvgpr_write_b32 a241, v109
    v_accvgpr_write_b32 a242, v110
    v_mfma_f32_16x16x32_bf16 v[148:151], v[72:75], v[36:39], v[148:151]
    ds_read_b64_tr_b16 v[84:85], v30 offset:49152
    buffer_load_dwordx4 v24, s[12:15], s27 offen offset:0 lds
    v_mfma_f32_16x16x32_bf16 v[152:155], v[76:79], v[36:39], v[152:155]
    v_accvgpr_write_b32 a243, v111
    v_accvgpr_read_b32 v116, a128
    v_mfma_f32_16x16x32_bf16 v[156:159], v[80:83], v[36:39], v[156:159]
    ds_read_b128 v[36:39], v29 offset:34816
    ds_read_b64_tr_b16 v[86:87], v30 offset:49664
    v_mfma_f32_16x16x32_bf16 v[160:163], v[68:71], v[40:43], v[160:163]
    buffer_load_dwordx4 v25, s[12:15], s27 offen offset:1024 lds
    v_accvgpr_read_b32 v117, a129
    v_mfma_f32_16x16x32_bf16 v[164:167], v[72:75], v[40:43], v[164:167]
    ds_read_b64_tr_b16 v[88:89], v31 offset:49152
    v_accvgpr_read_b32 v118, a130
    v_mfma_f32_16x16x32_bf16 v[168:171], v[76:79], v[40:43], v[168:171]
    v_accvgpr_read_b32 v119, a131
    v_accvgpr_read_b32 v120, a132
    v_mfma_f32_16x16x32_bf16 v[172:175], v[80:83], v[40:43], v[172:175]
    ds_read_b128 v[40:43], v29 offset:36864
    ds_read_b64_tr_b16 v[90:91], v31 offset:49664
    v_mfma_f32_16x16x32_bf16 v[176:179], v[68:71], v[44:47], v[176:179]
    buffer_load_dwordx4 v26, s[12:15], s27 offen offset:2048 lds
    v_accvgpr_read_b32 v121, a133
    v_mfma_f32_16x16x32_bf16 v[180:183], v[72:75], v[44:47], v[180:183]
    ds_read_b64_tr_b16 v[92:93], v30 offset:57344
    v_accvgpr_read_b32 v122, a134
    v_mfma_f32_16x16x32_bf16 v[184:187], v[76:79], v[44:47], v[184:187]
    buffer_load_dwordx4 v27, s[12:15], s27 offen offset:3072 lds
    v_accvgpr_read_b32 v123, a135
    v_mfma_f32_16x16x32_bf16 v[188:191], v[80:83], v[44:47], v[188:191]
    ds_read_b128 v[44:47], v29 offset:38912
    ds_read_b64_tr_b16 v[94:95], v30 offset:57856
    v_mfma_f32_16x16x32_bf16 v[192:195], v[68:71], v[48:51], v[192:195]
    s_lshl_b32 s31, s21, 17
    v_cvt_pk_bf16_f32 v116, v116, v117
    v_cvt_pk_bf16_f32 v117, v118, v119
    v_mfma_f32_16x16x32_bf16 v[196:199], v[72:75], v[48:51], v[196:199]
    ds_read_b64_tr_b16 v[96:97], v31 offset:57344
    v_cvt_pk_bf16_f32 v118, v120, v121
    v_mfma_f32_16x16x32_bf16 v[200:203], v[76:79], v[48:51], v[200:203]
    s_add_u32 s27, s27, 262144
    v_cvt_pk_bf16_f32 v119, v122, v123
    v_mfma_f32_16x16x32_bf16 v[204:207], v[80:83], v[48:51], v[204:207]
    s_waitcnt lgkmcnt(12)
    ds_read_b128 v[48:51], v29 offset:40960
    ds_read_b64_tr_b16 v[98:99], v31 offset:57856
    v_mfma_f32_16x16x32_bf16 v[208:211], v[68:71], v[52:55], v[208:211]
    buffer_store_dwordx4 v[116:119], v14, s[16:19], s32 offen offset:0 sc1
    v_mfma_f32_16x16x32_bf16 v[212:215], v[72:75], v[52:55], v[212:215]
    s_add_u32 m0, s76, 16384
    v_accvgpr_read_b32 v100, a136
    v_accvgpr_read_b32 v101, a137
    v_mfma_f32_16x16x32_bf16 v[216:219], v[76:79], v[52:55], v[216:219]
    v_accvgpr_read_b32 v102, a138
    v_mfma_f32_16x16x32_bf16 v[220:223], v[80:83], v[52:55], v[220:223]
    ds_read_b128 v[52:55], v29 offset:43008
    v_accvgpr_read_b32 v103, a139
    v_mfma_f32_16x16x32_bf16 v[224:227], v[68:71], v[56:59], v[224:227]
    buffer_load_dwordx4 v20, s[16:19], s26 offen offset:0 sc1 lds
    v_accvgpr_read_b32 v104, a140
    v_mfma_f32_16x16x32_bf16 v[228:231], v[72:75], v[56:59], v[228:231]
    v_accvgpr_read_b32 v105, a141
    v_mfma_f32_16x16x32_bf16 v[232:235], v[76:79], v[56:59], v[232:235]
    v_accvgpr_read_b32 v106, a142
    v_mfma_f32_16x16x32_bf16 v[236:239], v[80:83], v[56:59], v[236:239]
    ds_read_b128 v[56:59], v29 offset:45056
    buffer_load_dwordx4 v21, s[16:19], s26 offen offset:1024 sc1 lds
    v_mfma_f32_16x16x32_bf16 v[240:243], v[68:71], v[60:63], v[240:243]
    v_accvgpr_read_b32 v107, a143
    v_mfma_f32_16x16x32_bf16 v[244:247], v[72:75], v[60:63], v[244:247]
    v_cvt_pk_bf16_f32 v100, v100, v101
    v_cvt_pk_bf16_f32 v101, v102, v103
    v_mfma_f32_16x16x32_bf16 v[248:251], v[76:79], v[60:63], v[248:251]
    v_cvt_pk_bf16_f32 v102, v104, v105
    v_mfma_f32_16x16x32_bf16 v[252:255], v[80:83], v[60:63], v[252:255]
    s_waitcnt lgkmcnt(1)
    v_cvt_pk_bf16_f32 v103, v106, v107
    v_mfma_f32_16x16x32_bf16 v[128:131], v[84:87], v[32:35], v[128:131]
    s_waitcnt vmcnt(22)
    s_add_u32 s30, s30, s31
    v_mfma_f32_16x16x32_bf16 v[132:135], v[88:91], v[32:35], v[132:135]
    s_barrier
    v_mfma_f32_16x16x32_bf16 v[136:139], v[92:95], v[32:35], v[136:139]
    s_add_u32 m0, s76, 114688
    ds_read_b128 v[60:63], v28 offset:63488
    v_mfma_f32_16x16x32_bf16 v[140:143], v[96:99], v[32:35], v[140:143]
    ds_read_b128 v[32:35], v28 offset:49152
    v_mfma_f32_16x16x32_bf16 v[144:147], v[84:87], v[36:39], v[144:147]
    buffer_load_dwordx4 v24, s[12:15], s27 offen offset:0 lds
    v_mfma_f32_16x16x32_bf16 v[148:151], v[88:91], v[36:39], v[148:151]
    ds_read_b64_tr_b16 v[68:69], v8 offset:0
    v_mfma_f32_16x16x32_bf16 v[152:155], v[92:95], v[36:39], v[152:155]
    buffer_store_dwordx4 v[100:103], v14, s[16:19], s32 offen offset:1024 sc1
    v_mfma_f32_16x16x32_bf16 v[156:159], v[96:99], v[36:39], v[156:159]
    ds_read_b128 v[36:39], v28 offset:51200
    ds_read_b64_tr_b16 v[70:71], v8 offset:512
    v_mfma_f32_16x16x32_bf16 v[160:163], v[84:87], v[40:43], v[160:163]
    buffer_load_dwordx4 v25, s[12:15], s27 offen offset:1024 lds
    v_accvgpr_read_b32 v108, a248
    v_mfma_f32_16x16x32_bf16 v[164:167], v[88:91], v[40:43], v[164:167]
    ds_read_b64_tr_b16 v[72:73], v9 offset:0
    v_accvgpr_read_b32 v109, a249
    v_mfma_f32_16x16x32_bf16 v[168:171], v[92:95], v[40:43], v[168:171]
    buffer_load_dwordx4 v26, s[12:15], s27 offen offset:2048 lds
    v_accvgpr_read_b32 v110, a250
    v_mfma_f32_16x16x32_bf16 v[172:175], v[96:99], v[40:43], v[172:175]
    ds_read_b128 v[40:43], v28 offset:53248
    ds_read_b64_tr_b16 v[74:75], v9 offset:512
    v_mfma_f32_16x16x32_bf16 v[176:179], v[84:87], v[44:47], v[176:179]
    v_accvgpr_read_b32 v111, a251
    v_accvgpr_read_b32 v112, a252
    v_mfma_f32_16x16x32_bf16 v[180:183], v[88:91], v[44:47], v[180:183]
    ds_read_b64_tr_b16 v[76:77], v8 offset:8192
    buffer_load_dwordx4 v27, s[12:15], s27 offen offset:3072 lds
    v_mfma_f32_16x16x32_bf16 v[184:187], v[92:95], v[44:47], v[184:187]
    v_accvgpr_read_b32 v113, a253
    v_accvgpr_read_b32 v114, a254
    v_mfma_f32_16x16x32_bf16 v[188:191], v[96:99], v[44:47], v[188:191]
    ds_read_b128 v[44:47], v28 offset:55296
    ds_read_b64_tr_b16 v[78:79], v8 offset:8704
    v_mfma_f32_16x16x32_bf16 v[192:195], v[84:87], v[48:51], v[192:195]
    s_add_u32 s27, s27, 262144
    v_add_u32 v19, s30, v14
    v_accvgpr_read_b32 v115, a255
    v_mfma_f32_16x16x32_bf16 v[196:199], v[88:91], v[48:51], v[196:199]
    ds_read_b64_tr_b16 v[80:81], v9 offset:8192
    v_cvt_pk_bf16_f32 v108, v108, v109
    v_mfma_f32_16x16x32_bf16 v[200:203], v[92:95], v[48:51], v[200:203]
    v_cvt_pk_bf16_f32 v109, v110, v111
    v_cvt_pk_bf16_f32 v110, v112, v113
    v_mfma_f32_16x16x32_bf16 v[204:207], v[96:99], v[48:51], v[204:207]
    s_waitcnt lgkmcnt(12)
    ds_read_b128 v[48:51], v28 offset:57344
    ds_read_b64_tr_b16 v[82:83], v9 offset:8704
    v_mfma_f32_16x16x32_bf16 v[208:211], v[84:87], v[52:55], v[208:211]
    s_add_u32 m0, s76, 16384
    v_cvt_pk_bf16_f32 v111, v114, v115
    v_accvgpr_write_b32 a248, v108
    v_mfma_f32_16x16x32_bf16 v[212:215], v[88:91], v[52:55], v[212:215]
    v_accvgpr_write_b32 a249, v109
    v_accvgpr_write_b32 a250, v110
    v_mfma_f32_16x16x32_bf16 v[216:219], v[92:95], v[52:55], v[216:219]
    buffer_load_dwordx4 v22, s[16:19], s26 offen offset:2048 sc1 lds
    v_accvgpr_write_b32 a251, v111
    v_mfma_f32_16x16x32_bf16 v[220:223], v[96:99], v[52:55], v[220:223]
    ds_read_b128 v[52:55], v28 offset:59392
    v_accvgpr_read_b32 v116, a144
    v_mfma_f32_16x16x32_bf16 v[224:227], v[84:87], v[56:59], v[224:227]
    v_accvgpr_read_b32 v117, a145
    v_accvgpr_read_b32 v118, a146
    v_mfma_f32_16x16x32_bf16 v[228:231], v[88:91], v[56:59], v[228:231]
    buffer_load_dwordx4 v23, s[16:19], s26 offen offset:3072 sc1 lds
    v_accvgpr_read_b32 v119, a147
    v_mfma_f32_16x16x32_bf16 v[232:235], v[92:95], v[56:59], v[232:235]
    v_accvgpr_read_b32 v120, a148
    v_accvgpr_read_b32 v121, a149
    v_mfma_f32_16x16x32_bf16 v[236:239], v[96:99], v[56:59], v[236:239]
    ds_read_b128 v[56:59], v28 offset:61440
    v_accvgpr_read_b32 v122, a150
    v_mfma_f32_16x16x32_bf16 v[240:243], v[84:87], v[64:67], v[240:243]
    s_add_u32 s26, s26, 128
    v_accvgpr_read_b32 v123, a151
    v_mfma_f32_16x16x32_bf16 v[244:247], v[88:91], v[64:67], v[244:247]
    v_cvt_pk_bf16_f32 v116, v116, v117
    v_cvt_pk_bf16_f32 v117, v118, v119
    v_mfma_f32_16x16x32_bf16 v[248:251], v[92:95], v[64:67], v[248:251]
    v_cvt_pk_bf16_f32 v118, v120, v121
    v_cvt_pk_bf16_f32 v119, v122, v123
    v_mfma_f32_16x16x32_bf16 v[252:255], v[96:99], v[64:67], v[252:255]
    s_waitcnt lgkmcnt(1)
    buffer_store_dwordx4 v[116:119], v14, s[16:19], s32 offen offset:2048 sc1
    v_mfma_f32_16x16x32_bf16 a[0:3], v[68:71], v[32:35], 0
    v_lshrrev_b32 v5, 6, v14
    v_mul_f32 v136, v128, v136
    v_mfma_f32_16x16x32_bf16 a[4:7], v[72:75], v[32:35], 0
    s_barrier
    v_mfma_f32_16x16x32_bf16 a[8:11], v[76:79], v[32:35], 0
    s_add_u32 m0, s76, 131072
    ds_read_b128 v[64:67], v29 offset:63488
    v_mul_f32 v128, s40, v128
    v_mfma_f32_16x16x32_bf16 a[12:15], v[80:83], v[32:35], 0
    ds_read_b128 v[32:35], v29 offset:49152
    v_mul_f32 v137, v129, v137
    v_mfma_f32_16x16x32_bf16 a[16:19], v[68:71], v[36:39], 0
    v_mul_f32 v129, s40, v129
    v_exp_f32 v128, v128
    v_mfma_f32_16x16x32_bf16 a[20:23], v[72:75], v[36:39], 0
    ds_read_b64_tr_b16 v[84:85], v8 offset:16384
    buffer_load_dwordx4 v24, s[12:15], s27 offen offset:0 lds
    v_mfma_f32_16x16x32_bf16 a[24:27], v[76:79], v[36:39], 0
    v_bfe_u32 v6, v5, 1, 2
    v_mul_f32 v138, v130, v138
    v_mfma_f32_16x16x32_bf16 a[28:31], v[80:83], v[36:39], 0
    ds_read_b128 v[36:39], v29 offset:51200
    ds_read_b64_tr_b16 v[86:87], v8 offset:16896
    v_mfma_f32_16x16x32_bf16 a[32:35], v[68:71], v[40:43], 0
    buffer_load_dwordx4 v25, s[12:15], s27 offen offset:1024 lds
    v_mul_f32 v130, s40, v130
    v_mfma_f32_16x16x32_bf16 a[36:39], v[72:75], v[40:43], 0
    ds_read_b64_tr_b16 v[88:89], v9 offset:16384
    v_exp_f32 v129, v129
    v_mfma_f32_16x16x32_bf16 a[40:43], v[76:79], v[40:43], 0
    buffer_store_dwordx4 a[152:155], v14, s[16:19], s32 offen offset:3072 sc1
    v_mfma_f32_16x16x32_bf16 a[44:47], v[80:83], v[40:43], 0
    ds_read_b128 v[40:43], v29 offset:53248
    ds_read_b64_tr_b16 v[90:91], v9 offset:16896
    v_mfma_f32_16x16x32_bf16 a[48:51], v[68:71], v[44:47], 0
    buffer_load_dwordx4 v26, s[12:15], s27 offen offset:2048 lds
    v_lshlrev_b32 v5, 7, v5
    v_mfma_f32_16x16x32_bf16 a[52:55], v[72:75], v[44:47], 0
    ds_read_b64_tr_b16 v[92:93], v8 offset:24576
    v_mul_f32 v139, v131, v139
    v_mfma_f32_16x16x32_bf16 a[56:59], v[76:79], v[44:47], 0
    buffer_load_dwordx4 v27, s[12:15], s27 offen offset:3072 lds
    v_mul_f32 v131, s40, v131
    v_mfma_f32_16x16x32_bf16 a[60:63], v[80:83], v[44:47], 0
    ds_read_b128 v[44:47], v29 offset:55296
    ds_read_b64_tr_b16 v[94:95], v8 offset:25088
    v_mfma_f32_16x16x32_bf16 a[64:67], v[68:71], v[48:51], 0
    v_bfe_u32 v7, v14, 1, 5
    v_exp_f32 v130, v130
    v_mfma_f32_16x16x32_bf16 a[68:71], v[72:75], v[48:51], 0
    ds_read_b64_tr_b16 v[96:97], v9 offset:24576
    v_add_f32 v128, 1.0, v128
    v_mfma_f32_16x16x32_bf16 a[72:75], v[76:79], v[48:51], 0
    s_add_u32 s27, s27, 262144
    v_mul_f32 v140, v132, v140
    v_mul_f32 v132, s40, v132
    v_mfma_f32_16x16x32_bf16 a[76:79], v[80:83], v[48:51], 0
    s_waitcnt lgkmcnt(12)
    ds_read_b128 v[48:51], v29 offset:57344
    ds_read_b64_tr_b16 v[98:99], v9 offset:25088
    v_mfma_f32_16x16x32_bf16 a[80:83], v[68:71], v[52:55], 0
    v_exp_f32 v131, v131
    v_mfma_f32_16x16x32_bf16 a[84:87], v[72:75], v[52:55], 0
    s_add_u32 m0, s76, 32768
    v_add_u32 v5, v5, v7
    v_add_f32 v129, 1.0, v129
    v_mfma_f32_16x16x32_bf16 a[88:91], v[76:79], v[52:55], 0
    v_rcp_f32 v128, v128
    v_mfma_f32_16x16x32_bf16 a[92:95], v[80:83], v[52:55], 0
    ds_read_b128 v[52:55], v29 offset:59392
    v_mul_f32 v141, v133, v141
    v_mfma_f32_16x16x32_bf16 a[96:99], v[68:71], v[56:59], 0
    s_add_u32 s32, s32, 4096
    buffer_load_dwordx4 v20, s[16:19], s26 offen offset:0 sc1 lds
    v_mul_f32 v133, s40, v133
    v_mfma_f32_16x16x32_bf16 a[100:103], v[72:75], v[56:59], 0
    v_exp_f32 v132, v132
    v_mfma_f32_16x16x32_bf16 a[104:107], v[76:79], v[56:59], 0
    v_add_f32 v130, 1.0, v130
    v_mfma_f32_16x16x32_bf16 a[108:111], v[80:83], v[56:59], 0
    s_lshl_b32 s30, s22, 1
    ds_read_b128 v[56:59], v29 offset:61440
    buffer_load_dwordx4 v21, s[16:19], s26 offen offset:1024 sc1 lds
    v_mfma_f32_16x16x32_bf16 a[112:115], v[68:71], v[60:63], 0
    v_rcp_f32 v129, v129
    v_mfma_f32_16x16x32_bf16 a[116:119], v[72:75], v[60:63], 0
    v_mul_f32 v142, v134, v142
    v_mul_f32 v134, s40, v134
    v_mfma_f32_16x16x32_bf16 a[120:123], v[76:79], v[60:63], 0
    v_exp_f32 v133, v133
    v_mfma_f32_16x16x32_bf16 a[124:127], v[80:83], v[60:63], 0
    s_waitcnt lgkmcnt(1)
    v_add_f32 v131, 1.0, v131
    v_mul_f32 v136, v128, v136
    v_mfma_f32_16x16x32_bf16 a[0:3], v[84:87], v[32:35], a[0:3]
    s_waitcnt vmcnt(22)
    v_xor_b32 v6, s30, v6
    v_rcp_f32 v130, v130
    v_mfma_f32_16x16x32_bf16 a[4:7], v[88:91], v[32:35], a[4:7]
    s_barrier
    v_mfma_f32_16x16x32_bf16 a[8:11], v[92:95], v[32:35], a[8:11]
    s_add_u32 m0, s76, 147456
    ds_read_b128 v[60:63], v28 offset:14336
    v_mul_f32 v143, v135, v143
    v_mfma_f32_16x16x32_bf16 a[12:15], v[96:99], v[32:35], a[12:15]
    ds_read_b128 v[32:35], v28 offset:0
    v_mul_f32 v135, s40, v135
    v_mfma_f32_16x16x32_bf16 a[16:19], v[84:87], v[36:39], a[16:19]
    buffer_load_dwordx4 v24, s[12:15], s27 offen offset:0 lds
    v_exp_f32 v134, v134
    v_mfma_f32_16x16x32_bf16 a[20:23], v[88:91], v[36:39], a[20:23]
    ds_read_b64_tr_b16 v[68:69], v30 offset:0
    v_add_f32 v132, 1.0, v132
    v_mfma_f32_16x16x32_bf16 a[24:27], v[92:95], v[36:39], a[24:27]
    v_lshl_add_u32 v100, v6, 5, v5
    v_mul_f32 v137, v129, v137
    v_mfma_f32_16x16x32_bf16 a[28:31], v[96:99], v[36:39], a[28:31]
    ds_read_b128 v[36:39], v28 offset:2048
    ds_read_b64_tr_b16 v[70:71], v30 offset:512
    v_mfma_f32_16x16x32_bf16 a[32:35], v[84:87], v[40:43], a[32:35]
    buffer_load_dwordx4 v25, s[12:15], s27 offen offset:1024 lds
    v_rcp_f32 v131, v131
    v_mfma_f32_16x16x32_bf16 a[36:39], v[88:91], v[40:43], a[36:39]
    ds_read_b64_tr_b16 v[72:73], v31 offset:0
    v_mul_f32 v152, v144, v152
    v_mfma_f32_16x16x32_bf16 a[40:43], v[92:95], v[40:43], a[40:43]
    buffer_load_dwordx4 v26, s[12:15], s27 offen offset:2048 lds
    v_mul_f32 v144, s40, v144
    v_exp_f32 v135, v135
    v_mfma_f32_16x16x32_bf16 a[44:47], v[96:99], v[40:43], a[44:47]
    ds_read_b128 v[40:43], v28 offset:4096
    ds_read_b64_tr_b16 v[74:75], v31 offset:512
    v_cvt_pk_bf16_f32 v128, v136, v137
    v_mfma_f32_16x16x32_bf16 a[48:51], v[84:87], v[44:47], a[48:51]
    buffer_store_dwordx4 a[160:163], v14, s[16:19], s32 offen offset:0 sc1
    v_add_f32 v133, 1.0, v133
    v_mfma_f32_16x16x32_bf16 a[52:55], v[88:91], v[44:47], a[52:55]
    ds_read_b64_tr_b16 v[76:77], v30 offset:8192
    buffer_load_dwordx4 v27, s[12:15], s27 offen offset:3072 lds
    v_mfma_f32_16x16x32_bf16 a[56:59], v[92:95], v[44:47], a[56:59]
    v_xor_b32 v101, 32, v100
    v_mul_f32 v138, v130, v138
    v_rcp_f32 v132, v132
    v_mfma_f32_16x16x32_bf16 a[60:63], v[96:99], v[44:47], a[60:63]
    ds_read_b128 v[44:47], v28 offset:6144
    ds_read_b64_tr_b16 v[78:79], v30 offset:8704
    v_mfma_f32_16x16x32_bf16 a[64:67], v[84:87], v[48:51], a[64:67]
    s_add_u32 s27, s27, 262144
    v_mul_f32 v153, v145, v153
    v_mul_f32 v145, s40, v145
    v_mfma_f32_16x16x32_bf16 a[68:71], v[88:91], v[48:51], a[68:71]
    ds_read_b64_tr_b16 v[80:81], v31 offset:8192
    v_add_u32 v102, 0x10000, v100
    v_mfma_f32_16x16x32_bf16 a[72:75], v[92:95], v[48:51], a[72:75]
    v_exp_f32 v144, v144
    v_add_f32 v134, 1.0, v134
    v_mfma_f32_16x16x32_bf16 a[76:79], v[96:99], v[48:51], a[76:79]
    s_waitcnt lgkmcnt(12)
    ds_read_b128 v[48:51], v28 offset:8192
    ds_read_b64_tr_b16 v[82:83], v31 offset:8704
    v_mfma_f32_16x16x32_bf16 a[80:83], v[84:87], v[52:55], a[80:83]
    s_add_u32 m0, s76, 32768
    v_mul_f32 v139, v131, v139
    v_mfma_f32_16x16x32_bf16 a[84:87], v[88:91], v[52:55], a[84:87]
    v_rcp_f32 v133, v133
    v_mul_f32 v154, v146, v154
    v_mfma_f32_16x16x32_bf16 a[88:91], v[92:95], v[52:55], a[88:91]
    buffer_load_dwordx4 v22, s[16:19], s26 offen offset:2048 sc1 lds
    v_add_u32 v103, 0x10000, v101
    v_mfma_f32_16x16x32_bf16 a[92:95], v[96:99], v[52:55], a[92:95]
    ds_read_b128 v[52:55], v28 offset:10240
    v_mul_f32 v146, s40, v146
    v_mfma_f32_16x16x32_bf16 a[96:99], v[84:87], v[56:59], a[96:99]
    v_exp_f32 v145, v145
    v_mfma_f32_16x16x32_bf16 a[100:103], v[88:91], v[56:59], a[100:103]
    buffer_load_dwordx4 v23, s[16:19], s26 offen offset:3072 sc1 lds
    v_cvt_pk_bf16_f32 v129, v138, v139
    v_mfma_f32_16x16x32_bf16 a[104:107], v[92:95], v[56:59], a[104:107]
    v_add_f32 v135, 1.0, v135
    v_mul_f32 v140, v132, v140
    v_mfma_f32_16x16x32_bf16 a[108:111], v[96:99], v[56:59], a[108:111]
    s_lshl_b32 s30, s20, 10
    ds_read_b128 v[56:59], v28 offset:12288
    v_mfma_f32_16x16x32_bf16 a[112:115], v[84:87], v[64:67], a[112:115]
    s_add_u32 s26, s26, 128
    v_rcp_f32 v134, v134
    v_mfma_f32_16x16x32_bf16 a[116:119], v[88:91], v[64:67], a[116:119]
    v_mul_f32 v155, v147, v155
    v_mul_f32 v147, s40, v147
    v_mfma_f32_16x16x32_bf16 a[120:123], v[92:95], v[64:67], a[120:123]
    v_exp_f32 v146, v146
    v_mfma_f32_16x16x32_bf16 a[124:127], v[96:99], v[64:67], a[124:127]
    s_waitcnt lgkmcnt(1)
    v_add_f32 v144, 1.0, v144
    v_mul_f32 v141, v133, v141
    v_mfma_f32_16x16x32_bf16 a[0:3], v[68:71], v[32:35], a[0:3]
    v_rcp_f32 v135, v135
    v_mfma_f32_16x16x32_bf16 a[4:7], v[72:75], v[32:35], a[4:7]
    s_barrier
    v_mfma_f32_16x16x32_bf16 a[8:11], v[76:79], v[32:35], a[8:11]
    s_add_u32 m0, s76, 65536
    s_add_u32 s30, s30, 49152
    ds_read_b128 v[64:67], v29 offset:14336
    v_mfma_f32_16x16x32_bf16 a[12:15], v[80:83], v[32:35], a[12:15]
    ds_read_b128 v[32:35], v29 offset:0
    v_mul_f32 v156, v148, v156
    v_mfma_f32_16x16x32_bf16 a[16:19], v[68:71], v[36:39], a[16:19]
    v_mul_f32 v148, s40, v148
    v_exp_f32 v147, v147
    v_mfma_f32_16x16x32_bf16 a[20:23], v[72:75], v[36:39], a[20:23]
    ds_read_b64_tr_b16 v[84:85], v30 offset:16384
    buffer_load_dwordx4 v24, s[12:15], s27 offen offset:0 lds
    v_mfma_f32_16x16x32_bf16 a[24:27], v[76:79], v[36:39], a[24:27]
    v_cvt_pk_bf16_f32 v130, v140, v141
    v_add_u32 v104, s30, v14
    v_add_f32 v145, 1.0, v145
    v_mfma_f32_16x16x32_bf16 a[28:31], v[80:83], v[36:39], a[28:31]
    ds_read_b128 v[36:39], v29 offset:2048
    ds_read_b64_tr_b16 v[86:87], v30 offset:16896
    v_mfma_f32_16x16x32_bf16 a[32:35], v[68:71], v[40:43], a[32:35]
    buffer_load_dwordx4 v25, s[12:15], s27 offen offset:1024 lds
    v_mul_f32 v142, v134, v142
    v_mfma_f32_16x16x32_bf16 a[36:39], v[72:75], v[40:43], a[36:39]
    ds_read_b64_tr_b16 v[88:89], v31 offset:16384
    v_rcp_f32 v144, v144
    v_mfma_f32_16x16x32_bf16 a[40:43], v[76:79], v[40:43], a[40:43]
    buffer_store_dwordx4 a[168:171], v14, s[16:19], s32 offen offset:1024 sc1
    v_mul_f32 v157, v149, v157
    v_mfma_f32_16x16x32_bf16 a[44:47], v[80:83], v[40:43], a[44:47]
    ds_read_b128 v[40:43], v29 offset:4096
    ds_read_b64_tr_b16 v[90:91], v31 offset:16896
    v_mul_f32 v149, s40, v149
    v_mfma_f32_16x16x32_bf16 a[48:51], v[68:71], v[44:47], a[48:51]
    buffer_load_dwordx4 v26, s[12:15], s27 offen offset:2048 lds
    v_add_u32 v105, 0x10000, v104
    v_exp_f32 v148, v148
    v_mfma_f32_16x16x32_bf16 a[52:55], v[72:75], v[44:47], a[52:55]
    ds_read_b64_tr_b16 v[92:93], v30 offset:24576
    v_add_f32 v146, 1.0, v146
    v_mfma_f32_16x16x32_bf16 a[56:59], v[76:79], v[44:47], a[56:59]
    buffer_load_dwordx4 v27, s[12:15], s27 offen offset:3072 lds
    v_mul_f32 v143, v135, v143
    v_rcp_f32 v145, v145
    v_mfma_f32_16x16x32_bf16 a[60:63], v[80:83], v[44:47], a[60:63]
    ds_read_b128 v[44:47], v29 offset:6144
    ds_read_b64_tr_b16 v[94:95], v30 offset:25088
    v_mfma_f32_16x16x32_bf16 a[64:67], v[68:71], v[48:51], a[64:67]
    v_mul_f32 v158, v150, v158
    v_mul_f32 v150, s40, v150
    v_mfma_f32_16x16x32_bf16 a[68:71], v[72:75], v[48:51], a[68:71]
    s_lshl_b32 s30, s21, 16
    ds_read_b64_tr_b16 v[96:97], v31 offset:24576
    v_mfma_f32_16x16x32_bf16 a[72:75], v[76:79], v[48:51], a[72:75]
    s_add_u32 s27, s27, 262144
    v_exp_f32 v149, v149
    v_mfma_f32_16x16x32_bf16 a[76:79], v[80:83], v[48:51], a[76:79]
    s_waitcnt lgkmcnt(12)
    ds_read_b128 v[48:51], v29 offset:8192
    ds_read_b64_tr_b16 v[98:99], v31 offset:25088
    v_cvt_pk_bf16_f32 v131, v142, v143
    v_mfma_f32_16x16x32_bf16 a[80:83], v[68:71], v[52:55], a[80:83]
    buffer_store_dwordx4 a[176:179], v14, s[16:19], s32 offen offset:2048 sc1
    v_add_f32 v147, 1.0, v147
    v_mfma_f32_16x16x32_bf16 a[84:87], v[72:75], v[52:55], a[84:87]
    s_add_u32 m0, s76, 49152
    v_mul_f32 v152, v144, v152
    v_mfma_f32_16x16x32_bf16 a[88:91], v[76:79], v[52:55], a[88:91]
    v_rcp_f32 v146, v146
    v_mfma_f32_16x16x32_bf16 a[92:95], v[80:83], v[52:55], a[92:95]
    s_add_u32 s30, s30, 49152
    ds_read_b128 v[52:55], v29 offset:10240
    v_mul_f32 v159, v151, v159
    v_mfma_f32_16x16x32_bf16 a[96:99], v[68:71], v[56:59], a[96:99]
    buffer_load_dwordx4 v20, s[16:19], s26 offen offset:0 sc1 lds
    v_mul_f32 v151, s40, v151
    v_mfma_f32_16x16x32_bf16 a[100:103], v[72:75], v[56:59], a[100:103]
    v_exp_f32 v150, v150
    v_mfma_f32_16x16x32_bf16 a[104:107], v[76:79], v[56:59], a[104:107]
    v_add_f32 v148, 1.0, v148
    v_mul_f32 v153, v145, v153
    v_mfma_f32_16x16x32_bf16 a[108:111], v[80:83], v[56:59], a[108:111]
    ds_read_b128 v[56:59], v29 offset:12288
    buffer_load_dwordx4 v21, s[16:19], s26 offen offset:1024 sc1 lds
    v_mfma_f32_16x16x32_bf16 a[112:115], v[68:71], v[60:63], a[112:115]
    v_add_u32 v106, s30, v14
    v_rcp_f32 v147, v147
    v_mfma_f32_16x16x32_bf16 a[116:119], v[72:75], v[60:63], a[116:119]
    v_mul_f32 v168, v160, v168
    v_mul_f32 v160, s40, v160
    v_mfma_f32_16x16x32_bf16 a[120:123], v[76:79], v[60:63], a[120:123]
    v_exp_f32 v151, v151
    v_mfma_f32_16x16x32_bf16 a[124:127], v[80:83], v[60:63], a[124:127]
    s_waitcnt lgkmcnt(1)
    v_cvt_pk_bf16_f32 v132, v152, v153
    v_add_f32 v149, 1.0, v149
    v_mfma_f32_16x16x32_bf16 a[0:3], v[84:87], v[32:35], a[0:3]
    s_waitcnt vmcnt(23)
    v_mul_f32 v154, v146, v154
    v_rcp_f32 v148, v148
    v_mfma_f32_16x16x32_bf16 a[4:7], v[88:91], v[32:35], a[4:7]
    s_barrier
    v_mfma_f32_16x16x32_bf16 a[8:11], v[92:95], v[32:35], a[8:11]
    s_add_u32 m0, s76, 81920
    s_mov_b32 s52, s100
    ds_read_b128 v[60:63], v28 offset:30720
    v_mfma_f32_16x16x32_bf16 a[12:15], v[96:99], v[32:35], a[12:15]
    ds_read_b128 v[32:35], v28 offset:16384
    v_mul_f32 v169, v161, v169
    v_mfma_f32_16x16x32_bf16 a[16:19], v[84:87], v[36:39], a[16:19]
    buffer_load_dwordx4 v24, s[12:15], s27 offen offset:0 lds
    v_mul_f32 v161, s40, v161
    v_mfma_f32_16x16x32_bf16 a[20:23], v[88:91], v[36:39], a[20:23]
    ds_read_b64_tr_b16 v[68:69], v30 offset:32768
    v_exp_f32 v160, v160
    v_mfma_f32_16x16x32_bf16 a[24:27], v[92:95], v[36:39], a[24:27]
    v_add_f32 v150, 1.0, v150
    v_mul_f32 v155, v147, v155
    v_mfma_f32_16x16x32_bf16 a[28:31], v[96:99], v[36:39], a[28:31]
    s_and_b32 s53, s101, 0xffff
    ds_read_b128 v[36:39], v28 offset:18432
    ds_read_b64_tr_b16 v[70:71], v30 offset:33280
    v_mfma_f32_16x16x32_bf16 a[32:35], v[84:87], v[40:43], a[32:35]
    buffer_load_dwordx4 v25, s[12:15], s27 offen offset:1024 lds
    v_rcp_f32 v149, v149
    v_mfma_f32_16x16x32_bf16 a[36:39], v[88:91], v[40:43], a[36:39]
    ds_read_b64_tr_b16 v[72:73], v31 offset:32768
    v_mul_f32 v170, v162, v170
    v_mfma_f32_16x16x32_bf16 a[40:43], v[92:95], v[40:43], a[40:43]
    buffer_load_dwordx4 v26, s[12:15], s27 offen offset:2048 lds
    v_mul_f32 v162, s40, v162
    v_exp_f32 v161, v161
    v_mfma_f32_16x16x32_bf16 a[44:47], v[96:99], v[40:43], a[44:47]
    ds_read_b128 v[40:43], v28 offset:20480
    ds_read_b64_tr_b16 v[74:75], v31 offset:33280
    v_cvt_pk_bf16_f32 v133, v154, v155
    v_mfma_f32_16x16x32_bf16 a[48:51], v[84:87], v[44:47], a[48:51]
    s_mov_b32 s54, 1605632
    buffer_store_dwordx4 a[184:187], v14, s[16:19], s32 offen offset:3072 sc1
    v_mfma_f32_16x16x32_bf16 a[52:55], v[88:91], v[44:47], a[52:55]
    ds_read_b64_tr_b16 v[76:77], v30 offset:40960
    buffer_load_dwordx4 v27, s[12:15], s27 offen offset:3072 lds
    v_mfma_f32_16x16x32_bf16 a[56:59], v[92:95], v[44:47], a[56:59]
    v_add_f32 v151, 1.0, v151
    v_mul_f32 v156, v148, v156
    v_rcp_f32 v150, v150
    v_mfma_f32_16x16x32_bf16 a[60:63], v[96:99], v[44:47], a[60:63]
    ds_read_b128 v[44:47], v28 offset:22528
    ds_read_b64_tr_b16 v[78:79], v30 offset:41472
    v_mfma_f32_16x16x32_bf16 a[64:67], v[84:87], v[48:51], a[64:67]
    s_add_u32 s27, s27, 262144
    v_mul_f32 v171, v163, v171
    v_mul_f32 v163, s40, v163
    v_mfma_f32_16x16x32_bf16 a[68:71], v[88:91], v[48:51], a[68:71]
    ds_read_b64_tr_b16 v[80:81], v31 offset:40960
    v_mfma_f32_16x16x32_bf16 a[72:75], v[92:95], v[48:51], a[72:75]
    s_mul_i32 s77, s24, 114688
    v_exp_f32 v162, v162
    v_mfma_f32_16x16x32_bf16 a[76:79], v[96:99], v[48:51], a[76:79]
    s_waitcnt lgkmcnt(12)
    ds_read_b128 v[48:51], v28 offset:24576
    ds_read_b64_tr_b16 v[82:83], v31 offset:41472
    v_mfma_f32_16x16x32_bf16 a[80:83], v[84:87], v[52:55], a[80:83]
    s_add_u32 m0, s76, 49152
    v_add_f32 v160, 1.0, v160
    v_mul_f32 v157, v149, v157
    v_mfma_f32_16x16x32_bf16 a[84:87], v[88:91], v[52:55], a[84:87]
    v_rcp_f32 v151, v151
    v_mfma_f32_16x16x32_bf16 a[88:91], v[92:95], v[52:55], a[88:91]
    buffer_load_dwordx4 v22, s[16:19], s26 offen offset:2048 sc1 lds
    v_mul_f32 v172, v164, v172
    v_mfma_f32_16x16x32_bf16 a[92:95], v[96:99], v[52:55], a[92:95]
    s_mov_b32 s48, s56
    ds_read_b128 v[52:55], v28 offset:26624
    v_mul_f32 v164, s40, v164
    v_mfma_f32_16x16x32_bf16 a[96:99], v[84:87], v[56:59], a[96:99]
    s_add_u32 s32, s32, 12288
    v_exp_f32 v163, v163
    v_mfma_f32_16x16x32_bf16 a[100:103], v[88:91], v[56:59], a[100:103]
    buffer_load_dwordx4 v23, s[16:19], s26 offen offset:3072 sc1 lds
    v_cvt_pk_bf16_f32 v134, v156, v157
    v_mfma_f32_16x16x32_bf16 a[104:107], v[92:95], v[56:59], a[104:107]
    v_add_f32 v161, 1.0, v161
    v_mul_f32 v158, v150, v158
    v_mfma_f32_16x16x32_bf16 a[108:111], v[96:99], v[56:59], a[108:111]
    ds_read_b128 v[56:59], v28 offset:28672
    v_mfma_f32_16x16x32_bf16 a[112:115], v[84:87], v[64:67], a[112:115]
    s_add_u32 s26, s26, 128
    v_rcp_f32 v160, v160
    v_mfma_f32_16x16x32_bf16 a[116:119], v[88:91], v[64:67], a[116:119]
    s_and_b32 s49, s57, 0xffff
    v_mul_f32 v173, v165, v173
    v_mul_f32 v165, s40, v165
    v_mfma_f32_16x16x32_bf16 a[120:123], v[92:95], v[64:67], a[120:123]
    v_exp_f32 v164, v164
    v_mfma_f32_16x16x32_bf16 a[124:127], v[96:99], v[64:67], a[124:127]
    s_waitcnt lgkmcnt(1)
    v_add_f32 v162, 1.0, v162
    v_mul_f32 v159, v151, v159
    v_mfma_f32_16x16x32_bf16 a[0:3], v[68:71], v[32:35], a[0:3]
    v_rcp_f32 v161, v161
    v_mfma_f32_16x16x32_bf16 a[4:7], v[72:75], v[32:35], a[4:7]
    s_barrier
    v_mfma_f32_16x16x32_bf16 a[8:11], v[76:79], v[32:35], a[8:11]
    s_add_u32 m0, s76, 98304
    s_mov_b32 s50, 1835008
    ds_read_b128 v[64:67], v29 offset:30720
    v_mfma_f32_16x16x32_bf16 a[12:15], v[80:83], v[32:35], a[12:15]
    ds_read_b128 v[32:35], v29 offset:16384
    v_mul_f32 v174, v166, v174
    v_mfma_f32_16x16x32_bf16 a[16:19], v[68:71], v[36:39], a[16:19]
    v_mul_f32 v166, s40, v166
    v_exp_f32 v165, v165
    v_mfma_f32_16x16x32_bf16 a[20:23], v[72:75], v[36:39], a[20:23]
    ds_read_b64_tr_b16 v[84:85], v30 offset:49152
    buffer_load_dwordx4 v24, s[12:15], s27 offen offset:0 lds
    v_mfma_f32_16x16x32_bf16 a[24:27], v[76:79], v[36:39], a[24:27]
    v_cvt_pk_bf16_f32 v135, v158, v159
    v_add_f32 v163, 1.0, v163
    v_mfma_f32_16x16x32_bf16 a[28:31], v[80:83], v[36:39], a[28:31]
    ds_read_b128 v[36:39], v29 offset:18432
    ds_read_b64_tr_b16 v[86:87], v30 offset:49664
    v_mfma_f32_16x16x32_bf16 a[32:35], v[68:71], v[40:43], a[32:35]
    s_mov_b32 s68, s28
    buffer_load_dwordx4 v25, s[12:15], s27 offen offset:1024 lds
    v_mul_f32 v168, v160, v168
    v_mfma_f32_16x16x32_bf16 a[36:39], v[72:75], v[40:43], a[36:39]
    ds_read_b64_tr_b16 v[88:89], v31 offset:49152
    v_rcp_f32 v162, v162
    v_mfma_f32_16x16x32_bf16 a[40:43], v[76:79], v[40:43], a[40:43]
    buffer_store_dwordx4 a[192:195], v14, s[16:19], s32 offen offset:0 sc1
    v_mul_f32 v175, v167, v175
    v_mfma_f32_16x16x32_bf16 a[44:47], v[80:83], v[40:43], a[44:47]
    ds_read_b128 v[40:43], v29 offset:20480
    ds_read_b64_tr_b16 v[90:91], v31 offset:49664
    v_mul_f32 v167, s40, v167
    v_mfma_f32_16x16x32_bf16 a[48:51], v[68:71], v[44:47], a[48:51]
    buffer_load_dwordx4 v26, s[12:15], s27 offen offset:2048 lds
    v_exp_f32 v166, v166
    v_mfma_f32_16x16x32_bf16 a[52:55], v[72:75], v[44:47], a[52:55]
    s_and_b32 s69, s29, 0xffff
    ds_read_b64_tr_b16 v[92:93], v30 offset:57344
    v_add_f32 v164, 1.0, v164
    v_mfma_f32_16x16x32_bf16 a[56:59], v[76:79], v[44:47], a[56:59]
    buffer_load_dwordx4 v27, s[12:15], s27 offen offset:3072 lds
    v_mul_f32 v169, v161, v169
    v_rcp_f32 v163, v163
    v_mfma_f32_16x16x32_bf16 a[60:63], v[80:83], v[44:47], a[60:63]
    ds_read_b128 v[44:47], v29 offset:22528
    ds_read_b64_tr_b16 v[94:95], v30 offset:57856
    v_mfma_f32_16x16x32_bf16 a[64:67], v[68:71], v[48:51], a[64:67]
    v_mul_f32 v184, v176, v184
    v_mul_f32 v176, s40, v176
    v_mfma_f32_16x16x32_bf16 a[68:71], v[72:75], v[48:51], a[68:71]
    ds_read_b64_tr_b16 v[96:97], v31 offset:57344
    v_mfma_f32_16x16x32_bf16 a[72:75], v[76:79], v[48:51], a[72:75]
    s_add_u32 s27, s27, 262144
    v_exp_f32 v167, v167
    v_mfma_f32_16x16x32_bf16 a[76:79], v[80:83], v[48:51], a[76:79]
    s_waitcnt lgkmcnt(12)
    ds_read_b128 v[48:51], v29 offset:24576
    ds_read_b64_tr_b16 v[98:99], v31 offset:57856
    v_mfma_f32_16x16x32_bf16 a[80:83], v[68:71], v[52:55], a[80:83]
    s_mov_b32 s70, 1835008
    v_cvt_pk_bf16_f32 v136, v168, v169
    v_add_f32 v165, 1.0, v165
    v_mfma_f32_16x16x32_bf16 a[84:87], v[72:75], v[52:55], a[84:87]
    s_add_u32 m0, s76, 0
    v_mul_f32 v170, v162, v170
    v_mfma_f32_16x16x32_bf16 a[88:91], v[76:79], v[52:55], a[88:91]
    v_rcp_f32 v164, v164
    v_mfma_f32_16x16x32_bf16 a[92:95], v[80:83], v[52:55], a[92:95]
    ds_read_b128 v[52:55], v29 offset:26624
    v_mul_f32 v185, v177, v185
    v_mfma_f32_16x16x32_bf16 a[96:99], v[68:71], v[56:59], a[96:99]
    s_mov_b32 s71, 0x00020000
    buffer_load_dwordx4 v20, s[16:19], s26 offen offset:0 sc1 lds
    v_mul_f32 v177, s40, v177
    v_mfma_f32_16x16x32_bf16 a[100:103], v[72:75], v[56:59], a[100:103]
    v_exp_f32 v176, v176
    v_mfma_f32_16x16x32_bf16 a[104:107], v[76:79], v[56:59], a[104:107]
    v_add_f32 v166, 1.0, v166
    v_mul_f32 v171, v163, v171
    v_mfma_f32_16x16x32_bf16 a[108:111], v[80:83], v[56:59], a[108:111]
    ds_read_b128 v[56:59], v29 offset:28672
    buffer_load_dwordx4 v21, s[16:19], s26 offen offset:1024 sc1 lds
    v_mfma_f32_16x16x32_bf16 a[112:115], v[68:71], v[60:63], a[112:115]
    v_rcp_f32 v165, v165
    v_mfma_f32_16x16x32_bf16 a[116:119], v[72:75], v[60:63], a[116:119]
    s_add_u32 s23, s34, 786432
    v_mul_f32 v186, v178, v186
    v_mul_f32 v178, s40, v178
    v_mfma_f32_16x16x32_bf16 a[120:123], v[76:79], v[60:63], a[120:123]
    v_exp_f32 v177, v177
    v_mfma_f32_16x16x32_bf16 a[124:127], v[80:83], v[60:63], a[124:127]
    s_waitcnt lgkmcnt(1)
    v_cvt_pk_bf16_f32 v137, v170, v171
    v_add_f32 v167, 1.0, v167
    v_mfma_f32_16x16x32_bf16 a[0:3], v[84:87], v[32:35], a[0:3]
    s_waitcnt vmcnt(22)
    v_mul_f32 v172, v164, v172
    v_rcp_f32 v166, v166
    v_mfma_f32_16x16x32_bf16 a[4:7], v[88:91], v[32:35], a[4:7]
    s_barrier
    v_mfma_f32_16x16x32_bf16 a[8:11], v[92:95], v[32:35], a[8:11]
    s_add_u32 m0, s76, 114688
    ds_read_b128 v[60:63], v28 offset:47104
    v_mul_f32 v187, v179, v187
    v_mfma_f32_16x16x32_bf16 a[12:15], v[96:99], v[32:35], a[12:15]
    s_lshl_b32 s30, s24, 1
    ds_read_b128 v[32:35], v28 offset:32768
    v_mul_f32 v179, s40, v179
    v_mfma_f32_16x16x32_bf16 a[16:19], v[84:87], v[36:39], a[16:19]
    buffer_load_dwordx4 v24, s[12:15], s27 offen offset:0 lds
    v_mfma_f32_16x16x32_bf16 a[20:23], v[88:91], v[36:39], a[20:23]
    ds_read_b64_tr_b16 v[68:69], v8 offset:0
    v_mfma_f32_16x16x32_bf16 a[24:27], v[92:95], v[36:39], a[24:27]
    v_exp_f32 v178, v178
    v_add_f32 v176, 1.0, v176
    v_mfma_f32_16x16x32_bf16 a[28:31], v[96:99], v[36:39], a[28:31]
    ds_read_b128 v[36:39], v28 offset:34816
    ds_read_b64_tr_b16 v[70:71], v8 offset:512
    v_mfma_f32_16x16x32_bf16 a[32:35], v[84:87], v[40:43], a[32:35]
    s_add_u32 s30, s30, s21
    buffer_load_dwordx4 v25, s[12:15], s27 offen offset:1024 lds
    v_mul_f32 v173, v165, v173
    v_mfma_f32_16x16x32_bf16 a[36:39], v[88:91], v[40:43], a[36:39]
    ds_read_b64_tr_b16 v[72:73], v9 offset:0
    v_rcp_f32 v167, v167
    v_mfma_f32_16x16x32_bf16 a[40:43], v[92:95], v[40:43], a[40:43]
    buffer_load_dwordx4 v26, s[12:15], s27 offen offset:2048 lds
    v_mul_f32 v188, v180, v188
    v_mul_f32 v180, s40, v180
    v_mfma_f32_16x16x32_bf16 a[44:47], v[96:99], v[40:43], a[44:47]
    ds_read_b128 v[40:43], v28 offset:36864
    ds_read_b64_tr_b16 v[74:75], v9 offset:512
    v_exp_f32 v179, v179
    v_mfma_f32_16x16x32_bf16 a[48:51], v[84:87], v[44:47], a[48:51]
    buffer_store_dwordx4 a[200:203], v14, s[16:19], s32 offen offset:1024 sc1
    v_cvt_pk_bf16_f32 v138, v172, v173
    v_mfma_f32_16x16x32_bf16 a[52:55], v[88:91], v[44:47], a[52:55]
    ds_read_b64_tr_b16 v[76:77], v8 offset:8192
    buffer_load_dwordx4 v27, s[12:15], s27 offen offset:3072 lds
    v_mfma_f32_16x16x32_bf16 a[56:59], v[92:95], v[44:47], a[56:59]
    s_lshl_b32 s30, s30, 12
    v_add_f32 v177, 1.0, v177
    v_mul_f32 v174, v166, v174
    v_mfma_f32_16x16x32_bf16 a[60:63], v[96:99], v[44:47], a[60:63]
    ds_read_b128 v[44:47], v28 offset:38912
    ds_read_b64_tr_b16 v[78:79], v8 offset:8704
    v_mfma_f32_16x16x32_bf16 a[64:67], v[84:87], v[48:51], a[64:67]
    s_add_u32 s27, s27, 262144
    v_rcp_f32 v176, v176
    v_mfma_f32_16x16x32_bf16 a[68:71], v[88:91], v[48:51], a[68:71]
    ds_read_b64_tr_b16 v[80:81], v9 offset:8192
    v_mul_f32 v189, v181, v189
    v_mfma_f32_16x16x32_bf16 a[72:75], v[92:95], v[48:51], a[72:75]
    v_mul_f32 v181, s40, v181
    v_exp_f32 v180, v180
    v_mfma_f32_16x16x32_bf16 a[76:79], v[96:99], v[48:51], a[76:79]
    s_waitcnt lgkmcnt(12)
    ds_read_b128 v[48:51], v28 offset:40960
    ds_read_b64_tr_b16 v[82:83], v9 offset:8704
    v_mfma_f32_16x16x32_bf16 a[80:83], v[84:87], v[52:55], a[80:83]
    s_add_u32 m0, s76, 0
    s_mul_i32 s29, s41, 1835008
    v_add_f32 v178, 1.0, v178
    v_mfma_f32_16x16x32_bf16 a[84:87], v[88:91], v[52:55], a[84:87]
    v_mul_f32 v175, v167, v175
    v_rcp_f32 v177, v177
    v_mfma_f32_16x16x32_bf16 a[88:91], v[92:95], v[52:55], a[88:91]
    buffer_load_dwordx4 v22, s[16:19], s26 offen offset:2048 sc1 lds
    v_mul_f32 v190, v182, v190
    v_mfma_f32_16x16x32_bf16 a[92:95], v[96:99], v[52:55], a[92:95]
    ds_read_b128 v[52:55], v28 offset:43008
    v_mul_f32 v182, s40, v182
    v_mfma_f32_16x16x32_bf16 a[96:99], v[84:87], v[56:59], a[96:99]
    v_exp_f32 v181, v181
    v_mfma_f32_16x16x32_bf16 a[100:103], v[88:91], v[56:59], a[100:103]
    s_add_u32 s29, s29, s30
    buffer_load_dwordx4 v23, s[16:19], s26 offen offset:3072 sc1 lds
    v_cvt_pk_bf16_f32 v139, v174, v175
    v_mfma_f32_16x16x32_bf16 a[104:107], v[92:95], v[56:59], a[104:107]
    v_add_f32 v179, 1.0, v179
    v_mul_f32 v184, v176, v184
    v_mfma_f32_16x16x32_bf16 a[108:111], v[96:99], v[56:59], a[108:111]
    ds_read_b128 v[56:59], v28 offset:45056
    v_mfma_f32_16x16x32_bf16 a[112:115], v[84:87], v[64:67], a[112:115]
    s_add_u32 s26, s26, 128
    v_rcp_f32 v178, v178
    v_mfma_f32_16x16x32_bf16 a[116:119], v[88:91], v[64:67], a[116:119]
    v_mul_f32 v191, v183, v191
    v_mul_f32 v183, s40, v183
    v_mfma_f32_16x16x32_bf16 a[120:123], v[92:95], v[64:67], a[120:123]
    s_lshl_b32 s30, s22, 17
    v_exp_f32 v182, v182
    v_mfma_f32_16x16x32_bf16 a[124:127], v[96:99], v[64:67], a[124:127]
    s_waitcnt lgkmcnt(1)
    v_add_f32 v180, 1.0, v180
    v_mul_f32 v185, v177, v185
    v_mfma_f32_16x16x32_bf16 a[0:3], v[68:71], v[32:35], a[0:3]
    v_rcp_f32 v179, v179
    v_mfma_f32_16x16x32_bf16 a[4:7], v[72:75], v[32:35], a[4:7]
    s_barrier
    v_mfma_f32_16x16x32_bf16 a[8:11], v[76:79], v[32:35], a[8:11]
    s_add_u32 m0, s76, 131072
    ds_read_b128 v[64:67], v29 offset:47104
    v_mul_f32 v200, v192, v200
    v_mfma_f32_16x16x32_bf16 a[12:15], v[80:83], v[32:35], a[12:15]
    ds_read_b128 v[32:35], v29 offset:32768
    v_mul_f32 v192, s40, v192
    v_mfma_f32_16x16x32_bf16 a[16:19], v[68:71], v[36:39], a[16:19]
    s_add_u32 s29, s29, s30
    v_exp_f32 v183, v183
    v_mfma_f32_16x16x32_bf16 a[20:23], v[72:75], v[36:39], a[20:23]
    ds_read_b64_tr_b16 v[84:85], v8 offset:16384
    buffer_load_dwordx4 v24, s[12:15], s27 offen offset:0 lds
    v_mfma_f32_16x16x32_bf16 a[24:27], v[76:79], v[36:39], a[24:27]
    v_cvt_pk_bf16_f32 v140, v184, v185
    v_add_f32 v181, 1.0, v181
    v_mfma_f32_16x16x32_bf16 a[28:31], v[80:83], v[36:39], a[28:31]
    ds_read_b128 v[36:39], v29 offset:34816
    ds_read_b64_tr_b16 v[86:87], v8 offset:16896
    v_mfma_f32_16x16x32_bf16 a[32:35], v[68:71], v[40:43], a[32:35]
    buffer_load_dwordx4 v25, s[12:15], s27 offen offset:1024 lds
    v_mul_f32 v186, v178, v186
    v_mfma_f32_16x16x32_bf16 a[36:39], v[72:75], v[40:43], a[36:39]
    s_add_u32 s28, s29, 39845888
    ds_read_b64_tr_b16 v[88:89], v9 offset:16384
    v_rcp_f32 v180, v180
    v_mfma_f32_16x16x32_bf16 a[40:43], v[76:79], v[40:43], a[40:43]
    buffer_store_dwordx4 a[208:211], v14, s[16:19], s32 offen offset:2048 sc1
    v_mul_f32 v201, v193, v201
    v_mfma_f32_16x16x32_bf16 a[44:47], v[80:83], v[40:43], a[44:47]
    ds_read_b128 v[40:43], v29 offset:36864
    ds_read_b64_tr_b16 v[90:91], v9 offset:16896
    v_mfma_f32_16x16x32_bf16 a[48:51], v[68:71], v[44:47], a[48:51]
    buffer_load_dwordx4 v26, s[12:15], s27 offen offset:2048 lds
    v_mul_f32 v193, s40, v193
    v_exp_f32 v192, v192
    v_mfma_f32_16x16x32_bf16 a[52:55], v[72:75], v[44:47], a[52:55]
    ds_read_b64_tr_b16 v[92:93], v8 offset:24576
    v_add_f32 v182, 1.0, v182
    v_mfma_f32_16x16x32_bf16 a[56:59], v[76:79], v[44:47], a[56:59]
    s_add_u32 s29, s29, 69206016
    buffer_load_dwordx4 v27, s[12:15], s27 offen offset:3072 lds
    v_mul_f32 v187, v179, v187
    v_rcp_f32 v181, v181
    v_mfma_f32_16x16x32_bf16 a[60:63], v[80:83], v[44:47], a[60:63]
    ds_read_b128 v[44:47], v29 offset:38912
    ds_read_b64_tr_b16 v[94:95], v8 offset:25088
    v_mfma_f32_16x16x32_bf16 a[64:67], v[68:71], v[48:51], a[64:67]
    v_mul_f32 v202, v194, v202
    v_mul_f32 v194, s40, v194
    v_mfma_f32_16x16x32_bf16 a[68:71], v[72:75], v[48:51], a[68:71]
    ds_read_b64_tr_b16 v[96:97], v9 offset:24576
    v_exp_f32 v193, v193
    v_mfma_f32_16x16x32_bf16 a[72:75], v[76:79], v[48:51], a[72:75]
    s_add_u32 s27, s27, 262144
    buffer_store_dwordx4 a[216:219], v14, s[16:19], s32 offen offset:3072 sc1
    v_mfma_f32_16x16x32_bf16 a[76:79], v[80:83], v[48:51], a[76:79]
    s_waitcnt lgkmcnt(12)
    ds_read_b128 v[48:51], v29 offset:40960
    ds_read_b64_tr_b16 v[98:99], v9 offset:25088
    v_mfma_f32_16x16x32_bf16 a[80:83], v[68:71], v[52:55], a[80:83]
    s_lshl_b32 s25, s20, 7
    v_cvt_pk_bf16_f32 v141, v186, v187
    v_add_f32 v183, 1.0, v183
    v_mfma_f32_16x16x32_bf16 a[84:87], v[72:75], v[52:55], a[84:87]
    s_add_u32 m0, s76, 16384
    v_mul_f32 v188, v180, v188
    v_mfma_f32_16x16x32_bf16 a[88:91], v[76:79], v[52:55], a[88:91]
    v_rcp_f32 v182, v182
    v_mfma_f32_16x16x32_bf16 a[92:95], v[80:83], v[52:55], a[92:95]
    ds_read_b128 v[52:55], v29 offset:43008
    v_mul_f32 v203, v195, v203
    v_mfma_f32_16x16x32_bf16 a[96:99], v[68:71], v[56:59], a[96:99]
    buffer_load_dwordx4 v20, s[16:19], s26 offen offset:0 sc1 lds
    v_mul_f32 v195, s40, v195
    v_mfma_f32_16x16x32_bf16 a[100:103], v[72:75], v[56:59], a[100:103]
    s_add_u32 s25, s25, s3
    v_exp_f32 v194, v194
    v_mfma_f32_16x16x32_bf16 a[104:107], v[76:79], v[56:59], a[104:107]
    v_add_f32 v192, 1.0, v192
    v_mul_f32 v189, v181, v189
    v_mfma_f32_16x16x32_bf16 a[108:111], v[80:83], v[56:59], a[108:111]
    s_add_u32 s32, s32, 4096
    ds_read_b128 v[56:59], v29 offset:45056
    buffer_load_dwordx4 v21, s[16:19], s26 offen offset:1024 sc1 lds
    v_mfma_f32_16x16x32_bf16 a[112:115], v[68:71], v[60:63], a[112:115]
    v_rcp_f32 v183, v183
    v_mfma_f32_16x16x32_bf16 a[116:119], v[72:75], v[60:63], a[116:119]
    v_mul_f32 v204, v196, v204
    v_mul_f32 v196, s40, v196
    v_mfma_f32_16x16x32_bf16 a[120:123], v[76:79], v[60:63], a[120:123]
    v_exp_f32 v195, v195
    v_mfma_f32_16x16x32_bf16 a[124:127], v[80:83], v[60:63], a[124:127]
    s_waitcnt lgkmcnt(1)
    s_add_u32 s25, s25, 512
    v_cvt_pk_bf16_f32 v142, v188, v189
    v_mfma_f32_16x16x32_bf16 a[0:3], v[84:87], v[32:35], a[0:3]
    s_waitcnt vmcnt(22)
    v_add_f32 v193, 1.0, v193
    v_mul_f32 v190, v182, v190
    v_mfma_f32_16x16x32_bf16 a[4:7], v[88:91], v[32:35], a[4:7]
    s_barrier
    v_mfma_f32_16x16x32_bf16 a[8:11], v[92:95], v[32:35], a[8:11]
    s_add_u32 m0, s76, 147456
    ds_read_b128 v[60:63], v28 offset:63488
    v_rcp_f32 v192, v192
    v_mfma_f32_16x16x32_bf16 a[12:15], v[96:99], v[32:35], a[12:15]
    ds_read_b128 v[32:35], v28 offset:49152
    v_mul_f32 v205, v197, v205
    v_mfma_f32_16x16x32_bf16 a[16:19], v[84:87], v[36:39], a[16:19]
    s_bfe_u32 s35, s24, 0x20001
    buffer_load_dwordx4 v24, s[12:15], s27 offen offset:0 lds
    v_mul_f32 v197, s40, v197
    v_mfma_f32_16x16x32_bf16 a[20:23], v[88:91], v[36:39], a[20:23]
    ds_read_b64_tr_b16 v[68:69], v30 offset:0
    v_mfma_f32_16x16x32_bf16 a[24:27], v[92:95], v[36:39], a[24:27]
    v_exp_f32 v196, v196
    v_mfma_f32_16x16x32_bf16 a[28:31], v[96:99], v[36:39], a[28:31]
    ds_read_b128 v[36:39], v28 offset:51200
    ds_read_b64_tr_b16 v[70:71], v30 offset:512
    v_mfma_f32_16x16x32_bf16 a[32:35], v[84:87], v[40:43], a[32:35]
    buffer_load_dwordx4 v25, s[12:15], s27 offen offset:1024 lds
    v_add_f32 v194, 1.0, v194
    v_mul_f32 v191, v183, v191
    v_mfma_f32_16x16x32_bf16 a[36:39], v[88:91], v[40:43], a[36:39]
    ds_read_b64_tr_b16 v[72:73], v31 offset:0
    v_rcp_f32 v193, v193
    v_mfma_f32_16x16x32_bf16 a[40:43], v[92:95], v[40:43], a[40:43]
    s_lshl_b32 s35, s35, 7
    buffer_load_dwordx4 v26, s[12:15], s27 offen offset:2048 lds
    v_mul_f32 v206, v198, v206
    v_mul_f32 v198, s40, v198
    v_mfma_f32_16x16x32_bf16 a[44:47], v[96:99], v[40:43], a[44:47]
    ds_read_b128 v[40:43], v28 offset:53248
    ds_read_b64_tr_b16 v[74:75], v31 offset:512
    v_exp_f32 v197, v197
    v_mfma_f32_16x16x32_bf16 a[48:51], v[84:87], v[44:47], a[48:51]
    buffer_store_dwordx4 a[224:227], v14, s[16:19], s32 offen offset:0 sc1
    v_mfma_f32_16x16x32_bf16 a[52:55], v[88:91], v[44:47], a[52:55]
    ds_read_b64_tr_b16 v[76:77], v30 offset:8192
    buffer_load_dwordx4 v27, s[12:15], s27 offen offset:3072 lds
    v_mfma_f32_16x16x32_bf16 a[56:59], v[92:95], v[44:47], a[56:59]
    v_cvt_pk_bf16_f32 v143, v190, v191
    v_add_f32 v195, 1.0, v195
    v_mul_f32 v200, v192, v200
    v_mfma_f32_16x16x32_bf16 a[60:63], v[96:99], v[44:47], a[60:63]
    s_lshl_b32 s30, s41, 10
    ds_read_b128 v[44:47], v28 offset:55296
    ds_read_b64_tr_b16 v[78:79], v30 offset:8704
    v_mfma_f32_16x16x32_bf16 a[64:67], v[84:87], v[48:51], a[64:67]
    s_add_u32 s27, s27, 262144
    v_rcp_f32 v194, v194
    v_mfma_f32_16x16x32_bf16 a[68:71], v[88:91], v[48:51], a[68:71]
    ds_read_b64_tr_b16 v[80:81], v31 offset:8192
    v_mul_f32 v207, v199, v207
    v_mfma_f32_16x16x32_bf16 a[72:75], v[92:95], v[48:51], a[72:75]
    v_mul_f32 v199, s40, v199
    v_exp_f32 v198, v198
    v_mfma_f32_16x16x32_bf16 a[76:79], v[96:99], v[48:51], a[76:79]
    s_waitcnt lgkmcnt(12)
    ds_read_b128 v[48:51], v28 offset:57344
    ds_read_b64_tr_b16 v[82:83], v31 offset:8704
    v_mfma_f32_16x16x32_bf16 a[80:83], v[84:87], v[52:55], a[80:83]
    s_add_u32 m0, s76, 16384
    v_add_f32 v196, 1.0, v196
    v_mul_f32 v201, v193, v201
    v_mfma_f32_16x16x32_bf16 a[84:87], v[88:91], v[52:55], a[84:87]
    s_add_u32 s35, s35, s30
    v_rcp_f32 v195, v195
    v_mfma_f32_16x16x32_bf16 a[88:91], v[92:95], v[52:55], a[88:91]
    buffer_load_dwordx4 v22, s[16:19], s26 offen offset:2048 sc1 lds
    v_mul_f32 v216, v208, v216
    v_mfma_f32_16x16x32_bf16 a[92:95], v[96:99], v[52:55], a[92:95]
    ds_read_b128 v[52:55], v28 offset:59392
    v_mul_f32 v208, s40, v208
    v_mfma_f32_16x16x32_bf16 a[96:99], v[84:87], v[56:59], a[96:99]
    v_exp_f32 v199, v199
    v_mfma_f32_16x16x32_bf16 a[100:103], v[88:91], v[56:59], a[100:103]
    buffer_load_dwordx4 v23, s[16:19], s26 offen offset:3072 sc1 lds
    v_cvt_pk_bf16_f32 v144, v200, v201
    v_mfma_f32_16x16x32_bf16 a[104:107], v[92:95], v[56:59], a[104:107]
    s_add_u32 s35, s35, 34603520
    v_add_f32 v197, 1.0, v197
    v_mul_f32 v202, v194, v202
    v_mfma_f32_16x16x32_bf16 a[108:111], v[96:99], v[56:59], a[108:111]
    ds_read_b128 v[56:59], v28 offset:61440
    v_mfma_f32_16x16x32_bf16 a[112:115], v[84:87], v[64:67], a[112:115]
    s_add_u32 s26, s26, 128
    v_rcp_f32 v196, v196
    v_mfma_f32_16x16x32_bf16 a[116:119], v[88:91], v[64:67], a[116:119]
    v_mul_f32 v217, v209, v217
    v_mul_f32 v209, s40, v209
    v_mfma_f32_16x16x32_bf16 a[120:123], v[92:95], v[64:67], a[120:123]
    v_exp_f32 v208, v208
    v_mfma_f32_16x16x32_bf16 a[124:127], v[96:99], v[64:67], a[124:127]
    s_waitcnt lgkmcnt(1)
    v_add_f32 v198, 1.0, v198
    v_mul_f32 v203, v195, v203
    v_mfma_f32_16x16x32_bf16 a[0:3], v[68:71], v[32:35], a[0:3]
    s_lshl_b32 s30, s20, 11
    v_rcp_f32 v197, v197
    v_mfma_f32_16x16x32_bf16 a[4:7], v[72:75], v[32:35], a[4:7]
    s_barrier
    v_mfma_f32_16x16x32_bf16 a[8:11], v[76:79], v[32:35], a[8:11]
    s_add_u32 s31, s77, 0
    ds_read_b128 v[64:67], v29 offset:63488
    v_mul_f32 v218, v210, v218
    v_mfma_f32_16x16x32_bf16 a[12:15], v[80:83], v[32:35], a[12:15]
    ds_read_b128 v[32:35], v29 offset:49152
    v_mul_f32 v210, s40, v210
    v_mfma_f32_16x16x32_bf16 a[16:19], v[68:71], v[36:39], a[16:19]
    v_exp_f32 v209, v209
    v_mfma_f32_16x16x32_bf16 a[20:23], v[72:75], v[36:39], a[20:23]
    ds_read_b64_tr_b16 v[84:85], v30 offset:16384
    v_cvt_pk_bf16_f32 v145, v202, v203
    v_mfma_f32_16x16x32_bf16 a[24:27], v[76:79], v[36:39], a[24:27]
    s_add_u32 m0, s76, 65536
    v_add_u32 v24, s30, v14
    v_add_f32 v199, 1.0, v199
    v_mfma_f32_16x16x32_bf16 a[28:31], v[80:83], v[36:39], a[28:31]
    ds_read_b128 v[36:39], v29 offset:51200
    ds_read_b64_tr_b16 v[86:87], v30 offset:16896
    v_mfma_f32_16x16x32_bf16 a[32:35], v[68:71], v[40:43], a[32:35]
    buffer_store_dwordx4 a[232:235], v14, s[16:19], s32 offen offset:1024 sc1
    v_mfma_f32_16x16x32_bf16 a[36:39], v[72:75], v[40:43], a[36:39]
    ds_read_b64_tr_b16 v[88:89], v31 offset:16384
    v_mul_f32 v204, v196, v204
    v_mfma_f32_16x16x32_bf16 a[40:43], v[76:79], v[40:43], a[40:43]
    v_rcp_f32 v198, v198
    v_mul_f32 v219, v211, v219
    v_mfma_f32_16x16x32_bf16 a[44:47], v[80:83], v[40:43], a[44:47]
    ds_read_b128 v[40:43], v29 offset:53248
    ds_read_b64_tr_b16 v[90:91], v31 offset:16896
    v_mul_f32 v211, s40, v211
    v_mfma_f32_16x16x32_bf16 a[48:51], v[68:71], v[44:47], a[48:51]
    buffer_load_dwordx4 v10, s[52:55], s31 offen offset:0 lds
    v_add_u32 v25, 0x20000, v24
    v_mfma_f32_16x16x32_bf16 a[52:55], v[72:75], v[44:47], a[52:55]
    ds_read_b64_tr_b16 v[92:93], v30 offset:24576
    v_exp_f32 v210, v210
    v_mfma_f32_16x16x32_bf16 a[56:59], v[76:79], v[44:47], a[56:59]
    v_add_f32 v208, 1.0, v208
    v_mul_f32 v205, v197, v205
    v_mfma_f32_16x16x32_bf16 a[60:63], v[80:83], v[44:47], a[60:63]
    ds_read_b128 v[44:47], v29 offset:55296
    ds_read_b64_tr_b16 v[94:95], v30 offset:25088
    v_mfma_f32_16x16x32_bf16 a[64:67], v[68:71], v[48:51], a[64:67]
    buffer_load_dwordx4 v11, s[52:55], s31 offen offset:1024 lds
    v_rcp_f32 v199, v199
    v_mfma_f32_16x16x32_bf16 a[68:71], v[72:75], v[48:51], a[68:71]
    ds_read_b64_tr_b16 v[96:97], v31 offset:24576
    v_mul_f32 v220, v212, v220
    v_mfma_f32_16x16x32_bf16 a[72:75], v[76:79], v[48:51], a[72:75]
    v_mul_f32 v212, s40, v212
    v_exp_f32 v211, v211
    v_mfma_f32_16x16x32_bf16 a[76:79], v[80:83], v[48:51], a[76:79]
    s_waitcnt lgkmcnt(12)
    ds_read_b128 v[48:51], v29 offset:57344
    ds_read_b64_tr_b16 v[98:99], v31 offset:25088
    v_mfma_f32_16x16x32_bf16 a[80:83], v[68:71], v[52:55], a[80:83]
    s_mov_b32 s26, 0
    v_cvt_pk_bf16_f32 v146, v204, v205
    v_add_f32 v209, 1.0, v209
    v_mfma_f32_16x16x32_bf16 a[84:87], v[72:75], v[52:55], a[84:87]
    buffer_load_dwordx4 v12, s[52:55], s31 offen offset:2048 lds
    v_mul_f32 v206, v198, v206
    v_mfma_f32_16x16x32_bf16 a[88:91], v[76:79], v[52:55], a[88:91]
    v_rcp_f32 v208, v208
    v_mfma_f32_16x16x32_bf16 a[92:95], v[80:83], v[52:55], a[92:95]
    ds_read_b128 v[52:55], v29 offset:59392
    v_mul_f32 v221, v213, v221
    v_mfma_f32_16x16x32_bf16 a[96:99], v[68:71], v[56:59], a[96:99]
    v_mul_f32 v213, s40, v213
    v_mfma_f32_16x16x32_bf16 a[100:103], v[72:75], v[56:59], a[100:103]
    s_add_u32 s27, s7, 1835008
    v_exp_f32 v212, v212
    v_mfma_f32_16x16x32_bf16 a[104:107], v[76:79], v[56:59], a[104:107]
    buffer_load_dwordx4 v13, s[52:55], s31 offen offset:3072 lds
    v_add_f32 v210, 1.0, v210
    v_mfma_f32_16x16x32_bf16 a[108:111], v[80:83], v[56:59], a[108:111]
    ds_read_b128 v[56:59], v29 offset:61440
    v_mul_f32 v207, v199, v207
    v_mfma_f32_16x16x32_bf16 a[112:115], v[68:71], v[60:63], a[112:115]
    v_rcp_f32 v209, v209
    v_mfma_f32_16x16x32_bf16 a[116:119], v[72:75], v[60:63], a[116:119]
    v_mul_f32 v222, v214, v222
    v_mul_f32 v214, s40, v214
    v_mfma_f32_16x16x32_bf16 a[120:123], v[76:79], v[60:63], a[120:123]
    v_exp_f32 v213, v213
    v_mfma_f32_16x16x32_bf16 a[124:127], v[80:83], v[60:63], a[124:127]
    s_waitcnt lgkmcnt(1)
    v_cvt_pk_bf16_f32 v147, v206, v207
    v_add_f32 v211, 1.0, v211
    v_mfma_f32_16x16x32_bf16 a[0:3], v[84:87], v[32:35], a[0:3]
    s_waitcnt vmcnt(20)
    v_mov_b32 v20, 0
    v_mul_f32 v216, v208, v216
    v_mfma_f32_16x16x32_bf16 a[4:7], v[88:91], v[32:35], a[4:7]
    s_barrier
    v_mfma_f32_16x16x32_bf16 a[8:11], v[92:95], v[32:35], a[8:11]
    s_add_u32 s31, s77, 128
    ds_read_b128 v[60:63], v28 offset:14336
    v_mfma_f32_16x16x32_bf16 a[12:15], v[96:99], v[32:35], a[12:15]
    ds_read_b128 v[32:35], v28 offset:0
    v_mfma_f32_16x16x32_bf16 a[16:19], v[84:87], v[36:39], a[16:19]
    v_rcp_f32 v210, v210
    v_mfma_f32_16x16x32_bf16 a[20:23], v[88:91], v[36:39], a[20:23]
    ds_read_b64_tr_b16 v[68:69], v30 offset:32768
    v_mul_f32 v223, v215, v223
    v_mfma_f32_16x16x32_bf16 a[24:27], v[92:95], v[36:39], a[24:27]
    s_add_u32 m0, s76, 81920
    v_mov_b32 v21, 0
    v_mul_f32 v215, s40, v215
    v_exp_f32 v214, v214
    v_mfma_f32_16x16x32_bf16 a[28:31], v[96:99], v[36:39], a[28:31]
    ds_read_b128 v[36:39], v28 offset:2048
    ds_read_b64_tr_b16 v[70:71], v30 offset:33280
    v_add_f32 v212, 1.0, v212
    v_mfma_f32_16x16x32_bf16 a[32:35], v[84:87], v[40:43], a[32:35]
    buffer_store_dwordx4 a[240:243], v14, s[16:19], s32 offen offset:2048 sc1
    v_mfma_f32_16x16x32_bf16 a[36:39], v[88:91], v[40:43], a[36:39]
    ds_read_b64_tr_b16 v[72:73], v31 offset:32768
    v_mul_f32 v217, v209, v217
    v_mfma_f32_16x16x32_bf16 a[40:43], v[92:95], v[40:43], a[40:43]
    v_rcp_f32 v211, v211
    v_mul_f32 v232, v224, v232
    v_mfma_f32_16x16x32_bf16 a[44:47], v[96:99], v[40:43], a[44:47]
    ds_read_b128 v[40:43], v28 offset:4096
    ds_read_b64_tr_b16 v[74:75], v31 offset:33280
    v_mul_f32 v224, s40, v224
    v_mfma_f32_16x16x32_bf16 a[48:51], v[84:87], v[44:47], a[48:51]
    buffer_load_dwordx4 v10, s[52:55], s31 offen offset:0 lds
    v_mov_b32 v22, 0
    v_mfma_f32_16x16x32_bf16 a[52:55], v[88:91], v[44:47], a[52:55]
    ds_read_b64_tr_b16 v[76:77], v30 offset:40960
    v_exp_f32 v215, v215
    v_mfma_f32_16x16x32_bf16 a[56:59], v[92:95], v[44:47], a[56:59]
    v_cvt_pk_bf16_f32 v148, v216, v217
    v_add_f32 v213, 1.0, v213
    v_mfma_f32_16x16x32_bf16 a[60:63], v[96:99], v[44:47], a[60:63]
    ds_read_b128 v[44:47], v28 offset:6144
    ds_read_b64_tr_b16 v[78:79], v30 offset:41472
    v_mfma_f32_16x16x32_bf16 a[64:67], v[84:87], v[48:51], a[64:67]
    buffer_load_dwordx4 v11, s[52:55], s31 offen offset:1024 lds
    v_mul_f32 v218, v210, v218
    v_rcp_f32 v212, v212
    v_mfma_f32_16x16x32_bf16 a[68:71], v[88:91], v[48:51], a[68:71]
    ds_read_b64_tr_b16 v[80:81], v31 offset:40960
    v_mul_f32 v233, v225, v233
    v_mfma_f32_16x16x32_bf16 a[72:75], v[92:95], v[48:51], a[72:75]
    v_mul_f32 v225, s40, v225
    v_exp_f32 v224, v224
    v_mfma_f32_16x16x32_bf16 a[76:79], v[96:99], v[48:51], a[76:79]
    s_waitcnt lgkmcnt(12)
    ds_read_b128 v[48:51], v28 offset:8192
    ds_read_b64_tr_b16 v[82:83], v31 offset:41472
    v_mfma_f32_16x16x32_bf16 a[80:83], v[84:87], v[52:55], a[80:83]
    v_mov_b32 v23, 0
    v_add_f32 v214, 1.0, v214
    v_mfma_f32_16x16x32_bf16 a[84:87], v[88:91], v[52:55], a[84:87]
    buffer_load_dwordx4 v12, s[52:55], s31 offen offset:2048 lds
    v_mul_f32 v219, v211, v219
    v_mfma_f32_16x16x32_bf16 a[88:91], v[92:95], v[52:55], a[88:91]
    v_rcp_f32 v213, v213
    v_mfma_f32_16x16x32_bf16 a[92:95], v[96:99], v[52:55], a[92:95]
    ds_read_b128 v[52:55], v28 offset:10240
    v_mul_f32 v234, v226, v234
    v_mfma_f32_16x16x32_bf16 a[96:99], v[84:87], v[56:59], a[96:99]
    v_mul_f32 v226, s40, v226
    v_exp_f32 v225, v225
    v_mfma_f32_16x16x32_bf16 a[100:103], v[88:91], v[56:59], a[100:103]
    v_cvt_pk_bf16_f32 v149, v218, v219
    v_mov_b32 v112, 0
    v_mfma_f32_16x16x32_bf16 a[104:107], v[92:95], v[56:59], a[104:107]
    buffer_load_dwordx4 v13, s[52:55], s31 offen offset:3072 lds
    v_add_f32 v215, 1.0, v215
    v_mfma_f32_16x16x32_bf16 a[108:111], v[96:99], v[56:59], a[108:111]
    ds_read_b128 v[56:59], v28 offset:12288
    v_mul_f32 v220, v212, v220
    v_mfma_f32_16x16x32_bf16 a[112:115], v[84:87], v[64:67], a[112:115]
    v_rcp_f32 v214, v214
    v_mfma_f32_16x16x32_bf16 a[116:119], v[88:91], v[64:67], a[116:119]
    v_mul_f32 v235, v227, v235
    v_mul_f32 v227, s40, v227
    v_mfma_f32_16x16x32_bf16 a[120:123], v[92:95], v[64:67], a[120:123]
    v_exp_f32 v226, v226
    v_mfma_f32_16x16x32_bf16 a[124:127], v[96:99], v[64:67], a[124:127]
    s_waitcnt lgkmcnt(1)
    v_add_f32 v224, 1.0, v224
    v_mul_f32 v221, v213, v221
    v_mfma_f32_16x16x32_bf16 a[0:3], v[68:71], v[32:35], a[0:3]
    v_mov_b32 v113, 0
    v_rcp_f32 v215, v215
    v_mfma_f32_16x16x32_bf16 a[4:7], v[72:75], v[32:35], a[4:7]
    s_barrier
    v_mfma_f32_16x16x32_bf16 a[8:11], v[76:79], v[32:35], a[8:11]
    s_add_u32 s31, s77, 384
    ds_read_b128 v[64:67], v29 offset:14336
    v_mul_f32 v236, v228, v236
    v_mfma_f32_16x16x32_bf16 a[12:15], v[80:83], v[32:35], a[12:15]
    ds_read_b128 v[32:35], v29 offset:0
    v_mul_f32 v228, s40, v228
    v_mfma_f32_16x16x32_bf16 a[16:19], v[68:71], v[36:39], a[16:19]
    v_exp_f32 v227, v227
    v_mfma_f32_16x16x32_bf16 a[20:23], v[72:75], v[36:39], a[20:23]
    ds_read_b64_tr_b16 v[84:85], v30 offset:49152
    v_cvt_pk_bf16_f32 v150, v220, v221
    v_mfma_f32_16x16x32_bf16 a[24:27], v[76:79], v[36:39], a[24:27]
    s_add_u32 m0, s76, 32768
    v_mov_b32 v114, 0
    v_add_f32 v225, 1.0, v225
    v_mfma_f32_16x16x32_bf16 a[28:31], v[80:83], v[36:39], a[28:31]
    ds_read_b128 v[36:39], v29 offset:2048
    ds_read_b64_tr_b16 v[86:87], v30 offset:49664
    v_mfma_f32_16x16x32_bf16 a[32:35], v[68:71], v[40:43], a[32:35]
    buffer_store_dwordx4 a[248:251], v14, s[16:19], s32 offen offset:3072 sc1
    v_mfma_f32_16x16x32_bf16 a[36:39], v[72:75], v[40:43], a[36:39]
    ds_read_b64_tr_b16 v[88:89], v31 offset:49152
    v_mul_f32 v222, v214, v222
    v_mfma_f32_16x16x32_bf16 a[40:43], v[76:79], v[40:43], a[40:43]
    v_rcp_f32 v224, v224
    v_mul_f32 v237, v229, v237
    v_mfma_f32_16x16x32_bf16 a[44:47], v[80:83], v[40:43], a[44:47]
    ds_read_b128 v[40:43], v29 offset:4096
    ds_read_b64_tr_b16 v[90:91], v31 offset:49664
    v_mul_f32 v229, s40, v229
    v_mfma_f32_16x16x32_bf16 a[48:51], v[68:71], v[44:47], a[48:51]
    buffer_load_dwordx4 v10, s[52:55], s31 offen offset:0 lds
    v_mov_b32 v115, 0
    v_mfma_f32_16x16x32_bf16 a[52:55], v[72:75], v[44:47], a[52:55]
    ds_read_b64_tr_b16 v[92:93], v30 offset:57344
    v_exp_f32 v228, v228
    v_mfma_f32_16x16x32_bf16 a[56:59], v[76:79], v[44:47], a[56:59]
    v_add_f32 v226, 1.0, v226
    v_mul_f32 v223, v215, v223
    v_mfma_f32_16x16x32_bf16 a[60:63], v[80:83], v[44:47], a[60:63]
    ds_read_b128 v[44:47], v29 offset:6144
    ds_read_b64_tr_b16 v[94:95], v30 offset:57856
    v_mfma_f32_16x16x32_bf16 a[64:67], v[68:71], v[48:51], a[64:67]
    buffer_load_dwordx4 v11, s[52:55], s31 offen offset:1024 lds
    v_rcp_f32 v225, v225
    v_mfma_f32_16x16x32_bf16 a[68:71], v[72:75], v[48:51], a[68:71]
    ds_read_b64_tr_b16 v[96:97], v31 offset:57344
    v_mul_f32 v238, v230, v238
    v_mfma_f32_16x16x32_bf16 a[72:75], v[76:79], v[48:51], a[72:75]
    v_mul_f32 v230, s40, v230
    v_exp_f32 v229, v229
    v_mfma_f32_16x16x32_bf16 a[76:79], v[80:83], v[48:51], a[76:79]
    s_waitcnt lgkmcnt(12)
    ds_read_b128 v[48:51], v29 offset:8192
    ds_read_b64_tr_b16 v[98:99], v31 offset:57856
    v_mfma_f32_16x16x32_bf16 a[80:83], v[68:71], v[52:55], a[80:83]
    v_cvt_pk_bf16_f32 v151, v222, v223
    v_mov_b32 v116, 0
    v_mfma_f32_16x16x32_bf16 a[84:87], v[72:75], v[52:55], a[84:87]
    buffer_load_dwordx4 v12, s[52:55], s31 offen offset:2048 lds
    v_add_f32 v227, 1.0, v227
    v_mfma_f32_16x16x32_bf16 a[88:91], v[76:79], v[52:55], a[88:91]
    v_mul_f32 v232, v224, v232
    v_rcp_f32 v226, v226
    v_mfma_f32_16x16x32_bf16 a[92:95], v[80:83], v[52:55], a[92:95]
    ds_read_b128 v[52:55], v29 offset:10240
    v_mul_f32 v239, v231, v239
    v_mfma_f32_16x16x32_bf16 a[96:99], v[68:71], v[56:59], a[96:99]
    s_add_u32 s32, s32, 12288
    v_mul_f32 v231, s40, v231
    v_exp_f32 v230, v230
    v_mfma_f32_16x16x32_bf16 a[100:103], v[72:75], v[56:59], a[100:103]
    v_mov_b32 v117, 0
    v_add_f32 v228, 1.0, v228
    v_mfma_f32_16x16x32_bf16 a[104:107], v[76:79], v[56:59], a[104:107]
    buffer_load_dwordx4 v13, s[52:55], s31 offen offset:3072 lds
    v_mul_f32 v233, v225, v233
    v_mfma_f32_16x16x32_bf16 a[108:111], v[80:83], v[56:59], a[108:111]
    ds_read_b128 v[56:59], v29 offset:12288
    v_mfma_f32_16x16x32_bf16 a[112:115], v[68:71], v[60:63], a[112:115]
    v_rcp_f32 v227, v227
    v_mfma_f32_16x16x32_bf16 a[116:119], v[72:75], v[60:63], a[116:119]
    v_mul_f32 v248, v240, v248
    v_mul_f32 v240, s40, v240
    v_mfma_f32_16x16x32_bf16 a[120:123], v[76:79], v[60:63], a[120:123]
    v_exp_f32 v231, v231
    v_mfma_f32_16x16x32_bf16 a[124:127], v[80:83], v[60:63], a[124:127]
    s_waitcnt lgkmcnt(1)
    v_cvt_pk_bf16_f32 v152, v232, v233
    v_add_f32 v229, 1.0, v229
    v_mfma_f32_16x16x32_bf16 a[0:3], v[84:87], v[32:35], a[0:3]
    s_waitcnt vmcnt(15)
    v_mov_b32 v118, 0
    v_mul_f32 v234, v226, v234
    v_mfma_f32_16x16x32_bf16 a[4:7], v[88:91], v[32:35], a[4:7]
    s_barrier
    v_mfma_f32_16x16x32_bf16 a[8:11], v[92:95], v[32:35], a[8:11]
    s_add_u32 s31, s77, 512
    ds_read_b128 v[60:63], v28 offset:30720
    ds_write_b128 v105, v[144:147] offset:0
    v_mfma_f32_16x16x32_bf16 a[12:15], v[96:99], v[32:35], a[12:15]
    ds_read_b128 v[32:35], v28 offset:16384
    v_mfma_f32_16x16x32_bf16 a[16:19], v[84:87], v[36:39], a[16:19]
    v_rcp_f32 v228, v228
    v_mfma_f32_16x16x32_bf16 a[20:23], v[88:91], v[36:39], a[20:23]
    ds_read_b64_tr_b16 v[68:69], v8 offset:0
    v_mul_f32 v249, v241, v249
    v_mfma_f32_16x16x32_bf16 a[24:27], v[92:95], v[36:39], a[24:27]
    s_add_u32 m0, s76, 98304
    v_mov_b32 v119, 0
    v_mul_f32 v241, s40, v241
    v_exp_f32 v240, v240
    v_mfma_f32_16x16x32_bf16 a[28:31], v[96:99], v[36:39], a[28:31]
    ds_read_b128 v[36:39], v28 offset:18432
    ds_read_b64_tr_b16 v[70:71], v8 offset:512
    v_mfma_f32_16x16x32_bf16 a[32:35], v[84:87], v[40:43], a[32:35]
    v_add_f32 v230, 1.0, v230
    v_mul_f32 v235, v227, v235
    v_mfma_f32_16x16x32_bf16 a[36:39], v[88:91], v[40:43], a[36:39]
    ds_read_b64_tr_b16 v[72:73], v9 offset:0
    ds_write_b128 v105, v[148:151] offset:4096
    v_mfma_f32_16x16x32_bf16 a[40:43], v[92:95], v[40:43], a[40:43]
    v_rcp_f32 v229, v229
    v_mul_f32 v250, v242, v250
    v_mfma_f32_16x16x32_bf16 a[44:47], v[96:99], v[40:43], a[44:47]
    ds_read_b128 v[40:43], v28 offset:20480
    ds_read_b64_tr_b16 v[74:75], v9 offset:512
    v_mul_f32 v242, s40, v242
    v_mfma_f32_16x16x32_bf16 a[48:51], v[84:87], v[44:47], a[48:51]
    buffer_load_dwordx4 v10, s[52:55], s31 offen offset:0 lds
    v_mov_b32 v120, 0
    v_mfma_f32_16x16x32_bf16 a[52:55], v[88:91], v[44:47], a[52:55]
    ds_read_b64_tr_b16 v[76:77], v8 offset:8192
    v_exp_f32 v241, v241
    v_mfma_f32_16x16x32_bf16 a[56:59], v[92:95], v[44:47], a[56:59]
    v_cvt_pk_bf16_f32 v153, v234, v235
    v_add_f32 v231, 1.0, v231
    v_mfma_f32_16x16x32_bf16 a[60:63], v[96:99], v[44:47], a[60:63]
    ds_read_b128 v[44:47], v28 offset:22528
    ds_read_b64_tr_b16 v[78:79], v8 offset:8704
    v_mfma_f32_16x16x32_bf16 a[64:67], v[84:87], v[48:51], a[64:67]
    buffer_load_dwordx4 v11, s[52:55], s31 offen offset:1024 lds
    v_mul_f32 v236, v228, v236
    v_mfma_f32_16x16x32_bf16 a[68:71], v[88:91], v[48:51], a[68:71]
    ds_read_b64_tr_b16 v[80:81], v9 offset:8192
    v_rcp_f32 v230, v230
    v_mfma_f32_16x16x32_bf16 a[72:75], v[92:95], v[48:51], a[72:75]
    v_mul_f32 v251, v243, v251
    v_mul_f32 v243, s40, v243
    v_mfma_f32_16x16x32_bf16 a[76:79], v[96:99], v[48:51], a[76:79]
    s_waitcnt lgkmcnt(14)
    ds_read_b128 v[48:51], v28 offset:24576
    ds_read_b64_tr_b16 v[82:83], v9 offset:8704
    v_mfma_f32_16x16x32_bf16 a[80:83], v[84:87], v[52:55], a[80:83]
    v_mov_b32 v121, 0
    v_exp_f32 v242, v242
    v_mfma_f32_16x16x32_bf16 a[84:87], v[88:91], v[52:55], a[84:87]
    buffer_load_dwordx4 v12, s[52:55], s31 offen offset:2048 lds
    v_add_f32 v240, 1.0, v240
    v_mfma_f32_16x16x32_bf16 a[88:91], v[92:95], v[52:55], a[88:91]
    v_mul_f32 v237, v229, v237
    v_rcp_f32 v231, v231
    v_mfma_f32_16x16x32_bf16 a[92:95], v[96:99], v[52:55], a[92:95]
    ds_read_b128 v[52:55], v28 offset:26624
    v_mul_f32 v252, v244, v252
    v_mfma_f32_16x16x32_bf16 a[96:99], v[84:87], v[56:59], a[96:99]
    v_mul_f32 v244, s40, v244
    v_exp_f32 v243, v243
    v_mfma_f32_16x16x32_bf16 a[100:103], v[88:91], v[56:59], a[100:103]
    v_cvt_pk_bf16_f32 v154, v236, v237
    v_mov_b32 v122, 0
    v_mfma_f32_16x16x32_bf16 a[104:107], v[92:95], v[56:59], a[104:107]
    buffer_load_dwordx4 v13, s[52:55], s31 offen offset:3072 lds
    v_add_f32 v241, 1.0, v241
    v_mfma_f32_16x16x32_bf16 a[108:111], v[96:99], v[56:59], a[108:111]
    ds_read_b128 v[56:59], v28 offset:28672
    v_mul_f32 v238, v230, v238
    v_mfma_f32_16x16x32_bf16 a[112:115], v[84:87], v[64:67], a[112:115]
    v_rcp_f32 v240, v240
    v_mfma_f32_16x16x32_bf16 a[116:119], v[88:91], v[64:67], a[116:119]
    v_mul_f32 v253, v245, v253
    v_mul_f32 v245, s40, v245
    v_mfma_f32_16x16x32_bf16 a[120:123], v[92:95], v[64:67], a[120:123]
    v_exp_f32 v244, v244
    v_mfma_f32_16x16x32_bf16 a[124:127], v[96:99], v[64:67], a[124:127]
    s_waitcnt lgkmcnt(1)
    v_add_f32 v242, 1.0, v242
    v_mul_f32 v239, v231, v239
    v_mfma_f32_16x16x32_bf16 a[0:3], v[68:71], v[32:35], a[0:3]
    s_waitcnt vmcnt(8)
    v_mov_b32 v123, 0
    v_rcp_f32 v241, v241
    v_mfma_f32_16x16x32_bf16 a[4:7], v[72:75], v[32:35], a[4:7]
    s_barrier
    v_mfma_f32_16x16x32_bf16 a[8:11], v[76:79], v[32:35], a[8:11]
    s_add_u32 s31, s77, 256
    ds_read_b128 v[64:67], v29 offset:30720
    v_mul_f32 v254, v246, v254
    v_mfma_f32_16x16x32_bf16 a[12:15], v[80:83], v[32:35], a[12:15]
    s_cmp_eq_u32 s20, 0
    ds_read_b128 v[32:35], v29 offset:16384
    v_mul_f32 v246, s40, v246
    v_mfma_f32_16x16x32_bf16 a[16:19], v[68:71], v[36:39], a[16:19]
    s_cbranch_scc1 .Lmain_kernel_sd_22
.Lmain_kernel_sdr_23:
    v_mfma_f32_16x16x32_bf16 a[20:23], v[72:75], v[36:39], a[20:23]
    ds_read_b64_tr_b16 v[84:85], v8 offset:16384
    v_exp_f32 v245, v245
    v_mfma_f32_16x16x32_bf16 a[24:27], v[76:79], v[36:39], a[24:27]
    s_add_u32 m0, s76, 0
    v_cvt_pk_bf16_f32 v155, v238, v239
    v_mov_b32 v124, 0
    v_mfma_f32_16x16x32_bf16 a[28:31], v[80:83], v[36:39], a[28:31]
    ds_read_b128 v[36:39], v29 offset:18432
    ds_read_b64_tr_b16 v[86:87], v8 offset:16896
    v_mfma_f32_16x16x32_bf16 a[32:35], v[68:71], v[40:43], a[32:35]
    v_add_f32 v243, 1.0, v243
    v_mul_f32 v248, v240, v248
    v_mfma_f32_16x16x32_bf16 a[36:39], v[72:75], v[40:43], a[36:39]
    ds_read_b64_tr_b16 v[88:89], v9 offset:16384
    ds_write_b128 v105, v[152:155] offset:8192
    v_mfma_f32_16x16x32_bf16 a[40:43], v[76:79], v[40:43], a[40:43]
    v_rcp_f32 v242, v242
    v_mul_f32 v255, v247, v255
    v_mfma_f32_16x16x32_bf16 a[44:47], v[80:83], v[40:43], a[44:47]
    ds_read_b128 v[40:43], v29 offset:20480
    ds_read_b64_tr_b16 v[90:91], v9 offset:16896
    v_mfma_f32_16x16x32_bf16 a[48:51], v[68:71], v[44:47], a[48:51]
    buffer_load_dwordx4 v10, s[52:55], s31 offen offset:0 lds
    v_mov_b32 v125, 0
    v_mfma_f32_16x16x32_bf16 a[52:55], v[72:75], v[44:47], a[52:55]
    ds_read_b64_tr_b16 v[92:93], v8 offset:24576
    v_mul_f32 v247, s40, v247
    v_mfma_f32_16x16x32_bf16 a[56:59], v[76:79], v[44:47], a[56:59]
    v_exp_f32 v246, v246
    v_add_f32 v244, 1.0, v244
    v_mfma_f32_16x16x32_bf16 a[60:63], v[80:83], v[44:47], a[60:63]
    ds_read_b128 v[44:47], v29 offset:22528
    ds_read_b64_tr_b16 v[94:95], v8 offset:25088
    v_mfma_f32_16x16x32_bf16 a[64:67], v[68:71], v[48:51], a[64:67]
    buffer_load_dwordx4 v11, s[52:55], s31 offen offset:1024 lds
    v_mul_f32 v249, v241, v249
    v_mfma_f32_16x16x32_bf16 a[68:71], v[72:75], v[48:51], a[68:71]
    ds_read_b64_tr_b16 v[96:97], v9 offset:24576
    v_rcp_f32 v243, v243
    v_mfma_f32_16x16x32_bf16 a[72:75], v[76:79], v[48:51], a[72:75]
    v_exp_f32 v247, v247
    v_mfma_f32_16x16x32_bf16 a[76:79], v[80:83], v[48:51], a[76:79]
    s_waitcnt lgkmcnt(13)
    ds_read_b128 v[48:51], v29 offset:24576
    ds_read_b64_tr_b16 v[98:99], v9 offset:25088
    v_mfma_f32_16x16x32_bf16 a[80:83], v[68:71], v[52:55], a[80:83]
    v_cvt_pk_bf16_f32 v156, v248, v249
    v_mov_b32 v126, 0
    v_add_f32 v245, 1.0, v245
    v_mfma_f32_16x16x32_bf16 a[84:87], v[72:75], v[52:55], a[84:87]
    buffer_load_dwordx4 v12, s[52:55], s31 offen offset:2048 lds
    v_mul_f32 v250, v242, v250
    v_mfma_f32_16x16x32_bf16 a[88:91], v[76:79], v[52:55], a[88:91]
    v_rcp_f32 v244, v244
    v_mfma_f32_16x16x32_bf16 a[92:95], v[80:83], v[52:55], a[92:95]
    ds_read_b128 v[52:55], v29 offset:26624
    v_add_f32 v246, 1.0, v246
    v_mfma_f32_16x16x32_bf16 a[96:99], v[68:71], v[56:59], a[96:99]
    v_mul_f32 v251, v243, v251
    v_rcp_f32 v245, v245
    v_mfma_f32_16x16x32_bf16 a[100:103], v[72:75], v[56:59], a[100:103]
    v_cvt_pk_bf16_f32 v157, v250, v251
    v_mov_b32 v127, 0
    v_mfma_f32_16x16x32_bf16 a[104:107], v[76:79], v[56:59], a[104:107]
    buffer_load_dwordx4 v13, s[52:55], s31 offen offset:3072 lds
    v_add_f32 v247, 1.0, v247
    v_mfma_f32_16x16x32_bf16 a[108:111], v[80:83], v[56:59], a[108:111]
    ds_read_b128 v[56:59], v29 offset:28672
    v_mul_f32 v252, v244, v252
    v_rcp_f32 v246, v246
    v_mul_f32 v253, v245, v253
    v_rcp_f32 v247, v247
    v_cvt_pk_bf16_f32 v158, v252, v253
    v_mul_f32 v254, v246, v254
    v_mul_f32 v255, v247, v255
    v_cvt_pk_bf16_f32 v159, v254, v255
    v_mfma_f32_16x16x32_bf16 a[112:115], v[68:71], v[60:63], a[112:115]
    ds_write_b128 v104, v[128:131] offset:0
    ds_write_b128 v105, v[156:159] offset:12288
    v_mfma_f32_16x16x32_bf16 a[116:119], v[72:75], v[60:63], a[116:119]
    ds_write_b128 v104, v[132:135] offset:4096
    v_mfma_f32_16x16x32_bf16 a[120:123], v[76:79], v[60:63], a[120:123]
    ds_write_b128 v104, v[136:139] offset:8192
    v_mfma_f32_16x16x32_bf16 a[124:127], v[80:83], v[60:63], a[124:127]
    s_waitcnt lgkmcnt(5)
    ds_write_b128 v104, v[140:143] offset:12288
    v_mfma_f32_16x16x32_bf16 a[0:3], v[84:87], v[32:35], a[0:3]
    s_waitcnt lgkmcnt(0)
    v_mfma_f32_16x16x32_bf16 a[4:7], v[88:91], v[32:35], a[4:7]
    s_barrier
    v_mfma_f32_16x16x32_bf16 a[8:11], v[92:95], v[32:35], a[8:11]
    ds_read_b128 a[128:131], v106 offset:0
    v_mfma_f32_16x16x32_bf16 a[12:15], v[96:99], v[32:35], a[12:15]
    ds_read_b128 a[144:147], v106 offset:4096
    v_mfma_f32_16x16x32_bf16 a[16:19], v[84:87], v[36:39], a[16:19]
    ds_read_b128 a[160:163], v106 offset:8192
    v_mfma_f32_16x16x32_bf16 a[20:23], v[88:91], v[36:39], a[20:23]
    ds_read_b128 a[176:179], v106 offset:12288
    v_mfma_f32_16x16x32_bf16 a[24:27], v[92:95], v[36:39], a[24:27]
    v_mfma_f32_16x16x32_bf16 a[28:31], v[96:99], v[36:39], a[28:31]
    ds_read_b128 a[132:135], v106 offset:1024
    v_mfma_f32_16x16x32_bf16 a[32:35], v[84:87], v[40:43], a[32:35]
    ds_read_b128 a[148:151], v106 offset:5120
    v_mfma_f32_16x16x32_bf16 a[36:39], v[88:91], v[40:43], a[36:39]
    ds_read_b128 a[164:167], v106 offset:9216
    v_mfma_f32_16x16x32_bf16 a[40:43], v[92:95], v[40:43], a[40:43]
    v_accvgpr_read_b32 v160, a16
    v_accvgpr_read_b32 v161, a17
    v_mfma_f32_16x16x32_bf16 a[44:47], v[96:99], v[40:43], a[44:47]
    ds_read_b128 a[180:183], v106 offset:13312
    v_accvgpr_read_b32 v162, a18
    v_mfma_f32_16x16x32_bf16 a[48:51], v[84:87], v[44:47], a[48:51]
    ds_read_b128 a[136:139], v106 offset:2048
    v_accvgpr_read_b32 v163, a19
    v_mfma_f32_16x16x32_bf16 a[52:55], v[88:91], v[44:47], a[52:55]
    ds_read_b128 a[152:155], v106 offset:6144
    v_accvgpr_read_b32 v164, a20
    v_mfma_f32_16x16x32_bf16 a[56:59], v[92:95], v[44:47], a[56:59]
    v_accvgpr_read_b32 v165, a21
    v_accvgpr_read_b32 v166, a22
    v_mfma_f32_16x16x32_bf16 a[60:63], v[96:99], v[44:47], a[60:63]
    ds_read_b128 a[168:171], v106 offset:10240
    v_accvgpr_read_b32 v167, a23
    v_pk_mul_f32 v[160:161], v[160:161], s[44:45]
    v_mfma_f32_16x16x32_bf16 a[64:67], v[84:87], v[48:51], a[64:67]
    ds_read_b64_tr_b16 v[224:225], v102 offset:0
    v_and_b32 v1, 0xf0, v14
    v_pk_mul_f32 v[162:163], v[162:163], s[44:45]
    v_mfma_f32_16x16x32_bf16 a[68:71], v[88:91], v[48:51], a[68:71]
    ds_read_b128 a[184:187], v106 offset:14336
    ds_read_b128 a[140:143], v106 offset:3072
    v_mfma_f32_16x16x32_bf16 a[72:75], v[92:95], v[48:51], a[72:75]
    ds_read_b64_tr_b16 v[226:227], v102 offset:2048
    v_pk_mul_f32 v[164:165], v[164:165], s[44:45]
    v_mfma_f32_16x16x32_bf16 a[76:79], v[96:99], v[48:51], a[76:79]
    ds_read_b128 a[156:159], v106 offset:7168
    v_pk_mul_f32 v[166:167], v[166:167], s[44:45]
    v_mfma_f32_16x16x32_bf16 a[80:83], v[84:87], v[52:55], a[80:83]
    ds_read_b64_tr_b16 v[228:229], v103 offset:0
    v_cvt_pk_bf16_f32 v160, v160, v161
    v_cvt_pk_bf16_f32 v161, v162, v163
    v_lshlrev_b32 v1, 6, v1
    v_mfma_f32_16x16x32_bf16 a[84:87], v[88:91], v[52:55], a[84:87]
    ds_read_b128 a[172:175], v106 offset:11264
    ds_read_b128 a[188:191], v106 offset:15360
    v_cvt_pk_bf16_f32 v162, v164, v165
    v_mfma_f32_16x16x32_bf16 a[88:91], v[92:95], v[52:55], a[88:91]
    ds_read_b64_tr_b16 v[230:231], v103 offset:2048
    v_cvt_pk_bf16_f32 v163, v166, v167
    v_mfma_f32_16x16x32_bf16 a[92:95], v[96:99], v[52:55], a[92:95]
    ds_write_b128 v24, v[160:163] offset:16384
    v_mfma_f32_16x16x32_bf16 a[96:99], v[84:87], v[56:59], a[96:99]
    s_and_b32 s30, s3, 0xffffc000
    ds_read_b64_tr_b16 v[232:233], v102 offset:4096
    v_accvgpr_read_b32 v168, a24
    v_mfma_f32_16x16x32_bf16 a[100:103], v[88:91], v[56:59], a[100:103]
    v_accvgpr_read_b32 v169, a25
    v_accvgpr_read_b32 v170, a26
    v_mfma_f32_16x16x32_bf16 a[104:107], v[92:95], v[56:59], a[104:107]
    ds_read_b64_tr_b16 v[234:235], v102 offset:6144
    v_accvgpr_read_b32 v171, a27
    v_mfma_f32_16x16x32_bf16 a[108:111], v[96:99], v[56:59], a[108:111]
    v_accvgpr_read_b32 v172, a28
    v_accvgpr_read_b32 v173, a29
    v_mfma_f32_16x16x32_bf16 a[112:115], v[84:87], v[64:67], a[112:115]
    ds_read_b64_tr_b16 v[236:237], v103 offset:4096
    buffer_load_dword v1, v1, s[16:19], s30 offen sc1
    v_mfma_f32_16x16x32_bf16 a[116:119], v[88:91], v[64:67], a[116:119]
    v_accvgpr_read_b32 v174, a30
    v_accvgpr_read_b32 v175, a31
    v_mfma_f32_16x16x32_bf16 a[120:123], v[92:95], v[64:67], a[120:123]
    ds_read_b64_tr_b16 v[238:239], v103 offset:6144
    v_pk_mul_f32 v[168:169], v[168:169], s[44:45]
    v_mfma_f32_16x16x32_bf16 a[124:127], v[96:99], v[64:67], a[124:127]
    s_waitcnt lgkmcnt(5)
    v_pk_mul_f32 v[170:171], v[170:171], s[44:45]
    v_pk_mul_f32 v[172:173], v[172:173], s[44:45]
    v_mfma_f32_16x16x32_bf16 v[32:35], v[224:227], a[128:131], 0
    ds_read_b64_tr_b16 v[240:241], v102 offset:8192
    v_pk_mul_f32 v[174:175], v[174:175], s[44:45]
    v_mfma_f32_16x16x32_bf16 v[40:43], v[224:227], a[144:147], 0
    v_cvt_pk_bf16_f32 v168, v168, v169
    v_cvt_pk_bf16_f32 v169, v170, v171
    v_mfma_f32_16x16x32_bf16 v[48:51], v[224:227], a[160:163], 0
    ds_read_b64_tr_b16 v[242:243], v102 offset:10240
    v_cvt_pk_bf16_f32 v170, v172, v173
    v_mfma_f32_16x16x32_bf16 v[56:59], v[224:227], a[176:179], 0
    v_cvt_pk_bf16_f32 v171, v174, v175
    v_mfma_f32_16x16x32_bf16 v[36:39], v[228:231], a[128:131], 0
    ds_read_b64_tr_b16 v[244:245], v103 offset:8192
    ds_write_b128 v24, v[168:171] offset:24576
    v_mfma_f32_16x16x32_bf16 v[44:47], v[228:231], a[144:147], 0
    v_accvgpr_read_b32 v176, a32
    v_accvgpr_read_b32 v177, a33
    v_mfma_f32_16x16x32_bf16 v[52:55], v[228:231], a[160:163], 0
    ds_read_b64_tr_b16 v[246:247], v103 offset:10240
    v_accvgpr_read_b32 v178, a34
    v_mfma_f32_16x16x32_bf16 v[60:63], v[228:231], a[176:179], 0
    s_waitcnt lgkmcnt(5)
    v_accvgpr_read_b32 v179, a35
    v_accvgpr_read_b32 v180, a36
    v_mfma_f32_16x16x32_bf16 v[32:35], v[232:235], a[132:135], v[32:35]
    ds_read_b64_tr_b16 v[248:249], v102 offset:12288
    v_accvgpr_read_b32 v181, a37
    v_mfma_f32_16x16x32_bf16 v[40:43], v[232:235], a[148:151], v[40:43]
    v_accvgpr_read_b32 v182, a38
    v_accvgpr_read_b32 v183, a39
    v_mfma_f32_16x16x32_bf16 v[48:51], v[232:235], a[164:167], v[48:51]
    ds_read_b64_tr_b16 v[250:251], v102 offset:14336
    v_pk_mul_f32 v[176:177], v[176:177], s[44:45]
    v_mfma_f32_16x16x32_bf16 v[56:59], v[232:235], a[180:183], v[56:59]
    v_pk_mul_f32 v[178:179], v[178:179], s[44:45]
    v_pk_mul_f32 v[180:181], v[180:181], s[44:45]
    v_mfma_f32_16x16x32_bf16 v[36:39], v[236:239], a[132:135], v[36:39]
    ds_read_b64_tr_b16 v[252:253], v103 offset:12288
    v_pk_mul_f32 v[182:183], v[182:183], s[44:45]
    v_mfma_f32_16x16x32_bf16 v[44:47], v[236:239], a[148:151], v[44:47]
    v_cvt_pk_bf16_f32 v176, v176, v177
    v_cvt_pk_bf16_f32 v177, v178, v179
    v_mfma_f32_16x16x32_bf16 v[52:55], v[236:239], a[164:167], v[52:55]
    s_waitcnt lgkmcnt(3)
    ds_read_b64_tr_b16 v[254:255], v103 offset:14336
    v_cvt_pk_bf16_f32 v178, v180, v181
    v_mfma_f32_16x16x32_bf16 v[60:63], v[236:239], a[180:183], v[60:63]
    s_barrier
    v_mfma_f32_16x16x32_bf16 v[32:35], v[240:243], a[136:139], v[32:35]
    s_add_u32 s31, s77, 640
    ds_read_b64_tr_b16 v[224:225], v102 offset:16384
    v_cvt_pk_bf16_f32 v179, v182, v183
    v_mfma_f32_16x16x32_bf16 v[40:43], v[240:243], a[152:155], v[40:43]
    ds_write_b128 v25, v[176:179] offset:0
    v_mfma_f32_16x16x32_bf16 v[48:51], v[240:243], a[168:171], v[48:51]
    s_add_u32 m0, s76, 49152
    ds_read_b64_tr_b16 v[226:227], v102 offset:18432
    v_accvgpr_read_b32 v184, a40
    v_mfma_f32_16x16x32_bf16 v[56:59], v[240:243], a[184:187], v[56:59]
    v_accvgpr_read_b32 v185, a41
    v_accvgpr_read_b32 v186, a42
    v_mfma_f32_16x16x32_bf16 v[36:39], v[244:247], a[136:139], v[36:39]
    ds_read_b64_tr_b16 v[228:229], v103 offset:16384
    buffer_load_dwordx4 v10, s[52:55], s31 offen offset:0 lds
    v_mfma_f32_16x16x32_bf16 v[44:47], v[244:247], a[152:155], v[44:47]
    v_accvgpr_read_b32 v187, a43
    v_accvgpr_read_b32 v188, a44
    v_mfma_f32_16x16x32_bf16 v[52:55], v[244:247], a[168:171], v[52:55]
    ds_read_b64_tr_b16 v[230:231], v103 offset:18432
    v_accvgpr_read_b32 v189, a45
    v_mfma_f32_16x16x32_bf16 v[60:63], v[244:247], a[184:187], v[60:63]
    s_waitcnt lgkmcnt(5)
    buffer_load_dwordx4 v11, s[52:55], s31 offen offset:1024 lds
    v_accvgpr_read_b32 v190, a46
    v_mfma_f32_16x16x32_bf16 v[32:35], v[248:251], a[140:143], v[32:35]
    ds_read_b64_tr_b16 v[232:233], v102 offset:20480
    v_accvgpr_read_b32 v191, a47
    v_mfma_f32_16x16x32_bf16 v[40:43], v[248:251], a[156:159], v[40:43]
    buffer_load_dwordx4 v12, s[52:55], s31 offen offset:2048 lds
    v_pk_mul_f32 v[184:185], v[184:185], s[44:45]
    v_mfma_f32_16x16x32_bf16 v[48:51], v[248:251], a[172:175], v[48:51]
    ds_read_b64_tr_b16 v[234:235], v102 offset:22528
    v_pk_mul_f32 v[186:187], v[186:187], s[44:45]
    v_mfma_f32_16x16x32_bf16 v[56:59], v[248:251], a[188:191], v[56:59]
    v_pk_mul_f32 v[188:189], v[188:189], s[44:45]
    v_pk_mul_f32 v[190:191], v[190:191], s[44:45]
    v_mfma_f32_16x16x32_bf16 v[36:39], v[252:255], a[140:143], v[36:39]
    ds_read_b64_tr_b16 v[236:237], v103 offset:20480
    buffer_load_dwordx4 v13, s[52:55], s31 offen offset:3072 lds
    v_cvt_pk_bf16_f32 v184, v184, v185
    v_mfma_f32_16x16x32_bf16 v[44:47], v[252:255], a[156:159], v[44:47]
    v_cvt_pk_bf16_f32 v185, v186, v187
    v_cvt_pk_bf16_f32 v186, v188, v189
    v_mfma_f32_16x16x32_bf16 v[52:55], v[252:255], a[172:175], v[52:55]
    s_add_u32 s31, s77, 768
    ds_read_b64_tr_b16 v[238:239], v103 offset:22528
    v_cvt_pk_bf16_f32 v187, v190, v191
    v_mfma_f32_16x16x32_bf16 v[60:63], v[252:255], a[188:191], v[60:63]
    s_waitcnt lgkmcnt(4)
    ds_write_b128 v25, v[184:187] offset:8192
    v_mfma_f32_16x16x32_bf16 v[64:67], v[224:227], a[128:131], 0
    s_add_u32 m0, s76, 114688
    ds_read_b64_tr_b16 v[240:241], v102 offset:24576
    v_accvgpr_read_b32 v192, a48
    v_mfma_f32_16x16x32_bf16 v[72:75], v[224:227], a[144:147], 0
    v_accvgpr_read_b32 v193, a49
    v_accvgpr_read_b32 v194, a50
    v_accvgpr_read_b32 v195, a51
    v_mfma_f32_16x16x32_bf16 v[80:83], v[224:227], a[160:163], 0
    ds_read_b64_tr_b16 v[242:243], v102 offset:26624
    v_cvt_pk_bf16_f32 v32, v32, v33
    v_accvgpr_read_b32 v196, a52
    v_mfma_f32_16x16x32_bf16 v[88:91], v[224:227], a[176:179], 0
    buffer_load_dwordx4 v10, s[52:55], s31 offen offset:0 lds
    v_cvt_pk_bf16_f32 v33, v34, v35
    v_accvgpr_read_b32 v197, a53
    v_mfma_f32_16x16x32_bf16 v[68:71], v[228:231], a[128:131], 0
    ds_read_b64_tr_b16 v[244:245], v103 offset:24576
    v_cvt_pk_bf16_f32 v34, v36, v37
    v_accvgpr_read_b32 v198, a54
    v_mfma_f32_16x16x32_bf16 v[76:79], v[228:231], a[144:147], 0
    buffer_load_dwordx4 v11, s[52:55], s31 offen offset:1024 lds
    v_cvt_pk_bf16_f32 v35, v38, v39
    v_mfma_f32_16x16x32_bf16 v[84:87], v[228:231], a[160:163], 0
    ds_read_b64_tr_b16 v[246:247], v103 offset:26624
    v_accvgpr_read_b32 v199, a55
    v_pk_mul_f32 v[192:193], v[192:193], s[44:45]
    v_mfma_f32_16x16x32_bf16 v[92:95], v[228:231], a[176:179], 0
    s_waitcnt lgkmcnt(5)
    buffer_store_dwordx4 v[32:35], v15, s[16:19], s34 offen sc1
    v_pk_mul_f32 v[194:195], v[194:195], s[44:45]
    v_mfma_f32_16x16x32_bf16 v[64:67], v[232:235], a[132:135], v[64:67]
    s_add_u32 s34, s34, 16384
    ds_read_b64_tr_b16 v[248:249], v102 offset:28672
    buffer_load_dwordx4 v12, s[52:55], s31 offen offset:2048 lds
    v_pk_mul_f32 v[196:197], v[196:197], s[44:45]
    v_mfma_f32_16x16x32_bf16 v[72:75], v[232:235], a[148:151], v[72:75]
    v_cvt_pk_bf16_f32 v40, v40, v41
    v_pk_mul_f32 v[198:199], v[198:199], s[44:45]
    v_mfma_f32_16x16x32_bf16 v[80:83], v[232:235], a[164:167], v[80:83]
    ds_read_b64_tr_b16 v[250:251], v102 offset:30720
    buffer_load_dwordx4 v13, s[52:55], s31 offen offset:3072 lds
    v_cvt_pk_bf16_f32 v192, v192, v193
    v_cvt_pk_bf16_f32 v193, v194, v195
    v_mfma_f32_16x16x32_bf16 v[88:91], v[232:235], a[180:183], v[88:91]
    v_cvt_pk_bf16_f32 v41, v42, v43
    v_cvt_pk_bf16_f32 v42, v44, v45
    v_cvt_pk_bf16_f32 v194, v196, v197
    v_mfma_f32_16x16x32_bf16 v[68:71], v[236:239], a[132:135], v[68:71]
    ds_read_b64_tr_b16 v[252:253], v103 offset:28672
    v_cvt_pk_bf16_f32 v43, v46, v47
    v_cvt_pk_bf16_f32 v195, v198, v199
    v_mfma_f32_16x16x32_bf16 v[76:79], v[236:239], a[148:151], v[76:79]
    s_waitcnt vmcnt(10)
    buffer_store_dwordx4 v[40:43], v15, s[16:19], s34 offen sc1
    ds_write_b128 v25, v[192:195] offset:16384
    v_mfma_f32_16x16x32_bf16 v[84:87], v[236:239], a[164:167], v[84:87]
    s_waitcnt lgkmcnt(4)
    ds_read_b64_tr_b16 v[254:255], v103 offset:30720
    v_accvgpr_read_b32 v200, a56
    v_accvgpr_read_b32 v201, a57
    v_mfma_f32_16x16x32_bf16 v[92:95], v[236:239], a[180:183], v[92:95]
    s_barrier
    v_mfma_f32_16x16x32_bf16 v[64:67], v[240:243], a[136:139], v[64:67]
    s_add_u32 s34, s34, 16384
    ds_read_b64_tr_b16 v[224:225], v100 offset:0
    s_waitcnt vmcnt(10)
    v_and_b32 v1, 1, v1
    v_accvgpr_read_b32 v202, a58
    v_accvgpr_read_b32 v203, a59
    v_mfma_f32_16x16x32_bf16 v[72:75], v[240:243], a[152:155], v[72:75]
    v_cvt_pk_bf16_f32 v48, v48, v49
    v_accvgpr_read_b32 v204, a60
    v_accvgpr_read_b32 v205, a61
    v_mfma_f32_16x16x32_bf16 v[80:83], v[240:243], a[168:171], v[80:83]
    ds_read_b64_tr_b16 v[226:227], v100 offset:2048
    v_cvt_pk_bf16_f32 v49, v50, v51
    v_accvgpr_read_b32 v206, a62
    v_mfma_f32_16x16x32_bf16 v[88:91], v[240:243], a[184:187], v[88:91]
    v_cvt_pk_bf16_f32 v50, v52, v53
    v_cmp_ne_u32 vcc, 1, v1
    v_accvgpr_read_b32 v207, a63
    v_mfma_f32_16x16x32_bf16 v[68:71], v[244:247], a[136:139], v[68:71]
    ds_read_b64_tr_b16 v[228:229], v101 offset:0
    v_cvt_pk_bf16_f32 v51, v54, v55
    v_pk_mul_f32 v[200:201], v[200:201], s[44:45]
    v_pk_mul_f32 v[202:203], v[202:203], s[44:45]
    v_mfma_f32_16x16x32_bf16 v[76:79], v[244:247], a[152:155], v[76:79]
    s_cbranch_vccnz .Lmain_kernel_spin_25
.Lmain_kernel_pok_24:
    v_mfma_f32_16x16x32_bf16 v[84:87], v[244:247], a[168:171], v[84:87]
    ds_read_b64_tr_b16 v[230:231], v101 offset:2048
    v_pk_mul_f32 v[204:205], v[204:205], s[44:45]
    v_pk_mul_f32 v[206:207], v[206:207], s[44:45]
    v_mfma_f32_16x16x32_bf16 v[92:95], v[244:247], a[184:187], v[92:95]
    s_waitcnt lgkmcnt(4)
    buffer_store_dwordx4 v[48:51], v15, s[16:19], s34 offen sc1
    v_cvt_pk_bf16_f32 v200, v200, v201
    v_mfma_f32_16x16x32_bf16 v[64:67], v[248:251], a[140:143], v[64:67]
    s_add_u32 s34, s34, 16384
    ds_read_b64_tr_b16 v[232:233], v100 offset:4096
    v_cvt_pk_bf16_f32 v56, v56, v57
    v_cvt_pk_bf16_f32 v201, v202, v203
    v_mfma_f32_16x16x32_bf16 v[72:75], v[248:251], a[156:159], v[72:75]
    s_add_u32 m0, s76, 65536
    v_cvt_pk_bf16_f32 v57, v58, v59
    v_cvt_pk_bf16_f32 v202, v204, v205
    v_cvt_pk_bf16_f32 v203, v206, v207
    v_mfma_f32_16x16x32_bf16 v[80:83], v[248:251], a[172:175], v[80:83]
    ds_read_b64_tr_b16 v[234:235], v100 offset:6144
    ds_write_b128 v25, v[200:203] offset:24576
    v_cvt_pk_bf16_f32 v58, v60, v61
    v_mfma_f32_16x16x32_bf16 v[88:91], v[248:251], a[188:191], v[88:91]
    v_cvt_pk_bf16_f32 v59, v62, v63
    v_accvgpr_read_b32 v208, a80
    v_accvgpr_read_b32 v209, a81
    v_mfma_f32_16x16x32_bf16 v[68:71], v[252:255], a[140:143], v[68:71]
    ds_read_b64_tr_b16 v[236:237], v101 offset:4096
    buffer_load_dwordx4 v0, s[16:19], s39 offen offset:0 sc1 lds
    v_accvgpr_read_b32 v210, a82
    v_mfma_f32_16x16x32_bf16 v[76:79], v[252:255], a[156:159], v[76:79]
    buffer_store_dwordx4 v[56:59], v15, s[16:19], s34 offen sc1
    v_mfma_f32_16x16x32_bf16 v[84:87], v[252:255], a[172:175], v[84:87]
    s_add_u32 s34, s34, 212992
    ds_read_b64_tr_b16 v[238:239], v101 offset:6144
    v_accvgpr_read_b32 v211, a83
    v_mfma_f32_16x16x32_bf16 v[92:95], v[252:255], a[188:191], v[92:95]
    s_waitcnt lgkmcnt(5)
    v_accvgpr_read_b32 v212, a84
    v_accvgpr_read_b32 v213, a85
    v_accvgpr_read_b32 v214, a86
    v_mfma_f32_16x16x32_bf16 v[32:35], v[224:227], a[128:131], 0
    ds_read_b64_tr_b16 v[240:241], v100 offset:8192
    buffer_load_dwordx4 v0, s[16:19], s39 offen offset:1024 sc1 lds
    v_mfma_f32_16x16x32_bf16 v[40:43], v[224:227], a[144:147], 0
    v_accvgpr_read_b32 v215, a87
    v_pk_mul_f32 v[208:209], v[208:209], s[44:45]
    v_pk_mul_f32 v[210:211], v[210:211], s[44:45]
    v_mfma_f32_16x16x32_bf16 v[48:51], v[224:227], a[160:163], 0
    ds_read_b64_tr_b16 v[242:243], v100 offset:10240
    v_cvt_pk_bf16_f32 v64, v64, v65
    v_pk_mul_f32 v[212:213], v[212:213], s[44:45]
    v_mfma_f32_16x16x32_bf16 v[56:59], v[224:227], a[176:179], 0
    buffer_load_dwordx4 v0, s[16:19], s39 offen offset:2048 sc1 lds
    v_cvt_pk_bf16_f32 v65, v66, v67
    v_pk_mul_f32 v[214:215], v[214:215], s[44:45]
    v_mfma_f32_16x16x32_bf16 v[36:39], v[228:231], a[128:131], 0
    ds_read_b64_tr_b16 v[244:245], v101 offset:8192
    v_cvt_pk_bf16_f32 v66, v68, v69
    v_mfma_f32_16x16x32_bf16 v[44:47], v[228:231], a[144:147], 0
    v_cvt_pk_bf16_f32 v67, v70, v71
    v_cvt_pk_bf16_f32 v208, v208, v209
    v_cvt_pk_bf16_f32 v209, v210, v211
    v_mfma_f32_16x16x32_bf16 v[52:55], v[228:231], a[160:163], 0
    ds_read_b64_tr_b16 v[246:247], v101 offset:10240
    buffer_load_dwordx4 v0, s[16:19], s39 offen offset:3072 sc1 lds
    v_cvt_pk_bf16_f32 v210, v212, v213
    v_mfma_f32_16x16x32_bf16 v[60:63], v[228:231], a[176:179], 0
    s_waitcnt lgkmcnt(4)
    buffer_store_dwordx4 v[64:67], v15, s[16:19], s34 offen sc1
    v_cvt_pk_bf16_f32 v211, v214, v215
    v_mfma_f32_16x16x32_bf16 v[32:35], v[232:235], a[132:135], v[32:35]
    s_add_u32 s34, s34, 16384
    ds_read_b64_tr_b16 v[248:249], v100 offset:12288
    ds_write_b128 v24, v[208:211] offset:17408
    v_mfma_f32_16x16x32_bf16 v[40:43], v[232:235], a[148:151], v[40:43]
    s_add_u32 s39, s39, 16384
    v_cvt_pk_bf16_f32 v72, v72, v73
    v_accvgpr_read_b32 v216, a88
    v_accvgpr_read_b32 v217, a89
    v_mfma_f32_16x16x32_bf16 v[48:51], v[232:235], a[164:167], v[48:51]
    ds_read_b64_tr_b16 v[250:251], v100 offset:14336
    v_cvt_pk_bf16_f32 v73, v74, v75
    v_mfma_f32_16x16x32_bf16 v[56:59], v[232:235], a[180:183], v[56:59]
    v_cvt_pk_bf16_f32 v74, v76, v77
    v_accvgpr_read_b32 v218, a90
    v_accvgpr_read_b32 v219, a91
    v_mfma_f32_16x16x32_bf16 v[36:39], v[236:239], a[132:135], v[36:39]
    ds_read_b64_tr_b16 v[252:253], v101 offset:12288
    v_cvt_pk_bf16_f32 v75, v78, v79
    v_accvgpr_read_b32 v220, a92
    v_mfma_f32_16x16x32_bf16 v[44:47], v[236:239], a[148:151], v[44:47]
    buffer_store_dwordx4 v[72:75], v15, s[16:19], s34 offen sc1
    v_accvgpr_read_b32 v221, a93
    v_mfma_f32_16x16x32_bf16 v[52:55], v[236:239], a[164:167], v[52:55]
    s_waitcnt lgkmcnt(4)
    ds_read_b64_tr_b16 v[254:255], v101 offset:14336
    v_accvgpr_read_b32 v222, a94
    v_accvgpr_read_b32 v223, a95
    v_pk_mul_f32 v[216:217], v[216:217], s[44:45]
    v_mfma_f32_16x16x32_bf16 v[60:63], v[236:239], a[180:183], v[60:63]
    s_barrier
    v_mfma_f32_16x16x32_bf16 v[32:35], v[240:243], a[136:139], v[32:35]
    s_add_u32 m0, s76, 81920
    s_add_u32 s34, s34, 16384
    ds_read_b64_tr_b16 v[224:225], v100 offset:32768
    v_pk_mul_f32 v[218:219], v[218:219], s[44:45]
    v_mfma_f32_16x16x32_bf16 v[40:43], v[240:243], a[152:155], v[40:43]
    v_cvt_pk_bf16_f32 v80, v80, v81
    v_pk_mul_f32 v[220:221], v[220:221], s[44:45]
    v_pk_mul_f32 v[222:223], v[222:223], s[44:45]
    v_mfma_f32_16x16x32_bf16 v[48:51], v[240:243], a[168:171], v[48:51]
    ds_read_b64_tr_b16 v[226:227], v100 offset:34816
    v_cvt_pk_bf16_f32 v81, v82, v83
    v_cvt_pk_bf16_f32 v216, v216, v217
    v_mfma_f32_16x16x32_bf16 v[56:59], v[240:243], a[184:187], v[56:59]
    v_cvt_pk_bf16_f32 v82, v84, v85
    v_cvt_pk_bf16_f32 v217, v218, v219
    v_cvt_pk_bf16_f32 v218, v220, v221
    v_mfma_f32_16x16x32_bf16 v[36:39], v[244:247], a[136:139], v[36:39]
    ds_read_b64_tr_b16 v[228:229], v101 offset:32768
    buffer_load_dwordx4 v0, s[16:19], s39 offen offset:0 sc1 lds
    v_cvt_pk_bf16_f32 v219, v222, v223
    v_mfma_f32_16x16x32_bf16 v[44:47], v[244:247], a[152:155], v[44:47]
    ds_write_b128 v24, v[216:219] offset:25600
    v_cvt_pk_bf16_f32 v83, v86, v87
    v_mfma_f32_16x16x32_bf16 v[52:55], v[244:247], a[168:171], v[52:55]
    ds_read_b64_tr_b16 v[230:231], v101 offset:34816
    v_accvgpr_read_b32 v160, a96
    v_accvgpr_read_b32 v161, a97
    v_mfma_f32_16x16x32_bf16 v[60:63], v[244:247], a[184:187], v[60:63]
    s_waitcnt lgkmcnt(5)
    buffer_store_dwordx4 v[80:83], v15, s[16:19], s34 offen sc1
    v_accvgpr_read_b32 v162, a98
    v_mfma_f32_16x16x32_bf16 v[32:35], v[248:251], a[140:143], v[32:35]
    s_add_u32 s34, s34, 16384
    ds_read_b64_tr_b16 v[232:233], v100 offset:36864
    v_cvt_pk_bf16_f32 v88, v88, v89
    v_accvgpr_read_b32 v163, a99
    v_mfma_f32_16x16x32_bf16 v[40:43], v[248:251], a[156:159], v[40:43]
    buffer_load_dwordx4 v0, s[16:19], s39 offen offset:1024 sc1 lds
    v_cvt_pk_bf16_f32 v89, v90, v91
    v_accvgpr_read_b32 v164, a100
    v_mfma_f32_16x16x32_bf16 v[48:51], v[248:251], a[172:175], v[48:51]
    ds_read_b64_tr_b16 v[234:235], v100 offset:38912
    v_cvt_pk_bf16_f32 v90, v92, v93
    v_accvgpr_read_b32 v165, a101
    v_mfma_f32_16x16x32_bf16 v[56:59], v[248:251], a[188:191], v[56:59]
    v_cvt_pk_bf16_f32 v91, v94, v95
    v_accvgpr_read_b32 v166, a102
    v_mfma_f32_16x16x32_bf16 v[36:39], v[252:255], a[140:143], v[36:39]
    ds_read_b64_tr_b16 v[236:237], v101 offset:36864
    v_accvgpr_read_b32 v167, a103
    v_pk_mul_f32 v[160:161], v[160:161], s[44:45]
    v_mfma_f32_16x16x32_bf16 v[44:47], v[252:255], a[156:159], v[44:47]
    buffer_store_dwordx4 v[88:91], v15, s[16:19], s34 offen sc1
    v_pk_mul_f32 v[162:163], v[162:163], s[44:45]
    v_mfma_f32_16x16x32_bf16 v[52:55], v[252:255], a[172:175], v[52:55]
    s_add_u32 s34, s34, 212992
    ds_read_b64_tr_b16 v[238:239], v101 offset:38912
    buffer_load_dwordx4 v0, s[16:19], s39 offen offset:2048 sc1 lds
    v_pk_mul_f32 v[164:165], v[164:165], s[44:45]
    v_mfma_f32_16x16x32_bf16 v[60:63], v[252:255], a[188:191], v[60:63]
    s_waitcnt lgkmcnt(4)
    v_pk_mul_f32 v[166:167], v[166:167], s[44:45]
    v_mfma_f32_16x16x32_bf16 v[64:67], v[224:227], a[128:131], 0
    s_cmp_eq_u32 s37, s38
    ds_read_b64_tr_b16 v[240:241], v100 offset:40960
    v_cvt_pk_bf16_f32 v160, v160, v161
    v_cvt_pk_bf16_f32 v161, v162, v163
    v_cvt_pk_bf16_f32 v162, v164, v165
    v_mfma_f32_16x16x32_bf16 v[72:75], v[224:227], a[144:147], 0
    s_cbranch_scc1 .Lmain_kernel_mask_27
.Lmain_kernel_maskr_28:
    v_mfma_f32_16x16x32_bf16 v[80:83], v[224:227], a[160:163], 0
    ds_read_b64_tr_b16 v[242:243], v100 offset:43008
    v_cvt_pk_bf16_f32 v32, v32, v33
    v_cvt_pk_bf16_f32 v163, v166, v167
    v_mfma_f32_16x16x32_bf16 v[88:91], v[224:227], a[176:179], 0
    buffer_load_dwordx4 v0, s[16:19], s39 offen offset:3072 sc1 lds
    ds_write_b128 v25, v[160:163] offset:1024
    v_cvt_pk_bf16_f32 v33, v34, v35
    v_mfma_f32_16x16x32_bf16 v[68:71], v[228:231], a[128:131], 0
    ds_read_b64_tr_b16 v[244:245], v101 offset:40960
    v_cvt_pk_bf16_f32 v34, v36, v37
    v_accvgpr_read_b32 v168, a104
    v_mfma_f32_16x16x32_bf16 v[76:79], v[228:231], a[144:147], 0
    v_cvt_pk_bf16_f32 v35, v38, v39
    v_accvgpr_read_b32 v169, a105
    v_mfma_f32_16x16x32_bf16 v[84:87], v[228:231], a[160:163], 0
    ds_read_b64_tr_b16 v[246:247], v101 offset:43008
    v_accvgpr_read_b32 v170, a106
    v_accvgpr_read_b32 v171, a107
    v_mfma_f32_16x16x32_bf16 v[92:95], v[228:231], a[176:179], 0
    s_waitcnt lgkmcnt(5)
    buffer_store_dwordx4 v[32:35], v15, s[16:19], s34 offen sc1
    v_accvgpr_read_b32 v172, a108
    v_mfma_f32_16x16x32_bf16 v[64:67], v[232:235], a[132:135], v[64:67]
    s_add_u32 s39, s39, 16384
    s_add_u32 s34, s34, 16384
    ds_read_b64_tr_b16 v[248:249], v100 offset:45056
    v_accvgpr_read_b32 v173, a109
    v_mfma_f32_16x16x32_bf16 v[72:75], v[232:235], a[148:151], v[72:75]
    v_cvt_pk_bf16_f32 v40, v40, v41
    v_accvgpr_read_b32 v174, a110
    v_accvgpr_read_b32 v175, a111
    v_mfma_f32_16x16x32_bf16 v[80:83], v[232:235], a[164:167], v[80:83]
    ds_read_b64_tr_b16 v[250:251], v100 offset:47104
    v_cvt_pk_bf16_f32 v41, v42, v43
    v_pk_mul_f32 v[168:169], v[168:169], s[44:45]
    v_mfma_f32_16x16x32_bf16 v[88:91], v[232:235], a[180:183], v[88:91]
    v_cvt_pk_bf16_f32 v42, v44, v45
    v_pk_mul_f32 v[170:171], v[170:171], s[44:45]
    v_pk_mul_f32 v[172:173], v[172:173], s[44:45]
    v_mfma_f32_16x16x32_bf16 v[68:71], v[236:239], a[132:135], v[68:71]
    ds_read_b64_tr_b16 v[252:253], v101 offset:45056
    v_cvt_pk_bf16_f32 v43, v46, v47
    v_pk_mul_f32 v[174:175], v[174:175], s[44:45]
    v_mfma_f32_16x16x32_bf16 v[76:79], v[236:239], a[148:151], v[76:79]
    buffer_store_dwordx4 v[40:43], v15, s[16:19], s34 offen sc1
    v_cvt_pk_bf16_f32 v168, v168, v169
    v_mfma_f32_16x16x32_bf16 v[84:87], v[236:239], a[164:167], v[84:87]
    s_waitcnt lgkmcnt(3)
    ds_read_b64_tr_b16 v[254:255], v101 offset:47104
    v_cvt_pk_bf16_f32 v169, v170, v171
    v_cvt_pk_bf16_f32 v170, v172, v173
    v_cvt_pk_bf16_f32 v171, v174, v175
    v_mfma_f32_16x16x32_bf16 v[92:95], v[236:239], a[180:183], v[92:95]
    s_barrier
    v_mfma_f32_16x16x32_bf16 v[64:67], v[240:243], a[136:139], v[64:67]
    s_add_u32 s34, s34, 16384
    ds_read_b64_tr_b16 v[224:225], v102 offset:32768
    ds_write_b128 v25, v[168:171] offset:9216
    v_mfma_f32_16x16x32_bf16 v[72:75], v[240:243], a[152:155], v[72:75]
    v_cvt_pk_bf16_f32 v48, v48, v49
    v_accvgpr_read_b32 v176, a112
    v_accvgpr_read_b32 v177, a113
    v_mfma_f32_16x16x32_bf16 v[80:83], v[240:243], a[168:171], v[80:83]
    ds_read_b64_tr_b16 v[226:227], v102 offset:34816
    v_cvt_pk_bf16_f32 v49, v50, v51
    v_mfma_f32_16x16x32_bf16 v[88:91], v[240:243], a[184:187], v[88:91]
    v_cvt_pk_bf16_f32 v50, v52, v53
    v_accvgpr_read_b32 v178, a114
    v_accvgpr_read_b32 v179, a115
    v_mfma_f32_16x16x32_bf16 v[68:71], v[244:247], a[136:139], v[68:71]
    ds_read_b64_tr_b16 v[228:229], v103 offset:32768
    v_cvt_pk_bf16_f32 v51, v54, v55
    v_accvgpr_read_b32 v180, a116
    v_mfma_f32_16x16x32_bf16 v[76:79], v[244:247], a[152:155], v[76:79]
    buffer_store_dwordx4 v[48:51], v15, s[16:19], s34 offen sc1
    v_accvgpr_read_b32 v181, a117
    v_mfma_f32_16x16x32_bf16 v[84:87], v[244:247], a[168:171], v[84:87]
    ds_read_b64_tr_b16 v[230:231], v103 offset:34816
    v_accvgpr_read_b32 v182, a118
    v_mfma_f32_16x16x32_bf16 v[92:95], v[244:247], a[184:187], v[92:95]
    s_waitcnt lgkmcnt(5)
    s_add_u32 s34, s34, 16384
    v_accvgpr_read_b32 v183, a119
    v_pk_mul_f32 v[176:177], v[176:177], s[44:45]
    v_mfma_f32_16x16x32_bf16 v[64:67], v[248:251], a[140:143], v[64:67]
    ds_read_b64_tr_b16 v[232:233], v102 offset:36864
    v_cvt_pk_bf16_f32 v56, v56, v57
    v_pk_mul_f32 v[178:179], v[178:179], s[44:45]
    v_mfma_f32_16x16x32_bf16 v[72:75], v[248:251], a[156:159], v[72:75]
    v_cvt_pk_bf16_f32 v57, v58, v59
    v_pk_mul_f32 v[180:181], v[180:181], s[44:45]
    v_pk_mul_f32 v[182:183], v[182:183], s[44:45]
    v_mfma_f32_16x16x32_bf16 v[80:83], v[248:251], a[172:175], v[80:83]
    ds_read_b64_tr_b16 v[234:235], v102 offset:38912
    v_cvt_pk_bf16_f32 v58, v60, v61
    v_mfma_f32_16x16x32_bf16 v[88:91], v[248:251], a[188:191], v[88:91]
    v_cvt_pk_bf16_f32 v59, v62, v63
    v_cvt_pk_bf16_f32 v176, v176, v177
    v_cvt_pk_bf16_f32 v177, v178, v179
    v_mfma_f32_16x16x32_bf16 v[68:71], v[252:255], a[140:143], v[68:71]
    ds_read_b64_tr_b16 v[236:237], v103 offset:36864
    v_cvt_pk_bf16_f32 v178, v180, v181
    v_cvt_pk_bf16_f32 v179, v182, v183
    v_mfma_f32_16x16x32_bf16 v[76:79], v[252:255], a[156:159], v[76:79]
    buffer_store_dwordx4 v[56:59], v15, s[16:19], s34 offen sc1
    v_mfma_f32_16x16x32_bf16 v[84:87], v[252:255], a[172:175], v[84:87]
    s_add_u32 s34, s34, 999424
    ds_read_b64_tr_b16 v[238:239], v103 offset:38912
    ds_write_b128 v25, v[176:179] offset:17408
    v_mfma_f32_16x16x32_bf16 v[92:95], v[252:255], a[188:191], v[92:95]
    s_waitcnt lgkmcnt(5)
    v_accvgpr_read_b32 v184, a120
    v_accvgpr_read_b32 v185, a121
    v_mfma_f32_16x16x32_bf16 v[32:35], v[224:227], a[128:131], 0
    ds_read_b64_tr_b16 v[240:241], v102 offset:40960
    v_accvgpr_read_b32 v186, a122
    v_mfma_f32_16x16x32_bf16 v[40:43], v[224:227], a[144:147], 0
    v_accvgpr_read_b32 v187, a123
    v_accvgpr_read_b32 v188, a124
    v_accvgpr_read_b32 v189, a125
    v_mfma_f32_16x16x32_bf16 v[48:51], v[224:227], a[160:163], 0
    ds_read_b64_tr_b16 v[242:243], v102 offset:43008
    v_cvt_pk_bf16_f32 v64, v64, v65
    v_accvgpr_read_b32 v190, a126
    v_mfma_f32_16x16x32_bf16 v[56:59], v[224:227], a[176:179], 0
    v_cvt_pk_bf16_f32 v65, v66, v67
    v_cvt_pk_bf16_f32 v66, v68, v69
    v_accvgpr_read_b32 v191, a127
    v_mfma_f32_16x16x32_bf16 v[36:39], v[228:231], a[128:131], 0
    ds_read_b64_tr_b16 v[244:245], v103 offset:40960
    v_cvt_pk_bf16_f32 v67, v70, v71
    v_mfma_f32_16x16x32_bf16 v[44:47], v[228:231], a[144:147], 0
    v_accvgpr_write_b32 a192, v64
    v_pk_mul_f32 v[184:185], v[184:185], s[44:45]
    v_pk_mul_f32 v[186:187], v[186:187], s[44:45]
    v_mfma_f32_16x16x32_bf16 v[52:55], v[228:231], a[160:163], 0
    ds_read_b64_tr_b16 v[246:247], v103 offset:43008
    v_accvgpr_write_b32 a193, v65
    v_mfma_f32_16x16x32_bf16 v[60:63], v[228:231], a[176:179], 0
    s_waitcnt lgkmcnt(5)
    v_accvgpr_write_b32 a194, v66
    v_pk_mul_f32 v[188:189], v[188:189], s[44:45]
    v_pk_mul_f32 v[190:191], v[190:191], s[44:45]
    v_mfma_f32_16x16x32_bf16 v[32:35], v[232:235], a[132:135], v[32:35]
    ds_read_b64_tr_b16 v[248:249], v102 offset:45056
    v_cvt_pk_bf16_f32 v184, v184, v185
    v_accvgpr_write_b32 a195, v67
    v_mfma_f32_16x16x32_bf16 v[40:43], v[232:235], a[148:151], v[40:43]
    v_cvt_pk_bf16_f32 v72, v72, v73
    v_cvt_pk_bf16_f32 v185, v186, v187
    v_cvt_pk_bf16_f32 v186, v188, v189
    v_mfma_f32_16x16x32_bf16 v[48:51], v[232:235], a[164:167], v[48:51]
    ds_read_b64_tr_b16 v[250:251], v102 offset:47104
    v_cvt_pk_bf16_f32 v73, v74, v75
    v_cvt_pk_bf16_f32 v187, v190, v191
    v_mfma_f32_16x16x32_bf16 v[56:59], v[232:235], a[180:183], v[56:59]
    ds_write_b128 v25, v[184:187] offset:25600
    v_cvt_pk_bf16_f32 v74, v76, v77
    v_mfma_f32_16x16x32_bf16 v[36:39], v[236:239], a[132:135], v[36:39]
    ds_read_b64_tr_b16 v[252:253], v103 offset:45056
    v_cvt_pk_bf16_f32 v75, v78, v79
    v_mfma_f32_16x16x32_bf16 v[44:47], v[236:239], a[148:151], v[44:47]
    s_waitcnt vmcnt(24)
    v_accvgpr_write_b32 a196, v72
    v_accvgpr_read_b32 v192, a0
    v_accvgpr_read_b32 v193, a1
    v_mfma_f32_16x16x32_bf16 v[52:55], v[236:239], a[164:167], v[52:55]
    s_waitcnt lgkmcnt(4)
    ds_read_b64_tr_b16 v[254:255], v103 offset:47104
    v_accvgpr_write_b32 a197, v73
    v_accvgpr_read_b32 v194, a2
    v_accvgpr_read_b32 v195, a3
    v_mfma_f32_16x16x32_bf16 v[60:63], v[236:239], a[180:183], v[60:63]
    s_barrier
    v_mfma_f32_16x16x32_bf16 v[32:35], v[240:243], a[136:139], v[32:35]
    s_add_u32 m0, s76, 32768
    ds_read_b64_tr_b16 v[224:225], v100 offset:49152
    v_accvgpr_write_b32 a198, v74
    v_accvgpr_read_b32 v196, a4
    v_accvgpr_read_b32 v197, a5
    v_mfma_f32_16x16x32_bf16 v[40:43], v[240:243], a[152:155], v[40:43]
    v_accvgpr_write_b32 a199, v75
    v_accvgpr_read_b32 v198, a6
    v_accvgpr_read_b32 v199, a7
    v_mfma_f32_16x16x32_bf16 v[48:51], v[240:243], a[168:171], v[48:51]
    ds_read_b64_tr_b16 v[226:227], v100 offset:51200
    v_cvt_pk_bf16_f32 v80, v80, v81
    v_pk_mul_f32 v[192:193], v[192:193], s[44:45]
    v_mfma_f32_16x16x32_bf16 v[56:59], v[240:243], a[184:187], v[56:59]
    v_cvt_pk_bf16_f32 v81, v82, v83
    v_cvt_pk_bf16_f32 v82, v84, v85
    v_pk_mul_f32 v[194:195], v[194:195], s[44:45]
    v_mfma_f32_16x16x32_bf16 v[36:39], v[244:247], a[136:139], v[36:39]
    ds_read_b64_tr_b16 v[228:229], v101 offset:49152
    buffer_load_dwordx4 v0, s[64:67], s60 offen offset:0 sc1 lds
    v_pk_mul_f32 v[196:197], v[196:197], s[44:45]
    v_mfma_f32_16x16x32_bf16 v[44:47], v[244:247], a[152:155], v[44:47]
    v_cvt_pk_bf16_f32 v83, v86, v87
    v_accvgpr_write_b32 a200, v80
    v_pk_mul_f32 v[198:199], v[198:199], s[44:45]
    v_mfma_f32_16x16x32_bf16 v[52:55], v[244:247], a[168:171], v[52:55]
    ds_read_b64_tr_b16 v[230:231], v101 offset:51200
    v_cvt_pk_bf16_f32 v192, v192, v193
    v_cvt_pk_bf16_f32 v193, v194, v195
    v_accvgpr_write_b32 a201, v81
    v_mfma_f32_16x16x32_bf16 v[60:63], v[244:247], a[184:187], v[60:63]
    s_waitcnt lgkmcnt(4)
    v_cvt_pk_bf16_f32 v194, v196, v197
    v_accvgpr_write_b32 a202, v82
    v_accvgpr_write_b32 a203, v83
    v_mfma_f32_16x16x32_bf16 v[32:35], v[248:251], a[140:143], v[32:35]
    ds_read_b64_tr_b16 v[232:233], v100 offset:53248
    v_cvt_pk_bf16_f32 v88, v88, v89
    v_cvt_pk_bf16_f32 v195, v198, v199
    v_mfma_f32_16x16x32_bf16 v[40:43], v[248:251], a[156:159], v[40:43]
    buffer_load_dwordx4 v0, s[64:67], s60 offen offset:1024 sc1 lds
    ds_write_b128 v24, v[192:195] offset:0
    v_cvt_pk_bf16_f32 v89, v90, v91
    v_mfma_f32_16x16x32_bf16 v[48:51], v[248:251], a[172:175], v[48:51]
    ds_read_b64_tr_b16 v[234:235], v100 offset:55296
    v_cvt_pk_bf16_f32 v90, v92, v93
    v_accvgpr_read_b32 v200, a8
    v_mfma_f32_16x16x32_bf16 v[56:59], v[248:251], a[188:191], v[56:59]
    v_cvt_pk_bf16_f32 v91, v94, v95
    v_accvgpr_read_b32 v201, a9
    v_accvgpr_read_b32 v202, a10
    v_mfma_f32_16x16x32_bf16 v[36:39], v[252:255], a[140:143], v[36:39]
    ds_read_b64_tr_b16 v[236:237], v101 offset:53248
    v_accvgpr_write_b32 a204, v88
    v_accvgpr_read_b32 v203, a11
    v_mfma_f32_16x16x32_bf16 v[44:47], v[252:255], a[156:159], v[44:47]
    v_accvgpr_write_b32 a205, v89
    v_accvgpr_read_b32 v204, a12
    v_accvgpr_read_b32 v205, a13
    v_mfma_f32_16x16x32_bf16 v[52:55], v[252:255], a[172:175], v[52:55]
    ds_read_b64_tr_b16 v[238:239], v101 offset:55296
    buffer_load_dwordx4 v0, s[64:67], s60 offen offset:2048 sc1 lds
    v_accvgpr_read_b32 v206, a14
    v_mfma_f32_16x16x32_bf16 v[60:63], v[252:255], a[188:191], v[60:63]
    s_waitcnt lgkmcnt(5)
    v_accvgpr_write_b32 a206, v90
    v_accvgpr_write_b32 a207, v91
    v_accvgpr_read_b32 v207, a15
    v_mfma_f32_16x16x32_bf16 v[64:67], v[224:227], a[128:131], 0
    ds_read_b64_tr_b16 v[240:241], v100 offset:57344
    v_pk_mul_f32 v[200:201], v[200:201], s[44:45]
    v_mfma_f32_16x16x32_bf16 v[72:75], v[224:227], a[144:147], 0
    v_pk_mul_f32 v[202:203], v[202:203], s[44:45]
    v_pk_mul_f32 v[204:205], v[204:205], s[44:45]
    v_pk_mul_f32 v[206:207], v[206:207], s[44:45]
    v_mfma_f32_16x16x32_bf16 v[80:83], v[224:227], a[160:163], 0
    ds_read_b64_tr_b16 v[242:243], v100 offset:59392
    v_cvt_pk_bf16_f32 v32, v32, v33
    v_cvt_pk_bf16_f32 v200, v200, v201
    v_mfma_f32_16x16x32_bf16 v[88:91], v[224:227], a[176:179], 0
    buffer_load_dwordx4 v0, s[64:67], s60 offen offset:3072 sc1 lds
    v_cvt_pk_bf16_f32 v33, v34, v35
    v_cvt_pk_bf16_f32 v201, v202, v203
    v_mfma_f32_16x16x32_bf16 v[68:71], v[228:231], a[128:131], 0
    ds_read_b64_tr_b16 v[244:245], v101 offset:57344
    v_cvt_pk_bf16_f32 v34, v36, v37
    v_cvt_pk_bf16_f32 v202, v204, v205
    v_mfma_f32_16x16x32_bf16 v[76:79], v[228:231], a[144:147], 0
    v_cvt_pk_bf16_f32 v35, v38, v39
    v_cvt_pk_bf16_f32 v203, v206, v207
    v_accvgpr_write_b32 a208, v32
    v_mfma_f32_16x16x32_bf16 v[84:87], v[228:231], a[160:163], 0
    ds_read_b64_tr_b16 v[246:247], v101 offset:59392
    ds_write_b128 v24, v[200:203] offset:8192
    v_accvgpr_write_b32 a209, v33
    v_mfma_f32_16x16x32_bf16 v[92:95], v[228:231], a[176:179], 0
    s_waitcnt lgkmcnt(5)
    v_accvgpr_write_b32 a210, v34
    v_accvgpr_read_b32 v208, a64
    v_accvgpr_read_b32 v209, a65
    v_mfma_f32_16x16x32_bf16 v[64:67], v[232:235], a[132:135], v[64:67]
    s_add_u32 s60, s60, 16384
    ds_read_b64_tr_b16 v[248:249], v100 offset:61440
    v_accvgpr_write_b32 a211, v35
    v_mfma_f32_16x16x32_bf16 v[72:75], v[232:235], a[148:151], v[72:75]
    v_cvt_pk_bf16_f32 v40, v40, v41
    v_accvgpr_read_b32 v210, a66
    v_accvgpr_read_b32 v211, a67
    v_mfma_f32_16x16x32_bf16 v[80:83], v[232:235], a[164:167], v[80:83]
    ds_read_b64_tr_b16 v[250:251], v100 offset:63488
    v_cvt_pk_bf16_f32 v41, v42, v43
    v_mfma_f32_16x16x32_bf16 v[88:91], v[232:235], a[180:183], v[88:91]
    v_cvt_pk_bf16_f32 v42, v44, v45
    v_accvgpr_read_b32 v212, a68
    v_accvgpr_read_b32 v213, a69
    v_mfma_f32_16x16x32_bf16 v[68:71], v[236:239], a[132:135], v[68:71]
    ds_read_b64_tr_b16 v[252:253], v101 offset:61440
    v_cvt_pk_bf16_f32 v43, v46, v47
    v_accvgpr_read_b32 v214, a70
    v_mfma_f32_16x16x32_bf16 v[76:79], v[236:239], a[148:151], v[76:79]
    s_waitcnt vmcnt(23)
    v_accvgpr_write_b32 a212, v40
    v_accvgpr_read_b32 v215, a71
    v_pk_mul_f32 v[208:209], v[208:209], s[44:45]
    v_mfma_f32_16x16x32_bf16 v[84:87], v[236:239], a[164:167], v[84:87]
    s_waitcnt lgkmcnt(4)
    ds_read_b64_tr_b16 v[254:255], v101 offset:63488
    v_accvgpr_write_b32 a213, v41
    v_pk_mul_f32 v[210:211], v[210:211], s[44:45]
    v_pk_mul_f32 v[212:213], v[212:213], s[44:45]
    v_mfma_f32_16x16x32_bf16 v[92:95], v[236:239], a[180:183], v[92:95]
    s_barrier
    v_mfma_f32_16x16x32_bf16 v[64:67], v[240:243], a[136:139], v[64:67]
    s_add_u32 m0, s76, 98304
    ds_read_b64_tr_b16 v[224:225], v102 offset:49152
    v_accvgpr_write_b32 a214, v42
    v_pk_mul_f32 v[214:215], v[214:215], s[44:45]
    v_mfma_f32_16x16x32_bf16 v[72:75], v[240:243], a[152:155], v[72:75]
    v_cvt_pk_bf16_f32 v208, v208, v209
    v_cvt_pk_bf16_f32 v209, v210, v211
    v_accvgpr_write_b32 a215, v43
    v_mfma_f32_16x16x32_bf16 v[80:83], v[240:243], a[168:171], v[80:83]
    ds_read_b64_tr_b16 v[226:227], v102 offset:51200
    v_cvt_pk_bf16_f32 v48, v48, v49
    v_cvt_pk_bf16_f32 v210, v212, v213
    v_mfma_f32_16x16x32_bf16 v[88:91], v[240:243], a[184:187], v[88:91]
    v_cvt_pk_bf16_f32 v49, v50, v51
    v_cvt_pk_bf16_f32 v50, v52, v53
    v_cvt_pk_bf16_f32 v211, v214, v215
    v_mfma_f32_16x16x32_bf16 v[68:71], v[244:247], a[136:139], v[68:71]
    ds_read_b64_tr_b16 v[228:229], v103 offset:49152
    buffer_load_dwordx4 v0, s[16:19], s39 offen offset:0 sc1 lds
    ds_write_b128 v24, v[208:211] offset:1024
    v_mfma_f32_16x16x32_bf16 v[76:79], v[244:247], a[152:155], v[76:79]
    v_cvt_pk_bf16_f32 v51, v54, v55
    v_accvgpr_write_b32 a216, v48
    v_accvgpr_read_b32 v216, a72
    v_mfma_f32_16x16x32_bf16 v[84:87], v[244:247], a[168:171], v[84:87]
    ds_read_b64_tr_b16 v[230:231], v103 offset:51200
    v_accvgpr_write_b32 a217, v49
    v_accvgpr_read_b32 v217, a73
    v_mfma_f32_16x16x32_bf16 v[92:95], v[244:247], a[184:187], v[92:95]
    s_waitcnt lgkmcnt(5)
    v_accvgpr_write_b32 a218, v50
    v_accvgpr_write_b32 a219, v51
    v_accvgpr_read_b32 v218, a74
    v_accvgpr_read_b32 v219, a75
    v_mfma_f32_16x16x32_bf16 v[64:67], v[248:251], a[140:143], v[64:67]
    ds_read_b64_tr_b16 v[232:233], v102 offset:53248
    v_cvt_pk_bf16_f32 v56, v56, v57
    v_accvgpr_read_b32 v220, a76
    v_mfma_f32_16x16x32_bf16 v[72:75], v[248:251], a[156:159], v[72:75]
    buffer_load_dwordx4 v0, s[16:19], s39 offen offset:1024 sc1 lds
    v_cvt_pk_bf16_f32 v57, v58, v59
    v_accvgpr_read_b32 v221, a77
    v_mfma_f32_16x16x32_bf16 v[80:83], v[248:251], a[172:175], v[80:83]
    ds_read_b64_tr_b16 v[234:235], v102 offset:55296
    v_cvt_pk_bf16_f32 v58, v60, v61
    v_accvgpr_read_b32 v222, a78
    v_accvgpr_read_b32 v223, a79
    v_mfma_f32_16x16x32_bf16 v[88:91], v[248:251], a[188:191], v[88:91]
    v_cvt_pk_bf16_f32 v59, v62, v63
    v_pk_mul_f32 v[216:217], v[216:217], s[44:45]
    v_pk_mul_f32 v[218:219], v[218:219], s[44:45]
    v_mfma_f32_16x16x32_bf16 v[68:71], v[252:255], a[140:143], v[68:71]
    ds_read_b64_tr_b16 v[236:237], v103 offset:53248
    v_accvgpr_write_b32 a220, v56
    v_mfma_f32_16x16x32_bf16 v[76:79], v[252:255], a[156:159], v[76:79]
    v_accvgpr_write_b32 a221, v57
    v_pk_mul_f32 v[220:221], v[220:221], s[44:45]
    v_pk_mul_f32 v[222:223], v[222:223], s[44:45]
    v_mfma_f32_16x16x32_bf16 v[84:87], v[252:255], a[172:175], v[84:87]
    ds_read_b64_tr_b16 v[238:239], v103 offset:55296
    buffer_load_dwordx4 v0, s[16:19], s39 offen offset:2048 sc1 lds
    v_cvt_pk_bf16_f32 v216, v216, v217
    v_mfma_f32_16x16x32_bf16 v[92:95], v[252:255], a[188:191], v[92:95]
    s_waitcnt lgkmcnt(4)
    v_cvt_pk_bf16_f32 v217, v218, v219
    v_accvgpr_write_b32 a222, v58
    v_accvgpr_write_b32 a223, v59
    v_mfma_f32_16x16x32_bf16 v[32:35], v[224:227], a[128:131], 0
    ds_read_b64_tr_b16 v[240:241], v102 offset:57344
    v_cvt_pk_bf16_f32 v218, v220, v221
    v_cvt_pk_bf16_f32 v219, v222, v223
    v_mfma_f32_16x16x32_bf16 v[40:43], v[224:227], a[144:147], 0
    ds_write_b128 v24, v[216:219] offset:9216
    v_mfma_f32_16x16x32_bf16 v[48:51], v[224:227], a[160:163], 0
    ds_read_b64_tr_b16 v[242:243], v102 offset:59392
    v_cvt_pk_bf16_f32 v64, v64, v65
    v_mfma_f32_16x16x32_bf16 v[56:59], v[224:227], a[176:179], 0
    buffer_load_dwordx4 v0, s[16:19], s39 offen offset:3072 sc1 lds
    v_cvt_pk_bf16_f32 v65, v66, v67
    v_mfma_f32_16x16x32_bf16 v[36:39], v[228:231], a[128:131], 0
    ds_read_b64_tr_b16 v[244:245], v103 offset:57344
    v_cvt_pk_bf16_f32 v66, v68, v69
    v_mfma_f32_16x16x32_bf16 v[44:47], v[228:231], a[144:147], 0
    v_cvt_pk_bf16_f32 v67, v70, v71
    v_accvgpr_write_b32 a224, v64
    v_mfma_f32_16x16x32_bf16 v[52:55], v[228:231], a[160:163], 0
    ds_read_b64_tr_b16 v[246:247], v103 offset:59392
    v_accvgpr_write_b32 a225, v65
    v_mfma_f32_16x16x32_bf16 v[60:63], v[228:231], a[176:179], 0
    s_waitcnt lgkmcnt(5)
    v_accvgpr_write_b32 a226, v66
    v_accvgpr_write_b32 a227, v67
    v_mfma_f32_16x16x32_bf16 v[32:35], v[232:235], a[132:135], v[32:35]
    s_add_u32 s39, s39, 16384
    ds_read_b64_tr_b16 v[248:249], v102 offset:61440
    v_cvt_pk_bf16_f32 v72, v72, v73
    v_mfma_f32_16x16x32_bf16 v[40:43], v[232:235], a[148:151], v[40:43]
    v_cvt_pk_bf16_f32 v73, v74, v75
    v_cvt_pk_bf16_f32 v74, v76, v77
    v_mfma_f32_16x16x32_bf16 v[48:51], v[232:235], a[164:167], v[48:51]
    ds_read_b64_tr_b16 v[250:251], v102 offset:63488
    v_cvt_pk_bf16_f32 v75, v78, v79
    v_mfma_f32_16x16x32_bf16 v[56:59], v[232:235], a[180:183], v[56:59]
    v_accvgpr_write_b32 a228, v72
    v_accvgpr_write_b32 a229, v73
    v_mfma_f32_16x16x32_bf16 v[36:39], v[236:239], a[132:135], v[36:39]
    ds_read_b64_tr_b16 v[252:253], v103 offset:61440
    v_accvgpr_write_b32 a230, v74
    v_mfma_f32_16x16x32_bf16 v[44:47], v[236:239], a[148:151], v[44:47]
    s_waitcnt vmcnt(20) lgkmcnt(6)
    v_accvgpr_write_b32 a231, v75
    v_mfma_f32_16x16x32_bf16 v[52:55], v[236:239], a[164:167], v[52:55]
    s_waitcnt lgkmcnt(3)
    ds_read_b64_tr_b16 v[254:255], v103 offset:63488
    v_cvt_pk_bf16_f32 v80, v80, v81
    v_mfma_f32_16x16x32_bf16 v[60:63], v[236:239], a[180:183], v[60:63]
    s_barrier
    v_mfma_f32_16x16x32_bf16 v[32:35], v[240:243], a[136:139], v[32:35]
    s_add_u32 m0, s76, 49152
    ds_read_b128 a[0:3], v19 offset:0
    ds_read_b128 a[64:67], v16 offset:0
    v_mfma_f32_16x16x32_bf16 v[40:43], v[240:243], a[152:155], v[40:43]
    ds_read_b128 a[4:7], v19 offset:1024
    v_cvt_pk_bf16_f32 v81, v82, v83
    v_cvt_pk_bf16_f32 v82, v84, v85
    v_mfma_f32_16x16x32_bf16 v[48:51], v[240:243], a[168:171], v[48:51]
    ds_read_b128 a[68:71], v16 offset:1024
    ds_read_b128 a[8:11], v19 offset:2048
    v_cvt_pk_bf16_f32 v83, v86, v87
    v_mfma_f32_16x16x32_bf16 v[56:59], v[240:243], a[184:187], v[56:59]
    ds_read_b128 a[72:75], v16 offset:2048
    buffer_load_dwordx4 v0, s[64:67], s60 offen offset:0 sc1 lds
    v_accvgpr_write_b32 a232, v80
    v_mfma_f32_16x16x32_bf16 v[36:39], v[244:247], a[136:139], v[36:39]
    ds_read_b128 a[12:15], v19 offset:3072
    ds_read_b128 a[76:79], v16 offset:3072
    v_accvgpr_write_b32 a233, v81
    v_mfma_f32_16x16x32_bf16 v[44:47], v[244:247], a[152:155], v[44:47]
    ds_read_b128 a[16:19], v19 offset:4096
    buffer_load_dwordx4 v0, s[64:67], s60 offen offset:1024 sc1 lds
    v_mfma_f32_16x16x32_bf16 v[52:55], v[244:247], a[168:171], v[52:55]
    ds_read_b128 a[80:83], v16 offset:4096
    ds_read_b128 a[20:23], v19 offset:5120
    v_mfma_f32_16x16x32_bf16 v[60:63], v[244:247], a[184:187], v[60:63]
    s_waitcnt lgkmcnt(11)
    ds_read_b128 a[84:87], v16 offset:5120
    v_accvgpr_write_b32 a234, v82
    v_accvgpr_write_b32 a235, v83
    v_mfma_f32_16x16x32_bf16 v[32:35], v[248:251], a[140:143], v[32:35]
    ds_read_b128 a[24:27], v19 offset:6144
    ds_read_b128 a[88:91], v16 offset:6144
    v_cvt_pk_bf16_f32 v88, v88, v89
    v_mfma_f32_16x16x32_bf16 v[40:43], v[248:251], a[156:159], v[40:43]
    ds_read_b128 a[28:31], v19 offset:7168
    buffer_load_dwordx4 v0, s[64:67], s60 offen offset:2048 sc1 lds
    v_cvt_pk_bf16_f32 v89, v90, v91
    v_mfma_f32_16x16x32_bf16 v[48:51], v[248:251], a[172:175], v[48:51]
    ds_read_b128 a[92:95], v16 offset:7168
    ds_read_b128 a[32:35], v19 offset:8192
    v_cvt_pk_bf16_f32 v90, v92, v93
    v_mfma_f32_16x16x32_bf16 v[56:59], v[248:251], a[188:191], v[56:59]
    ds_read_b128 a[36:39], v19 offset:9216
    buffer_load_dwordx4 v0, s[64:67], s60 offen offset:3072 sc1 lds
    v_cvt_pk_bf16_f32 v91, v94, v95
    v_mfma_f32_16x16x32_bf16 v[36:39], v[252:255], a[140:143], v[36:39]
    ds_read_b128 a[40:43], v19 offset:10240
    ds_read_b128 a[44:47], v19 offset:11264
    v_mfma_f32_16x16x32_bf16 v[44:47], v[252:255], a[156:159], v[44:47]
    s_add_u32 s60, s60, 16384
    ds_read_b128 a[48:51], v19 offset:12288
    v_accvgpr_write_b32 a236, v88
    v_accvgpr_write_b32 a237, v89
    v_mfma_f32_16x16x32_bf16 v[52:55], v[252:255], a[172:175], v[52:55]
    ds_read_b128 a[52:55], v19 offset:13312
    ds_read_b128 a[56:59], v19 offset:14336
    v_mfma_f32_16x16x32_bf16 v[60:63], v[252:255], a[188:191], v[60:63]
    ds_read_b128 a[60:63], v19 offset:15360
    v_accvgpr_write_b32 a238, v90
    v_accvgpr_write_b32 a239, v91
.Lmain_kernel_job_29:
    s_waitcnt vmcnt(19) lgkmcnt(15)
    v_mfma_f32_16x16x32_bf16 v[64:67], a[64:67], a[0:3], v[112:115]
    ds_read_b128 a[96:99], v16 offset:8192
    s_waitcnt vmcnt(18)
    v_mfma_f32_16x16x32_bf16 v[72:75], a[64:67], a[4:7], v[120:123]
    v_mfma_f32_16x16x32_bf16 v[68:71], a[68:71], a[0:3], v[116:119]
    ds_read_b128 a[100:103], v16 offset:9216
    v_cvt_pk_bf16_f32 v144, v32, v33
    v_mfma_f32_16x16x32_bf16 v[76:79], a[68:71], a[4:7], v[124:127]
    v_cvt_pk_bf16_f32 v145, v34, v35
    s_waitcnt vmcnt(17)
    v_mfma_f32_16x16x32_bf16 v[64:67], a[72:75], a[8:11], v[64:67]
    ds_read_b128 a[104:107], v16 offset:10240
    buffer_store_dwordx4 a[0:3], v14, s[16:19], s6 offen offset:0 sc1
    s_waitcnt vmcnt(17)
    v_mfma_f32_16x16x32_bf16 v[72:75], a[72:75], a[12:15], v[72:75]
    buffer_store_dwordx4 a[4:7], v14, s[16:19], s6 offen offset:1024 sc1
    v_cvt_pk_bf16_f32 v146, v36, v37
    v_mfma_f32_16x16x32_bf16 v[68:71], a[76:79], a[8:11], v[68:71]
    ds_read_b128 a[108:111], v16 offset:11264
    buffer_store_dwordx4 a[8:11], v14, s[16:19], s6 offen offset:2048 sc1
    v_mfma_f32_16x16x32_bf16 v[76:79], a[76:79], a[12:15], v[76:79]
    s_waitcnt lgkmcnt(4)
    buffer_store_dwordx4 a[12:15], v14, s[16:19], s6 offen offset:3072 sc1
    v_cvt_pk_bf16_f32 v147, v38, v39
    s_waitcnt vmcnt(19)
    v_mfma_f32_16x16x32_bf16 v[64:67], a[80:83], a[16:19], v[64:67]
    s_cmp_eq_u32 s37, s38
    ds_read_b128 a[112:115], v16 offset:12288
    s_waitcnt vmcnt(18)
    v_mfma_f32_16x16x32_bf16 v[72:75], a[80:83], a[20:23], v[72:75]
    s_cbranch_scc1 .Lmain_kernel_mask_30
.Lmain_kernel_maskr_31:
    v_mfma_f32_16x16x32_bf16 v[68:71], a[84:87], a[16:19], v[68:71]
    s_add_u32 s6, s6, 4096
    ds_read_b128 a[116:119], v16 offset:13312
    v_cvt_pk_bf16_f32 v148, v40, v41
    v_mfma_f32_16x16x32_bf16 v[76:79], a[84:87], a[20:23], v[76:79]
    buffer_store_dwordx4 a[16:19], v14, s[16:19], s6 offen offset:0 sc1
    v_cvt_pk_bf16_f32 v149, v42, v43
    s_waitcnt vmcnt(18)
    v_mfma_f32_16x16x32_bf16 v[64:67], a[88:91], a[24:27], v[64:67]
    ds_read_b128 a[120:123], v16 offset:14336
    buffer_store_dwordx4 a[20:23], v14, s[16:19], s6 offen offset:1024 sc1
    s_waitcnt vmcnt(18)
    v_mfma_f32_16x16x32_bf16 v[72:75], a[88:91], a[28:31], v[72:75]
    buffer_store_dwordx4 a[24:27], v14, s[16:19], s6 offen offset:2048 sc1
    v_cvt_pk_bf16_f32 v150, v44, v45
    v_mfma_f32_16x16x32_bf16 v[68:71], a[92:95], a[24:27], v[68:71]
    s_waitcnt lgkmcnt(3)
    ds_read_b128 a[124:127], v16 offset:15360
    v_mfma_f32_16x16x32_bf16 v[76:79], a[92:95], a[28:31], v[76:79]
    s_barrier
    s_waitcnt vmcnt(18)
    v_mfma_f32_16x16x32_bf16 v[64:67], a[96:99], a[32:35], v[64:67]
    s_add_u32 m0, s76, 114688
    ds_read_b128 a[64:67], v16 offset:16384
    v_cvt_pk_bf16_f32 v151, v46, v47
    s_waitcnt vmcnt(17)
    v_mfma_f32_16x16x32_bf16 v[72:75], a[96:99], a[36:39], v[72:75]
    buffer_load_dwordx4 v0, s[16:19], s39 offen offset:0 sc1 lds
    v_cvt_pk_bf16_f32 v152, v48, v49
    v_mfma_f32_16x16x32_bf16 v[68:71], a[100:103], a[32:35], v[68:71]
    ds_read_b128 a[68:71], v16 offset:17408
    v_cvt_pk_bf16_f32 v153, v50, v51
    v_mfma_f32_16x16x32_bf16 v[76:79], a[100:103], a[36:39], v[76:79]
    buffer_load_dwordx4 v0, s[16:19], s39 offen offset:1024 sc1 lds
    s_waitcnt vmcnt(18)
    v_mfma_f32_16x16x32_bf16 v[64:67], a[104:107], a[40:43], v[64:67]
    ds_read_b128 a[72:75], v16 offset:18432
    buffer_load_dwordx4 v0, s[16:19], s39 offen offset:2048 sc1 lds
    s_waitcnt vmcnt(18)
    v_mfma_f32_16x16x32_bf16 v[72:75], a[104:107], a[44:47], v[72:75]
    v_cvt_pk_bf16_f32 v154, v52, v53
    v_mfma_f32_16x16x32_bf16 v[68:71], a[108:111], a[40:43], v[68:71]
    ds_read_b128 a[76:79], v16 offset:19456
    buffer_load_dwordx4 v0, s[16:19], s39 offen offset:3072 sc1 lds
    v_mfma_f32_16x16x32_bf16 v[76:79], a[108:111], a[44:47], v[76:79]
    s_waitcnt lgkmcnt(4)
    v_cvt_pk_bf16_f32 v155, v54, v55
    s_waitcnt vmcnt(18)
    v_mfma_f32_16x16x32_bf16 v[64:67], a[112:115], a[48:51], v[64:67]
    s_add_u32 s39, s39, 16384
    ds_read_b128 a[80:83], v16 offset:20480
    v_cvt_pk_bf16_f32 v156, v56, v57
    s_waitcnt vmcnt(17)
    v_mfma_f32_16x16x32_bf16 v[72:75], a[112:115], a[52:55], v[72:75]
    s_cmp_eq_u32 s39, s61
    s_cselect_b32 s39, s62, s39
    s_cselect_b32 s61, s5, s61
    v_mfma_f32_16x16x32_bf16 v[68:71], a[116:119], a[48:51], v[68:71]
    s_cselect_b32 s62, 1073741824, s62
    ds_read_b128 a[84:87], v16 offset:21504
    v_cvt_pk_bf16_f32 v157, v58, v59
    v_mfma_f32_16x16x32_bf16 v[76:79], a[116:119], a[52:55], v[76:79]
    buffer_store_dwordx4 a[28:31], v14, s[16:19], s6 offen offset:3072 sc1
    s_waitcnt vmcnt(17)
    v_mfma_f32_16x16x32_bf16 v[64:67], a[120:123], a[56:59], v[64:67]
    s_add_u32 s6, s6, 4096
    ds_read_b128 a[88:91], v16 offset:22528
    v_cvt_pk_bf16_f32 v158, v60, v61
    s_waitcnt vmcnt(16)
    v_mfma_f32_16x16x32_bf16 v[72:75], a[120:123], a[60:63], v[72:75]
    buffer_store_dwordx4 a[32:35], v14, s[16:19], s6 offen offset:0 sc1
    v_mfma_f32_16x16x32_bf16 v[68:71], a[124:127], a[56:59], v[68:71]
    ds_read_b128 a[92:95], v16 offset:23552
    v_cvt_pk_bf16_f32 v159, v62, v63
    v_mfma_f32_16x16x32_bf16 v[76:79], a[124:127], a[60:63], v[76:79]
    s_waitcnt lgkmcnt(4)
    buffer_store_dwordx4 a[36:39], v14, s[16:19], s6 offen offset:1024 sc1
    v_mfma_f32_16x16x32_bf16 v[80:83], a[64:67], a[0:3], v[112:115]
    ds_read_b128 a[96:99], v16 offset:24576
    v_mfma_f32_16x16x32_bf16 v[88:91], a[64:67], a[4:7], v[120:123]
    v_max3_f32 v2, v64, v65, v66
    v_max3_f32 v3, v72, v73, v74
    v_mfma_f32_16x16x32_bf16 v[84:87], a[68:71], a[0:3], v[116:119]
    ds_read_b128 a[100:103], v16 offset:25600
    v_max3_f32 v2, v2, v67, v68
    v_mfma_f32_16x16x32_bf16 v[92:95], a[68:71], a[4:7], v[124:127]
    v_max3_f32 v3, v3, v75, v76
    v_max3_f32 v2, v2, v69, v70
    v_max3_f32 v3, v3, v77, v78
    v_mfma_f32_16x16x32_bf16 v[80:83], a[72:75], a[8:11], v[80:83]
    ds_read_b128 a[104:107], v16 offset:26624
    v_max_f32 v2, v2, v71
    v_max_f32 v3, v3, v79
    s_nop 1
    v_permlane32_swap_b32 v2, v3
    v_mfma_f32_16x16x32_bf16 v[88:91], a[72:75], a[12:15], v[88:91]
    v_max_f32 v2, v2, v3
    v_mov_b32 v4, v2
    s_nop 1
    v_permlane16_swap_b32 v2, v4
    v_mfma_f32_16x16x32_bf16 v[84:87], a[76:79], a[8:11], v[84:87]
    ds_read_b128 a[108:111], v16 offset:27648
    v_max_f32 v2, v2, v4
    v_mov_b32 v3, v2
    s_nop 1
    v_permlane32_swap_b32 v2, v3
    v_mfma_f32_16x16x32_bf16 v[92:95], a[76:79], a[12:15], v[92:95]
    s_waitcnt lgkmcnt(4)
    v_sub_f32 v20, 0, v2
    v_sub_f32 v21, 0, v3
    v_sub_f32 v48, v64, v2
    v_mfma_f32_16x16x32_bf16 v[80:83], a[80:83], a[16:19], v[80:83]
    ds_read_b128 a[112:115], v16 offset:28672
    v_exp_f32 v48, v48
    v_sub_f32 v49, v65, v2
    v_mfma_f32_16x16x32_bf16 v[88:91], a[80:83], a[20:23], v[88:91]
    v_exp_f32 v49, v49
    v_sub_f32 v50, v66, v2
    v_mfma_f32_16x16x32_bf16 v[84:87], a[84:87], a[16:19], v[84:87]
    ds_read_b128 a[116:119], v16 offset:29696
    v_exp_f32 v50, v50
    v_add_f32 v8, v48, v49
    v_mfma_f32_16x16x32_bf16 v[92:95], a[84:87], a[20:23], v[92:95]
    v_sub_f32 v51, v67, v2
    v_exp_f32 v51, v51
    v_mfma_f32_16x16x32_bf16 v[80:83], a[88:91], a[24:27], v[80:83]
    ds_read_b128 a[120:123], v16 offset:30720
    v_add_f32 v8, v8, v50
    v_sub_f32 v56, v72, v3
    v_mfma_f32_16x16x32_bf16 v[88:91], a[88:91], a[28:31], v[88:91]
    v_exp_f32 v56, v56
    v_add_f32 v8, v8, v51
    v_sub_f32 v57, v73, v3
    v_mfma_f32_16x16x32_bf16 v[84:87], a[92:95], a[24:27], v[84:87]
    s_waitcnt lgkmcnt(3)
    ds_read_b128 a[124:127], v16 offset:31744
    v_exp_f32 v57, v57
    v_sub_f32 v58, v74, v3
    v_exp_f32 v58, v58
    v_add_f32 v9, v56, v57
    v_mfma_f32_16x16x32_bf16 v[92:95], a[92:95], a[28:31], v[92:95]
    s_barrier
    v_mfma_f32_16x16x32_bf16 v[80:83], a[96:99], a[32:35], v[80:83]
    ds_read_b128 a[64:67], v14 offset:32768
    v_sub_f32 v59, v75, v3
    v_exp_f32 v59, v59
    v_mfma_f32_16x16x32_bf16 v[88:91], a[96:99], a[36:39], v[88:91]
    buffer_store_dwordx4 a[40:43], v14, s[16:19], s6 offen offset:2048 sc1
    v_add_f32 v9, v9, v58
    v_sub_f32 v52, v68, v2
    v_mfma_f32_16x16x32_bf16 v[84:87], a[100:103], a[32:35], v[84:87]
    ds_read_b128 a[68:71], v14 offset:33792
    buffer_store_dwordx4 a[44:47], v14, s[16:19], s6 offen offset:3072 sc1
    v_exp_f32 v52, v52
    v_mfma_f32_16x16x32_bf16 v[92:95], a[100:103], a[36:39], v[92:95]
    s_add_u32 s6, s6, 4096
    buffer_store_dwordx4 a[48:51], v14, s[16:19], s6 offen offset:0 sc1
    v_add_f32 v9, v9, v59
    v_sub_f32 v53, v69, v2
    v_mfma_f32_16x16x32_bf16 v[80:83], a[104:107], a[40:43], v[80:83]
    ds_read_b128 a[72:75], v14 offset:34816
    buffer_store_dwordx4 a[52:55], v14, s[16:19], s6 offen offset:1024 sc1
    v_exp_f32 v53, v53
    v_mfma_f32_16x16x32_bf16 v[88:91], a[104:107], a[44:47], v[88:91]
    buffer_store_dwordx4 a[56:59], v14, s[16:19], s6 offen offset:2048 sc1
    v_add_f32 v8, v8, v52
    v_sub_f32 v54, v70, v2
    v_mfma_f32_16x16x32_bf16 v[84:87], a[108:111], a[40:43], v[84:87]
    ds_read_b128 a[76:79], v14 offset:35840
    v_exp_f32 v54, v54
    v_add_f32 v8, v8, v53
    v_mfma_f32_16x16x32_bf16 v[92:95], a[108:111], a[44:47], v[92:95]
    s_waitcnt lgkmcnt(4)
    buffer_store_dwordx4 a[60:63], v14, s[16:19], s6 offen offset:3072 sc1
    v_sub_f32 v55, v71, v2
    v_mfma_f32_16x16x32_bf16 v[80:83], a[112:115], a[48:51], v[80:83]
    s_add_u32 s6, s6, 4096
    s_mov_b32 s6, 1073741824
    ds_read_b128 a[80:83], v14 offset:36864
    v_exp_f32 v55, v55
    v_mfma_f32_16x16x32_bf16 v[88:91], a[112:115], a[52:55], v[88:91]
    s_add_u32 m0, s76, 0
    v_add_f32 v8, v8, v54
    v_sub_f32 v60, v76, v3
    v_exp_f32 v60, v60
    v_mfma_f32_16x16x32_bf16 v[84:87], a[116:119], a[48:51], v[84:87]
    ds_read_b128 a[84:87], v14 offset:37888
    buffer_load_dwordx4 v0, s[64:67], s60 offen offset:0 sc1 lds
    buffer_load_dwordx4 v0, s[64:67], s60 offen offset:1024 sc1 lds
    v_add_f32 v8, v8, v55
    v_mfma_f32_16x16x32_bf16 v[92:95], a[116:119], a[52:55], v[92:95]
    buffer_load_dwordx4 v0, s[64:67], s60 offen offset:2048 sc1 lds
    buffer_load_dwordx4 v0, s[64:67], s60 offen offset:3072 sc1 lds
    v_sub_f32 v61, v77, v3
    v_mfma_f32_16x16x32_bf16 v[80:83], a[120:123], a[56:59], v[80:83]
    s_add_u32 s60, s60, 16384
    s_add_u32 m0, s76, 65536
    ds_read_b128 a[88:91], v14 offset:38912
    v_exp_f32 v61, v61
    v_mfma_f32_16x16x32_bf16 v[88:91], a[120:123], a[60:63], v[88:91]
    buffer_load_dwordx4 v0, s[16:19], s39 offen offset:0 sc1 lds
    buffer_load_dwordx4 v0, s[16:19], s39 offen offset:1024 sc1 lds
    v_add_f32 v9, v9, v60
    v_sub_f32 v62, v78, v3
    v_mfma_f32_16x16x32_bf16 v[84:87], a[124:127], a[56:59], v[84:87]
    ds_read_b128 a[92:95], v14 offset:39936
    buffer_load_dwordx4 v0, s[16:19], s39 offen offset:2048 sc1 lds
    v_exp_f32 v62, v62
    v_add_f32 v9, v9, v61
    v_sub_f32 v63, v79, v3
    v_exp_f32 v63, v63
    v_add_f32 v9, v9, v62
    v_add_f32 v9, v9, v63
    v_add_f32 v22, v22, v8
    v_add_f32 v23, v23, v9
    v_cvt_pk_bf16_f32 v24, v48, v49
    v_cvt_pk_bf16_f32 v25, v50, v51
    v_cvt_pk_bf16_f32 v26, v52, v53
    v_cvt_pk_bf16_f32 v27, v54, v55
    v_cvt_pk_bf16_f32 v28, v56, v57
    v_cvt_pk_bf16_f32 v29, v58, v59
    v_cvt_pk_bf16_f32 v30, v60, v61
    v_cvt_pk_bf16_f32 v31, v62, v63
    v_mfma_f32_16x16x32_bf16 v[92:95], a[124:127], a[60:63], v[92:95]
    s_waitcnt lgkmcnt(4)
    buffer_load_dwordx4 v0, s[16:19], s39 offen offset:3072 sc1 lds
    s_add_u32 s39, s39, 16384
    v_mfma_f32_16x16x32_bf16 v[32:35], a[64:67], v[24:27], 0
    ds_read_b128 a[96:99], v14 offset:40960
    v_mov_b32 v112, v20
    v_mfma_f32_16x16x32_bf16 v[40:43], a[64:67], v[28:31], 0
    v_add_f32 v80, v80, v20
    v_mov_b32 v113, v20
    v_mfma_f32_16x16x32_bf16 v[36:39], a[68:71], v[24:27], 0
    s_add_u32 m0, s76, 16384
    ds_read_b128 a[100:103], v14 offset:41984
    v_mov_b32 v114, v20
    v_mov_b32 v115, v20
    v_mfma_f32_16x16x32_bf16 v[44:47], a[68:71], v[28:31], 0
    buffer_load_dwordx4 v0, s[64:67], s60 offen offset:0 sc1 lds
    v_exp_f32 v48, v80
    v_mfma_f32_16x16x32_bf16 v[96:99], a[72:75], v[24:27], 0
    ds_read_b128 a[104:107], v14 offset:43008
    buffer_load_dwordx4 v0, s[64:67], s60 offen offset:1024 sc1 lds
    v_add_f32 v81, v81, v20
    v_mfma_f32_16x16x32_bf16 v[104:107], a[72:75], v[28:31], 0
    buffer_load_dwordx4 v0, s[64:67], s60 offen offset:2048 sc1 lds
    v_exp_f32 v49, v81
    v_mfma_f32_16x16x32_bf16 v[100:103], a[76:79], v[24:27], 0
    ds_read_b128 a[108:111], v14 offset:44032
    v_add_f32 v82, v82, v20
    v_mov_b32 v116, v20
    v_mfma_f32_16x16x32_bf16 v[108:111], a[76:79], v[28:31], 0
    s_waitcnt lgkmcnt(4)
    v_exp_f32 v50, v82
    v_mov_b32 v117, v20
    v_mfma_f32_16x16x32_bf16 v[160:163], a[80:83], v[24:27], 0
    ds_read_b128 a[112:115], v14 offset:45056
    v_add_f32 v8, v48, v49
    v_mov_b32 v118, v20
    v_mfma_f32_16x16x32_bf16 v[168:171], a[80:83], v[28:31], 0
    v_add_f32 v83, v83, v20
    v_exp_f32 v51, v83
    v_mfma_f32_16x16x32_bf16 v[164:167], a[84:87], v[24:27], 0
    ds_read_b128 a[116:119], v14 offset:46080
    v_add_f32 v8, v8, v50
    v_mov_b32 v119, v20
    v_mfma_f32_16x16x32_bf16 v[172:175], a[84:87], v[28:31], 0
    v_add_f32 v88, v88, v21
    v_exp_f32 v56, v88
    v_mfma_f32_16x16x32_bf16 v[176:179], a[88:91], v[24:27], 0
    ds_read_b128 a[120:123], v14 offset:47104
    v_add_f32 v8, v8, v51
    v_mov_b32 v120, v21
    v_mfma_f32_16x16x32_bf16 v[184:187], a[88:91], v[28:31], 0
    v_add_f32 v89, v89, v21
    v_exp_f32 v57, v89
    v_mfma_f32_16x16x32_bf16 v[180:183], a[92:95], v[24:27], 0
    ds_read_b128 a[124:127], v14 offset:48128
    v_add_f32 v90, v90, v21
    v_mov_b32 v121, v21
    v_mfma_f32_16x16x32_bf16 v[188:191], a[92:95], v[28:31], 0
    s_waitcnt lgkmcnt(4)
    v_exp_f32 v58, v90
    v_mov_b32 v122, v21
    v_mfma_f32_16x16x32_bf16 v[192:195], a[96:99], v[24:27], 0
    ds_read_b128 a[64:67], v16 offset:32768
    v_add_f32 v9, v56, v57
    v_mov_b32 v123, v21
    v_mfma_f32_16x16x32_bf16 v[200:203], a[96:99], v[28:31], 0
    buffer_load_dwordx4 v0, s[64:67], s60 offen offset:3072 sc1 lds
    v_add_f32 v91, v91, v21
    v_mov_b32 v124, v21
    v_mfma_f32_16x16x32_bf16 v[196:199], a[100:103], v[24:27], 0
    s_add_u32 s60, s60, 16384
    s_cmp_eq_u32 s60, s63
    ds_read_b128 a[68:71], v16 offset:33792
    v_mov_b32 v125, v21
    v_mfma_f32_16x16x32_bf16 v[204:207], a[100:103], v[28:31], 0
    s_cselect_b32 s60, s4, s60
    v_exp_f32 v59, v91
    v_mov_b32 v126, v21
    v_mfma_f32_16x16x32_bf16 v[208:211], a[104:107], v[24:27], 0
    ds_read_b128 a[72:75], v16 offset:34816
    v_add_f32 v9, v9, v58
    v_add_f32 v84, v84, v20
    v_mfma_f32_16x16x32_bf16 v[216:219], a[104:107], v[28:31], 0
    s_cselect_b32 s63, s5, s63
    v_exp_f32 v52, v84
    v_mov_b32 v127, v21
    v_mfma_f32_16x16x32_bf16 v[212:215], a[108:111], v[24:27], 0
    s_cselect_b32 s4, 1073741824, s4
    ds_read_b128 a[76:79], v16 offset:35840
    v_add_f32 v9, v9, v59
    v_mfma_f32_16x16x32_bf16 v[220:223], a[108:111], v[28:31], 0
    s_waitcnt lgkmcnt(4)
    v_add_f32 v85, v85, v20
    v_exp_f32 v53, v85
    v_mfma_f32_16x16x32_bf16 v[224:227], a[112:115], v[24:27], 0
    ds_read_b128 a[80:83], v16 offset:36864
    v_add_f32 v8, v8, v52
    v_mfma_f32_16x16x32_bf16 v[232:235], a[112:115], v[28:31], 0
    v_add_f32 v86, v86, v20
    v_exp_f32 v54, v86
    v_mfma_f32_16x16x32_bf16 v[228:231], a[116:119], v[24:27], 0
    s_cmp_eq_u32 s37, s38
    ds_read_b128 a[84:87], v16 offset:37888
    v_add_f32 v8, v8, v53
    v_mfma_f32_16x16x32_bf16 v[236:239], a[116:119], v[28:31], 0
    s_cbranch_scc1 .Lmain_kernel_mask_32
.Lmain_kernel_maskr_33:
    v_mfma_f32_16x16x32_bf16 v[240:243], a[120:123], v[24:27], 0
    ds_read_b128 a[88:91], v16 offset:38912
    v_add_f32 v87, v87, v20
    v_mfma_f32_16x16x32_bf16 v[248:251], a[120:123], v[28:31], 0
    v_exp_f32 v55, v87
    v_mfma_f32_16x16x32_bf16 v[244:247], a[124:127], v[24:27], 0
    ds_read_b128 a[92:95], v16 offset:39936
    v_add_f32 v8, v8, v54
    v_add_f32 v92, v92, v21
    v_mfma_f32_16x16x32_bf16 v[252:255], a[124:127], v[28:31], 0
    s_waitcnt lgkmcnt(4)
    v_exp_f32 v60, v92
    v_mfma_f32_16x16x32_bf16 v[64:67], a[64:67], a[0:3], v[112:115]
    ds_read_b128 a[96:99], v16 offset:40960
    v_add_f32 v8, v8, v55
    v_mfma_f32_16x16x32_bf16 v[72:75], a[64:67], a[4:7], v[120:123]
    v_add_f32 v93, v93, v21
    v_exp_f32 v61, v93
    v_mfma_f32_16x16x32_bf16 v[68:71], a[68:71], a[0:3], v[116:119]
    ds_read_b128 a[100:103], v16 offset:41984
    v_add_f32 v9, v9, v60
    v_mfma_f32_16x16x32_bf16 v[76:79], a[68:71], a[4:7], v[124:127]
    v_add_f32 v94, v94, v21
    v_exp_f32 v62, v94
    v_mfma_f32_16x16x32_bf16 v[64:67], a[72:75], a[8:11], v[64:67]
    ds_read_b128 a[104:107], v16 offset:43008
    v_add_f32 v9, v9, v61
    v_mfma_f32_16x16x32_bf16 v[72:75], a[72:75], a[12:15], v[72:75]
    v_add_f32 v95, v95, v21
    v_exp_f32 v63, v95
    v_mfma_f32_16x16x32_bf16 v[68:71], a[76:79], a[8:11], v[68:71]
    ds_read_b128 a[108:111], v16 offset:44032
    v_add_f32 v9, v9, v62
    v_mfma_f32_16x16x32_bf16 v[76:79], a[76:79], a[12:15], v[76:79]
    s_waitcnt lgkmcnt(4)
    v_add_f32 v9, v9, v63
    v_add_f32 v2, v8, v9
    v_mfma_f32_16x16x32_bf16 v[64:67], a[80:83], a[16:19], v[64:67]
    ds_read_b128 a[112:115], v16 offset:45056
    v_cmp_nge_f32 vcc, 1266679808, v2
    v_mfma_f32_16x16x32_bf16 v[72:75], a[80:83], a[20:23], v[72:75]
    buffer_store_dwordx4 v[144:147], v15, s[16:19], s34 offen sc1
    v_mfma_f32_16x16x32_bf16 v[68:71], a[84:87], a[16:19], v[68:71]
    ds_read_b128 a[116:119], v16 offset:46080
    v_mfma_f32_16x16x32_bf16 v[76:79], a[84:87], a[20:23], v[76:79]
    s_cbranch_vccnz .Lmain_kernel_rare_34
.Lmain_kernel_rarer_35:
    v_mfma_f32_16x16x32_bf16 v[64:67], a[88:91], a[24:27], v[64:67]
    ds_read_b128 a[120:123], v16 offset:47104
    v_add_f32 v22, v22, v8
    v_mfma_f32_16x16x32_bf16 v[72:75], a[88:91], a[28:31], v[72:75]
    v_add_f32 v23, v23, v9
    v_mfma_f32_16x16x32_bf16 v[68:71], a[92:95], a[24:27], v[68:71]
    s_waitcnt vmcnt(22)
    s_waitcnt lgkmcnt(3)
    ds_read_b128 a[124:127], v16 offset:48128
    v_mfma_f32_16x16x32_bf16 v[76:79], a[92:95], a[28:31], v[76:79]
    s_barrier
    v_mfma_f32_16x16x32_bf16 v[64:67], a[96:99], a[32:35], v[64:67]
    s_add_u32 m0, s76, 81920
    ds_read_b128 a[64:67], v14 offset:49152
    v_cvt_pk_bf16_f32 v24, v48, v49
    v_mfma_f32_16x16x32_bf16 v[72:75], a[96:99], a[36:39], v[72:75]
    v_cvt_pk_bf16_f32 v25, v50, v51
    v_mfma_f32_16x16x32_bf16 v[68:71], a[100:103], a[32:35], v[68:71]
    ds_read_b128 a[68:71], v14 offset:50176
    buffer_load_dwordx4 v0, s[16:19], s39 offen offset:0 sc1 lds
    v_mfma_f32_16x16x32_bf16 v[76:79], a[100:103], a[36:39], v[76:79]
    v_cvt_pk_bf16_f32 v26, v52, v53
    v_mfma_f32_16x16x32_bf16 v[64:67], a[104:107], a[40:43], v[64:67]
    ds_read_b128 a[72:75], v14 offset:51200
    v_mfma_f32_16x16x32_bf16 v[72:75], a[104:107], a[44:47], v[72:75]
    s_add_u32 s34, s34, 16384
    buffer_load_dwordx4 v0, s[16:19], s39 offen offset:1024 sc1 lds
    v_cvt_pk_bf16_f32 v27, v54, v55
    v_mfma_f32_16x16x32_bf16 v[68:71], a[108:111], a[40:43], v[68:71]
    ds_read_b128 a[76:79], v14 offset:52224
    v_mfma_f32_16x16x32_bf16 v[76:79], a[108:111], a[44:47], v[76:79]
    s_waitcnt lgkmcnt(4)
    v_cvt_pk_bf16_f32 v28, v56, v57
    v_mfma_f32_16x16x32_bf16 v[64:67], a[112:115], a[48:51], v[64:67]
    ds_read_b128 a[80:83], v14 offset:53248
    buffer_load_dwordx4 v0, s[16:19], s39 offen offset:2048 sc1 lds
    v_mfma_f32_16x16x32_bf16 v[72:75], a[112:115], a[52:55], v[72:75]
    v_cvt_pk_bf16_f32 v29, v58, v59
    v_mfma_f32_16x16x32_bf16 v[68:71], a[116:119], a[48:51], v[68:71]
    ds_read_b128 a[84:87], v14 offset:54272
    buffer_load_dwordx4 v0, s[16:19], s39 offen offset:3072 sc1 lds
    v_mfma_f32_16x16x32_bf16 v[76:79], a[116:119], a[52:55], v[76:79]
    v_cvt_pk_bf16_f32 v30, v60, v61
    v_mfma_f32_16x16x32_bf16 v[64:67], a[120:123], a[56:59], v[64:67]
    ds_read_b128 a[88:91], v14 offset:55296
    v_mfma_f32_16x16x32_bf16 v[72:75], a[120:123], a[60:63], v[72:75]
    s_add_u32 s39, s39, 16384
    v_cvt_pk_bf16_f32 v31, v62, v63
    v_mfma_f32_16x16x32_bf16 v[68:71], a[124:127], a[56:59], v[68:71]
    ds_read_b128 a[92:95], v14 offset:56320
    v_mfma_f32_16x16x32_bf16 v[76:79], a[124:127], a[60:63], v[76:79]
    s_waitcnt lgkmcnt(4)
    v_mfma_f32_16x16x32_bf16 v[32:35], a[64:67], v[24:27], v[32:35]
    ds_read_b128 a[96:99], v14 offset:57344
    v_mfma_f32_16x16x32_bf16 v[40:43], a[64:67], v[28:31], v[40:43]
    v_exp_f32 v48, v64
    v_mfma_f32_16x16x32_bf16 v[36:39], a[68:71], v[24:27], v[36:39]
    s_add_u32 s31, s33, 0
    s_add_u32 m0, s76, 131072
    ds_read_b128 a[100:103], v14 offset:58368
    v_mfma_f32_16x16x32_bf16 v[44:47], a[68:71], v[28:31], v[44:47]
    v_exp_f32 v49, v65
    v_mfma_f32_16x16x32_bf16 v[96:99], a[72:75], v[24:27], v[96:99]
    ds_read_b128 a[104:107], v14 offset:59392
    buffer_load_dwordx4 v10, s[8:11], s31 offen offset:0 lds
    buffer_load_dwordx4 v11, s[8:11], s31 offen offset:1024 lds
    v_mfma_f32_16x16x32_bf16 v[104:107], a[72:75], v[28:31], v[104:107]
    buffer_load_dwordx4 v12, s[8:11], s31 offen offset:2048 lds
    v_exp_f32 v50, v66
    v_mfma_f32_16x16x32_bf16 v[100:103], a[76:79], v[24:27], v[100:103]
    ds_read_b128 a[108:111], v14 offset:60416
    buffer_load_dwordx4 v13, s[8:11], s31 offen offset:3072 lds
    v_add_f32 v8, v48, v49
    v_mfma_f32_16x16x32_bf16 v[108:111], a[76:79], v[28:31], v[108:111]
    s_waitcnt lgkmcnt(4)
    v_exp_f32 v51, v67
    v_mfma_f32_16x16x32_bf16 v[160:163], a[80:83], v[24:27], v[160:163]
    s_add_u32 s31, s33, 114688
    ds_read_b128 a[112:115], v14 offset:61440
    v_add_f32 v8, v8, v50
    v_mfma_f32_16x16x32_bf16 v[168:171], a[80:83], v[28:31], v[168:171]
    s_add_u32 m0, s76, 147456
    v_exp_f32 v56, v72
    v_mfma_f32_16x16x32_bf16 v[164:167], a[84:87], v[24:27], v[164:167]
    ds_read_b128 a[116:119], v14 offset:62464
    v_add_f32 v8, v8, v51
    v_mfma_f32_16x16x32_bf16 v[172:175], a[84:87], v[28:31], v[172:175]
    v_exp_f32 v57, v73
    v_mfma_f32_16x16x32_bf16 v[176:179], a[88:91], v[24:27], v[176:179]
    ds_read_b128 a[120:123], v14 offset:63488
    buffer_load_dwordx4 v10, s[8:11], s31 offen offset:0 lds
    v_mfma_f32_16x16x32_bf16 v[184:187], a[88:91], v[28:31], v[184:187]
    v_exp_f32 v58, v74
    v_mfma_f32_16x16x32_bf16 v[180:183], a[92:95], v[24:27], v[180:183]
    ds_read_b128 a[124:127], v14 offset:64512
    buffer_load_dwordx4 v11, s[8:11], s31 offen offset:1024 lds
    v_mfma_f32_16x16x32_bf16 v[188:191], a[92:95], v[28:31], v[188:191]
    s_waitcnt lgkmcnt(4)
    buffer_load_dwordx4 v12, s[8:11], s31 offen offset:2048 lds
    v_add_f32 v9, v56, v57
    v_mfma_f32_16x16x32_bf16 v[192:195], a[96:99], v[24:27], v[192:195]
    ds_read_b128 a[64:67], v16 offset:49152
    buffer_load_dwordx4 v13, s[8:11], s31 offen offset:3072 lds
    v_mfma_f32_16x16x32_bf16 v[200:203], a[96:99], v[28:31], v[200:203]
    s_add_u32 m0, s76, 32768
    v_exp_f32 v59, v75
    v_mfma_f32_16x16x32_bf16 v[196:199], a[100:103], v[24:27], v[196:199]
    ds_read_b128 a[68:71], v16 offset:50176
    v_add_f32 v9, v9, v58
    v_mfma_f32_16x16x32_bf16 v[204:207], a[100:103], v[28:31], v[204:207]
    v_exp_f32 v52, v68
    v_mfma_f32_16x16x32_bf16 v[208:211], a[104:107], v[24:27], v[208:211]
    ds_read_b128 a[72:75], v16 offset:51200
    v_add_f32 v9, v9, v59
    v_mfma_f32_16x16x32_bf16 v[216:219], a[104:107], v[28:31], v[216:219]
    v_exp_f32 v53, v69
    v_mfma_f32_16x16x32_bf16 v[212:215], a[108:111], v[24:27], v[212:215]
    ds_read_b128 a[76:79], v16 offset:52224
    v_add_f32 v8, v8, v52
    v_mfma_f32_16x16x32_bf16 v[220:223], a[108:111], v[28:31], v[220:223]
    s_waitcnt lgkmcnt(4)
    v_exp_f32 v54, v70
    v_mfma_f32_16x16x32_bf16 v[224:227], a[112:115], v[24:27], v[224:227]
    ds_read_b128 a[80:83], v16 offset:53248
    buffer_load_dwordx4 v0, s[64:67], s60 offen offset:0 sc1 lds
    v_mfma_f32_16x16x32_bf16 v[232:235], a[112:115], v[28:31], v[232:235]
    buffer_load_dwordx4 v0, s[64:67], s60 offen offset:1024 sc1 lds
    v_add_f32 v8, v8, v53
    v_mfma_f32_16x16x32_bf16 v[228:231], a[116:119], v[24:27], v[228:231]
    s_cmp_eq_u32 s37, s38
    ds_read_b128 a[84:87], v16 offset:54272
    buffer_load_dwordx4 v0, s[64:67], s60 offen offset:2048 sc1 lds
    v_mfma_f32_16x16x32_bf16 v[236:239], a[116:119], v[28:31], v[236:239]
    s_cbranch_scc1 .Lmain_kernel_mask_38
.Lmain_kernel_maskr_39:
    v_mfma_f32_16x16x32_bf16 v[240:243], a[120:123], v[24:27], v[240:243]
    ds_read_b128 a[88:91], v16 offset:55296
    buffer_load_dwordx4 v0, s[64:67], s60 offen offset:3072 sc1 lds
    v_mfma_f32_16x16x32_bf16 v[248:251], a[120:123], v[28:31], v[248:251]
    s_add_u32 s60, s60, 16384
    v_exp_f32 v55, v71
    v_mfma_f32_16x16x32_bf16 v[244:247], a[124:127], v[24:27], v[244:247]
    ds_read_b128 a[92:95], v16 offset:56320
    v_add_f32 v8, v8, v54
    v_mfma_f32_16x16x32_bf16 v[252:255], a[124:127], v[28:31], v[252:255]
    s_waitcnt lgkmcnt(4)
    v_exp_f32 v60, v76
    v_mfma_f32_16x16x32_bf16 v[80:83], a[64:67], a[0:3], v[112:115]
    ds_read_b128 a[96:99], v16 offset:57344
    v_add_f32 v8, v8, v55
    v_mfma_f32_16x16x32_bf16 v[88:91], a[64:67], a[4:7], v[120:123]
    v_exp_f32 v61, v77
    v_mfma_f32_16x16x32_bf16 v[84:87], a[68:71], a[0:3], v[116:119]
    ds_read_b128 a[100:103], v16 offset:58368
    v_add_f32 v9, v9, v60
    v_mfma_f32_16x16x32_bf16 v[92:95], a[68:71], a[4:7], v[124:127]
    v_exp_f32 v62, v78
    v_mfma_f32_16x16x32_bf16 v[80:83], a[72:75], a[8:11], v[80:83]
    ds_read_b128 a[104:107], v16 offset:59392
    v_add_f32 v9, v9, v61
    v_mfma_f32_16x16x32_bf16 v[88:91], a[72:75], a[12:15], v[88:91]
    v_exp_f32 v63, v79
    v_mfma_f32_16x16x32_bf16 v[84:87], a[76:79], a[8:11], v[84:87]
    ds_read_b128 a[108:111], v16 offset:60416
    v_add_f32 v9, v9, v62
    v_mfma_f32_16x16x32_bf16 v[92:95], a[76:79], a[12:15], v[92:95]
    s_waitcnt lgkmcnt(4)
    v_add_f32 v9, v9, v63
    v_add_f32 v2, v8, v9
    v_mfma_f32_16x16x32_bf16 v[80:83], a[80:83], a[16:19], v[80:83]
    ds_read_b128 a[112:115], v16 offset:61440
    v_cmp_nge_f32 vcc, 1266679808, v2
    v_mfma_f32_16x16x32_bf16 v[88:91], a[80:83], a[20:23], v[88:91]
    buffer_store_dwordx4 v[148:151], v15, s[16:19], s34 offen sc1
    v_mfma_f32_16x16x32_bf16 v[84:87], a[84:87], a[16:19], v[84:87]
    s_add_u32 s34, s34, 16384
    ds_read_b128 a[116:119], v16 offset:62464
    s_cbranch_vccnz .Lmain_kernel_rare_40
.Lmain_kernel_rarer_41:
    v_mfma_f32_16x16x32_bf16 v[92:95], a[84:87], a[20:23], v[92:95]
    buffer_store_dwordx4 v[152:155], v15, s[16:19], s34 offen sc1
    v_mfma_f32_16x16x32_bf16 v[80:83], a[88:91], a[24:27], v[80:83]
    s_add_u32 s34, s34, 16384
    ds_read_b128 a[120:123], v16 offset:63488
    v_add_f32 v22, v22, v8
    v_mfma_f32_16x16x32_bf16 v[88:91], a[88:91], a[28:31], v[88:91]
    v_add_f32 v23, v23, v9
    v_mfma_f32_16x16x32_bf16 v[84:87], a[92:95], a[24:27], v[84:87]
    s_waitcnt vmcnt(23)
    s_waitcnt lgkmcnt(3)
    ds_read_b128 a[124:127], v16 offset:64512
    v_mfma_f32_16x16x32_bf16 v[92:95], a[92:95], a[28:31], v[92:95]
    s_barrier
    v_mfma_f32_16x16x32_bf16 v[80:83], a[96:99], a[32:35], v[80:83]
    s_add_u32 m0, s76, 98304
    s_cmp_eq_u32 s20, 0
    ds_read_b128 a[64:67], v14 offset:0
    v_mfma_f32_16x16x32_bf16 v[88:91], a[96:99], a[36:39], v[88:91]
    s_cbranch_scc1 .Lmain_kernel_sd_36
.Lmain_kernel_sdr_37:
    v_mfma_f32_16x16x32_bf16 v[84:87], a[100:103], a[32:35], v[84:87]
    ds_read_b128 a[68:71], v14 offset:1024
    buffer_load_dwordx4 v0, s[16:19], s39 offen offset:0 sc1 lds
    v_mfma_f32_16x16x32_bf16 v[92:95], a[100:103], a[36:39], v[92:95]
    buffer_store_dwordx4 v[156:159], v15, s[16:19], s34 offen sc1
    v_mfma_f32_16x16x32_bf16 v[80:83], a[104:107], a[40:43], v[80:83]
    ds_read_b128 a[72:75], v14 offset:2048
    v_cvt_pk_bf16_f32 v24, v48, v49
    v_mfma_f32_16x16x32_bf16 v[88:91], a[104:107], a[44:47], v[88:91]
    buffer_load_dwordx4 v0, s[16:19], s39 offen offset:1024 sc1 lds
    v_cvt_pk_bf16_f32 v25, v50, v51
    v_mfma_f32_16x16x32_bf16 v[84:87], a[108:111], a[40:43], v[84:87]
    ds_read_b128 a[76:79], v14 offset:3072
    v_cvt_pk_bf16_f32 v26, v52, v53
    v_mfma_f32_16x16x32_bf16 v[92:95], a[108:111], a[44:47], v[92:95]
    s_waitcnt lgkmcnt(4)
    v_cvt_pk_bf16_f32 v27, v54, v55
    v_cvt_pk_bf16_f32 v28, v56, v57
    v_mfma_f32_16x16x32_bf16 v[80:83], a[112:115], a[48:51], v[80:83]
    ds_read_b128 a[80:83], v14 offset:4096
    buffer_load_dwordx4 v0, s[16:19], s39 offen offset:2048 sc1 lds
    v_mfma_f32_16x16x32_bf16 v[88:91], a[112:115], a[52:55], v[88:91]
    v_cvt_pk_bf16_f32 v29, v58, v59
    v_mfma_f32_16x16x32_bf16 v[84:87], a[116:119], a[48:51], v[84:87]
    ds_read_b128 a[84:87], v14 offset:5120
    buffer_load_dwordx4 v0, s[16:19], s39 offen offset:3072 sc1 lds
    v_mfma_f32_16x16x32_bf16 v[92:95], a[116:119], a[52:55], v[92:95]
    s_mov_b32 s34, 1073741824
    v_cvt_pk_bf16_f32 v30, v60, v61
    v_mfma_f32_16x16x32_bf16 v[80:83], a[120:123], a[56:59], v[80:83]
    ds_read_b128 a[88:91], v14 offset:6144
    v_mfma_f32_16x16x32_bf16 v[88:91], a[120:123], a[60:63], v[88:91]
    s_add_u32 s39, s39, 16384
    v_cvt_pk_bf16_f32 v31, v62, v63
    v_mfma_f32_16x16x32_bf16 v[84:87], a[124:127], a[56:59], v[84:87]
    ds_read_b128 a[92:95], v14 offset:7168
    v_mfma_f32_16x16x32_bf16 v[92:95], a[124:127], a[60:63], v[92:95]
    s_waitcnt lgkmcnt(4)
    s_cmp_eq_u32 s37, 0
    s_cbranch_scc1 .Lmain_kernel_tail_42
    s_cmp_lg_u32 s26, 0
    s_cbranch_scc1 .Lmain_kernel_disp_50
.Lmain_kernel_it_44:
    v_mfma_f32_16x16x32_bf16 v[32:35], a[64:67], v[24:27], v[32:35]
    s_sub_u32 s37, s37, 1
    ds_read_b128 a[96:99], v14 offset:8192
    v_mfma_f32_16x16x32_bf16 v[40:43], a[64:67], v[28:31], v[40:43]
    v_exp_f32 v48, v80
    v_mfma_f32_16x16x32_bf16 v[36:39], a[68:71], v[24:27], v[36:39]
    s_add_u32 m0, s76, 49152
    ds_read_b128 a[100:103], v14 offset:9216
    buffer_store_dwordx4 a[192:195], v15, s[16:19], s23 offen sc1
    v_mfma_f32_16x16x32_bf16 v[44:47], a[68:71], v[28:31], v[44:47]
    s_add_u32 s23, s23, 16384
    v_exp_f32 v49, v81
    v_mfma_f32_16x16x32_bf16 v[96:99], a[72:75], v[24:27], v[96:99]
    ds_read_b128 a[104:107], v14 offset:10240
    buffer_store_dwordx4 a[196:199], v15, s[16:19], s23 offen sc1
    v_mfma_f32_16x16x32_bf16 v[104:107], a[72:75], v[28:31], v[104:107]
    s_add_u32 s23, s23, 16384
    v_exp_f32 v50, v82
    v_mfma_f32_16x16x32_bf16 v[100:103], a[76:79], v[24:27], v[100:103]
    ds_read_b128 a[108:111], v14 offset:11264
    v_add_f32 v8, v48, v49
    v_mfma_f32_16x16x32_bf16 v[108:111], a[76:79], v[28:31], v[108:111]
    s_waitcnt lgkmcnt(4)
    v_exp_f32 v51, v83
    v_mfma_f32_16x16x32_bf16 v[160:163], a[80:83], v[24:27], v[160:163]
    ds_read_b128 a[112:115], v14 offset:12288
    v_add_f32 v8, v8, v50
    v_mfma_f32_16x16x32_bf16 v[168:171], a[80:83], v[28:31], v[168:171]
    v_exp_f32 v56, v88
    v_mfma_f32_16x16x32_bf16 v[164:167], a[84:87], v[24:27], v[164:167]
    s_add_u32 s26, s26, 1
    ds_read_b128 a[116:119], v14 offset:13312
    v_add_f32 v8, v8, v51
    v_mfma_f32_16x16x32_bf16 v[172:175], a[84:87], v[28:31], v[172:175]
    v_exp_f32 v57, v89
    v_mfma_f32_16x16x32_bf16 v[176:179], a[88:91], v[24:27], v[176:179]
    ds_read_b128 a[120:123], v14 offset:14336
    buffer_load_dwordx4 v0, s[64:67], s60 offen offset:0 sc1 lds
    v_mfma_f32_16x16x32_bf16 v[184:187], a[88:91], v[28:31], v[184:187]
    v_exp_f32 v58, v90
    v_mfma_f32_16x16x32_bf16 v[180:183], a[92:95], v[24:27], v[180:183]
    ds_read_b128 a[124:127], v14 offset:15360
    buffer_load_dwordx4 v0, s[64:67], s60 offen offset:1024 sc1 lds
    v_mfma_f32_16x16x32_bf16 v[188:191], a[92:95], v[28:31], v[188:191]
    s_waitcnt lgkmcnt(4)
    buffer_store_dwordx4 a[200:203], v15, s[16:19], s23 offen sc1
    v_add_f32 v9, v56, v57
    v_mfma_f32_16x16x32_bf16 v[192:195], a[96:99], v[24:27], v[192:195]
    s_add_u32 s23, s23, 16384
    ds_read_b128 a[64:67], v16 offset:0
    buffer_load_dwordx4 v0, s[64:67], s60 offen offset:2048 sc1 lds
    v_mfma_f32_16x16x32_bf16 v[200:203], a[96:99], v[28:31], v[200:203]
    v_exp_f32 v59, v91
    v_mfma_f32_16x16x32_bf16 v[196:199], a[100:103], v[24:27], v[196:199]
    ds_read_b128 a[68:71], v16 offset:1024
    v_add_f32 v9, v9, v58
    v_mfma_f32_16x16x32_bf16 v[204:207], a[100:103], v[28:31], v[204:207]
    v_exp_f32 v52, v84
    v_mfma_f32_16x16x32_bf16 v[208:211], a[104:107], v[24:27], v[208:211]
    ds_read_b128 a[72:75], v16 offset:2048
    v_add_f32 v9, v9, v59
    v_mfma_f32_16x16x32_bf16 v[216:219], a[104:107], v[28:31], v[216:219]
    v_exp_f32 v53, v85
    v_mfma_f32_16x16x32_bf16 v[212:215], a[108:111], v[24:27], v[212:215]
    ds_read_b128 a[76:79], v16 offset:3072
    v_add_f32 v8, v8, v52
    v_mfma_f32_16x16x32_bf16 v[220:223], a[108:111], v[28:31], v[220:223]
    s_waitcnt lgkmcnt(4)
    v_exp_f32 v54, v86
    v_mfma_f32_16x16x32_bf16 v[224:227], a[112:115], v[24:27], v[224:227]
    ds_read_b128 a[80:83], v16 offset:4096
    buffer_load_dwordx4 v0, s[64:67], s60 offen offset:3072 sc1 lds
    v_mfma_f32_16x16x32_bf16 v[232:235], a[112:115], v[28:31], v[232:235]
    v_add_f32 v8, v8, v53
    v_mfma_f32_16x16x32_bf16 v[228:231], a[116:119], v[24:27], v[228:231]
    s_cmp_eq_u32 s37, s38
    ds_read_b128 a[84:87], v16 offset:5120
    v_mfma_f32_16x16x32_bf16 v[236:239], a[116:119], v[28:31], v[236:239]
    s_cbranch_scc1 .Lmain_kernel_mask_52
.Lmain_kernel_maskr_53:
    v_mfma_f32_16x16x32_bf16 v[240:243], a[120:123], v[24:27], v[240:243]
    s_add_u32 s60, s60, 16384
    ds_read_b128 a[88:91], v16 offset:6144
    v_mfma_f32_16x16x32_bf16 v[248:251], a[120:123], v[28:31], v[248:251]
    v_exp_f32 v55, v87
    v_mfma_f32_16x16x32_bf16 v[244:247], a[124:127], v[24:27], v[244:247]
    ds_read_b128 a[92:95], v16 offset:7168
    v_add_f32 v8, v8, v54
    v_mfma_f32_16x16x32_bf16 v[252:255], a[124:127], v[28:31], v[252:255]
    s_waitcnt lgkmcnt(4)
    v_exp_f32 v60, v92
    v_mfma_f32_16x16x32_bf16 v[64:67], a[64:67], a[0:3], v[112:115]
    ds_read_b128 a[96:99], v16 offset:8192
    v_add_f32 v8, v8, v55
    v_mfma_f32_16x16x32_bf16 v[72:75], a[64:67], a[4:7], v[120:123]
    v_exp_f32 v61, v93
    v_mfma_f32_16x16x32_bf16 v[68:71], a[68:71], a[0:3], v[116:119]
    ds_read_b128 a[100:103], v16 offset:9216
    v_add_f32 v9, v9, v60
    v_mfma_f32_16x16x32_bf16 v[76:79], a[68:71], a[4:7], v[124:127]
    v_exp_f32 v62, v94
    v_mfma_f32_16x16x32_bf16 v[64:67], a[72:75], a[8:11], v[64:67]
    ds_read_b128 a[104:107], v16 offset:10240
    v_add_f32 v9, v9, v61
    v_mfma_f32_16x16x32_bf16 v[72:75], a[72:75], a[12:15], v[72:75]
    v_exp_f32 v63, v95
    v_mfma_f32_16x16x32_bf16 v[68:71], a[76:79], a[8:11], v[68:71]
    ds_read_b128 a[108:111], v16 offset:11264
    v_add_f32 v9, v9, v62
    v_mfma_f32_16x16x32_bf16 v[76:79], a[76:79], a[12:15], v[76:79]
    s_waitcnt lgkmcnt(4)
    v_add_f32 v9, v9, v63
    v_add_f32 v2, v8, v9
    v_mfma_f32_16x16x32_bf16 v[64:67], a[80:83], a[16:19], v[64:67]
    ds_read_b128 a[112:115], v16 offset:12288
    v_cmp_nge_f32 vcc, 1266679808, v2
    v_mfma_f32_16x16x32_bf16 v[72:75], a[80:83], a[20:23], v[72:75]
    s_getpc_b64 s[12:13]
.Lmain_kernel_pc_56:
    s_sub_u32 s12, s12, .Lmain_kernel_pc_56-main_kernel
    s_subb_u32 s13, s13, 0
    v_mfma_f32_16x16x32_bf16 v[68:71], a[84:87], a[16:19], v[68:71]
    s_and_b32 s13, s13, 0xffff
    ds_read_b128 a[116:119], v16 offset:13312
    v_mfma_f32_16x16x32_bf16 v[76:79], a[84:87], a[20:23], v[76:79]
    s_cbranch_vccnz .Lmain_kernel_rare_54
.Lmain_kernel_rarer_55:
    v_mfma_f32_16x16x32_bf16 v[64:67], a[88:91], a[24:27], v[64:67]
    s_mov_b32 s14, .Ltext_end-main_kernel
    ds_read_b128 a[120:123], v16 offset:14336
    v_add_f32 v22, v22, v8
    v_mfma_f32_16x16x32_bf16 v[72:75], a[88:91], a[28:31], v[72:75]
    v_add_f32 v23, v23, v9
    v_mfma_f32_16x16x32_bf16 v[68:71], a[92:95], a[24:27], v[68:71]
    s_waitcnt vmcnt(26)
    s_waitcnt lgkmcnt(3)
    ds_read_b128 a[124:127], v16 offset:15360
    v_mfma_f32_16x16x32_bf16 v[76:79], a[92:95], a[28:31], v[76:79]
    s_barrier
    v_mfma_f32_16x16x32_bf16 v[64:67], a[96:99], a[32:35], v[64:67]
    s_add_u32 m0, s76, 114688
    ds_read_b128 a[64:67], v14 offset:16384
    v_cvt_pk_bf16_f32 v24, v48, v49
    v_mfma_f32_16x16x32_bf16 v[72:75], a[96:99], a[36:39], v[72:75]
    s_mov_b32 s15, 0x00020000
    buffer_load_dwordx4 v0, s[16:19], s39 offen offset:0 sc1 lds
    v_cvt_pk_bf16_f32 v25, v50, v51
    v_mfma_f32_16x16x32_bf16 v[68:71], a[100:103], a[32:35], v[68:71]
    s_and_b32 s30, s2, 56
    ds_read_b128 a[68:71], v14 offset:17408
    v_mfma_f32_16x16x32_bf16 v[76:79], a[100:103], a[36:39], v[76:79]
    buffer_load_dwordx4 v0, s[16:19], s39 offen offset:1024 sc1 lds
    v_cvt_pk_bf16_f32 v26, v52, v53
    v_mfma_f32_16x16x32_bf16 v[64:67], a[104:107], a[40:43], v[64:67]
    s_lshl_b32 s30, s30, 12
    ds_read_b128 a[72:75], v14 offset:18432
    buffer_load_dwordx4 v0, s[16:19], s39 offen offset:2048 sc1 lds
    v_mfma_f32_16x16x32_bf16 v[72:75], a[104:107], a[44:47], v[72:75]
    v_cvt_pk_bf16_f32 v27, v54, v55
    v_mfma_f32_16x16x32_bf16 v[68:71], a[108:111], a[40:43], v[68:71]
    ds_read_b128 a[76:79], v14 offset:19456
    buffer_load_dwordx4 v0, s[16:19], s39 offen offset:3072 sc1 lds
    v_mfma_f32_16x16x32_bf16 v[76:79], a[108:111], a[44:47], v[76:79]
    s_waitcnt lgkmcnt(4)
    v_cvt_pk_bf16_f32 v28, v56, v57
    v_lshlrev_b32 v128, 3, v14
    v_mfma_f32_16x16x32_bf16 v[64:67], a[112:115], a[48:51], v[64:67]
    s_add_u32 s39, s39, 16384
    s_lshl_b32 s31, s20, 13
    ds_read_b128 a[80:83], v14 offset:20480
    v_mfma_f32_16x16x32_bf16 v[72:75], a[112:115], a[52:55], v[72:75]
    s_cmp_eq_u32 s39, s61
    s_cselect_b32 s39, s62, s39
    s_cselect_b32 s61, s5, s61
    v_mfma_f32_16x16x32_bf16 v[68:71], a[116:119], a[48:51], v[68:71]
    s_cselect_b32 s62, 1073741824, s62
    ds_read_b128 a[84:87], v14 offset:21504
    v_cvt_pk_bf16_f32 v29, v58, v59
    v_mfma_f32_16x16x32_bf16 v[76:79], a[116:119], a[52:55], v[76:79]
    v_cvt_pk_bf16_f32 v30, v60, v61
    v_add_u32 v128, s31, v128
    v_mfma_f32_16x16x32_bf16 v[64:67], a[120:123], a[56:59], v[64:67]
    ds_read_b128 a[88:91], v14 offset:22528
    v_mfma_f32_16x16x32_bf16 v[72:75], a[120:123], a[60:63], v[72:75]
    buffer_load_dword v128, v128, s[12:15], s30 offen
    v_cvt_pk_bf16_f32 v31, v62, v63
    v_mfma_f32_16x16x32_bf16 v[68:71], a[124:127], a[56:59], v[68:71]
    ds_read_b128 a[92:95], v14 offset:23552
    v_mfma_f32_16x16x32_bf16 v[76:79], a[124:127], a[60:63], v[76:79]
    s_waitcnt lgkmcnt(4)
    v_mfma_f32_16x16x32_bf16 v[32:35], a[64:67], v[24:27], v[32:35]
    ds_read_b128 a[96:99], v14 offset:24576
    v_mfma_f32_16x16x32_bf16 v[40:43], a[64:67], v[28:31], v[40:43]
    v_exp_f32 v48, v64
    v_mfma_f32_16x16x32_bf16 v[36:39], a[68:71], v[24:27], v[36:39]
    s_add_u32 m0, s76, 0
    ds_read_b128 a[100:103], v14 offset:25600
    buffer_store_dwordx4 a[204:207], v15, s[16:19], s23 offen sc1
    v_mfma_f32_16x16x32_bf16 v[44:47], a[68:71], v[28:31], v[44:47]
    s_add_u32 s23, s23, 212992
    v_exp_f32 v49, v65
    v_mfma_f32_16x16x32_bf16 v[96:99], a[72:75], v[24:27], v[96:99]
    ds_read_b128 a[104:107], v14 offset:26624
    buffer_store_dwordx4 a[208:211], v15, s[16:19], s23 offen sc1
    v_mfma_f32_16x16x32_bf16 v[104:107], a[72:75], v[28:31], v[104:107]
    s_add_u32 s23, s23, 16384
    v_exp_f32 v50, v66
    v_mfma_f32_16x16x32_bf16 v[100:103], a[76:79], v[24:27], v[100:103]
    ds_read_b128 a[108:111], v14 offset:27648
    v_add_f32 v8, v48, v49
    v_mfma_f32_16x16x32_bf16 v[108:111], a[76:79], v[28:31], v[108:111]
    s_waitcnt lgkmcnt(4)
    v_exp_f32 v51, v67
    v_mfma_f32_16x16x32_bf16 v[160:163], a[80:83], v[24:27], v[160:163]
    ds_read_b128 a[112:115], v14 offset:28672
    v_add_f32 v8, v8, v50
    v_mfma_f32_16x16x32_bf16 v[168:171], a[80:83], v[28:31], v[168:171]
    v_exp_f32 v56, v72
    v_mfma_f32_16x16x32_bf16 v[164:167], a[84:87], v[24:27], v[164:167]
    ds_read_b128 a[116:119], v14 offset:29696
    v_add_f32 v8, v8, v51
    v_mfma_f32_16x16x32_bf16 v[172:175], a[84:87], v[28:31], v[172:175]
    v_exp_f32 v57, v73
    v_mfma_f32_16x16x32_bf16 v[176:179], a[88:91], v[24:27], v[176:179]
    ds_read_b128 a[120:123], v14 offset:30720
    buffer_load_dwordx4 v0, s[64:67], s60 offen offset:0 sc1 lds
    v_mfma_f32_16x16x32_bf16 v[184:187], a[88:91], v[28:31], v[184:187]
    v_exp_f32 v58, v74
    v_mfma_f32_16x16x32_bf16 v[180:183], a[92:95], v[24:27], v[180:183]
    ds_read_b128 a[124:127], v14 offset:31744
    buffer_load_dwordx4 v0, s[64:67], s60 offen offset:1024 sc1 lds
    v_mfma_f32_16x16x32_bf16 v[188:191], a[92:95], v[28:31], v[188:191]
    s_waitcnt lgkmcnt(4)
    v_add_f32 v9, v56, v57
    v_mfma_f32_16x16x32_bf16 v[192:195], a[96:99], v[24:27], v[192:195]
    ds_read_b128 a[64:67], v16 offset:16384
    buffer_load_dwordx4 v0, s[64:67], s60 offen offset:2048 sc1 lds
    v_mfma_f32_16x16x32_bf16 v[200:203], a[96:99], v[28:31], v[200:203]
    v_exp_f32 v59, v75
    v_mfma_f32_16x16x32_bf16 v[196:199], a[100:103], v[24:27], v[196:199]
    ds_read_b128 a[68:71], v16 offset:17408
    v_add_f32 v9, v9, v58
    v_mfma_f32_16x16x32_bf16 v[204:207], a[100:103], v[28:31], v[204:207]
    v_exp_f32 v52, v68
    v_mfma_f32_16x16x32_bf16 v[208:211], a[104:107], v[24:27], v[208:211]
    ds_read_b128 a[72:75], v16 offset:18432
    v_add_f32 v9, v9, v59
    v_mfma_f32_16x16x32_bf16 v[216:219], a[104:107], v[28:31], v[216:219]
    v_exp_f32 v53, v69
    v_mfma_f32_16x16x32_bf16 v[212:215], a[108:111], v[24:27], v[212:215]
    ds_read_b128 a[76:79], v16 offset:19456
    v_add_f32 v8, v8, v52
    v_mfma_f32_16x16x32_bf16 v[220:223], a[108:111], v[28:31], v[220:223]
    s_waitcnt lgkmcnt(4)
    v_exp_f32 v54, v70
    v_mfma_f32_16x16x32_bf16 v[224:227], a[112:115], v[24:27], v[224:227]
    ds_read_b128 a[80:83], v16 offset:20480
    buffer_load_dwordx4 v0, s[64:67], s60 offen offset:3072 sc1 lds
    v_mfma_f32_16x16x32_bf16 v[232:235], a[112:115], v[28:31], v[232:235]
    v_add_f32 v8, v8, v53
    v_mfma_f32_16x16x32_bf16 v[228:231], a[116:119], v[24:27], v[228:231]
    s_cmp_eq_u32 s37, s38
    ds_read_b128 a[84:87], v16 offset:21504
    v_mfma_f32_16x16x32_bf16 v[236:239], a[116:119], v[28:31], v[236:239]
    s_cbranch_scc1 .Lmain_kernel_mask_57
.Lmain_kernel_maskr_58:
    v_mfma_f32_16x16x32_bf16 v[240:243], a[120:123], v[24:27], v[240:243]
    s_add_u32 s60, s60, 16384
    ds_read_b128 a[88:91], v16 offset:22528
    v_mfma_f32_16x16x32_bf16 v[248:251], a[120:123], v[28:31], v[248:251]
    v_exp_f32 v55, v71
    v_mfma_f32_16x16x32_bf16 v[244:247], a[124:127], v[24:27], v[244:247]
    ds_read_b128 a[92:95], v16 offset:23552
    v_add_f32 v8, v8, v54
    v_mfma_f32_16x16x32_bf16 v[252:255], a[124:127], v[28:31], v[252:255]
    s_waitcnt lgkmcnt(4)
    v_exp_f32 v60, v76
    v_mfma_f32_16x16x32_bf16 v[80:83], a[64:67], a[0:3], v[112:115]
    ds_read_b128 a[96:99], v16 offset:24576
    v_add_f32 v8, v8, v55
    v_mfma_f32_16x16x32_bf16 v[88:91], a[64:67], a[4:7], v[120:123]
    v_exp_f32 v61, v77
    v_mfma_f32_16x16x32_bf16 v[84:87], a[68:71], a[0:3], v[116:119]
    ds_read_b128 a[100:103], v16 offset:25600
    v_add_f32 v9, v9, v60
    v_mfma_f32_16x16x32_bf16 v[92:95], a[68:71], a[4:7], v[124:127]
    v_exp_f32 v62, v78
    v_mfma_f32_16x16x32_bf16 v[80:83], a[72:75], a[8:11], v[80:83]
    ds_read_b128 a[104:107], v16 offset:26624
    v_add_f32 v9, v9, v61
    v_mfma_f32_16x16x32_bf16 v[88:91], a[72:75], a[12:15], v[88:91]
    v_exp_f32 v63, v79
    v_mfma_f32_16x16x32_bf16 v[84:87], a[76:79], a[8:11], v[84:87]
    ds_read_b128 a[108:111], v16 offset:27648
    v_add_f32 v9, v9, v62
    v_mfma_f32_16x16x32_bf16 v[92:95], a[76:79], a[12:15], v[92:95]
    s_waitcnt lgkmcnt(4)
    v_add_f32 v9, v9, v63
    v_add_f32 v2, v8, v9
    v_mfma_f32_16x16x32_bf16 v[80:83], a[80:83], a[16:19], v[80:83]
    ds_read_b128 a[112:115], v16 offset:28672
    v_cmp_nge_f32 vcc, 1266679808, v2
    v_mfma_f32_16x16x32_bf16 v[88:91], a[80:83], a[20:23], v[88:91]
    buffer_store_dwordx4 a[212:215], v15, s[16:19], s23 offen sc1
    v_mfma_f32_16x16x32_bf16 v[84:87], a[84:87], a[16:19], v[84:87]
    s_add_u32 s23, s23, 16384
    ds_read_b128 a[116:119], v16 offset:29696
    v_mfma_f32_16x16x32_bf16 v[92:95], a[84:87], a[20:23], v[92:95]
    s_cbranch_vccnz .Lmain_kernel_rare_59
.Lmain_kernel_rarer_60:
    v_mfma_f32_16x16x32_bf16 v[80:83], a[88:91], a[24:27], v[80:83]
    ds_read_b128 a[120:123], v16 offset:30720
    v_add_f32 v22, v22, v8
    v_mfma_f32_16x16x32_bf16 v[88:91], a[88:91], a[28:31], v[88:91]
    v_add_f32 v23, v23, v9
    v_mfma_f32_16x16x32_bf16 v[84:87], a[92:95], a[24:27], v[84:87]
    s_waitcnt vmcnt(19)
    s_waitcnt lgkmcnt(3)
    ds_read_b128 a[124:127], v16 offset:31744
    v_mfma_f32_16x16x32_bf16 v[92:95], a[92:95], a[28:31], v[92:95]
    s_barrier
    v_mfma_f32_16x16x32_bf16 v[80:83], a[96:99], a[32:35], v[80:83]
    s_add_u32 m0, s76, 65536
    ds_read_b128 a[64:67], v14 offset:32768
    v_cvt_pk_bf16_f32 v24, v48, v49
    v_mfma_f32_16x16x32_bf16 v[88:91], a[96:99], a[36:39], v[88:91]
    v_cvt_pk_bf16_f32 v25, v50, v51
    v_mfma_f32_16x16x32_bf16 v[84:87], a[100:103], a[32:35], v[84:87]
    ds_read_b128 a[68:71], v14 offset:33792
    buffer_load_dwordx4 v0, s[16:19], s39 offen offset:0 sc1 lds
    v_mfma_f32_16x16x32_bf16 v[92:95], a[100:103], a[36:39], v[92:95]
    v_cvt_pk_bf16_f32 v26, v52, v53
    v_mfma_f32_16x16x32_bf16 v[80:83], a[104:107], a[40:43], v[80:83]
    ds_read_b128 a[72:75], v14 offset:34816
    v_mfma_f32_16x16x32_bf16 v[88:91], a[104:107], a[44:47], v[88:91]
    buffer_load_dwordx4 v0, s[16:19], s39 offen offset:1024 sc1 lds
    v_cvt_pk_bf16_f32 v27, v54, v55
    v_mfma_f32_16x16x32_bf16 v[84:87], a[108:111], a[40:43], v[84:87]
    ds_read_b128 a[76:79], v14 offset:35840
    v_mfma_f32_16x16x32_bf16 v[92:95], a[108:111], a[44:47], v[92:95]
    s_waitcnt lgkmcnt(4)
    v_cvt_pk_bf16_f32 v28, v56, v57
    v_mfma_f32_16x16x32_bf16 v[80:83], a[112:115], a[48:51], v[80:83]
    ds_read_b128 a[80:83], v14 offset:36864
    buffer_load_dwordx4 v0, s[16:19], s39 offen offset:2048 sc1 lds
    v_mfma_f32_16x16x32_bf16 v[88:91], a[112:115], a[52:55], v[88:91]
    v_cvt_pk_bf16_f32 v29, v58, v59
    v_mfma_f32_16x16x32_bf16 v[84:87], a[116:119], a[48:51], v[84:87]
    ds_read_b128 a[84:87], v14 offset:37888
    buffer_load_dwordx4 v0, s[16:19], s39 offen offset:3072 sc1 lds
    v_mfma_f32_16x16x32_bf16 v[92:95], a[116:119], a[52:55], v[92:95]
    v_cvt_pk_bf16_f32 v30, v60, v61
    v_mfma_f32_16x16x32_bf16 v[80:83], a[120:123], a[56:59], v[80:83]
    ds_read_b128 a[88:91], v14 offset:38912
    v_mfma_f32_16x16x32_bf16 v[88:91], a[120:123], a[60:63], v[88:91]
    s_add_u32 s39, s39, 16384
    v_cvt_pk_bf16_f32 v31, v62, v63
    v_mfma_f32_16x16x32_bf16 v[84:87], a[124:127], a[56:59], v[84:87]
    ds_read_b128 a[92:95], v14 offset:39936
    v_mfma_f32_16x16x32_bf16 v[92:95], a[124:127], a[60:63], v[92:95]
    s_waitcnt lgkmcnt(4)
    v_mfma_f32_16x16x32_bf16 v[32:35], a[64:67], v[24:27], v[32:35]
    ds_read_b128 a[96:99], v14 offset:40960
    v_mfma_f32_16x16x32_bf16 v[40:43], a[64:67], v[28:31], v[40:43]
    v_exp_f32 v48, v80
    v_mfma_f32_16x16x32_bf16 v[36:39], a[68:71], v[24:27], v[36:39]
    s_add_u32 m0, s76, 16384
    ds_read_b128 a[100:103], v14 offset:41984
    buffer_store_dwordx4 a[216:219], v15, s[16:19], s23 offen sc1
    v_mfma_f32_16x16x32_bf16 v[44:47], a[68:71], v[28:31], v[44:47]
    s_add_u32 s23, s23, 16384
    v_exp_f32 v49, v81
    v_mfma_f32_16x16x32_bf16 v[96:99], a[72:75], v[24:27], v[96:99]
    ds_read_b128 a[104:107], v14 offset:43008
    buffer_load_dwordx4 v0, s[64:67], s60 offen offset:0 sc1 lds
    v_mfma_f32_16x16x32_bf16 v[104:107], a[72:75], v[28:31], v[104:107]
    v_exp_f32 v50, v82
    v_mfma_f32_16x16x32_bf16 v[100:103], a[76:79], v[24:27], v[100:103]
    ds_read_b128 a[108:111], v14 offset:44032
    v_add_f32 v8, v48, v49
    v_mfma_f32_16x16x32_bf16 v[108:111], a[76:79], v[28:31], v[108:111]
    s_waitcnt lgkmcnt(4)
    v_exp_f32 v51, v83
    v_mfma_f32_16x16x32_bf16 v[160:163], a[80:83], v[24:27], v[160:163]
    ds_read_b128 a[112:115], v14 offset:45056
    v_add_f32 v8, v8, v50
    v_mfma_f32_16x16x32_bf16 v[168:171], a[80:83], v[28:31], v[168:171]
    v_exp_f32 v56, v88
    v_mfma_f32_16x16x32_bf16 v[164:167], a[84:87], v[24:27], v[164:167]
    ds_read_b128 a[116:119], v14 offset:46080
    v_add_f32 v8, v8, v51
    v_mfma_f32_16x16x32_bf16 v[172:175], a[84:87], v[28:31], v[172:175]
    v_exp_f32 v57, v89
    v_mfma_f32_16x16x32_bf16 v[176:179], a[88:91], v[24:27], v[176:179]
    ds_read_b128 a[120:123], v14 offset:47104
    buffer_load_dwordx4 v0, s[64:67], s60 offen offset:1024 sc1 lds
    v_mfma_f32_16x16x32_bf16 v[184:187], a[88:91], v[28:31], v[184:187]
    v_exp_f32 v58, v90
    v_mfma_f32_16x16x32_bf16 v[180:183], a[92:95], v[24:27], v[180:183]
    ds_read_b128 a[124:127], v14 offset:48128
    buffer_load_dwordx4 v0, s[64:67], s60 offen offset:2048 sc1 lds
    v_mfma_f32_16x16x32_bf16 v[188:191], a[92:95], v[28:31], v[188:191]
    s_waitcnt lgkmcnt(4)
    buffer_load_dwordx4 v0, s[64:67], s60 offen offset:3072 sc1 lds
    v_add_f32 v9, v56, v57
    v_mfma_f32_16x16x32_bf16 v[192:195], a[96:99], v[24:27], v[192:195]
    s_add_u32 s60, s60, 16384
    ds_read_b128 a[64:67], v16 offset:32768
    buffer_store_dwordx4 a[220:223], v15, s[16:19], s23 offen sc1
    v_mfma_f32_16x16x32_bf16 v[200:203], a[96:99], v[28:31], v[200:203]
    s_add_u32 s23, s23, 212992
    v_exp_f32 v59, v91
    v_mfma_f32_16x16x32_bf16 v[196:199], a[100:103], v[24:27], v[196:199]
    ds_read_b128 a[68:71], v16 offset:33792
    v_add_f32 v9, v9, v58
    v_mfma_f32_16x16x32_bf16 v[204:207], a[100:103], v[28:31], v[204:207]
    s_cmp_eq_u32 s60, s63
    v_exp_f32 v52, v84
    v_mfma_f32_16x16x32_bf16 v[208:211], a[104:107], v[24:27], v[208:211]
    s_cselect_b32 s60, s4, s60
    ds_read_b128 a[72:75], v16 offset:34816
    v_add_f32 v9, v9, v59
    v_mfma_f32_16x16x32_bf16 v[216:219], a[104:107], v[28:31], v[216:219]
    s_cselect_b32 s63, s5, s63
    v_exp_f32 v53, v85
    v_mfma_f32_16x16x32_bf16 v[212:215], a[108:111], v[24:27], v[212:215]
    s_cselect_b32 s4, 1073741824, s4
    ds_read_b128 a[76:79], v16 offset:35840
    v_add_f32 v8, v8, v52
    v_mfma_f32_16x16x32_bf16 v[220:223], a[108:111], v[28:31], v[220:223]
    s_waitcnt lgkmcnt(4)
    v_exp_f32 v54, v86
    v_mfma_f32_16x16x32_bf16 v[224:227], a[112:115], v[24:27], v[224:227]
    ds_read_b128 a[80:83], v16 offset:36864
    v_mfma_f32_16x16x32_bf16 v[232:235], a[112:115], v[28:31], v[232:235]
    v_add_f32 v8, v8, v53
    v_mfma_f32_16x16x32_bf16 v[228:231], a[116:119], v[24:27], v[228:231]
    s_cmp_eq_u32 s37, s38
    ds_read_b128 a[84:87], v16 offset:37888
    v_mfma_f32_16x16x32_bf16 v[236:239], a[116:119], v[28:31], v[236:239]
    s_cbranch_scc1 .Lmain_kernel_mask_61
.Lmain_kernel_maskr_62:
    v_mfma_f32_16x16x32_bf16 v[240:243], a[120:123], v[24:27], v[240:243]
    ds_read_b128 a[88:91], v16 offset:38912
    v_mfma_f32_16x16x32_bf16 v[248:251], a[120:123], v[28:31], v[248:251]
    v_exp_f32 v55, v87
    v_mfma_f32_16x16x32_bf16 v[244:247], a[124:127], v[24:27], v[244:247]
    ds_read_b128 a[92:95], v16 offset:39936
    v_add_f32 v8, v8, v54
    v_mfma_f32_16x16x32_bf16 v[252:255], a[124:127], v[28:31], v[252:255]
    s_waitcnt lgkmcnt(4)
    v_exp_f32 v60, v92
    v_mfma_f32_16x16x32_bf16 v[64:67], a[64:67], a[0:3], v[112:115]
    ds_read_b128 a[96:99], v16 offset:40960
    v_add_f32 v8, v8, v55
    v_mfma_f32_16x16x32_bf16 v[72:75], a[64:67], a[4:7], v[120:123]
    v_exp_f32 v61, v93
    v_mfma_f32_16x16x32_bf16 v[68:71], a[68:71], a[0:3], v[116:119]
    ds_read_b128 a[100:103], v16 offset:41984
    v_add_f32 v9, v9, v60
    v_mfma_f32_16x16x32_bf16 v[76:79], a[68:71], a[4:7], v[124:127]
    v_exp_f32 v62, v94
    v_mfma_f32_16x16x32_bf16 v[64:67], a[72:75], a[8:11], v[64:67]
    ds_read_b128 a[104:107], v16 offset:43008
    v_add_f32 v9, v9, v61
    v_mfma_f32_16x16x32_bf16 v[72:75], a[72:75], a[12:15], v[72:75]
    v_exp_f32 v63, v95
    v_mfma_f32_16x16x32_bf16 v[68:71], a[76:79], a[8:11], v[68:71]
    ds_read_b128 a[108:111], v16 offset:44032
    v_add_f32 v9, v9, v62
    v_mfma_f32_16x16x32_bf16 v[76:79], a[76:79], a[12:15], v[76:79]
    s_waitcnt lgkmcnt(4)
    v_add_f32 v9, v9, v63
    v_add_f32 v2, v8, v9
    v_mfma_f32_16x16x32_bf16 v[64:67], a[80:83], a[16:19], v[64:67]
    ds_read_b128 a[112:115], v16 offset:45056
    v_cmp_nge_f32 vcc, 1266679808, v2
    v_mfma_f32_16x16x32_bf16 v[72:75], a[80:83], a[20:23], v[72:75]
    buffer_store_dwordx4 a[224:227], v15, s[16:19], s23 offen sc1
    v_mfma_f32_16x16x32_bf16 v[68:71], a[84:87], a[16:19], v[68:71]
    s_add_u32 s23, s23, 16384
    ds_read_b128 a[116:119], v16 offset:46080
    v_mfma_f32_16x16x32_bf16 v[76:79], a[84:87], a[20:23], v[76:79]
    s_cbranch_vccnz .Lmain_kernel_rare_63
.Lmain_kernel_rarer_64:
    v_mfma_f32_16x16x32_bf16 v[64:67], a[88:91], a[24:27], v[64:67]
    ds_read_b128 a[120:123], v16 offset:47104
    v_add_f32 v22, v22, v8
    v_mfma_f32_16x16x32_bf16 v[72:75], a[88:91], a[28:31], v[72:75]
    v_add_f32 v23, v23, v9
    v_mfma_f32_16x16x32_bf16 v[68:71], a[92:95], a[24:27], v[68:71]
    s_waitcnt vmcnt(19)
    s_waitcnt lgkmcnt(3)
    ds_read_b128 a[124:127], v16 offset:48128
    v_mfma_f32_16x16x32_bf16 v[76:79], a[92:95], a[28:31], v[76:79]
    s_barrier
    v_mfma_f32_16x16x32_bf16 v[64:67], a[96:99], a[32:35], v[64:67]
    s_add_u32 m0, s76, 81920
    ds_read_b128 a[64:67], v14 offset:49152
    v_cvt_pk_bf16_f32 v24, v48, v49
    v_mfma_f32_16x16x32_bf16 v[72:75], a[96:99], a[36:39], v[72:75]
    v_cvt_pk_bf16_f32 v25, v50, v51
    v_mfma_f32_16x16x32_bf16 v[68:71], a[100:103], a[32:35], v[68:71]
    ds_read_b128 a[68:71], v14 offset:50176
    buffer_load_dwordx4 v0, s[16:19], s39 offen offset:0 sc1 lds
    v_mfma_f32_16x16x32_bf16 v[76:79], a[100:103], a[36:39], v[76:79]
    v_cvt_pk_bf16_f32 v26, v52, v53
    v_mfma_f32_16x16x32_bf16 v[64:67], a[104:107], a[40:43], v[64:67]
    ds_read_b128 a[72:75], v14 offset:51200
    v_mfma_f32_16x16x32_bf16 v[72:75], a[104:107], a[44:47], v[72:75]
    buffer_load_dwordx4 v0, s[16:19], s39 offen offset:1024 sc1 lds
    v_cvt_pk_bf16_f32 v27, v54, v55
    v_mfma_f32_16x16x32_bf16 v[68:71], a[108:111], a[40:43], v[68:71]
    ds_read_b128 a[76:79], v14 offset:52224
    v_mfma_f32_16x16x32_bf16 v[76:79], a[108:111], a[44:47], v[76:79]
    s_waitcnt lgkmcnt(4)
    v_cvt_pk_bf16_f32 v28, v56, v57
    v_mfma_f32_16x16x32_bf16 v[64:67], a[112:115], a[48:51], v[64:67]
    ds_read_b128 a[80:83], v14 offset:53248
    buffer_load_dwordx4 v0, s[16:19], s39 offen offset:2048 sc1 lds
    v_mfma_f32_16x16x32_bf16 v[72:75], a[112:115], a[52:55], v[72:75]
    v_cvt_pk_bf16_f32 v29, v58, v59
    v_mfma_f32_16x16x32_bf16 v[68:71], a[116:119], a[48:51], v[68:71]
    ds_read_b128 a[84:87], v14 offset:54272
    buffer_load_dwordx4 v0, s[16:19], s39 offen offset:3072 sc1 lds
    v_mfma_f32_16x16x32_bf16 v[76:79], a[116:119], a[52:55], v[76:79]
    v_cvt_pk_bf16_f32 v30, v60, v61
    v_mfma_f32_16x16x32_bf16 v[64:67], a[120:123], a[56:59], v[64:67]
    ds_read_b128 a[88:91], v14 offset:55296
    v_mfma_f32_16x16x32_bf16 v[72:75], a[120:123], a[60:63], v[72:75]
    s_add_u32 s39, s39, 16384
    v_cvt_pk_bf16_f32 v31, v62, v63
    v_mfma_f32_16x16x32_bf16 v[68:71], a[124:127], a[56:59], v[68:71]
    ds_read_b128 a[92:95], v14 offset:56320
    v_mfma_f32_16x16x32_bf16 v[76:79], a[124:127], a[60:63], v[76:79]
    s_waitcnt lgkmcnt(4)
    v_mfma_f32_16x16x32_bf16 v[32:35], a[64:67], v[24:27], v[32:35]
    ds_read_b128 a[96:99], v14 offset:57344
    v_mfma_f32_16x16x32_bf16 v[40:43], a[64:67], v[28:31], v[40:43]
    v_exp_f32 v48, v64
    v_mfma_f32_16x16x32_bf16 v[36:39], a[68:71], v[24:27], v[36:39]
    s_add_u32 m0, s76, 32768
    ds_read_b128 a[100:103], v14 offset:58368
    buffer_store_dwordx4 a[228:231], v15, s[16:19], s23 offen sc1
    v_mfma_f32_16x16x32_bf16 v[44:47], a[68:71], v[28:31], v[44:47]
    s_add_u32 s23, s23, 16384
    v_exp_f32 v49, v65
    v_mfma_f32_16x16x32_bf16 v[96:99], a[72:75], v[24:27], v[96:99]
    ds_read_b128 a[104:107], v14 offset:59392
    buffer_store_dwordx4 a[232:235], v15, s[16:19], s23 offen sc1
    v_mfma_f32_16x16x32_bf16 v[104:107], a[72:75], v[28:31], v[104:107]
    s_add_u32 s23, s23, 16384
    v_exp_f32 v50, v66
    v_mfma_f32_16x16x32_bf16 v[100:103], a[76:79], v[24:27], v[100:103]
    ds_read_b128 a[108:111], v14 offset:60416
    v_add_f32 v8, v48, v49
    v_mfma_f32_16x16x32_bf16 v[108:111], a[76:79], v[28:31], v[108:111]
    s_waitcnt lgkmcnt(4)
    v_exp_f32 v51, v67
    v_mfma_f32_16x16x32_bf16 v[160:163], a[80:83], v[24:27], v[160:163]
    ds_read_b128 a[112:115], v14 offset:61440
    v_add_f32 v8, v8, v50
    v_mfma_f32_16x16x32_bf16 v[168:171], a[80:83], v[28:31], v[168:171]
    v_exp_f32 v56, v72
    v_mfma_f32_16x16x32_bf16 v[164:167], a[84:87], v[24:27], v[164:167]
    ds_read_b128 a[116:119], v14 offset:62464
    v_add_f32 v8, v8, v51
    v_mfma_f32_16x16x32_bf16 v[172:175], a[84:87], v[28:31], v[172:175]
    v_exp_f32 v57, v73
    v_mfma_f32_16x16x32_bf16 v[176:179], a[88:91], v[24:27], v[176:179]
    ds_read_b128 a[120:123], v14 offset:63488
    buffer_load_dwordx4 v0, s[64:67], s60 offen offset:0 sc1 lds
    v_mfma_f32_16x16x32_bf16 v[184:187], a[88:91], v[28:31], v[184:187]
    v_exp_f32 v58, v74
    v_mfma_f32_16x16x32_bf16 v[180:183], a[92:95], v[24:27], v[180:183]
    ds_read_b128 a[124:127], v14 offset:64512
    buffer_load_dwordx4 v0, s[64:67], s60 offen offset:1024 sc1 lds
    v_mfma_f32_16x16x32_bf16 v[188:191], a[92:95], v[28:31], v[188:191]
    s_waitcnt lgkmcnt(4)
    v_add_f32 v9, v56, v57
    v_mfma_f32_16x16x32_bf16 v[192:195], a[96:99], v[24:27], v[192:195]
    ds_read_b128 a[64:67], v16 offset:49152
    buffer_load_dwordx4 v0, s[64:67], s60 offen offset:2048 sc1 lds
    v_mfma_f32_16x16x32_bf16 v[200:203], a[96:99], v[28:31], v[200:203]
    v_exp_f32 v59, v75
    v_mfma_f32_16x16x32_bf16 v[196:199], a[100:103], v[24:27], v[196:199]
    ds_read_b128 a[68:71], v16 offset:50176
    v_add_f32 v9, v9, v58
    v_mfma_f32_16x16x32_bf16 v[204:207], a[100:103], v[28:31], v[204:207]
    v_exp_f32 v52, v68
    v_mfma_f32_16x16x32_bf16 v[208:211], a[104:107], v[24:27], v[208:211]
    ds_read_b128 a[72:75], v16 offset:51200
    v_add_f32 v9, v9, v59
    v_mfma_f32_16x16x32_bf16 v[216:219], a[104:107], v[28:31], v[216:219]
    v_exp_f32 v53, v69
    v_mfma_f32_16x16x32_bf16 v[212:215], a[108:111], v[24:27], v[212:215]
    ds_read_b128 a[76:79], v16 offset:52224
    v_add_f32 v8, v8, v52
    v_mfma_f32_16x16x32_bf16 v[220:223], a[108:111], v[28:31], v[220:223]
    s_waitcnt lgkmcnt(4)
    v_exp_f32 v54, v70
    v_mfma_f32_16x16x32_bf16 v[224:227], a[112:115], v[24:27], v[224:227]
    ds_read_b128 a[80:83], v16 offset:53248
    buffer_load_dwordx4 v0, s[64:67], s60 offen offset:3072 sc1 lds
    v_mfma_f32_16x16x32_bf16 v[232:235], a[112:115], v[28:31], v[232:235]
    v_add_f32 v8, v8, v53
    v_mfma_f32_16x16x32_bf16 v[228:231], a[116:119], v[24:27], v[228:231]
    s_cmp_eq_u32 s37, s38
    ds_read_b128 a[84:87], v16 offset:54272
    v_mfma_f32_16x16x32_bf16 v[236:239], a[116:119], v[28:31], v[236:239]
    s_cbranch_scc1 .Lmain_kernel_mask_65
.Lmain_kernel_maskr_66:
    v_mfma_f32_16x16x32_bf16 v[240:243], a[120:123], v[24:27], v[240:243]
    s_add_u32 s60, s60, 16384
    ds_read_b128 a[88:91], v16 offset:55296
    v_mfma_f32_16x16x32_bf16 v[248:251], a[120:123], v[28:31], v[248:251]
    v_exp_f32 v55, v71
    v_mfma_f32_16x16x32_bf16 v[244:247], a[124:127], v[24:27], v[244:247]
    ds_read_b128 a[92:95], v16 offset:56320
    v_add_f32 v8, v8, v54
    v_mfma_f32_16x16x32_bf16 v[252:255], a[124:127], v[28:31], v[252:255]
    s_waitcnt lgkmcnt(4)
    v_exp_f32 v60, v76
    v_mfma_f32_16x16x32_bf16 v[80:83], a[64:67], a[0:3], v[112:115]
    ds_read_b128 a[96:99], v16 offset:57344
    v_add_f32 v8, v8, v55
    v_mfma_f32_16x16x32_bf16 v[88:91], a[64:67], a[4:7], v[120:123]
    v_exp_f32 v61, v77
    v_mfma_f32_16x16x32_bf16 v[84:87], a[68:71], a[0:3], v[116:119]
    ds_read_b128 a[100:103], v16 offset:58368
    v_add_f32 v9, v9, v60
    v_mfma_f32_16x16x32_bf16 v[92:95], a[68:71], a[4:7], v[124:127]
    v_exp_f32 v62, v78
    v_mfma_f32_16x16x32_bf16 v[80:83], a[72:75], a[8:11], v[80:83]
    ds_read_b128 a[104:107], v16 offset:59392
    v_add_f32 v9, v9, v61
    v_mfma_f32_16x16x32_bf16 v[88:91], a[72:75], a[12:15], v[88:91]
    v_exp_f32 v63, v79
    v_mfma_f32_16x16x32_bf16 v[84:87], a[76:79], a[8:11], v[84:87]
    ds_read_b128 a[108:111], v16 offset:60416
    v_add_f32 v9, v9, v62
    v_mfma_f32_16x16x32_bf16 v[92:95], a[76:79], a[12:15], v[92:95]
    s_waitcnt lgkmcnt(4)
    v_add_f32 v9, v9, v63
    v_add_f32 v2, v8, v9
    v_mfma_f32_16x16x32_bf16 v[80:83], a[80:83], a[16:19], v[80:83]
    ds_read_b128 a[112:115], v16 offset:61440
    v_cmp_nge_f32 vcc, 1266679808, v2
    v_mfma_f32_16x16x32_bf16 v[88:91], a[80:83], a[20:23], v[88:91]
    buffer_store_dwordx4 a[236:239], v15, s[16:19], s23 offen sc1
    v_mfma_f32_16x16x32_bf16 v[84:87], a[84:87], a[16:19], v[84:87]
    s_add_u32 s23, s23, 212992
    ds_read_b128 a[116:119], v16 offset:62464
    v_mfma_f32_16x16x32_bf16 v[92:95], a[84:87], a[20:23], v[92:95]
    s_cbranch_vccnz .Lmain_kernel_rare_67
.Lmain_kernel_rarer_68:
    v_mfma_f32_16x16x32_bf16 v[80:83], a[88:91], a[24:27], v[80:83]
    ds_read_b128 a[120:123], v16 offset:63488
    v_add_f32 v22, v22, v8
    v_mfma_f32_16x16x32_bf16 v[88:91], a[88:91], a[28:31], v[88:91]
    v_add_f32 v23, v23, v9
    v_mfma_f32_16x16x32_bf16 v[84:87], a[92:95], a[24:27], v[84:87]
    s_waitcnt vmcnt(18)
    s_waitcnt lgkmcnt(3)
    ds_read_b128 a[124:127], v16 offset:64512
    v_mfma_f32_16x16x32_bf16 v[92:95], a[92:95], a[28:31], v[92:95]
    s_barrier
    v_mfma_f32_16x16x32_bf16 v[80:83], a[96:99], a[32:35], v[80:83]
    s_add_u32 m0, s76, 98304
    ds_read_b128 a[64:67], v14 offset:0
    v_cvt_pk_bf16_f32 v24, v48, v49
    v_mfma_f32_16x16x32_bf16 v[88:91], a[96:99], a[36:39], v[88:91]
    v_cvt_pk_bf16_f32 v25, v50, v51
    v_mfma_f32_16x16x32_bf16 v[84:87], a[100:103], a[32:35], v[84:87]
    ds_read_b128 a[68:71], v14 offset:1024
    buffer_load_dwordx4 v0, s[16:19], s39 offen offset:0 sc1 lds
    v_mfma_f32_16x16x32_bf16 v[92:95], a[100:103], a[36:39], v[92:95]
    v_cvt_pk_bf16_f32 v26, v52, v53
    v_mfma_f32_16x16x32_bf16 v[80:83], a[104:107], a[40:43], v[80:83]
    ds_read_b128 a[72:75], v14 offset:2048
    v_mfma_f32_16x16x32_bf16 v[88:91], a[104:107], a[44:47], v[88:91]
    buffer_load_dwordx4 v0, s[16:19], s39 offen offset:1024 sc1 lds
    v_cvt_pk_bf16_f32 v27, v54, v55
    v_mfma_f32_16x16x32_bf16 v[84:87], a[108:111], a[40:43], v[84:87]
    ds_read_b128 a[76:79], v14 offset:3072
    v_mfma_f32_16x16x32_bf16 v[92:95], a[108:111], a[44:47], v[92:95]
    s_waitcnt lgkmcnt(4)
    v_cvt_pk_bf16_f32 v28, v56, v57
    v_mfma_f32_16x16x32_bf16 v[80:83], a[112:115], a[48:51], v[80:83]
    ds_read_b128 a[80:83], v14 offset:4096
    buffer_load_dwordx4 v0, s[16:19], s39 offen offset:2048 sc1 lds
    v_mfma_f32_16x16x32_bf16 v[88:91], a[112:115], a[52:55], v[88:91]
    v_cvt_pk_bf16_f32 v29, v58, v59
    v_mfma_f32_16x16x32_bf16 v[84:87], a[116:119], a[48:51], v[84:87]
    ds_read_b128 a[84:87], v14 offset:5120
    buffer_load_dwordx4 v0, s[16:19], s39 offen offset:3072 sc1 lds
    v_mfma_f32_16x16x32_bf16 v[92:95], a[116:119], a[52:55], v[92:95]
    v_cvt_pk_bf16_f32 v30, v60, v61
    v_mfma_f32_16x16x32_bf16 v[80:83], a[120:123], a[56:59], v[80:83]
    ds_read_b128 a[88:91], v14 offset:6144
    v_mfma_f32_16x16x32_bf16 v[88:91], a[120:123], a[60:63], v[88:91]
    s_add_u32 s39, s39, 16384
    v_cvt_pk_bf16_f32 v31, v62, v63
    v_mfma_f32_16x16x32_bf16 v[84:87], a[124:127], a[56:59], v[84:87]
    ds_read_b128 a[92:95], v14 offset:7168
    v_mfma_f32_16x16x32_bf16 v[92:95], a[124:127], a[60:63], v[92:95]
    s_waitcnt lgkmcnt(4)
    s_cmp_eq_u32 s37, 0
    s_cbranch_scc1 .Lmain_kernel_tail_42
.Lmain_kernel_it_45:
    v_mfma_f32_16x16x32_bf16 v[32:35], a[64:67], v[24:27], v[32:35]
    s_sub_u32 s37, s37, 1
    ds_read_b128 a[96:99], v14 offset:8192
    v_mfma_f32_16x16x32_bf16 v[40:43], a[64:67], v[28:31], v[40:43]
    v_exp_f32 v48, v80
    v_mfma_f32_16x16x32_bf16 v[36:39], a[68:71], v[24:27], v[36:39]
    s_add_u32 m0, s76, 49152
    ds_read_b128 a[100:103], v14 offset:9216
    v_mfma_f32_16x16x32_bf16 v[44:47], a[68:71], v[28:31], v[44:47]
    v_exp_f32 v49, v81
    v_mfma_f32_16x16x32_bf16 v[96:99], a[72:75], v[24:27], v[96:99]
    ds_read_b128 a[104:107], v14 offset:10240
    v_mfma_f32_16x16x32_bf16 v[104:107], a[72:75], v[28:31], v[104:107]
    v_exp_f32 v50, v82
    v_mfma_f32_16x16x32_bf16 v[100:103], a[76:79], v[24:27], v[100:103]
    ds_read_b128 a[108:111], v14 offset:11264
    v_add_f32 v8, v48, v49
    v_mfma_f32_16x16x32_bf16 v[108:111], a[76:79], v[28:31], v[108:111]
    s_waitcnt lgkmcnt(4)
    v_exp_f32 v51, v83
    v_mfma_f32_16x16x32_bf16 v[160:163], a[80:83], v[24:27], v[160:163]
    ds_read_b128 a[112:115], v14 offset:12288
    v_add_f32 v8, v8, v50
    v_mfma_f32_16x16x32_bf16 v[168:171], a[80:83], v[28:31], v[168:171]
    v_exp_f32 v56, v88
    v_mfma_f32_16x16x32_bf16 v[164:167], a[84:87], v[24:27], v[164:167]
    s_add_u32 s26, s26, 1
    ds_read_b128 a[116:119], v14 offset:13312
    v_add_f32 v8, v8, v51
    v_mfma_f32_16x16x32_bf16 v[172:175], a[84:87], v[28:31], v[172:175]
    v_exp_f32 v57, v89
    v_mfma_f32_16x16x32_bf16 v[176:179], a[88:91], v[24:27], v[176:179]
    ds_read_b128 a[120:123], v14 offset:14336
    buffer_load_dwordx4 v0, s[64:67], s60 offen offset:0 sc1 lds
    v_mfma_f32_16x16x32_bf16 v[184:187], a[88:91], v[28:31], v[184:187]
    v_exp_f32 v58, v90
    v_mfma_f32_16x16x32_bf16 v[180:183], a[92:95], v[24:27], v[180:183]
    ds_read_b128 a[124:127], v14 offset:15360
    buffer_load_dwordx4 v0, s[64:67], s60 offen offset:1024 sc1 lds
    v_mfma_f32_16x16x32_bf16 v[188:191], a[92:95], v[28:31], v[188:191]
    s_waitcnt lgkmcnt(4)
    v_add_f32 v9, v56, v57
    v_mfma_f32_16x16x32_bf16 v[192:195], a[96:99], v[24:27], v[192:195]
    ds_read_b128 a[64:67], v16 offset:0
    buffer_load_dwordx4 v0, s[64:67], s60 offen offset:2048 sc1 lds
    v_mfma_f32_16x16x32_bf16 v[200:203], a[96:99], v[28:31], v[200:203]
    v_exp_f32 v59, v91
    v_mfma_f32_16x16x32_bf16 v[196:199], a[100:103], v[24:27], v[196:199]
    ds_read_b128 a[68:71], v16 offset:1024
    v_add_f32 v9, v9, v58
    v_mfma_f32_16x16x32_bf16 v[204:207], a[100:103], v[28:31], v[204:207]
    v_exp_f32 v52, v84
    v_mfma_f32_16x16x32_bf16 v[208:211], a[104:107], v[24:27], v[208:211]
    ds_read_b128 a[72:75], v16 offset:2048
    v_add_f32 v9, v9, v59
    v_mfma_f32_16x16x32_bf16 v[216:219], a[104:107], v[28:31], v[216:219]
    v_exp_f32 v53, v85
    v_mfma_f32_16x16x32_bf16 v[212:215], a[108:111], v[24:27], v[212:215]
    ds_read_b128 a[76:79], v16 offset:3072
    v_add_f32 v8, v8, v52
    v_mfma_f32_16x16x32_bf16 v[220:223], a[108:111], v[28:31], v[220:223]
    s_waitcnt lgkmcnt(4)
    v_exp_f32 v54, v86
    v_mfma_f32_16x16x32_bf16 v[224:227], a[112:115], v[24:27], v[224:227]
    ds_read_b128 a[80:83], v16 offset:4096
    buffer_load_dwordx4 v0, s[64:67], s60 offen offset:3072 sc1 lds
    v_mfma_f32_16x16x32_bf16 v[232:235], a[112:115], v[28:31], v[232:235]
    v_add_f32 v8, v8, v53
    v_mfma_f32_16x16x32_bf16 v[228:231], a[116:119], v[24:27], v[228:231]
    s_cmp_eq_u32 s37, s38
    ds_read_b128 a[84:87], v16 offset:5120
    v_mfma_f32_16x16x32_bf16 v[236:239], a[116:119], v[28:31], v[236:239]
    s_cbranch_scc1 .Lmain_kernel_mask_70
.Lmain_kernel_maskr_71:
    v_mfma_f32_16x16x32_bf16 v[240:243], a[120:123], v[24:27], v[240:243]
    s_add_u32 s60, s60, 16384
    ds_read_b128 a[88:91], v16 offset:6144
    v_mfma_f32_16x16x32_bf16 v[248:251], a[120:123], v[28:31], v[248:251]
    v_exp_f32 v55, v87
    v_mfma_f32_16x16x32_bf16 v[244:247], a[124:127], v[24:27], v[244:247]
    ds_read_b128 a[92:95], v16 offset:7168
    v_add_f32 v8, v8, v54
    v_mfma_f32_16x16x32_bf16 v[252:255], a[124:127], v[28:31], v[252:255]
    s_waitcnt lgkmcnt(4)
    v_exp_f32 v60, v92
    v_mfma_f32_16x16x32_bf16 v[64:67], a[64:67], a[0:3], v[112:115]
    ds_read_b128 a[96:99], v16 offset:8192
    v_add_f32 v8, v8, v55
    v_mfma_f32_16x16x32_bf16 v[72:75], a[64:67], a[4:7], v[120:123]
    v_exp_f32 v61, v93
    v_mfma_f32_16x16x32_bf16 v[68:71], a[68:71], a[0:3], v[116:119]
    ds_read_b128 a[100:103], v16 offset:9216
    v_add_f32 v9, v9, v60
    v_mfma_f32_16x16x32_bf16 v[76:79], a[68:71], a[4:7], v[124:127]
    v_exp_f32 v62, v94
    v_mfma_f32_16x16x32_bf16 v[64:67], a[72:75], a[8:11], v[64:67]
    ds_read_b128 a[104:107], v16 offset:10240
    v_add_f32 v9, v9, v61
    v_mfma_f32_16x16x32_bf16 v[72:75], a[72:75], a[12:15], v[72:75]
    v_exp_f32 v63, v95
    v_mfma_f32_16x16x32_bf16 v[68:71], a[76:79], a[8:11], v[68:71]
    ds_read_b128 a[108:111], v16 offset:11264
    v_add_f32 v9, v9, v62
    v_mfma_f32_16x16x32_bf16 v[76:79], a[76:79], a[12:15], v[76:79]
    s_waitcnt lgkmcnt(4)
    v_add_f32 v9, v9, v63
    v_add_f32 v2, v8, v9
    v_mfma_f32_16x16x32_bf16 v[64:67], a[80:83], a[16:19], v[64:67]
    ds_read_b128 a[112:115], v16 offset:12288
    v_cmp_nge_f32 vcc, 1266679808, v2
    v_mfma_f32_16x16x32_bf16 v[72:75], a[80:83], a[20:23], v[72:75]
    v_mfma_f32_16x16x32_bf16 v[68:71], a[84:87], a[16:19], v[68:71]
    ds_read_b128 a[116:119], v16 offset:13312
    v_mfma_f32_16x16x32_bf16 v[76:79], a[84:87], a[20:23], v[76:79]
    s_cbranch_vccnz .Lmain_kernel_rare_54
.Lmain_kernel_rarer_72:
    v_mfma_f32_16x16x32_bf16 v[64:67], a[88:91], a[24:27], v[64:67]
    ds_read_b128 a[120:123], v16 offset:14336
    v_add_f32 v22, v22, v8
    v_mfma_f32_16x16x32_bf16 v[72:75], a[88:91], a[28:31], v[72:75]
    v_add_f32 v23, v23, v9
    v_and_b32 v129, 16, v14
    v_mov_b32 v130, 0x3f80
    v_mfma_f32_16x16x32_bf16 v[68:71], a[92:95], a[24:27], v[68:71]
    s_waitcnt vmcnt(15)
    s_waitcnt lgkmcnt(3)
    ds_read_b128 a[124:127], v16 offset:15360
    v_lshlrev_b32 v129, v129, v130
    v_mfma_f32_16x16x32_bf16 v[76:79], a[92:95], a[28:31], v[76:79]
    s_barrier
    v_mfma_f32_16x16x32_bf16 v[64:67], a[96:99], a[32:35], v[64:67]
    s_add_u32 m0, s76, 114688
    ds_read_b128 a[64:67], v14 offset:16384
    v_cvt_pk_bf16_f32 v24, v48, v49
    v_bfe_u32 v130, v14, 5, 3
    v_mfma_f32_16x16x32_bf16 v[72:75], a[96:99], a[36:39], v[72:75]
    buffer_load_dwordx4 v0, s[16:19], s39 offen offset:0 sc1 lds
    v_cvt_pk_bf16_f32 v25, v50, v51
    v_cmp_eq_u32 vcc, 0, v130
    v_mfma_f32_16x16x32_bf16 v[68:71], a[100:103], a[32:35], v[68:71]
    ds_read_b128 a[68:71], v14 offset:17408
    v_cndmask_b32 v136, 0, v129, vcc
    v_cmp_eq_u32 vcc, 1, v130
    v_mfma_f32_16x16x32_bf16 v[76:79], a[100:103], a[36:39], v[76:79]
    buffer_load_dwordx4 v0, s[16:19], s39 offen offset:1024 sc1 lds
    v_cvt_pk_bf16_f32 v26, v52, v53
    v_cndmask_b32 v137, 0, v129, vcc
    v_mfma_f32_16x16x32_bf16 v[64:67], a[104:107], a[40:43], v[64:67]
    ds_read_b128 a[72:75], v14 offset:18432
    buffer_load_dwordx4 v0, s[16:19], s39 offen offset:2048 sc1 lds
    v_mfma_f32_16x16x32_bf16 v[72:75], a[104:107], a[44:47], v[72:75]
    v_cvt_pk_bf16_f32 v27, v54, v55
    v_cmp_eq_u32 vcc, 2, v130
    s_nop 1
    v_cndmask_b32 v138, 0, v129, vcc
    v_mfma_f32_16x16x32_bf16 v[68:71], a[108:111], a[40:43], v[68:71]
    ds_read_b128 a[76:79], v14 offset:19456
    buffer_load_dwordx4 v0, s[16:19], s39 offen offset:3072 sc1 lds
    v_mfma_f32_16x16x32_bf16 v[76:79], a[108:111], a[44:47], v[76:79]
    s_waitcnt lgkmcnt(4)
    v_cvt_pk_bf16_f32 v28, v56, v57
    v_cmp_eq_u32 vcc, 3, v130
    v_mfma_f32_16x16x32_bf16 v[64:67], a[112:115], a[48:51], v[64:67]
    s_add_u32 s39, s39, 16384
    ds_read_b128 a[80:83], v14 offset:20480
    v_cndmask_b32 v139, 0, v129, vcc
    v_cmp_eq_u32 vcc, 4, v130
    v_mfma_f32_16x16x32_bf16 v[72:75], a[112:115], a[52:55], v[72:75]
    s_cmp_eq_u32 s39, s61
    s_cselect_b32 s39, s62, s39
    s_cselect_b32 s61, s5, s61
    v_cndmask_b32 v140, 0, v129, vcc
    v_mfma_f32_16x16x32_bf16 v[68:71], a[116:119], a[48:51], v[68:71]
    s_cselect_b32 s62, 1073741824, s62
    ds_read_b128 a[84:87], v14 offset:21504
    v_cvt_pk_bf16_f32 v29, v58, v59
    v_mfma_f32_16x16x32_bf16 v[76:79], a[116:119], a[52:55], v[76:79]
    v_cvt_pk_bf16_f32 v30, v60, v61
    v_cmp_eq_u32 vcc, 5, v130
    v_mfma_f32_16x16x32_bf16 v[64:67], a[120:123], a[56:59], v[64:67]
    ds_read_b128 a[88:91], v14 offset:22528
    v_cndmask_b32 v141, 0, v129, vcc
    v_mfma_f32_16x16x32_bf16 v[72:75], a[120:123], a[60:63], v[72:75]
    v_cvt_pk_bf16_f32 v31, v62, v63
    v_cmp_eq_u32 vcc, 6, v130
    v_mfma_f32_16x16x32_bf16 v[68:71], a[124:127], a[56:59], v[68:71]
    ds_read_b128 a[92:95], v14 offset:23552
    v_cndmask_b32 v142, 0, v129, vcc
    v_mfma_f32_16x16x32_bf16 v[76:79], a[124:127], a[60:63], v[76:79]
    s_waitcnt lgkmcnt(4)
    v_cmp_eq_u32 vcc, 7, v130
    s_nop 1
    v_cndmask_b32 v143, 0, v129, vcc
    v_mfma_f32_16x16x32_bf16 v[32:35], a[64:67], v[24:27], v[32:35]
    ds_read_b128 a[96:99], v14 offset:24576
    v_mfma_f32_16x16x32_bf16 v[40:43], a[64:67], v[28:31], v[40:43]
    v_exp_f32 v48, v64
    v_mfma_f32_16x16x32_bf16 v[36:39], a[68:71], v[24:27], v[36:39]
    s_add_u32 m0, s76, 0
    ds_read_b128 a[100:103], v14 offset:25600
    v_mfma_f32_16x16x32_bf16 v[44:47], a[68:71], v[28:31], v[44:47]
    v_exp_f32 v49, v65
    v_mfma_f32_16x16x32_bf16 v[96:99], a[72:75], v[24:27], v[96:99]
    ds_read_b128 a[104:107], v14 offset:26624
    v_mfma_f32_16x16x32_bf16 v[104:107], a[72:75], v[28:31], v[104:107]
    v_exp_f32 v50, v66
    v_mfma_f32_16x16x32_bf16 v[100:103], a[76:79], v[24:27], v[100:103]
    ds_read_b128 a[108:111], v14 offset:27648
    v_add_f32 v8, v48, v49
    v_mfma_f32_16x16x32_bf16 v[108:111], a[76:79], v[28:31], v[108:111]
    s_waitcnt lgkmcnt(4)
    v_exp_f32 v51, v67
    v_mfma_f32_16x16x32_bf16 v[160:163], a[80:83], v[24:27], v[160:163]
    ds_read_b128 a[112:115], v14 offset:28672
    v_add_f32 v8, v8, v50
    v_mfma_f32_16x16x32_bf16 v[168:171], a[80:83], v[28:31], v[168:171]
    v_exp_f32 v56, v72
    v_mfma_f32_16x16x32_bf16 v[164:167], a[84:87], v[24:27], v[164:167]
    ds_read_b128 a[116:119], v14 offset:29696
    v_add_f32 v8, v8, v51
    v_mfma_f32_16x16x32_bf16 v[172:175], a[84:87], v[28:31], v[172:175]
    v_exp_f32 v57, v73
    v_mfma_f32_16x16x32_bf16 v[176:179], a[88:91], v[24:27], v[176:179]
    ds_read_b128 a[120:123], v14 offset:30720
    buffer_load_dwordx4 v0, s[64:67], s60 offen offset:0 sc1 lds
    v_mfma_f32_16x16x32_bf16 v[184:187], a[88:91], v[28:31], v[184:187]
    v_exp_f32 v58, v74
    v_mfma_f32_16x16x32_bf16 v[180:183], a[92:95], v[24:27], v[180:183]
    ds_read_b128 a[124:127], v14 offset:31744
    buffer_load_dwordx4 v0, s[64:67], s60 offen offset:1024 sc1 lds
    v_mfma_f32_16x16x32_bf16 v[188:191], a[92:95], v[28:31], v[188:191]
    s_waitcnt lgkmcnt(4)
    v_add_f32 v9, v56, v57
    v_mfma_f32_16x16x32_bf16 v[192:195], a[96:99], v[24:27], v[192:195]
    ds_read_b128 a[64:67], v16 offset:16384
    buffer_load_dwordx4 v0, s[64:67], s60 offen offset:2048 sc1 lds
    v_mfma_f32_16x16x32_bf16 v[200:203], a[96:99], v[28:31], v[200:203]
    v_exp_f32 v59, v75
    v_mfma_f32_16x16x32_bf16 v[196:199], a[100:103], v[24:27], v[196:199]
    ds_read_b128 a[68:71], v16 offset:17408
    v_add_f32 v9, v9, v58
    v_mfma_f32_16x16x32_bf16 v[204:207], a[100:103], v[28:31], v[204:207]
    v_exp_f32 v52, v68
    v_mfma_f32_16x16x32_bf16 v[208:211], a[104:107], v[24:27], v[208:211]
    ds_read_b128 a[72:75], v16 offset:18432
    v_add_f32 v9, v9, v59
    v_mfma_f32_16x16x32_bf16 v[216:219], a[104:107], v[28:31], v[216:219]
    v_exp_f32 v53, v69
    v_mfma_f32_16x16x32_bf16 v[212:215], a[108:111], v[24:27], v[212:215]
    ds_read_b128 a[76:79], v16 offset:19456
    v_add_f32 v8, v8, v52
    v_mfma_f32_16x16x32_bf16 v[220:223], a[108:111], v[28:31], v[220:223]
    s_waitcnt lgkmcnt(4)
    v_exp_f32 v54, v70
    v_mfma_f32_16x16x32_bf16 v[224:227], a[112:115], v[24:27], v[224:227]
    ds_read_b128 a[80:83], v16 offset:20480
    buffer_load_dwordx4 v0, s[64:67], s60 offen offset:3072 sc1 lds
    v_mfma_f32_16x16x32_bf16 v[232:235], a[112:115], v[28:31], v[232:235]
    v_add_f32 v8, v8, v53
    v_mfma_f32_16x16x32_bf16 v[228:231], a[116:119], v[24:27], v[228:231]
    s_cmp_eq_u32 s37, s38
    ds_read_b128 a[84:87], v16 offset:21504
    v_mfma_f32_16x16x32_bf16 v[236:239], a[116:119], v[28:31], v[236:239]
    s_cbranch_scc1 .Lmain_kernel_mask_73
.Lmain_kernel_maskr_74:
    v_mfma_f32_16x16x32_bf16 v[240:243], a[120:123], v[24:27], v[240:243]
    s_add_u32 s60, s60, 16384
    ds_read_b128 a[88:91], v16 offset:22528
    v_mfma_f32_16x16x32_bf16 v[248:251], a[120:123], v[28:31], v[248:251]
    v_exp_f32 v55, v71
    v_mfma_f32_16x16x32_bf16 v[244:247], a[124:127], v[24:27], v[244:247]
    ds_read_b128 a[92:95], v16 offset:23552
    v_add_f32 v8, v8, v54
    v_mfma_f32_16x16x32_bf16 v[252:255], a[124:127], v[28:31], v[252:255]
    s_waitcnt lgkmcnt(4)
    v_exp_f32 v60, v76
    v_mfma_f32_16x16x32_bf16 v[80:83], a[64:67], a[0:3], v[112:115]
    ds_read_b128 a[96:99], v16 offset:24576
    v_add_f32 v8, v8, v55
    v_mfma_f32_16x16x32_bf16 v[88:91], a[64:67], a[4:7], v[120:123]
    s_waitcnt vmcnt(15)
    v_exp_f32 v61, v77
    v_mfma_f32_16x16x32_bf16 v[84:87], a[68:71], a[0:3], v[116:119]
    ds_read_b128 a[100:103], v16 offset:25600
    v_add_f32 v9, v9, v60
    v_mfma_f32_16x16x32_bf16 v[92:95], a[68:71], a[4:7], v[124:127]
    v_exp_f32 v62, v78
    v_mfma_f32_16x16x32_bf16 v[80:83], a[72:75], a[8:11], v[80:83]
    ds_read_b128 a[104:107], v16 offset:26624
    v_add_f32 v9, v9, v61
    v_mfma_f32_16x16x32_bf16 v[88:91], a[72:75], a[12:15], v[88:91]
    v_exp_f32 v63, v79
    v_mfma_f32_16x16x32_bf16 v[84:87], a[76:79], a[8:11], v[84:87]
    ds_read_b128 a[108:111], v16 offset:27648
    v_add_f32 v9, v9, v62
    v_mfma_f32_16x16x32_bf16 v[92:95], a[76:79], a[12:15], v[92:95]
    s_waitcnt lgkmcnt(4)
    v_add_f32 v9, v9, v63
    v_add_f32 v2, v8, v9
    v_mfma_f32_16x16x32_bf16 v[80:83], a[80:83], a[16:19], v[80:83]
    ds_read_b128 a[112:115], v16 offset:28672
    v_cmp_nge_f32 vcc, 1266679808, v2
    v_mfma_f32_16x16x32_bf16 v[88:91], a[80:83], a[20:23], v[88:91]
    v_mov_b32 v129, 1
    s_mov_b64 exec, 1
    buffer_store_dword v129, off, s[16:19], s25 sc1
    s_mov_b64 exec, -1
    v_mfma_f32_16x16x32_bf16 v[84:87], a[84:87], a[16:19], v[84:87]
    ds_read_b128 a[116:119], v16 offset:29696
    v_mfma_f32_16x16x32_bf16 v[92:95], a[84:87], a[20:23], v[92:95]
    s_cbranch_vccnz .Lmain_kernel_rare_59
.Lmain_kernel_rarer_75:
    v_mfma_f32_16x16x32_bf16 v[80:83], a[88:91], a[24:27], v[80:83]
    ds_read_b128 a[120:123], v16 offset:30720
    v_add_f32 v22, v22, v8
    v_mfma_f32_16x16x32_bf16 v[88:91], a[88:91], a[28:31], v[88:91]
    s_and_b32 s30, s24, 1
    v_add_f32 v23, v23, v9
    v_mfma_f32_16x16x32_bf16 v[84:87], a[92:95], a[24:27], v[84:87]
    s_waitcnt vmcnt(13)
    s_waitcnt lgkmcnt(3)
    ds_read_b128 a[124:127], v16 offset:31744
    v_mfma_f32_16x16x32_bf16 v[92:95], a[92:95], a[28:31], v[92:95]
    s_barrier
    v_mfma_f32_16x16x32_bf16 v[80:83], a[96:99], a[32:35], v[80:83]
    s_add_u32 m0, s76, 65536
    ds_read_b128 a[64:67], v14 offset:32768
    v_cvt_pk_bf16_f32 v24, v48, v49
    v_mfma_f32_16x16x32_bf16 v[88:91], a[96:99], a[36:39], v[88:91]
    s_lshl_b32 s30, s30, 10
    v_cvt_pk_bf16_f32 v25, v50, v51
    v_add_u32 v134, s30, v14
    v_mfma_f32_16x16x32_bf16 v[84:87], a[100:103], a[32:35], v[84:87]
    ds_read_b128 a[68:71], v14 offset:33792
    buffer_load_dwordx4 v0, s[16:19], s39 offen offset:0 sc1 lds
    v_mfma_f32_16x16x32_bf16 v[92:95], a[100:103], a[36:39], v[92:95]
    v_cvt_pk_bf16_f32 v26, v52, v53
    v_mfma_f32_16x16x32_bf16 v[80:83], a[104:107], a[40:43], v[80:83]
    s_lshl_b32 s30, s21, 9
    ds_read_b128 a[72:75], v14 offset:34816
    v_mfma_f32_16x16x32_bf16 v[88:91], a[104:107], a[44:47], v[88:91]
    buffer_load_dwordx4 v0, s[16:19], s39 offen offset:1024 sc1 lds
    v_cvt_pk_bf16_f32 v27, v54, v55
    v_mfma_f32_16x16x32_bf16 v[84:87], a[108:111], a[40:43], v[84:87]
    s_add_u32 s30, s30, 1024
    ds_read_b128 a[76:79], v14 offset:35840
    v_mfma_f32_16x16x32_bf16 v[92:95], a[108:111], a[44:47], v[92:95]
    s_waitcnt lgkmcnt(4)
    v_cvt_pk_bf16_f32 v28, v56, v57
    v_mfma_f32_16x16x32_bf16 v[80:83], a[112:115], a[48:51], v[80:83]
    ds_read_b128 a[80:83], v14 offset:36864
    buffer_load_dwordx4 v0, s[16:19], s39 offen offset:2048 sc1 lds
    v_mfma_f32_16x16x32_bf16 v[88:91], a[112:115], a[52:55], v[88:91]
    v_cvt_pk_bf16_f32 v29, v58, v59
    v_xor_b32 v135, s30, v134
    v_mfma_f32_16x16x32_bf16 v[84:87], a[116:119], a[48:51], v[84:87]
    ds_read_b128 a[84:87], v14 offset:37888
    buffer_load_dwordx4 v0, s[16:19], s39 offen offset:3072 sc1 lds
    v_mfma_f32_16x16x32_bf16 v[92:95], a[116:119], a[52:55], v[92:95]
    v_cvt_pk_bf16_f32 v30, v60, v61
    v_and_b32 v129, 0x200, v14
    v_mfma_f32_16x16x32_bf16 v[80:83], a[120:123], a[56:59], v[80:83]
    ds_read_b128 a[88:91], v14 offset:38912
    v_mfma_f32_16x16x32_bf16 v[88:91], a[120:123], a[60:63], v[88:91]
    s_add_u32 s39, s39, 16384
    v_cvt_pk_bf16_f32 v31, v62, v63
    v_lshl_add_u32 v135, v129, 21, v135
    v_mfma_f32_16x16x32_bf16 v[84:87], a[124:127], a[56:59], v[84:87]
    ds_read_b128 a[92:95], v14 offset:39936
    v_mfma_f32_16x16x32_bf16 v[92:95], a[124:127], a[60:63], v[92:95]
    s_waitcnt lgkmcnt(4)
    v_mfma_f32_16x16x32_bf16 v[32:35], a[64:67], v[24:27], v[32:35]
    ds_read_b128 a[96:99], v14 offset:40960
    v_mfma_f32_16x16x32_bf16 v[40:43], a[64:67], v[28:31], v[40:43]
    v_exp_f32 v48, v80
    v_mfma_f32_16x16x32_bf16 v[36:39], a[68:71], v[24:27], v[36:39]
    s_add_u32 m0, s76, 16384
    ds_read_b128 a[100:103], v14 offset:41984
    v_mfma_f32_16x16x32_bf16 v[44:47], a[68:71], v[28:31], v[44:47]
    v_exp_f32 v49, v81
    v_mfma_f32_16x16x32_bf16 v[96:99], a[72:75], v[24:27], v[96:99]
    ds_read_b128 a[104:107], v14 offset:43008
    buffer_load_dwordx4 v0, s[64:67], s60 offen offset:0 sc1 lds
    v_mfma_f32_16x16x32_bf16 v[104:107], a[72:75], v[28:31], v[104:107]
    v_exp_f32 v50, v82
    v_mfma_f32_16x16x32_bf16 v[100:103], a[76:79], v[24:27], v[100:103]
    ds_read_b128 a[108:111], v14 offset:44032
    v_add_f32 v8, v48, v49
    v_mfma_f32_16x16x32_bf16 v[108:111], a[76:79], v[28:31], v[108:111]
    s_waitcnt lgkmcnt(4)
    v_exp_f32 v51, v83
    v_mfma_f32_16x16x32_bf16 v[160:163], a[80:83], v[24:27], v[160:163]
    ds_read_b128 a[112:115], v14 offset:45056
    v_add_f32 v8, v8, v50
    v_mfma_f32_16x16x32_bf16 v[168:171], a[80:83], v[28:31], v[168:171]
    v_exp_f32 v56, v88
    v_mfma_f32_16x16x32_bf16 v[164:167], a[84:87], v[24:27], v[164:167]
    ds_read_b128 a[116:119], v14 offset:46080
    v_add_f32 v8, v8, v51
    v_mfma_f32_16x16x32_bf16 v[172:175], a[84:87], v[28:31], v[172:175]
    v_exp_f32 v57, v89
    v_mfma_f32_16x16x32_bf16 v[176:179], a[88:91], v[24:27], v[176:179]
    ds_read_b128 a[120:123], v14 offset:47104
    buffer_load_dwordx4 v0, s[64:67], s60 offen offset:1024 sc1 lds
    v_mfma_f32_16x16x32_bf16 v[184:187], a[88:91], v[28:31], v[184:187]
    v_exp_f32 v58, v90
    v_mfma_f32_16x16x32_bf16 v[180:183], a[92:95], v[24:27], v[180:183]
    ds_read_b128 a[124:127], v14 offset:48128
    buffer_load_dwordx4 v0, s[64:67], s60 offen offset:2048 sc1 lds
    v_mfma_f32_16x16x32_bf16 v[188:191], a[92:95], v[28:31], v[188:191]
    s_waitcnt lgkmcnt(4)
    buffer_load_dwordx4 v0, s[64:67], s60 offen offset:3072 sc1 lds
    v_add_f32 v9, v56, v57
    v_mfma_f32_16x16x32_bf16 v[192:195], a[96:99], v[24:27], v[192:195]
    s_add_u32 s60, s60, 16384
    ds_read_b128 a[64:67], v16 offset:32768
    v_mfma_f32_16x16x32_bf16 v[200:203], a[96:99], v[28:31], v[200:203]
    v_exp_f32 v59, v91
    v_mfma_f32_16x16x32_bf16 v[196:199], a[100:103], v[24:27], v[196:199]
    ds_read_b128 a[68:71], v16 offset:33792
    v_add_f32 v9, v9, v58
    v_mfma_f32_16x16x32_bf16 v[204:207], a[100:103], v[28:31], v[204:207]
    s_cmp_eq_u32 s60, s63
    v_exp_f32 v52, v84
    v_mfma_f32_16x16x32_bf16 v[208:211], a[104:107], v[24:27], v[208:211]
    s_cselect_b32 s60, s4, s60
    ds_read_b128 a[72:75], v16 offset:34816
    v_add_f32 v9, v9, v59
    v_mfma_f32_16x16x32_bf16 v[216:219], a[104:107], v[28:31], v[216:219]
    s_cselect_b32 s63, s5, s63
    v_exp_f32 v53, v85
    v_mfma_f32_16x16x32_bf16 v[212:215], a[108:111], v[24:27], v[212:215]
    s_cselect_b32 s4, 1073741824, s4
    ds_read_b128 a[76:79], v16 offset:35840
    v_add_f32 v8, v8, v52
    v_mfma_f32_16x16x32_bf16 v[220:223], a[108:111], v[28:31], v[220:223]
    s_waitcnt lgkmcnt(4)
    v_exp_f32 v54, v86
    v_mfma_f32_16x16x32_bf16 v[224:227], a[112:115], v[24:27], v[224:227]
    ds_read_b128 a[80:83], v16 offset:36864
    v_mfma_f32_16x16x32_bf16 v[232:235], a[112:115], v[28:31], v[232:235]
    v_add_f32 v8, v8, v53
    v_mfma_f32_16x16x32_bf16 v[228:231], a[116:119], v[24:27], v[228:231]
    s_cmp_eq_u32 s37, s38
    ds_read_b128 a[84:87], v16 offset:37888
    v_mfma_f32_16x16x32_bf16 v[236:239], a[116:119], v[28:31], v[236:239]
    s_cbranch_scc1 .Lmain_kernel_mask_76
.Lmain_kernel_maskr_77:
    v_mfma_f32_16x16x32_bf16 v[240:243], a[120:123], v[24:27], v[240:243]
    ds_read_b128 a[88:91], v16 offset:38912
    v_mfma_f32_16x16x32_bf16 v[248:251], a[120:123], v[28:31], v[248:251]
    v_exp_f32 v55, v87
    v_mfma_f32_16x16x32_bf16 v[244:247], a[124:127], v[24:27], v[244:247]
    ds_read_b128 a[92:95], v16 offset:39936
    v_add_f32 v8, v8, v54
    v_mfma_f32_16x16x32_bf16 v[252:255], a[124:127], v[28:31], v[252:255]
    s_waitcnt lgkmcnt(4)
    v_exp_f32 v60, v92
    v_mfma_f32_16x16x32_bf16 v[64:67], a[64:67], a[0:3], v[112:115]
    ds_read_b128 a[96:99], v16 offset:40960
    v_add_f32 v8, v8, v55
    v_mfma_f32_16x16x32_bf16 v[72:75], a[64:67], a[4:7], v[120:123]
    v_exp_f32 v61, v93
    v_mfma_f32_16x16x32_bf16 v[68:71], a[68:71], a[0:3], v[116:119]
    ds_read_b128 a[100:103], v16 offset:41984
    v_add_f32 v9, v9, v60
    v_mfma_f32_16x16x32_bf16 v[76:79], a[68:71], a[4:7], v[124:127]
    v_exp_f32 v62, v94
    v_mfma_f32_16x16x32_bf16 v[64:67], a[72:75], a[8:11], v[64:67]
    ds_read_b128 a[104:107], v16 offset:43008
    v_add_f32 v9, v9, v61
    v_mfma_f32_16x16x32_bf16 v[72:75], a[72:75], a[12:15], v[72:75]
    v_exp_f32 v63, v95
    v_mfma_f32_16x16x32_bf16 v[68:71], a[76:79], a[8:11], v[68:71]
    ds_read_b128 a[108:111], v16 offset:44032
    v_add_f32 v9, v9, v62
    v_mfma_f32_16x16x32_bf16 v[76:79], a[76:79], a[12:15], v[76:79]
    s_waitcnt lgkmcnt(4)
    v_add_f32 v9, v9, v63
    v_add_f32 v2, v8, v9
    v_mfma_f32_16x16x32_bf16 v[64:67], a[80:83], a[16:19], v[64:67]
    ds_read_b128 a[112:115], v16 offset:45056
    v_cmp_nge_f32 vcc, 1266679808, v2
    v_mfma_f32_16x16x32_bf16 v[72:75], a[80:83], a[20:23], v[72:75]
    v_mfma_f32_16x16x32_bf16 v[68:71], a[84:87], a[16:19], v[68:71]
    ds_read_b128 a[116:119], v16 offset:46080
    v_mfma_f32_16x16x32_bf16 v[76:79], a[84:87], a[20:23], v[76:79]
    s_cbranch_vccnz .Lmain_kernel_rare_63
.Lmain_kernel_rarer_78:
    v_mfma_f32_16x16x32_bf16 v[64:67], a[88:91], a[24:27], v[64:67]
    ds_read_b128 a[120:123], v16 offset:47104
    v_add_f32 v22, v22, v8
    v_mfma_f32_16x16x32_bf16 v[72:75], a[88:91], a[28:31], v[72:75]
    v_add_f32 v23, v23, v9
    v_mfma_f32_16x16x32_bf16 v[68:71], a[92:95], a[24:27], v[68:71]
    s_waitcnt vmcnt(13)
    s_waitcnt lgkmcnt(3)
    ds_read_b128 a[124:127], v16 offset:48128
    v_mfma_f32_16x16x32_bf16 v[76:79], a[92:95], a[28:31], v[76:79]
    s_barrier
    v_mfma_f32_16x16x32_bf16 v[64:67], a[96:99], a[32:35], v[64:67]
    s_add_u32 m0, s76, 81920
    ds_read_b128 a[64:67], v14 offset:49152
    v_cvt_pk_bf16_f32 v24, v48, v49
    v_mfma_f32_16x16x32_bf16 v[72:75], a[96:99], a[36:39], v[72:75]
    v_cvt_pk_bf16_f32 v25, v50, v51
    v_mfma_f32_16x16x32_bf16 v[68:71], a[100:103], a[32:35], v[68:71]
    ds_read_b128 a[68:71], v14 offset:50176
    buffer_load_dwordx4 v0, s[16:19], s39 offen offset:0 sc1 lds
    v_mfma_f32_16x16x32_bf16 v[76:79], a[100:103], a[36:39], v[76:79]
    v_cvt_pk_bf16_f32 v26, v52, v53
    v_mfma_f32_16x16x32_bf16 v[64:67], a[104:107], a[40:43], v[64:67]
    ds_read_b128 a[72:75], v14 offset:51200
    v_mfma_f32_16x16x32_bf16 v[72:75], a[104:107], a[44:47], v[72:75]
    buffer_load_dwordx4 v0, s[16:19], s39 offen offset:1024 sc1 lds
    v_cvt_pk_bf16_f32 v27, v54, v55
    v_mfma_f32_16x16x32_bf16 v[68:71], a[108:111], a[40:43], v[68:71]
    ds_read_b128 a[76:79], v14 offset:52224
    v_mfma_f32_16x16x32_bf16 v[76:79], a[108:111], a[44:47], v[76:79]
    s_waitcnt lgkmcnt(4)
    v_cvt_pk_bf16_f32 v28, v56, v57
    v_mfma_f32_16x16x32_bf16 v[64:67], a[112:115], a[48:51], v[64:67]
    ds_read_b128 a[80:83], v14 offset:53248
    buffer_load_dwordx4 v0, s[16:19], s39 offen offset:2048 sc1 lds
    v_mfma_f32_16x16x32_bf16 v[72:75], a[112:115], a[52:55], v[72:75]
    v_cvt_pk_bf16_f32 v29, v58, v59
    v_mfma_f32_16x16x32_bf16 v[68:71], a[116:119], a[48:51], v[68:71]
    ds_read_b128 a[84:87], v14 offset:54272
    buffer_load_dwordx4 v0, s[16:19], s39 offen offset:3072 sc1 lds
    v_mfma_f32_16x16x32_bf16 v[76:79], a[116:119], a[52:55], v[76:79]
    v_cvt_pk_bf16_f32 v30, v60, v61
    v_mfma_f32_16x16x32_bf16 v[64:67], a[120:123], a[56:59], v[64:67]
    ds_read_b128 a[88:91], v14 offset:55296
    v_mfma_f32_16x16x32_bf16 v[72:75], a[120:123], a[60:63], v[72:75]
    s_add_u32 s39, s39, 16384
    v_cvt_pk_bf16_f32 v31, v62, v63
    v_mfma_f32_16x16x32_bf16 v[68:71], a[124:127], a[56:59], v[68:71]
    ds_read_b128 a[92:95], v14 offset:56320
    v_mfma_f32_16x16x32_bf16 v[76:79], a[124:127], a[60:63], v[76:79]
    s_waitcnt lgkmcnt(4)
    v_mfma_f32_16x16x32_bf16 v[32:35], a[64:67], v[24:27], v[32:35]
    ds_read_b128 a[96:99], v14 offset:57344
    v_mfma_f32_16x16x32_bf16 v[40:43], a[64:67], v[28:31], v[40:43]
    v_exp_f32 v48, v64
    v_mfma_f32_16x16x32_bf16 v[36:39], a[68:71], v[24:27], v[36:39]
    s_add_u32 m0, s76, 32768
    ds_read_b128 a[100:103], v14 offset:58368
    v_mfma_f32_16x16x32_bf16 v[44:47], a[68:71], v[28:31], v[44:47]
    v_exp_f32 v49, v65
    v_mfma_f32_16x16x32_bf16 v[96:99], a[72:75], v[24:27], v[96:99]
    ds_read_b128 a[104:107], v14 offset:59392
    v_mfma_f32_16x16x32_bf16 v[104:107], a[72:75], v[28:31], v[104:107]
    v_exp_f32 v50, v66
    v_mfma_f32_16x16x32_bf16 v[100:103], a[76:79], v[24:27], v[100:103]
    ds_read_b128 a[108:111], v14 offset:60416
    v_add_f32 v8, v48, v49
    v_mfma_f32_16x16x32_bf16 v[108:111], a[76:79], v[28:31], v[108:111]
    s_waitcnt lgkmcnt(4)
    v_exp_f32 v51, v67
    v_mfma_f32_16x16x32_bf16 v[160:163], a[80:83], v[24:27], v[160:163]
    ds_read_b128 a[112:115], v14 offset:61440
    v_add_f32 v8, v8, v50
    v_mfma_f32_16x16x32_bf16 v[168:171], a[80:83], v[28:31], v[168:171]
    v_exp_f32 v56, v72
    v_mfma_f32_16x16x32_bf16 v[164:167], a[84:87], v[24:27], v[164:167]
    ds_read_b128 a[116:119], v14 offset:62464
    v_add_f32 v8, v8, v51
    v_mfma_f32_16x16x32_bf16 v[172:175], a[84:87], v[28:31], v[172:175]
    v_exp_f32 v57, v73
    v_mfma_f32_16x16x32_bf16 v[176:179], a[88:91], v[24:27], v[176:179]
    ds_read_b128 a[120:123], v14 offset:63488
    buffer_load_dwordx4 v0, s[64:67], s60 offen offset:0 sc1 lds
    v_mfma_f32_16x16x32_bf16 v[184:187], a[88:91], v[28:31], v[184:187]
    v_exp_f32 v58, v74
    v_mfma_f32_16x16x32_bf16 v[180:183], a[92:95], v[24:27], v[180:183]
    ds_read_b128 a[124:127], v14 offset:64512
    buffer_load_dwordx4 v0, s[64:67], s60 offen offset:1024 sc1 lds
    v_mfma_f32_16x16x32_bf16 v[188:191], a[92:95], v[28:31], v[188:191]
    s_waitcnt lgkmcnt(4)
    v_add_f32 v9, v56, v57
    v_mfma_f32_16x16x32_bf16 v[192:195], a[96:99], v[24:27], v[192:195]
    ds_read_b128 a[64:67], v16 offset:49152
    buffer_load_dwordx4 v0, s[64:67], s60 offen offset:2048 sc1 lds
    v_mfma_f32_16x16x32_bf16 v[200:203], a[96:99], v[28:31], v[200:203]
    v_exp_f32 v59, v75
    v_mfma_f32_16x16x32_bf16 v[196:199], a[100:103], v[24:27], v[196:199]
    ds_read_b128 a[68:71], v16 offset:50176
    v_add_f32 v9, v9, v58
    v_mfma_f32_16x16x32_bf16 v[204:207], a[100:103], v[28:31], v[204:207]
    v_exp_f32 v52, v68
    v_mfma_f32_16x16x32_bf16 v[208:211], a[104:107], v[24:27], v[208:211]
    ds_read_b128 a[72:75], v16 offset:51200
    v_add_f32 v9, v9, v59
    v_mfma_f32_16x16x32_bf16 v[216:219], a[104:107], v[28:31], v[216:219]
    v_exp_f32 v53, v69
    v_mfma_f32_16x16x32_bf16 v[212:215], a[108:111], v[24:27], v[212:215]
    ds_read_b128 a[76:79], v16 offset:52224
    v_add_f32 v8, v8, v52
    v_mfma_f32_16x16x32_bf16 v[220:223], a[108:111], v[28:31], v[220:223]
    s_waitcnt lgkmcnt(4)
    v_exp_f32 v54, v70
    v_mfma_f32_16x16x32_bf16 v[224:227], a[112:115], v[24:27], v[224:227]
    ds_read_b128 a[80:83], v16 offset:53248
    buffer_load_dwordx4 v0, s[64:67], s60 offen offset:3072 sc1 lds
    v_mfma_f32_16x16x32_bf16 v[232:235], a[112:115], v[28:31], v[232:235]
    v_add_f32 v8, v8, v53
    v_mfma_f32_16x16x32_bf16 v[228:231], a[116:119], v[24:27], v[228:231]
    s_cmp_eq_u32 s37, s38
    ds_read_b128 a[84:87], v16 offset:54272
    v_mfma_f32_16x16x32_bf16 v[236:239], a[116:119], v[28:31], v[236:239]
    s_cbranch_scc1 .Lmain_kernel_mask_79
.Lmain_kernel_maskr_80:
    v_mfma_f32_16x16x32_bf16 v[240:243], a[120:123], v[24:27], v[240:243]
    s_add_u32 s60, s60, 16384
    ds_read_b128 a[88:91], v16 offset:55296
    v_mfma_f32_16x16x32_bf16 v[248:251], a[120:123], v[28:31], v[248:251]
    v_exp_f32 v55, v71
    v_mfma_f32_16x16x32_bf16 v[244:247], a[124:127], v[24:27], v[244:247]
    ds_read_b128 a[92:95], v16 offset:56320
    v_add_f32 v8, v8, v54
    v_mfma_f32_16x16x32_bf16 v[252:255], a[124:127], v[28:31], v[252:255]
    s_waitcnt lgkmcnt(4)
    v_exp_f32 v60, v76
    v_mfma_f32_16x16x32_bf16 v[80:83], a[64:67], a[0:3], v[112:115]
    ds_read_b128 a[96:99], v16 offset:57344
    v_add_f32 v8, v8, v55
    v_mfma_f32_16x16x32_bf16 v[88:91], a[64:67], a[4:7], v[120:123]
    v_exp_f32 v61, v77
    v_mfma_f32_16x16x32_bf16 v[84:87], a[68:71], a[0:3], v[116:119]
    ds_read_b128 a[100:103], v16 offset:58368
    v_add_f32 v9, v9, v60
    v_mfma_f32_16x16x32_bf16 v[92:95], a[68:71], a[4:7], v[124:127]
    v_exp_f32 v62, v78
    v_mfma_f32_16x16x32_bf16 v[80:83], a[72:75], a[8:11], v[80:83]
    ds_read_b128 a[104:107], v16 offset:59392
    v_add_f32 v9, v9, v61
    v_mfma_f32_16x16x32_bf16 v[88:91], a[72:75], a[12:15], v[88:91]
    v_exp_f32 v63, v79
    v_mfma_f32_16x16x32_bf16 v[84:87], a[76:79], a[8:11], v[84:87]
    ds_read_b128 a[108:111], v16 offset:60416
    v_add_f32 v9, v9, v62
    v_mfma_f32_16x16x32_bf16 v[92:95], a[76:79], a[12:15], v[92:95]
    s_waitcnt lgkmcnt(4)
    v_add_f32 v9, v9, v63
    v_add_f32 v2, v8, v9
    v_mfma_f32_16x16x32_bf16 v[80:83], a[80:83], a[16:19], v[80:83]
    ds_read_b128 a[112:115], v16 offset:61440
    v_cmp_nge_f32 vcc, 1266679808, v2
    v_mfma_f32_16x16x32_bf16 v[88:91], a[80:83], a[20:23], v[88:91]
    v_mfma_f32_16x16x32_bf16 v[84:87], a[84:87], a[16:19], v[84:87]
    ds_read_b128 a[116:119], v16 offset:62464
    v_mfma_f32_16x16x32_bf16 v[92:95], a[84:87], a[20:23], v[92:95]
    s_cbranch_vccnz .Lmain_kernel_rare_67
.Lmain_kernel_rarer_81:
    v_mfma_f32_16x16x32_bf16 v[80:83], a[88:91], a[24:27], v[80:83]
    ds_read_b128 a[120:123], v16 offset:63488
    v_add_f32 v22, v22, v8
    v_mfma_f32_16x16x32_bf16 v[88:91], a[88:91], a[28:31], v[88:91]
    v_add_f32 v23, v23, v9
    v_mfma_f32_16x16x32_bf16 v[84:87], a[92:95], a[24:27], v[84:87]
    s_waitcnt vmcnt(12)
    s_waitcnt lgkmcnt(3)
    ds_read_b128 a[124:127], v16 offset:64512
    v_mfma_f32_16x16x32_bf16 v[92:95], a[92:95], a[28:31], v[92:95]
    s_barrier
    v_mfma_f32_16x16x32_bf16 v[80:83], a[96:99], a[32:35], v[80:83]
    s_add_u32 m0, s76, 98304
    ds_read_b128 a[64:67], v14 offset:0
    v_cvt_pk_bf16_f32 v24, v48, v49
    v_mfma_f32_16x16x32_bf16 v[88:91], a[96:99], a[36:39], v[88:91]
    v_cvt_pk_bf16_f32 v25, v50, v51
    v_mfma_f32_16x16x32_bf16 v[84:87], a[100:103], a[32:35], v[84:87]
    ds_read_b128 a[68:71], v14 offset:1024
    buffer_load_dwordx4 v0, s[16:19], s39 offen offset:0 sc1 lds
    v_mfma_f32_16x16x32_bf16 v[92:95], a[100:103], a[36:39], v[92:95]
    v_cvt_pk_bf16_f32 v26, v52, v53
    v_mfma_f32_16x16x32_bf16 v[80:83], a[104:107], a[40:43], v[80:83]
    ds_read_b128 a[72:75], v14 offset:2048
    v_mfma_f32_16x16x32_bf16 v[88:91], a[104:107], a[44:47], v[88:91]
    buffer_load_dwordx4 v0, s[16:19], s39 offen offset:1024 sc1 lds
    v_cvt_pk_bf16_f32 v27, v54, v55
    v_mfma_f32_16x16x32_bf16 v[84:87], a[108:111], a[40:43], v[84:87]
    ds_read_b128 a[76:79], v14 offset:3072
    v_mfma_f32_16x16x32_bf16 v[92:95], a[108:111], a[44:47], v[92:95]
    s_waitcnt lgkmcnt(4)
    v_cvt_pk_bf16_f32 v28, v56, v57
    v_mfma_f32_16x16x32_bf16 v[80:83], a[112:115], a[48:51], v[80:83]
    ds_read_b128 a[80:83], v14 offset:4096
    buffer_load_dwordx4 v0, s[16:19], s39 offen offset:2048 sc1 lds
    v_mfma_f32_16x16x32_bf16 v[88:91], a[112:115], a[52:55], v[88:91]
    v_cvt_pk_bf16_f32 v29, v58, v59
    v_mfma_f32_16x16x32_bf16 v[84:87], a[116:119], a[48:51], v[84:87]
    ds_read_b128 a[84:87], v14 offset:5120
    buffer_load_dwordx4 v0, s[16:19], s39 offen offset:3072 sc1 lds
    v_mfma_f32_16x16x32_bf16 v[92:95], a[116:119], a[52:55], v[92:95]
    v_cvt_pk_bf16_f32 v30, v60, v61
    v_mfma_f32_16x16x32_bf16 v[80:83], a[120:123], a[56:59], v[80:83]
    ds_read_b128 a[88:91], v14 offset:6144
    v_mfma_f32_16x16x32_bf16 v[88:91], a[120:123], a[60:63], v[88:91]
    s_add_u32 s39, s39, 16384
    v_cvt_pk_bf16_f32 v31, v62, v63
    v_mfma_f32_16x16x32_bf16 v[84:87], a[124:127], a[56:59], v[84:87]
    ds_read_b128 a[92:95], v14 offset:7168
    v_mfma_f32_16x16x32_bf16 v[92:95], a[124:127], a[60:63], v[92:95]
    s_waitcnt lgkmcnt(4)
    s_cmp_eq_u32 s37, 0
    s_cbranch_scc1 .Lmain_kernel_tail_42
.Lmain_kernel_it_46:
    v_mfma_f32_16x16x32_bf16 v[32:35], a[64:67], v[24:27], v[32:35]
    s_sub_u32 s37, s37, 1
    ds_read_b128 a[96:99], v14 offset:8192
    v_mfma_f32_16x16x32_bf16 v[40:43], a[64:67], v[28:31], v[40:43]
    v_exp_f32 v48, v80
    v_mfma_f32_16x16x32_bf16 v[36:39], a[68:71], v[24:27], v[36:39]
    s_add_u32 m0, s76, 49152
    ds_read_b128 a[100:103], v14 offset:9216
    v_mfma_f32_16x16x32_bf16 v[44:47], a[68:71], v[28:31], v[44:47]
    v_exp_f32 v49, v81
    v_mfma_f32_16x16x32_bf16 v[96:99], a[72:75], v[24:27], v[96:99]
    ds_read_b128 a[104:107], v14 offset:10240
    v_mfma_f32_16x16x32_bf16 v[104:107], a[72:75], v[28:31], v[104:107]
    v_exp_f32 v50, v82
    v_mfma_f32_16x16x32_bf16 v[100:103], a[76:79], v[24:27], v[100:103]
    ds_read_b128 a[108:111], v14 offset:11264
    v_add_f32 v8, v48, v49
    v_mfma_f32_16x16x32_bf16 v[108:111], a[76:79], v[28:31], v[108:111]
    s_waitcnt lgkmcnt(4)
    v_exp_f32 v51, v83
    v_mfma_f32_16x16x32_bf16 v[160:163], a[80:83], v[24:27], v[160:163]
    ds_read_b128 a[112:115], v14 offset:12288
    v_add_f32 v8, v8, v50
    v_mfma_f32_16x16x32_bf16 v[168:171], a[80:83], v[28:31], v[168:171]
    v_exp_f32 v56, v88
    v_mfma_f32_16x16x32_bf16 v[164:167], a[84:87], v[24:27], v[164:167]
    s_add_u32 s26, s26, 1
    ds_read_b128 a[116:119], v14 offset:13312
    v_add_f32 v8, v8, v51
    v_mfma_f32_16x16x32_bf16 v[172:175], a[84:87], v[28:31], v[172:175]
    v_exp_f32 v57, v89
    v_mfma_f32_16x16x32_bf16 v[176:179], a[88:91], v[24:27], v[176:179]
    ds_read_b128 a[120:123], v14 offset:14336
    buffer_load_dwordx4 v0, s[64:67], s60 offen offset:0 sc1 lds
    v_mfma_f32_16x16x32_bf16 v[184:187], a[88:91], v[28:31], v[184:187]
    v_exp_f32 v58, v90
    v_mfma_f32_16x16x32_bf16 v[180:183], a[92:95], v[24:27], v[180:183]
    ds_read_b128 a[124:127], v14 offset:15360
    buffer_load_dwordx4 v0, s[64:67], s60 offen offset:1024 sc1 lds
    v_mfma_f32_16x16x32_bf16 v[188:191], a[92:95], v[28:31], v[188:191]
    s_waitcnt lgkmcnt(4)
    v_add_f32 v9, v56, v57
    v_mfma_f32_16x16x32_bf16 v[192:195], a[96:99], v[24:27], v[192:195]
    ds_read_b128 a[64:67], v16 offset:0
    buffer_load_dwordx4 v0, s[64:67], s60 offen offset:2048 sc1 lds
    v_mfma_f32_16x16x32_bf16 v[200:203], a[96:99], v[28:31], v[200:203]
    v_exp_f32 v59, v91
    v_mfma_f32_16x16x32_bf16 v[196:199], a[100:103], v[24:27], v[196:199]
    ds_read_b128 a[68:71], v16 offset:1024
    v_add_f32 v9, v9, v58
    v_mfma_f32_16x16x32_bf16 v[204:207], a[100:103], v[28:31], v[204:207]
    v_exp_f32 v52, v84
    v_mfma_f32_16x16x32_bf16 v[208:211], a[104:107], v[24:27], v[208:211]
    ds_read_b128 a[72:75], v16 offset:2048
    v_add_f32 v9, v9, v59
    v_mfma_f32_16x16x32_bf16 v[216:219], a[104:107], v[28:31], v[216:219]
    v_exp_f32 v53, v85
    v_mfma_f32_16x16x32_bf16 v[212:215], a[108:111], v[24:27], v[212:215]
    ds_read_b128 a[76:79], v16 offset:3072
    v_add_f32 v8, v8, v52
    v_mfma_f32_16x16x32_bf16 v[220:223], a[108:111], v[28:31], v[220:223]
    s_waitcnt lgkmcnt(4)
    v_exp_f32 v54, v86
    v_mfma_f32_16x16x32_bf16 v[224:227], a[112:115], v[24:27], v[224:227]
    ds_read_b128 a[80:83], v16 offset:4096
    buffer_load_dwordx4 v0, s[64:67], s60 offen offset:3072 sc1 lds
    v_mfma_f32_16x16x32_bf16 v[232:235], a[112:115], v[28:31], v[232:235]
    v_add_f32 v8, v8, v53
    v_mfma_f32_16x16x32_bf16 v[228:231], a[116:119], v[24:27], v[228:231]
    s_cmp_eq_u32 s37, s38
    ds_read_b128 a[84:87], v16 offset:5120
    v_mfma_f32_16x16x32_bf16 v[236:239], a[116:119], v[28:31], v[236:239]
    s_cbranch_scc1 .Lmain_kernel_mask_83
.Lmain_kernel_maskr_84:
    v_mfma_f32_16x16x32_bf16 v[240:243], a[120:123], v[24:27], v[240:243]
    s_add_u32 s60, s60, 16384
    ds_read_b128 a[88:91], v16 offset:6144
    v_mfma_f32_16x16x32_bf16 v[248:251], a[120:123], v[28:31], v[248:251]
    v_exp_f32 v55, v87
    v_mfma_f32_16x16x32_bf16 v[244:247], a[124:127], v[24:27], v[244:247]
    ds_read_b128 a[92:95], v16 offset:7168
    v_add_f32 v8, v8, v54
    v_mfma_f32_16x16x32_bf16 v[252:255], a[124:127], v[28:31], v[252:255]
    s_waitcnt lgkmcnt(4)
    v_exp_f32 v60, v92
    v_mfma_f32_16x16x32_bf16 v[64:67], a[64:67], a[0:3], v[112:115]
    ds_read_b128 a[96:99], v16 offset:8192
    v_add_f32 v8, v8, v55
    v_mfma_f32_16x16x32_bf16 v[72:75], a[64:67], a[4:7], v[120:123]
    v_exp_f32 v61, v93
    v_mfma_f32_16x16x32_bf16 v[68:71], a[68:71], a[0:3], v[116:119]
    ds_read_b128 a[100:103], v16 offset:9216
    v_add_f32 v9, v9, v60
    v_mfma_f32_16x16x32_bf16 v[76:79], a[68:71], a[4:7], v[124:127]
    v_exp_f32 v62, v94
    v_mfma_f32_16x16x32_bf16 v[64:67], a[72:75], a[8:11], v[64:67]
    ds_read_b128 a[104:107], v16 offset:10240
    v_add_f32 v9, v9, v61
    v_mfma_f32_16x16x32_bf16 v[72:75], a[72:75], a[12:15], v[72:75]
    v_exp_f32 v63, v95
    v_mfma_f32_16x16x32_bf16 v[68:71], a[76:79], a[8:11], v[68:71]
    ds_read_b128 a[108:111], v16 offset:11264
    v_add_f32 v9, v9, v62
    v_mfma_f32_16x16x32_bf16 v[76:79], a[76:79], a[12:15], v[76:79]
    s_waitcnt lgkmcnt(4)
    v_add_f32 v9, v9, v63
    v_add_f32 v2, v8, v9
    v_mfma_f32_16x16x32_bf16 v[64:67], a[80:83], a[16:19], v[64:67]
    ds_read_b128 a[112:115], v16 offset:12288
    v_cmp_nge_f32 vcc, 1266679808, v2
    v_mfma_f32_16x16x32_bf16 v[72:75], a[80:83], a[20:23], v[72:75]
    v_and_b32 v131, 0xf0, v14
    v_mfma_f32_16x16x32_bf16 v[68:71], a[84:87], a[16:19], v[68:71]
    ds_read_b128 a[116:119], v16 offset:13312
    v_mfma_f32_16x16x32_bf16 v[76:79], a[84:87], a[20:23], v[76:79]
    s_cbranch_vccnz .Lmain_kernel_rare_54
.Lmain_kernel_rarer_85:
    v_mfma_f32_16x16x32_bf16 v[64:67], a[88:91], a[24:27], v[64:67]
    ds_read_b128 a[120:123], v16 offset:14336
    v_add_f32 v22, v22, v8
    v_mfma_f32_16x16x32_bf16 v[72:75], a[88:91], a[28:31], v[72:75]
    v_add_f32 v23, v23, v9
    v_lshlrev_b32 v131, 10, v131
    v_mfma_f32_16x16x32_bf16 v[68:71], a[92:95], a[24:27], v[68:71]
    s_waitcnt vmcnt(12)
    s_waitcnt lgkmcnt(3)
    ds_read_b128 a[124:127], v16 offset:15360
    v_mfma_f32_16x16x32_bf16 v[76:79], a[92:95], a[28:31], v[76:79]
    s_barrier
    v_mfma_f32_16x16x32_bf16 v[64:67], a[96:99], a[32:35], v[64:67]
    s_add_u32 m0, s76, 114688
    ds_read_b128 a[64:67], v14 offset:16384
    v_cvt_pk_bf16_f32 v24, v48, v49
    v_mfma_f32_16x16x32_bf16 v[72:75], a[96:99], a[36:39], v[72:75]
    buffer_load_dwordx4 v0, s[16:19], s39 offen offset:0 sc1 lds
    v_cvt_pk_bf16_f32 v25, v50, v51
    v_mfma_f32_16x16x32_bf16 v[68:71], a[100:103], a[32:35], v[68:71]
    ds_read_b128 a[68:71], v14 offset:17408
    v_mfma_f32_16x16x32_bf16 v[76:79], a[100:103], a[36:39], v[76:79]
    buffer_load_dwordx4 v0, s[16:19], s39 offen offset:1024 sc1 lds
    v_cvt_pk_bf16_f32 v26, v52, v53
    v_mfma_f32_16x16x32_bf16 v[64:67], a[104:107], a[40:43], v[64:67]
    ds_read_b128 a[72:75], v14 offset:18432
    buffer_load_dwordx4 v0, s[16:19], s39 offen offset:2048 sc1 lds
    v_mfma_f32_16x16x32_bf16 v[72:75], a[104:107], a[44:47], v[72:75]
    buffer_load_dword v131, v131, s[16:19], s35 offen sc1
    v_cvt_pk_bf16_f32 v27, v54, v55
    v_mfma_f32_16x16x32_bf16 v[68:71], a[108:111], a[40:43], v[68:71]
    ds_read_b128 a[76:79], v14 offset:19456
    buffer_load_dwordx4 v0, s[16:19], s39 offen offset:3072 sc1 lds
    v_mfma_f32_16x16x32_bf16 v[76:79], a[108:111], a[44:47], v[76:79]
    s_waitcnt lgkmcnt(4)
    v_cvt_pk_bf16_f32 v28, v56, v57
    v_mfma_f32_16x16x32_bf16 v[64:67], a[112:115], a[48:51], v[64:67]
    s_add_u32 s39, s39, 16384
    ds_read_b128 a[80:83], v14 offset:20480
    v_mfma_f32_16x16x32_bf16 v[72:75], a[112:115], a[52:55], v[72:75]
    s_cmp_eq_u32 s39, s61
    s_cselect_b32 s39, s62, s39
    s_cselect_b32 s61, s5, s61
    v_mfma_f32_16x16x32_bf16 v[68:71], a[116:119], a[48:51], v[68:71]
    s_cselect_b32 s62, 1073741824, s62
    ds_read_b128 a[84:87], v14 offset:21504
    v_cvt_pk_bf16_f32 v29, v58, v59
    v_mfma_f32_16x16x32_bf16 v[76:79], a[116:119], a[52:55], v[76:79]
    v_cvt_pk_bf16_f32 v30, v60, v61
    v_mfma_f32_16x16x32_bf16 v[64:67], a[120:123], a[56:59], v[64:67]
    ds_read_b128 a[88:91], v14 offset:22528
    v_mfma_f32_16x16x32_bf16 v[72:75], a[120:123], a[60:63], v[72:75]
    v_cvt_pk_bf16_f32 v31, v62, v63
    v_mfma_f32_16x16x32_bf16 v[68:71], a[124:127], a[56:59], v[68:71]
    ds_read_b128 a[92:95], v14 offset:23552
    v_mfma_f32_16x16x32_bf16 v[76:79], a[124:127], a[60:63], v[76:79]
    s_waitcnt lgkmcnt(4)
    v_mfma_f32_16x16x32_bf16 v[32:35], a[64:67], v[24:27], v[32:35]
    ds_read_b128 a[96:99], v14 offset:24576
    v_mfma_f32_16x16x32_bf16 v[40:43], a[64:67], v[28:31], v[40:43]
    v_exp_f32 v48, v64
    v_mfma_f32_16x16x32_bf16 v[36:39], a[68:71], v[24:27], v[36:39]
    s_add_u32 m0, s76, 0
    ds_read_b128 a[100:103], v14 offset:25600
    v_mfma_f32_16x16x32_bf16 v[44:47], a[68:71], v[28:31], v[44:47]
    v_exp_f32 v49, v65
    v_mfma_f32_16x16x32_bf16 v[96:99], a[72:75], v[24:27], v[96:99]
    ds_read_b128 a[104:107], v14 offset:26624
    v_mfma_f32_16x16x32_bf16 v[104:107], a[72:75], v[28:31], v[104:107]
    v_exp_f32 v50, v66
    v_mfma_f32_16x16x32_bf16 v[100:103], a[76:79], v[24:27], v[100:103]
    ds_read_b128 a[108:111], v14 offset:27648
    v_add_f32 v8, v48, v49
    v_mfma_f32_16x16x32_bf16 v[108:111], a[76:79], v[28:31], v[108:111]
    s_waitcnt lgkmcnt(4)
    v_exp_f32 v51, v67
    v_mfma_f32_16x16x32_bf16 v[160:163], a[80:83], v[24:27], v[160:163]
    ds_read_b128 a[112:115], v14 offset:28672
    v_add_f32 v8, v8, v50
    v_mfma_f32_16x16x32_bf16 v[168:171], a[80:83], v[28:31], v[168:171]
    v_exp_f32 v56, v72
    v_mfma_f32_16x16x32_bf16 v[164:167], a[84:87], v[24:27], v[164:167]
    ds_read_b128 a[116:119], v14 offset:29696
    v_add_f32 v8, v8, v51
    v_mfma_f32_16x16x32_bf16 v[172:175], a[84:87], v[28:31], v[172:175]
    v_exp_f32 v57, v73
    v_mfma_f32_16x16x32_bf16 v[176:179], a[88:91], v[24:27], v[176:179]
    ds_read_b128 a[120:123], v14 offset:30720
    buffer_load_dwordx4 v0, s[64:67], s60 offen offset:0 sc1 lds
    v_mfma_f32_16x16x32_bf16 v[184:187], a[88:91], v[28:31], v[184:187]
    v_exp_f32 v58, v74
    v_mfma_f32_16x16x32_bf16 v[180:183], a[92:95], v[24:27], v[180:183]
    ds_read_b128 a[124:127], v14 offset:31744
    buffer_load_dwordx4 v0, s[64:67], s60 offen offset:1024 sc1 lds
    v_mfma_f32_16x16x32_bf16 v[188:191], a[92:95], v[28:31], v[188:191]
    s_waitcnt lgkmcnt(4)
    v_add_f32 v9, v56, v57
    v_mfma_f32_16x16x32_bf16 v[192:195], a[96:99], v[24:27], v[192:195]
    ds_read_b128 a[64:67], v16 offset:16384
    buffer_load_dwordx4 v0, s[64:67], s60 offen offset:2048 sc1 lds
    v_mfma_f32_16x16x32_bf16 v[200:203], a[96:99], v[28:31], v[200:203]
    v_exp_f32 v59, v75
    v_mfma_f32_16x16x32_bf16 v[196:199], a[100:103], v[24:27], v[196:199]
    ds_read_b128 a[68:71], v16 offset:17408
    v_add_f32 v9, v9, v58
    v_mfma_f32_16x16x32_bf16 v[204:207], a[100:103], v[28:31], v[204:207]
    v_exp_f32 v52, v68
    v_mfma_f32_16x16x32_bf16 v[208:211], a[104:107], v[24:27], v[208:211]
    ds_read_b128 a[72:75], v16 offset:18432
    v_add_f32 v9, v9, v59
    v_mfma_f32_16x16x32_bf16 v[216:219], a[104:107], v[28:31], v[216:219]
    v_exp_f32 v53, v69
    v_mfma_f32_16x16x32_bf16 v[212:215], a[108:111], v[24:27], v[212:215]
    ds_read_b128 a[76:79], v16 offset:19456
    v_add_f32 v8, v8, v52
    v_mfma_f32_16x16x32_bf16 v[220:223], a[108:111], v[28:31], v[220:223]
    s_waitcnt lgkmcnt(4)
    v_exp_f32 v54, v70
    v_mfma_f32_16x16x32_bf16 v[224:227], a[112:115], v[24:27], v[224:227]
    ds_read_b128 a[80:83], v16 offset:20480
    buffer_load_dwordx4 v0, s[64:67], s60 offen offset:3072 sc1 lds
    v_mfma_f32_16x16x32_bf16 v[232:235], a[112:115], v[28:31], v[232:235]
    v_add_f32 v8, v8, v53
    v_mfma_f32_16x16x32_bf16 v[228:231], a[116:119], v[24:27], v[228:231]
    s_cmp_eq_u32 s37, s38
    ds_read_b128 a[84:87], v16 offset:21504
    v_mfma_f32_16x16x32_bf16 v[236:239], a[116:119], v[28:31], v[236:239]
    s_cbranch_scc1 .Lmain_kernel_mask_86
.Lmain_kernel_maskr_87:
    v_mfma_f32_16x16x32_bf16 v[240:243], a[120:123], v[24:27], v[240:243]
    s_add_u32 s60, s60, 16384
    ds_read_b128 a[88:91], v16 offset:22528
    v_mfma_f32_16x16x32_bf16 v[248:251], a[120:123], v[28:31], v[248:251]
    v_exp_f32 v55, v71
    v_mfma_f32_16x16x32_bf16 v[244:247], a[124:127], v[24:27], v[244:247]
    ds_read_b128 a[92:95], v16 offset:23552
    v_add_f32 v8, v8, v54
    v_mfma_f32_16x16x32_bf16 v[252:255], a[124:127], v[28:31], v[252:255]
    s_waitcnt lgkmcnt(4)
    v_exp_f32 v60, v76
    v_mfma_f32_16x16x32_bf16 v[80:83], a[64:67], a[0:3], v[112:115]
    ds_read_b128 a[96:99], v16 offset:24576
    v_add_f32 v8, v8, v55
    v_mfma_f32_16x16x32_bf16 v[88:91], a[64:67], a[4:7], v[120:123]
    v_exp_f32 v61, v77
    v_mfma_f32_16x16x32_bf16 v[84:87], a[68:71], a[0:3], v[116:119]
    ds_read_b128 a[100:103], v16 offset:25600
    v_add_f32 v9, v9, v60
    v_mfma_f32_16x16x32_bf16 v[92:95], a[68:71], a[4:7], v[124:127]
    v_exp_f32 v62, v78
    v_mfma_f32_16x16x32_bf16 v[80:83], a[72:75], a[8:11], v[80:83]
    ds_read_b128 a[104:107], v16 offset:26624
    v_add_f32 v9, v9, v61
    v_mfma_f32_16x16x32_bf16 v[88:91], a[72:75], a[12:15], v[88:91]
    v_exp_f32 v63, v79
    v_mfma_f32_16x16x32_bf16 v[84:87], a[76:79], a[8:11], v[84:87]
    ds_read_b128 a[108:111], v16 offset:27648
    v_add_f32 v9, v9, v62
    v_mfma_f32_16x16x32_bf16 v[92:95], a[76:79], a[12:15], v[92:95]
    s_waitcnt lgkmcnt(4)
    v_add_f32 v9, v9, v63
    v_add_f32 v2, v8, v9
    v_mfma_f32_16x16x32_bf16 v[80:83], a[80:83], a[16:19], v[80:83]
    ds_read_b128 a[112:115], v16 offset:28672
    v_cmp_nge_f32 vcc, 1266679808, v2
    v_mfma_f32_16x16x32_bf16 v[88:91], a[80:83], a[20:23], v[88:91]
    v_mfma_f32_16x16x32_bf16 v[84:87], a[84:87], a[16:19], v[84:87]
    ds_read_b128 a[116:119], v16 offset:29696
    v_mfma_f32_16x16x32_bf16 v[92:95], a[84:87], a[20:23], v[92:95]
    s_cbranch_vccnz .Lmain_kernel_rare_59
.Lmain_kernel_rarer_88:
    v_mfma_f32_16x16x32_bf16 v[80:83], a[88:91], a[24:27], v[80:83]
    ds_read_b128 a[120:123], v16 offset:30720
    v_add_f32 v22, v22, v8
    v_mfma_f32_16x16x32_bf16 v[88:91], a[88:91], a[28:31], v[88:91]
    v_add_f32 v23, v23, v9
    v_mfma_f32_16x16x32_bf16 v[84:87], a[92:95], a[24:27], v[84:87]
    s_waitcnt vmcnt(13)
    s_waitcnt lgkmcnt(3)
    ds_read_b128 a[124:127], v16 offset:31744
    v_mfma_f32_16x16x32_bf16 v[92:95], a[92:95], a[28:31], v[92:95]
    s_barrier
    v_mfma_f32_16x16x32_bf16 v[80:83], a[96:99], a[32:35], v[80:83]
    s_add_u32 m0, s76, 65536
    ds_read_b128 a[64:67], v14 offset:32768
    v_cvt_pk_bf16_f32 v24, v48, v49
    v_mfma_f32_16x16x32_bf16 v[88:91], a[96:99], a[36:39], v[88:91]
    v_cvt_pk_bf16_f32 v25, v50, v51
    v_mfma_f32_16x16x32_bf16 v[84:87], a[100:103], a[32:35], v[84:87]
    ds_read_b128 a[68:71], v14 offset:33792
    buffer_load_dwordx4 v0, s[16:19], s39 offen offset:0 sc1 lds
    v_mfma_f32_16x16x32_bf16 v[92:95], a[100:103], a[36:39], v[92:95]
    v_cvt_pk_bf16_f32 v26, v52, v53
    v_mfma_f32_16x16x32_bf16 v[80:83], a[104:107], a[40:43], v[80:83]
    ds_read_b128 a[72:75], v14 offset:34816
    v_mfma_f32_16x16x32_bf16 v[88:91], a[104:107], a[44:47], v[88:91]
    buffer_load_dwordx4 v0, s[16:19], s39 offen offset:1024 sc1 lds
    v_cvt_pk_bf16_f32 v27, v54, v55
    v_mfma_f32_16x16x32_bf16 v[84:87], a[108:111], a[40:43], v[84:87]
    ds_read_b128 a[76:79], v14 offset:35840
    v_mfma_f32_16x16x32_bf16 v[92:95], a[108:111], a[44:47], v[92:95]
    s_waitcnt lgkmcnt(4)
    v_cvt_pk_bf16_f32 v28, v56, v57
    v_mfma_f32_16x16x32_bf16 v[80:83], a[112:115], a[48:51], v[80:83]
    ds_read_b128 a[80:83], v14 offset:36864
    buffer_load_dwordx4 v0, s[16:19], s39 offen offset:2048 sc1 lds
    v_mfma_f32_16x16x32_bf16 v[88:91], a[112:115], a[52:55], v[88:91]
    v_cvt_pk_bf16_f32 v29, v58, v59
    v_mfma_f32_16x16x32_bf16 v[84:87], a[116:119], a[48:51], v[84:87]
    ds_read_b128 a[84:87], v14 offset:37888
    buffer_load_dwordx4 v0, s[16:19], s39 offen offset:3072 sc1 lds
    v_mfma_f32_16x16x32_bf16 v[92:95], a[116:119], a[52:55], v[92:95]
    v_cvt_pk_bf16_f32 v30, v60, v61
    v_mfma_f32_16x16x32_bf16 v[80:83], a[120:123], a[56:59], v[80:83]
    ds_read_b128 a[88:91], v14 offset:38912
    v_mfma_f32_16x16x32_bf16 v[88:91], a[120:123], a[60:63], v[88:91]
    s_add_u32 s39, s39, 16384
    v_cvt_pk_bf16_f32 v31, v62, v63
    v_mfma_f32_16x16x32_bf16 v[84:87], a[124:127], a[56:59], v[84:87]
    ds_read_b128 a[92:95], v14 offset:39936
    v_mfma_f32_16x16x32_bf16 v[92:95], a[124:127], a[60:63], v[92:95]
    s_waitcnt lgkmcnt(4)
    v_mfma_f32_16x16x32_bf16 v[32:35], a[64:67], v[24:27], v[32:35]
    ds_read_b128 a[96:99], v14 offset:40960
    v_mfma_f32_16x16x32_bf16 v[40:43], a[64:67], v[28:31], v[40:43]
    v_exp_f32 v48, v80
    v_mfma_f32_16x16x32_bf16 v[36:39], a[68:71], v[24:27], v[36:39]
    s_add_u32 m0, s76, 16384
    ds_read_b128 a[100:103], v14 offset:41984
    s_waitcnt vmcnt(9)
    v_and_b32 v131, 1, v131
    v_cmp_ne_u32 vcc, 1, v131
    v_mfma_f32_16x16x32_bf16 v[44:47], a[68:71], v[28:31], v[44:47]
    v_exp_f32 v49, v81
    v_mfma_f32_16x16x32_bf16 v[96:99], a[72:75], v[24:27], v[96:99]
    ds_read_b128 a[104:107], v14 offset:43008
    buffer_load_dwordx4 v0, s[64:67], s60 offen offset:0 sc1 lds
    s_cbranch_vccnz .Lmain_kernel_spin_93
.Lmain_kernel_pok_92:
    v_mfma_f32_16x16x32_bf16 v[104:107], a[72:75], v[28:31], v[104:107]
    v_exp_f32 v50, v82
    v_mfma_f32_16x16x32_bf16 v[100:103], a[76:79], v[24:27], v[100:103]
    ds_read_b128 a[108:111], v14 offset:44032
    v_add_f32 v8, v48, v49
    v_mfma_f32_16x16x32_bf16 v[108:111], a[76:79], v[28:31], v[108:111]
    s_waitcnt lgkmcnt(4)
    v_exp_f32 v51, v83
    v_mfma_f32_16x16x32_bf16 v[160:163], a[80:83], v[24:27], v[160:163]
    ds_read_b128 a[112:115], v14 offset:45056
    v_add_f32 v8, v8, v50
    v_mfma_f32_16x16x32_bf16 v[168:171], a[80:83], v[28:31], v[168:171]
    v_exp_f32 v56, v88
    v_mfma_f32_16x16x32_bf16 v[164:167], a[84:87], v[24:27], v[164:167]
    ds_read_b128 a[116:119], v14 offset:46080
    v_add_f32 v8, v8, v51
    v_mfma_f32_16x16x32_bf16 v[172:175], a[84:87], v[28:31], v[172:175]
    v_exp_f32 v57, v89
    v_mfma_f32_16x16x32_bf16 v[176:179], a[88:91], v[24:27], v[176:179]
    ds_read_b128 a[120:123], v14 offset:47104
    buffer_load_dwordx4 v0, s[64:67], s60 offen offset:1024 sc1 lds
    v_mfma_f32_16x16x32_bf16 v[184:187], a[88:91], v[28:31], v[184:187]
    v_exp_f32 v58, v90
    v_mfma_f32_16x16x32_bf16 v[180:183], a[92:95], v[24:27], v[180:183]
    ds_read_b128 a[124:127], v14 offset:48128
    buffer_load_dwordx4 v0, s[64:67], s60 offen offset:2048 sc1 lds
    v_mfma_f32_16x16x32_bf16 v[188:191], a[92:95], v[28:31], v[188:191]
    s_waitcnt lgkmcnt(4)
    buffer_load_dwordx4 v0, s[64:67], s60 offen offset:3072 sc1 lds
    v_add_f32 v9, v56, v57
    v_mfma_f32_16x16x32_bf16 v[192:195], a[96:99], v[24:27], v[192:195]
    s_add_u32 s60, s60, 16384
    ds_read_b128 a[64:67], v16 offset:32768
    v_mfma_f32_16x16x32_bf16 v[200:203], a[96:99], v[28:31], v[200:203]
    v_exp_f32 v59, v91
    v_mfma_f32_16x16x32_bf16 v[196:199], a[100:103], v[24:27], v[196:199]
    ds_read_b128 a[68:71], v16 offset:33792
    v_add_f32 v9, v9, v58
    v_mfma_f32_16x16x32_bf16 v[204:207], a[100:103], v[28:31], v[204:207]
    s_cmp_eq_u32 s60, s63
    v_exp_f32 v52, v84
    v_mfma_f32_16x16x32_bf16 v[208:211], a[104:107], v[24:27], v[208:211]
    s_cselect_b32 s60, s4, s60
    ds_read_b128 a[72:75], v16 offset:34816
    v_add_f32 v9, v9, v59
    v_mfma_f32_16x16x32_bf16 v[216:219], a[104:107], v[28:31], v[216:219]
    s_cselect_b32 s63, s5, s63
    v_exp_f32 v53, v85
    v_mfma_f32_16x16x32_bf16 v[212:215], a[108:111], v[24:27], v[212:215]
    s_cselect_b32 s4, 1073741824, s4
    ds_read_b128 a[76:79], v16 offset:35840
    v_add_f32 v8, v8, v52
    v_mfma_f32_16x16x32_bf16 v[220:223], a[108:111], v[28:31], v[220:223]
    s_waitcnt lgkmcnt(4)
    v_exp_f32 v54, v86
    v_mfma_f32_16x16x32_bf16 v[224:227], a[112:115], v[24:27], v[224:227]
    ds_read_b128 a[80:83], v16 offset:36864
    v_mfma_f32_16x16x32_bf16 v[232:235], a[112:115], v[28:31], v[232:235]
    v_add_f32 v8, v8, v53
    v_mfma_f32_16x16x32_bf16 v[228:231], a[116:119], v[24:27], v[228:231]
    s_cmp_eq_u32 s37, s38
    ds_read_b128 a[84:87], v16 offset:37888
    buffer_load_dwordx4 a[192:195], v14, s[16:19], s28 offen offset:0 sc1
    v_mfma_f32_16x16x32_bf16 v[236:239], a[116:119], v[28:31], v[236:239]
    s_cbranch_scc1 .Lmain_kernel_mask_89
.Lmain_kernel_maskr_90:
    v_mfma_f32_16x16x32_bf16 v[240:243], a[120:123], v[24:27], v[240:243]
    ds_read_b128 a[88:91], v16 offset:38912
    v_mfma_f32_16x16x32_bf16 v[248:251], a[120:123], v[28:31], v[248:251]
    v_exp_f32 v55, v87
    v_mfma_f32_16x16x32_bf16 v[244:247], a[124:127], v[24:27], v[244:247]
    ds_read_b128 a[92:95], v16 offset:39936
    v_add_f32 v8, v8, v54
    v_mfma_f32_16x16x32_bf16 v[252:255], a[124:127], v[28:31], v[252:255]
    s_waitcnt lgkmcnt(4)
    v_exp_f32 v60, v92
    v_mfma_f32_16x16x32_bf16 v[64:67], a[64:67], a[0:3], v[112:115]
    ds_read_b128 a[96:99], v16 offset:40960
    v_add_f32 v8, v8, v55
    v_mfma_f32_16x16x32_bf16 v[72:75], a[64:67], a[4:7], v[120:123]
    v_exp_f32 v61, v93
    v_mfma_f32_16x16x32_bf16 v[68:71], a[68:71], a[0:3], v[116:119]
    ds_read_b128 a[100:103], v16 offset:41984
    v_add_f32 v9, v9, v60
    v_mfma_f32_16x16x32_bf16 v[76:79], a[68:71], a[4:7], v[124:127]
    v_exp_f32 v62, v94
    v_mfma_f32_16x16x32_bf16 v[64:67], a[72:75], a[8:11], v[64:67]
    ds_read_b128 a[104:107], v16 offset:43008
    v_add_f32 v9, v9, v61
    v_mfma_f32_16x16x32_bf16 v[72:75], a[72:75], a[12:15], v[72:75]
    v_exp_f32 v63, v95
    v_mfma_f32_16x16x32_bf16 v[68:71], a[76:79], a[8:11], v[68:71]
    ds_read_b128 a[108:111], v16 offset:44032
    v_add_f32 v9, v9, v62
    v_mfma_f32_16x16x32_bf16 v[76:79], a[76:79], a[12:15], v[76:79]
    s_waitcnt lgkmcnt(4)
    v_add_f32 v9, v9, v63
    v_add_f32 v2, v8, v9
    v_mfma_f32_16x16x32_bf16 v[64:67], a[80:83], a[16:19], v[64:67]
    ds_read_b128 a[112:115], v16 offset:45056
    v_cmp_nge_f32 vcc, 1266679808, v2
    v_mfma_f32_16x16x32_bf16 v[72:75], a[80:83], a[20:23], v[72:75]
    v_mfma_f32_16x16x32_bf16 v[68:71], a[84:87], a[16:19], v[68:71]
    ds_read_b128 a[116:119], v16 offset:46080
    v_mfma_f32_16x16x32_bf16 v[76:79], a[84:87], a[20:23], v[76:79]
    s_cbranch_vccnz .Lmain_kernel_rare_63
.Lmain_kernel_rarer_91:
    v_mfma_f32_16x16x32_bf16 v[64:67], a[88:91], a[24:27], v[64:67]
    ds_read_b128 a[120:123], v16 offset:47104
    v_add_f32 v22, v22, v8
    v_mfma_f32_16x16x32_bf16 v[72:75], a[88:91], a[28:31], v[72:75]
    buffer_load_dwordx4 a[196:199], v14, s[16:19], s28 offen offset:1024 sc1
    v_add_f32 v23, v23, v9
    v_mfma_f32_16x16x32_bf16 v[68:71], a[92:95], a[24:27], v[68:71]
    s_waitcnt vmcnt(14)
    s_waitcnt lgkmcnt(3)
    ds_read_b128 a[124:127], v16 offset:48128
    v_mfma_f32_16x16x32_bf16 v[76:79], a[92:95], a[28:31], v[76:79]
    s_barrier
    v_mfma_f32_16x16x32_bf16 v[64:67], a[96:99], a[32:35], v[64:67]
    s_add_u32 m0, s76, 81920
    ds_read_b128 a[64:67], v14 offset:49152
    v_cvt_pk_bf16_f32 v24, v48, v49
    v_mfma_f32_16x16x32_bf16 v[72:75], a[96:99], a[36:39], v[72:75]
    v_cvt_pk_bf16_f32 v25, v50, v51
    v_mfma_f32_16x16x32_bf16 v[68:71], a[100:103], a[32:35], v[68:71]
    ds_read_b128 a[68:71], v14 offset:50176
    buffer_load_dwordx4 v0, s[16:19], s39 offen offset:0 sc1 lds
    v_mfma_f32_16x16x32_bf16 v[76:79], a[100:103], a[36:39], v[76:79]
    v_cvt_pk_bf16_f32 v26, v52, v53
    v_mfma_f32_16x16x32_bf16 v[64:67], a[104:107], a[40:43], v[64:67]
    ds_read_b128 a[72:75], v14 offset:51200
    v_mfma_f32_16x16x32_bf16 v[72:75], a[104:107], a[44:47], v[72:75]
    buffer_load_dwordx4 v0, s[16:19], s39 offen offset:1024 sc1 lds
    v_cvt_pk_bf16_f32 v27, v54, v55
    v_mfma_f32_16x16x32_bf16 v[68:71], a[108:111], a[40:43], v[68:71]
    ds_read_b128 a[76:79], v14 offset:52224
    v_mfma_f32_16x16x32_bf16 v[76:79], a[108:111], a[44:47], v[76:79]
    s_waitcnt lgkmcnt(4)
    v_cvt_pk_bf16_f32 v28, v56, v57
    v_mfma_f32_16x16x32_bf16 v[64:67], a[112:115], a[48:51], v[64:67]
    ds_read_b128 a[80:83], v14 offset:53248
    buffer_load_dwordx4 v0, s[16:19], s39 offen offset:2048 sc1 lds
    v_mfma_f32_16x16x32_bf16 v[72:75], a[112:115], a[52:55], v[72:75]
    v_cvt_pk_bf16_f32 v29, v58, v59
    v_mfma_f32_16x16x32_bf16 v[68:71], a[116:119], a[48:51], v[68:71]
    ds_read_b128 a[84:87], v14 offset:54272
    buffer_load_dwordx4 v0, s[16:19], s39 offen offset:3072 sc1 lds
    v_mfma_f32_16x16x32_bf16 v[76:79], a[116:119], a[52:55], v[76:79]
    v_cvt_pk_bf16_f32 v30, v60, v61
    v_mfma_f32_16x16x32_bf16 v[64:67], a[120:123], a[56:59], v[64:67]
    ds_read_b128 a[88:91], v14 offset:55296
    v_mfma_f32_16x16x32_bf16 v[72:75], a[120:123], a[60:63], v[72:75]
    s_add_u32 s39, s39, 16384
    v_cvt_pk_bf16_f32 v31, v62, v63
    v_mfma_f32_16x16x32_bf16 v[68:71], a[124:127], a[56:59], v[68:71]
    ds_read_b128 a[92:95], v14 offset:56320
    v_mfma_f32_16x16x32_bf16 v[76:79], a[124:127], a[60:63], v[76:79]
    s_waitcnt lgkmcnt(4)
    v_mfma_f32_16x16x32_bf16 v[32:35], a[64:67], v[24:27], v[32:35]
    ds_read_b128 a[96:99], v14 offset:57344
    v_mfma_f32_16x16x32_bf16 v[40:43], a[64:67], v[28:31], v[40:43]
    v_exp_f32 v48, v64
    v_mfma_f32_16x16x32_bf16 v[36:39], a[68:71], v[24:27], v[36:39]
    s_add_u32 m0, s76, 32768
    ds_read_b128 a[100:103], v14 offset:58368
    buffer_load_dwordx4 a[200:203], v134, s[16:19], s28 offen offset:2048 sc1
    v_mfma_f32_16x16x32_bf16 v[44:47], a[68:71], v[28:31], v[44:47]
    v_exp_f32 v49, v65
    v_mfma_f32_16x16x32_bf16 v[96:99], a[72:75], v[24:27], v[96:99]
    ds_read_b128 a[104:107], v14 offset:59392
    v_mfma_f32_16x16x32_bf16 v[104:107], a[72:75], v[28:31], v[104:107]
    v_exp_f32 v50, v66
    v_mfma_f32_16x16x32_bf16 v[100:103], a[76:79], v[24:27], v[100:103]
    ds_read_b128 a[108:111], v14 offset:60416
    v_add_f32 v8, v48, v49
    v_mfma_f32_16x16x32_bf16 v[108:111], a[76:79], v[28:31], v[108:111]
    s_waitcnt lgkmcnt(4)
    v_exp_f32 v51, v67
    v_mfma_f32_16x16x32_bf16 v[160:163], a[80:83], v[24:27], v[160:163]
    ds_read_b128 a[112:115], v14 offset:61440
    v_add_f32 v8, v8, v50
    v_mfma_f32_16x16x32_bf16 v[168:171], a[80:83], v[28:31], v[168:171]
    v_exp_f32 v56, v72
    v_mfma_f32_16x16x32_bf16 v[164:167], a[84:87], v[24:27], v[164:167]
    ds_read_b128 a[116:119], v14 offset:62464
    v_add_f32 v8, v8, v51
    v_mfma_f32_16x16x32_bf16 v[172:175], a[84:87], v[28:31], v[172:175]
    v_exp_f32 v57, v73
    v_mfma_f32_16x16x32_bf16 v[176:179], a[88:91], v[24:27], v[176:179]
    ds_read_b128 a[120:123], v14 offset:63488
    buffer_load_dwordx4 v0, s[64:67], s60 offen offset:0 sc1 lds
    v_mfma_f32_16x16x32_bf16 v[184:187], a[88:91], v[28:31], v[184:187]
    v_exp_f32 v58, v74
    v_mfma_f32_16x16x32_bf16 v[180:183], a[92:95], v[24:27], v[180:183]
    ds_read_b128 a[124:127], v14 offset:64512
    buffer_load_dwordx4 v0, s[64:67], s60 offen offset:1024 sc1 lds
    v_mfma_f32_16x16x32_bf16 v[188:191], a[92:95], v[28:31], v[188:191]
    s_waitcnt lgkmcnt(4)
    v_add_f32 v9, v56, v57
    v_mfma_f32_16x16x32_bf16 v[192:195], a[96:99], v[24:27], v[192:195]
    ds_read_b128 a[64:67], v16 offset:49152
    buffer_load_dwordx4 v0, s[64:67], s60 offen offset:2048 sc1 lds
    v_mfma_f32_16x16x32_bf16 v[200:203], a[96:99], v[28:31], v[200:203]
    v_exp_f32 v59, v75
    v_mfma_f32_16x16x32_bf16 v[196:199], a[100:103], v[24:27], v[196:199]
    ds_read_b128 a[68:71], v16 offset:50176
    v_add_f32 v9, v9, v58
    v_mfma_f32_16x16x32_bf16 v[204:207], a[100:103], v[28:31], v[204:207]
    v_exp_f32 v52, v68
    v_mfma_f32_16x16x32_bf16 v[208:211], a[104:107], v[24:27], v[208:211]
    ds_read_b128 a[72:75], v16 offset:51200
    v_add_f32 v9, v9, v59
    v_mfma_f32_16x16x32_bf16 v[216:219], a[104:107], v[28:31], v[216:219]
    v_exp_f32 v53, v69
    v_mfma_f32_16x16x32_bf16 v[212:215], a[108:111], v[24:27], v[212:215]
    ds_read_b128 a[76:79], v16 offset:52224
    v_add_f32 v8, v8, v52
    v_mfma_f32_16x16x32_bf16 v[220:223], a[108:111], v[28:31], v[220:223]
    s_waitcnt lgkmcnt(4)
    v_exp_f32 v54, v70
    v_mfma_f32_16x16x32_bf16 v[224:227], a[112:115], v[24:27], v[224:227]
    ds_read_b128 a[80:83], v16 offset:53248
    buffer_load_dwordx4 v0, s[64:67], s60 offen offset:3072 sc1 lds
    v_mfma_f32_16x16x32_bf16 v[232:235], a[112:115], v[28:31], v[232:235]
    buffer_load_dwordx4 a[204:207], v135, s[16:19], s28 offen offset:2048 sc1
    v_add_f32 v8, v8, v53
    v_mfma_f32_16x16x32_bf16 v[228:231], a[116:119], v[24:27], v[228:231]
    s_cmp_eq_u32 s37, s38
    ds_read_b128 a[84:87], v16 offset:54272
    v_mfma_f32_16x16x32_bf16 v[236:239], a[116:119], v[28:31], v[236:239]
    s_cbranch_scc1 .Lmain_kernel_mask_95
.Lmain_kernel_maskr_96:
    v_mfma_f32_16x16x32_bf16 v[240:243], a[120:123], v[24:27], v[240:243]
    s_add_u32 s60, s60, 16384
    ds_read_b128 a[88:91], v16 offset:55296
    v_mfma_f32_16x16x32_bf16 v[248:251], a[120:123], v[28:31], v[248:251]
    v_exp_f32 v55, v71
    v_mfma_f32_16x16x32_bf16 v[244:247], a[124:127], v[24:27], v[244:247]
    ds_read_b128 a[92:95], v16 offset:56320
    v_add_f32 v8, v8, v54
    v_mfma_f32_16x16x32_bf16 v[252:255], a[124:127], v[28:31], v[252:255]
    s_waitcnt lgkmcnt(4)
    v_exp_f32 v60, v76
    v_mfma_f32_16x16x32_bf16 v[80:83], a[64:67], a[0:3], v[112:115]
    ds_read_b128 a[96:99], v16 offset:57344
    v_add_f32 v8, v8, v55
    v_mfma_f32_16x16x32_bf16 v[88:91], a[64:67], a[4:7], v[120:123]
    v_exp_f32 v61, v77
    v_mfma_f32_16x16x32_bf16 v[84:87], a[68:71], a[0:3], v[116:119]
    ds_read_b128 a[100:103], v16 offset:58368
    v_add_f32 v9, v9, v60
    v_mfma_f32_16x16x32_bf16 v[92:95], a[68:71], a[4:7], v[124:127]
    v_exp_f32 v62, v78
    v_mfma_f32_16x16x32_bf16 v[80:83], a[72:75], a[8:11], v[80:83]
    ds_read_b128 a[104:107], v16 offset:59392
    v_add_f32 v9, v9, v61
    v_mfma_f32_16x16x32_bf16 v[88:91], a[72:75], a[12:15], v[88:91]
    v_exp_f32 v63, v79
    v_mfma_f32_16x16x32_bf16 v[84:87], a[76:79], a[8:11], v[84:87]
    ds_read_b128 a[108:111], v16 offset:60416
    v_add_f32 v9, v9, v62
    v_mfma_f32_16x16x32_bf16 v[92:95], a[76:79], a[12:15], v[92:95]
    s_waitcnt lgkmcnt(4)
    v_add_f32 v9, v9, v63
    v_add_f32 v2, v8, v9
    v_mfma_f32_16x16x32_bf16 v[80:83], a[80:83], a[16:19], v[80:83]
    ds_read_b128 a[112:115], v16 offset:61440
    v_cmp_nge_f32 vcc, 1266679808, v2
    v_mfma_f32_16x16x32_bf16 v[88:91], a[80:83], a[20:23], v[88:91]
    v_mfma_f32_16x16x32_bf16 v[84:87], a[84:87], a[16:19], v[84:87]
    s_add_u32 s28, s28, 262144
    ds_read_b128 a[116:119], v16 offset:62464
    v_mfma_f32_16x16x32_bf16 v[92:95], a[84:87], a[20:23], v[92:95]
    s_cbranch_vccnz .Lmain_kernel_rare_67
.Lmain_kernel_rarer_97:
    v_mfma_f32_16x16x32_bf16 v[80:83], a[88:91], a[24:27], v[80:83]
    ds_read_b128 a[120:123], v16 offset:63488
    v_add_f32 v22, v22, v8
    v_mfma_f32_16x16x32_bf16 v[88:91], a[88:91], a[28:31], v[88:91]
    v_add_f32 v23, v23, v9
    v_mfma_f32_16x16x32_bf16 v[84:87], a[92:95], a[24:27], v[84:87]
    s_waitcnt vmcnt(16)
    s_waitcnt lgkmcnt(3)
    ds_read_b128 a[124:127], v16 offset:64512
    v_mfma_f32_16x16x32_bf16 v[92:95], a[92:95], a[28:31], v[92:95]
    s_barrier
    v_mfma_f32_16x16x32_bf16 v[80:83], a[96:99], a[32:35], v[80:83]
    s_add_u32 m0, s76, 98304
    ds_read_b128 a[64:67], v14 offset:0
    v_cvt_pk_bf16_f32 v24, v48, v49
    v_mfma_f32_16x16x32_bf16 v[88:91], a[96:99], a[36:39], v[88:91]
    v_cvt_pk_bf16_f32 v25, v50, v51
    v_mfma_f32_16x16x32_bf16 v[84:87], a[100:103], a[32:35], v[84:87]
    ds_read_b128 a[68:71], v14 offset:1024
    buffer_load_dwordx4 v0, s[16:19], s39 offen offset:0 sc1 lds
    v_mfma_f32_16x16x32_bf16 v[92:95], a[100:103], a[36:39], v[92:95]
    v_cvt_pk_bf16_f32 v26, v52, v53
    v_mfma_f32_16x16x32_bf16 v[80:83], a[104:107], a[40:43], v[80:83]
    ds_read_b128 a[72:75], v14 offset:2048
    v_mfma_f32_16x16x32_bf16 v[88:91], a[104:107], a[44:47], v[88:91]
    buffer_load_dwordx4 v0, s[16:19], s39 offen offset:1024 sc1 lds
    v_cvt_pk_bf16_f32 v27, v54, v55
    v_mfma_f32_16x16x32_bf16 v[84:87], a[108:111], a[40:43], v[84:87]
    ds_read_b128 a[76:79], v14 offset:3072
    v_mfma_f32_16x16x32_bf16 v[92:95], a[108:111], a[44:47], v[92:95]
    s_waitcnt lgkmcnt(4)
    v_cvt_pk_bf16_f32 v28, v56, v57
    v_mfma_f32_16x16x32_bf16 v[80:83], a[112:115], a[48:51], v[80:83]
    ds_read_b128 a[80:83], v14 offset:4096
    buffer_load_dwordx4 v0, s[16:19], s39 offen offset:2048 sc1 lds
    v_mfma_f32_16x16x32_bf16 v[88:91], a[112:115], a[52:55], v[88:91]
    v_cvt_pk_bf16_f32 v29, v58, v59
    v_mfma_f32_16x16x32_bf16 v[84:87], a[116:119], a[48:51], v[84:87]
    ds_read_b128 a[84:87], v14 offset:5120
    buffer_load_dwordx4 v0, s[16:19], s39 offen offset:3072 sc1 lds
    v_mfma_f32_16x16x32_bf16 v[92:95], a[116:119], a[52:55], v[92:95]
    v_cvt_pk_bf16_f32 v30, v60, v61
    v_mfma_f32_16x16x32_bf16 v[80:83], a[120:123], a[56:59], v[80:83]
    ds_read_b128 a[88:91], v14 offset:6144
    v_mfma_f32_16x16x32_bf16 v[88:91], a[120:123], a[60:63], v[88:91]
    s_add_u32 s39, s39, 16384
    v_cvt_pk_bf16_f32 v31, v62, v63
    v_mfma_f32_16x16x32_bf16 v[84:87], a[124:127], a[56:59], v[84:87]
    ds_read_b128 a[92:95], v14 offset:7168
    v_mfma_f32_16x16x32_bf16 v[92:95], a[124:127], a[60:63], v[92:95]
    s_waitcnt lgkmcnt(4)
    s_cmp_eq_u32 s37, 0
    s_cbranch_scc1 .Lmain_kernel_tail_42
.Lmain_kernel_it_47:
    v_mfma_f32_16x16x32_bf16 v[32:35], a[64:67], v[24:27], v[32:35]
    s_sub_u32 s37, s37, 1
    ds_read_b128 a[96:99], v14 offset:8192
    v_mfma_f32_16x16x32_bf16 v[40:43], a[64:67], v[28:31], v[40:43]
    v_exp_f32 v48, v80
    v_mfma_f32_16x16x32_bf16 v[36:39], a[68:71], v[24:27], v[36:39]
    s_add_u32 m0, s76, 49152
    ds_read_b128 a[100:103], v14 offset:9216
    buffer_load_dwordx4 a[208:211], v14, s[16:19], s28 offen offset:0 sc1
    v_mfma_f32_16x16x32_bf16 v[44:47], a[68:71], v[28:31], v[44:47]
    v_exp_f32 v49, v81
    v_mfma_f32_16x16x32_bf16 v[96:99], a[72:75], v[24:27], v[96:99]
    ds_read_b128 a[104:107], v14 offset:10240
    v_mfma_f32_16x16x32_bf16 v[104:107], a[72:75], v[28:31], v[104:107]
    v_exp_f32 v50, v82
    v_mfma_f32_16x16x32_bf16 v[100:103], a[76:79], v[24:27], v[100:103]
    ds_read_b128 a[108:111], v14 offset:11264
    v_add_f32 v8, v48, v49
    v_mfma_f32_16x16x32_bf16 v[108:111], a[76:79], v[28:31], v[108:111]
    s_waitcnt lgkmcnt(4)
    v_exp_f32 v51, v83
    v_mfma_f32_16x16x32_bf16 v[160:163], a[80:83], v[24:27], v[160:163]
    ds_read_b128 a[112:115], v14 offset:12288
    v_add_f32 v8, v8, v50
    v_mfma_f32_16x16x32_bf16 v[168:171], a[80:83], v[28:31], v[168:171]
    v_exp_f32 v56, v88
    v_mfma_f32_16x16x32_bf16 v[164:167], a[84:87], v[24:27], v[164:167]
    s_add_u32 s26, s26, 1
    ds_read_b128 a[116:119], v14 offset:13312
    v_add_f32 v8, v8, v51
    v_mfma_f32_16x16x32_bf16 v[172:175], a[84:87], v[28:31], v[172:175]
    v_exp_f32 v57, v89
    v_mfma_f32_16x16x32_bf16 v[176:179], a[88:91], v[24:27], v[176:179]
    ds_read_b128 a[120:123], v14 offset:14336
    buffer_load_dwordx4 v0, s[64:67], s60 offen offset:0 sc1 lds
    v_mfma_f32_16x16x32_bf16 v[184:187], a[88:91], v[28:31], v[184:187]
    v_exp_f32 v58, v90
    v_mfma_f32_16x16x32_bf16 v[180:183], a[92:95], v[24:27], v[180:183]
    ds_read_b128 a[124:127], v14 offset:15360
    buffer_load_dwordx4 v0, s[64:67], s60 offen offset:1024 sc1 lds
    v_mfma_f32_16x16x32_bf16 v[188:191], a[92:95], v[28:31], v[188:191]
    s_waitcnt lgkmcnt(4)
    v_add_f32 v9, v56, v57
    v_mfma_f32_16x16x32_bf16 v[192:195], a[96:99], v[24:27], v[192:195]
    ds_read_b128 a[64:67], v16 offset:0
    buffer_load_dwordx4 v0, s[64:67], s60 offen offset:2048 sc1 lds
    v_mfma_f32_16x16x32_bf16 v[200:203], a[96:99], v[28:31], v[200:203]
    v_exp_f32 v59, v91
    v_mfma_f32_16x16x32_bf16 v[196:199], a[100:103], v[24:27], v[196:199]
    ds_read_b128 a[68:71], v16 offset:1024
    v_add_f32 v9, v9, v58
    v_mfma_f32_16x16x32_bf16 v[204:207], a[100:103], v[28:31], v[204:207]
    v_exp_f32 v52, v84
    v_mfma_f32_16x16x32_bf16 v[208:211], a[104:107], v[24:27], v[208:211]
    ds_read_b128 a[72:75], v16 offset:2048
    v_add_f32 v9, v9, v59
    v_mfma_f32_16x16x32_bf16 v[216:219], a[104:107], v[28:31], v[216:219]
    v_exp_f32 v53, v85
    v_mfma_f32_16x16x32_bf16 v[212:215], a[108:111], v[24:27], v[212:215]
    ds_read_b128 a[76:79], v16 offset:3072
    v_add_f32 v8, v8, v52
    v_mfma_f32_16x16x32_bf16 v[220:223], a[108:111], v[28:31], v[220:223]
    s_waitcnt lgkmcnt(4)
    v_exp_f32 v54, v86
    v_mfma_f32_16x16x32_bf16 v[224:227], a[112:115], v[24:27], v[224:227]
    ds_read_b128 a[80:83], v16 offset:4096
    buffer_load_dwordx4 v0, s[64:67], s60 offen offset:3072 sc1 lds
    v_mfma_f32_16x16x32_bf16 v[232:235], a[112:115], v[28:31], v[232:235]
    v_add_f32 v8, v8, v53
    v_mfma_f32_16x16x32_bf16 v[228:231], a[116:119], v[24:27], v[228:231]
    s_cmp_eq_u32 s37, s38
    ds_read_b128 a[84:87], v16 offset:5120
    v_mfma_f32_16x16x32_bf16 v[236:239], a[116:119], v[28:31], v[236:239]
    s_cbranch_scc1 .Lmain_kernel_mask_99
.Lmain_kernel_maskr_100:
    v_mfma_f32_16x16x32_bf16 v[240:243], a[120:123], v[24:27], v[240:243]
    s_add_u32 s60, s60, 16384
    ds_read_b128 a[88:91], v16 offset:6144
    v_mfma_f32_16x16x32_bf16 v[248:251], a[120:123], v[28:31], v[248:251]
    v_exp_f32 v55, v87
    v_mfma_f32_16x16x32_bf16 v[244:247], a[124:127], v[24:27], v[244:247]
    ds_read_b128 a[92:95], v16 offset:7168
    v_add_f32 v8, v8, v54
    v_mfma_f32_16x16x32_bf16 v[252:255], a[124:127], v[28:31], v[252:255]
    s_waitcnt lgkmcnt(4)
    v_exp_f32 v60, v92
    v_mfma_f32_16x16x32_bf16 v[64:67], a[64:67], a[0:3], v[112:115]
    ds_read_b128 a[96:99], v16 offset:8192
    v_add_f32 v8, v8, v55
    v_mfma_f32_16x16x32_bf16 v[72:75], a[64:67], a[4:7], v[120:123]
    v_exp_f32 v61, v93
    v_mfma_f32_16x16x32_bf16 v[68:71], a[68:71], a[0:3], v[116:119]
    ds_read_b128 a[100:103], v16 offset:9216
    v_add_f32 v9, v9, v60
    v_mfma_f32_16x16x32_bf16 v[76:79], a[68:71], a[4:7], v[124:127]
    v_exp_f32 v62, v94
    v_mfma_f32_16x16x32_bf16 v[64:67], a[72:75], a[8:11], v[64:67]
    ds_read_b128 a[104:107], v16 offset:10240
    v_add_f32 v9, v9, v61
    v_mfma_f32_16x16x32_bf16 v[72:75], a[72:75], a[12:15], v[72:75]
    v_exp_f32 v63, v95
    v_mfma_f32_16x16x32_bf16 v[68:71], a[76:79], a[8:11], v[68:71]
    ds_read_b128 a[108:111], v16 offset:11264
    v_add_f32 v9, v9, v62
    v_mfma_f32_16x16x32_bf16 v[76:79], a[76:79], a[12:15], v[76:79]
    s_waitcnt lgkmcnt(4)
    v_add_f32 v9, v9, v63
    v_add_f32 v2, v8, v9
    v_mfma_f32_16x16x32_bf16 v[64:67], a[80:83], a[16:19], v[64:67]
    ds_read_b128 a[112:115], v16 offset:12288
    v_cmp_nge_f32 vcc, 1266679808, v2
    v_mfma_f32_16x16x32_bf16 v[72:75], a[80:83], a[20:23], v[72:75]
    buffer_load_dwordx4 a[212:215], v14, s[16:19], s28 offen offset:1024 sc1
    v_mfma_f32_16x16x32_bf16 v[68:71], a[84:87], a[16:19], v[68:71]
    ds_read_b128 a[116:119], v16 offset:13312
    v_mfma_f32_16x16x32_bf16 v[76:79], a[84:87], a[20:23], v[76:79]
    s_cbranch_vccnz .Lmain_kernel_rare_54
.Lmain_kernel_rarer_101:
    v_mfma_f32_16x16x32_bf16 v[64:67], a[88:91], a[24:27], v[64:67]
    ds_read_b128 a[120:123], v16 offset:14336
    v_add_f32 v22, v22, v8
    v_mfma_f32_16x16x32_bf16 v[72:75], a[88:91], a[28:31], v[72:75]
    v_add_f32 v23, v23, v9
    v_mfma_f32_16x16x32_bf16 v[68:71], a[92:95], a[24:27], v[68:71]
    s_waitcnt vmcnt(16)
    s_waitcnt lgkmcnt(3)
    ds_read_b128 a[124:127], v16 offset:15360
    v_mfma_f32_16x16x32_bf16 v[76:79], a[92:95], a[28:31], v[76:79]
    s_barrier
    v_mfma_f32_16x16x32_bf16 v[64:67], a[96:99], a[32:35], v[64:67]
    s_add_u32 m0, s76, 114688
    ds_read_b128 a[64:67], v14 offset:16384
    v_cvt_pk_bf16_f32 v24, v48, v49
    v_mfma_f32_16x16x32_bf16 v[72:75], a[96:99], a[36:39], v[72:75]
    buffer_load_dwordx4 v0, s[16:19], s39 offen offset:0 sc1 lds
    v_cvt_pk_bf16_f32 v25, v50, v51
    v_mfma_f32_16x16x32_bf16 v[68:71], a[100:103], a[32:35], v[68:71]
    ds_read_b128 a[68:71], v14 offset:17408
    v_mfma_f32_16x16x32_bf16 v[76:79], a[100:103], a[36:39], v[76:79]
    buffer_load_dwordx4 v0, s[16:19], s39 offen offset:1024 sc1 lds
    v_cvt_pk_bf16_f32 v26, v52, v53
    v_mfma_f32_16x16x32_bf16 v[64:67], a[104:107], a[40:43], v[64:67]
    ds_read_b128 a[72:75], v14 offset:18432
    buffer_load_dwordx4 v0, s[16:19], s39 offen offset:2048 sc1 lds
    v_mfma_f32_16x16x32_bf16 v[72:75], a[104:107], a[44:47], v[72:75]
    v_cvt_pk_bf16_f32 v27, v54, v55
    v_mfma_f32_16x16x32_bf16 v[68:71], a[108:111], a[40:43], v[68:71]
    ds_read_b128 a[76:79], v14 offset:19456
    buffer_load_dwordx4 v0, s[16:19], s39 offen offset:3072 sc1 lds
    v_mfma_f32_16x16x32_bf16 v[76:79], a[108:111], a[44:47], v[76:79]
    s_waitcnt lgkmcnt(4)
    v_cvt_pk_bf16_f32 v28, v56, v57
    v_mfma_f32_16x16x32_bf16 v[64:67], a[112:115], a[48:51], v[64:67]
    s_add_u32 s39, s39, 16384
    ds_read_b128 a[80:83], v14 offset:20480
    v_mfma_f32_16x16x32_bf16 v[72:75], a[112:115], a[52:55], v[72:75]
    s_cmp_eq_u32 s39, s61
    s_cselect_b32 s39, s62, s39
    s_cselect_b32 s61, s5, s61
    v_mfma_f32_16x16x32_bf16 v[68:71], a[116:119], a[48:51], v[68:71]
    s_cselect_b32 s62, 1073741824, s62
    ds_read_b128 a[84:87], v14 offset:21504
    v_cvt_pk_bf16_f32 v29, v58, v59
    v_mfma_f32_16x16x32_bf16 v[76:79], a[116:119], a[52:55], v[76:79]
    v_cvt_pk_bf16_f32 v30, v60, v61
    v_mfma_f32_16x16x32_bf16 v[64:67], a[120:123], a[56:59], v[64:67]
    ds_read_b128 a[88:91], v14 offset:22528
    v_mfma_f32_16x16x32_bf16 v[72:75], a[120:123], a[60:63], v[72:75]
    v_cvt_pk_bf16_f32 v31, v62, v63
    v_mfma_f32_16x16x32_bf16 v[68:71], a[124:127], a[56:59], v[68:71]
    ds_read_b128 a[92:95], v14 offset:23552
    v_mfma_f32_16x16x32_bf16 v[76:79], a[124:127], a[60:63], v[76:79]
    s_waitcnt lgkmcnt(4)
    v_mfma_f32_16x16x32_bf16 v[32:35], a[64:67], v[24:27], v[32:35]
    ds_read_b128 a[96:99], v14 offset:24576
    v_mfma_f32_16x16x32_bf16 v[40:43], a[64:67], v[28:31], v[40:43]
    v_exp_f32 v48, v64
    v_mfma_f32_16x16x32_bf16 v[36:39], a[68:71], v[24:27], v[36:39]
    s_add_u32 m0, s76, 0
    ds_read_b128 a[100:103], v14 offset:25600
    buffer_load_dwordx4 a[216:219], v134, s[16:19], s28 offen offset:2048 sc1
    v_mfma_f32_16x16x32_bf16 v[44:47], a[68:71], v[28:31], v[44:47]
    v_exp_f32 v49, v65
    v_mfma_f32_16x16x32_bf16 v[96:99], a[72:75], v[24:27], v[96:99]
    ds_read_b128 a[104:107], v14 offset:26624
    v_mfma_f32_16x16x32_bf16 v[104:107], a[72:75], v[28:31], v[104:107]
    v_exp_f32 v50, v66
    v_mfma_f32_16x16x32_bf16 v[100:103], a[76:79], v[24:27], v[100:103]
    ds_read_b128 a[108:111], v14 offset:27648
    v_add_f32 v8, v48, v49
    v_mfma_f32_16x16x32_bf16 v[108:111], a[76:79], v[28:31], v[108:111]
    s_waitcnt lgkmcnt(4)
    v_exp_f32 v51, v67
    v_mfma_f32_16x16x32_bf16 v[160:163], a[80:83], v[24:27], v[160:163]
    ds_read_b128 a[112:115], v14 offset:28672
    v_add_f32 v8, v8, v50
    v_mfma_f32_16x16x32_bf16 v[168:171], a[80:83], v[28:31], v[168:171]
    v_exp_f32 v56, v72
    v_mfma_f32_16x16x32_bf16 v[164:167], a[84:87], v[24:27], v[164:167]
    ds_read_b128 a[116:119], v14 offset:29696
    v_add_f32 v8, v8, v51
    v_mfma_f32_16x16x32_bf16 v[172:175], a[84:87], v[28:31], v[172:175]
    v_exp_f32 v57, v73
    v_mfma_f32_16x16x32_bf16 v[176:179], a[88:91], v[24:27], v[176:179]
    ds_read_b128 a[120:123], v14 offset:30720
    buffer_load_dwordx4 v0, s[64:67], s60 offen offset:0 sc1 lds
    v_mfma_f32_16x16x32_bf16 v[184:187], a[88:91], v[28:31], v[184:187]
    v_exp_f32 v58, v74
    v_mfma_f32_16x16x32_bf16 v[180:183], a[92:95], v[24:27], v[180:183]
    ds_read_b128 a[124:127], v14 offset:31744
    buffer_load_dwordx4 v0, s[64:67], s60 offen offset:1024 sc1 lds
    v_mfma_f32_16x16x32_bf16 v[188:191], a[92:95], v[28:31], v[188:191]
    s_waitcnt lgkmcnt(4)
    v_add_f32 v9, v56, v57
    v_mfma_f32_16x16x32_bf16 v[192:195], a[96:99], v[24:27], v[192:195]
    ds_read_b128 a[64:67], v16 offset:16384
    buffer_load_dwordx4 v0, s[64:67], s60 offen offset:2048 sc1 lds
    v_mfma_f32_16x16x32_bf16 v[200:203], a[96:99], v[28:31], v[200:203]
    v_exp_f32 v59, v75
    v_mfma_f32_16x16x32_bf16 v[196:199], a[100:103], v[24:27], v[196:199]
    ds_read_b128 a[68:71], v16 offset:17408
    v_add_f32 v9, v9, v58
    v_mfma_f32_16x16x32_bf16 v[204:207], a[100:103], v[28:31], v[204:207]
    v_exp_f32 v52, v68
    v_mfma_f32_16x16x32_bf16 v[208:211], a[104:107], v[24:27], v[208:211]
    ds_read_b128 a[72:75], v16 offset:18432
    v_add_f32 v9, v9, v59
    v_mfma_f32_16x16x32_bf16 v[216:219], a[104:107], v[28:31], v[216:219]
    v_exp_f32 v53, v69
    v_mfma_f32_16x16x32_bf16 v[212:215], a[108:111], v[24:27], v[212:215]
    ds_read_b128 a[76:79], v16 offset:19456
    v_add_f32 v8, v8, v52
    v_mfma_f32_16x16x32_bf16 v[220:223], a[108:111], v[28:31], v[220:223]
    s_waitcnt lgkmcnt(4)
    v_exp_f32 v54, v70
    v_mfma_f32_16x16x32_bf16 v[224:227], a[112:115], v[24:27], v[224:227]
    ds_read_b128 a[80:83], v16 offset:20480
    buffer_load_dwordx4 v0, s[64:67], s60 offen offset:3072 sc1 lds
    v_mfma_f32_16x16x32_bf16 v[232:235], a[112:115], v[28:31], v[232:235]
    buffer_load_dwordx4 a[220:223], v135, s[16:19], s28 offen offset:2048 sc1
    v_add_f32 v8, v8, v53
    v_mfma_f32_16x16x32_bf16 v[228:231], a[116:119], v[24:27], v[228:231]
    s_cmp_eq_u32 s37, s38
    ds_read_b128 a[84:87], v16 offset:21504
    v_mfma_f32_16x16x32_bf16 v[236:239], a[116:119], v[28:31], v[236:239]
    s_cbranch_scc1 .Lmain_kernel_mask_102
.Lmain_kernel_maskr_103:
    v_mfma_f32_16x16x32_bf16 v[240:243], a[120:123], v[24:27], v[240:243]
    s_add_u32 s60, s60, 16384
    ds_read_b128 a[88:91], v16 offset:22528
    v_mfma_f32_16x16x32_bf16 v[248:251], a[120:123], v[28:31], v[248:251]
    v_exp_f32 v55, v71
    v_mfma_f32_16x16x32_bf16 v[244:247], a[124:127], v[24:27], v[244:247]
    ds_read_b128 a[92:95], v16 offset:23552
    v_add_f32 v8, v8, v54
    v_mfma_f32_16x16x32_bf16 v[252:255], a[124:127], v[28:31], v[252:255]
    s_waitcnt lgkmcnt(4)
    v_exp_f32 v60, v76
    v_mfma_f32_16x16x32_bf16 v[80:83], a[64:67], a[0:3], v[112:115]
    ds_read_b128 a[96:99], v16 offset:24576
    v_add_f32 v8, v8, v55
    v_mfma_f32_16x16x32_bf16 v[88:91], a[64:67], a[4:7], v[120:123]
    v_exp_f32 v61, v77
    v_mfma_f32_16x16x32_bf16 v[84:87], a[68:71], a[0:3], v[116:119]
    ds_read_b128 a[100:103], v16 offset:25600
    v_add_f32 v9, v9, v60
    v_mfma_f32_16x16x32_bf16 v[92:95], a[68:71], a[4:7], v[124:127]
    v_exp_f32 v62, v78
    v_mfma_f32_16x16x32_bf16 v[80:83], a[72:75], a[8:11], v[80:83]
    ds_read_b128 a[104:107], v16 offset:26624
    v_add_f32 v9, v9, v61
    v_mfma_f32_16x16x32_bf16 v[88:91], a[72:75], a[12:15], v[88:91]
    v_exp_f32 v63, v79
    v_mfma_f32_16x16x32_bf16 v[84:87], a[76:79], a[8:11], v[84:87]
    ds_read_b128 a[108:111], v16 offset:27648
    v_add_f32 v9, v9, v62
    v_mfma_f32_16x16x32_bf16 v[92:95], a[76:79], a[12:15], v[92:95]
    s_waitcnt lgkmcnt(4)
    v_add_f32 v9, v9, v63
    v_add_f32 v2, v8, v9
    v_mfma_f32_16x16x32_bf16 v[80:83], a[80:83], a[16:19], v[80:83]
    ds_read_b128 a[112:115], v16 offset:28672
    v_cmp_nge_f32 vcc, 1266679808, v2
    v_mfma_f32_16x16x32_bf16 v[88:91], a[80:83], a[20:23], v[88:91]
    v_mfma_f32_16x16x32_bf16 v[84:87], a[84:87], a[16:19], v[84:87]
    s_add_u32 s28, s28, 262144
    ds_read_b128 a[116:119], v16 offset:29696
    v_mfma_f32_16x16x32_bf16 v[92:95], a[84:87], a[20:23], v[92:95]
    s_cbranch_vccnz .Lmain_kernel_rare_59
.Lmain_kernel_rarer_104:
    v_mfma_f32_16x16x32_bf16 v[80:83], a[88:91], a[24:27], v[80:83]
    ds_read_b128 a[120:123], v16 offset:30720
    v_add_f32 v22, v22, v8
    v_mfma_f32_16x16x32_bf16 v[88:91], a[88:91], a[28:31], v[88:91]
    v_add_f32 v23, v23, v9
    v_mfma_f32_16x16x32_bf16 v[84:87], a[92:95], a[24:27], v[84:87]
    s_waitcnt vmcnt(16)
    s_waitcnt lgkmcnt(3)
    ds_read_b128 a[124:127], v16 offset:31744
    v_mfma_f32_16x16x32_bf16 v[92:95], a[92:95], a[28:31], v[92:95]
    s_barrier
    v_mfma_f32_16x16x32_bf16 v[80:83], a[96:99], a[32:35], v[80:83]
    s_add_u32 m0, s76, 65536
    ds_read_b128 a[64:67], v14 offset:32768
    v_cvt_pk_bf16_f32 v24, v48, v49
    v_mfma_f32_16x16x32_bf16 v[88:91], a[96:99], a[36:39], v[88:91]
    v_cvt_pk_bf16_f32 v25, v50, v51
    v_mfma_f32_16x16x32_bf16 v[84:87], a[100:103], a[32:35], v[84:87]
    ds_read_b128 a[68:71], v14 offset:33792
    buffer_load_dwordx4 v0, s[16:19], s39 offen offset:0 sc1 lds
    v_mfma_f32_16x16x32_bf16 v[92:95], a[100:103], a[36:39], v[92:95]
    v_cvt_pk_bf16_f32 v26, v52, v53
    v_mfma_f32_16x16x32_bf16 v[80:83], a[104:107], a[40:43], v[80:83]
    ds_read_b128 a[72:75], v14 offset:34816
    v_mfma_f32_16x16x32_bf16 v[88:91], a[104:107], a[44:47], v[88:91]
    buffer_load_dwordx4 v0, s[16:19], s39 offen offset:1024 sc1 lds
    v_cvt_pk_bf16_f32 v27, v54, v55
    v_mfma_f32_16x16x32_bf16 v[84:87], a[108:111], a[40:43], v[84:87]
    ds_read_b128 a[76:79], v14 offset:35840
    v_mfma_f32_16x16x32_bf16 v[92:95], a[108:111], a[44:47], v[92:95]
    s_waitcnt lgkmcnt(4)
    v_cvt_pk_bf16_f32 v28, v56, v57
    v_mfma_f32_16x16x32_bf16 v[80:83], a[112:115], a[48:51], v[80:83]
    ds_read_b128 a[80:83], v14 offset:36864
    buffer_load_dwordx4 v0, s[16:19], s39 offen offset:2048 sc1 lds
    v_mfma_f32_16x16x32_bf16 v[88:91], a[112:115], a[52:55], v[88:91]
    v_cvt_pk_bf16_f32 v29, v58, v59
    v_mfma_f32_16x16x32_bf16 v[84:87], a[116:119], a[48:51], v[84:87]
    ds_read_b128 a[84:87], v14 offset:37888
    buffer_load_dwordx4 v0, s[16:19], s39 offen offset:3072 sc1 lds
    v_mfma_f32_16x16x32_bf16 v[92:95], a[116:119], a[52:55], v[92:95]
    v_cvt_pk_bf16_f32 v30, v60, v61
    v_mfma_f32_16x16x32_bf16 v[80:83], a[120:123], a[56:59], v[80:83]
    ds_read_b128 a[88:91], v14 offset:38912
    v_mfma_f32_16x16x32_bf16 v[88:91], a[120:123], a[60:63], v[88:91]
    s_add_u32 s39, s39, 16384
    v_cvt_pk_bf16_f32 v31, v62, v63
    v_mfma_f32_16x16x32_bf16 v[84:87], a[124:127], a[56:59], v[84:87]
    ds_read_b128 a[92:95], v14 offset:39936
    v_mfma_f32_16x16x32_bf16 v[92:95], a[124:127], a[60:63], v[92:95]
    s_waitcnt lgkmcnt(4)
    v_mfma_f32_16x16x32_bf16 v[32:35], a[64:67], v[24:27], v[32:35]
    ds_read_b128 a[96:99], v14 offset:40960
    v_mfma_f32_16x16x32_bf16 v[40:43], a[64:67], v[28:31], v[40:43]
    v_exp_f32 v48, v80
    v_mfma_f32_16x16x32_bf16 v[36:39], a[68:71], v[24:27], v[36:39]
    s_add_u32 m0, s76, 16384
    ds_read_b128 a[100:103], v14 offset:41984
    buffer_load_dwordx4 a[224:227], v14, s[16:19], s28 offen offset:0 sc1
    v_mfma_f32_16x16x32_bf16 v[44:47], a[68:71], v[28:31], v[44:47]
    v_exp_f32 v49, v81
    v_mfma_f32_16x16x32_bf16 v[96:99], a[72:75], v[24:27], v[96:99]
    ds_read_b128 a[104:107], v14 offset:43008
    buffer_load_dwordx4 v0, s[64:67], s60 offen offset:0 sc1 lds
    v_mfma_f32_16x16x32_bf16 v[104:107], a[72:75], v[28:31], v[104:107]
    v_exp_f32 v50, v82
    v_mfma_f32_16x16x32_bf16 v[100:103], a[76:79], v[24:27], v[100:103]
    ds_read_b128 a[108:111], v14 offset:44032
    v_add_f32 v8, v48, v49
    v_mfma_f32_16x16x32_bf16 v[108:111], a[76:79], v[28:31], v[108:111]
    s_waitcnt lgkmcnt(4)
    v_exp_f32 v51, v83
    v_mfma_f32_16x16x32_bf16 v[160:163], a[80:83], v[24:27], v[160:163]
    ds_read_b128 a[112:115], v14 offset:45056
    v_add_f32 v8, v8, v50
    v_mfma_f32_16x16x32_bf16 v[168:171], a[80:83], v[28:31], v[168:171]
    v_exp_f32 v56, v88
    v_mfma_f32_16x16x32_bf16 v[164:167], a[84:87], v[24:27], v[164:167]
    ds_read_b128 a[116:119], v14 offset:46080
    v_add_f32 v8, v8, v51
    v_mfma_f32_16x16x32_bf16 v[172:175], a[84:87], v[28:31], v[172:175]
    v_exp_f32 v57, v89
    v_mfma_f32_16x16x32_bf16 v[176:179], a[88:91], v[24:27], v[176:179]
    ds_read_b128 a[120:123], v14 offset:47104
    buffer_load_dwordx4 v0, s[64:67], s60 offen offset:1024 sc1 lds
    v_mfma_f32_16x16x32_bf16 v[184:187], a[88:91], v[28:31], v[184:187]
    v_exp_f32 v58, v90
    v_mfma_f32_16x16x32_bf16 v[180:183], a[92:95], v[24:27], v[180:183]
    ds_read_b128 a[124:127], v14 offset:48128
    buffer_load_dwordx4 v0, s[64:67], s60 offen offset:2048 sc1 lds
    v_mfma_f32_16x16x32_bf16 v[188:191], a[92:95], v[28:31], v[188:191]
    s_waitcnt lgkmcnt(4)
    buffer_load_dwordx4 v0, s[64:67], s60 offen offset:3072 sc1 lds
    v_add_f32 v9, v56, v57
    v_mfma_f32_16x16x32_bf16 v[192:195], a[96:99], v[24:27], v[192:195]
    s_add_u32 s60, s60, 16384
    ds_read_b128 a[64:67], v16 offset:32768
    v_mfma_f32_16x16x32_bf16 v[200:203], a[96:99], v[28:31], v[200:203]
    v_exp_f32 v59, v91
    v_mfma_f32_16x16x32_bf16 v[196:199], a[100:103], v[24:27], v[196:199]
    ds_read_b128 a[68:71], v16 offset:33792
    v_add_f32 v9, v9, v58
    v_mfma_f32_16x16x32_bf16 v[204:207], a[100:103], v[28:31], v[204:207]
    s_cmp_eq_u32 s60, s63
    v_exp_f32 v52, v84
    v_mfma_f32_16x16x32_bf16 v[208:211], a[104:107], v[24:27], v[208:211]
    s_cselect_b32 s60, s4, s60
    ds_read_b128 a[72:75], v16 offset:34816
    v_add_f32 v9, v9, v59
    v_mfma_f32_16x16x32_bf16 v[216:219], a[104:107], v[28:31], v[216:219]
    s_cselect_b32 s63, s5, s63
    v_exp_f32 v53, v85
    v_mfma_f32_16x16x32_bf16 v[212:215], a[108:111], v[24:27], v[212:215]
    s_cselect_b32 s4, 1073741824, s4
    ds_read_b128 a[76:79], v16 offset:35840
    v_add_f32 v8, v8, v52
    v_mfma_f32_16x16x32_bf16 v[220:223], a[108:111], v[28:31], v[220:223]
    s_waitcnt lgkmcnt(4)
    v_exp_f32 v54, v86
    v_mfma_f32_16x16x32_bf16 v[224:227], a[112:115], v[24:27], v[224:227]
    ds_read_b128 a[80:83], v16 offset:36864
    v_mfma_f32_16x16x32_bf16 v[232:235], a[112:115], v[28:31], v[232:235]
    v_add_f32 v8, v8, v53
    v_mfma_f32_16x16x32_bf16 v[228:231], a[116:119], v[24:27], v[228:231]
    s_cmp_eq_u32 s37, s38
    ds_read_b128 a[84:87], v16 offset:37888
    v_mfma_f32_16x16x32_bf16 v[236:239], a[116:119], v[28:31], v[236:239]
    s_cbranch_scc1 .Lmain_kernel_mask_105
.Lmain_kernel_maskr_106:
    v_mfma_f32_16x16x32_bf16 v[240:243], a[120:123], v[24:27], v[240:243]
    ds_read_b128 a[88:91], v16 offset:38912
    v_mfma_f32_16x16x32_bf16 v[248:251], a[120:123], v[28:31], v[248:251]
    v_exp_f32 v55, v87
    v_mfma_f32_16x16x32_bf16 v[244:247], a[124:127], v[24:27], v[244:247]
    ds_read_b128 a[92:95], v16 offset:39936
    v_add_f32 v8, v8, v54
    v_mfma_f32_16x16x32_bf16 v[252:255], a[124:127], v[28:31], v[252:255]
    s_waitcnt lgkmcnt(4)
    v_exp_f32 v60, v92
    v_mfma_f32_16x16x32_bf16 v[64:67], a[64:67], a[0:3], v[112:115]
    ds_read_b128 a[96:99], v16 offset:40960
    v_add_f32 v8, v8, v55
    v_mfma_f32_16x16x32_bf16 v[72:75], a[64:67], a[4:7], v[120:123]
    v_exp_f32 v61, v93
    v_mfma_f32_16x16x32_bf16 v[68:71], a[68:71], a[0:3], v[116:119]
    ds_read_b128 a[100:103], v16 offset:41984
    v_add_f32 v9, v9, v60
    v_mfma_f32_16x16x32_bf16 v[76:79], a[68:71], a[4:7], v[124:127]
    v_exp_f32 v62, v94
    v_mfma_f32_16x16x32_bf16 v[64:67], a[72:75], a[8:11], v[64:67]
    ds_read_b128 a[104:107], v16 offset:43008
    v_add_f32 v9, v9, v61
    v_mfma_f32_16x16x32_bf16 v[72:75], a[72:75], a[12:15], v[72:75]
    v_exp_f32 v63, v95
    v_mfma_f32_16x16x32_bf16 v[68:71], a[76:79], a[8:11], v[68:71]
    ds_read_b128 a[108:111], v16 offset:44032
    v_add_f32 v9, v9, v62
    v_mfma_f32_16x16x32_bf16 v[76:79], a[76:79], a[12:15], v[76:79]
    s_waitcnt lgkmcnt(4)
    v_add_f32 v9, v9, v63
    v_add_f32 v2, v8, v9
    v_mfma_f32_16x16x32_bf16 v[64:67], a[80:83], a[16:19], v[64:67]
    ds_read_b128 a[112:115], v16 offset:45056
    v_cmp_nge_f32 vcc, 1266679808, v2
    v_mfma_f32_16x16x32_bf16 v[72:75], a[80:83], a[20:23], v[72:75]
    buffer_load_dwordx4 a[228:231], v14, s[16:19], s28 offen offset:1024 sc1
    v_mfma_f32_16x16x32_bf16 v[68:71], a[84:87], a[16:19], v[68:71]
    ds_read_b128 a[116:119], v16 offset:46080
    v_mfma_f32_16x16x32_bf16 v[76:79], a[84:87], a[20:23], v[76:79]
    s_cbranch_vccnz .Lmain_kernel_rare_63
.Lmain_kernel_rarer_107:
    v_mfma_f32_16x16x32_bf16 v[64:67], a[88:91], a[24:27], v[64:67]
    ds_read_b128 a[120:123], v16 offset:47104
    v_add_f32 v22, v22, v8
    v_mfma_f32_16x16x32_bf16 v[72:75], a[88:91], a[28:31], v[72:75]
    v_add_f32 v23, v23, v9
    v_mfma_f32_16x16x32_bf16 v[68:71], a[92:95], a[24:27], v[68:71]
    s_waitcnt vmcnt(16)
    s_waitcnt lgkmcnt(3)
    ds_read_b128 a[124:127], v16 offset:48128
    v_mfma_f32_16x16x32_bf16 v[76:79], a[92:95], a[28:31], v[76:79]
    s_barrier
    v_mfma_f32_16x16x32_bf16 v[64:67], a[96:99], a[32:35], v[64:67]
    s_add_u32 m0, s76, 81920
    ds_read_b128 a[64:67], v14 offset:49152
    v_cvt_pk_bf16_f32 v24, v48, v49
    v_mfma_f32_16x16x32_bf16 v[72:75], a[96:99], a[36:39], v[72:75]
    v_cvt_pk_bf16_f32 v25, v50, v51
    v_mfma_f32_16x16x32_bf16 v[68:71], a[100:103], a[32:35], v[68:71]
    ds_read_b128 a[68:71], v14 offset:50176
    buffer_load_dwordx4 v0, s[16:19], s39 offen offset:0 sc1 lds
    v_mfma_f32_16x16x32_bf16 v[76:79], a[100:103], a[36:39], v[76:79]
    v_cvt_pk_bf16_f32 v26, v52, v53
    v_mfma_f32_16x16x32_bf16 v[64:67], a[104:107], a[40:43], v[64:67]
    ds_read_b128 a[72:75], v14 offset:51200
    v_mfma_f32_16x16x32_bf16 v[72:75], a[104:107], a[44:47], v[72:75]
    buffer_load_dwordx4 v0, s[16:19], s39 offen offset:1024 sc1 lds
    v_cvt_pk_bf16_f32 v27, v54, v55
    v_mfma_f32_16x16x32_bf16 v[68:71], a[108:111], a[40:43], v[68:71]
    ds_read_b128 a[76:79], v14 offset:52224
    v_mfma_f32_16x16x32_bf16 v[76:79], a[108:111], a[44:47], v[76:79]
    s_waitcnt lgkmcnt(4)
    v_cvt_pk_bf16_f32 v28, v56, v57
    v_mfma_f32_16x16x32_bf16 v[64:67], a[112:115], a[48:51], v[64:67]
    ds_read_b128 a[80:83], v14 offset:53248
    buffer_load_dwordx4 v0, s[16:19], s39 offen offset:2048 sc1 lds
    v_mfma_f32_16x16x32_bf16 v[72:75], a[112:115], a[52:55], v[72:75]
    v_cvt_pk_bf16_f32 v29, v58, v59
    v_mfma_f32_16x16x32_bf16 v[68:71], a[116:119], a[48:51], v[68:71]
    ds_read_b128 a[84:87], v14 offset:54272
    buffer_load_dwordx4 v0, s[16:19], s39 offen offset:3072 sc1 lds
    v_mfma_f32_16x16x32_bf16 v[76:79], a[116:119], a[52:55], v[76:79]
    v_cvt_pk_bf16_f32 v30, v60, v61
    v_mfma_f32_16x16x32_bf16 v[64:67], a[120:123], a[56:59], v[64:67]
    ds_read_b128 a[88:91], v14 offset:55296
    v_mfma_f32_16x16x32_bf16 v[72:75], a[120:123], a[60:63], v[72:75]
    s_add_u32 s39, s39, 16384
    v_cvt_pk_bf16_f32 v31, v62, v63
    v_mfma_f32_16x16x32_bf16 v[68:71], a[124:127], a[56:59], v[68:71]
    ds_read_b128 a[92:95], v14 offset:56320
    v_mfma_f32_16x16x32_bf16 v[76:79], a[124:127], a[60:63], v[76:79]
    s_waitcnt lgkmcnt(4)
    v_mfma_f32_16x16x32_bf16 v[32:35], a[64:67], v[24:27], v[32:35]
    ds_read_b128 a[96:99], v14 offset:57344
    v_mfma_f32_16x16x32_bf16 v[40:43], a[64:67], v[28:31], v[40:43]
    v_exp_f32 v48, v64
    v_mfma_f32_16x16x32_bf16 v[36:39], a[68:71], v[24:27], v[36:39]
    s_add_u32 m0, s76, 32768
    ds_read_b128 a[100:103], v14 offset:58368
    buffer_load_dwordx4 a[232:235], v134, s[16:19], s28 offen offset:2048 sc1
    v_mfma_f32_16x16x32_bf16 v[44:47], a[68:71], v[28:31], v[44:47]
    v_exp_f32 v49, v65
    v_mfma_f32_16x16x32_bf16 v[96:99], a[72:75], v[24:27], v[96:99]
    ds_read_b128 a[104:107], v14 offset:59392
    v_mfma_f32_16x16x32_bf16 v[104:107], a[72:75], v[28:31], v[104:107]
    v_exp_f32 v50, v66
    v_mfma_f32_16x16x32_bf16 v[100:103], a[76:79], v[24:27], v[100:103]
    ds_read_b128 a[108:111], v14 offset:60416
    v_add_f32 v8, v48, v49
    v_mfma_f32_16x16x32_bf16 v[108:111], a[76:79], v[28:31], v[108:111]
    s_waitcnt lgkmcnt(4)
    v_exp_f32 v51, v67
    v_mfma_f32_16x16x32_bf16 v[160:163], a[80:83], v[24:27], v[160:163]
    ds_read_b128 a[112:115], v14 offset:61440
    v_add_f32 v8, v8, v50
    v_mfma_f32_16x16x32_bf16 v[168:171], a[80:83], v[28:31], v[168:171]
    v_exp_f32 v56, v72
    v_mfma_f32_16x16x32_bf16 v[164:167], a[84:87], v[24:27], v[164:167]
    ds_read_b128 a[116:119], v14 offset:62464
    v_add_f32 v8, v8, v51
    v_mfma_f32_16x16x32_bf16 v[172:175], a[84:87], v[28:31], v[172:175]
    v_exp_f32 v57, v73
    v_mfma_f32_16x16x32_bf16 v[176:179], a[88:91], v[24:27], v[176:179]
    ds_read_b128 a[120:123], v14 offset:63488
    buffer_load_dwordx4 v0, s[64:67], s60 offen offset:0 sc1 lds
    v_mfma_f32_16x16x32_bf16 v[184:187], a[88:91], v[28:31], v[184:187]
    v_exp_f32 v58, v74
    v_mfma_f32_16x16x32_bf16 v[180:183], a[92:95], v[24:27], v[180:183]
    ds_read_b128 a[124:127], v14 offset:64512
    buffer_load_dwordx4 v0, s[64:67], s60 offen offset:1024 sc1 lds
    v_mfma_f32_16x16x32_bf16 v[188:191], a[92:95], v[28:31], v[188:191]
    s_waitcnt lgkmcnt(4)
    v_add_f32 v9, v56, v57
    v_mfma_f32_16x16x32_bf16 v[192:195], a[96:99], v[24:27], v[192:195]
    ds_read_b128 a[64:67], v16 offset:49152
    buffer_load_dwordx4 v0, s[64:67], s60 offen offset:2048 sc1 lds
    v_mfma_f32_16x16x32_bf16 v[200:203], a[96:99], v[28:31], v[200:203]
    v_exp_f32 v59, v75
    v_mfma_f32_16x16x32_bf16 v[196:199], a[100:103], v[24:27], v[196:199]
    ds_read_b128 a[68:71], v16 offset:50176
    v_add_f32 v9, v9, v58
    v_mfma_f32_16x16x32_bf16 v[204:207], a[100:103], v[28:31], v[204:207]
    v_exp_f32 v52, v68
    v_mfma_f32_16x16x32_bf16 v[208:211], a[104:107], v[24:27], v[208:211]
    ds_read_b128 a[72:75], v16 offset:51200
    v_add_f32 v9, v9, v59
    v_mfma_f32_16x16x32_bf16 v[216:219], a[104:107], v[28:31], v[216:219]
    v_exp_f32 v53, v69
    v_mfma_f32_16x16x32_bf16 v[212:215], a[108:111], v[24:27], v[212:215]
    ds_read_b128 a[76:79], v16 offset:52224
    v_add_f32 v8, v8, v52
    v_mfma_f32_16x16x32_bf16 v[220:223], a[108:111], v[28:31], v[220:223]
    s_waitcnt lgkmcnt(4)
    v_exp_f32 v54, v70
    v_mfma_f32_16x16x32_bf16 v[224:227], a[112:115], v[24:27], v[224:227]
    ds_read_b128 a[80:83], v16 offset:53248
    buffer_load_dwordx4 v0, s[64:67], s60 offen offset:3072 sc1 lds
    v_mfma_f32_16x16x32_bf16 v[232:235], a[112:115], v[28:31], v[232:235]
    buffer_load_dwordx4 a[236:239], v135, s[16:19], s28 offen offset:2048 sc1
    v_add_f32 v8, v8, v53
    v_mfma_f32_16x16x32_bf16 v[228:231], a[116:119], v[24:27], v[228:231]
    s_cmp_eq_u32 s37, s38
    ds_read_b128 a[84:87], v16 offset:54272
    v_mfma_f32_16x16x32_bf16 v[236:239], a[116:119], v[28:31], v[236:239]
    s_cbranch_scc1 .Lmain_kernel_mask_108
.Lmain_kernel_maskr_109:
    v_mfma_f32_16x16x32_bf16 v[240:243], a[120:123], v[24:27], v[240:243]
    s_add_u32 s60, s60, 16384
    ds_read_b128 a[88:91], v16 offset:55296
    v_mfma_f32_16x16x32_bf16 v[248:251], a[120:123], v[28:31], v[248:251]
    v_exp_f32 v55, v71
    v_mfma_f32_16x16x32_bf16 v[244:247], a[124:127], v[24:27], v[244:247]
    ds_read_b128 a[92:95], v16 offset:56320
    v_add_f32 v8, v8, v54
    v_mfma_f32_16x16x32_bf16 v[252:255], a[124:127], v[28:31], v[252:255]
    s_waitcnt lgkmcnt(4)
    v_exp_f32 v60, v76
    v_mfma_f32_16x16x32_bf16 v[80:83], a[64:67], a[0:3], v[112:115]
    ds_read_b128 a[96:99], v16 offset:57344
    v_add_f32 v8, v8, v55
    v_mfma_f32_16x16x32_bf16 v[88:91], a[64:67], a[4:7], v[120:123]
    v_exp_f32 v61, v77
    v_mfma_f32_16x16x32_bf16 v[84:87], a[68:71], a[0:3], v[116:119]
    ds_read_b128 a[100:103], v16 offset:58368
    v_add_f32 v9, v9, v60
    v_mfma_f32_16x16x32_bf16 v[92:95], a[68:71], a[4:7], v[124:127]
    v_exp_f32 v62, v78
    v_mfma_f32_16x16x32_bf16 v[80:83], a[72:75], a[8:11], v[80:83]
    ds_read_b128 a[104:107], v16 offset:59392
    v_add_f32 v9, v9, v61
    v_mfma_f32_16x16x32_bf16 v[88:91], a[72:75], a[12:15], v[88:91]
    v_exp_f32 v63, v79
    v_mfma_f32_16x16x32_bf16 v[84:87], a[76:79], a[8:11], v[84:87]
    ds_read_b128 a[108:111], v16 offset:60416
    v_add_f32 v9, v9, v62
    v_mfma_f32_16x16x32_bf16 v[92:95], a[76:79], a[12:15], v[92:95]
    s_waitcnt lgkmcnt(4)
    v_add_f32 v9, v9, v63
    v_add_f32 v2, v8, v9
    v_mfma_f32_16x16x32_bf16 v[80:83], a[80:83], a[16:19], v[80:83]
    ds_read_b128 a[112:115], v16 offset:61440
    v_cmp_nge_f32 vcc, 1266679808, v2
    v_mfma_f32_16x16x32_bf16 v[88:91], a[80:83], a[20:23], v[88:91]
    v_mfma_f32_16x16x32_bf16 v[84:87], a[84:87], a[16:19], v[84:87]
    s_add_u32 s28, s28, 262144
    ds_read_b128 a[116:119], v16 offset:62464
    v_mfma_f32_16x16x32_bf16 v[92:95], a[84:87], a[20:23], v[92:95]
    s_cbranch_vccnz .Lmain_kernel_rare_67
.Lmain_kernel_rarer_110:
    v_mfma_f32_16x16x32_bf16 v[80:83], a[88:91], a[24:27], v[80:83]
    ds_read_b128 a[120:123], v16 offset:63488
    v_add_f32 v22, v22, v8
    v_mfma_f32_16x16x32_bf16 v[88:91], a[88:91], a[28:31], v[88:91]
    v_add_f32 v23, v23, v9
    v_mfma_f32_16x16x32_bf16 v[84:87], a[92:95], a[24:27], v[84:87]
    s_waitcnt vmcnt(16)
    s_waitcnt lgkmcnt(3)
    ds_read_b128 a[124:127], v16 offset:64512
    v_mfma_f32_16x16x32_bf16 v[92:95], a[92:95], a[28:31], v[92:95]
    s_barrier
    v_mfma_f32_16x16x32_bf16 v[80:83], a[96:99], a[32:35], v[80:83]
    s_add_u32 m0, s76, 98304
    ds_read_b128 a[64:67], v14 offset:0
    v_cvt_pk_bf16_f32 v24, v48, v49
    v_mfma_f32_16x16x32_bf16 v[88:91], a[96:99], a[36:39], v[88:91]
    v_cvt_pk_bf16_f32 v25, v50, v51
    v_mfma_f32_16x16x32_bf16 v[84:87], a[100:103], a[32:35], v[84:87]
    ds_read_b128 a[68:71], v14 offset:1024
    buffer_load_dwordx4 v0, s[16:19], s39 offen offset:0 sc1 lds
    v_mfma_f32_16x16x32_bf16 v[92:95], a[100:103], a[36:39], v[92:95]
    v_cvt_pk_bf16_f32 v26, v52, v53
    v_mfma_f32_16x16x32_bf16 v[80:83], a[104:107], a[40:43], v[80:83]
    ds_read_b128 a[72:75], v14 offset:2048
    v_mfma_f32_16x16x32_bf16 v[88:91], a[104:107], a[44:47], v[88:91]
    buffer_load_dwordx4 v0, s[16:19], s39 offen offset:1024 sc1 lds
    v_cvt_pk_bf16_f32 v27, v54, v55
    v_mfma_f32_16x16x32_bf16 v[84:87], a[108:111], a[40:43], v[84:87]
    ds_read_b128 a[76:79], v14 offset:3072
    v_mfma_f32_16x16x32_bf16 v[92:95], a[108:111], a[44:47], v[92:95]
    s_waitcnt lgkmcnt(4)
    v_cvt_pk_bf16_f32 v28, v56, v57
    v_mfma_f32_16x16x32_bf16 v[80:83], a[112:115], a[48:51], v[80:83]
    ds_read_b128 a[80:83], v14 offset:4096
    buffer_load_dwordx4 v0, s[16:19], s39 offen offset:2048 sc1 lds
    v_mfma_f32_16x16x32_bf16 v[88:91], a[112:115], a[52:55], v[88:91]
    v_cvt_pk_bf16_f32 v29, v58, v59
    v_mfma_f32_16x16x32_bf16 v[84:87], a[116:119], a[48:51], v[84:87]
    ds_read_b128 a[84:87], v14 offset:5120
    buffer_load_dwordx4 v0, s[16:19], s39 offen offset:3072 sc1 lds
    v_mfma_f32_16x16x32_bf16 v[92:95], a[116:119], a[52:55], v[92:95]
    v_cvt_pk_bf16_f32 v30, v60, v61
    v_mfma_f32_16x16x32_bf16 v[80:83], a[120:123], a[56:59], v[80:83]
    ds_read_b128 a[88:91], v14 offset:6144
    v_mfma_f32_16x16x32_bf16 v[88:91], a[120:123], a[60:63], v[88:91]
    s_add_u32 s39, s39, 16384
    v_cvt_pk_bf16_f32 v31, v62, v63
    v_mfma_f32_16x16x32_bf16 v[84:87], a[124:127], a[56:59], v[84:87]
    ds_read_b128 a[92:95], v14 offset:7168
    v_mfma_f32_16x16x32_bf16 v[92:95], a[124:127], a[60:63], v[92:95]
    s_waitcnt lgkmcnt(4)
    s_cmp_eq_u32 s37, 0
    s_cbranch_scc1 .Lmain_kernel_tail_42
.Lmain_kernel_it_48:
    v_mfma_f32_16x16x32_bf16 v[32:35], a[64:67], v[24:27], v[32:35]
    s_sub_u32 s37, s37, 1
    ds_read_b128 a[96:99], v14 offset:8192
    v_mfma_f32_16x16x32_bf16 v[40:43], a[64:67], v[28:31], v[40:43]
    v_exp_f32 v48, v80
    v_mfma_f32_16x16x32_bf16 v[36:39], a[68:71], v[24:27], v[36:39]
    s_add_u32 m0, s76, 49152
    ds_read_b128 a[100:103], v14 offset:9216
    buffer_load_dwordx4 a[240:243], v14, s[16:19], s28 offen offset:0 sc1
    v_mfma_f32_16x16x32_bf16 v[44:47], a[68:71], v[28:31], v[44:47]
    v_exp_f32 v49, v81
    v_mfma_f32_16x16x32_bf16 v[96:99], a[72:75], v[24:27], v[96:99]
    ds_read_b128 a[104:107], v14 offset:10240
    v_mfma_f32_16x16x32_bf16 v[104:107], a[72:75], v[28:31], v[104:107]
    v_exp_f32 v50, v82
    v_mfma_f32_16x16x32_bf16 v[100:103], a[76:79], v[24:27], v[100:103]
    ds_read_b128 a[108:111], v14 offset:11264
    v_add_f32 v8, v48, v49
    v_mfma_f32_16x16x32_bf16 v[108:111], a[76:79], v[28:31], v[108:111]
    s_waitcnt lgkmcnt(4)
    v_exp_f32 v51, v83
    v_mfma_f32_16x16x32_bf16 v[160:163], a[80:83], v[24:27], v[160:163]
    ds_read_b128 a[112:115], v14 offset:12288
    v_add_f32 v8, v8, v50
    v_mfma_f32_16x16x32_bf16 v[168:171], a[80:83], v[28:31], v[168:171]
    v_exp_f32 v56, v88
    v_mfma_f32_16x16x32_bf16 v[164:167], a[84:87], v[24:27], v[164:167]
    s_add_u32 s26, s26, 1
    ds_read_b128 a[116:119], v14 offset:13312
    v_add_f32 v8, v8, v51
    v_mfma_f32_16x16x32_bf16 v[172:175], a[84:87], v[28:31], v[172:175]
    v_exp_f32 v57, v89
    v_mfma_f32_16x16x32_bf16 v[176:179], a[88:91], v[24:27], v[176:179]
    ds_read_b128 a[120:123], v14 offset:14336
    buffer_load_dwordx4 v0, s[64:67], s60 offen offset:0 sc1 lds
    v_mfma_f32_16x16x32_bf16 v[184:187], a[88:91], v[28:31], v[184:187]
    v_exp_f32 v58, v90
    v_mfma_f32_16x16x32_bf16 v[180:183], a[92:95], v[24:27], v[180:183]
    ds_read_b128 a[124:127], v14 offset:15360
    buffer_load_dwordx4 v0, s[64:67], s60 offen offset:1024 sc1 lds
    v_mfma_f32_16x16x32_bf16 v[188:191], a[92:95], v[28:31], v[188:191]
    s_waitcnt lgkmcnt(4)
    v_add_f32 v9, v56, v57
    v_mfma_f32_16x16x32_bf16 v[192:195], a[96:99], v[24:27], v[192:195]
    ds_read_b128 a[64:67], v16 offset:0
    buffer_load_dwordx4 v0, s[64:67], s60 offen offset:2048 sc1 lds
    v_mfma_f32_16x16x32_bf16 v[200:203], a[96:99], v[28:31], v[200:203]
    v_exp_f32 v59, v91
    v_mfma_f32_16x16x32_bf16 v[196:199], a[100:103], v[24:27], v[196:199]
    ds_read_b128 a[68:71], v16 offset:1024
    v_add_f32 v9, v9, v58
    v_mfma_f32_16x16x32_bf16 v[204:207], a[100:103], v[28:31], v[204:207]
    v_exp_f32 v52, v84
    v_mfma_f32_16x16x32_bf16 v[208:211], a[104:107], v[24:27], v[208:211]
    ds_read_b128 a[72:75], v16 offset:2048
    v_add_f32 v9, v9, v59
    v_mfma_f32_16x16x32_bf16 v[216:219], a[104:107], v[28:31], v[216:219]
    v_exp_f32 v53, v85
    v_mfma_f32_16x16x32_bf16 v[212:215], a[108:111], v[24:27], v[212:215]
    ds_read_b128 a[76:79], v16 offset:3072
    v_add_f32 v8, v8, v52
    v_mfma_f32_16x16x32_bf16 v[220:223], a[108:111], v[28:31], v[220:223]
    s_waitcnt lgkmcnt(4)
    v_exp_f32 v54, v86
    v_mfma_f32_16x16x32_bf16 v[224:227], a[112:115], v[24:27], v[224:227]
    ds_read_b128 a[80:83], v16 offset:4096
    buffer_load_dwordx4 v0, s[64:67], s60 offen offset:3072 sc1 lds
    v_mfma_f32_16x16x32_bf16 v[232:235], a[112:115], v[28:31], v[232:235]
    v_add_f32 v8, v8, v53
    v_mfma_f32_16x16x32_bf16 v[228:231], a[116:119], v[24:27], v[228:231]
    s_cmp_eq_u32 s37, s38
    ds_read_b128 a[84:87], v16 offset:5120
    v_mfma_f32_16x16x32_bf16 v[236:239], a[116:119], v[28:31], v[236:239]
    s_cbranch_scc1 .Lmain_kernel_mask_112
.Lmain_kernel_maskr_113:
    v_mfma_f32_16x16x32_bf16 v[240:243], a[120:123], v[24:27], v[240:243]
    s_add_u32 s60, s60, 16384
    ds_read_b128 a[88:91], v16 offset:6144
    v_mfma_f32_16x16x32_bf16 v[248:251], a[120:123], v[28:31], v[248:251]
    v_exp_f32 v55, v87
    v_mfma_f32_16x16x32_bf16 v[244:247], a[124:127], v[24:27], v[244:247]
    ds_read_b128 a[92:95], v16 offset:7168
    v_add_f32 v8, v8, v54
    v_mfma_f32_16x16x32_bf16 v[252:255], a[124:127], v[28:31], v[252:255]
    s_waitcnt lgkmcnt(4)
    v_exp_f32 v60, v92
    v_mfma_f32_16x16x32_bf16 v[64:67], a[64:67], a[0:3], v[112:115]
    ds_read_b128 a[96:99], v16 offset:8192
    v_add_f32 v8, v8, v55
    v_mfma_f32_16x16x32_bf16 v[72:75], a[64:67], a[4:7], v[120:123]
    v_exp_f32 v61, v93
    v_mfma_f32_16x16x32_bf16 v[68:71], a[68:71], a[0:3], v[116:119]
    ds_read_b128 a[100:103], v16 offset:9216
    v_add_f32 v9, v9, v60
    v_mfma_f32_16x16x32_bf16 v[76:79], a[68:71], a[4:7], v[124:127]
    v_exp_f32 v62, v94
    v_mfma_f32_16x16x32_bf16 v[64:67], a[72:75], a[8:11], v[64:67]
    ds_read_b128 a[104:107], v16 offset:10240
    v_add_f32 v9, v9, v61
    v_mfma_f32_16x16x32_bf16 v[72:75], a[72:75], a[12:15], v[72:75]
    v_exp_f32 v63, v95
    v_mfma_f32_16x16x32_bf16 v[68:71], a[76:79], a[8:11], v[68:71]
    ds_read_b128 a[108:111], v16 offset:11264
    v_add_f32 v9, v9, v62
    v_mfma_f32_16x16x32_bf16 v[76:79], a[76:79], a[12:15], v[76:79]
    s_waitcnt lgkmcnt(4)
    v_add_f32 v9, v9, v63
    v_add_f32 v2, v8, v9
    v_mfma_f32_16x16x32_bf16 v[64:67], a[80:83], a[16:19], v[64:67]
    ds_read_b128 a[112:115], v16 offset:12288
    v_cmp_nge_f32 vcc, 1266679808, v2
    v_mfma_f32_16x16x32_bf16 v[72:75], a[80:83], a[20:23], v[72:75]
    buffer_load_dwordx4 a[244:247], v14, s[16:19], s28 offen offset:1024 sc1
    v_mfma_f32_16x16x32_bf16 v[68:71], a[84:87], a[16:19], v[68:71]
    ds_read_b128 a[116:119], v16 offset:13312
    v_mfma_f32_16x16x32_bf16 v[76:79], a[84:87], a[20:23], v[76:79]
    s_cbranch_vccnz .Lmain_kernel_rare_54
.Lmain_kernel_rarer_114:
    v_mfma_f32_16x16x32_bf16 v[64:67], a[88:91], a[24:27], v[64:67]
    ds_read_b128 a[120:123], v16 offset:14336
    v_add_f32 v22, v22, v8
    v_mfma_f32_16x16x32_bf16 v[72:75], a[88:91], a[28:31], v[72:75]
    v_add_f32 v23, v23, v9
    v_mfma_f32_16x16x32_bf16 v[68:71], a[92:95], a[24:27], v[68:71]
    s_waitcnt vmcnt(16)
    s_waitcnt lgkmcnt(3)
    ds_read_b128 a[124:127], v16 offset:15360
    v_mfma_f32_16x16x32_bf16 v[76:79], a[92:95], a[28:31], v[76:79]
    s_barrier
    v_mfma_f32_16x16x32_bf16 v[64:67], a[96:99], a[32:35], v[64:67]
    s_add_u32 m0, s76, 114688
    ds_read_b128 a[64:67], v14 offset:16384
    v_cvt_pk_bf16_f32 v24, v48, v49
    v_mfma_f32_16x16x32_bf16 v[72:75], a[96:99], a[36:39], v[72:75]
    buffer_load_dwordx4 v0, s[16:19], s39 offen offset:0 sc1 lds
    v_cvt_pk_bf16_f32 v25, v50, v51
    v_mfma_f32_16x16x32_bf16 v[68:71], a[100:103], a[32:35], v[68:71]
    ds_read_b128 a[68:71], v14 offset:17408
    v_mfma_f32_16x16x32_bf16 v[76:79], a[100:103], a[36:39], v[76:79]
    buffer_load_dwordx4 v0, s[16:19], s39 offen offset:1024 sc1 lds
    v_cvt_pk_bf16_f32 v26, v52, v53
    v_mfma_f32_16x16x32_bf16 v[64:67], a[104:107], a[40:43], v[64:67]
    ds_read_b128 a[72:75], v14 offset:18432
    buffer_load_dwordx4 v0, s[16:19], s39 offen offset:2048 sc1 lds
    v_mfma_f32_16x16x32_bf16 v[72:75], a[104:107], a[44:47], v[72:75]
    v_cvt_pk_bf16_f32 v27, v54, v55
    v_mfma_f32_16x16x32_bf16 v[68:71], a[108:111], a[40:43], v[68:71]
    ds_read_b128 a[76:79], v14 offset:19456
    buffer_load_dwordx4 v0, s[16:19], s39 offen offset:3072 sc1 lds
    v_mfma_f32_16x16x32_bf16 v[76:79], a[108:111], a[44:47], v[76:79]
    s_waitcnt lgkmcnt(4)
    v_cvt_pk_bf16_f32 v28, v56, v57
    v_mfma_f32_16x16x32_bf16 v[64:67], a[112:115], a[48:51], v[64:67]
    s_add_u32 s39, s39, 16384
    ds_read_b128 a[80:83], v14 offset:20480
    v_mfma_f32_16x16x32_bf16 v[72:75], a[112:115], a[52:55], v[72:75]
    s_cmp_eq_u32 s39, s61
    s_cselect_b32 s39, s62, s39
    s_cselect_b32 s61, s5, s61
    v_mfma_f32_16x16x32_bf16 v[68:71], a[116:119], a[48:51], v[68:71]
    s_cselect_b32 s62, 1073741824, s62
    ds_read_b128 a[84:87], v14 offset:21504
    v_cvt_pk_bf16_f32 v29, v58, v59
    v_mfma_f32_16x16x32_bf16 v[76:79], a[116:119], a[52:55], v[76:79]
    v_cvt_pk_bf16_f32 v30, v60, v61
    v_mfma_f32_16x16x32_bf16 v[64:67], a[120:123], a[56:59], v[64:67]
    ds_read_b128 a[88:91], v14 offset:22528
    v_mfma_f32_16x16x32_bf16 v[72:75], a[120:123], a[60:63], v[72:75]
    v_cvt_pk_bf16_f32 v31, v62, v63
    v_mfma_f32_16x16x32_bf16 v[68:71], a[124:127], a[56:59], v[68:71]
    ds_read_b128 a[92:95], v14 offset:23552
    v_mfma_f32_16x16x32_bf16 v[76:79], a[124:127], a[60:63], v[76:79]
    s_waitcnt lgkmcnt(4)
    v_mfma_f32_16x16x32_bf16 v[32:35], a[64:67], v[24:27], v[32:35]
    ds_read_b128 a[96:99], v14 offset:24576
    v_mfma_f32_16x16x32_bf16 v[40:43], a[64:67], v[28:31], v[40:43]
    v_exp_f32 v48, v64
    v_mfma_f32_16x16x32_bf16 v[36:39], a[68:71], v[24:27], v[36:39]
    s_add_u32 m0, s76, 0
    ds_read_b128 a[100:103], v14 offset:25600
    v_mfma_f32_16x16x32_bf16 v[44:47], a[68:71], v[28:31], v[44:47]
    v_exp_f32 v49, v65
    v_mfma_f32_16x16x32_bf16 v[96:99], a[72:75], v[24:27], v[96:99]
    ds_read_b128 a[104:107], v14 offset:26624
    v_mfma_f32_16x16x32_bf16 v[104:107], a[72:75], v[28:31], v[104:107]
    v_exp_f32 v50, v66
    v_mfma_f32_16x16x32_bf16 v[100:103], a[76:79], v[24:27], v[100:103]
    ds_read_b128 a[108:111], v14 offset:27648
    v_add_f32 v8, v48, v49
    v_mfma_f32_16x16x32_bf16 v[108:111], a[76:79], v[28:31], v[108:111]
    s_waitcnt lgkmcnt(4)
    v_exp_f32 v51, v67
    v_mfma_f32_16x16x32_bf16 v[160:163], a[80:83], v[24:27], v[160:163]
    ds_read_b128 a[112:115], v14 offset:28672
    v_add_f32 v8, v8, v50
    v_mfma_f32_16x16x32_bf16 v[168:171], a[80:83], v[28:31], v[168:171]
    v_exp_f32 v56, v72
    v_mfma_f32_16x16x32_bf16 v[164:167], a[84:87], v[24:27], v[164:167]
    ds_read_b128 a[116:119], v14 offset:29696
    v_add_f32 v8, v8, v51
    v_mfma_f32_16x16x32_bf16 v[172:175], a[84:87], v[28:31], v[172:175]
    v_exp_f32 v57, v73
    v_mfma_f32_16x16x32_bf16 v[176:179], a[88:91], v[24:27], v[176:179]
    ds_read_b128 a[120:123], v14 offset:30720
    buffer_load_dwordx4 v0, s[64:67], s60 offen offset:0 sc1 lds
    v_mfma_f32_16x16x32_bf16 v[184:187], a[88:91], v[28:31], v[184:187]
    v_exp_f32 v58, v74
    v_mfma_f32_16x16x32_bf16 v[180:183], a[92:95], v[24:27], v[180:183]
    ds_read_b128 a[124:127], v14 offset:31744
    buffer_load_dwordx4 v0, s[64:67], s60 offen offset:1024 sc1 lds
    v_mfma_f32_16x16x32_bf16 v[188:191], a[92:95], v[28:31], v[188:191]
    s_waitcnt lgkmcnt(4)
    v_add_f32 v9, v56, v57
    v_mfma_f32_16x16x32_bf16 a[248:251], v[136:139], a[192:195], 0
    v_mfma_f32_16x16x32_bf16 v[192:195], a[96:99], v[24:27], v[192:195]
    ds_read_b128 a[64:67], v16 offset:16384
    buffer_load_dwordx4 v0, s[64:67], s60 offen offset:2048 sc1 lds
    v_mfma_f32_16x16x32_bf16 v[200:203], a[96:99], v[28:31], v[200:203]
    v_exp_f32 v59, v75
    v_mfma_f32_16x16x32_bf16 v[196:199], a[100:103], v[24:27], v[196:199]
    ds_read_b128 a[68:71], v16 offset:17408
    v_add_f32 v9, v9, v58
    v_mfma_f32_16x16x32_bf16 v[204:207], a[100:103], v[28:31], v[204:207]
    v_exp_f32 v52, v68
    v_mfma_f32_16x16x32_bf16 v[208:211], a[104:107], v[24:27], v[208:211]
    ds_read_b128 a[72:75], v16 offset:18432
    v_add_f32 v9, v9, v59
    v_mfma_f32_16x16x32_bf16 v[216:219], a[104:107], v[28:31], v[216:219]
    v_exp_f32 v53, v69
    v_mfma_f32_16x16x32_bf16 v[212:215], a[108:111], v[24:27], v[212:215]
    ds_read_b128 a[76:79], v16 offset:19456
    v_add_f32 v8, v8, v52
    v_mfma_f32_16x16x32_bf16 v[220:223], a[108:111], v[28:31], v[220:223]
    s_waitcnt lgkmcnt(4)
    v_exp_f32 v54, v70
    v_mfma_f32_16x16x32_bf16 v[224:227], a[112:115], v[24:27], v[224:227]
    ds_read_b128 a[80:83], v16 offset:20480
    buffer_load_dwordx4 v0, s[64:67], s60 offen offset:3072 sc1 lds
    v_mfma_f32_16x16x32_bf16 v[232:235], a[112:115], v[28:31], v[232:235]
    buffer_load_dwordx4 a[192:195], v134, s[16:19], s28 offen offset:2048 sc1
    v_add_f32 v8, v8, v53
    v_mfma_f32_16x16x32_bf16 v[228:231], a[116:119], v[24:27], v[228:231]
    s_cmp_eq_u32 s37, s38
    ds_read_b128 a[84:87], v16 offset:21504
    v_mfma_f32_16x16x32_bf16 v[236:239], a[116:119], v[28:31], v[236:239]
    s_cbranch_scc1 .Lmain_kernel_mask_115
.Lmain_kernel_maskr_116:
    v_mfma_f32_16x16x32_bf16 v[240:243], a[120:123], v[24:27], v[240:243]
    s_add_u32 s60, s60, 16384
    ds_read_b128 a[88:91], v16 offset:22528
    v_mfma_f32_16x16x32_bf16 v[248:251], a[120:123], v[28:31], v[248:251]
    v_exp_f32 v55, v71
    v_mfma_f32_16x16x32_bf16 v[244:247], a[124:127], v[24:27], v[244:247]
    ds_read_b128 a[92:95], v16 offset:23552
    v_add_f32 v8, v8, v54
    v_mfma_f32_16x16x32_bf16 v[252:255], a[124:127], v[28:31], v[252:255]
    s_waitcnt lgkmcnt(4)
    v_exp_f32 v60, v76
    v_mfma_f32_16x16x32_bf16 v[80:83], a[64:67], a[0:3], v[112:115]
    ds_read_b128 a[96:99], v16 offset:24576
    v_add_f32 v8, v8, v55
    v_mfma_f32_16x16x32_bf16 v[88:91], a[64:67], a[4:7], v[120:123]
    v_exp_f32 v61, v77
    v_mfma_f32_16x16x32_bf16 v[84:87], a[68:71], a[0:3], v[116:119]
    ds_read_b128 a[100:103], v16 offset:25600
    v_add_f32 v9, v9, v60
    v_mfma_f32_16x16x32_bf16 v[92:95], a[68:71], a[4:7], v[124:127]
    v_exp_f32 v62, v78
    v_mfma_f32_16x16x32_bf16 v[80:83], a[72:75], a[8:11], v[80:83]
    ds_read_b128 a[104:107], v16 offset:26624
    v_add_f32 v9, v9, v61
    v_mfma_f32_16x16x32_bf16 v[88:91], a[72:75], a[12:15], v[88:91]
    v_exp_f32 v63, v79
    v_mfma_f32_16x16x32_bf16 v[84:87], a[76:79], a[8:11], v[84:87]
    ds_read_b128 a[108:111], v16 offset:27648
    v_add_f32 v9, v9, v62
    v_mfma_f32_16x16x32_bf16 v[92:95], a[76:79], a[12:15], v[92:95]
    s_waitcnt lgkmcnt(4)
    v_add_f32 v9, v9, v63
    v_add_f32 v2, v8, v9
    v_mfma_f32_16x16x32_bf16 v[80:83], a[80:83], a[16:19], v[80:83]
    ds_read_b128 a[112:115], v16 offset:28672
    v_cmp_nge_f32 vcc, 1266679808, v2
    v_mfma_f32_16x16x32_bf16 v[88:91], a[80:83], a[20:23], v[88:91]
    v_mfma_f32_16x16x32_bf16 a[248:251], v[136:139], a[196:199], a[248:251]
    v_mfma_f32_16x16x32_bf16 v[84:87], a[84:87], a[16:19], v[84:87]
    ds_read_b128 a[116:119], v16 offset:29696
    v_mfma_f32_16x16x32_bf16 v[92:95], a[84:87], a[20:23], v[92:95]
    s_cbranch_vccnz .Lmain_kernel_rare_59
.Lmain_kernel_rarer_117:
    v_mfma_f32_16x16x32_bf16 v[80:83], a[88:91], a[24:27], v[80:83]
    ds_read_b128 a[120:123], v16 offset:30720
    v_add_f32 v22, v22, v8
    v_mfma_f32_16x16x32_bf16 v[88:91], a[88:91], a[28:31], v[88:91]
    buffer_load_dwordx4 a[196:199], v135, s[16:19], s28 offen offset:2048 sc1
    v_add_f32 v23, v23, v9
    v_mfma_f32_16x16x32_bf16 v[84:87], a[92:95], a[24:27], v[84:87]
    s_waitcnt vmcnt(16)
    s_waitcnt lgkmcnt(3)
    ds_read_b128 a[124:127], v16 offset:31744
    v_mfma_f32_16x16x32_bf16 v[92:95], a[92:95], a[28:31], v[92:95]
    s_barrier
    v_mfma_f32_16x16x32_bf16 v[80:83], a[96:99], a[32:35], v[80:83]
    s_add_u32 m0, s76, 65536
    ds_read_b128 a[64:67], v14 offset:32768
    v_cvt_pk_bf16_f32 v24, v48, v49
    v_mfma_f32_16x16x32_bf16 v[88:91], a[96:99], a[36:39], v[88:91]
    v_cvt_pk_bf16_f32 v25, v50, v51
    v_mfma_f32_16x16x32_bf16 v[84:87], a[100:103], a[32:35], v[84:87]
    ds_read_b128 a[68:71], v14 offset:33792
    buffer_load_dwordx4 v0, s[16:19], s39 offen offset:0 sc1 lds
    v_mfma_f32_16x16x32_bf16 v[92:95], a[100:103], a[36:39], v[92:95]
    v_cvt_pk_bf16_f32 v26, v52, v53
    v_mfma_f32_16x16x32_bf16 v[80:83], a[104:107], a[40:43], v[80:83]
    ds_read_b128 a[72:75], v14 offset:34816
    v_mfma_f32_16x16x32_bf16 v[88:91], a[104:107], a[44:47], v[88:91]
    buffer_load_dwordx4 v0, s[16:19], s39 offen offset:1024 sc1 lds
    v_cvt_pk_bf16_f32 v27, v54, v55
    v_mfma_f32_16x16x32_bf16 v[84:87], a[108:111], a[40:43], v[84:87]
    s_add_u32 s28, s28, 262144
    ds_read_b128 a[76:79], v14 offset:35840
    v_mfma_f32_16x16x32_bf16 v[92:95], a[108:111], a[44:47], v[92:95]
    s_waitcnt lgkmcnt(4)
    v_cvt_pk_bf16_f32 v28, v56, v57
    v_mfma_f32_16x16x32_bf16 v[80:83], a[112:115], a[48:51], v[80:83]
    ds_read_b128 a[80:83], v14 offset:36864
    buffer_load_dwordx4 v0, s[16:19], s39 offen offset:2048 sc1 lds
    v_mfma_f32_16x16x32_bf16 v[88:91], a[112:115], a[52:55], v[88:91]
    v_cvt_pk_bf16_f32 v29, v58, v59
    v_mfma_f32_16x16x32_bf16 v[84:87], a[116:119], a[48:51], v[84:87]
    ds_read_b128 a[84:87], v14 offset:37888
    buffer_load_dwordx4 v0, s[16:19], s39 offen offset:3072 sc1 lds
    v_mfma_f32_16x16x32_bf16 v[92:95], a[116:119], a[52:55], v[92:95]
    v_cvt_pk_bf16_f32 v30, v60, v61
    v_mfma_f32_16x16x32_bf16 v[80:83], a[120:123], a[56:59], v[80:83]
    ds_read_b128 a[88:91], v14 offset:38912
    v_mfma_f32_16x16x32_bf16 v[88:91], a[120:123], a[60:63], v[88:91]
    s_add_u32 s39, s39, 16384
    v_cvt_pk_bf16_f32 v31, v62, v63
    v_mfma_f32_16x16x32_bf16 v[84:87], a[124:127], a[56:59], v[84:87]
    ds_read_b128 a[92:95], v14 offset:39936
    v_mfma_f32_16x16x32_bf16 v[92:95], a[124:127], a[60:63], v[92:95]
    s_waitcnt lgkmcnt(4)
    v_mfma_f32_16x16x32_bf16 v[32:35], a[64:67], v[24:27], v[32:35]
    ds_read_b128 a[96:99], v14 offset:40960
    v_mfma_f32_16x16x32_bf16 v[40:43], a[64:67], v[28:31], v[40:43]
    v_exp_f32 v48, v80
    v_mfma_f32_16x16x32_bf16 v[36:39], a[68:71], v[24:27], v[36:39]
    s_add_u32 m0, s76, 16384
    ds_read_b128 a[100:103], v14 offset:41984
    v_mfma_f32_16x16x32_bf16 v[44:47], a[68:71], v[28:31], v[44:47]
    v_exp_f32 v49, v81
    v_mfma_f32_16x16x32_bf16 v[96:99], a[72:75], v[24:27], v[96:99]
    ds_read_b128 a[104:107], v14 offset:43008
    buffer_load_dwordx4 v0, s[64:67], s60 offen offset:0 sc1 lds
    v_mfma_f32_16x16x32_bf16 v[104:107], a[72:75], v[28:31], v[104:107]
    v_exp_f32 v50, v82
    v_mfma_f32_16x16x32_bf16 v[100:103], a[76:79], v[24:27], v[100:103]
    ds_read_b128 a[108:111], v14 offset:44032
    v_add_f32 v8, v48, v49
    v_mfma_f32_16x16x32_bf16 v[108:111], a[76:79], v[28:31], v[108:111]
    s_waitcnt lgkmcnt(4)
    v_exp_f32 v51, v83
    v_mfma_f32_16x16x32_bf16 v[160:163], a[80:83], v[24:27], v[160:163]
    ds_read_b128 a[112:115], v14 offset:45056
    v_add_f32 v8, v8, v50
    v_mfma_f32_16x16x32_bf16 v[168:171], a[80:83], v[28:31], v[168:171]
    v_exp_f32 v56, v88
    v_mfma_f32_16x16x32_bf16 v[164:167], a[84:87], v[24:27], v[164:167]
    ds_read_b128 a[116:119], v14 offset:46080
    v_add_f32 v8, v8, v51
    v_mfma_f32_16x16x32_bf16 v[172:175], a[84:87], v[28:31], v[172:175]
    v_exp_f32 v57, v89
    v_mfma_f32_16x16x32_bf16 v[176:179], a[88:91], v[24:27], v[176:179]
    ds_read_b128 a[120:123], v14 offset:47104
    buffer_load_dwordx4 v0, s[64:67], s60 offen offset:1024 sc1 lds
    v_mfma_f32_16x16x32_bf16 v[184:187], a[88:91], v[28:31], v[184:187]
    v_exp_f32 v58, v90
    v_mfma_f32_16x16x32_bf16 v[180:183], a[92:95], v[24:27], v[180:183]
    ds_read_b128 a[124:127], v14 offset:48128
    buffer_load_dwordx4 v0, s[64:67], s60 offen offset:2048 sc1 lds
    v_mfma_f32_16x16x32_bf16 v[188:191], a[92:95], v[28:31], v[188:191]
    s_waitcnt lgkmcnt(4)
    buffer_load_dwordx4 v0, s[64:67], s60 offen offset:3072 sc1 lds
    v_add_f32 v9, v56, v57
    v_mfma_f32_16x16x32_bf16 v[192:195], a[96:99], v[24:27], v[192:195]
    s_add_u32 s60, s60, 16384
    ds_read_b128 a[64:67], v16 offset:32768
    v_mfma_f32_16x16x32_bf16 a[248:251], v[136:139], a[200:203], a[248:251]
    v_mfma_f32_16x16x32_bf16 v[200:203], a[96:99], v[28:31], v[200:203]
    v_exp_f32 v59, v91
    v_mfma_f32_16x16x32_bf16 v[196:199], a[100:103], v[24:27], v[196:199]
    ds_read_b128 a[68:71], v16 offset:33792
    v_add_f32 v9, v9, v58
    v_mfma_f32_16x16x32_bf16 v[204:207], a[100:103], v[28:31], v[204:207]
    s_cmp_eq_u32 s60, s63
    v_exp_f32 v52, v84
    v_mfma_f32_16x16x32_bf16 v[208:211], a[104:107], v[24:27], v[208:211]
    s_cselect_b32 s60, s4, s60
    ds_read_b128 a[72:75], v16 offset:34816
    v_add_f32 v9, v9, v59
    v_mfma_f32_16x16x32_bf16 v[216:219], a[104:107], v[28:31], v[216:219]
    s_cselect_b32 s63, s5, s63
    v_exp_f32 v53, v85
    v_mfma_f32_16x16x32_bf16 v[212:215], a[108:111], v[24:27], v[212:215]
    s_cselect_b32 s4, 1073741824, s4
    ds_read_b128 a[76:79], v16 offset:35840
    v_add_f32 v8, v8, v52
    v_mfma_f32_16x16x32_bf16 v[220:223], a[108:111], v[28:31], v[220:223]
    s_waitcnt lgkmcnt(4)
    v_exp_f32 v54, v86
    v_mfma_f32_16x16x32_bf16 v[224:227], a[112:115], v[24:27], v[224:227]
    ds_read_b128 a[80:83], v16 offset:36864
    buffer_load_dwordx4 a[200:203], v14, s[16:19], s28 offen offset:0 sc1
    v_mfma_f32_16x16x32_bf16 v[232:235], a[112:115], v[28:31], v[232:235]
    v_add_f32 v8, v8, v53
    v_mfma_f32_16x16x32_bf16 v[228:231], a[116:119], v[24:27], v[228:231]
    s_cmp_eq_u32 s37, s38
    ds_read_b128 a[84:87], v16 offset:37888
    v_mfma_f32_16x16x32_bf16 v[236:239], a[116:119], v[28:31], v[236:239]
    s_cbranch_scc1 .Lmain_kernel_mask_118
.Lmain_kernel_maskr_119:
    v_mfma_f32_16x16x32_bf16 v[240:243], a[120:123], v[24:27], v[240:243]
    ds_read_b128 a[88:91], v16 offset:38912
    v_mfma_f32_16x16x32_bf16 v[248:251], a[120:123], v[28:31], v[248:251]
    v_exp_f32 v55, v87
    v_mfma_f32_16x16x32_bf16 v[244:247], a[124:127], v[24:27], v[244:247]
    ds_read_b128 a[92:95], v16 offset:39936
    v_add_f32 v8, v8, v54
    v_mfma_f32_16x16x32_bf16 v[252:255], a[124:127], v[28:31], v[252:255]
    s_waitcnt lgkmcnt(4)
    v_exp_f32 v60, v92
    v_mfma_f32_16x16x32_bf16 v[64:67], a[64:67], a[0:3], v[112:115]
    ds_read_b128 a[96:99], v16 offset:40960
    v_add_f32 v8, v8, v55
    v_mfma_f32_16x16x32_bf16 v[72:75], a[64:67], a[4:7], v[120:123]
    v_exp_f32 v61, v93
    v_mfma_f32_16x16x32_bf16 v[68:71], a[68:71], a[0:3], v[116:119]
    ds_read_b128 a[100:103], v16 offset:41984
    v_add_f32 v9, v9, v60
    v_mfma_f32_16x16x32_bf16 v[76:79], a[68:71], a[4:7], v[124:127]
    v_exp_f32 v62, v94
    v_mfma_f32_16x16x32_bf16 v[64:67], a[72:75], a[8:11], v[64:67]
    ds_read_b128 a[104:107], v16 offset:43008
    v_add_f32 v9, v9, v61
    v_mfma_f32_16x16x32_bf16 v[72:75], a[72:75], a[12:15], v[72:75]
    v_exp_f32 v63, v95
    v_mfma_f32_16x16x32_bf16 v[68:71], a[76:79], a[8:11], v[68:71]
    ds_read_b128 a[108:111], v16 offset:44032
    v_add_f32 v9, v9, v62
    v_mfma_f32_16x16x32_bf16 v[76:79], a[76:79], a[12:15], v[76:79]
    s_waitcnt lgkmcnt(4)
    v_add_f32 v9, v9, v63
    v_add_f32 v2, v8, v9
    v_mfma_f32_16x16x32_bf16 v[64:67], a[80:83], a[16:19], v[64:67]
    ds_read_b128 a[112:115], v16 offset:45056
    v_cmp_nge_f32 vcc, 1266679808, v2
    v_mfma_f32_16x16x32_bf16 v[72:75], a[80:83], a[20:23], v[72:75]
    v_mfma_f32_16x16x32_bf16 v[68:71], a[84:87], a[16:19], v[68:71]
    ds_read_b128 a[116:119], v16 offset:46080
    v_mfma_f32_16x16x32_bf16 a[248:251], v[136:139], a[204:207], a[248:251]
    v_mfma_f32_16x16x32_bf16 v[76:79], a[84:87], a[20:23], v[76:79]
    s_cbranch_vccnz .Lmain_kernel_rare_63
.Lmain_kernel_rarer_120:
    v_mfma_f32_16x16x32_bf16 v[64:67], a[88:91], a[24:27], v[64:67]
    ds_read_b128 a[120:123], v16 offset:47104
    v_add_f32 v22, v22, v8
    v_mfma_f32_16x16x32_bf16 v[72:75], a[88:91], a[28:31], v[72:75]
    v_add_f32 v23, v23, v9
    v_mfma_f32_16x16x32_bf16 v[68:71], a[92:95], a[24:27], v[68:71]
    s_waitcnt vmcnt(15)
    s_waitcnt lgkmcnt(3)
    ds_read_b128 a[124:127], v16 offset:48128
    v_mfma_f32_16x16x32_bf16 v[76:79], a[92:95], a[28:31], v[76:79]
    s_barrier
    v_mfma_f32_16x16x32_bf16 v[64:67], a[96:99], a[32:35], v[64:67]
    s_add_u32 m0, s76, 81920
    ds_read_b128 a[64:67], v14 offset:49152
    v_cvt_pk_bf16_f32 v24, v48, v49
    v_mfma_f32_16x16x32_bf16 v[72:75], a[96:99], a[36:39], v[72:75]
    v_cvt_pk_bf16_f32 v25, v50, v51
    v_mfma_f32_16x16x32_bf16 v[68:71], a[100:103], a[32:35], v[68:71]
    ds_read_b128 a[68:71], v14 offset:50176
    buffer_load_dwordx4 v0, s[16:19], s39 offen offset:0 sc1 lds
    v_mfma_f32_16x16x32_bf16 v[76:79], a[100:103], a[36:39], v[76:79]
    v_cvt_pk_bf16_f32 v26, v52, v53
    v_mfma_f32_16x16x32_bf16 v[64:67], a[104:107], a[40:43], v[64:67]
    ds_read_b128 a[72:75], v14 offset:51200
    buffer_load_dwordx4 a[204:207], v14, s[16:19], s28 offen offset:1024 sc1
    v_mfma_f32_16x16x32_bf16 v[72:75], a[104:107], a[44:47], v[72:75]
    buffer_load_dwordx4 v0, s[16:19], s39 offen offset:1024 sc1 lds
    v_cvt_pk_bf16_f32 v27, v54, v55
    v_mfma_f32_16x16x32_bf16 v[68:71], a[108:111], a[40:43], v[68:71]
    ds_read_b128 a[76:79], v14 offset:52224
    v_mfma_f32_16x16x32_bf16 v[76:79], a[108:111], a[44:47], v[76:79]
    s_waitcnt lgkmcnt(4)
    v_cvt_pk_bf16_f32 v28, v56, v57
    v_mfma_f32_16x16x32_bf16 v[64:67], a[112:115], a[48:51], v[64:67]
    ds_read_b128 a[80:83], v14 offset:53248
    buffer_load_dwordx4 v0, s[16:19], s39 offen offset:2048 sc1 lds
    v_mfma_f32_16x16x32_bf16 v[72:75], a[112:115], a[52:55], v[72:75]
    v_cvt_pk_bf16_f32 v29, v58, v59
    v_mfma_f32_16x16x32_bf16 v[68:71], a[116:119], a[48:51], v[68:71]
    ds_read_b128 a[84:87], v14 offset:54272
    buffer_load_dwordx4 v0, s[16:19], s39 offen offset:3072 sc1 lds
    v_mfma_f32_16x16x32_bf16 v[76:79], a[116:119], a[52:55], v[76:79]
    v_cvt_pk_bf16_f32 v30, v60, v61
    v_mfma_f32_16x16x32_bf16 v[64:67], a[120:123], a[56:59], v[64:67]
    ds_read_b128 a[88:91], v14 offset:55296
    v_mfma_f32_16x16x32_bf16 v[72:75], a[120:123], a[60:63], v[72:75]
    s_add_u32 s39, s39, 16384
    v_cvt_pk_bf16_f32 v31, v62, v63
    v_mfma_f32_16x16x32_bf16 v[68:71], a[124:127], a[56:59], v[68:71]
    ds_read_b128 a[92:95], v14 offset:56320
    v_mfma_f32_16x16x32_bf16 v[76:79], a[124:127], a[60:63], v[76:79]
    s_waitcnt lgkmcnt(4)
    v_mfma_f32_16x16x32_bf16 v[32:35], a[64:67], v[24:27], v[32:35]
    ds_read_b128 a[96:99], v14 offset:57344
    v_mfma_f32_16x16x32_bf16 v[40:43], a[64:67], v[28:31], v[40:43]
    v_exp_f32 v48, v64
    v_mfma_f32_16x16x32_bf16 v[36:39], a[68:71], v[24:27], v[36:39]
    s_add_u32 m0, s76, 32768
    ds_read_b128 a[100:103], v14 offset:58368
    v_mfma_f32_16x16x32_bf16 v[44:47], a[68:71], v[28:31], v[44:47]
    v_exp_f32 v49, v65
    v_mfma_f32_16x16x32_bf16 v[96:99], a[72:75], v[24:27], v[96:99]
    ds_read_b128 a[104:107], v14 offset:59392
    v_mfma_f32_16x16x32_bf16 v[104:107], a[72:75], v[28:31], v[104:107]
    v_exp_f32 v50, v66
    v_mfma_f32_16x16x32_bf16 v[100:103], a[76:79], v[24:27], v[100:103]
    ds_read_b128 a[108:111], v14 offset:60416
    v_add_f32 v8, v48, v49
    v_mfma_f32_16x16x32_bf16 v[108:111], a[76:79], v[28:31], v[108:111]
    s_waitcnt lgkmcnt(4)
    v_exp_f32 v51, v67
    v_mfma_f32_16x16x32_bf16 v[160:163], a[80:83], v[24:27], v[160:163]
    ds_read_b128 a[112:115], v14 offset:61440
    v_add_f32 v8, v8, v50
    v_mfma_f32_16x16x32_bf16 v[168:171], a[80:83], v[28:31], v[168:171]
    v_exp_f32 v56, v72
    v_mfma_f32_16x16x32_bf16 v[164:167], a[84:87], v[24:27], v[164:167]
    ds_read_b128 a[116:119], v14 offset:62464
    v_add_f32 v8, v8, v51
    v_mfma_f32_16x16x32_bf16 v[172:175], a[84:87], v[28:31], v[172:175]
    v_exp_f32 v57, v73
    v_mfma_f32_16x16x32_bf16 v[176:179], a[88:91], v[24:27], v[176:179]
    ds_read_b128 a[120:123], v14 offset:63488
    buffer_load_dwordx4 v0, s[64:67], s60 offen offset:0 sc1 lds
    v_mfma_f32_16x16x32_bf16 v[184:187], a[88:91], v[28:31], v[184:187]
    v_exp_f32 v58, v74
    v_mfma_f32_16x16x32_bf16 v[180:183], a[92:95], v[24:27], v[180:183]
    ds_read_b128 a[124:127], v14 offset:64512
    buffer_load_dwordx4 v0, s[64:67], s60 offen offset:1024 sc1 lds
    v_mfma_f32_16x16x32_bf16 v[188:191], a[92:95], v[28:31], v[188:191]
    s_waitcnt lgkmcnt(4)
    v_add_f32 v9, v56, v57
    v_mfma_f32_16x16x32_bf16 a[248:251], v[140:143], a[208:211], a[248:251]
    v_mfma_f32_16x16x32_bf16 v[192:195], a[96:99], v[24:27], v[192:195]
    ds_read_b128 a[64:67], v16 offset:49152
    buffer_load_dwordx4 v0, s[64:67], s60 offen offset:2048 sc1 lds
    v_mfma_f32_16x16x32_bf16 v[200:203], a[96:99], v[28:31], v[200:203]
    v_exp_f32 v59, v75
    v_mfma_f32_16x16x32_bf16 v[196:199], a[100:103], v[24:27], v[196:199]
    ds_read_b128 a[68:71], v16 offset:50176
    v_add_f32 v9, v9, v58
    v_mfma_f32_16x16x32_bf16 v[204:207], a[100:103], v[28:31], v[204:207]
    v_exp_f32 v52, v68
    v_mfma_f32_16x16x32_bf16 v[208:211], a[104:107], v[24:27], v[208:211]
    ds_read_b128 a[72:75], v16 offset:51200
    v_add_f32 v9, v9, v59
    v_mfma_f32_16x16x32_bf16 v[216:219], a[104:107], v[28:31], v[216:219]
    v_exp_f32 v53, v69
    v_mfma_f32_16x16x32_bf16 v[212:215], a[108:111], v[24:27], v[212:215]
    ds_read_b128 a[76:79], v16 offset:52224
    v_add_f32 v8, v8, v52
    v_mfma_f32_16x16x32_bf16 v[220:223], a[108:111], v[28:31], v[220:223]
    s_waitcnt lgkmcnt(4)
    v_exp_f32 v54, v70
    v_mfma_f32_16x16x32_bf16 v[224:227], a[112:115], v[24:27], v[224:227]
    ds_read_b128 a[80:83], v16 offset:53248
    buffer_load_dwordx4 v0, s[64:67], s60 offen offset:3072 sc1 lds
    v_mfma_f32_16x16x32_bf16 v[232:235], a[112:115], v[28:31], v[232:235]
    buffer_load_dwordx4 a[208:211], v134, s[16:19], s28 offen offset:2048 sc1
    v_add_f32 v8, v8, v53
    v_mfma_f32_16x16x32_bf16 v[228:231], a[116:119], v[24:27], v[228:231]
    s_cmp_eq_u32 s37, s38
    ds_read_b128 a[84:87], v16 offset:54272
    v_mfma_f32_16x16x32_bf16 v[236:239], a[116:119], v[28:31], v[236:239]
    s_cbranch_scc1 .Lmain_kernel_mask_121
.Lmain_kernel_maskr_122:
    v_mfma_f32_16x16x32_bf16 v[240:243], a[120:123], v[24:27], v[240:243]
    s_add_u32 s60, s60, 16384
    ds_read_b128 a[88:91], v16 offset:55296
    v_mfma_f32_16x16x32_bf16 v[248:251], a[120:123], v[28:31], v[248:251]
    v_exp_f32 v55, v71
    v_mfma_f32_16x16x32_bf16 v[244:247], a[124:127], v[24:27], v[244:247]
    ds_read_b128 a[92:95], v16 offset:56320
    v_add_f32 v8, v8, v54
    v_mfma_f32_16x16x32_bf16 v[252:255], a[124:127], v[28:31], v[252:255]
    s_waitcnt lgkmcnt(4)
    v_exp_f32 v60, v76
    v_mfma_f32_16x16x32_bf16 v[80:83], a[64:67], a[0:3], v[112:115]
    ds_read_b128 a[96:99], v16 offset:57344
    v_add_f32 v8, v8, v55
    v_mfma_f32_16x16x32_bf16 v[88:91], a[64:67], a[4:7], v[120:123]
    v_exp_f32 v61, v77
    v_mfma_f32_16x16x32_bf16 v[84:87], a[68:71], a[0:3], v[116:119]
    ds_read_b128 a[100:103], v16 offset:58368
    v_add_f32 v9, v9, v60
    v_mfma_f32_16x16x32_bf16 v[92:95], a[68:71], a[4:7], v[124:127]
    v_exp_f32 v62, v78
    v_mfma_f32_16x16x32_bf16 v[80:83], a[72:75], a[8:11], v[80:83]
    ds_read_b128 a[104:107], v16 offset:59392
    v_add_f32 v9, v9, v61
    v_mfma_f32_16x16x32_bf16 v[88:91], a[72:75], a[12:15], v[88:91]
    v_exp_f32 v63, v79
    v_mfma_f32_16x16x32_bf16 v[84:87], a[76:79], a[8:11], v[84:87]
    ds_read_b128 a[108:111], v16 offset:60416
    v_add_f32 v9, v9, v62
    v_mfma_f32_16x16x32_bf16 v[92:95], a[76:79], a[12:15], v[92:95]
    s_waitcnt lgkmcnt(4)
    v_add_f32 v9, v9, v63
    v_add_f32 v2, v8, v9
    v_mfma_f32_16x16x32_bf16 v[80:83], a[80:83], a[16:19], v[80:83]
    ds_read_b128 a[112:115], v16 offset:61440
    v_cmp_nge_f32 vcc, 1266679808, v2
    v_mfma_f32_16x16x32_bf16 v[88:91], a[80:83], a[20:23], v[88:91]
    v_mfma_f32_16x16x32_bf16 a[248:251], v[140:143], a[212:215], a[248:251]
    v_mfma_f32_16x16x32_bf16 v[84:87], a[84:87], a[16:19], v[84:87]
    ds_read_b128 a[116:119], v16 offset:62464
    v_mfma_f32_16x16x32_bf16 v[92:95], a[84:87], a[20:23], v[92:95]
    s_cbranch_vccnz .Lmain_kernel_rare_67
.Lmain_kernel_rarer_123:
    v_mfma_f32_16x16x32_bf16 v[80:83], a[88:91], a[24:27], v[80:83]
    ds_read_b128 a[120:123], v16 offset:63488
    v_add_f32 v22, v22, v8
    v_mfma_f32_16x16x32_bf16 v[88:91], a[88:91], a[28:31], v[88:91]
    buffer_load_dwordx4 a[212:215], v135, s[16:19], s28 offen offset:2048 sc1
    v_add_f32 v23, v23, v9
    v_mfma_f32_16x16x32_bf16 v[84:87], a[92:95], a[24:27], v[84:87]
    s_waitcnt vmcnt(16)
    s_waitcnt lgkmcnt(3)
    ds_read_b128 a[124:127], v16 offset:64512
    v_mfma_f32_16x16x32_bf16 v[92:95], a[92:95], a[28:31], v[92:95]
    s_barrier
    v_mfma_f32_16x16x32_bf16 v[80:83], a[96:99], a[32:35], v[80:83]
    s_add_u32 m0, s76, 98304
    ds_read_b128 a[64:67], v14 offset:0
    v_cvt_pk_bf16_f32 v24, v48, v49
    v_mfma_f32_16x16x32_bf16 v[88:91], a[96:99], a[36:39], v[88:91]
    v_cvt_pk_bf16_f32 v25, v50, v51
    v_mfma_f32_16x16x32_bf16 v[84:87], a[100:103], a[32:35], v[84:87]
    ds_read_b128 a[68:71], v14 offset:1024
    buffer_load_dwordx4 v0, s[16:19], s39 offen offset:0 sc1 lds
    v_mfma_f32_16x16x32_bf16 v[92:95], a[100:103], a[36:39], v[92:95]
    v_cvt_pk_bf16_f32 v26, v52, v53
    v_mfma_f32_16x16x32_bf16 v[80:83], a[104:107], a[40:43], v[80:83]
    ds_read_b128 a[72:75], v14 offset:2048
    v_mfma_f32_16x16x32_bf16 v[88:91], a[104:107], a[44:47], v[88:91]
    buffer_load_dwordx4 v0, s[16:19], s39 offen offset:1024 sc1 lds
    v_cvt_pk_bf16_f32 v27, v54, v55
    v_mfma_f32_16x16x32_bf16 v[84:87], a[108:111], a[40:43], v[84:87]
    s_add_u32 s28, s28, 262144
    ds_read_b128 a[76:79], v14 offset:3072
    v_mfma_f32_16x16x32_bf16 v[92:95], a[108:111], a[44:47], v[92:95]
    s_waitcnt lgkmcnt(4)
    v_cvt_pk_bf16_f32 v28, v56, v57
    v_mfma_f32_16x16x32_bf16 v[80:83], a[112:115], a[48:51], v[80:83]
    ds_read_b128 a[80:83], v14 offset:4096
    buffer_load_dwordx4 v0, s[16:19], s39 offen offset:2048 sc1 lds
    v_mfma_f32_16x16x32_bf16 v[88:91], a[112:115], a[52:55], v[88:91]
    v_cvt_pk_bf16_f32 v29, v58, v59
    v_mfma_f32_16x16x32_bf16 v[84:87], a[116:119], a[48:51], v[84:87]
    ds_read_b128 a[84:87], v14 offset:5120
    buffer_load_dwordx4 v0, s[16:19], s39 offen offset:3072 sc1 lds
    v_mfma_f32_16x16x32_bf16 v[92:95], a[116:119], a[52:55], v[92:95]
    v_cvt_pk_bf16_f32 v30, v60, v61
    v_mfma_f32_16x16x32_bf16 v[80:83], a[120:123], a[56:59], v[80:83]
    ds_read_b128 a[88:91], v14 offset:6144
    v_mfma_f32_16x16x32_bf16 v[88:91], a[120:123], a[60:63], v[88:91]
    s_add_u32 s39, s39, 16384
    v_cvt_pk_bf16_f32 v31, v62, v63
    v_mfma_f32_16x16x32_bf16 v[84:87], a[124:127], a[56:59], v[84:87]
    ds_read_b128 a[92:95], v14 offset:7168
    v_mfma_f32_16x16x32_bf16 v[92:95], a[124:127], a[60:63], v[92:95]
    s_waitcnt lgkmcnt(4)
    s_cmp_eq_u32 s37, 0
    s_cbranch_scc1 .Lmain_kernel_tail_42
.Lmain_kernel_it_49:
    v_mfma_f32_16x16x32_bf16 v[32:35], a[64:67], v[24:27], v[32:35]
    s_sub_u32 s37, s37, 1
    ds_read_b128 a[96:99], v14 offset:8192
    v_mfma_f32_16x16x32_bf16 v[40:43], a[64:67], v[28:31], v[40:43]
    v_exp_f32 v48, v80
    v_mfma_f32_16x16x32_bf16 v[36:39], a[68:71], v[24:27], v[36:39]
    s_add_u32 m0, s76, 49152
    ds_read_b128 a[100:103], v14 offset:9216
    v_mfma_f32_16x16x32_bf16 v[44:47], a[68:71], v[28:31], v[44:47]
    v_exp_f32 v49, v81
    v_mfma_f32_16x16x32_bf16 v[96:99], a[72:75], v[24:27], v[96:99]
    ds_read_b128 a[104:107], v14 offset:10240
    v_mfma_f32_16x16x32_bf16 v[104:107], a[72:75], v[28:31], v[104:107]
    v_exp_f32 v50, v82
    v_mfma_f32_16x16x32_bf16 v[100:103], a[76:79], v[24:27], v[100:103]
    ds_read_b128 a[108:111], v14 offset:11264
    v_add_f32 v8, v48, v49
    v_mfma_f32_16x16x32_bf16 v[108:111], a[76:79], v[28:31], v[108:111]
    s_waitcnt lgkmcnt(4)
    v_exp_f32 v51, v83
    v_mfma_f32_16x16x32_bf16 v[160:163], a[80:83], v[24:27], v[160:163]
    ds_read_b128 a[112:115], v14 offset:12288
    v_add_f32 v8, v8, v50
    v_mfma_f32_16x16x32_bf16 v[168:171], a[80:83], v[28:31], v[168:171]
    v_exp_f32 v56, v88
    v_mfma_f32_16x16x32_bf16 v[164:167], a[84:87], v[24:27], v[164:167]
    s_add_u32 s26, s26, 1
    ds_read_b128 a[116:119], v14 offset:13312
    v_add_f32 v8, v8, v51
    v_mfma_f32_16x16x32_bf16 v[172:175], a[84:87], v[28:31], v[172:175]
    v_exp_f32 v57, v89
    v_mfma_f32_16x16x32_bf16 v[176:179], a[88:91], v[24:27], v[176:179]
    ds_read_b128 a[120:123], v14 offset:14336
    buffer_load_dwordx4 v0, s[64:67], s60 offen offset:0 sc1 lds
    v_mfma_f32_16x16x32_bf16 v[184:187], a[88:91], v[28:31], v[184:187]
    v_exp_f32 v58, v90
    v_mfma_f32_16x16x32_bf16 v[180:183], a[92:95], v[24:27], v[180:183]
    ds_read_b128 a[124:127], v14 offset:15360
    buffer_load_dwordx4 v0, s[64:67], s60 offen offset:1024 sc1 lds
    v_mfma_f32_16x16x32_bf16 v[188:191], a[92:95], v[28:31], v[188:191]
    s_waitcnt lgkmcnt(4)
    v_add_f32 v9, v56, v57
    v_mfma_f32_16x16x32_bf16 a[248:251], v[140:143], a[216:219], a[248:251]
    v_mfma_f32_16x16x32_bf16 v[192:195], a[96:99], v[24:27], v[192:195]
    ds_read_b128 a[64:67], v16 offset:0
    buffer_load_dwordx4 v0, s[64:67], s60 offen offset:2048 sc1 lds
    v_mfma_f32_16x16x32_bf16 v[200:203], a[96:99], v[28:31], v[200:203]
    v_exp_f32 v59, v91
    v_mfma_f32_16x16x32_bf16 v[196:199], a[100:103], v[24:27], v[196:199]
    ds_read_b128 a[68:71], v16 offset:1024
    v_add_f32 v9, v9, v58
    v_mfma_f32_16x16x32_bf16 v[204:207], a[100:103], v[28:31], v[204:207]
    v_exp_f32 v52, v84
    v_mfma_f32_16x16x32_bf16 v[208:211], a[104:107], v[24:27], v[208:211]
    ds_read_b128 a[72:75], v16 offset:2048
    v_add_f32 v9, v9, v59
    v_mfma_f32_16x16x32_bf16 v[216:219], a[104:107], v[28:31], v[216:219]
    v_exp_f32 v53, v85
    v_mfma_f32_16x16x32_bf16 v[212:215], a[108:111], v[24:27], v[212:215]
    ds_read_b128 a[76:79], v16 offset:3072
    v_add_f32 v8, v8, v52
    v_mfma_f32_16x16x32_bf16 v[220:223], a[108:111], v[28:31], v[220:223]
    s_waitcnt lgkmcnt(4)
    v_exp_f32 v54, v86
    v_mfma_f32_16x16x32_bf16 v[224:227], a[112:115], v[24:27], v[224:227]
    ds_read_b128 a[80:83], v16 offset:4096
    buffer_load_dwordx4 v0, s[64:67], s60 offen offset:3072 sc1 lds
    v_mfma_f32_16x16x32_bf16 v[232:235], a[112:115], v[28:31], v[232:235]
    buffer_load_dwordx4 a[216:219], v14, s[16:19], s28 offen offset:0 sc1
    v_add_f32 v8, v8, v53
    v_mfma_f32_16x16x32_bf16 v[228:231], a[116:119], v[24:27], v[228:231]
    s_cmp_eq_u32 s37, s38
    ds_read_b128 a[84:87], v16 offset:5120
    v_mfma_f32_16x16x32_bf16 v[236:239], a[116:119], v[28:31], v[236:239]
    s_cbranch_scc1 .Lmain_kernel_mask_125
.Lmain_kernel_maskr_126:
    v_mfma_f32_16x16x32_bf16 v[240:243], a[120:123], v[24:27], v[240:243]
    s_add_u32 s60, s60, 16384
    ds_read_b128 a[88:91], v16 offset:6144
    v_mfma_f32_16x16x32_bf16 v[248:251], a[120:123], v[28:31], v[248:251]
    v_exp_f32 v55, v87
    v_mfma_f32_16x16x32_bf16 v[244:247], a[124:127], v[24:27], v[244:247]
    ds_read_b128 a[92:95], v16 offset:7168
    v_add_f32 v8, v8, v54
    v_mfma_f32_16x16x32_bf16 v[252:255], a[124:127], v[28:31], v[252:255]
    s_waitcnt lgkmcnt(4)
    v_exp_f32 v60, v92
    v_mfma_f32_16x16x32_bf16 v[64:67], a[64:67], a[0:3], v[112:115]
    ds_read_b128 a[96:99], v16 offset:8192
    v_add_f32 v8, v8, v55
    v_mfma_f32_16x16x32_bf16 v[72:75], a[64:67], a[4:7], v[120:123]
    v_exp_f32 v61, v93
    v_mfma_f32_16x16x32_bf16 v[68:71], a[68:71], a[0:3], v[116:119]
    ds_read_b128 a[100:103], v16 offset:9216
    v_add_f32 v9, v9, v60
    v_mfma_f32_16x16x32_bf16 v[76:79], a[68:71], a[4:7], v[124:127]
    v_exp_f32 v62, v94
    v_mfma_f32_16x16x32_bf16 v[64:67], a[72:75], a[8:11], v[64:67]
    ds_read_b128 a[104:107], v16 offset:10240
    v_add_f32 v9, v9, v61
    v_mfma_f32_16x16x32_bf16 v[72:75], a[72:75], a[12:15], v[72:75]
    v_exp_f32 v63, v95
    v_mfma_f32_16x16x32_bf16 v[68:71], a[76:79], a[8:11], v[68:71]
    ds_read_b128 a[108:111], v16 offset:11264
    v_add_f32 v9, v9, v62
    v_mfma_f32_16x16x32_bf16 v[76:79], a[76:79], a[12:15], v[76:79]
    s_waitcnt lgkmcnt(4)
    v_add_f32 v9, v9, v63
    v_add_f32 v2, v8, v9
    v_mfma_f32_16x16x32_bf16 v[64:67], a[80:83], a[16:19], v[64:67]
    ds_read_b128 a[112:115], v16 offset:12288
    v_cmp_nge_f32 vcc, 1266679808, v2
    v_mfma_f32_16x16x32_bf16 v[72:75], a[80:83], a[20:23], v[72:75]
    v_mfma_f32_16x16x32_bf16 v[68:71], a[84:87], a[16:19], v[68:71]
    ds_read_b128 a[116:119], v16 offset:13312
    v_mfma_f32_16x16x32_bf16 a[248:251], v[140:143], a[220:223], a[248:251]
    v_mfma_f32_16x16x32_bf16 v[76:79], a[84:87], a[20:23], v[76:79]
    s_cbranch_vccnz .Lmain_kernel_rare_54
.Lmain_kernel_rarer_127:
    v_mfma_f32_16x16x32_bf16 v[64:67], a[88:91], a[24:27], v[64:67]
    ds_read_b128 a[120:123], v16 offset:14336
    v_add_f32 v22, v22, v8
    v_mfma_f32_16x16x32_bf16 v[72:75], a[88:91], a[28:31], v[72:75]
    v_add_f32 v23, v23, v9
    v_mfma_f32_16x16x32_bf16 v[68:71], a[92:95], a[24:27], v[68:71]
    s_waitcnt vmcnt(15)
    s_waitcnt lgkmcnt(3)
    ds_read_b128 a[124:127], v16 offset:15360
    v_mfma_f32_16x16x32_bf16 v[76:79], a[92:95], a[28:31], v[76:79]
    s_barrier
    v_mfma_f32_16x16x32_bf16 v[64:67], a[96:99], a[32:35], v[64:67]
    s_add_u32 m0, s76, 114688
    ds_read_b128 a[64:67], v14 offset:16384
    v_cvt_pk_bf16_f32 v24, v48, v49
    v_mfma_f32_16x16x32_bf16 v[72:75], a[96:99], a[36:39], v[72:75]
    buffer_load_dwordx4 v0, s[16:19], s39 offen offset:0 sc1 lds
    v_cvt_pk_bf16_f32 v25, v50, v51
    v_mfma_f32_16x16x32_bf16 v[68:71], a[100:103], a[32:35], v[68:71]
    ds_read_b128 a[68:71], v14 offset:17408
    v_mfma_f32_16x16x32_bf16 v[76:79], a[100:103], a[36:39], v[76:79]
    buffer_load_dwordx4 v0, s[16:19], s39 offen offset:1024 sc1 lds
    v_cvt_pk_bf16_f32 v26, v52, v53
    v_mfma_f32_16x16x32_bf16 v[64:67], a[104:107], a[40:43], v[64:67]
    ds_read_b128 a[72:75], v14 offset:18432
    buffer_load_dwordx4 v0, s[16:19], s39 offen offset:2048 sc1 lds
    v_mfma_f32_16x16x32_bf16 v[72:75], a[104:107], a[44:47], v[72:75]
    buffer_load_dwordx4 a[220:223], v14, s[16:19], s28 offen offset:1024 sc1
    v_cvt_pk_bf16_f32 v27, v54, v55
    v_mfma_f32_16x16x32_bf16 v[68:71], a[108:111], a[40:43], v[68:71]
    ds_read_b128 a[76:79], v14 offset:19456
    buffer_load_dwordx4 v0, s[16:19], s39 offen offset:3072 sc1 lds
    v_mfma_f32_16x16x32_bf16 v[76:79], a[108:111], a[44:47], v[76:79]
    s_waitcnt lgkmcnt(4)
    v_cvt_pk_bf16_f32 v28, v56, v57
    v_mfma_f32_16x16x32_bf16 v[64:67], a[112:115], a[48:51], v[64:67]
    s_add_u32 s39, s39, 16384
    ds_read_b128 a[80:83], v14 offset:20480
    v_mfma_f32_16x16x32_bf16 v[72:75], a[112:115], a[52:55], v[72:75]
    s_cmp_eq_u32 s39, s61
    s_cselect_b32 s39, s62, s39
    s_cselect_b32 s61, s5, s61
    v_mfma_f32_16x16x32_bf16 v[68:71], a[116:119], a[48:51], v[68:71]
    s_cselect_b32 s62, 1073741824, s62
    ds_read_b128 a[84:87], v14 offset:21504
    v_cvt_pk_bf16_f32 v29, v58, v59
    v_mfma_f32_16x16x32_bf16 v[76:79], a[116:119], a[52:55], v[76:79]
    v_cvt_pk_bf16_f32 v30, v60, v61
    v_mfma_f32_16x16x32_bf16 v[64:67], a[120:123], a[56:59], v[64:67]
    ds_read_b128 a[88:91], v14 offset:22528
    v_mfma_f32_16x16x32_bf16 v[72:75], a[120:123], a[60:63], v[72:75]
    v_cvt_pk_bf16_f32 v31, v62, v63
    v_mfma_f32_16x16x32_bf16 v[68:71], a[124:127], a[56:59], v[68:71]
    ds_read_b128 a[92:95], v14 offset:23552
    v_mfma_f32_16x16x32_bf16 v[76:79], a[124:127], a[60:63], v[76:79]
    s_waitcnt lgkmcnt(4)
    v_mfma_f32_16x16x32_bf16 v[32:35], a[64:67], v[24:27], v[32:35]
    ds_read_b128 a[96:99], v14 offset:24576
    v_mfma_f32_16x16x32_bf16 v[40:43], a[64:67], v[28:31], v[40:43]
    v_exp_f32 v48, v64
    v_mfma_f32_16x16x32_bf16 v[36:39], a[68:71], v[24:27], v[36:39]
    s_add_u32 m0, s76, 0
    ds_read_b128 a[100:103], v14 offset:25600
    v_mfma_f32_16x16x32_bf16 v[44:47], a[68:71], v[28:31], v[44:47]
    v_exp_f32 v49, v65
    v_mfma_f32_16x16x32_bf16 v[96:99], a[72:75], v[24:27], v[96:99]
    ds_read_b128 a[104:107], v14 offset:26624
    v_mfma_f32_16x16x32_bf16 v[104:107], a[72:75], v[28:31], v[104:107]
    v_exp_f32 v50, v66
    v_mfma_f32_16x16x32_bf16 v[100:103], a[76:79], v[24:27], v[100:103]
    ds_read_b128 a[108:111], v14 offset:27648
    v_add_f32 v8, v48, v49
    v_mfma_f32_16x16x32_bf16 v[108:111], a[76:79], v[28:31], v[108:111]
    s_waitcnt lgkmcnt(4)
    v_exp_f32 v51, v67
    v_mfma_f32_16x16x32_bf16 v[160:163], a[80:83], v[24:27], v[160:163]
    ds_read_b128 a[112:115], v14 offset:28672
    v_add_f32 v8, v8, v50
    v_mfma_f32_16x16x32_bf16 v[168:171], a[80:83], v[28:31], v[168:171]
    v_exp_f32 v56, v72
    v_mfma_f32_16x16x32_bf16 v[164:167], a[84:87], v[24:27], v[164:167]
    ds_read_b128 a[116:119], v14 offset:29696
    v_add_f32 v8, v8, v51
    v_mfma_f32_16x16x32_bf16 v[172:175], a[84:87], v[28:31], v[172:175]
    v_exp_f32 v57, v73
    v_mfma_f32_16x16x32_bf16 v[176:179], a[88:91], v[24:27], v[176:179]
    ds_read_b128 a[120:123], v14 offset:30720
    buffer_load_dwordx4 v0, s[64:67], s60 offen offset:0 sc1 lds
    v_mfma_f32_16x16x32_bf16 v[184:187], a[88:91], v[28:31], v[184:187]
    v_exp_f32 v58, v74
    v_mfma_f32_16x16x32_bf16 v[180:183], a[92:95], v[24:27], v[180:183]
    ds_read_b128 a[124:127], v14 offset:31744
    buffer_load_dwordx4 v0, s[64:67], s60 offen offset:1024 sc1 lds
    v_mfma_f32_16x16x32_bf16 v[188:191], a[92:95], v[28:31], v[188:191]
    s_waitcnt lgkmcnt(4)
    v_add_f32 v9, v56, v57
    v_mfma_f32_16x16x32_bf16 a[252:255], v[136:139], a[224:227], 0
    v_mfma_f32_16x16x32_bf16 v[192:195], a[96:99], v[24:27], v[192:195]
    ds_read_b128 a[64:67], v16 offset:16384
    buffer_load_dwordx4 v0, s[64:67], s60 offen offset:2048 sc1 lds
    v_mfma_f32_16x16x32_bf16 v[200:203], a[96:99], v[28:31], v[200:203]
    v_exp_f32 v59, v75
    v_mfma_f32_16x16x32_bf16 v[196:199], a[100:103], v[24:27], v[196:199]
    ds_read_b128 a[68:71], v16 offset:17408
    v_add_f32 v9, v9, v58
    v_mfma_f32_16x16x32_bf16 v[204:207], a[100:103], v[28:31], v[204:207]
    v_exp_f32 v52, v68
    v_mfma_f32_16x16x32_bf16 v[208:211], a[104:107], v[24:27], v[208:211]
    ds_read_b128 a[72:75], v16 offset:18432
    v_add_f32 v9, v9, v59
    v_mfma_f32_16x16x32_bf16 v[216:219], a[104:107], v[28:31], v[216:219]
    v_exp_f32 v53, v69
    v_mfma_f32_16x16x32_bf16 v[212:215], a[108:111], v[24:27], v[212:215]
    ds_read_b128 a[76:79], v16 offset:19456
    v_add_f32 v8, v8, v52
    v_mfma_f32_16x16x32_bf16 v[220:223], a[108:111], v[28:31], v[220:223]
    s_waitcnt lgkmcnt(4)
    v_exp_f32 v54, v70
    v_mfma_f32_16x16x32_bf16 v[224:227], a[112:115], v[24:27], v[224:227]
    ds_read_b128 a[80:83], v16 offset:20480
    buffer_load_dwordx4 v0, s[64:67], s60 offen offset:3072 sc1 lds
    v_mfma_f32_16x16x32_bf16 v[232:235], a[112:115], v[28:31], v[232:235]
    buffer_load_dwordx4 a[224:227], v134, s[16:19], s28 offen offset:2048 sc1
    v_add_f32 v8, v8, v53
    v_mfma_f32_16x16x32_bf16 v[228:231], a[116:119], v[24:27], v[228:231]
    s_cmp_eq_u32 s37, s38
    ds_read_b128 a[84:87], v16 offset:21504
    v_mfma_f32_16x16x32_bf16 v[236:239], a[116:119], v[28:31], v[236:239]
    s_cbranch_scc1 .Lmain_kernel_mask_128
.Lmain_kernel_maskr_129:
    v_mfma_f32_16x16x32_bf16 v[240:243], a[120:123], v[24:27], v[240:243]
    s_add_u32 s60, s60, 16384
    ds_read_b128 a[88:91], v16 offset:22528
    v_mfma_f32_16x16x32_bf16 v[248:251], a[120:123], v[28:31], v[248:251]
    v_exp_f32 v55, v71
    v_mfma_f32_16x16x32_bf16 v[244:247], a[124:127], v[24:27], v[244:247]
    ds_read_b128 a[92:95], v16 offset:23552
    v_add_f32 v8, v8, v54
    v_mfma_f32_16x16x32_bf16 v[252:255], a[124:127], v[28:31], v[252:255]
    s_waitcnt lgkmcnt(4)
    v_exp_f32 v60, v76
    v_mfma_f32_16x16x32_bf16 v[80:83], a[64:67], a[0:3], v[112:115]
    ds_read_b128 a[96:99], v16 offset:24576
    v_add_f32 v8, v8, v55
    v_mfma_f32_16x16x32_bf16 v[88:91], a[64:67], a[4:7], v[120:123]
    v_exp_f32 v61, v77
    v_mfma_f32_16x16x32_bf16 v[84:87], a[68:71], a[0:3], v[116:119]
    ds_read_b128 a[100:103], v16 offset:25600
    v_add_f32 v9, v9, v60
    v_mfma_f32_16x16x32_bf16 v[92:95], a[68:71], a[4:7], v[124:127]
    v_exp_f32 v62, v78
    v_mfma_f32_16x16x32_bf16 v[80:83], a[72:75], a[8:11], v[80:83]
    ds_read_b128 a[104:107], v16 offset:26624
    v_add_f32 v9, v9, v61
    v_mfma_f32_16x16x32_bf16 v[88:91], a[72:75], a[12:15], v[88:91]
    v_exp_f32 v63, v79
    v_mfma_f32_16x16x32_bf16 v[84:87], a[76:79], a[8:11], v[84:87]
    ds_read_b128 a[108:111], v16 offset:27648
    v_add_f32 v9, v9, v62
    v_mfma_f32_16x16x32_bf16 v[92:95], a[76:79], a[12:15], v[92:95]
    s_waitcnt lgkmcnt(4)
    v_add_f32 v9, v9, v63
    v_add_f32 v2, v8, v9
    v_mfma_f32_16x16x32_bf16 v[80:83], a[80:83], a[16:19], v[80:83]
    ds_read_b128 a[112:115], v16 offset:28672
    v_cmp_nge_f32 vcc, 1266679808, v2
    v_mfma_f32_16x16x32_bf16 v[88:91], a[80:83], a[20:23], v[88:91]
    v_mfma_f32_16x16x32_bf16 a[252:255], v[136:139], a[228:231], a[252:255]
    v_mfma_f32_16x16x32_bf16 v[84:87], a[84:87], a[16:19], v[84:87]
    ds_read_b128 a[116:119], v16 offset:29696
    v_mfma_f32_16x16x32_bf16 v[92:95], a[84:87], a[20:23], v[92:95]
    s_cbranch_vccnz .Lmain_kernel_rare_59
.Lmain_kernel_rarer_130:
    v_mfma_f32_16x16x32_bf16 v[80:83], a[88:91], a[24:27], v[80:83]
    ds_read_b128 a[120:123], v16 offset:30720
    v_add_f32 v22, v22, v8
    v_mfma_f32_16x16x32_bf16 v[88:91], a[88:91], a[28:31], v[88:91]
    buffer_load_dwordx4 a[228:231], v135, s[16:19], s28 offen offset:2048 sc1
    v_add_f32 v23, v23, v9
    v_mfma_f32_16x16x32_bf16 v[84:87], a[92:95], a[24:27], v[84:87]
    s_waitcnt vmcnt(16)
    s_waitcnt lgkmcnt(3)
    ds_read_b128 a[124:127], v16 offset:31744
    v_mfma_f32_16x16x32_bf16 v[92:95], a[92:95], a[28:31], v[92:95]
    s_barrier
    v_mfma_f32_16x16x32_bf16 v[80:83], a[96:99], a[32:35], v[80:83]
    s_add_u32 m0, s76, 65536
    ds_read_b128 a[64:67], v14 offset:32768
    v_cvt_pk_bf16_f32 v24, v48, v49
    v_mfma_f32_16x16x32_bf16 v[88:91], a[96:99], a[36:39], v[88:91]
    v_cvt_pk_bf16_f32 v25, v50, v51
    v_mfma_f32_16x16x32_bf16 v[84:87], a[100:103], a[32:35], v[84:87]
    ds_read_b128 a[68:71], v14 offset:33792
    buffer_load_dwordx4 v0, s[16:19], s39 offen offset:0 sc1 lds
    v_mfma_f32_16x16x32_bf16 v[92:95], a[100:103], a[36:39], v[92:95]
    v_cvt_pk_bf16_f32 v26, v52, v53
    v_mfma_f32_16x16x32_bf16 v[80:83], a[104:107], a[40:43], v[80:83]
    ds_read_b128 a[72:75], v14 offset:34816
    v_mfma_f32_16x16x32_bf16 v[88:91], a[104:107], a[44:47], v[88:91]
    buffer_load_dwordx4 v0, s[16:19], s39 offen offset:1024 sc1 lds
    v_cvt_pk_bf16_f32 v27, v54, v55
    v_mfma_f32_16x16x32_bf16 v[84:87], a[108:111], a[40:43], v[84:87]
    s_add_u32 s28, s28, 262144
    ds_read_b128 a[76:79], v14 offset:35840
    v_mfma_f32_16x16x32_bf16 v[92:95], a[108:111], a[44:47], v[92:95]
    s_waitcnt lgkmcnt(4)
    v_cvt_pk_bf16_f32 v28, v56, v57
    v_mfma_f32_16x16x32_bf16 v[80:83], a[112:115], a[48:51], v[80:83]
    ds_read_b128 a[80:83], v14 offset:36864
    buffer_load_dwordx4 v0, s[16:19], s39 offen offset:2048 sc1 lds
    v_mfma_f32_16x16x32_bf16 v[88:91], a[112:115], a[52:55], v[88:91]
    v_cvt_pk_bf16_f32 v29, v58, v59
    v_mfma_f32_16x16x32_bf16 v[84:87], a[116:119], a[48:51], v[84:87]
    ds_read_b128 a[84:87], v14 offset:37888
    buffer_load_dwordx4 v0, s[16:19], s39 offen offset:3072 sc1 lds
    v_mfma_f32_16x16x32_bf16 v[92:95], a[116:119], a[52:55], v[92:95]
    v_cvt_pk_bf16_f32 v30, v60, v61
    v_mfma_f32_16x16x32_bf16 v[80:83], a[120:123], a[56:59], v[80:83]
    ds_read_b128 a[88:91], v14 offset:38912
    v_mfma_f32_16x16x32_bf16 v[88:91], a[120:123], a[60:63], v[88:91]
    s_add_u32 s39, s39, 16384
    v_cvt_pk_bf16_f32 v31, v62, v63
    v_mfma_f32_16x16x32_bf16 v[84:87], a[124:127], a[56:59], v[84:87]
    ds_read_b128 a[92:95], v14 offset:39936
    v_mfma_f32_16x16x32_bf16 v[92:95], a[124:127], a[60:63], v[92:95]
    s_waitcnt lgkmcnt(4)
    v_mfma_f32_16x16x32_bf16 v[32:35], a[64:67], v[24:27], v[32:35]
    ds_read_b128 a[96:99], v14 offset:40960
    v_mfma_f32_16x16x32_bf16 v[40:43], a[64:67], v[28:31], v[40:43]
    v_exp_f32 v48, v80
    v_mfma_f32_16x16x32_bf16 v[36:39], a[68:71], v[24:27], v[36:39]
    s_add_u32 m0, s76, 16384
    ds_read_b128 a[100:103], v14 offset:41984
    v_mfma_f32_16x16x32_bf16 v[44:47], a[68:71], v[28:31], v[44:47]
    v_exp_f32 v49, v81
    v_mfma_f32_16x16x32_bf16 v[96:99], a[72:75], v[24:27], v[96:99]
    ds_read_b128 a[104:107], v14 offset:43008
    buffer_load_dwordx4 v0, s[64:67], s60 offen offset:0 sc1 lds
    v_mfma_f32_16x16x32_bf16 v[104:107], a[72:75], v[28:31], v[104:107]
    v_exp_f32 v50, v82
    v_mfma_f32_16x16x32_bf16 v[100:103], a[76:79], v[24:27], v[100:103]
    ds_read_b128 a[108:111], v14 offset:44032
    v_add_f32 v8, v48, v49
    v_mfma_f32_16x16x32_bf16 v[108:111], a[76:79], v[28:31], v[108:111]
    s_waitcnt lgkmcnt(4)
    v_exp_f32 v51, v83
    v_mfma_f32_16x16x32_bf16 v[160:163], a[80:83], v[24:27], v[160:163]
    ds_read_b128 a[112:115], v14 offset:45056
    v_add_f32 v8, v8, v50
    v_mfma_f32_16x16x32_bf16 v[168:171], a[80:83], v[28:31], v[168:171]
    v_exp_f32 v56, v88
    v_mfma_f32_16x16x32_bf16 v[164:167], a[84:87], v[24:27], v[164:167]
    ds_read_b128 a[116:119], v14 offset:46080
    v_add_f32 v8, v8, v51
    v_mfma_f32_16x16x32_bf16 v[172:175], a[84:87], v[28:31], v[172:175]
    v_exp_f32 v57, v89
    v_mfma_f32_16x16x32_bf16 v[176:179], a[88:91], v[24:27], v[176:179]
    ds_read_b128 a[120:123], v14 offset:47104
    buffer_load_dwordx4 v0, s[64:67], s60 offen offset:1024 sc1 lds
    v_mfma_f32_16x16x32_bf16 v[184:187], a[88:91], v[28:31], v[184:187]
    v_exp_f32 v58, v90
    v_mfma_f32_16x16x32_bf16 v[180:183], a[92:95], v[24:27], v[180:183]
    ds_read_b128 a[124:127], v14 offset:48128
    buffer_load_dwordx4 v0, s[64:67], s60 offen offset:2048 sc1 lds
    v_mfma_f32_16x16x32_bf16 v[188:191], a[92:95], v[28:31], v[188:191]
    s_waitcnt lgkmcnt(4)
    buffer_load_dwordx4 v0, s[64:67], s60 offen offset:3072 sc1 lds
    v_add_f32 v9, v56, v57
    v_mfma_f32_16x16x32_bf16 v[192:195], a[96:99], v[24:27], v[192:195]
    s_add_u32 s60, s60, 16384
    ds_read_b128 a[64:67], v16 offset:32768
    v_mfma_f32_16x16x32_bf16 a[252:255], v[136:139], a[232:235], a[252:255]
    v_mfma_f32_16x16x32_bf16 v[200:203], a[96:99], v[28:31], v[200:203]
    v_exp_f32 v59, v91
    v_mfma_f32_16x16x32_bf16 v[196:199], a[100:103], v[24:27], v[196:199]
    ds_read_b128 a[68:71], v16 offset:33792
    v_add_f32 v9, v9, v58
    v_mfma_f32_16x16x32_bf16 v[204:207], a[100:103], v[28:31], v[204:207]
    s_cmp_eq_u32 s60, s63
    v_exp_f32 v52, v84
    v_mfma_f32_16x16x32_bf16 v[208:211], a[104:107], v[24:27], v[208:211]
    s_cselect_b32 s60, s4, s60
    ds_read_b128 a[72:75], v16 offset:34816
    v_add_f32 v9, v9, v59
    v_mfma_f32_16x16x32_bf16 v[216:219], a[104:107], v[28:31], v[216:219]
    s_cselect_b32 s63, s5, s63
    v_exp_f32 v53, v85
    v_mfma_f32_16x16x32_bf16 v[212:215], a[108:111], v[24:27], v[212:215]
    s_cselect_b32 s4, 1073741824, s4
    ds_read_b128 a[76:79], v16 offset:35840
    v_add_f32 v8, v8, v52
    v_mfma_f32_16x16x32_bf16 v[220:223], a[108:111], v[28:31], v[220:223]
    s_waitcnt lgkmcnt(4)
    v_exp_f32 v54, v86
    v_mfma_f32_16x16x32_bf16 v[224:227], a[112:115], v[24:27], v[224:227]
    ds_read_b128 a[80:83], v16 offset:36864
    buffer_load_dwordx4 a[232:235], v14, s[16:19], s28 offen offset:0 sc1
    v_mfma_f32_16x16x32_bf16 v[232:235], a[112:115], v[28:31], v[232:235]
    v_add_f32 v8, v8, v53
    v_mfma_f32_16x16x32_bf16 v[228:231], a[116:119], v[24:27], v[228:231]
    s_cmp_eq_u32 s37, s38
    ds_read_b128 a[84:87], v16 offset:37888
    v_mfma_f32_16x16x32_bf16 v[236:239], a[116:119], v[28:31], v[236:239]
    s_cbranch_scc1 .Lmain_kernel_mask_131
.Lmain_kernel_maskr_132:
    v_mfma_f32_16x16x32_bf16 v[240:243], a[120:123], v[24:27], v[240:243]
    ds_read_b128 a[88:91], v16 offset:38912
    v_mfma_f32_16x16x32_bf16 v[248:251], a[120:123], v[28:31], v[248:251]
    v_exp_f32 v55, v87
    v_mfma_f32_16x16x32_bf16 v[244:247], a[124:127], v[24:27], v[244:247]
    ds_read_b128 a[92:95], v16 offset:39936
    v_add_f32 v8, v8, v54
    v_mfma_f32_16x16x32_bf16 v[252:255], a[124:127], v[28:31], v[252:255]
    s_waitcnt lgkmcnt(4)
    v_exp_f32 v60, v92
    v_mfma_f32_16x16x32_bf16 v[64:67], a[64:67], a[0:3], v[112:115]
    ds_read_b128 a[96:99], v16 offset:40960
    v_add_f32 v8, v8, v55
    v_mfma_f32_16x16x32_bf16 v[72:75], a[64:67], a[4:7], v[120:123]
    v_exp_f32 v61, v93
    v_mfma_f32_16x16x32_bf16 v[68:71], a[68:71], a[0:3], v[116:119]
    ds_read_b128 a[100:103], v16 offset:41984
    v_add_f32 v9, v9, v60
    v_mfma_f32_16x16x32_bf16 v[76:79], a[68:71], a[4:7], v[124:127]
    v_exp_f32 v62, v94
    v_mfma_f32_16x16x32_bf16 v[64:67], a[72:75], a[8:11], v[64:67]
    ds_read_b128 a[104:107], v16 offset:43008
    v_add_f32 v9, v9, v61
    v_mfma_f32_16x16x32_bf16 v[72:75], a[72:75], a[12:15], v[72:75]
    v_exp_f32 v63, v95
    v_mfma_f32_16x16x32_bf16 v[68:71], a[76:79], a[8:11], v[68:71]
    ds_read_b128 a[108:111], v16 offset:44032
    v_add_f32 v9, v9, v62
    v_mfma_f32_16x16x32_bf16 v[76:79], a[76:79], a[12:15], v[76:79]
    s_waitcnt lgkmcnt(4)
    v_add_f32 v9, v9, v63
    v_add_f32 v2, v8, v9
    v_mfma_f32_16x16x32_bf16 v[64:67], a[80:83], a[16:19], v[64:67]
    ds_read_b128 a[112:115], v16 offset:45056
    v_cmp_nge_f32 vcc, 1266679808, v2
    v_mfma_f32_16x16x32_bf16 v[72:75], a[80:83], a[20:23], v[72:75]
    v_mfma_f32_16x16x32_bf16 v[68:71], a[84:87], a[16:19], v[68:71]
    ds_read_b128 a[116:119], v16 offset:46080
    v_mfma_f32_16x16x32_bf16 a[252:255], v[136:139], a[236:239], a[252:255]
    v_mfma_f32_16x16x32_bf16 v[76:79], a[84:87], a[20:23], v[76:79]
    s_cbranch_vccnz .Lmain_kernel_rare_63
.Lmain_kernel_rarer_133:
    v_mfma_f32_16x16x32_bf16 v[64:67], a[88:91], a[24:27], v[64:67]
    ds_read_b128 a[120:123], v16 offset:47104
    v_add_f32 v22, v22, v8
    v_mfma_f32_16x16x32_bf16 v[72:75], a[88:91], a[28:31], v[72:75]
    v_add_f32 v23, v23, v9
    v_mfma_f32_16x16x32_bf16 v[68:71], a[92:95], a[24:27], v[68:71]
    s_waitcnt vmcnt(15)
    s_waitcnt lgkmcnt(3)
    ds_read_b128 a[124:127], v16 offset:48128
    v_mfma_f32_16x16x32_bf16 v[76:79], a[92:95], a[28:31], v[76:79]
    s_barrier
    v_mfma_f32_16x16x32_bf16 v[64:67], a[96:99], a[32:35], v[64:67]
    s_add_u32 m0, s76, 81920
    ds_read_b128 a[64:67], v14 offset:49152
    v_cvt_pk_bf16_f32 v24, v48, v49
    v_mfma_f32_16x16x32_bf16 v[72:75], a[96:99], a[36:39], v[72:75]
    v_cvt_pk_bf16_f32 v25, v50, v51
    v_mfma_f32_16x16x32_bf16 v[68:71], a[100:103], a[32:35], v[68:71]
    ds_read_b128 a[68:71], v14 offset:50176
    buffer_load_dwordx4 v0, s[16:19], s39 offen offset:0 sc1 lds
    v_mfma_f32_16x16x32_bf16 v[76:79], a[100:103], a[36:39], v[76:79]
    v_cvt_pk_bf16_f32 v26, v52, v53
    v_mfma_f32_16x16x32_bf16 v[64:67], a[104:107], a[40:43], v[64:67]
    ds_read_b128 a[72:75], v14 offset:51200
    buffer_load_dwordx4 a[236:239], v14, s[16:19], s28 offen offset:1024 sc1
    v_mfma_f32_16x16x32_bf16 v[72:75], a[104:107], a[44:47], v[72:75]
    buffer_load_dwordx4 v0, s[16:19], s39 offen offset:1024 sc1 lds
    v_cvt_pk_bf16_f32 v27, v54, v55
    v_mfma_f32_16x16x32_bf16 v[68:71], a[108:111], a[40:43], v[68:71]
    ds_read_b128 a[76:79], v14 offset:52224
    v_mfma_f32_16x16x32_bf16 v[76:79], a[108:111], a[44:47], v[76:79]
    s_waitcnt lgkmcnt(4)
    v_cvt_pk_bf16_f32 v28, v56, v57
    v_mfma_f32_16x16x32_bf16 v[64:67], a[112:115], a[48:51], v[64:67]
    ds_read_b128 a[80:83], v14 offset:53248
    buffer_load_dwordx4 v0, s[16:19], s39 offen offset:2048 sc1 lds
    v_mfma_f32_16x16x32_bf16 v[72:75], a[112:115], a[52:55], v[72:75]
    v_cvt_pk_bf16_f32 v29, v58, v59
    v_mfma_f32_16x16x32_bf16 v[68:71], a[116:119], a[48:51], v[68:71]
    ds_read_b128 a[84:87], v14 offset:54272
    buffer_load_dwordx4 v0, s[16:19], s39 offen offset:3072 sc1 lds
    v_mfma_f32_16x16x32_bf16 v[76:79], a[116:119], a[52:55], v[76:79]
    v_cvt_pk_bf16_f32 v30, v60, v61
    v_mfma_f32_16x16x32_bf16 v[64:67], a[120:123], a[56:59], v[64:67]
    ds_read_b128 a[88:91], v14 offset:55296
    v_mfma_f32_16x16x32_bf16 v[72:75], a[120:123], a[60:63], v[72:75]
    s_add_u32 s39, s39, 16384
    v_cvt_pk_bf16_f32 v31, v62, v63
    v_mfma_f32_16x16x32_bf16 v[68:71], a[124:127], a[56:59], v[68:71]
    ds_read_b128 a[92:95], v14 offset:56320
    v_mfma_f32_16x16x32_bf16 v[76:79], a[124:127], a[60:63], v[76:79]
    s_waitcnt lgkmcnt(4)
    v_mfma_f32_16x16x32_bf16 v[32:35], a[64:67], v[24:27], v[32:35]
    ds_read_b128 a[96:99], v14 offset:57344
    v_mfma_f32_16x16x32_bf16 v[40:43], a[64:67], v[28:31], v[40:43]
    v_exp_f32 v48, v64
    v_mfma_f32_16x16x32_bf16 v[36:39], a[68:71], v[24:27], v[36:39]
    s_add_u32 m0, s76, 32768
    ds_read_b128 a[100:103], v14 offset:58368
    v_mfma_f32_16x16x32_bf16 v[44:47], a[68:71], v[28:31], v[44:47]
    v_exp_f32 v49, v65
    v_mfma_f32_16x16x32_bf16 v[96:99], a[72:75], v[24:27], v[96:99]
    ds_read_b128 a[104:107], v14 offset:59392
    v_mfma_f32_16x16x32_bf16 v[104:107], a[72:75], v[28:31], v[104:107]
    v_exp_f32 v50, v66
    v_mfma_f32_16x16x32_bf16 v[100:103], a[76:79], v[24:27], v[100:103]
    ds_read_b128 a[108:111], v14 offset:60416
    v_add_f32 v8, v48, v49
    v_mfma_f32_16x16x32_bf16 v[108:111], a[76:79], v[28:31], v[108:111]
    s_waitcnt lgkmcnt(4)
    v_exp_f32 v51, v67
    v_mfma_f32_16x16x32_bf16 v[160:163], a[80:83], v[24:27], v[160:163]
    ds_read_b128 a[112:115], v14 offset:61440
    v_add_f32 v8, v8, v50
    v_mfma_f32_16x16x32_bf16 v[168:171], a[80:83], v[28:31], v[168:171]
    v_exp_f32 v56, v72
    v_mfma_f32_16x16x32_bf16 v[164:167], a[84:87], v[24:27], v[164:167]
    ds_read_b128 a[116:119], v14 offset:62464
    v_add_f32 v8, v8, v51
    v_mfma_f32_16x16x32_bf16 v[172:175], a[84:87], v[28:31], v[172:175]
    v_exp_f32 v57, v73
    v_mfma_f32_16x16x32_bf16 v[176:179], a[88:91], v[24:27], v[176:179]
    ds_read_b128 a[120:123], v14 offset:63488
    buffer_load_dwordx4 v0, s[64:67], s60 offen offset:0 sc1 lds
    v_mfma_f32_16x16x32_bf16 v[184:187], a[88:91], v[28:31], v[184:187]
    v_exp_f32 v58, v74
    v_mfma_f32_16x16x32_bf16 v[180:183], a[92:95], v[24:27], v[180:183]
    ds_read_b128 a[124:127], v14 offset:64512
    buffer_load_dwordx4 v0, s[64:67], s60 offen offset:1024 sc1 lds
    v_mfma_f32_16x16x32_bf16 v[188:191], a[92:95], v[28:31], v[188:191]
    s_waitcnt lgkmcnt(4)
    v_add_f32 v9, v56, v57
    v_mfma_f32_16x16x32_bf16 a[252:255], v[140:143], a[240:243], a[252:255]
    v_mfma_f32_16x16x32_bf16 v[192:195], a[96:99], v[24:27], v[192:195]
    ds_read_b128 a[64:67], v16 offset:49152
    buffer_load_dwordx4 v0, s[64:67], s60 offen offset:2048 sc1 lds
    v_mfma_f32_16x16x32_bf16 v[200:203], a[96:99], v[28:31], v[200:203]
    v_exp_f32 v59, v75
    v_mfma_f32_16x16x32_bf16 v[196:199], a[100:103], v[24:27], v[196:199]
    ds_read_b128 a[68:71], v16 offset:50176
    v_add_f32 v9, v9, v58
    v_mfma_f32_16x16x32_bf16 v[204:207], a[100:103], v[28:31], v[204:207]
    v_exp_f32 v52, v68
    v_mfma_f32_16x16x32_bf16 v[208:211], a[104:107], v[24:27], v[208:211]
    ds_read_b128 a[72:75], v16 offset:51200
    v_add_f32 v9, v9, v59
    v_mfma_f32_16x16x32_bf16 v[216:219], a[104:107], v[28:31], v[216:219]
    v_exp_f32 v53, v69
    v_mfma_f32_16x16x32_bf16 v[212:215], a[108:111], v[24:27], v[212:215]
    ds_read_b128 a[76:79], v16 offset:52224
    v_add_f32 v8, v8, v52
    v_mfma_f32_16x16x32_bf16 v[220:223], a[108:111], v[28:31], v[220:223]
    s_waitcnt lgkmcnt(4)
    v_exp_f32 v54, v70
    v_mfma_f32_16x16x32_bf16 v[224:227], a[112:115], v[24:27], v[224:227]
    ds_read_b128 a[80:83], v16 offset:53248
    buffer_load_dwordx4 v0, s[64:67], s60 offen offset:3072 sc1 lds
    v_mfma_f32_16x16x32_bf16 v[232:235], a[112:115], v[28:31], v[232:235]
    buffer_load_dwordx4 a[240:243], v134, s[16:19], s28 offen offset:2048 sc1
    v_add_f32 v8, v8, v53
    v_mfma_f32_16x16x32_bf16 v[228:231], a[116:119], v[24:27], v[228:231]
    s_cmp_eq_u32 s37, s38
    ds_read_b128 a[84:87], v16 offset:54272
    v_mfma_f32_16x16x32_bf16 v[236:239], a[116:119], v[28:31], v[236:239]
    s_cbranch_scc1 .Lmain_kernel_mask_134
.Lmain_kernel_maskr_135:
    v_mfma_f32_16x16x32_bf16 v[240:243], a[120:123], v[24:27], v[240:243]
    s_add_u32 s60, s60, 16384
    ds_read_b128 a[88:91], v16 offset:55296
    v_mfma_f32_16x16x32_bf16 v[248:251], a[120:123], v[28:31], v[248:251]
    v_exp_f32 v55, v71
    v_mfma_f32_16x16x32_bf16 v[244:247], a[124:127], v[24:27], v[244:247]
    ds_read_b128 a[92:95], v16 offset:56320
    v_add_f32 v8, v8, v54
    v_mfma_f32_16x16x32_bf16 v[252:255], a[124:127], v[28:31], v[252:255]
    s_waitcnt lgkmcnt(4)
    v_exp_f32 v60, v76
    v_mfma_f32_16x16x32_bf16 v[80:83], a[64:67], a[0:3], v[112:115]
    ds_read_b128 a[96:99], v16 offset:57344
    v_add_f32 v8, v8, v55
    v_mfma_f32_16x16x32_bf16 v[88:91], a[64:67], a[4:7], v[120:123]
    v_exp_f32 v61, v77
    v_mfma_f32_16x16x32_bf16 v[84:87], a[68:71], a[0:3], v[116:119]
    ds_read_b128 a[100:103], v16 offset:58368
    v_add_f32 v9, v9, v60
    v_mfma_f32_16x16x32_bf16 v[92:95], a[68:71], a[4:7], v[124:127]
    v_exp_f32 v62, v78
    v_mfma_f32_16x16x32_bf16 v[80:83], a[72:75], a[8:11], v[80:83]
    ds_read_b128 a[104:107], v16 offset:59392
    v_add_f32 v9, v9, v61
    v_mfma_f32_16x16x32_bf16 v[88:91], a[72:75], a[12:15], v[88:91]
    v_exp_f32 v63, v79
    v_mfma_f32_16x16x32_bf16 v[84:87], a[76:79], a[8:11], v[84:87]
    ds_read_b128 a[108:111], v16 offset:60416
    v_add_f32 v9, v9, v62
    v_mfma_f32_16x16x32_bf16 v[92:95], a[76:79], a[12:15], v[92:95]
    s_waitcnt lgkmcnt(4)
    v_add_f32 v9, v9, v63
    v_add_f32 v2, v8, v9
    v_mfma_f32_16x16x32_bf16 v[80:83], a[80:83], a[16:19], v[80:83]
    ds_read_b128 a[112:115], v16 offset:61440
    v_cmp_nge_f32 vcc, 1266679808, v2
    v_mfma_f32_16x16x32_bf16 v[88:91], a[80:83], a[20:23], v[88:91]
    v_mfma_f32_16x16x32_bf16 a[252:255], v[140:143], a[244:247], a[252:255]
    v_mfma_f32_16x16x32_bf16 v[84:87], a[84:87], a[16:19], v[84:87]
    ds_read_b128 a[116:119], v16 offset:62464
    v_mfma_f32_16x16x32_bf16 v[92:95], a[84:87], a[20:23], v[92:95]
    s_cbranch_vccnz .Lmain_kernel_rare_67
.Lmain_kernel_rarer_136:
    v_mfma_f32_16x16x32_bf16 v[80:83], a[88:91], a[24:27], v[80:83]
    ds_read_b128 a[120:123], v16 offset:63488
    v_add_f32 v22, v22, v8
    v_mfma_f32_16x16x32_bf16 v[88:91], a[88:91], a[28:31], v[88:91]
    buffer_load_dwordx4 a[244:247], v135, s[16:19], s28 offen offset:2048 sc1
    v_add_f32 v23, v23, v9
    v_mfma_f32_16x16x32_bf16 v[84:87], a[92:95], a[24:27], v[84:87]
    s_waitcnt vmcnt(16)
    s_waitcnt lgkmcnt(3)
    ds_read_b128 a[124:127], v16 offset:64512
    v_mfma_f32_16x16x32_bf16 v[92:95], a[92:95], a[28:31], v[92:95]
    s_barrier
    v_mfma_f32_16x16x32_bf16 v[80:83], a[96:99], a[32:35], v[80:83]
    s_add_u32 m0, s76, 98304
    ds_read_b128 a[64:67], v14 offset:0
    v_cvt_pk_bf16_f32 v24, v48, v49
    v_mfma_f32_16x16x32_bf16 v[88:91], a[96:99], a[36:39], v[88:91]
    v_cvt_pk_bf16_f32 v25, v50, v51
    v_mfma_f32_16x16x32_bf16 v[84:87], a[100:103], a[32:35], v[84:87]
    ds_read_b128 a[68:71], v14 offset:1024
    buffer_load_dwordx4 v0, s[16:19], s39 offen offset:0 sc1 lds
    v_mfma_f32_16x16x32_bf16 v[92:95], a[100:103], a[36:39], v[92:95]
    v_cvt_pk_bf16_f32 v26, v52, v53
    v_mfma_f32_16x16x32_bf16 v[80:83], a[104:107], a[40:43], v[80:83]
    ds_read_b128 a[72:75], v14 offset:2048
    v_mfma_f32_16x16x32_bf16 v[88:91], a[104:107], a[44:47], v[88:91]
    buffer_load_dwordx4 v0, s[16:19], s39 offen offset:1024 sc1 lds
    v_cvt_pk_bf16_f32 v27, v54, v55
    v_mfma_f32_16x16x32_bf16 v[84:87], a[108:111], a[40:43], v[84:87]
    s_add_u32 s28, s28, 262144
    ds_read_b128 a[76:79], v14 offset:3072
    v_mfma_f32_16x16x32_bf16 v[92:95], a[108:111], a[44:47], v[92:95]
    s_waitcnt lgkmcnt(4)
    v_cvt_pk_bf16_f32 v28, v56, v57
    v_mfma_f32_16x16x32_bf16 v[80:83], a[112:115], a[48:51], v[80:83]
    ds_read_b128 a[80:83], v14 offset:4096
    buffer_load_dwordx4 v0, s[16:19], s39 offen offset:2048 sc1 lds
    v_mfma_f32_16x16x32_bf16 v[88:91], a[112:115], a[52:55], v[88:91]
    v_cvt_pk_bf16_f32 v29, v58, v59
    v_mfma_f32_16x16x32_bf16 v[84:87], a[116:119], a[48:51], v[84:87]
    ds_read_b128 a[84:87], v14 offset:5120
    buffer_load_dwordx4 v0, s[16:19], s39 offen offset:3072 sc1 lds
    v_mfma_f32_16x16x32_bf16 v[92:95], a[116:119], a[52:55], v[92:95]
    v_cvt_pk_bf16_f32 v30, v60, v61
    v_mfma_f32_16x16x32_bf16 v[80:83], a[120:123], a[56:59], v[80:83]
    ds_read_b128 a[88:91], v14 offset:6144
    v_mfma_f32_16x16x32_bf16 v[88:91], a[120:123], a[60:63], v[88:91]
    s_add_u32 s39, s39, 16384
    v_cvt_pk_bf16_f32 v31, v62, v63
    v_mfma_f32_16x16x32_bf16 v[84:87], a[124:127], a[56:59], v[84:87]
    ds_read_b128 a[92:95], v14 offset:7168
    v_mfma_f32_16x16x32_bf16 v[92:95], a[124:127], a[60:63], v[92:95]
    s_waitcnt lgkmcnt(4)
    s_cmp_eq_u32 s37, 0
    s_cbranch_scc1 .Lmain_kernel_tail_42
.p2align 6
.Lmain_kernel_loop_43:
    v_mfma_f32_16x16x32_bf16 v[32:35], a[64:67], v[24:27], v[32:35]
    s_sub_u32 s37, s37, 1
    ds_read_b128 a[96:99], v14 offset:8192
    v_mfma_f32_16x16x32_bf16 v[40:43], a[64:67], v[28:31], v[40:43]
    v_exp_f32 v48, v80
    v_mfma_f32_16x16x32_bf16 v[36:39], a[68:71], v[24:27], v[36:39]
    s_add_u32 m0, s76, 49152
    ds_read_b128 a[100:103], v14 offset:9216
    v_mfma_f32_16x16x32_bf16 v[44:47], a[68:71], v[28:31], v[44:47]
    v_exp_f32 v49, v81
    v_mfma_f32_16x16x32_bf16 v[96:99], a[72:75], v[24:27], v[96:99]
    ds_read_b128 a[104:107], v14 offset:10240
    v_mfma_f32_16x16x32_bf16 v[104:107], a[72:75], v[28:31], v[104:107]
    v_exp_f32 v50, v82
    v_mfma_f32_16x16x32_bf16 v[100:103], a[76:79], v[24:27], v[100:103]
    ds_read_b128 a[108:111], v14 offset:11264
    v_add_f32 v8, v48, v49
    v_mfma_f32_16x16x32_bf16 v[108:111], a[76:79], v[28:31], v[108:111]
    s_waitcnt lgkmcnt(4)
    v_exp_f32 v51, v83
    v_mfma_f32_16x16x32_bf16 v[160:163], a[80:83], v[24:27], v[160:163]
    ds_read_b128 a[112:115], v14 offset:12288
    v_add_f32 v8, v8, v50
    v_mfma_f32_16x16x32_bf16 v[168:171], a[80:83], v[28:31], v[168:171]
    v_exp_f32 v56, v88
    v_mfma_f32_16x16x32_bf16 v[164:167], a[84:87], v[24:27], v[164:167]
    s_add_u32 s26, s26, 1
    ds_read_b128 a[116:119], v14 offset:13312
    v_add_f32 v8, v8, v51
    v_mfma_f32_16x16x32_bf16 v[172:175], a[84:87], v[28:31], v[172:175]
    v_exp_f32 v57, v89
    v_mfma_f32_16x16x32_bf16 v[176:179], a[88:91], v[24:27], v[176:179]
    ds_read_b128 a[120:123], v14 offset:14336
    buffer_load_dwordx4 v0, s[64:67], s60 offen offset:0 sc1 lds
    v_mfma_f32_16x16x32_bf16 v[184:187], a[88:91], v[28:31], v[184:187]
    v_exp_f32 v58, v90
    v_mfma_f32_16x16x32_bf16 v[180:183], a[92:95], v[24:27], v[180:183]
    ds_read_b128 a[124:127], v14 offset:15360
    buffer_load_dwordx4 v0, s[64:67], s60 offen offset:1024 sc1 lds
    v_mfma_f32_16x16x32_bf16 v[188:191], a[92:95], v[28:31], v[188:191]
    s_waitcnt lgkmcnt(4)
    v_add_f32 v9, v56, v57
    v_mfma_f32_16x16x32_bf16 v[192:195], a[96:99], v[24:27], v[192:195]
    ds_read_b128 a[64:67], v16 offset:0
    buffer_load_dwordx4 v0, s[64:67], s60 offen offset:2048 sc1 lds
    v_mfma_f32_16x16x32_bf16 v[200:203], a[96:99], v[28:31], v[200:203]
    v_exp_f32 v59, v91
    v_mfma_f32_16x16x32_bf16 v[196:199], a[100:103], v[24:27], v[196:199]
    ds_read_b128 a[68:71], v16 offset:1024
    v_add_f32 v9, v9, v58
    v_mfma_f32_16x16x32_bf16 v[204:207], a[100:103], v[28:31], v[204:207]
    v_exp_f32 v52, v84
    v_mfma_f32_16x16x32_bf16 v[208:211], a[104:107], v[24:27], v[208:211]
    ds_read_b128 a[72:75], v16 offset:2048
    v_add_f32 v9, v9, v59
    v_mfma_f32_16x16x32_bf16 v[216:219], a[104:107], v[28:31], v[216:219]
    v_exp_f32 v53, v85
    v_mfma_f32_16x16x32_bf16 v[212:215], a[108:111], v[24:27], v[212:215]
    ds_read_b128 a[76:79], v16 offset:3072
    v_add_f32 v8, v8, v52
    v_mfma_f32_16x16x32_bf16 v[220:223], a[108:111], v[28:31], v[220:223]
    s_waitcnt lgkmcnt(4)
    v_exp_f32 v54, v86
    v_mfma_f32_16x16x32_bf16 v[224:227], a[112:115], v[24:27], v[224:227]
    ds_read_b128 a[80:83], v16 offset:4096
    buffer_load_dwordx4 v0, s[64:67], s60 offen offset:3072 sc1 lds
    v_mfma_f32_16x16x32_bf16 v[232:235], a[112:115], v[28:31], v[232:235]
    v_add_f32 v8, v8, v53
    v_mfma_f32_16x16x32_bf16 v[228:231], a[116:119], v[24:27], v[228:231]
    s_cmp_eq_u32 s37, s38
    ds_read_b128 a[84:87], v16 offset:5120
    v_mfma_f32_16x16x32_bf16 v[236:239], a[116:119], v[28:31], v[236:239]
    s_cbranch_scc1 .Lmain_kernel_mask_138
.Lmain_kernel_maskr_139:
    v_mfma_f32_16x16x32_bf16 v[240:243], a[120:123], v[24:27], v[240:243]
    s_add_u32 s60, s60, 16384
    ds_read_b128 a[88:91], v16 offset:6144
    v_mfma_f32_16x16x32_bf16 v[248:251], a[120:123], v[28:31], v[248:251]
    v_exp_f32 v55, v87
    v_mfma_f32_16x16x32_bf16 v[244:247], a[124:127], v[24:27], v[244:247]
    ds_read_b128 a[92:95], v16 offset:7168
    v_add_f32 v8, v8, v54
    v_mfma_f32_16x16x32_bf16 v[252:255], a[124:127], v[28:31], v[252:255]
    s_waitcnt lgkmcnt(4)
    v_exp_f32 v60, v92
    v_mfma_f32_16x16x32_bf16 v[64:67], a[64:67], a[0:3], v[112:115]
    ds_read_b128 a[96:99], v16 offset:8192
    v_add_f32 v8, v8, v55
    v_mfma_f32_16x16x32_bf16 v[72:75], a[64:67], a[4:7], v[120:123]
    v_exp_f32 v61, v93
    v_mfma_f32_16x16x32_bf16 v[68:71], a[68:71], a[0:3], v[116:119]
    ds_read_b128 a[100:103], v16 offset:9216
    v_add_f32 v9, v9, v60
    v_mfma_f32_16x16x32_bf16 v[76:79], a[68:71], a[4:7], v[124:127]
    v_exp_f32 v62, v94
    v_mfma_f32_16x16x32_bf16 v[64:67], a[72:75], a[8:11], v[64:67]
    ds_read_b128 a[104:107], v16 offset:10240
    v_add_f32 v9, v9, v61
    v_mfma_f32_16x16x32_bf16 v[72:75], a[72:75], a[12:15], v[72:75]
    v_exp_f32 v63, v95
    v_mfma_f32_16x16x32_bf16 v[68:71], a[76:79], a[8:11], v[68:71]
    ds_read_b128 a[108:111], v16 offset:11264
    v_add_f32 v9, v9, v62
    v_mfma_f32_16x16x32_bf16 v[76:79], a[76:79], a[12:15], v[76:79]
    s_waitcnt lgkmcnt(4)
    v_add_f32 v9, v9, v63
    v_add_f32 v2, v8, v9
    v_mfma_f32_16x16x32_bf16 v[64:67], a[80:83], a[16:19], v[64:67]
    ds_read_b128 a[112:115], v16 offset:12288
    v_cmp_nge_f32 vcc, 1266679808, v2
    v_mfma_f32_16x16x32_bf16 v[72:75], a[80:83], a[20:23], v[72:75]
    v_mfma_f32_16x16x32_bf16 v[68:71], a[84:87], a[16:19], v[68:71]
    ds_read_b128 a[116:119], v16 offset:13312
    v_mfma_f32_16x16x32_bf16 v[76:79], a[84:87], a[20:23], v[76:79]
    s_cbranch_vccnz .Lmain_kernel_rare_54
.Lmain_kernel_rarer_140:
    v_mfma_f32_16x16x32_bf16 v[64:67], a[88:91], a[24:27], v[64:67]
    ds_read_b128 a[120:123], v16 offset:14336
    v_add_f32 v22, v22, v8
    v_mfma_f32_16x16x32_bf16 v[72:75], a[88:91], a[28:31], v[72:75]
    v_add_f32 v23, v23, v9
    v_mfma_f32_16x16x32_bf16 v[68:71], a[92:95], a[24:27], v[68:71]
    s_waitcnt vmcnt(12)
    s_waitcnt lgkmcnt(3)
    ds_read_b128 a[124:127], v16 offset:15360
    v_mfma_f32_16x16x32_bf16 v[76:79], a[92:95], a[28:31], v[76:79]
    s_barrier
    v_mfma_f32_16x16x32_bf16 v[64:67], a[96:99], a[32:35], v[64:67]
    s_add_u32 m0, s76, 114688
    ds_read_b128 a[64:67], v14 offset:16384
    v_cvt_pk_bf16_f32 v24, v48, v49
    v_mfma_f32_16x16x32_bf16 v[72:75], a[96:99], a[36:39], v[72:75]
    buffer_load_dwordx4 v0, s[16:19], s39 offen offset:0 sc1 lds
    v_cvt_pk_bf16_f32 v25, v50, v51
    v_mfma_f32_16x16x32_bf16 v[68:71], a[100:103], a[32:35], v[68:71]
    ds_read_b128 a[68:71], v14 offset:17408
    v_mfma_f32_16x16x32_bf16 v[76:79], a[100:103], a[36:39], v[76:79]
    buffer_load_dwordx4 v0, s[16:19], s39 offen offset:1024 sc1 lds
    v_cvt_pk_bf16_f32 v26, v52, v53
    v_mfma_f32_16x16x32_bf16 v[64:67], a[104:107], a[40:43], v[64:67]
    ds_read_b128 a[72:75], v14 offset:18432
    buffer_load_dwordx4 v0, s[16:19], s39 offen offset:2048 sc1 lds
    v_mfma_f32_16x16x32_bf16 v[72:75], a[104:107], a[44:47], v[72:75]
    v_cvt_pk_bf16_f32 v27, v54, v55
    v_mfma_f32_16x16x32_bf16 v[68:71], a[108:111], a[40:43], v[68:71]
    ds_read_b128 a[76:79], v14 offset:19456
    buffer_load_dwordx4 v0, s[16:19], s39 offen offset:3072 sc1 lds
    v_mfma_f32_16x16x32_bf16 v[76:79], a[108:111], a[44:47], v[76:79]
    s_waitcnt lgkmcnt(4)
    v_cvt_pk_bf16_f32 v28, v56, v57
    v_mfma_f32_16x16x32_bf16 v[64:67], a[112:115], a[48:51], v[64:67]
    s_add_u32 s39, s39, 16384
    ds_read_b128 a[80:83], v14 offset:20480
    v_mfma_f32_16x16x32_bf16 v[72:75], a[112:115], a[52:55], v[72:75]
    s_cmp_eq_u32 s39, s61
    s_cselect_b32 s39, s62, s39
    s_cselect_b32 s61, s5, s61
    v_mfma_f32_16x16x32_bf16 v[68:71], a[116:119], a[48:51], v[68:71]
    s_cselect_b32 s62, 1073741824, s62
    ds_read_b128 a[84:87], v14 offset:21504
    v_cvt_pk_bf16_f32 v29, v58, v59
    v_mfma_f32_16x16x32_bf16 v[76:79], a[116:119], a[52:55], v[76:79]
    v_cvt_pk_bf16_f32 v30, v60, v61
    v_mfma_f32_16x16x32_bf16 v[64:67], a[120:123], a[56:59], v[64:67]
    ds_read_b128 a[88:91], v14 offset:22528
    v_mfma_f32_16x16x32_bf16 v[72:75], a[120:123], a[60:63], v[72:75]
    v_cvt_pk_bf16_f32 v31, v62, v63
    v_mfma_f32_16x16x32_bf16 v[68:71], a[124:127], a[56:59], v[68:71]
    ds_read_b128 a[92:95], v14 offset:23552
    v_mfma_f32_16x16x32_bf16 v[76:79], a[124:127], a[60:63], v[76:79]
    s_waitcnt lgkmcnt(4)
    v_mfma_f32_16x16x32_bf16 v[32:35], a[64:67], v[24:27], v[32:35]
    ds_read_b128 a[96:99], v14 offset:24576
    v_mfma_f32_16x16x32_bf16 v[40:43], a[64:67], v[28:31], v[40:43]
    v_exp_f32 v48, v64
    v_mfma_f32_16x16x32_bf16 v[36:39], a[68:71], v[24:27], v[36:39]
    s_add_u32 m0, s76, 0
    ds_read_b128 a[100:103], v14 offset:25600
    v_mfma_f32_16x16x32_bf16 v[44:47], a[68:71], v[28:31], v[44:47]
    v_exp_f32 v49, v65
    v_mfma_f32_16x16x32_bf16 v[96:99], a[72:75], v[24:27], v[96:99]
    ds_read_b128 a[104:107], v14 offset:26624
    v_mfma_f32_16x16x32_bf16 v[104:107], a[72:75], v[28:31], v[104:107]
    v_exp_f32 v50, v66
    v_mfma_f32_16x16x32_bf16 v[100:103], a[76:79], v[24:27], v[100:103]
    ds_read_b128 a[108:111], v14 offset:27648
    v_add_f32 v8, v48, v49
    v_mfma_f32_16x16x32_bf16 v[108:111], a[76:79], v[28:31], v[108:111]
    s_waitcnt lgkmcnt(4)
    v_exp_f32 v51, v67
    v_mfma_f32_16x16x32_bf16 v[160:163], a[80:83], v[24:27], v[160:163]
    ds_read_b128 a[112:115], v14 offset:28672
    v_add_f32 v8, v8, v50
    v_mfma_f32_16x16x32_bf16 v[168:171], a[80:83], v[28:31], v[168:171]
    v_exp_f32 v56, v72
    v_mfma_f32_16x16x32_bf16 v[164:167], a[84:87], v[24:27], v[164:167]
    ds_read_b128 a[116:119], v14 offset:29696
    v_add_f32 v8, v8, v51
    v_mfma_f32_16x16x32_bf16 v[172:175], a[84:87], v[28:31], v[172:175]
    v_exp_f32 v57, v73
    v_mfma_f32_16x16x32_bf16 v[176:179], a[88:91], v[24:27], v[176:179]
    ds_read_b128 a[120:123], v14 offset:30720
    buffer_load_dwordx4 v0, s[64:67], s60 offen offset:0 sc1 lds
    v_mfma_f32_16x16x32_bf16 v[184:187], a[88:91], v[28:31], v[184:187]
    v_exp_f32 v58, v74
    v_mfma_f32_16x16x32_bf16 v[180:183], a[92:95], v[24:27], v[180:183]
    ds_read_b128 a[124:127], v14 offset:31744
    buffer_load_dwordx4 v0, s[64:67], s60 offen offset:1024 sc1 lds
    v_mfma_f32_16x16x32_bf16 v[188:191], a[92:95], v[28:31], v[188:191]
    s_waitcnt lgkmcnt(4)
    v_add_f32 v9, v56, v57
    v_mfma_f32_16x16x32_bf16 v[192:195], a[96:99], v[24:27], v[192:195]
    ds_read_b128 a[64:67], v16 offset:16384
    buffer_load_dwordx4 v0, s[64:67], s60 offen offset:2048 sc1 lds
    v_mfma_f32_16x16x32_bf16 v[200:203], a[96:99], v[28:31], v[200:203]
    v_exp_f32 v59, v75
    v_mfma_f32_16x16x32_bf16 v[196:199], a[100:103], v[24:27], v[196:199]
    ds_read_b128 a[68:71], v16 offset:17408
    v_add_f32 v9, v9, v58
    v_mfma_f32_16x16x32_bf16 v[204:207], a[100:103], v[28:31], v[204:207]
    v_exp_f32 v52, v68
    v_mfma_f32_16x16x32_bf16 v[208:211], a[104:107], v[24:27], v[208:211]
    ds_read_b128 a[72:75], v16 offset:18432
    v_add_f32 v9, v9, v59
    v_mfma_f32_16x16x32_bf16 v[216:219], a[104:107], v[28:31], v[216:219]
    v_exp_f32 v53, v69
    v_mfma_f32_16x16x32_bf16 v[212:215], a[108:111], v[24:27], v[212:215]
    ds_read_b128 a[76:79], v16 offset:19456
    v_add_f32 v8, v8, v52
    v_mfma_f32_16x16x32_bf16 v[220:223], a[108:111], v[28:31], v[220:223]
    s_waitcnt lgkmcnt(4)
    v_exp_f32 v54, v70
    v_mfma_f32_16x16x32_bf16 v[224:227], a[112:115], v[24:27], v[224:227]
    ds_read_b128 a[80:83], v16 offset:20480
    buffer_load_dwordx4 v0, s[64:67], s60 offen offset:3072 sc1 lds
    v_mfma_f32_16x16x32_bf16 v[232:235], a[112:115], v[28:31], v[232:235]
    v_add_f32 v8, v8, v53
    v_mfma_f32_16x16x32_bf16 v[228:231], a[116:119], v[24:27], v[228:231]
    s_cmp_eq_u32 s37, s38
    ds_read_b128 a[84:87], v16 offset:21504
    v_mfma_f32_16x16x32_bf16 v[236:239], a[116:119], v[28:31], v[236:239]
    s_cbranch_scc1 .Lmain_kernel_mask_141
.Lmain_kernel_maskr_142:
    v_mfma_f32_16x16x32_bf16 v[240:243], a[120:123], v[24:27], v[240:243]
    s_add_u32 s60, s60, 16384
    ds_read_b128 a[88:91], v16 offset:22528
    v_mfma_f32_16x16x32_bf16 v[248:251], a[120:123], v[28:31], v[248:251]
    v_exp_f32 v55, v71
    v_mfma_f32_16x16x32_bf16 v[244:247], a[124:127], v[24:27], v[244:247]
    ds_read_b128 a[92:95], v16 offset:23552
    v_add_f32 v8, v8, v54
    v_mfma_f32_16x16x32_bf16 v[252:255], a[124:127], v[28:31], v[252:255]
    s_waitcnt lgkmcnt(4)
    v_exp_f32 v60, v76
    v_mfma_f32_16x16x32_bf16 v[80:83], a[64:67], a[0:3], v[112:115]
    ds_read_b128 a[96:99], v16 offset:24576
    v_add_f32 v8, v8, v55
    v_mfma_f32_16x16x32_bf16 v[88:91], a[64:67], a[4:7], v[120:123]
    v_exp_f32 v61, v77
    v_mfma_f32_16x16x32_bf16 v[84:87], a[68:71], a[0:3], v[116:119]
    ds_read_b128 a[100:103], v16 offset:25600
    v_add_f32 v9, v9, v60
    v_mfma_f32_16x16x32_bf16 v[92:95], a[68:71], a[4:7], v[124:127]
    v_exp_f32 v62, v78
    v_mfma_f32_16x16x32_bf16 v[80:83], a[72:75], a[8:11], v[80:83]
    ds_read_b128 a[104:107], v16 offset:26624
    v_add_f32 v9, v9, v61
    v_mfma_f32_16x16x32_bf16 v[88:91], a[72:75], a[12:15], v[88:91]
    v_exp_f32 v63, v79
    v_mfma_f32_16x16x32_bf16 v[84:87], a[76:79], a[8:11], v[84:87]
    ds_read_b128 a[108:111], v16 offset:27648
    v_add_f32 v9, v9, v62
    v_mfma_f32_16x16x32_bf16 v[92:95], a[76:79], a[12:15], v[92:95]
    s_waitcnt lgkmcnt(4)
    v_add_f32 v9, v9, v63
    v_add_f32 v2, v8, v9
    v_mfma_f32_16x16x32_bf16 v[80:83], a[80:83], a[16:19], v[80:83]
    ds_read_b128 a[112:115], v16 offset:28672
    v_cmp_nge_f32 vcc, 1266679808, v2
    v_mfma_f32_16x16x32_bf16 v[88:91], a[80:83], a[20:23], v[88:91]
    v_mfma_f32_16x16x32_bf16 v[84:87], a[84:87], a[16:19], v[84:87]
    ds_read_b128 a[116:119], v16 offset:29696
    v_mfma_f32_16x16x32_bf16 v[92:95], a[84:87], a[20:23], v[92:95]
    s_cbranch_vccnz .Lmain_kernel_rare_59
.Lmain_kernel_rarer_143:
    v_mfma_f32_16x16x32_bf16 v[80:83], a[88:91], a[24:27], v[80:83]
    ds_read_b128 a[120:123], v16 offset:30720
    v_add_f32 v22, v22, v8
    v_mfma_f32_16x16x32_bf16 v[88:91], a[88:91], a[28:31], v[88:91]
    v_add_f32 v23, v23, v9
    v_mfma_f32_16x16x32_bf16 v[84:87], a[92:95], a[24:27], v[84:87]
    s_waitcnt vmcnt(12)
    s_waitcnt lgkmcnt(3)
    ds_read_b128 a[124:127], v16 offset:31744
    v_mfma_f32_16x16x32_bf16 v[92:95], a[92:95], a[28:31], v[92:95]
    s_barrier
    v_mfma_f32_16x16x32_bf16 v[80:83], a[96:99], a[32:35], v[80:83]
    s_add_u32 m0, s76, 65536
    ds_read_b128 a[64:67], v14 offset:32768
    v_cvt_pk_bf16_f32 v24, v48, v49
    v_mfma_f32_16x16x32_bf16 v[88:91], a[96:99], a[36:39], v[88:91]
    v_cvt_pk_bf16_f32 v25, v50, v51
    v_mfma_f32_16x16x32_bf16 v[84:87], a[100:103], a[32:35], v[84:87]
    ds_read_b128 a[68:71], v14 offset:33792
    buffer_load_dwordx4 v0, s[16:19], s39 offen offset:0 sc1 lds
    v_mfma_f32_16x16x32_bf16 v[92:95], a[100:103], a[36:39], v[92:95]
    v_cvt_pk_bf16_f32 v26, v52, v53
    v_mfma_f32_16x16x32_bf16 v[80:83], a[104:107], a[40:43], v[80:83]
    ds_read_b128 a[72:75], v14 offset:34816
    v_mfma_f32_16x16x32_bf16 v[88:91], a[104:107], a[44:47], v[88:91]
    buffer_load_dwordx4 v0, s[16:19], s39 offen offset:1024 sc1 lds
    v_cvt_pk_bf16_f32 v27, v54, v55
    v_mfma_f32_16x16x32_bf16 v[84:87], a[108:111], a[40:43], v[84:87]
    ds_read_b128 a[76:79], v14 offset:35840
    v_mfma_f32_16x16x32_bf16 v[92:95], a[108:111], a[44:47], v[92:95]
    s_waitcnt lgkmcnt(4)
    v_cvt_pk_bf16_f32 v28, v56, v57
    v_mfma_f32_16x16x32_bf16 v[80:83], a[112:115], a[48:51], v[80:83]
    ds_read_b128 a[80:83], v14 offset:36864
    buffer_load_dwordx4 v0, s[16:19], s39 offen offset:2048 sc1 lds
    v_mfma_f32_16x16x32_bf16 v[88:91], a[112:115], a[52:55], v[88:91]
    v_cvt_pk_bf16_f32 v29, v58, v59
    v_mfma_f32_16x16x32_bf16 v[84:87], a[116:119], a[48:51], v[84:87]
    ds_read_b128 a[84:87], v14 offset:37888
    buffer_load_dwordx4 v0, s[16:19], s39 offen offset:3072 sc1 lds
    v_mfma_f32_16x16x32_bf16 v[92:95], a[116:119], a[52:55], v[92:95]
    v_cvt_pk_bf16_f32 v30, v60, v61
    v_mfma_f32_16x16x32_bf16 v[80:83], a[120:123], a[56:59], v[80:83]
    ds_read_b128 a[88:91], v14 offset:38912
    v_mfma_f32_16x16x32_bf16 v[88:91], a[120:123], a[60:63], v[88:91]
    s_add_u32 s39, s39, 16384
    v_cvt_pk_bf16_f32 v31, v62, v63
    v_mfma_f32_16x16x32_bf16 v[84:87], a[124:127], a[56:59], v[84:87]
    ds_read_b128 a[92:95], v14 offset:39936
    v_mfma_f32_16x16x32_bf16 v[92:95], a[124:127], a[60:63], v[92:95]
    s_waitcnt lgkmcnt(4)
    v_mfma_f32_16x16x32_bf16 v[32:35], a[64:67], v[24:27], v[32:35]
    ds_read_b128 a[96:99], v14 offset:40960
    v_mfma_f32_16x16x32_bf16 v[40:43], a[64:67], v[28:31], v[40:43]
    v_exp_f32 v48, v80
    v_mfma_f32_16x16x32_bf16 v[36:39], a[68:71], v[24:27], v[36:39]
    s_add_u32 m0, s76, 16384
    ds_read_b128 a[100:103], v14 offset:41984
    v_mfma_f32_16x16x32_bf16 v[44:47], a[68:71], v[28:31], v[44:47]
    v_exp_f32 v49, v81
    v_mfma_f32_16x16x32_bf16 v[96:99], a[72:75], v[24:27], v[96:99]
    ds_read_b128 a[104:107], v14 offset:43008
    buffer_load_dwordx4 v0, s[64:67], s60 offen offset:0 sc1 lds
    v_mfma_f32_16x16x32_bf16 v[104:107], a[72:75], v[28:31], v[104:107]
    v_exp_f32 v50, v82
    v_mfma_f32_16x16x32_bf16 v[100:103], a[76:79], v[24:27], v[100:103]
    ds_read_b128 a[108:111], v14 offset:44032
    v_add_f32 v8, v48, v49
    v_mfma_f32_16x16x32_bf16 v[108:111], a[76:79], v[28:31], v[108:111]
    s_waitcnt lgkmcnt(4)
    v_exp_f32 v51, v83
    v_mfma_f32_16x16x32_bf16 v[160:163], a[80:83], v[24:27], v[160:163]
    ds_read_b128 a[112:115], v14 offset:45056
    v_add_f32 v8, v8, v50
    v_mfma_f32_16x16x32_bf16 v[168:171], a[80:83], v[28:31], v[168:171]
    v_exp_f32 v56, v88
    v_mfma_f32_16x16x32_bf16 v[164:167], a[84:87], v[24:27], v[164:167]
    ds_read_b128 a[116:119], v14 offset:46080
    v_add_f32 v8, v8, v51
    v_mfma_f32_16x16x32_bf16 v[172:175], a[84:87], v[28:31], v[172:175]
    v_exp_f32 v57, v89
    v_mfma_f32_16x16x32_bf16 v[176:179], a[88:91], v[24:27], v[176:179]
    ds_read_b128 a[120:123], v14 offset:47104
    buffer_load_dwordx4 v0, s[64:67], s60 offen offset:1024 sc1 lds
    v_mfma_f32_16x16x32_bf16 v[184:187], a[88:91], v[28:31], v[184:187]
    v_exp_f32 v58, v90
    v_mfma_f32_16x16x32_bf16 v[180:183], a[92:95], v[24:27], v[180:183]
    ds_read_b128 a[124:127], v14 offset:48128
    buffer_load_dwordx4 v0, s[64:67], s60 offen offset:2048 sc1 lds
    v_mfma_f32_16x16x32_bf16 v[188:191], a[92:95], v[28:31], v[188:191]
    s_waitcnt lgkmcnt(4)
    buffer_load_dwordx4 v0, s[64:67], s60 offen offset:3072 sc1 lds
    v_add_f32 v9, v56, v57
    v_mfma_f32_16x16x32_bf16 v[192:195], a[96:99], v[24:27], v[192:195]
    s_add_u32 s60, s60, 16384
    ds_read_b128 a[64:67], v16 offset:32768
    v_mfma_f32_16x16x32_bf16 v[200:203], a[96:99], v[28:31], v[200:203]
    v_exp_f32 v59, v91
    v_mfma_f32_16x16x32_bf16 v[196:199], a[100:103], v[24:27], v[196:199]
    ds_read_b128 a[68:71], v16 offset:33792
    v_add_f32 v9, v9, v58
    v_mfma_f32_16x16x32_bf16 v[204:207], a[100:103], v[28:31], v[204:207]
    s_cmp_eq_u32 s60, s63
    v_exp_f32 v52, v84
    v_mfma_f32_16x16x32_bf16 v[208:211], a[104:107], v[24:27], v[208:211]
    s_cselect_b32 s60, s4, s60
    ds_read_b128 a[72:75], v16 offset:34816
    v_add_f32 v9, v9, v59
    v_mfma_f32_16x16x32_bf16 v[216:219], a[104:107], v[28:31], v[216:219]
    s_cselect_b32 s63, s5, s63
    v_exp_f32 v53, v85
    v_mfma_f32_16x16x32_bf16 v[212:215], a[108:111], v[24:27], v[212:215]
    s_cselect_b32 s4, 1073741824, s4
    ds_read_b128 a[76:79], v16 offset:35840
    v_add_f32 v8, v8, v52
    v_mfma_f32_16x16x32_bf16 v[220:223], a[108:111], v[28:31], v[220:223]
    s_waitcnt lgkmcnt(4)
    v_exp_f32 v54, v86
    v_mfma_f32_16x16x32_bf16 v[224:227], a[112:115], v[24:27], v[224:227]
    ds_read_b128 a[80:83], v16 offset:36864
    v_mfma_f32_16x16x32_bf16 v[232:235], a[112:115], v[28:31], v[232:235]
    v_add_f32 v8, v8, v53
    v_mfma_f32_16x16x32_bf16 v[228:231], a[116:119], v[24:27], v[228:231]
    s_cmp_eq_u32 s37, s38
    ds_read_b128 a[84:87], v16 offset:37888
    v_mfma_f32_16x16x32_bf16 v[236:239], a[116:119], v[28:31], v[236:239]
    s_cbranch_scc1 .Lmain_kernel_mask_144
.Lmain_kernel_maskr_145:
    v_mfma_f32_16x16x32_bf16 v[240:243], a[120:123], v[24:27], v[240:243]
    ds_read_b128 a[88:91], v16 offset:38912
    v_mfma_f32_16x16x32_bf16 v[248:251], a[120:123], v[28:31], v[248:251]
    v_exp_f32 v55, v87
    v_mfma_f32_16x16x32_bf16 v[244:247], a[124:127], v[24:27], v[244:247]
    ds_read_b128 a[92:95], v16 offset:39936
    v_add_f32 v8, v8, v54
    v_mfma_f32_16x16x32_bf16 v[252:255], a[124:127], v[28:31], v[252:255]
    s_waitcnt lgkmcnt(4)
    v_exp_f32 v60, v92
    v_mfma_f32_16x16x32_bf16 v[64:67], a[64:67], a[0:3], v[112:115]
    ds_read_b128 a[96:99], v16 offset:40960
    v_add_f32 v8, v8, v55
    v_mfma_f32_16x16x32_bf16 v[72:75], a[64:67], a[4:7], v[120:123]
    v_exp_f32 v61, v93
    v_mfma_f32_16x16x32_bf16 v[68:71], a[68:71], a[0:3], v[116:119]
    ds_read_b128 a[100:103], v16 offset:41984
    v_add_f32 v9, v9, v60
    v_mfma_f32_16x16x32_bf16 v[76:79], a[68:71], a[4:7], v[124:127]
    v_exp_f32 v62, v94
    v_mfma_f32_16x16x32_bf16 v[64:67], a[72:75], a[8:11], v[64:67]
    ds_read_b128 a[104:107], v16 offset:43008
    v_add_f32 v9, v9, v61
    v_mfma_f32_16x16x32_bf16 v[72:75], a[72:75], a[12:15], v[72:75]
    v_exp_f32 v63, v95
    v_mfma_f32_16x16x32_bf16 v[68:71], a[76:79], a[8:11], v[68:71]
    ds_read_b128 a[108:111], v16 offset:44032
    v_add_f32 v9, v9, v62
    v_mfma_f32_16x16x32_bf16 v[76:79], a[76:79], a[12:15], v[76:79]
    s_waitcnt lgkmcnt(4)
    v_add_f32 v9, v9, v63
    v_add_f32 v2, v8, v9
    v_mfma_f32_16x16x32_bf16 v[64:67], a[80:83], a[16:19], v[64:67]
    ds_read_b128 a[112:115], v16 offset:45056
    v_cmp_nge_f32 vcc, 1266679808, v2
    v_mfma_f32_16x16x32_bf16 v[72:75], a[80:83], a[20:23], v[72:75]
    v_mfma_f32_16x16x32_bf16 v[68:71], a[84:87], a[16:19], v[68:71]
    ds_read_b128 a[116:119], v16 offset:46080
    v_mfma_f32_16x16x32_bf16 v[76:79], a[84:87], a[20:23], v[76:79]
    s_cbranch_vccnz .Lmain_kernel_rare_63
.Lmain_kernel_rarer_146:
    v_mfma_f32_16x16x32_bf16 v[64:67], a[88:91], a[24:27], v[64:67]
    ds_read_b128 a[120:123], v16 offset:47104
    v_add_f32 v22, v22, v8
    v_mfma_f32_16x16x32_bf16 v[72:75], a[88:91], a[28:31], v[72:75]
    v_add_f32 v23, v23, v9
    v_mfma_f32_16x16x32_bf16 v[68:71], a[92:95], a[24:27], v[68:71]
    s_waitcnt vmcnt(12)
    s_waitcnt lgkmcnt(3)
    ds_read_b128 a[124:127], v16 offset:48128
    v_mfma_f32_16x16x32_bf16 v[76:79], a[92:95], a[28:31], v[76:79]
    s_barrier
    v_mfma_f32_16x16x32_bf16 v[64:67], a[96:99], a[32:35], v[64:67]
    s_add_u32 m0, s76, 81920
    ds_read_b128 a[64:67], v14 offset:49152
    v_cvt_pk_bf16_f32 v24, v48, v49
    v_mfma_f32_16x16x32_bf16 v[72:75], a[96:99], a[36:39], v[72:75]
    v_cvt_pk_bf16_f32 v25, v50, v51
    v_mfma_f32_16x16x32_bf16 v[68:71], a[100:103], a[32:35], v[68:71]
    ds_read_b128 a[68:71], v14 offset:50176
    buffer_load_dwordx4 v0, s[16:19], s39 offen offset:0 sc1 lds
    v_mfma_f32_16x16x32_bf16 v[76:79], a[100:103], a[36:39], v[76:79]
    v_cvt_pk_bf16_f32 v26, v52, v53
    v_mfma_f32_16x16x32_bf16 v[64:67], a[104:107], a[40:43], v[64:67]
    ds_read_b128 a[72:75], v14 offset:51200
    v_mfma_f32_16x16x32_bf16 v[72:75], a[104:107], a[44:47], v[72:75]
    buffer_load_dwordx4 v0, s[16:19], s39 offen offset:1024 sc1 lds
    v_cvt_pk_bf16_f32 v27, v54, v55
    v_mfma_f32_16x16x32_bf16 v[68:71], a[108:111], a[40:43], v[68:71]
    ds_read_b128 a[76:79], v14 offset:52224
    v_mfma_f32_16x16x32_bf16 v[76:79], a[108:111], a[44:47], v[76:79]
    s_waitcnt lgkmcnt(4)
    v_cvt_pk_bf16_f32 v28, v56, v57
    v_mfma_f32_16x16x32_bf16 v[64:67], a[112:115], a[48:51], v[64:67]
    ds_read_b128 a[80:83], v14 offset:53248
    buffer_load_dwordx4 v0, s[16:19], s39 offen offset:2048 sc1 lds
    v_mfma_f32_16x16x32_bf16 v[72:75], a[112:115], a[52:55], v[72:75]
    v_cvt_pk_bf16_f32 v29, v58, v59
    v_mfma_f32_16x16x32_bf16 v[68:71], a[116:119], a[48:51], v[68:71]
    ds_read_b128 a[84:87], v14 offset:54272
    buffer_load_dwordx4 v0, s[16:19], s39 offen offset:3072 sc1 lds
    v_mfma_f32_16x16x32_bf16 v[76:79], a[116:119], a[52:55], v[76:79]
    v_cvt_pk_bf16_f32 v30, v60, v61
    v_mfma_f32_16x16x32_bf16 v[64:67], a[120:123], a[56:59], v[64:67]
    ds_read_b128 a[88:91], v14 offset:55296
    v_mfma_f32_16x16x32_bf16 v[72:75], a[120:123], a[60:63], v[72:75]
    s_add_u32 s39, s39, 16384
    v_cvt_pk_bf16_f32 v31, v62, v63
    v_mfma_f32_16x16x32_bf16 v[68:71], a[124:127], a[56:59], v[68:71]
    ds_read_b128 a[92:95], v14 offset:56320
    v_mfma_f32_16x16x32_bf16 v[76:79], a[124:127], a[60:63], v[76:79]
    s_waitcnt lgkmcnt(4)
    v_mfma_f32_16x16x32_bf16 v[32:35], a[64:67], v[24:27], v[32:35]
    ds_read_b128 a[96:99], v14 offset:57344
    v_mfma_f32_16x16x32_bf16 v[40:43], a[64:67], v[28:31], v[40:43]
    v_exp_f32 v48, v64
    v_mfma_f32_16x16x32_bf16 v[36:39], a[68:71], v[24:27], v[36:39]
    s_add_u32 m0, s76, 32768
    ds_read_b128 a[100:103], v14 offset:58368
    v_mfma_f32_16x16x32_bf16 v[44:47], a[68:71], v[28:31], v[44:47]
    v_exp_f32 v49, v65
    v_mfma_f32_16x16x32_bf16 v[96:99], a[72:75], v[24:27], v[96:99]
    ds_read_b128 a[104:107], v14 offset:59392
    v_mfma_f32_16x16x32_bf16 v[104:107], a[72:75], v[28:31], v[104:107]
    v_exp_f32 v50, v66
    v_mfma_f32_16x16x32_bf16 v[100:103], a[76:79], v[24:27], v[100:103]
    ds_read_b128 a[108:111], v14 offset:60416
    v_add_f32 v8, v48, v49
    v_mfma_f32_16x16x32_bf16 v[108:111], a[76:79], v[28:31], v[108:111]
    s_waitcnt lgkmcnt(4)
    v_exp_f32 v51, v67
    v_mfma_f32_16x16x32_bf16 v[160:163], a[80:83], v[24:27], v[160:163]
    ds_read_b128 a[112:115], v14 offset:61440
    v_add_f32 v8, v8, v50
    v_mfma_f32_16x16x32_bf16 v[168:171], a[80:83], v[28:31], v[168:171]
    v_exp_f32 v56, v72
    v_mfma_f32_16x16x32_bf16 v[164:167], a[84:87], v[24:27], v[164:167]
    ds_read_b128 a[116:119], v14 offset:62464
    v_add_f32 v8, v8, v51
    v_mfma_f32_16x16x32_bf16 v[172:175], a[84:87], v[28:31], v[172:175]
    v_exp_f32 v57, v73
    v_mfma_f32_16x16x32_bf16 v[176:179], a[88:91], v[24:27], v[176:179]
    ds_read_b128 a[120:123], v14 offset:63488
    buffer_load_dwordx4 v0, s[64:67], s60 offen offset:0 sc1 lds
    v_mfma_f32_16x16x32_bf16 v[184:187], a[88:91], v[28:31], v[184:187]
    v_exp_f32 v58, v74
    v_mfma_f32_16x16x32_bf16 v[180:183], a[92:95], v[24:27], v[180:183]
    ds_read_b128 a[124:127], v14 offset:64512
    buffer_load_dwordx4 v0, s[64:67], s60 offen offset:1024 sc1 lds
    v_mfma_f32_16x16x32_bf16 v[188:191], a[92:95], v[28:31], v[188:191]
    s_waitcnt lgkmcnt(4)
    v_add_f32 v9, v56, v57
    v_mfma_f32_16x16x32_bf16 v[192:195], a[96:99], v[24:27], v[192:195]
    ds_read_b128 a[64:67], v16 offset:49152
    buffer_load_dwordx4 v0, s[64:67], s60 offen offset:2048 sc1 lds
    v_mfma_f32_16x16x32_bf16 v[200:203], a[96:99], v[28:31], v[200:203]
    v_exp_f32 v59, v75
    v_mfma_f32_16x16x32_bf16 v[196:199], a[100:103], v[24:27], v[196:199]
    ds_read_b128 a[68:71], v16 offset:50176
    v_add_f32 v9, v9, v58
    v_mfma_f32_16x16x32_bf16 v[204:207], a[100:103], v[28:31], v[204:207]
    v_exp_f32 v52, v68
    v_mfma_f32_16x16x32_bf16 v[208:211], a[104:107], v[24:27], v[208:211]
    ds_read_b128 a[72:75], v16 offset:51200
    v_add_f32 v9, v9, v59
    v_mfma_f32_16x16x32_bf16 v[216:219], a[104:107], v[28:31], v[216:219]
    v_exp_f32 v53, v69
    v_mfma_f32_16x16x32_bf16 v[212:215], a[108:111], v[24:27], v[212:215]
    ds_read_b128 a[76:79], v16 offset:52224
    v_add_f32 v8, v8, v52
    v_mfma_f32_16x16x32_bf16 v[220:223], a[108:111], v[28:31], v[220:223]
    s_waitcnt lgkmcnt(4)
    v_exp_f32 v54, v70
    v_mfma_f32_16x16x32_bf16 v[224:227], a[112:115], v[24:27], v[224:227]
    ds_read_b128 a[80:83], v16 offset:53248
    buffer_load_dwordx4 v0, s[64:67], s60 offen offset:3072 sc1 lds
    v_mfma_f32_16x16x32_bf16 v[232:235], a[112:115], v[28:31], v[232:235]
    v_add_f32 v8, v8, v53
    v_mfma_f32_16x16x32_bf16 v[228:231], a[116:119], v[24:27], v[228:231]
    s_cmp_eq_u32 s37, s38
    ds_read_b128 a[84:87], v16 offset:54272
    v_mfma_f32_16x16x32_bf16 v[236:239], a[116:119], v[28:31], v[236:239]
    s_cbranch_scc1 .Lmain_kernel_mask_147
.Lmain_kernel_maskr_148:
    v_mfma_f32_16x16x32_bf16 v[240:243], a[120:123], v[24:27], v[240:243]
    s_add_u32 s60, s60, 16384
    ds_read_b128 a[88:91], v16 offset:55296
    v_mfma_f32_16x16x32_bf16 v[248:251], a[120:123], v[28:31], v[248:251]
    v_exp_f32 v55, v71
    v_mfma_f32_16x16x32_bf16 v[244:247], a[124:127], v[24:27], v[244:247]
    ds_read_b128 a[92:95], v16 offset:56320
    v_add_f32 v8, v8, v54
    v_mfma_f32_16x16x32_bf16 v[252:255], a[124:127], v[28:31], v[252:255]
    s_waitcnt lgkmcnt(4)
    v_exp_f32 v60, v76
    v_mfma_f32_16x16x32_bf16 v[80:83], a[64:67], a[0:3], v[112:115]
    ds_read_b128 a[96:99], v16 offset:57344
    v_add_f32 v8, v8, v55
    v_mfma_f32_16x16x32_bf16 v[88:91], a[64:67], a[4:7], v[120:123]
    v_exp_f32 v61, v77
    v_mfma_f32_16x16x32_bf16 v[84:87], a[68:71], a[0:3], v[116:119]
    ds_read_b128 a[100:103], v16 offset:58368
    v_add_f32 v9, v9, v60
    v_mfma_f32_16x16x32_bf16 v[92:95], a[68:71], a[4:7], v[124:127]
    v_exp_f32 v62, v78
    v_mfma_f32_16x16x32_bf16 v[80:83], a[72:75], a[8:11], v[80:83]
    ds_read_b128 a[104:107], v16 offset:59392
    v_add_f32 v9, v9, v61
    v_mfma_f32_16x16x32_bf16 v[88:91], a[72:75], a[12:15], v[88:91]
    v_exp_f32 v63, v79
    v_mfma_f32_16x16x32_bf16 v[84:87], a[76:79], a[8:11], v[84:87]
    ds_read_b128 a[108:111], v16 offset:60416
    v_add_f32 v9, v9, v62
    v_mfma_f32_16x16x32_bf16 v[92:95], a[76:79], a[12:15], v[92:95]
    s_waitcnt lgkmcnt(4)
    v_add_f32 v9, v9, v63
    v_add_f32 v2, v8, v9
    v_mfma_f32_16x16x32_bf16 v[80:83], a[80:83], a[16:19], v[80:83]
    ds_read_b128 a[112:115], v16 offset:61440
    v_cmp_nge_f32 vcc, 1266679808, v2
    v_mfma_f32_16x16x32_bf16 v[88:91], a[80:83], a[20:23], v[88:91]
    v_mfma_f32_16x16x32_bf16 v[84:87], a[84:87], a[16:19], v[84:87]
    ds_read_b128 a[116:119], v16 offset:62464
    v_mfma_f32_16x16x32_bf16 v[92:95], a[84:87], a[20:23], v[92:95]
    s_cbranch_vccnz .Lmain_kernel_rare_67
.Lmain_kernel_rarer_149:
    v_mfma_f32_16x16x32_bf16 v[80:83], a[88:91], a[24:27], v[80:83]
    ds_read_b128 a[120:123], v16 offset:63488
    v_add_f32 v22, v22, v8
    v_mfma_f32_16x16x32_bf16 v[88:91], a[88:91], a[28:31], v[88:91]
    v_add_f32 v23, v23, v9
    v_mfma_f32_16x16x32_bf16 v[84:87], a[92:95], a[24:27], v[84:87]
    s_waitcnt vmcnt(12)
    s_waitcnt lgkmcnt(3)
    ds_read_b128 a[124:127], v16 offset:64512
    v_mfma_f32_16x16x32_bf16 v[92:95], a[92:95], a[28:31], v[92:95]
    s_barrier
    v_mfma_f32_16x16x32_bf16 v[80:83], a[96:99], a[32:35], v[80:83]
    s_add_u32 m0, s76, 98304
    ds_read_b128 a[64:67], v14 offset:0
    v_cvt_pk_bf16_f32 v24, v48, v49
    v_mfma_f32_16x16x32_bf16 v[88:91], a[96:99], a[36:39], v[88:91]
    v_cvt_pk_bf16_f32 v25, v50, v51
    v_mfma_f32_16x16x32_bf16 v[84:87], a[100:103], a[32:35], v[84:87]
    ds_read_b128 a[68:71], v14 offset:1024
    buffer_load_dwordx4 v0, s[16:19], s39 offen offset:0 sc1 lds
    v_mfma_f32_16x16x32_bf16 v[92:95], a[100:103], a[36:39], v[92:95]
    v_cvt_pk_bf16_f32 v26, v52, v53
    v_mfma_f32_16x16x32_bf16 v[80:83], a[104:107], a[40:43], v[80:83]
    ds_read_b128 a[72:75], v14 offset:2048
    v_mfma_f32_16x16x32_bf16 v[88:91], a[104:107], a[44:47], v[88:91]
    buffer_load_dwordx4 v0, s[16:19], s39 offen offset:1024 sc1 lds
    v_cvt_pk_bf16_f32 v27, v54, v55
    v_mfma_f32_16x16x32_bf16 v[84:87], a[108:111], a[40:43], v[84:87]
    ds_read_b128 a[76:79], v14 offset:3072
    v_mfma_f32_16x16x32_bf16 v[92:95], a[108:111], a[44:47], v[92:95]
    s_waitcnt lgkmcnt(4)
    v_cvt_pk_bf16_f32 v28, v56, v57
    v_mfma_f32_16x16x32_bf16 v[80:83], a[112:115], a[48:51], v[80:83]
    ds_read_b128 a[80:83], v14 offset:4096
    buffer_load_dwordx4 v0, s[16:19], s39 offen offset:2048 sc1 lds
    v_mfma_f32_16x16x32_bf16 v[88:91], a[112:115], a[52:55], v[88:91]
    v_cvt_pk_bf16_f32 v29, v58, v59
    v_mfma_f32_16x16x32_bf16 v[84:87], a[116:119], a[48:51], v[84:87]
    ds_read_b128 a[84:87], v14 offset:5120
    buffer_load_dwordx4 v0, s[16:19], s39 offen offset:3072 sc1 lds
    v_mfma_f32_16x16x32_bf16 v[92:95], a[116:119], a[52:55], v[92:95]
    v_cvt_pk_bf16_f32 v30, v60, v61
    v_mfma_f32_16x16x32_bf16 v[80:83], a[120:123], a[56:59], v[80:83]
    ds_read_b128 a[88:91], v14 offset:6144
    v_mfma_f32_16x16x32_bf16 v[88:91], a[120:123], a[60:63], v[88:91]
    s_add_u32 s39, s39, 16384
    v_cvt_pk_bf16_f32 v31, v62, v63
    v_mfma_f32_16x16x32_bf16 v[84:87], a[124:127], a[56:59], v[84:87]
    ds_read_b128 a[92:95], v14 offset:7168
    v_mfma_f32_16x16x32_bf16 v[92:95], a[124:127], a[60:63], v[92:95]
    s_waitcnt lgkmcnt(4)
    s_cmp_lg_u32 s37, 0
    s_cbranch_scc1 .Lmain_kernel_loop_43
.Lmain_kernel_tail_42:
    s_cmp_lg_u32 s36, 1
    s_cbranch_scc1 .Lmain_kernel_fin_150
    s_xor_b32 s32, s43, 15
    s_lshl_b32 s32, s32, 2
    s_add_u32 s32, s32, s20
    s_lshl_b32 s32, s32, 14
    s_add_u32 s32, s32, 117440512
    s_waitcnt vmcnt(4)
    v_and_b32 v1, 1, v1
    v_cmp_ne_u32 vcc, 1, v1
    s_nop 0
    s_cbranch_vccnz .Lmain_kernel_spin_155
.Lmain_kernel_pok_154:
    v_mfma_f32_16x16x32_bf16 v[32:35], a[64:67], v[24:27], v[32:35]
    ds_read_b128 a[96:99], v14 offset:8192
    buffer_load_dwordx4 a[0:3], v14, s[16:19], s32 offen offset:0 sc1
    v_mfma_f32_16x16x32_bf16 v[40:43], a[64:67], v[28:31], v[40:43]
    v_exp_f32 v48, v80
    v_mfma_f32_16x16x32_bf16 v[36:39], a[68:71], v[24:27], v[36:39]
    ds_read_b128 a[100:103], v14 offset:9216
    buffer_load_dwordx4 a[4:7], v14, s[16:19], s32 offen offset:1024 sc1
    v_mfma_f32_16x16x32_bf16 v[44:47], a[68:71], v[28:31], v[44:47]
    v_exp_f32 v49, v81
    v_mfma_f32_16x16x32_bf16 v[96:99], a[72:75], v[24:27], v[96:99]
    ds_read_b128 a[104:107], v14 offset:10240
    v_exp_f32 v50, v82
    v_mfma_f32_16x16x32_bf16 v[104:107], a[72:75], v[28:31], v[104:107]
    buffer_load_dwordx4 a[8:11], v14, s[16:19], s32 offen offset:2048 sc1
    v_add_f32 v8, v48, v49
    v_exp_f32 v51, v83
    v_mfma_f32_16x16x32_bf16 v[100:103], a[76:79], v[24:27], v[100:103]
    ds_read_b128 a[108:111], v14 offset:11264
    v_add_f32 v8, v8, v50
    v_mfma_f32_16x16x32_bf16 v[108:111], a[76:79], v[28:31], v[108:111]
    s_waitcnt lgkmcnt(4)
    v_exp_f32 v56, v88
    v_add_f32 v8, v8, v51
    v_mfma_f32_16x16x32_bf16 v[160:163], a[80:83], v[24:27], v[160:163]
    ds_read_b128 a[112:115], v14 offset:12288
    buffer_load_dwordx4 a[12:15], v14, s[16:19], s32 offen offset:3072 sc1
    v_exp_f32 v57, v89
    v_mfma_f32_16x16x32_bf16 v[168:171], a[80:83], v[28:31], v[168:171]
    v_exp_f32 v58, v90
    v_mfma_f32_16x16x32_bf16 v[164:167], a[84:87], v[24:27], v[164:167]
    s_add_u32 s32, s32, 4096
    ds_read_b128 a[116:119], v14 offset:13312
    v_add_f32 v9, v56, v57
    v_mfma_f32_16x16x32_bf16 v[172:175], a[84:87], v[28:31], v[172:175]
    v_exp_f32 v59, v91
    v_mfma_f32_16x16x32_bf16 v[176:179], a[88:91], v[24:27], v[176:179]
    ds_read_b128 a[120:123], v14 offset:14336
    v_add_f32 v9, v9, v58
    v_exp_f32 v52, v84
    v_mfma_f32_16x16x32_bf16 v[184:187], a[88:91], v[28:31], v[184:187]
    buffer_load_dwordx4 a[16:19], v14, s[16:19], s32 offen offset:0 sc1
    v_add_f32 v9, v9, v59
    v_exp_f32 v53, v85
    v_mfma_f32_16x16x32_bf16 v[180:183], a[92:95], v[24:27], v[180:183]
    s_waitcnt vmcnt(17)
    s_waitcnt lgkmcnt(3)
    ds_read_b128 a[124:127], v14 offset:15360
    v_add_f32 v8, v8, v52
    v_exp_f32 v54, v86
    v_mfma_f32_16x16x32_bf16 v[188:191], a[92:95], v[28:31], v[188:191]
    s_barrier
    v_mfma_f32_16x16x32_bf16 v[192:195], a[96:99], v[24:27], v[192:195]
    ds_read_b128 a[64:67], v14 offset:16384
    buffer_load_dwordx4 a[20:23], v14, s[16:19], s32 offen offset:1024 sc1
    v_add_f32 v8, v8, v53
    v_mfma_f32_16x16x32_bf16 v[200:203], a[96:99], v[28:31], v[200:203]
    v_exp_f32 v55, v87
    v_add_f32 v8, v8, v54
    v_mfma_f32_16x16x32_bf16 v[196:199], a[100:103], v[24:27], v[196:199]
    ds_read_b128 a[68:71], v14 offset:17408
    buffer_load_dwordx4 a[24:27], v14, s[16:19], s32 offen offset:2048 sc1
    v_exp_f32 v60, v92
    v_mfma_f32_16x16x32_bf16 v[204:207], a[100:103], v[28:31], v[204:207]
    v_add_f32 v8, v8, v55
    v_exp_f32 v61, v93
    v_mfma_f32_16x16x32_bf16 v[208:211], a[104:107], v[24:27], v[208:211]
    ds_read_b128 a[72:75], v14 offset:18432
    v_add_f32 v9, v9, v60
    v_mfma_f32_16x16x32_bf16 v[216:219], a[104:107], v[28:31], v[216:219]
    buffer_load_dwordx4 a[28:31], v14, s[16:19], s32 offen offset:3072 sc1
    v_exp_f32 v62, v94
    v_mfma_f32_16x16x32_bf16 v[212:215], a[108:111], v[24:27], v[212:215]
    ds_read_b128 a[76:79], v14 offset:19456
    v_add_f32 v9, v9, v61
    v_mfma_f32_16x16x32_bf16 v[220:223], a[108:111], v[28:31], v[220:223]
    s_waitcnt lgkmcnt(4)
    v_exp_f32 v63, v95
    v_mfma_f32_16x16x32_bf16 v[224:227], a[112:115], v[24:27], v[224:227]
    s_add_u32 s32, s32, 4096
    ds_read_b128 a[80:83], v14 offset:20480
    v_add_f32 v9, v9, v62
    v_mfma_f32_16x16x32_bf16 v[232:235], a[112:115], v[28:31], v[232:235]
    v_add_f32 v9, v9, v63
    v_cvt_pk_bf16_f32 v64, v48, v49
    v_mfma_f32_16x16x32_bf16 v[228:231], a[116:119], v[24:27], v[228:231]
    ds_read_b128 a[84:87], v14 offset:21504
    buffer_load_dwordx4 a[32:35], v14, s[16:19], s32 offen offset:0 sc1
    v_cvt_pk_bf16_f32 v65, v50, v51
    v_cvt_pk_bf16_f32 v66, v52, v53
    v_mfma_f32_16x16x32_bf16 v[236:239], a[116:119], v[28:31], v[236:239]
    v_cvt_pk_bf16_f32 v67, v54, v55
    v_cvt_pk_bf16_f32 v68, v56, v57
    v_mfma_f32_16x16x32_bf16 v[240:243], a[120:123], v[24:27], v[240:243]
    ds_read_b128 a[88:91], v14 offset:22528
    v_cvt_pk_bf16_f32 v69, v58, v59
    v_cvt_pk_bf16_f32 v70, v60, v61
    v_mfma_f32_16x16x32_bf16 v[248:251], a[120:123], v[28:31], v[248:251]
    buffer_load_dwordx4 a[36:39], v14, s[16:19], s32 offen offset:1024 sc1
    v_cvt_pk_bf16_f32 v71, v62, v63
    v_add_f32 v2, v8, v9
    v_mfma_f32_16x16x32_bf16 v[244:247], a[124:127], v[24:27], v[244:247]
    ds_read_b128 a[92:95], v14 offset:23552
    v_cmp_nge_f32 vcc, 1266679808, v2
    v_mfma_f32_16x16x32_bf16 v[252:255], a[124:127], v[28:31], v[252:255]
    s_waitcnt lgkmcnt(4)
    s_cbranch_vccnz .Lmain_kernel_rare_157
.Lmain_kernel_rarer_158:
    v_mfma_f32_16x16x32_bf16 v[32:35], a[64:67], v[64:67], v[32:35]
    s_mov_b32 s36, 3
    s_mov_b32 s38, -1
    ds_read_b128 a[96:99], v14 offset:24576
    buffer_load_dwordx4 a[40:43], v14, s[16:19], s32 offen offset:2048 sc1
    v_mfma_f32_16x16x32_bf16 v[40:43], a[64:67], v[68:71], v[40:43]
    s_sub_u32 s37, 6, s41
    v_add_f32 v22, v22, v8
    v_add_f32 v23, v23, v9
    s_nop 1
    v_permlane32_swap_b32 v22, v23
    v_mfma_f32_16x16x32_bf16 v[36:39], a[68:71], v[64:67], v[36:39]
    ds_read_b128 a[100:103], v14 offset:25600
    buffer_load_dwordx4 a[44:47], v14, s[16:19], s32 offen offset:3072 sc1
    v_add_f32 v22, v22, v23
    v_mov_b32 v4, v22
    v_mfma_f32_16x16x32_bf16 v[44:47], a[68:71], v[68:71], v[44:47]
    s_nop 0
    v_permlane16_swap_b32 v22, v4
    v_add_f32 v22, v22, v4
    v_mov_b32 v23, v22
    v_mfma_f32_16x16x32_bf16 v[96:99], a[72:75], v[64:67], v[96:99]
    s_add_u32 s32, s32, 4096
    ds_read_b128 a[104:107], v14 offset:26624
    v_permlane32_swap_b32 v22, v23
    v_rcp_f32 v132, v22
    v_mfma_f32_16x16x32_bf16 v[104:107], a[72:75], v[68:71], v[104:107]
    v_rcp_f32 v133, v23
    v_mov_b32 v20, 0
    v_mfma_f32_16x16x32_bf16 v[100:103], a[76:79], v[64:67], v[100:103]
    ds_read_b128 a[108:111], v14 offset:27648
    buffer_load_dwordx4 a[48:51], v14, s[16:19], s32 offen offset:0 sc1
    v_mov_b32 v21, 0
    v_mov_b32 v22, 0
    v_mfma_f32_16x16x32_bf16 v[108:111], a[76:79], v[68:71], v[108:111]
    s_waitcnt lgkmcnt(4)
    v_cvt_pk_bf16_f32 v32, v32, v33
    v_cvt_pk_bf16_f32 v33, v34, v35
    v_cvt_pk_bf16_f32 v34, v36, v37
    v_mov_b32 v23, 0
    v_mov_b32 v112, 0
    v_mfma_f32_16x16x32_bf16 v[160:163], a[80:83], v[64:67], v[160:163]
    ds_read_b128 a[112:115], v14 offset:28672
    v_cvt_pk_bf16_f32 v35, v38, v39
    v_mov_b32 v113, 0
    v_mov_b32 v114, 0
    v_mov_b32 v115, 0
    v_mfma_f32_16x16x32_bf16 v[168:171], a[80:83], v[68:71], v[168:171]
    buffer_load_dwordx4 a[52:55], v14, s[16:19], s32 offen offset:1024 sc1
    v_mov_b32 v116, 0
    v_mov_b32 v117, 0
    v_accvgpr_write_b32 a128, v32
    v_accvgpr_write_b32 a129, v33
    v_mfma_f32_16x16x32_bf16 v[164:167], a[84:87], v[64:67], v[164:167]
    ds_read_b128 a[116:119], v14 offset:29696
    v_cvt_pk_bf16_f32 v96, v96, v97
    v_cvt_pk_bf16_f32 v97, v98, v99
    v_cvt_pk_bf16_f32 v98, v100, v101
    v_mov_b32 v118, 0
    v_mov_b32 v119, 0
    v_mov_b32 v120, 0
    v_accvgpr_write_b32 a130, v34
    v_mfma_f32_16x16x32_bf16 v[172:175], a[84:87], v[68:71], v[172:175]
    buffer_load_dwordx4 a[56:59], v14, s[16:19], s32 offen offset:2048 sc1
    v_mov_b32 v121, 0
    v_mov_b32 v122, 0
    v_accvgpr_write_b32 a131, v35
    v_cvt_pk_bf16_f32 v40, v40, v41
    v_cvt_pk_bf16_f32 v41, v42, v43
    v_cvt_pk_bf16_f32 v42, v44, v45
    v_cvt_pk_bf16_f32 v43, v46, v47
    v_accvgpr_write_b32 a132, v40
    v_accvgpr_write_b32 a133, v41
    v_accvgpr_write_b32 a134, v42
    v_accvgpr_write_b32 a135, v43
    v_mfma_f32_16x16x32_bf16 v[176:179], a[88:91], v[64:67], v[176:179]
    ds_read_b128 a[120:123], v14 offset:30720
    v_cvt_pk_bf16_f32 v99, v102, v103
    v_mov_b32 v123, 0
    v_mov_b32 v124, 0
    v_mov_b32 v125, 0
    v_mov_b32 v126, 0
    v_mov_b32 v127, 0
    v_mfma_f32_16x16x32_bf16 v[184:187], a[88:91], v[68:71], v[184:187]
    buffer_load_dwordx4 a[60:63], v14, s[16:19], s32 offen offset:3072 sc1
    v_accvgpr_write_b32 a136, v96
    v_accvgpr_write_b32 a137, v97
    v_accvgpr_write_b32 a138, v98
    v_mfma_f32_16x16x32_bf16 v[180:183], a[92:95], v[64:67], v[180:183]
    s_waitcnt lgkmcnt(3)
    ds_read_b128 a[124:127], v14 offset:31744
    v_cvt_pk_bf16_f32 v160, v160, v161
    v_cvt_pk_bf16_f32 v161, v162, v163
    v_cvt_pk_bf16_f32 v162, v164, v165
    v_accvgpr_write_b32 a139, v99
    v_cvt_pk_bf16_f32 v104, v104, v105
    v_cvt_pk_bf16_f32 v105, v106, v107
    v_cvt_pk_bf16_f32 v106, v108, v109
    v_cvt_pk_bf16_f32 v107, v110, v111
    v_accvgpr_write_b32 a140, v104
    v_accvgpr_write_b32 a141, v105
    v_accvgpr_write_b32 a142, v106
    v_accvgpr_write_b32 a143, v107
    v_mfma_f32_16x16x32_bf16 v[188:191], a[92:95], v[68:71], v[188:191]
    s_barrier
    v_mfma_f32_16x16x32_bf16 v[192:195], a[96:99], v[64:67], v[192:195]
    s_add_u32 s32, s32, 4096
    ds_read_b128 a[64:67], v16 offset:0
    v_cvt_pk_bf16_f32 v163, v166, v167
    v_accvgpr_write_b32 a144, v160
    v_accvgpr_write_b32 a145, v161
    v_mfma_f32_16x16x32_bf16 v[200:203], a[96:99], v[68:71], v[200:203]
    v_accvgpr_write_b32 a146, v162
    v_accvgpr_write_b32 a147, v163
    v_mfma_f32_16x16x32_bf16 v[196:199], a[100:103], v[64:67], v[196:199]
    s_add_u32 m0, s76, 49152
    ds_read_b128 a[68:71], v16 offset:1024
    v_cvt_pk_bf16_f32 v168, v168, v169
    v_cvt_pk_bf16_f32 v169, v170, v171
    v_cvt_pk_bf16_f32 v170, v172, v173
    v_cvt_pk_bf16_f32 v176, v176, v177
    v_cvt_pk_bf16_f32 v177, v178, v179
    v_mfma_f32_16x16x32_bf16 v[204:207], a[100:103], v[68:71], v[204:207]
    v_cvt_pk_bf16_f32 v171, v174, v175
    v_cvt_pk_bf16_f32 v178, v180, v181
    v_accvgpr_write_b32 a148, v168
    v_accvgpr_write_b32 a149, v169
    v_accvgpr_write_b32 a150, v170
    v_accvgpr_write_b32 a151, v171
    v_mfma_f32_16x16x32_bf16 v[208:211], a[104:107], v[64:67], v[208:211]
    ds_read_b128 a[72:75], v16 offset:2048
    buffer_load_dwordx4 v0, s[64:67], s60 offen offset:0 sc1 lds
    v_cvt_pk_bf16_f32 v179, v182, v183
    v_accvgpr_write_b32 a152, v176
    v_mfma_f32_16x16x32_bf16 v[216:219], a[104:107], v[68:71], v[216:219]
    v_accvgpr_write_b32 a153, v177
    v_accvgpr_write_b32 a154, v178
    v_accvgpr_write_b32 a155, v179
    v_mfma_f32_16x16x32_bf16 v[212:215], a[108:111], v[64:67], v[212:215]
    ds_read_b128 a[76:79], v16 offset:3072
    buffer_load_dwordx4 v0, s[64:67], s60 offen offset:1024 sc1 lds
    v_cvt_pk_bf16_f32 v184, v184, v185
    v_cvt_pk_bf16_f32 v185, v186, v187
    v_cvt_pk_bf16_f32 v192, v192, v193
    v_cvt_pk_bf16_f32 v193, v194, v195
    v_cvt_pk_bf16_f32 v194, v196, v197
    v_mfma_f32_16x16x32_bf16 v[220:223], a[108:111], v[68:71], v[220:223]
    s_waitcnt lgkmcnt(4)
    v_cvt_pk_bf16_f32 v186, v188, v189
    v_cvt_pk_bf16_f32 v187, v190, v191
    v_accvgpr_write_b32 a156, v184
    v_accvgpr_write_b32 a157, v185
    v_accvgpr_write_b32 a158, v186
    v_accvgpr_write_b32 a159, v187
    v_mfma_f32_16x16x32_bf16 v[224:227], a[112:115], v[64:67], v[224:227]
    ds_read_b128 a[80:83], v16 offset:4096
    v_cvt_pk_bf16_f32 v195, v198, v199
    v_accvgpr_write_b32 a160, v192
    v_accvgpr_write_b32 a161, v193
    v_mfma_f32_16x16x32_bf16 v[232:235], a[112:115], v[68:71], v[232:235]
    buffer_load_dwordx4 v0, s[64:67], s60 offen offset:2048 sc1 lds
    v_accvgpr_write_b32 a162, v194
    v_accvgpr_write_b32 a163, v195
    v_mfma_f32_16x16x32_bf16 v[228:231], a[116:119], v[64:67], v[228:231]
    ds_read_b128 a[84:87], v16 offset:5120
    v_cvt_pk_bf16_f32 v200, v200, v201
    v_cvt_pk_bf16_f32 v201, v202, v203
    v_cvt_pk_bf16_f32 v202, v204, v205
    v_cvt_pk_bf16_f32 v208, v208, v209
    v_cvt_pk_bf16_f32 v209, v210, v211
    v_cvt_pk_bf16_f32 v210, v212, v213
    v_mfma_f32_16x16x32_bf16 v[236:239], a[116:119], v[68:71], v[236:239]
    buffer_load_dwordx4 v0, s[64:67], s60 offen offset:3072 sc1 lds
    v_cvt_pk_bf16_f32 v203, v206, v207
    v_accvgpr_write_b32 a164, v200
    v_accvgpr_write_b32 a165, v201
    v_accvgpr_write_b32 a166, v202
    v_accvgpr_write_b32 a167, v203
    v_mfma_f32_16x16x32_bf16 v[240:243], a[120:123], v[64:67], v[240:243]
    ds_read_b128 a[88:91], v16 offset:6144
    v_cvt_pk_bf16_f32 v211, v214, v215
    v_accvgpr_write_b32 a168, v208
    v_accvgpr_write_b32 a169, v209
    v_mfma_f32_16x16x32_bf16 v[248:251], a[120:123], v[68:71], v[248:251]
    s_add_u32 s60, s60, 16384
    v_accvgpr_write_b32 a170, v210
    v_accvgpr_write_b32 a171, v211
    v_mfma_f32_16x16x32_bf16 v[244:247], a[124:127], v[64:67], v[244:247]
    ds_read_b128 a[92:95], v16 offset:7168
    v_cvt_pk_bf16_f32 v216, v216, v217
    v_cvt_pk_bf16_f32 v217, v218, v219
    v_cvt_pk_bf16_f32 v218, v220, v221
    v_cvt_pk_bf16_f32 v224, v224, v225
    v_cvt_pk_bf16_f32 v225, v226, v227
    v_mfma_f32_16x16x32_bf16 v[252:255], a[124:127], v[68:71], v[252:255]
    s_waitcnt lgkmcnt(4)
    v_cvt_pk_bf16_f32 v219, v222, v223
    v_cvt_pk_bf16_f32 v226, v228, v229
    v_cvt_pk_bf16_f32 v227, v230, v231
    v_accvgpr_write_b32 a172, v216
    v_accvgpr_write_b32 a173, v217
    v_accvgpr_write_b32 a174, v218
    v_accvgpr_write_b32 a175, v219
    v_accvgpr_write_b32 a176, v224
    v_accvgpr_write_b32 a177, v225
    v_accvgpr_write_b32 a178, v226
    v_accvgpr_write_b32 a179, v227
    v_cvt_pk_bf16_f32 v232, v232, v233
    v_cvt_pk_bf16_f32 v233, v234, v235
    v_cvt_pk_bf16_f32 v234, v236, v237
    v_cvt_pk_bf16_f32 v235, v238, v239
    v_accvgpr_write_b32 a180, v232
    v_accvgpr_write_b32 a181, v233
    v_accvgpr_write_b32 a182, v234
    v_accvgpr_write_b32 a183, v235
    v_cvt_pk_bf16_f32 v240, v240, v241
    v_cvt_pk_bf16_f32 v241, v242, v243
    v_cvt_pk_bf16_f32 v242, v244, v245
    v_cvt_pk_bf16_f32 v243, v246, v247
    v_accvgpr_write_b32 a184, v240
    v_accvgpr_write_b32 a185, v241
    v_accvgpr_write_b32 a186, v242
    v_accvgpr_write_b32 a187, v243
    v_cvt_pk_bf16_f32 v248, v248, v249
    v_cvt_pk_bf16_f32 v249, v250, v251
    v_cvt_pk_bf16_f32 v250, v252, v253
    v_cvt_pk_bf16_f32 v251, v254, v255
    v_accvgpr_write_b32 a188, v248
    v_accvgpr_write_b32 a189, v249
    v_accvgpr_write_b32 a190, v250
    v_accvgpr_write_b32 a191, v251
    s_branch .Lmain_kernel_job_29
.Lmain_kernel_fin_150:
    s_cmp_eq_u32 s36, 3
    s_cbranch_scc1 .Lmain_kernel_part_151
    v_mfma_f32_16x16x32_bf16 v[32:35], a[64:67], v[24:27], v[32:35]
    s_add_u32 s31, s33, 128
    ds_read_b128 a[96:99], v14 offset:8192
    v_lshrrev_b32 v129, 6, v14
    v_mfma_f32_16x16x32_bf16 v[40:43], a[64:67], v[28:31], v[40:43]
    v_bfe_u32 v130, v129, 1, 2
    v_exp_f32 v48, v80
    v_mfma_f32_16x16x32_bf16 v[36:39], a[68:71], v[24:27], v[36:39]
    s_add_u32 m0, s76, 65536
    ds_read_b128 a[100:103], v14 offset:9216
    v_lshlrev_b32 v129, 7, v129
    v_mfma_f32_16x16x32_bf16 v[44:47], a[68:71], v[28:31], v[44:47]
    v_bfe_u32 v131, v14, 1, 5
    v_exp_f32 v49, v81
    v_mfma_f32_16x16x32_bf16 v[96:99], a[72:75], v[24:27], v[96:99]
    ds_read_b128 a[104:107], v14 offset:10240
    v_add_u32 v129, v129, v131
    v_exp_f32 v50, v82
    v_mfma_f32_16x16x32_bf16 v[104:107], a[72:75], v[28:31], v[104:107]
    buffer_load_dwordx4 v10, s[8:11], s31 offen offset:0 lds
    v_xor_b32 v131, 0, v130
    v_add_f32 v8, v48, v49
    v_mfma_f32_16x16x32_bf16 v[100:103], a[76:79], v[24:27], v[100:103]
    ds_read_b128 a[108:111], v14 offset:11264
    v_lshl_add_u32 v144, v131, 5, v129
    v_exp_f32 v51, v83
    v_mfma_f32_16x16x32_bf16 v[108:111], a[76:79], v[28:31], v[108:111]
    s_waitcnt lgkmcnt(4)
    buffer_load_dwordx4 v11, s[8:11], s31 offen offset:1024 lds
    v_xor_b32 v131, 1, v130
    v_add_f32 v8, v8, v50
    v_mfma_f32_16x16x32_bf16 v[160:163], a[80:83], v[24:27], v[160:163]
    ds_read_b128 a[112:115], v14 offset:12288
    v_exp_f32 v56, v88
    v_add_f32 v8, v8, v51
    v_mfma_f32_16x16x32_bf16 v[168:171], a[80:83], v[28:31], v[168:171]
    v_lshl_add_u32 v145, v131, 5, v129
    v_exp_f32 v57, v89
    v_mfma_f32_16x16x32_bf16 v[164:167], a[84:87], v[24:27], v[164:167]
    ds_read_b128 a[116:119], v14 offset:13312
    buffer_load_dwordx4 v12, s[8:11], s31 offen offset:2048 lds
    v_exp_f32 v58, v90
    v_mfma_f32_16x16x32_bf16 v[172:175], a[84:87], v[28:31], v[172:175]
    v_xor_b32 v131, 2, v130
    v_lshl_add_u32 v146, v131, 5, v129
    v_add_f32 v9, v56, v57
    v_mfma_f32_16x16x32_bf16 v[176:179], a[88:91], v[24:27], v[176:179]
    ds_read_b128 a[120:123], v14 offset:14336
    buffer_load_dwordx4 v13, s[8:11], s31 offen offset:3072 lds
    v_exp_f32 v59, v91
    v_mfma_f32_16x16x32_bf16 v[184:187], a[88:91], v[28:31], v[184:187]
    v_xor_b32 v131, 3, v130
    v_lshl_add_u32 v147, v131, 5, v129
    v_add_f32 v9, v9, v58
    v_mfma_f32_16x16x32_bf16 v[180:183], a[92:95], v[24:27], v[180:183]
    s_waitcnt vmcnt(16)
    s_waitcnt lgkmcnt(3)
    ds_read_b128 a[124:127], v14 offset:15360
    v_exp_f32 v52, v84
    v_add_f32 v9, v9, v59
    v_exp_f32 v53, v85
    v_add_f32 v8, v8, v52
    v_mfma_f32_16x16x32_bf16 v[188:191], a[92:95], v[28:31], v[188:191]
    s_barrier
    v_mfma_f32_16x16x32_bf16 v[192:195], a[96:99], v[24:27], v[192:195]
    s_add_u32 s31, s33, 114816
    ds_read_b128 a[64:67], v14 offset:16384
    v_add_u32 v152, 0x20000, v144
    v_exp_f32 v54, v86
    v_mfma_f32_16x16x32_bf16 v[200:203], a[96:99], v[28:31], v[200:203]
    v_add_u32 v153, 0x20000, v145
    v_add_u32 v154, 0x20000, v146
    v_add_f32 v8, v8, v53
    v_mfma_f32_16x16x32_bf16 v[196:199], a[100:103], v[24:27], v[196:199]
    s_add_u32 m0, s76, 81920
    ds_read_b128 a[68:71], v14 offset:17408
    v_add_u32 v155, 0x20000, v147
    v_exp_f32 v55, v87
    v_mfma_f32_16x16x32_bf16 v[204:207], a[100:103], v[28:31], v[204:207]
    v_add_u32 v148, 0x10000, v144
    v_add_f32 v8, v8, v54
    v_exp_f32 v60, v92
    v_mfma_f32_16x16x32_bf16 v[208:211], a[104:107], v[24:27], v[208:211]
    ds_read_b128 a[72:75], v14 offset:18432
    buffer_load_dwordx4 v10, s[8:11], s31 offen offset:0 lds
    v_add_f32 v8, v8, v55
    v_mfma_f32_16x16x32_bf16 v[216:219], a[104:107], v[28:31], v[216:219]
    v_add_u32 v149, 0x10000, v145
    v_add_u32 v150, 0x10000, v146
    v_exp_f32 v61, v93
    v_mfma_f32_16x16x32_bf16 v[212:215], a[108:111], v[24:27], v[212:215]
    ds_read_b128 a[76:79], v14 offset:19456
    v_add_u32 v151, 0x10000, v147
    v_add_f32 v9, v9, v60
    v_mfma_f32_16x16x32_bf16 v[220:223], a[108:111], v[28:31], v[220:223]
    s_waitcnt lgkmcnt(4)
    buffer_load_dwordx4 v11, s[8:11], s31 offen offset:1024 lds
    buffer_load_dwordx4 v[128:131], v14, s[16:19], s47 offen sc1
    v_exp_f32 v62, v94
    v_mfma_f32_16x16x32_bf16 v[224:227], a[112:115], v[24:27], v[224:227]
    ds_read_b128 a[80:83], v14 offset:20480
    v_add_f32 v9, v9, v61
    v_exp_f32 v63, v95
    v_mfma_f32_16x16x32_bf16 v[232:235], a[112:115], v[28:31], v[232:235]
    buffer_load_dwordx4 v12, s[8:11], s31 offen offset:2048 lds
    v_add_f32 v9, v9, v62
    v_mfma_f32_16x16x32_bf16 v[228:231], a[116:119], v[24:27], v[228:231]
    ds_read_b128 a[84:87], v14 offset:21504
    v_add_f32 v9, v9, v63
    v_cvt_pk_bf16_f32 v64, v48, v49
    v_mfma_f32_16x16x32_bf16 v[236:239], a[116:119], v[28:31], v[236:239]
    v_cvt_pk_bf16_f32 v65, v50, v51
    v_cvt_pk_bf16_f32 v66, v52, v53
    v_cvt_pk_bf16_f32 v67, v54, v55
    v_mfma_f32_16x16x32_bf16 v[240:243], a[120:123], v[24:27], v[240:243]
    ds_read_b128 a[88:91], v14 offset:22528
    buffer_load_dwordx4 v13, s[8:11], s31 offen offset:3072 lds
    v_cvt_pk_bf16_f32 v68, v56, v57
    v_mfma_f32_16x16x32_bf16 v[248:251], a[120:123], v[28:31], v[248:251]
    v_cvt_pk_bf16_f32 v69, v58, v59
    v_cvt_pk_bf16_f32 v70, v60, v61
    v_mfma_f32_16x16x32_bf16 v[244:247], a[124:127], v[24:27], v[244:247]
    ds_read_b128 a[92:95], v14 offset:23552
    v_cvt_pk_bf16_f32 v71, v62, v63
    v_add_f32 v2, v8, v9
    v_cmp_nge_f32 vcc, 1266679808, v2
    v_mfma_f32_16x16x32_bf16 v[252:255], a[124:127], v[28:31], v[252:255]
    s_waitcnt lgkmcnt(4)
    s_cbranch_vccnz .Lmain_kernel_rare_159
.Lmain_kernel_rarer_160:
    s_cmp_eq_u32 s36, 2
    s_cbranch_scc1 .Lmain_kernel_merge_152
    v_mfma_f32_16x16x32_bf16 v[32:35], a[64:67], v[64:67], v[32:35]
    s_add_u32 s31, s33, 256
    ds_read_b128 a[96:99], v14 offset:24576
    v_add_f32 v22, v22, v8
    v_mfma_f32_16x16x32_bf16 v[40:43], a[64:67], v[68:71], v[40:43]
    v_add_f32 v23, v23, v9
    s_nop 1
    v_permlane32_swap_b32 v22, v23
    v_mfma_f32_16x16x32_bf16 v[36:39], a[68:71], v[64:67], v[36:39]
    s_add_u32 m0, s76, 98304
    ds_read_b128 a[100:103], v14 offset:25600
    v_add_f32 v22, v22, v23
    v_mfma_f32_16x16x32_bf16 v[44:47], a[68:71], v[68:71], v[44:47]
    v_mov_b32 v4, v22
    s_nop 1
    v_permlane16_swap_b32 v22, v4
    v_mfma_f32_16x16x32_bf16 v[96:99], a[72:75], v[64:67], v[96:99]
    ds_read_b128 a[104:107], v14 offset:26624
    v_add_f32 v22, v22, v4
    v_mfma_f32_16x16x32_bf16 v[104:107], a[72:75], v[68:71], v[104:107]
    buffer_load_dwordx4 v10, s[8:11], s31 offen offset:0 lds
    v_mov_b32 v23, v22
    v_mfma_f32_16x16x32_bf16 v[100:103], a[76:79], v[64:67], v[100:103]
    ds_read_b128 a[108:111], v14 offset:27648
    v_cvt_pk_bf16_f32 v32, v32, v33
    v_cvt_pk_bf16_f32 v33, v34, v35
    v_permlane32_swap_b32 v22, v23
    v_mfma_f32_16x16x32_bf16 v[108:111], a[76:79], v[68:71], v[108:111]
    s_waitcnt lgkmcnt(4)
    buffer_load_dwordx4 v11, s[8:11], s31 offen offset:1024 lds
    v_cvt_pk_bf16_f32 v34, v36, v37
    v_rcp_f32 v132, v22
    v_mfma_f32_16x16x32_bf16 v[160:163], a[80:83], v[64:67], v[160:163]
    ds_read_b128 a[112:115], v14 offset:28672
    v_rcp_f32 v133, v23
    v_mfma_f32_16x16x32_bf16 v[168:171], a[80:83], v[68:71], v[168:171]
    v_cvt_pk_bf16_f32 v35, v38, v39
    v_cvt_pk_bf16_f32 v40, v40, v41
    v_cvt_pk_bf16_f32 v41, v42, v43
    v_mfma_f32_16x16x32_bf16 v[164:167], a[84:87], v[64:67], v[164:167]
    ds_read_b128 a[116:119], v14 offset:29696
    buffer_load_dwordx4 v12, s[8:11], s31 offen offset:2048 lds
    v_cvt_pk_bf16_f32 v96, v96, v97
    v_mfma_f32_16x16x32_bf16 v[172:175], a[84:87], v[68:71], v[172:175]
    v_cvt_pk_bf16_f32 v42, v44, v45
    v_cvt_pk_bf16_f32 v43, v46, v47
    v_cvt_pk_bf16_f32 v97, v98, v99
    v_mfma_f32_16x16x32_bf16 v[176:179], a[88:91], v[64:67], v[176:179]
    ds_read_b128 a[120:123], v14 offset:30720
    buffer_load_dwordx4 v13, s[8:11], s31 offen offset:3072 lds
    v_cvt_pk_bf16_f32 v98, v100, v101
    v_mfma_f32_16x16x32_bf16 v[184:187], a[88:91], v[68:71], v[184:187]
    v_cvt_pk_bf16_f32 v99, v102, v103
    v_cvt_pk_bf16_f32 v104, v104, v105
    v_cvt_pk_bf16_f32 v105, v106, v107
    v_mfma_f32_16x16x32_bf16 v[180:183], a[92:95], v[64:67], v[180:183]
    s_waitcnt vmcnt(24)
    s_waitcnt lgkmcnt(3)
    ds_read_b128 a[124:127], v14 offset:31744
    v_cvt_pk_bf16_f32 v106, v108, v109
    v_cvt_pk_bf16_f32 v107, v110, v111
    v_cvt_pk_bf16_f32 v160, v160, v161
    v_cvt_pk_bf16_f32 v161, v162, v163
    v_mfma_f32_16x16x32_bf16 v[188:191], a[92:95], v[68:71], v[188:191]
    s_barrier
    v_mfma_f32_16x16x32_bf16 v[192:195], a[96:99], v[64:67], v[192:195]
    s_add_u32 s31, s33, 114944
    ds_read_b64_tr_b16 a[64:65], v152 offset:0
    ds_read_b64_tr_b16 a[66:67], v152 offset:2048
    v_cvt_pk_bf16_f32 v162, v164, v165
    v_mfma_f32_16x16x32_bf16 v[200:203], a[96:99], v[68:71], v[200:203]
    v_cvt_pk_bf16_f32 v163, v166, v167
    v_cvt_pk_bf16_f32 v168, v168, v169
    v_cvt_pk_bf16_f32 v169, v170, v171
    v_mfma_f32_16x16x32_bf16 v[196:199], a[100:103], v[64:67], v[196:199]
    s_add_u32 m0, s76, 114688
    ds_read_b64_tr_b16 a[68:69], v153 offset:0
    ds_read_b64_tr_b16 a[70:71], v153 offset:2048
    v_cvt_pk_bf16_f32 v176, v176, v177
    v_mfma_f32_16x16x32_bf16 v[204:207], a[100:103], v[68:71], v[204:207]
    v_cvt_pk_bf16_f32 v170, v172, v173
    v_cvt_pk_bf16_f32 v171, v174, v175
    v_cvt_pk_bf16_f32 v177, v178, v179
    v_mfma_f32_16x16x32_bf16 v[208:211], a[104:107], v[64:67], v[208:211]
    ds_read_b64_tr_b16 a[72:73], v152 offset:4096
    ds_read_b64_tr_b16 a[74:75], v152 offset:6144
    v_cvt_pk_bf16_f32 v178, v180, v181
    v_mfma_f32_16x16x32_bf16 v[216:219], a[104:107], v[68:71], v[216:219]
    buffer_load_dwordx4 v10, s[8:11], s31 offen offset:0 lds
    v_cvt_pk_bf16_f32 v179, v182, v183
    v_cvt_pk_bf16_f32 v184, v184, v185
    v_mfma_f32_16x16x32_bf16 v[212:215], a[108:111], v[64:67], v[212:215]
    ds_read_b64_tr_b16 a[76:77], v153 offset:4096
    ds_read_b64_tr_b16 a[78:79], v153 offset:6144
    v_cvt_pk_bf16_f32 v185, v186, v187
    v_cvt_pk_bf16_f32 v192, v192, v193
    v_mfma_f32_16x16x32_bf16 v[220:223], a[108:111], v[68:71], v[220:223]
    s_waitcnt lgkmcnt(8)
    buffer_load_dwordx4 v11, s[8:11], s31 offen offset:1024 lds
    v_cvt_pk_bf16_f32 v186, v188, v189
    v_cvt_pk_bf16_f32 v187, v190, v191
    v_cvt_pk_bf16_f32 v193, v194, v195
    v_mfma_f32_16x16x32_bf16 v[224:227], a[112:115], v[64:67], v[224:227]
    ds_read_b64_tr_b16 a[80:81], v152 offset:8192
    ds_read_b64_tr_b16 a[82:83], v152 offset:10240
    v_cvt_pk_bf16_f32 v194, v196, v197
    v_mfma_f32_16x16x32_bf16 v[232:235], a[112:115], v[68:71], v[232:235]
    buffer_load_dwordx4 v12, s[8:11], s31 offen offset:2048 lds
    v_cvt_pk_bf16_f32 v195, v198, v199
    v_cvt_pk_bf16_f32 v200, v200, v201
    v_mfma_f32_16x16x32_bf16 v[228:231], a[116:119], v[64:67], v[228:231]
    ds_read_b64_tr_b16 a[84:85], v153 offset:8192
    ds_read_b64_tr_b16 a[86:87], v153 offset:10240
    v_cvt_pk_bf16_f32 v201, v202, v203
    v_mfma_f32_16x16x32_bf16 v[236:239], a[116:119], v[68:71], v[236:239]
    v_cvt_pk_bf16_f32 v202, v204, v205
    v_cvt_pk_bf16_f32 v203, v206, v207
    v_cvt_pk_bf16_f32 v208, v208, v209
    v_cvt_pk_bf16_f32 v209, v210, v211
    v_mfma_f32_16x16x32_bf16 v[240:243], a[120:123], v[64:67], v[240:243]
    ds_read_b64_tr_b16 a[88:89], v152 offset:12288
    ds_read_b64_tr_b16 a[90:91], v152 offset:14336
    v_cvt_pk_bf16_f32 v210, v212, v213
    v_mfma_f32_16x16x32_bf16 v[248:251], a[120:123], v[68:71], v[248:251]
    buffer_load_dwordx4 v13, s[8:11], s31 offen offset:3072 lds
    v_cvt_pk_bf16_f32 v211, v214, v215
    v_cvt_pk_bf16_f32 v216, v216, v217
    v_mfma_f32_16x16x32_bf16 v[244:247], a[124:127], v[64:67], v[244:247]
    ds_read_b64_tr_b16 a[92:93], v153 offset:12288
    ds_read_b64_tr_b16 a[94:95], v153 offset:14336
    v_cvt_pk_bf16_f32 v217, v218, v219
    v_mfma_f32_16x16x32_bf16 v[252:255], a[124:127], v[68:71], v[252:255]
    s_waitcnt lgkmcnt(8)
    v_cvt_pk_bf16_f32 v218, v220, v221
    v_cvt_pk_bf16_f32 v219, v222, v223
    s_branch .Lmain_kernel_wo_153
.Lmain_kernel_part_151:
    v_mfma_f32_16x16x32_bf16 v[32:35], a[64:67], v[24:27], v[32:35]
    s_add_u32 s31, s33, 128
    s_add_u32 m0, s76, 65536
    ds_read_b128 a[96:99], v14 offset:8192
    v_mfma_f32_16x16x32_bf16 v[40:43], a[64:67], v[28:31], v[40:43]
    buffer_load_dwordx4 v10, s[8:11], s31 offen offset:0 lds
    v_exp_f32 v48, v80
    v_exp_f32 v49, v81
    v_mfma_f32_16x16x32_bf16 v[36:39], a[68:71], v[24:27], v[36:39]
    s_waitcnt vmcnt(13)
    ds_read_b128 a[100:103], v14 offset:9216
    v_exp_f32 v50, v82
    v_add_f32 v8, v48, v49
    v_exp_f32 v51, v83
    v_add_f32 v8, v8, v50
    v_mfma_f32_16x16x32_bf16 v[44:47], a[68:71], v[28:31], v[44:47]
    s_barrier
    v_mfma_f32_16x16x32_bf16 v[96:99], a[72:75], v[24:27], v[96:99]
    ds_read_b128 a[104:107], v14 offset:16384
    v_exp_f32 v56, v88
    v_add_f32 v8, v8, v51
    v_mfma_f32_16x16x32_bf16 v[104:107], a[72:75], v[28:31], v[104:107]
    v_exp_f32 v57, v89
    v_exp_f32 v58, v90
    v_mfma_f32_16x16x32_bf16 v[100:103], a[76:79], v[24:27], v[100:103]
    ds_read_b128 a[108:111], v14 offset:17408
    v_add_f32 v9, v56, v57
    v_exp_f32 v59, v91
    v_mfma_f32_16x16x32_bf16 v[108:111], a[76:79], v[28:31], v[108:111]
    s_waitcnt lgkmcnt(4)
    buffer_load_dwordx4 v11, s[8:11], s31 offen offset:1024 lds
    v_add_f32 v9, v9, v58
    v_exp_f32 v52, v84
    v_mfma_f32_16x16x32_bf16 v[160:163], a[80:83], v[24:27], v[160:163]
    ds_read_b128 a[112:115], v14 offset:18432
    v_add_f32 v9, v9, v59
    v_exp_f32 v53, v85
    v_mfma_f32_16x16x32_bf16 v[168:171], a[80:83], v[28:31], v[168:171]
    buffer_load_dwordx4 v12, s[8:11], s31 offen offset:2048 lds
    v_add_f32 v8, v8, v52
    v_exp_f32 v54, v86
    v_mfma_f32_16x16x32_bf16 v[164:167], a[84:87], v[24:27], v[164:167]
    ds_read_b128 a[116:119], v14 offset:19456
    v_add_f32 v8, v8, v53
    v_exp_f32 v55, v87
    v_mfma_f32_16x16x32_bf16 v[172:175], a[84:87], v[28:31], v[172:175]
    buffer_load_dwordx4 v13, s[8:11], s31 offen offset:3072 lds
    v_add_f32 v8, v8, v54
    v_exp_f32 v60, v92
    v_mfma_f32_16x16x32_bf16 v[176:179], a[88:91], v[24:27], v[176:179]
    ds_read_b128 a[120:123], v14 offset:20480
    v_add_f32 v8, v8, v55
    v_exp_f32 v61, v93
    v_mfma_f32_16x16x32_bf16 v[184:187], a[88:91], v[28:31], v[184:187]
    v_add_f32 v9, v9, v60
    v_exp_f32 v62, v94
    v_mfma_f32_16x16x32_bf16 v[180:183], a[92:95], v[24:27], v[180:183]
    ds_read_b128 a[124:127], v14 offset:21504
    v_add_f32 v9, v9, v61
    v_exp_f32 v63, v95
    v_mfma_f32_16x16x32_bf16 v[188:191], a[92:95], v[28:31], v[188:191]
    s_waitcnt lgkmcnt(4)
    v_add_f32 v9, v9, v62
    v_add_f32 v9, v9, v63
    v_cvt_pk_bf16_f32 v64, v48, v49
    v_mfma_f32_16x16x32_bf16 v[192:195], a[96:99], v[24:27], v[192:195]
    ds_read_b128 a[64:67], v14 offset:22528
    v_cvt_pk_bf16_f32 v65, v50, v51
    v_cvt_pk_bf16_f32 v66, v52, v53
    v_cvt_pk_bf16_f32 v67, v54, v55
    v_mfma_f32_16x16x32_bf16 v[200:203], a[96:99], v[28:31], v[200:203]
    v_cvt_pk_bf16_f32 v68, v56, v57
    v_cvt_pk_bf16_f32 v69, v58, v59
    v_cvt_pk_bf16_f32 v70, v60, v61
    v_cvt_pk_bf16_f32 v71, v62, v63
    v_add_f32 v2, v8, v9
    v_cmp_nge_f32 vcc, 1266679808, v2
    v_mfma_f32_16x16x32_bf16 v[196:199], a[100:103], v[24:27], v[196:199]
    ds_read_b128 a[68:71], v14 offset:23552
    v_mfma_f32_16x16x32_bf16 v[204:207], a[100:103], v[28:31], v[204:207]
    s_cbranch_vccnz .Lmain_kernel_rare_161
.Lmain_kernel_rarer_162:
    v_mfma_f32_16x16x32_bf16 v[32:35], a[104:107], v[64:67], v[32:35]
    ds_read_b128 a[72:75], v14 offset:24576
    v_lshrrev_b32 v129, 6, v14
    v_mfma_f32_16x16x32_bf16 v[40:43], a[104:107], v[68:71], v[40:43]
    v_bfe_u32 v130, v129, 1, 2
    v_lshlrev_b32 v129, 7, v129
    v_mfma_f32_16x16x32_bf16 v[36:39], a[108:111], v[64:67], v[36:39]
    ds_read_b128 a[76:79], v14 offset:25600
    v_bfe_u32 v131, v14, 1, 5
    v_mfma_f32_16x16x32_bf16 v[44:47], a[108:111], v[68:71], v[44:47]
    s_waitcnt lgkmcnt(4)
    v_add_u32 v129, v129, v131
    v_xor_b32 v131, 0, v130
    v_mfma_f32_16x16x32_bf16 v[96:99], a[112:115], v[64:67], v[96:99]
    ds_read_b128 a[80:83], v14 offset:10240
    v_lshl_add_u32 v144, v131, 5, v129
    v_mfma_f32_16x16x32_bf16 v[104:107], a[112:115], v[68:71], v[104:107]
    v_xor_b32 v131, 1, v130
    v_lshl_add_u32 v145, v131, 5, v129
    v_xor_b32 v131, 2, v130
    v_mfma_f32_16x16x32_bf16 v[100:103], a[116:119], v[64:67], v[100:103]
    ds_read_b128 a[84:87], v14 offset:26624
    v_cvt_pk_bf16_f32 v32, v32, v33
    v_lshl_add_u32 v146, v131, 5, v129
    v_mfma_f32_16x16x32_bf16 v[108:111], a[116:119], v[68:71], v[108:111]
    v_cvt_pk_bf16_f32 v33, v34, v35
    v_cvt_pk_bf16_f32 v34, v36, v37
    v_xor_b32 v131, 3, v130
    v_mfma_f32_16x16x32_bf16 v[160:163], a[120:123], v[64:67], v[160:163]
    ds_read_b128 a[88:91], v14 offset:11264
    v_cvt_pk_bf16_f32 v35, v38, v39
    v_lshl_add_u32 v147, v131, 5, v129
    v_mfma_f32_16x16x32_bf16 v[168:171], a[120:123], v[68:71], v[168:171]
    buffer_store_dwordx4 v[32:35], v14, s[16:19], s46 offen offset:0 sc1
    v_cvt_pk_bf16_f32 v40, v40, v41
    v_cvt_pk_bf16_f32 v41, v42, v43
    v_mfma_f32_16x16x32_bf16 v[164:167], a[124:127], v[64:67], v[164:167]
    ds_read_b128 a[92:95], v14 offset:27648
    v_cvt_pk_bf16_f32 v42, v44, v45
    v_cvt_pk_bf16_f32 v43, v46, v47
    buffer_store_dwordx4 v[40:43], v14, s[16:19], s46 offen offset:1024 sc1
    v_mfma_f32_16x16x32_bf16 v[172:175], a[124:127], v[68:71], v[172:175]
    s_waitcnt lgkmcnt(4)
    v_cvt_pk_bf16_f32 v96, v96, v97
    v_cvt_pk_bf16_f32 v97, v98, v99
    v_add_u32 v152, 0x20000, v144
    v_mfma_f32_16x16x32_bf16 v[176:179], a[64:67], v[64:67], v[176:179]
    ds_read_b128 a[96:99], v14 offset:12288
    v_cvt_pk_bf16_f32 v98, v100, v101
    v_add_u32 v153, 0x20000, v145
    v_mfma_f32_16x16x32_bf16 v[184:187], a[64:67], v[68:71], v[184:187]
    v_cvt_pk_bf16_f32 v99, v102, v103
    buffer_store_dwordx4 v[96:99], v14, s[16:19], s46 offen offset:2048 sc1
    v_mfma_f32_16x16x32_bf16 v[180:183], a[68:71], v[64:67], v[180:183]
    ds_read_b128 a[100:103], v14 offset:28672
    v_cvt_pk_bf16_f32 v104, v104, v105
    v_cvt_pk_bf16_f32 v105, v106, v107
    v_mfma_f32_16x16x32_bf16 v[188:191], a[68:71], v[68:71], v[188:191]
    v_cvt_pk_bf16_f32 v106, v108, v109
    v_cvt_pk_bf16_f32 v107, v110, v111
    buffer_store_dwordx4 v[104:107], v14, s[16:19], s46 offen offset:3072 sc1
    s_add_u32 s46, s46, 4096
    v_mfma_f32_16x16x32_bf16 v[192:195], a[72:75], v[64:67], v[192:195]
    ds_read_b128 a[104:107], v14 offset:13312
    v_cvt_pk_bf16_f32 v160, v160, v161
    v_add_u32 v154, 0x20000, v146
    v_mfma_f32_16x16x32_bf16 v[200:203], a[72:75], v[68:71], v[200:203]
    v_cvt_pk_bf16_f32 v161, v162, v163
    v_cvt_pk_bf16_f32 v162, v164, v165
    v_add_u32 v155, 0x20000, v147
    v_mfma_f32_16x16x32_bf16 v[196:199], a[76:79], v[64:67], v[196:199]
    ds_read_b128 a[108:111], v14 offset:29696
    v_cvt_pk_bf16_f32 v163, v166, v167
    v_add_u32 v148, 0x10000, v144
    v_mfma_f32_16x16x32_bf16 v[204:207], a[76:79], v[68:71], v[204:207]
    s_waitcnt lgkmcnt(4)
    buffer_store_dwordx4 v[160:163], v14, s[16:19], s46 offen offset:0 sc1
    v_cvt_pk_bf16_f32 v168, v168, v169
    v_cvt_pk_bf16_f32 v169, v170, v171
    v_mfma_f32_16x16x32_bf16 v[208:211], a[80:83], v[24:27], v[208:211]
    ds_read_b128 a[112:115], v14 offset:14336
    v_cvt_pk_bf16_f32 v170, v172, v173
    v_cvt_pk_bf16_f32 v171, v174, v175
    buffer_store_dwordx4 v[168:171], v14, s[16:19], s46 offen offset:1024 sc1
    v_mfma_f32_16x16x32_bf16 v[216:219], a[80:83], v[28:31], v[216:219]
    v_cvt_pk_bf16_f32 v176, v176, v177
    v_cvt_pk_bf16_f32 v177, v178, v179
    v_add_u32 v149, 0x10000, v145
    v_mfma_f32_16x16x32_bf16 v[208:211], a[84:87], v[64:67], v[208:211]
    ds_read_b128 a[116:119], v14 offset:30720
    v_cvt_pk_bf16_f32 v178, v180, v181
    v_add_u32 v150, 0x10000, v146
    v_add_u32 v151, 0x10000, v147
    v_mfma_f32_16x16x32_bf16 v[216:219], a[84:87], v[68:71], v[216:219]
    v_cvt_pk_bf16_f32 v179, v182, v183
    buffer_store_dwordx4 v[176:179], v14, s[16:19], s46 offen offset:2048 sc1
    v_mfma_f32_16x16x32_bf16 v[212:215], a[88:91], v[24:27], v[212:215]
    ds_read_b128 a[120:123], v14 offset:15360
    v_cvt_pk_bf16_f32 v184, v184, v185
    v_cvt_pk_bf16_f32 v185, v186, v187
    v_mfma_f32_16x16x32_bf16 v[220:223], a[88:91], v[28:31], v[220:223]
    v_cvt_pk_bf16_f32 v186, v188, v189
    v_cvt_pk_bf16_f32 v187, v190, v191
    buffer_store_dwordx4 v[184:187], v14, s[16:19], s46 offen offset:3072 sc1
    s_add_u32 s46, s46, 4096
    v_mfma_f32_16x16x32_bf16 v[212:215], a[92:95], v[64:67], v[212:215]
    s_waitcnt vmcnt(23)
    s_waitcnt lgkmcnt(3)
    ds_read_b128 a[124:127], v14 offset:31744
    v_cvt_pk_bf16_f32 v192, v192, v193
    v_cvt_pk_bf16_f32 v193, v194, v195
    v_cvt_pk_bf16_f32 v194, v196, v197
    v_mfma_f32_16x16x32_bf16 v[220:223], a[92:95], v[68:71], v[220:223]
    s_barrier
    v_mfma_f32_16x16x32_bf16 v[224:227], a[96:99], v[24:27], v[224:227]
    ds_read_b64_tr_b16 a[64:65], v152 offset:0
    ds_read_b64_tr_b16 a[66:67], v152 offset:2048
    v_cvt_pk_bf16_f32 v195, v198, v199
    v_add_f32 v22, v22, v8
    v_mfma_f32_16x16x32_bf16 v[232:235], a[96:99], v[28:31], v[232:235]
    buffer_store_dwordx4 v[192:195], v14, s[16:19], s46 offen offset:0 sc1
    v_cvt_pk_bf16_f32 v200, v200, v201
    v_cvt_pk_bf16_f32 v201, v202, v203
    v_mfma_f32_16x16x32_bf16 v[224:227], a[100:103], v[64:67], v[224:227]
    ds_read_b64_tr_b16 a[68:69], v153 offset:0
    ds_read_b64_tr_b16 a[70:71], v153 offset:2048
    v_cvt_pk_bf16_f32 v202, v204, v205
    v_cvt_pk_bf16_f32 v203, v206, v207
    buffer_store_dwordx4 v[200:203], v14, s[16:19], s46 offen offset:1024 sc1
    v_mfma_f32_16x16x32_bf16 v[232:235], a[100:103], v[68:71], v[232:235]
    v_cvt_pk_bf16_f32 v208, v208, v209
    v_cvt_pk_bf16_f32 v209, v210, v211
    v_cvt_pk_bf16_f32 v210, v212, v213
    v_add_f32 v23, v23, v9
    v_mfma_f32_16x16x32_bf16 v[228:231], a[104:107], v[24:27], v[228:231]
    ds_read_b64_tr_b16 a[72:73], v152 offset:4096
    ds_read_b64_tr_b16 a[74:75], v152 offset:6144
    v_permlane32_swap_b32 v22, v23
    v_add_f32 v22, v22, v23
    v_mfma_f32_16x16x32_bf16 v[236:239], a[104:107], v[28:31], v[236:239]
    v_cvt_pk_bf16_f32 v211, v214, v215
    buffer_store_dwordx4 v[208:211], v14, s[16:19], s46 offen offset:2048 sc1
    v_mov_b32 v4, v22
    v_mfma_f32_16x16x32_bf16 v[228:231], a[108:111], v[64:67], v[228:231]
    ds_read_b64_tr_b16 a[76:77], v153 offset:4096
    ds_read_b64_tr_b16 a[78:79], v153 offset:6144
    v_cvt_pk_bf16_f32 v216, v216, v217
    v_cvt_pk_bf16_f32 v217, v218, v219
    v_mfma_f32_16x16x32_bf16 v[236:239], a[108:111], v[68:71], v[236:239]
    s_waitcnt lgkmcnt(8)
    v_cvt_pk_bf16_f32 v218, v220, v221
    v_cvt_pk_bf16_f32 v219, v222, v223
    buffer_store_dwordx4 v[216:219], v14, s[16:19], s46 offen offset:3072 sc1
    s_add_u32 s46, s46, 4096
    v_mfma_f32_16x16x32_bf16 v[240:243], a[112:115], v[24:27], v[240:243]
    ds_read_b64_tr_b16 a[80:81], v152 offset:8192
    ds_read_b64_tr_b16 a[82:83], v152 offset:10240
    v_permlane16_swap_b32 v22, v4
    v_mfma_f32_16x16x32_bf16 v[248:251], a[112:115], v[28:31], v[248:251]
    v_add_f32 v22, v22, v4
    v_mov_b32 v23, v22
    s_nop 1
    v_permlane32_swap_b32 v22, v23
    v_mfma_f32_16x16x32_bf16 v[240:243], a[116:119], v[64:67], v[240:243]
    ds_read_b64_tr_b16 a[84:85], v153 offset:8192
    ds_read_b64_tr_b16 a[86:87], v153 offset:10240
    v_mov_b32 v128, v20
    v_mov_b32 v129, v22
    v_mfma_f32_16x16x32_bf16 v[248:251], a[116:119], v[68:71], v[248:251]
    v_cvt_pk_bf16_f32 v224, v224, v225
    v_cvt_pk_bf16_f32 v225, v226, v227
    v_cvt_pk_bf16_f32 v226, v228, v229
    v_mfma_f32_16x16x32_bf16 v[244:247], a[120:123], v[24:27], v[244:247]
    ds_read_b64_tr_b16 a[88:89], v152 offset:12288
    ds_read_b64_tr_b16 a[90:91], v152 offset:14336
    v_cvt_pk_bf16_f32 v227, v230, v231
    v_mfma_f32_16x16x32_bf16 v[252:255], a[120:123], v[28:31], v[252:255]
    buffer_store_dwordx4 v[224:227], v14, s[16:19], s46 offen offset:0 sc1
    v_cvt_pk_bf16_f32 v232, v232, v233
    v_cvt_pk_bf16_f32 v233, v234, v235
    v_mfma_f32_16x16x32_bf16 v[244:247], a[124:127], v[64:67], v[244:247]
    ds_read_b64_tr_b16 a[92:93], v153 offset:12288
    ds_read_b64_tr_b16 a[94:95], v153 offset:14336
    v_cvt_pk_bf16_f32 v234, v236, v237
    v_cvt_pk_bf16_f32 v235, v238, v239
    buffer_store_dwordx4 v[232:235], v14, s[16:19], s46 offen offset:1024 sc1
    v_mfma_f32_16x16x32_bf16 v[252:255], a[124:127], v[68:71], v[252:255]
    s_waitcnt lgkmcnt(8)
    v_mov_b32 v130, v21
    v_mov_b32 v131, v23
    v_cvt_pk_bf16_f32 v240, v240, v241
    v_cvt_pk_bf16_f32 v241, v242, v243
    v_cvt_pk_bf16_f32 v242, v244, v245
    v_cvt_pk_bf16_f32 v243, v246, v247
    buffer_store_dwordx4 v[240:243], v14, s[16:19], s46 offen offset:2048 sc1
    v_cvt_pk_bf16_f32 v248, v248, v249
    v_cvt_pk_bf16_f32 v249, v250, v251
    v_cvt_pk_bf16_f32 v250, v252, v253
    v_cvt_pk_bf16_f32 v251, v254, v255
    buffer_store_dwordx4 v[248:251], v14, s[16:19], s46 offen offset:3072 sc1
    s_add_u32 s46, s46, 4096
    v_accvgpr_read_b32 v32, a128
    v_accvgpr_read_b32 v33, a129
    v_accvgpr_read_b32 v34, a130
    v_accvgpr_read_b32 v35, a131
    v_accvgpr_read_b32 v40, a132
    v_accvgpr_read_b32 v41, a133
    v_accvgpr_read_b32 v42, a134
    v_accvgpr_read_b32 v43, a135
    v_accvgpr_read_b32 v96, a136
    v_accvgpr_read_b32 v97, a137
    v_accvgpr_read_b32 v98, a138
    v_accvgpr_read_b32 v99, a139
    v_accvgpr_read_b32 v104, a140
    v_accvgpr_read_b32 v105, a141
    v_accvgpr_read_b32 v106, a142
    v_accvgpr_read_b32 v107, a143
    v_accvgpr_read_b32 v160, a144
    v_accvgpr_read_b32 v161, a145
    v_accvgpr_read_b32 v162, a146
    v_accvgpr_read_b32 v163, a147
    v_accvgpr_read_b32 v168, a148
    v_accvgpr_read_b32 v169, a149
    v_accvgpr_read_b32 v170, a150
    v_accvgpr_read_b32 v171, a151
    v_accvgpr_read_b32 v176, a152
    v_accvgpr_read_b32 v177, a153
    v_accvgpr_read_b32 v178, a154
    v_accvgpr_read_b32 v179, a155
    v_accvgpr_read_b32 v184, a156
    v_accvgpr_read_b32 v185, a157
    v_accvgpr_read_b32 v186, a158
    v_accvgpr_read_b32 v187, a159
    v_accvgpr_read_b32 v192, a160
    v_accvgpr_read_b32 v193, a161
    v_accvgpr_read_b32 v194, a162
    v_accvgpr_read_b32 v195, a163
    v_accvgpr_read_b32 v200, a164
    v_accvgpr_read_b32 v201, a165
    v_accvgpr_read_b32 v202, a166
    v_accvgpr_read_b32 v203, a167
    v_accvgpr_read_b32 v208, a168
    v_accvgpr_read_b32 v209, a169
    v_accvgpr_read_b32 v210, a170
    v_accvgpr_read_b32 v211, a171
    v_accvgpr_read_b32 v216, a172
    v_accvgpr_read_b32 v217, a173
    v_accvgpr_read_b32 v218, a174
    v_accvgpr_read_b32 v219, a175
    v_accvgpr_read_b32 v224, a176
    v_accvgpr_read_b32 v225, a177
    v_accvgpr_read_b32 v226, a178
    v_accvgpr_read_b32 v227, a179
    v_accvgpr_read_b32 v232, a180
    v_accvgpr_read_b32 v233, a181
    v_accvgpr_read_b32 v234, a182
    v_accvgpr_read_b32 v235, a183
    v_accvgpr_read_b32 v240, a184
    v_accvgpr_read_b32 v241, a185
    v_accvgpr_read_b32 v242, a186
    v_accvgpr_read_b32 v243, a187
    v_accvgpr_read_b32 v248, a188
    v_accvgpr_read_b32 v249, a189
    v_accvgpr_read_b32 v250, a190
    v_accvgpr_read_b32 v251, a191
    s_waitcnt vmcnt(0)
    buffer_store_dwordx4 v[128:131], v14, s[16:19], s47 offen sc1
    s_add_u32 s31, s33, 114816
    s_add_u32 m0, s76, 81920
    s_nop 0
    buffer_load_dwordx4 v10, s[8:11], s31 offen offset:0 lds
    buffer_load_dwordx4 v11, s[8:11], s31 offen offset:1024 lds
    buffer_load_dwordx4 v12, s[8:11], s31 offen offset:2048 lds
    buffer_load_dwordx4 v13, s[8:11], s31 offen offset:3072 lds
    s_add_u32 s31, s33, 256
    s_add_u32 m0, s76, 98304
    s_nop 0
    buffer_load_dwordx4 v10, s[8:11], s31 offen offset:0 lds
    buffer_load_dwordx4 v11, s[8:11], s31 offen offset:1024 lds
    buffer_load_dwordx4 v12, s[8:11], s31 offen offset:2048 lds
    buffer_load_dwordx4 v13, s[8:11], s31 offen offset:3072 lds
    s_add_u32 s31, s33, 114944
    s_add_u32 m0, s76, 114688
    s_nop 0
    buffer_load_dwordx4 v10, s[8:11], s31 offen offset:0 lds
    buffer_load_dwordx4 v11, s[8:11], s31 offen offset:1024 lds
    buffer_load_dwordx4 v12, s[8:11], s31 offen offset:2048 lds
    buffer_load_dwordx4 v13, s[8:11], s31 offen offset:3072 lds
    v_mfma_f32_16x16x32_bf16 v[64:67], a[64:67], v[32:35], 0
    s_add_u32 s31, s33, 384
    ds_read_b64_tr_b16 a[96:97], v152 offset:16384
    ds_read_b64_tr_b16 a[98:99], v152 offset:18432
    v_mfma_f32_16x16x32_bf16 v[72:75], a[64:67], v[40:43], 0
    v_mfma_f32_16x16x32_bf16 v[68:71], a[68:71], v[32:35], 0
    ds_read_b64_tr_b16 a[100:101], v153 offset:16384
    ds_read_b64_tr_b16 a[102:103], v153 offset:18432
    v_mfma_f32_16x16x32_bf16 v[76:79], a[68:71], v[40:43], 0
    v_mfma_f32_16x16x32_bf16 v[64:67], a[72:75], v[96:99], v[64:67]
    ds_read_b64_tr_b16 a[104:105], v152 offset:20480
    ds_read_b64_tr_b16 a[106:107], v152 offset:22528
    v_mfma_f32_16x16x32_bf16 v[72:75], a[72:75], v[104:107], v[72:75]
    s_add_u32 m0, s76, 32768
    v_mfma_f32_16x16x32_bf16 v[68:71], a[76:79], v[96:99], v[68:71]
    ds_read_b64_tr_b16 a[108:109], v153 offset:20480
    ds_read_b64_tr_b16 a[110:111], v153 offset:22528
    v_mfma_f32_16x16x32_bf16 v[76:79], a[76:79], v[104:107], v[76:79]
    s_waitcnt lgkmcnt(8)
    v_mfma_f32_16x16x32_bf16 v[64:67], a[80:83], v[160:163], v[64:67]
    ds_read_b64_tr_b16 a[112:113], v152 offset:24576
    ds_read_b64_tr_b16 a[114:115], v152 offset:26624
    v_mfma_f32_16x16x32_bf16 v[72:75], a[80:83], v[168:171], v[72:75]
    v_mfma_f32_16x16x32_bf16 v[68:71], a[84:87], v[160:163], v[68:71]
    ds_read_b64_tr_b16 a[116:117], v153 offset:24576
    ds_read_b64_tr_b16 a[118:119], v153 offset:26624
    v_mfma_f32_16x16x32_bf16 v[76:79], a[84:87], v[168:171], v[76:79]
    buffer_load_dwordx4 v10, s[8:11], s31 offen offset:0 lds
    v_mfma_f32_16x16x32_bf16 v[64:67], a[88:91], v[176:179], v[64:67]
    ds_read_b64_tr_b16 a[120:121], v152 offset:28672
    ds_read_b64_tr_b16 a[122:123], v152 offset:30720
    v_mfma_f32_16x16x32_bf16 v[72:75], a[88:91], v[184:187], v[72:75]
    v_mfma_f32_16x16x32_bf16 v[68:71], a[92:95], v[176:179], v[68:71]
    ds_read_b64_tr_b16 a[124:125], v153 offset:28672
    ds_read_b64_tr_b16 a[126:127], v153 offset:30720
    v_mfma_f32_16x16x32_bf16 v[76:79], a[92:95], v[184:187], v[76:79]
    s_waitcnt lgkmcnt(8)
    buffer_load_dwordx4 v11, s[8:11], s31 offen offset:1024 lds
    v_mfma_f32_16x16x32_bf16 v[64:67], a[96:99], v[192:195], v[64:67]
    ds_read_b64_tr_b16 a[64:65], v154 offset:0
    ds_read_b64_tr_b16 a[66:67], v154 offset:2048
    v_mfma_f32_16x16x32_bf16 v[72:75], a[96:99], v[200:203], v[72:75]
    v_mfma_f32_16x16x32_bf16 v[68:71], a[100:103], v[192:195], v[68:71]
    ds_read_b64_tr_b16 a[68:69], v155 offset:0
    ds_read_b64_tr_b16 a[70:71], v155 offset:2048
    v_mfma_f32_16x16x32_bf16 v[76:79], a[100:103], v[200:203], v[76:79]
    v_mfma_f32_16x16x32_bf16 v[64:67], a[104:107], v[208:211], v[64:67]
    ds_read_b64_tr_b16 a[72:73], v154 offset:4096
    ds_read_b64_tr_b16 a[74:75], v154 offset:6144
    v_mfma_f32_16x16x32_bf16 v[72:75], a[104:107], v[216:219], v[72:75]
    buffer_load_dwordx4 v12, s[8:11], s31 offen offset:2048 lds
    v_mfma_f32_16x16x32_bf16 v[68:71], a[108:111], v[208:211], v[68:71]
    ds_read_b64_tr_b16 a[76:77], v155 offset:4096
    ds_read_b64_tr_b16 a[78:79], v155 offset:6144
    v_mfma_f32_16x16x32_bf16 v[76:79], a[108:111], v[216:219], v[76:79]
    s_waitcnt lgkmcnt(8)
    v_mfma_f32_16x16x32_bf16 v[64:67], a[112:115], v[224:227], v[64:67]
    ds_read_b64_tr_b16 a[80:81], v154 offset:8192
    ds_read_b64_tr_b16 a[82:83], v154 offset:10240
    v_mfma_f32_16x16x32_bf16 v[72:75], a[112:115], v[232:235], v[72:75]
    v_mfma_f32_16x16x32_bf16 v[68:71], a[116:119], v[224:227], v[68:71]
    ds_read_b64_tr_b16 a[84:85], v155 offset:8192
    ds_read_b64_tr_b16 a[86:87], v155 offset:10240
    v_mfma_f32_16x16x32_bf16 v[76:79], a[116:119], v[232:235], v[76:79]
    buffer_load_dwordx4 v13, s[8:11], s31 offen offset:3072 lds
    v_mfma_f32_16x16x32_bf16 v[64:67], a[120:123], v[240:243], v[64:67]
    ds_read_b64_tr_b16 a[88:89], v154 offset:12288
    ds_read_b64_tr_b16 a[90:91], v154 offset:14336
    v_mfma_f32_16x16x32_bf16 v[72:75], a[120:123], v[248:251], v[72:75]
    v_mfma_f32_16x16x32_bf16 v[68:71], a[124:127], v[240:243], v[68:71]
    ds_read_b64_tr_b16 a[92:93], v155 offset:12288
    ds_read_b64_tr_b16 a[94:95], v155 offset:14336
    v_mfma_f32_16x16x32_bf16 v[76:79], a[124:127], v[248:251], v[76:79]
    s_waitcnt lgkmcnt(8)
    s_add_u32 s31, s33, 115072
    v_mfma_f32_16x16x32_bf16 v[80:83], a[64:67], v[32:35], 0
    ds_read_b64_tr_b16 a[96:97], v154 offset:16384
    ds_read_b64_tr_b16 a[98:99], v154 offset:18432
    v_mfma_f32_16x16x32_bf16 v[88:91], a[64:67], v[40:43], 0
    v_mfma_f32_16x16x32_bf16 v[84:87], a[68:71], v[32:35], 0
    ds_read_b64_tr_b16 a[100:101], v155 offset:16384
    ds_read_b64_tr_b16 a[102:103], v155 offset:18432
    v_mfma_f32_16x16x32_bf16 v[92:95], a[68:71], v[40:43], 0
    v_mul_f32 v64, v64, v132
    v_mul_f32 v65, v65, v132
    v_mfma_f32_16x16x32_bf16 v[80:83], a[72:75], v[96:99], v[80:83]
    s_add_u32 m0, s76, 49152
    ds_read_b64_tr_b16 a[104:105], v154 offset:20480
    ds_read_b64_tr_b16 a[106:107], v154 offset:22528
    v_mfma_f32_16x16x32_bf16 v[88:91], a[72:75], v[104:107], v[88:91]
    v_mul_f32 v66, v66, v132
    v_mul_f32 v67, v67, v132
    v_mfma_f32_16x16x32_bf16 v[84:87], a[76:79], v[96:99], v[84:87]
    ds_read_b64_tr_b16 a[108:109], v155 offset:20480
    ds_read_b64_tr_b16 a[110:111], v155 offset:22528
    v_mfma_f32_16x16x32_bf16 v[92:95], a[76:79], v[104:107], v[92:95]
    s_waitcnt lgkmcnt(8)
    v_mul_f32 v68, v68, v132
    v_mul_f32 v69, v69, v132
    v_mfma_f32_16x16x32_bf16 v[80:83], a[80:83], v[160:163], v[80:83]
    ds_read_b64_tr_b16 a[112:113], v154 offset:24576
    ds_read_b64_tr_b16 a[114:115], v154 offset:26624
    v_mfma_f32_16x16x32_bf16 v[88:91], a[80:83], v[168:171], v[88:91]
    v_mul_f32 v70, v70, v132
    v_mul_f32 v71, v71, v132
    v_mfma_f32_16x16x32_bf16 v[84:87], a[84:87], v[160:163], v[84:87]
    ds_read_b64_tr_b16 a[116:117], v155 offset:24576
    ds_read_b64_tr_b16 a[118:119], v155 offset:26624
    v_mfma_f32_16x16x32_bf16 v[92:95], a[84:87], v[168:171], v[92:95]
    buffer_load_dwordx4 v10, s[8:11], s31 offen offset:0 lds
    v_cvt_pk_bf16_f32 v112, v64, v65
    v_mfma_f32_16x16x32_bf16 v[80:83], a[88:91], v[176:179], v[80:83]
    ds_read_b64_tr_b16 a[120:121], v154 offset:28672
    ds_read_b64_tr_b16 a[122:123], v154 offset:30720
    v_mfma_f32_16x16x32_bf16 v[88:91], a[88:91], v[184:187], v[88:91]
    v_cvt_pk_bf16_f32 v113, v66, v67
    v_cvt_pk_bf16_f32 v114, v68, v69
    v_cvt_pk_bf16_f32 v115, v70, v71
    v_mfma_f32_16x16x32_bf16 v[84:87], a[92:95], v[176:179], v[84:87]
    s_waitcnt vmcnt(13)
    s_waitcnt lgkmcnt(6)
    ds_read_b64_tr_b16 a[124:125], v155 offset:28672
    ds_read_b64_tr_b16 a[126:127], v155 offset:30720
    v_mfma_f32_16x16x32_bf16 v[92:95], a[92:95], v[184:187], v[92:95]
    s_barrier
    v_mfma_f32_16x16x32_bf16 v[80:83], a[96:99], v[192:195], v[80:83]
    ds_read_b64_tr_b16 a[64:65], v148 offset:0
    ds_read_b64_tr_b16 a[66:67], v148 offset:2048
    buffer_store_dwordx4 v[112:115], v15, s[16:19], s7 offen sc1
    v_mfma_f32_16x16x32_bf16 v[88:91], a[96:99], v[200:203], v[88:91]
    s_add_u32 s7, s7, 65536
    buffer_load_dwordx4 v11, s[8:11], s31 offen offset:1024 lds
    v_mul_f32 v72, v72, v133
    v_mfma_f32_16x16x32_bf16 v[84:87], a[100:103], v[192:195], v[84:87]
    ds_read_b64_tr_b16 a[68:69], v149 offset:0
    ds_read_b64_tr_b16 a[70:71], v149 offset:2048
    v_mfma_f32_16x16x32_bf16 v[92:95], a[100:103], v[200:203], v[92:95]
    v_mul_f32 v73, v73, v133
    v_mul_f32 v74, v74, v133
    v_mfma_f32_16x16x32_bf16 v[80:83], a[104:107], v[208:211], v[80:83]
    ds_read_b64_tr_b16 a[72:73], v148 offset:4096
    ds_read_b64_tr_b16 a[74:75], v148 offset:6144
    v_mfma_f32_16x16x32_bf16 v[88:91], a[104:107], v[216:219], v[88:91]
    buffer_load_dwordx4 v12, s[8:11], s31 offen offset:2048 lds
    v_mul_f32 v75, v75, v133
    v_mfma_f32_16x16x32_bf16 v[84:87], a[108:111], v[208:211], v[84:87]
    ds_read_b64_tr_b16 a[76:77], v149 offset:4096
    ds_read_b64_tr_b16 a[78:79], v149 offset:6144
    v_mfma_f32_16x16x32_bf16 v[92:95], a[108:111], v[216:219], v[92:95]
    s_waitcnt lgkmcnt(8)
    v_mul_f32 v76, v76, v133
    v_mul_f32 v77, v77, v133
    v_mfma_f32_16x16x32_bf16 v[80:83], a[112:115], v[224:227], v[80:83]
    ds_read_b64_tr_b16 a[80:81], v148 offset:8192
    ds_read_b64_tr_b16 a[82:83], v148 offset:10240
    v_mfma_f32_16x16x32_bf16 v[88:91], a[112:115], v[232:235], v[88:91]
    buffer_load_dwordx4 v13, s[8:11], s31 offen offset:3072 lds
    v_mul_f32 v78, v78, v133
    v_mul_f32 v79, v79, v133
    v_mfma_f32_16x16x32_bf16 v[84:87], a[116:119], v[224:227], v[84:87]
    ds_read_b64_tr_b16 a[84:85], v149 offset:8192
    ds_read_b64_tr_b16 a[86:87], v149 offset:10240
    v_mfma_f32_16x16x32_bf16 v[92:95], a[116:119], v[232:235], v[92:95]
    v_cvt_pk_bf16_f32 v116, v72, v73
    v_cvt_pk_bf16_f32 v117, v74, v75
    v_mfma_f32_16x16x32_bf16 v[80:83], a[120:123], v[240:243], v[80:83]
    ds_read_b64_tr_b16 a[88:89], v148 offset:12288
    ds_read_b64_tr_b16 a[90:91], v148 offset:14336
    v_mfma_f32_16x16x32_bf16 v[88:91], a[120:123], v[248:251], v[88:91]
    v_cvt_pk_bf16_f32 v118, v76, v77
    v_cvt_pk_bf16_f32 v119, v78, v79
    v_mfma_f32_16x16x32_bf16 v[84:87], a[124:127], v[240:243], v[84:87]
    ds_read_b64_tr_b16 a[92:93], v149 offset:12288
    ds_read_b64_tr_b16 a[94:95], v149 offset:14336
    v_mfma_f32_16x16x32_bf16 v[92:95], a[124:127], v[248:251], v[92:95]
    s_waitcnt lgkmcnt(8)
    buffer_store_dwordx4 v[116:119], v15, s[16:19], s7 offen sc1
    s_add_u32 s7, s7, 65536
    s_branch .Lmain_kernel_wo1_163
.Lmain_kernel_merge_152:
    v_mfma_f32_16x16x32_bf16 v[32:35], a[64:67], v[64:67], v[32:35]
    s_add_u32 s31, s33, 256
    ds_read_b128 a[96:99], v14 offset:24576
    v_add_f32 v22, v22, v8
    v_mfma_f32_16x16x32_bf16 v[40:43], a[64:67], v[68:71], v[40:43]
    v_add_f32 v23, v23, v9
    v_mfma_f32_16x16x32_bf16 v[36:39], a[68:71], v[64:67], v[36:39]
    s_add_u32 m0, s76, 98304
    ds_read_b128 a[100:103], v14 offset:25600
    v_permlane32_swap_b32 v22, v23
    v_mfma_f32_16x16x32_bf16 v[44:47], a[68:71], v[68:71], v[44:47]
    v_add_f32 v22, v22, v23
    v_mfma_f32_16x16x32_bf16 v[96:99], a[72:75], v[64:67], v[96:99]
    ds_read_b128 a[104:107], v14 offset:26624
    buffer_load_dwordx4 v10, s[8:11], s31 offen offset:0 lds
    v_mfma_f32_16x16x32_bf16 v[104:107], a[72:75], v[68:71], v[104:107]
    v_mov_b32 v4, v22
    s_nop 1
    v_permlane16_swap_b32 v22, v4
    v_mfma_f32_16x16x32_bf16 v[100:103], a[76:79], v[64:67], v[100:103]
    ds_read_b128 a[108:111], v14 offset:27648
    buffer_load_dwordx4 v11, s[8:11], s31 offen offset:1024 lds
    v_mfma_f32_16x16x32_bf16 v[108:111], a[76:79], v[68:71], v[108:111]
    s_waitcnt lgkmcnt(4)
    v_add_f32 v22, v22, v4
    v_mov_b32 v23, v22
    v_mfma_f32_16x16x32_bf16 v[160:163], a[80:83], v[64:67], v[160:163]
    ds_read_b128 a[112:115], v14 offset:28672
    buffer_load_dwordx4 v12, s[8:11], s31 offen offset:2048 lds
    v_mfma_f32_16x16x32_bf16 v[168:171], a[80:83], v[68:71], v[168:171]
    v_permlane32_swap_b32 v22, v23
    v_mfma_f32_16x16x32_bf16 v[164:167], a[84:87], v[64:67], v[164:167]
    s_lshl_b32 s30, s20, 4
    ds_read_b128 a[116:119], v14 offset:29696
    buffer_load_dwordx4 v13, s[8:11], s31 offen offset:3072 lds
    v_mfma_f32_16x16x32_bf16 v[172:175], a[84:87], v[68:71], v[172:175]
    v_subrev_u32 v6, s30, v17
    v_mov_b32 v8, 0x3f80
    v_mfma_f32_16x16x32_bf16 v[176:179], a[88:91], v[64:67], v[176:179]
    s_add_u32 s31, s33, 114944
    ds_read_b128 a[120:123], v14 offset:30720
    v_mov_b32 v9, 0x3f800000
    v_mfma_f32_16x16x32_bf16 v[184:187], a[88:91], v[68:71], v[184:187]
    v_mov_b32 v136, 0
    v_mfma_f32_16x16x32_bf16 v[180:183], a[92:95], v[64:67], v[180:183]
    s_waitcnt vmcnt(24)
    s_waitcnt lgkmcnt(3)
    ds_read_b128 a[124:127], v14 offset:31744
    v_mfma_f32_16x16x32_bf16 v[188:191], a[92:95], v[68:71], v[188:191]
    s_barrier
    v_mfma_f32_16x16x32_bf16 v[192:195], a[96:99], v[64:67], v[192:195]
    s_add_u32 m0, s76, 114688
    ds_read_b64_tr_b16 a[64:65], v152 offset:0
    ds_read_b64_tr_b16 a[66:67], v152 offset:2048
    v_mfma_f32_16x16x32_bf16 v[200:203], a[96:99], v[68:71], v[200:203]
    buffer_load_dwordx4 v10, s[8:11], s31 offen offset:0 lds
    v_mov_b32 v137, 0
    v_mfma_f32_16x16x32_bf16 v[196:199], a[100:103], v[64:67], v[196:199]
    ds_read_b64_tr_b16 a[68:69], v153 offset:0
    ds_read_b64_tr_b16 a[70:71], v153 offset:2048
    v_mfma_f32_16x16x32_bf16 v[204:207], a[100:103], v[68:71], v[204:207]
    buffer_load_dwordx4 v11, s[8:11], s31 offen offset:1024 lds
    v_mov_b32 v140, 0
    v_mfma_f32_16x16x32_bf16 v[208:211], a[104:107], v[64:67], v[208:211]
    ds_read_b64_tr_b16 a[72:73], v152 offset:4096
    ds_read_b64_tr_b16 a[74:75], v152 offset:6144
    v_mfma_f32_16x16x32_bf16 v[216:219], a[104:107], v[68:71], v[216:219]
    buffer_load_dwordx4 v12, s[8:11], s31 offen offset:2048 lds
    v_mov_b32 v141, 0
    v_mfma_f32_16x16x32_bf16 v[212:215], a[108:111], v[64:67], v[212:215]
    ds_read_b64_tr_b16 a[76:77], v153 offset:4096
    ds_read_b64_tr_b16 a[78:79], v153 offset:6144
    v_mfma_f32_16x16x32_bf16 v[220:223], a[108:111], v[68:71], v[220:223]
    s_waitcnt lgkmcnt(8)
    buffer_load_dwordx4 v13, s[8:11], s31 offen offset:3072 lds
    v_cmp_eq_u32 vcc, 0, v6
    v_mfma_f32_16x16x32_bf16 v[224:227], a[112:115], v[64:67], v[224:227]
    ds_read_b64_tr_b16 a[80:81], v152 offset:8192
    ds_read_b64_tr_b16 a[82:83], v152 offset:10240
    v_mfma_f32_16x16x32_bf16 v[232:235], a[112:115], v[68:71], v[232:235]
    s_waitcnt vmcnt(10)
    buffer_load_dwordx4 v[128:131], v14, s[16:19], s47 offen sc1
    v_cndmask_b32 v138, 0, v8, vcc
    v_mfma_f32_16x16x32_bf16 v[228:231], a[116:119], v[64:67], v[228:231]
    ds_read_b64_tr_b16 a[84:85], v153 offset:8192
    ds_read_b64_tr_b16 a[86:87], v153 offset:10240
    v_mfma_f32_16x16x32_bf16 v[236:239], a[116:119], v[68:71], v[236:239]
    v_cmp_eq_u32 vcc, 1, v6
    s_nop 1
    v_cndmask_b32 v138, v138, v9, vcc
    v_mfma_f32_16x16x32_bf16 v[240:243], a[120:123], v[64:67], v[240:243]
    ds_read_b64_tr_b16 a[88:89], v152 offset:12288
    ds_read_b64_tr_b16 a[90:91], v152 offset:14336
    v_mfma_f32_16x16x32_bf16 v[248:251], a[120:123], v[68:71], v[248:251]
    v_cmp_eq_u32 vcc, 2, v6
    s_nop 1
    v_cndmask_b32 v139, 0, v8, vcc
    v_mfma_f32_16x16x32_bf16 v[244:247], a[124:127], v[64:67], v[244:247]
    ds_read_b64_tr_b16 a[92:93], v153 offset:12288
    ds_read_b64_tr_b16 a[94:95], v153 offset:14336
    v_mfma_f32_16x16x32_bf16 v[252:255], a[124:127], v[68:71], v[252:255]
    s_waitcnt lgkmcnt(8)
    v_cmp_eq_u32 vcc, 3, v6
    s_nop 1
    v_cndmask_b32 v139, v139, v9, vcc
    s_mov_b32 s31, 0
.Lmain_kernel_mspin_165:
    s_waitcnt vmcnt(0)
    v_min_u32 v2, v129, v131
    v_cmp_eq_u32 vcc, 0, v2
    s_nop 0
    s_cbranch_vccz .Lmain_kernel_mok_164
    s_add_u32 s31, s31, 1
    s_cmp_gt_u32 s31, 0x40000
    s_cbranch_scc1 .Lmain_kernel_mok_164
    s_sleep 2
    buffer_load_dwordx4 v[128:131], v14, s[16:19], s47 offen sc1
    s_branch .Lmain_kernel_mspin_165
.Lmain_kernel_mok_164:
    buffer_load_dwordx4 a[128:131], v14, s[16:19], s46 offen offset:0 sc1
    buffer_load_dwordx4 a[132:135], v14, s[16:19], s46 offen offset:1024 sc1
    buffer_load_dwordx4 a[136:139], v14, s[16:19], s46 offen offset:2048 sc1
    buffer_load_dwordx4 a[140:143], v14, s[16:19], s46 offen offset:3072 sc1
    s_add_u32 s46, s46, 4096
    buffer_load_dwordx4 a[144:147], v14, s[16:19], s46 offen offset:0 sc1
    buffer_load_dwordx4 a[148:151], v14, s[16:19], s46 offen offset:1024 sc1
    buffer_load_dwordx4 a[152:155], v14, s[16:19], s46 offen offset:2048 sc1
    buffer_load_dwordx4 a[156:159], v14, s[16:19], s46 offen offset:3072 sc1
    s_add_u32 s46, s46, 4096
    buffer_load_dwordx4 a[160:163], v14, s[16:19], s46 offen offset:0 sc1
    buffer_load_dwordx4 a[164:167], v14, s[16:19], s46 offen offset:1024 sc1
    buffer_load_dwordx4 a[168:171], v14, s[16:19], s46 offen offset:2048 sc1
    buffer_load_dwordx4 a[172:175], v14, s[16:19], s46 offen offset:3072 sc1
    s_add_u32 s46, s46, 4096
    buffer_load_dwordx4 a[176:179], v14, s[16:19], s46 offen offset:0 sc1
    buffer_load_dwordx4 a[180:183], v14, s[16:19], s46 offen offset:1024 sc1
    buffer_load_dwordx4 a[184:187], v14, s[16:19], s46 offen offset:2048 sc1
    buffer_load_dwordx4 a[188:191], v14, s[16:19], s46 offen offset:3072 sc1
    s_add_u32 s46, s46, 4096
    v_sub_f32 v2, v128, v20
    v_min_f32 v2, 1114636288, v2
    v_exp_f32 v2, v2
    v_sub_f32 v3, v130, v21
    v_min_f32 v3, 1114636288, v3
    v_exp_f32 v3, v3
    v_mul_f32 v32, v32, v2
    v_mul_f32 v33, v33, v2
    v_mul_f32 v34, v34, v2
    v_mul_f32 v35, v35, v2
    v_mul_f32 v36, v36, v2
    v_mul_f32 v37, v37, v2
    v_mul_f32 v38, v38, v2
    v_mul_f32 v39, v39, v2
    v_mul_f32 v40, v40, v3
    v_mul_f32 v41, v41, v3
    v_mul_f32 v42, v42, v3
    v_mul_f32 v43, v43, v3
    v_mul_f32 v44, v44, v3
    v_mul_f32 v45, v45, v3
    v_mul_f32 v46, v46, v3
    v_mul_f32 v47, v47, v3
    v_mul_f32 v96, v96, v2
    v_mul_f32 v97, v97, v2
    v_mul_f32 v98, v98, v2
    v_mul_f32 v99, v99, v2
    v_mul_f32 v100, v100, v2
    v_mul_f32 v101, v101, v2
    v_mul_f32 v102, v102, v2
    v_mul_f32 v103, v103, v2
    v_mul_f32 v104, v104, v3
    v_mul_f32 v105, v105, v3
    v_mul_f32 v106, v106, v3
    v_mul_f32 v107, v107, v3
    v_mul_f32 v108, v108, v3
    v_mul_f32 v109, v109, v3
    v_mul_f32 v110, v110, v3
    v_mul_f32 v111, v111, v3
    v_mul_f32 v160, v160, v2
    v_mul_f32 v161, v161, v2
    v_mul_f32 v162, v162, v2
    v_mul_f32 v163, v163, v2
    v_mul_f32 v164, v164, v2
    v_mul_f32 v165, v165, v2
    v_mul_f32 v166, v166, v2
    v_mul_f32 v167, v167, v2
    v_mul_f32 v168, v168, v3
    v_mul_f32 v169, v169, v3
    v_mul_f32 v170, v170, v3
    v_mul_f32 v171, v171, v3
    v_mul_f32 v172, v172, v3
    v_mul_f32 v173, v173, v3
    v_mul_f32 v174, v174, v3
    v_mul_f32 v175, v175, v3
    v_mul_f32 v176, v176, v2
    v_mul_f32 v177, v177, v2
    v_mul_f32 v178, v178, v2
    v_mul_f32 v179, v179, v2
    v_mul_f32 v180, v180, v2
    v_mul_f32 v181, v181, v2
    v_mul_f32 v182, v182, v2
    v_mul_f32 v183, v183, v2
    v_mul_f32 v184, v184, v3
    v_mul_f32 v185, v185, v3
    v_mul_f32 v186, v186, v3
    v_mul_f32 v187, v187, v3
    v_mul_f32 v188, v188, v3
    v_mul_f32 v189, v189, v3
    v_mul_f32 v190, v190, v3
    v_mul_f32 v191, v191, v3
    v_mul_f32 v192, v192, v2
    v_mul_f32 v193, v193, v2
    v_mul_f32 v194, v194, v2
    v_mul_f32 v195, v195, v2
    v_mul_f32 v196, v196, v2
    v_mul_f32 v197, v197, v2
    v_mul_f32 v198, v198, v2
    v_mul_f32 v199, v199, v2
    v_mul_f32 v200, v200, v3
    v_mul_f32 v201, v201, v3
    v_mul_f32 v202, v202, v3
    v_mul_f32 v203, v203, v3
    v_mul_f32 v204, v204, v3
    v_mul_f32 v205, v205, v3
    v_mul_f32 v206, v206, v3
    v_mul_f32 v207, v207, v3
    v_mul_f32 v208, v208, v2
    v_mul_f32 v209, v209, v2
    v_mul_f32 v210, v210, v2
    v_mul_f32 v211, v211, v2
    v_mul_f32 v212, v212, v2
    v_mul_f32 v213, v213, v2
    v_mul_f32 v214, v214, v2
    v_mul_f32 v215, v215, v2
    v_mul_f32 v216, v216, v3
    v_mul_f32 v217, v217, v3
    v_mul_f32 v218, v218, v3
    v_mul_f32 v219, v219, v3
    v_mul_f32 v220, v220, v3
    v_mul_f32 v221, v221, v3
    v_mul_f32 v222, v222, v3
    v_mul_f32 v223, v223, v3
    v_mul_f32 v224, v224, v2
    v_mul_f32 v225, v225, v2
    v_mul_f32 v226, v226, v2
    v_mul_f32 v227, v227, v2
    v_mul_f32 v228, v228, v2
    v_mul_f32 v229, v229, v2
    v_mul_f32 v230, v230, v2
    v_mul_f32 v231, v231, v2
    v_mul_f32 v232, v232, v3
    v_mul_f32 v233, v233, v3
    v_mul_f32 v234, v234, v3
    v_mul_f32 v235, v235, v3
    v_mul_f32 v236, v236, v3
    v_mul_f32 v237, v237, v3
    v_mul_f32 v238, v238, v3
    v_mul_f32 v239, v239, v3
    v_mul_f32 v240, v240, v2
    v_mul_f32 v241, v241, v2
    v_mul_f32 v242, v242, v2
    v_mul_f32 v243, v243, v2
    v_mul_f32 v244, v244, v2
    v_mul_f32 v245, v245, v2
    v_mul_f32 v246, v246, v2
    v_mul_f32 v247, v247, v2
    v_mul_f32 v248, v248, v3
    v_mul_f32 v249, v249, v3
    v_mul_f32 v250, v250, v3
    v_mul_f32 v251, v251, v3
    v_mul_f32 v252, v252, v3
    v_mul_f32 v253, v253, v3
    v_mul_f32 v254, v254, v3
    v_mul_f32 v255, v255, v3
    v_fma_f32 v22, v22, v2, v129
    v_rcp_f32 v132, v22
    v_fma_f32 v23, v23, v3, v131
    v_rcp_f32 v133, v23
    s_waitcnt vmcnt(15)
    v_mfma_f32_16x16x32_bf16 v[32:35], v[138:141], a[128:131], v[32:35]
    s_waitcnt vmcnt(14)
    v_mfma_f32_16x16x32_bf16 v[40:43], v[138:141], a[132:135], v[40:43]
    v_mfma_f32_16x16x32_bf16 v[36:39], v[136:139], a[128:131], v[36:39]
    v_mfma_f32_16x16x32_bf16 v[44:47], v[136:139], a[132:135], v[44:47]
    s_waitcnt vmcnt(13)
    v_mfma_f32_16x16x32_bf16 v[96:99], v[138:141], a[136:139], v[96:99]
    s_waitcnt vmcnt(12)
    v_mfma_f32_16x16x32_bf16 v[104:107], v[138:141], a[140:143], v[104:107]
    v_cvt_pk_bf16_f32 v32, v32, v33
    v_cvt_pk_bf16_f32 v33, v34, v35
    v_mfma_f32_16x16x32_bf16 v[100:103], v[136:139], a[136:139], v[100:103]
    v_cvt_pk_bf16_f32 v34, v36, v37
    v_cvt_pk_bf16_f32 v35, v38, v39
    v_mfma_f32_16x16x32_bf16 v[108:111], v[136:139], a[140:143], v[108:111]
    v_cvt_pk_bf16_f32 v40, v40, v41
    v_cvt_pk_bf16_f32 v41, v42, v43
    v_cvt_pk_bf16_f32 v42, v44, v45
    v_cvt_pk_bf16_f32 v43, v46, v47
    v_mfma_f32_16x16x32_bf16 v[64:67], a[64:67], v[32:35], 0
    s_add_u32 s31, s33, 384
    ds_read_b64_tr_b16 a[96:97], v152 offset:16384
    ds_read_b64_tr_b16 a[98:99], v152 offset:18432
    v_mfma_f32_16x16x32_bf16 v[72:75], a[64:67], v[40:43], 0
    v_cvt_pk_bf16_f32 v96, v96, v97
    v_cvt_pk_bf16_f32 v97, v98, v99
    v_mfma_f32_16x16x32_bf16 v[68:71], a[68:71], v[32:35], 0
    ds_read_b64_tr_b16 a[100:101], v153 offset:16384
    ds_read_b64_tr_b16 a[102:103], v153 offset:18432
    v_mfma_f32_16x16x32_bf16 v[76:79], a[68:71], v[40:43], 0
    v_cvt_pk_bf16_f32 v98, v100, v101
    v_cvt_pk_bf16_f32 v99, v102, v103
    s_waitcnt vmcnt(11)
    v_mfma_f32_16x16x32_bf16 v[160:163], v[138:141], a[144:147], v[160:163]
    v_cvt_pk_bf16_f32 v104, v104, v105
    s_waitcnt vmcnt(10)
    v_mfma_f32_16x16x32_bf16 v[168:171], v[138:141], a[148:151], v[168:171]
    v_cvt_pk_bf16_f32 v105, v106, v107
    v_mfma_f32_16x16x32_bf16 v[164:167], v[136:139], a[144:147], v[164:167]
    v_cvt_pk_bf16_f32 v106, v108, v109
    v_mfma_f32_16x16x32_bf16 v[172:175], v[136:139], a[148:151], v[172:175]
    s_add_u32 m0, s76, 32768
    v_cvt_pk_bf16_f32 v107, v110, v111
    v_mfma_f32_16x16x32_bf16 v[64:67], a[72:75], v[96:99], v[64:67]
    ds_read_b64_tr_b16 a[104:105], v152 offset:20480
    ds_read_b64_tr_b16 a[106:107], v152 offset:22528
    v_mfma_f32_16x16x32_bf16 v[72:75], a[72:75], v[104:107], v[72:75]
    v_mfma_f32_16x16x32_bf16 v[68:71], a[76:79], v[96:99], v[68:71]
    ds_read_b64_tr_b16 a[108:109], v153 offset:20480
    ds_read_b64_tr_b16 a[110:111], v153 offset:22528
    v_mfma_f32_16x16x32_bf16 v[76:79], a[76:79], v[104:107], v[76:79]
    v_cvt_pk_bf16_f32 v160, v160, v161
    v_cvt_pk_bf16_f32 v161, v162, v163
    s_waitcnt vmcnt(9)
    v_mfma_f32_16x16x32_bf16 v[176:179], v[138:141], a[152:155], v[176:179]
    v_cvt_pk_bf16_f32 v162, v164, v165
    v_cvt_pk_bf16_f32 v163, v166, v167
    s_waitcnt vmcnt(8)
    v_mfma_f32_16x16x32_bf16 v[184:187], v[138:141], a[156:159], v[184:187]
    v_cvt_pk_bf16_f32 v168, v168, v169
    v_cvt_pk_bf16_f32 v169, v170, v171
    v_mfma_f32_16x16x32_bf16 v[180:183], v[136:139], a[152:155], v[180:183]
    buffer_load_dwordx4 v10, s[8:11], s31 offen offset:0 lds
    v_cvt_pk_bf16_f32 v170, v172, v173
    v_mfma_f32_16x16x32_bf16 v[188:191], v[136:139], a[156:159], v[188:191]
    s_waitcnt lgkmcnt(8)
    v_cvt_pk_bf16_f32 v171, v174, v175
    v_mfma_f32_16x16x32_bf16 v[64:67], a[80:83], v[160:163], v[64:67]
    ds_read_b64_tr_b16 a[112:113], v152 offset:24576
    ds_read_b64_tr_b16 a[114:115], v152 offset:26624
    v_mfma_f32_16x16x32_bf16 v[72:75], a[80:83], v[168:171], v[72:75]
    v_mfma_f32_16x16x32_bf16 v[68:71], a[84:87], v[160:163], v[68:71]
    ds_read_b64_tr_b16 a[116:117], v153 offset:24576
    ds_read_b64_tr_b16 a[118:119], v153 offset:26624
    v_mfma_f32_16x16x32_bf16 v[76:79], a[84:87], v[168:171], v[76:79]
    v_cvt_pk_bf16_f32 v176, v176, v177
    v_cvt_pk_bf16_f32 v177, v178, v179
    s_waitcnt vmcnt(8)
    v_mfma_f32_16x16x32_bf16 v[192:195], v[138:141], a[160:163], v[192:195]
    v_cvt_pk_bf16_f32 v178, v180, v181
    v_cvt_pk_bf16_f32 v179, v182, v183
    s_waitcnt vmcnt(7)
    v_mfma_f32_16x16x32_bf16 v[200:203], v[138:141], a[164:167], v[200:203]
    v_cvt_pk_bf16_f32 v184, v184, v185
    v_cvt_pk_bf16_f32 v185, v186, v187
    v_mfma_f32_16x16x32_bf16 v[196:199], v[136:139], a[160:163], v[196:199]
    buffer_load_dwordx4 v11, s[8:11], s31 offen offset:1024 lds
    v_cvt_pk_bf16_f32 v186, v188, v189
    v_mfma_f32_16x16x32_bf16 v[204:207], v[136:139], a[164:167], v[204:207]
    v_cvt_pk_bf16_f32 v187, v190, v191
    v_mfma_f32_16x16x32_bf16 v[64:67], a[88:91], v[176:179], v[64:67]
    ds_read_b64_tr_b16 a[120:121], v152 offset:28672
    ds_read_b64_tr_b16 a[122:123], v152 offset:30720
    v_mfma_f32_16x16x32_bf16 v[72:75], a[88:91], v[184:187], v[72:75]
    v_mfma_f32_16x16x32_bf16 v[68:71], a[92:95], v[176:179], v[68:71]
    ds_read_b64_tr_b16 a[124:125], v153 offset:28672
    ds_read_b64_tr_b16 a[126:127], v153 offset:30720
    v_mfma_f32_16x16x32_bf16 v[76:79], a[92:95], v[184:187], v[76:79]
    v_cvt_pk_bf16_f32 v192, v192, v193
    v_cvt_pk_bf16_f32 v193, v194, v195
    s_waitcnt vmcnt(7)
    v_mfma_f32_16x16x32_bf16 v[208:211], v[138:141], a[168:171], v[208:211]
    v_cvt_pk_bf16_f32 v194, v196, v197
    v_cvt_pk_bf16_f32 v195, v198, v199
    s_waitcnt vmcnt(6)
    v_mfma_f32_16x16x32_bf16 v[216:219], v[138:141], a[172:175], v[216:219]
    v_cvt_pk_bf16_f32 v200, v200, v201
    v_cvt_pk_bf16_f32 v201, v202, v203
    v_mfma_f32_16x16x32_bf16 v[212:215], v[136:139], a[168:171], v[212:215]
    buffer_load_dwordx4 v12, s[8:11], s31 offen offset:2048 lds
    v_cvt_pk_bf16_f32 v202, v204, v205
    v_mfma_f32_16x16x32_bf16 v[220:223], v[136:139], a[172:175], v[220:223]
    s_waitcnt lgkmcnt(8)
    v_cvt_pk_bf16_f32 v203, v206, v207
    v_mfma_f32_16x16x32_bf16 v[64:67], a[96:99], v[192:195], v[64:67]
    ds_read_b64_tr_b16 a[64:65], v154 offset:0
    ds_read_b64_tr_b16 a[66:67], v154 offset:2048
    v_mfma_f32_16x16x32_bf16 v[72:75], a[96:99], v[200:203], v[72:75]
    v_mfma_f32_16x16x32_bf16 v[68:71], a[100:103], v[192:195], v[68:71]
    ds_read_b64_tr_b16 a[68:69], v155 offset:0
    ds_read_b64_tr_b16 a[70:71], v155 offset:2048
    v_mfma_f32_16x16x32_bf16 v[76:79], a[100:103], v[200:203], v[76:79]
    v_cvt_pk_bf16_f32 v208, v208, v209
    v_cvt_pk_bf16_f32 v209, v210, v211
    s_waitcnt vmcnt(6)
    v_mfma_f32_16x16x32_bf16 v[224:227], v[138:141], a[176:179], v[224:227]
    v_cvt_pk_bf16_f32 v210, v212, v213
    v_cvt_pk_bf16_f32 v211, v214, v215
    s_waitcnt vmcnt(5)
    v_mfma_f32_16x16x32_bf16 v[232:235], v[138:141], a[180:183], v[232:235]
    v_cvt_pk_bf16_f32 v216, v216, v217
    v_cvt_pk_bf16_f32 v217, v218, v219
    v_mfma_f32_16x16x32_bf16 v[228:231], v[136:139], a[176:179], v[228:231]
    buffer_load_dwordx4 v13, s[8:11], s31 offen offset:3072 lds
    v_cvt_pk_bf16_f32 v218, v220, v221
    v_mfma_f32_16x16x32_bf16 v[236:239], v[136:139], a[180:183], v[236:239]
    v_cvt_pk_bf16_f32 v219, v222, v223
    v_mfma_f32_16x16x32_bf16 v[64:67], a[104:107], v[208:211], v[64:67]
    ds_read_b64_tr_b16 a[72:73], v154 offset:4096
    ds_read_b64_tr_b16 a[74:75], v154 offset:6144
    v_mfma_f32_16x16x32_bf16 v[72:75], a[104:107], v[216:219], v[72:75]
    v_mfma_f32_16x16x32_bf16 v[68:71], a[108:111], v[208:211], v[68:71]
    ds_read_b64_tr_b16 a[76:77], v155 offset:4096
    ds_read_b64_tr_b16 a[78:79], v155 offset:6144
    v_mfma_f32_16x16x32_bf16 v[76:79], a[108:111], v[216:219], v[76:79]
    s_add_u32 s31, s33, 115072
    v_cvt_pk_bf16_f32 v224, v224, v225
    v_cvt_pk_bf16_f32 v225, v226, v227
    s_waitcnt vmcnt(5)
    v_mfma_f32_16x16x32_bf16 v[240:243], v[138:141], a[184:187], v[240:243]
    v_cvt_pk_bf16_f32 v226, v228, v229
    v_cvt_pk_bf16_f32 v227, v230, v231
    s_waitcnt vmcnt(4)
    v_mfma_f32_16x16x32_bf16 v[248:251], v[138:141], a[188:191], v[248:251]
    v_cvt_pk_bf16_f32 v232, v232, v233
    v_cvt_pk_bf16_f32 v233, v234, v235
    v_mfma_f32_16x16x32_bf16 v[244:247], v[136:139], a[184:187], v[244:247]
    v_cvt_pk_bf16_f32 v234, v236, v237
    v_mfma_f32_16x16x32_bf16 v[252:255], v[136:139], a[188:191], v[252:255]
    s_waitcnt lgkmcnt(8)
    v_cvt_pk_bf16_f32 v235, v238, v239
    v_mfma_f32_16x16x32_bf16 v[64:67], a[112:115], v[224:227], v[64:67]
    ds_read_b64_tr_b16 a[80:81], v154 offset:8192
    ds_read_b64_tr_b16 a[82:83], v154 offset:10240
    v_mfma_f32_16x16x32_bf16 v[72:75], a[112:115], v[232:235], v[72:75]
    v_mfma_f32_16x16x32_bf16 v[68:71], a[116:119], v[224:227], v[68:71]
    s_add_u32 m0, s76, 49152
    ds_read_b64_tr_b16 a[84:85], v155 offset:8192
    ds_read_b64_tr_b16 a[86:87], v155 offset:10240
    v_mfma_f32_16x16x32_bf16 v[76:79], a[116:119], v[232:235], v[76:79]
    v_cvt_pk_bf16_f32 v240, v240, v241
    v_cvt_pk_bf16_f32 v241, v242, v243
    v_cvt_pk_bf16_f32 v242, v244, v245
    v_cvt_pk_bf16_f32 v243, v246, v247
    v_cvt_pk_bf16_f32 v248, v248, v249
    v_cvt_pk_bf16_f32 v249, v250, v251
    v_cvt_pk_bf16_f32 v250, v252, v253
    v_cvt_pk_bf16_f32 v251, v254, v255
    v_mfma_f32_16x16x32_bf16 v[64:67], a[120:123], v[240:243], v[64:67]
    ds_read_b64_tr_b16 a[88:89], v154 offset:12288
    ds_read_b64_tr_b16 a[90:91], v154 offset:14336
    v_mfma_f32_16x16x32_bf16 v[72:75], a[120:123], v[248:251], v[72:75]
    v_mfma_f32_16x16x32_bf16 v[68:71], a[124:127], v[240:243], v[68:71]
    ds_read_b64_tr_b16 a[92:93], v155 offset:12288
    ds_read_b64_tr_b16 a[94:95], v155 offset:14336
    v_mfma_f32_16x16x32_bf16 v[76:79], a[124:127], v[248:251], v[76:79]
    s_waitcnt lgkmcnt(8)
    v_mfma_f32_16x16x32_bf16 v[80:83], a[64:67], v[32:35], 0
    ds_read_b64_tr_b16 a[96:97], v154 offset:16384
    ds_read_b64_tr_b16 a[98:99], v154 offset:18432
    v_mfma_f32_16x16x32_bf16 v[88:91], a[64:67], v[40:43], 0
    v_mfma_f32_16x16x32_bf16 v[84:87], a[68:71], v[32:35], 0
    ds_read_b64_tr_b16 a[100:101], v155 offset:16384
    ds_read_b64_tr_b16 a[102:103], v155 offset:18432
    v_mfma_f32_16x16x32_bf16 v[92:95], a[68:71], v[40:43], 0
    buffer_load_dwordx4 v10, s[8:11], s31 offen offset:0 lds
    v_mul_f32 v64, v64, v132
    v_mfma_f32_16x16x32_bf16 v[80:83], a[72:75], v[96:99], v[80:83]
    ds_read_b64_tr_b16 a[104:105], v154 offset:20480
    ds_read_b64_tr_b16 a[106:107], v154 offset:22528
    v_mfma_f32_16x16x32_bf16 v[88:91], a[72:75], v[104:107], v[88:91]
    v_mul_f32 v65, v65, v132
    v_mul_f32 v66, v66, v132
    v_mfma_f32_16x16x32_bf16 v[84:87], a[76:79], v[96:99], v[84:87]
    ds_read_b64_tr_b16 a[108:109], v155 offset:20480
    ds_read_b64_tr_b16 a[110:111], v155 offset:22528
    v_mfma_f32_16x16x32_bf16 v[92:95], a[76:79], v[104:107], v[92:95]
    s_waitcnt lgkmcnt(8)
    v_mul_f32 v67, v67, v132
    v_mul_f32 v68, v68, v132
    v_mfma_f32_16x16x32_bf16 v[80:83], a[80:83], v[160:163], v[80:83]
    ds_read_b64_tr_b16 a[112:113], v154 offset:24576
    ds_read_b64_tr_b16 a[114:115], v154 offset:26624
    v_mfma_f32_16x16x32_bf16 v[88:91], a[80:83], v[168:171], v[88:91]
    buffer_load_dwordx4 v11, s[8:11], s31 offen offset:1024 lds
    v_mul_f32 v69, v69, v132
    v_mfma_f32_16x16x32_bf16 v[84:87], a[84:87], v[160:163], v[84:87]
    ds_read_b64_tr_b16 a[116:117], v155 offset:24576
    ds_read_b64_tr_b16 a[118:119], v155 offset:26624
    v_mfma_f32_16x16x32_bf16 v[92:95], a[84:87], v[168:171], v[92:95]
    v_mul_f32 v70, v70, v132
    v_mul_f32 v71, v71, v132
    v_mfma_f32_16x16x32_bf16 v[80:83], a[88:91], v[176:179], v[80:83]
    ds_read_b64_tr_b16 a[120:121], v154 offset:28672
    ds_read_b64_tr_b16 a[122:123], v154 offset:30720
    v_mfma_f32_16x16x32_bf16 v[88:91], a[88:91], v[184:187], v[88:91]
    v_cvt_pk_bf16_f32 v112, v64, v65
    v_cvt_pk_bf16_f32 v113, v66, v67
    v_cvt_pk_bf16_f32 v114, v68, v69
    v_mfma_f32_16x16x32_bf16 v[84:87], a[92:95], v[176:179], v[84:87]
    s_waitcnt lgkmcnt(6)
    ds_read_b64_tr_b16 a[124:125], v155 offset:28672
    ds_read_b64_tr_b16 a[126:127], v155 offset:30720
    v_mfma_f32_16x16x32_bf16 v[92:95], a[92:95], v[184:187], v[92:95]
    s_barrier
    v_mfma_f32_16x16x32_bf16 v[80:83], a[96:99], v[192:195], v[80:83]
    ds_read_b64_tr_b16 a[64:65], v148 offset:0
    ds_read_b64_tr_b16 a[66:67], v148 offset:2048
    v_cvt_pk_bf16_f32 v115, v70, v71
    v_mfma_f32_16x16x32_bf16 v[88:91], a[96:99], v[200:203], v[88:91]
    buffer_load_dwordx4 v12, s[8:11], s31 offen offset:2048 lds
    buffer_store_dwordx4 v[112:115], v15, s[16:19], s7 offen sc1
    v_mfma_f32_16x16x32_bf16 v[84:87], a[100:103], v[192:195], v[84:87]
    s_add_u32 s7, s7, 65536
    ds_read_b64_tr_b16 a[68:69], v149 offset:0
    ds_read_b64_tr_b16 a[70:71], v149 offset:2048
    v_mfma_f32_16x16x32_bf16 v[92:95], a[100:103], v[200:203], v[92:95]
    v_mul_f32 v72, v72, v133
    v_mul_f32 v73, v73, v133
    v_mfma_f32_16x16x32_bf16 v[80:83], a[104:107], v[208:211], v[80:83]
    ds_read_b64_tr_b16 a[72:73], v148 offset:4096
    ds_read_b64_tr_b16 a[74:75], v148 offset:6144
    v_mfma_f32_16x16x32_bf16 v[88:91], a[104:107], v[216:219], v[88:91]
    v_mul_f32 v74, v74, v133
    v_mul_f32 v75, v75, v133
    v_mfma_f32_16x16x32_bf16 v[84:87], a[108:111], v[208:211], v[84:87]
    ds_read_b64_tr_b16 a[76:77], v149 offset:4096
    ds_read_b64_tr_b16 a[78:79], v149 offset:6144
    v_mfma_f32_16x16x32_bf16 v[92:95], a[108:111], v[216:219], v[92:95]
    s_waitcnt lgkmcnt(8)
    buffer_load_dwordx4 v13, s[8:11], s31 offen offset:3072 lds
    v_mul_f32 v76, v76, v133
    v_mul_f32 v77, v77, v133
    v_mfma_f32_16x16x32_bf16 v[80:83], a[112:115], v[224:227], v[80:83]
    ds_read_b64_tr_b16 a[80:81], v148 offset:8192
    ds_read_b64_tr_b16 a[82:83], v148 offset:10240
    v_mfma_f32_16x16x32_bf16 v[88:91], a[112:115], v[232:235], v[88:91]
    v_mul_f32 v78, v78, v133
    v_mul_f32 v79, v79, v133
    v_mfma_f32_16x16x32_bf16 v[84:87], a[116:119], v[224:227], v[84:87]
    ds_read_b64_tr_b16 a[84:85], v149 offset:8192
    ds_read_b64_tr_b16 a[86:87], v149 offset:10240
    v_mfma_f32_16x16x32_bf16 v[92:95], a[116:119], v[232:235], v[92:95]
    v_cvt_pk_bf16_f32 v116, v72, v73
    v_cvt_pk_bf16_f32 v117, v74, v75
    v_mfma_f32_16x16x32_bf16 v[80:83], a[120:123], v[240:243], v[80:83]
    ds_read_b64_tr_b16 a[88:89], v148 offset:12288
    ds_read_b64_tr_b16 a[90:91], v148 offset:14336
    v_mfma_f32_16x16x32_bf16 v[88:91], a[120:123], v[248:251], v[88:91]
    v_cvt_pk_bf16_f32 v118, v76, v77
    v_cvt_pk_bf16_f32 v119, v78, v79
    v_mfma_f32_16x16x32_bf16 v[84:87], a[124:127], v[240:243], v[84:87]
    ds_read_b64_tr_b16 a[92:93], v149 offset:12288
    ds_read_b64_tr_b16 a[94:95], v149 offset:14336
    v_mfma_f32_16x16x32_bf16 v[92:95], a[124:127], v[248:251], v[92:95]
    s_waitcnt lgkmcnt(8)
    buffer_store_dwordx4 v[116:119], v15, s[16:19], s7 offen sc1
    s_add_u32 s7, s7, 65536
    s_branch .Lmain_kernel_wo1_163
.Lmain_kernel_wo_153:
    v_mfma_f32_16x16x32_bf16 v[64:67], a[64:67], v[32:35], 0
    s_add_u32 s31, s33, 384
    ds_read_b64_tr_b16 a[96:97], v152 offset:16384
    ds_read_b64_tr_b16 a[98:99], v152 offset:18432
    v_mfma_f32_16x16x32_bf16 v[72:75], a[64:67], v[40:43], 0
    v_mfma_f32_16x16x32_bf16 v[68:71], a[68:71], v[32:35], 0
    ds_read_b64_tr_b16 a[100:101], v153 offset:16384
    ds_read_b64_tr_b16 a[102:103], v153 offset:18432
    v_mfma_f32_16x16x32_bf16 v[76:79], a[68:71], v[40:43], 0
    v_cvt_pk_bf16_f32 v224, v224, v225
    v_mfma_f32_16x16x32_bf16 v[64:67], a[72:75], v[96:99], v[64:67]
    ds_read_b64_tr_b16 a[104:105], v152 offset:20480
    ds_read_b64_tr_b16 a[106:107], v152 offset:22528
    v_mfma_f32_16x16x32_bf16 v[72:75], a[72:75], v[104:107], v[72:75]
    s_add_u32 m0, s76, 32768
    v_cvt_pk_bf16_f32 v225, v226, v227
    v_cvt_pk_bf16_f32 v226, v228, v229
    v_mfma_f32_16x16x32_bf16 v[68:71], a[76:79], v[96:99], v[68:71]
    ds_read_b64_tr_b16 a[108:109], v153 offset:20480
    ds_read_b64_tr_b16 a[110:111], v153 offset:22528
    v_mfma_f32_16x16x32_bf16 v[76:79], a[76:79], v[104:107], v[76:79]
    s_waitcnt lgkmcnt(8)
    v_cvt_pk_bf16_f32 v227, v230, v231
    v_cvt_pk_bf16_f32 v232, v232, v233
    v_mfma_f32_16x16x32_bf16 v[64:67], a[80:83], v[160:163], v[64:67]
    ds_read_b64_tr_b16 a[112:113], v152 offset:24576
    ds_read_b64_tr_b16 a[114:115], v152 offset:26624
    v_mfma_f32_16x16x32_bf16 v[72:75], a[80:83], v[168:171], v[72:75]
    v_cvt_pk_bf16_f32 v233, v234, v235
    v_cvt_pk_bf16_f32 v234, v236, v237
    v_mfma_f32_16x16x32_bf16 v[68:71], a[84:87], v[160:163], v[68:71]
    ds_read_b64_tr_b16 a[116:117], v153 offset:24576
    ds_read_b64_tr_b16 a[118:119], v153 offset:26624
    v_mfma_f32_16x16x32_bf16 v[76:79], a[84:87], v[168:171], v[76:79]
    buffer_load_dwordx4 v10, s[8:11], s31 offen offset:0 lds
    v_cvt_pk_bf16_f32 v235, v238, v239
    v_mfma_f32_16x16x32_bf16 v[64:67], a[88:91], v[176:179], v[64:67]
    ds_read_b64_tr_b16 a[120:121], v152 offset:28672
    ds_read_b64_tr_b16 a[122:123], v152 offset:30720
    v_mfma_f32_16x16x32_bf16 v[72:75], a[88:91], v[184:187], v[72:75]
    v_cvt_pk_bf16_f32 v240, v240, v241
    v_cvt_pk_bf16_f32 v241, v242, v243
    v_mfma_f32_16x16x32_bf16 v[68:71], a[92:95], v[176:179], v[68:71]
    ds_read_b64_tr_b16 a[124:125], v153 offset:28672
    ds_read_b64_tr_b16 a[126:127], v153 offset:30720
    v_mfma_f32_16x16x32_bf16 v[76:79], a[92:95], v[184:187], v[76:79]
    s_waitcnt lgkmcnt(8)
    v_cvt_pk_bf16_f32 v242, v244, v245
    v_cvt_pk_bf16_f32 v243, v246, v247
    v_mfma_f32_16x16x32_bf16 v[64:67], a[96:99], v[192:195], v[64:67]
    ds_read_b64_tr_b16 a[64:65], v154 offset:0
    ds_read_b64_tr_b16 a[66:67], v154 offset:2048
    v_mfma_f32_16x16x32_bf16 v[72:75], a[96:99], v[200:203], v[72:75]
    v_cvt_pk_bf16_f32 v248, v248, v249
    v_cvt_pk_bf16_f32 v249, v250, v251
    v_mfma_f32_16x16x32_bf16 v[68:71], a[100:103], v[192:195], v[68:71]
    ds_read_b64_tr_b16 a[68:69], v155 offset:0
    ds_read_b64_tr_b16 a[70:71], v155 offset:2048
    v_mfma_f32_16x16x32_bf16 v[76:79], a[100:103], v[200:203], v[76:79]
    v_cvt_pk_bf16_f32 v250, v252, v253
    v_cvt_pk_bf16_f32 v251, v254, v255
    v_mfma_f32_16x16x32_bf16 v[64:67], a[104:107], v[208:211], v[64:67]
    ds_read_b64_tr_b16 a[72:73], v154 offset:4096
    ds_read_b64_tr_b16 a[74:75], v154 offset:6144
    v_mfma_f32_16x16x32_bf16 v[72:75], a[104:107], v[216:219], v[72:75]
    buffer_load_dwordx4 v11, s[8:11], s31 offen offset:1024 lds
    buffer_load_dwordx4 v12, s[8:11], s31 offen offset:2048 lds
    v_mfma_f32_16x16x32_bf16 v[68:71], a[108:111], v[208:211], v[68:71]
    ds_read_b64_tr_b16 a[76:77], v155 offset:4096
    ds_read_b64_tr_b16 a[78:79], v155 offset:6144
    v_mfma_f32_16x16x32_bf16 v[76:79], a[108:111], v[216:219], v[76:79]
    s_waitcnt lgkmcnt(8)
    v_mfma_f32_16x16x32_bf16 v[64:67], a[112:115], v[224:227], v[64:67]
    ds_read_b64_tr_b16 a[80:81], v154 offset:8192
    ds_read_b64_tr_b16 a[82:83], v154 offset:10240
    v_mfma_f32_16x16x32_bf16 v[72:75], a[112:115], v[232:235], v[72:75]
    v_mfma_f32_16x16x32_bf16 v[68:71], a[116:119], v[224:227], v[68:71]
    ds_read_b64_tr_b16 a[84:85], v155 offset:8192
    ds_read_b64_tr_b16 a[86:87], v155 offset:10240
    v_mfma_f32_16x16x32_bf16 v[76:79], a[116:119], v[232:235], v[76:79]
    buffer_load_dwordx4 v13, s[8:11], s31 offen offset:3072 lds
    v_mfma_f32_16x16x32_bf16 v[64:67], a[120:123], v[240:243], v[64:67]
    ds_read_b64_tr_b16 a[88:89], v154 offset:12288
    ds_read_b64_tr_b16 a[90:91], v154 offset:14336
    v_mfma_f32_16x16x32_bf16 v[72:75], a[120:123], v[248:251], v[72:75]
    v_mfma_f32_16x16x32_bf16 v[68:71], a[124:127], v[240:243], v[68:71]
    ds_read_b64_tr_b16 a[92:93], v155 offset:12288
    ds_read_b64_tr_b16 a[94:95], v155 offset:14336
    v_mfma_f32_16x16x32_bf16 v[76:79], a[124:127], v[248:251], v[76:79]
    s_waitcnt lgkmcnt(8)
    s_add_u32 s31, s33, 115072
    v_mfma_f32_16x16x32_bf16 v[80:83], a[64:67], v[32:35], 0
    ds_read_b64_tr_b16 a[96:97], v154 offset:16384
    ds_read_b64_tr_b16 a[98:99], v154 offset:18432
    v_mfma_f32_16x16x32_bf16 v[88:91], a[64:67], v[40:43], 0
    v_mfma_f32_16x16x32_bf16 v[84:87], a[68:71], v[32:35], 0
    ds_read_b64_tr_b16 a[100:101], v155 offset:16384
    ds_read_b64_tr_b16 a[102:103], v155 offset:18432
    v_mfma_f32_16x16x32_bf16 v[92:95], a[68:71], v[40:43], 0
    v_mul_f32 v64, v64, v132
    v_mul_f32 v65, v65, v132
    v_mfma_f32_16x16x32_bf16 v[80:83], a[72:75], v[96:99], v[80:83]
    s_add_u32 m0, s76, 49152
    ds_read_b64_tr_b16 a[104:105], v154 offset:20480
    ds_read_b64_tr_b16 a[106:107], v154 offset:22528
    v_mfma_f32_16x16x32_bf16 v[88:91], a[72:75], v[104:107], v[88:91]
    v_mul_f32 v66, v66, v132
    v_mul_f32 v67, v67, v132
    v_mfma_f32_16x16x32_bf16 v[84:87], a[76:79], v[96:99], v[84:87]
    ds_read_b64_tr_b16 a[108:109], v155 offset:20480
    ds_read_b64_tr_b16 a[110:111], v155 offset:22528
    v_mfma_f32_16x16x32_bf16 v[92:95], a[76:79], v[104:107], v[92:95]
    s_waitcnt lgkmcnt(8)
    v_mul_f32 v68, v68, v132
    v_mul_f32 v69, v69, v132
    v_mfma_f32_16x16x32_bf16 v[80:83], a[80:83], v[160:163], v[80:83]
    ds_read_b64_tr_b16 a[112:113], v154 offset:24576
    ds_read_b64_tr_b16 a[114:115], v154 offset:26624
    v_mfma_f32_16x16x32_bf16 v[88:91], a[80:83], v[168:171], v[88:91]
    v_mul_f32 v70, v70, v132
    v_mul_f32 v71, v71, v132
    v_mfma_f32_16x16x32_bf16 v[84:87], a[84:87], v[160:163], v[84:87]
    ds_read_b64_tr_b16 a[116:117], v155 offset:24576
    ds_read_b64_tr_b16 a[118:119], v155 offset:26624
    v_mfma_f32_16x16x32_bf16 v[92:95], a[84:87], v[168:171], v[92:95]
    buffer_load_dwordx4 v10, s[8:11], s31 offen offset:0 lds
    v_cvt_pk_bf16_f32 v112, v64, v65
    v_mfma_f32_16x16x32_bf16 v[80:83], a[88:91], v[176:179], v[80:83]
    ds_read_b64_tr_b16 a[120:121], v154 offset:28672
    ds_read_b64_tr_b16 a[122:123], v154 offset:30720
    v_mfma_f32_16x16x32_bf16 v[88:91], a[88:91], v[184:187], v[88:91]
    v_cvt_pk_bf16_f32 v113, v66, v67
    v_cvt_pk_bf16_f32 v114, v68, v69
    v_cvt_pk_bf16_f32 v115, v70, v71
    v_mfma_f32_16x16x32_bf16 v[84:87], a[92:95], v[176:179], v[84:87]
    s_waitcnt vmcnt(13)
    s_waitcnt lgkmcnt(6)
    ds_read_b64_tr_b16 a[124:125], v155 offset:28672
    ds_read_b64_tr_b16 a[126:127], v155 offset:30720
    v_mfma_f32_16x16x32_bf16 v[92:95], a[92:95], v[184:187], v[92:95]
    s_barrier
    v_mfma_f32_16x16x32_bf16 v[80:83], a[96:99], v[192:195], v[80:83]
    ds_read_b64_tr_b16 a[64:65], v148 offset:0
    ds_read_b64_tr_b16 a[66:67], v148 offset:2048
    buffer_store_dwordx4 v[112:115], v15, s[16:19], s7 offen sc1
    v_mfma_f32_16x16x32_bf16 v[88:91], a[96:99], v[200:203], v[88:91]
    s_add_u32 s7, s7, 65536
    buffer_load_dwordx4 v11, s[8:11], s31 offen offset:1024 lds
    v_mul_f32 v72, v72, v133
    v_mfma_f32_16x16x32_bf16 v[84:87], a[100:103], v[192:195], v[84:87]
    ds_read_b64_tr_b16 a[68:69], v149 offset:0
    ds_read_b64_tr_b16 a[70:71], v149 offset:2048
    v_mfma_f32_16x16x32_bf16 v[92:95], a[100:103], v[200:203], v[92:95]
    v_mul_f32 v73, v73, v133
    v_mul_f32 v74, v74, v133
    v_mfma_f32_16x16x32_bf16 v[80:83], a[104:107], v[208:211], v[80:83]
    ds_read_b64_tr_b16 a[72:73], v148 offset:4096
    ds_read_b64_tr_b16 a[74:75], v148 offset:6144
    v_mfma_f32_16x16x32_bf16 v[88:91], a[104:107], v[216:219], v[88:91]
    buffer_load_dwordx4 v12, s[8:11], s31 offen offset:2048 lds
    v_mul_f32 v75, v75, v133
    v_mfma_f32_16x16x32_bf16 v[84:87], a[108:111], v[208:211], v[84:87]
    ds_read_b64_tr_b16 a[76:77], v149 offset:4096
    ds_read_b64_tr_b16 a[78:79], v149 offset:6144
    v_mfma_f32_16x16x32_bf16 v[92:95], a[108:111], v[216:219], v[92:95]
    s_waitcnt lgkmcnt(8)
    v_mul_f32 v76, v76, v133
    v_mul_f32 v77, v77, v133
    v_mfma_f32_16x16x32_bf16 v[80:83], a[112:115], v[224:227], v[80:83]
    ds_read_b64_tr_b16 a[80:81], v148 offset:8192
    ds_read_b64_tr_b16 a[82:83], v148 offset:10240
    v_mfma_f32_16x16x32_bf16 v[88:91], a[112:115], v[232:235], v[88:91]
    buffer_load_dwordx4 v13, s[8:11], s31 offen offset:3072 lds
    v_mul_f32 v78, v78, v133
    v_mul_f32 v79, v79, v133
    v_mfma_f32_16x16x32_bf16 v[84:87], a[116:119], v[224:227], v[84:87]
    ds_read_b64_tr_b16 a[84:85], v149 offset:8192
    ds_read_b64_tr_b16 a[86:87], v149 offset:10240
    v_mfma_f32_16x16x32_bf16 v[92:95], a[116:119], v[232:235], v[92:95]
    v_cvt_pk_bf16_f32 v116, v72, v73
    v_cvt_pk_bf16_f32 v117, v74, v75
    v_mfma_f32_16x16x32_bf16 v[80:83], a[120:123], v[240:243], v[80:83]
    ds_read_b64_tr_b16 a[88:89], v148 offset:12288
    ds_read_b64_tr_b16 a[90:91], v148 offset:14336
    v_mfma_f32_16x16x32_bf16 v[88:91], a[120:123], v[248:251], v[88:91]
    v_cvt_pk_bf16_f32 v118, v76, v77
    v_cvt_pk_bf16_f32 v119, v78, v79
    v_mfma_f32_16x16x32_bf16 v[84:87], a[124:127], v[240:243], v[84:87]
    ds_read_b64_tr_b16 a[92:93], v149 offset:12288
    ds_read_b64_tr_b16 a[94:95], v149 offset:14336
    v_mfma_f32_16x16x32_bf16 v[92:95], a[124:127], v[248:251], v[92:95]
    s_waitcnt lgkmcnt(8)
    buffer_store_dwordx4 v[116:119], v15, s[16:19], s7 offen sc1
    s_add_u32 s7, s7, 65536
.Lmain_kernel_wo1_163:
    v_mfma_f32_16x16x32_bf16 v[64:67], a[64:67], v[32:35], 0
    s_add_u32 s31, s33, 512
    ds_read_b64_tr_b16 a[96:97], v148 offset:16384
    ds_read_b64_tr_b16 a[98:99], v148 offset:18432
    v_mfma_f32_16x16x32_bf16 v[72:75], a[64:67], v[40:43], 0
    v_mfma_f32_16x16x32_bf16 v[68:71], a[68:71], v[32:35], 0
    ds_read_b64_tr_b16 a[100:101], v149 offset:16384
    ds_read_b64_tr_b16 a[102:103], v149 offset:18432
    v_mfma_f32_16x16x32_bf16 v[76:79], a[68:71], v[40:43], 0
    v_mul_f32 v80, v80, v132
    v_mul_f32 v81, v81, v132
    v_mfma_f32_16x16x32_bf16 v[64:67], a[72:75], v[96:99], v[64:67]
    ds_read_b64_tr_b16 a[104:105], v148 offset:20480
    ds_read_b64_tr_b16 a[106:107], v148 offset:22528
    v_mfma_f32_16x16x32_bf16 v[72:75], a[72:75], v[104:107], v[72:75]
    s_add_u32 m0, s76, 0
    v_mul_f32 v82, v82, v132
    v_mul_f32 v83, v83, v132
    v_mfma_f32_16x16x32_bf16 v[68:71], a[76:79], v[96:99], v[68:71]
    ds_read_b64_tr_b16 a[108:109], v149 offset:20480
    ds_read_b64_tr_b16 a[110:111], v149 offset:22528
    v_mfma_f32_16x16x32_bf16 v[76:79], a[76:79], v[104:107], v[76:79]
    s_waitcnt lgkmcnt(8)
    v_mul_f32 v84, v84, v132
    v_mul_f32 v85, v85, v132
    v_mfma_f32_16x16x32_bf16 v[64:67], a[80:83], v[160:163], v[64:67]
    ds_read_b64_tr_b16 a[112:113], v148 offset:24576
    ds_read_b64_tr_b16 a[114:115], v148 offset:26624
    v_mfma_f32_16x16x32_bf16 v[72:75], a[80:83], v[168:171], v[72:75]
    v_mul_f32 v86, v86, v132
    v_mul_f32 v87, v87, v132
    v_mfma_f32_16x16x32_bf16 v[68:71], a[84:87], v[160:163], v[68:71]
    ds_read_b64_tr_b16 a[116:117], v149 offset:24576
    ds_read_b64_tr_b16 a[118:119], v149 offset:26624
    v_mfma_f32_16x16x32_bf16 v[76:79], a[84:87], v[168:171], v[76:79]
    buffer_load_dwordx4 v10, s[8:11], s31 offen offset:0 lds
    v_cvt_pk_bf16_f32 v48, v80, v81
    v_mfma_f32_16x16x32_bf16 v[64:67], a[88:91], v[176:179], v[64:67]
    ds_read_b64_tr_b16 a[120:121], v148 offset:28672
    ds_read_b64_tr_b16 a[122:123], v148 offset:30720
    v_mfma_f32_16x16x32_bf16 v[72:75], a[88:91], v[184:187], v[72:75]
    v_cvt_pk_bf16_f32 v49, v82, v83
    v_cvt_pk_bf16_f32 v50, v84, v85
    v_mfma_f32_16x16x32_bf16 v[68:71], a[92:95], v[176:179], v[68:71]
    ds_read_b64_tr_b16 a[124:125], v149 offset:28672
    ds_read_b64_tr_b16 a[126:127], v149 offset:30720
    v_mfma_f32_16x16x32_bf16 v[76:79], a[92:95], v[184:187], v[76:79]
    s_waitcnt lgkmcnt(8)
    buffer_load_dwordx4 v11, s[8:11], s31 offen offset:1024 lds
    v_cvt_pk_bf16_f32 v51, v86, v87
    v_mfma_f32_16x16x32_bf16 v[64:67], a[96:99], v[192:195], v[64:67]
    ds_read_b64_tr_b16 a[64:65], v150 offset:0
    ds_read_b64_tr_b16 a[66:67], v150 offset:2048
    v_mfma_f32_16x16x32_bf16 v[72:75], a[96:99], v[200:203], v[72:75]
    buffer_store_dwordx4 v[48:51], v15, s[16:19], s7 offen sc1
    v_mfma_f32_16x16x32_bf16 v[68:71], a[100:103], v[192:195], v[68:71]
    s_add_u32 s7, s7, 65536
    ds_read_b64_tr_b16 a[68:69], v151 offset:0
    ds_read_b64_tr_b16 a[70:71], v151 offset:2048
    v_mfma_f32_16x16x32_bf16 v[76:79], a[100:103], v[200:203], v[76:79]
    v_mul_f32 v88, v88, v133
    v_mul_f32 v89, v89, v133
    v_mfma_f32_16x16x32_bf16 v[64:67], a[104:107], v[208:211], v[64:67]
    ds_read_b64_tr_b16 a[72:73], v150 offset:4096
    ds_read_b64_tr_b16 a[74:75], v150 offset:6144
    v_mfma_f32_16x16x32_bf16 v[72:75], a[104:107], v[216:219], v[72:75]
    buffer_load_dwordx4 v12, s[8:11], s31 offen offset:2048 lds
    v_mul_f32 v90, v90, v133
    v_mfma_f32_16x16x32_bf16 v[68:71], a[108:111], v[208:211], v[68:71]
    ds_read_b64_tr_b16 a[76:77], v151 offset:4096
    ds_read_b64_tr_b16 a[78:79], v151 offset:6144
    v_mfma_f32_16x16x32_bf16 v[76:79], a[108:111], v[216:219], v[76:79]
    s_waitcnt lgkmcnt(8)
    v_mul_f32 v91, v91, v133
    v_mul_f32 v92, v92, v133
    v_mfma_f32_16x16x32_bf16 v[64:67], a[112:115], v[224:227], v[64:67]
    ds_read_b64_tr_b16 a[80:81], v150 offset:8192
    ds_read_b64_tr_b16 a[82:83], v150 offset:10240
    v_mfma_f32_16x16x32_bf16 v[72:75], a[112:115], v[232:235], v[72:75]
    v_mul_f32 v93, v93, v133
    v_mul_f32 v94, v94, v133
    v_mfma_f32_16x16x32_bf16 v[68:71], a[116:119], v[224:227], v[68:71]
    ds_read_b64_tr_b16 a[84:85], v151 offset:8192
    ds_read_b64_tr_b16 a[86:87], v151 offset:10240
    v_mfma_f32_16x16x32_bf16 v[76:79], a[116:119], v[232:235], v[76:79]
    buffer_load_dwordx4 v13, s[8:11], s31 offen offset:3072 lds
    v_mul_f32 v95, v95, v133
    v_mfma_f32_16x16x32_bf16 v[64:67], a[120:123], v[240:243], v[64:67]
    ds_read_b64_tr_b16 a[88:89], v150 offset:12288
    ds_read_b64_tr_b16 a[90:91], v150 offset:14336
    v_cvt_pk_bf16_f32 v52, v88, v89
    v_mfma_f32_16x16x32_bf16 v[72:75], a[120:123], v[248:251], v[72:75]
    v_cvt_pk_bf16_f32 v53, v90, v91
    v_cvt_pk_bf16_f32 v54, v92, v93
    v_mfma_f32_16x16x32_bf16 v[68:71], a[124:127], v[240:243], v[68:71]
    ds_read_b64_tr_b16 a[92:93], v151 offset:12288
    ds_read_b64_tr_b16 a[94:95], v151 offset:14336
    v_mfma_f32_16x16x32_bf16 v[76:79], a[124:127], v[248:251], v[76:79]
    s_waitcnt lgkmcnt(8)
    s_add_u32 s31, s33, 115200
    v_cvt_pk_bf16_f32 v55, v94, v95
    buffer_store_dwordx4 v[52:55], v15, s[16:19], s7 offen sc1
    s_add_u32 s7, s7, 65536
    v_mfma_f32_16x16x32_bf16 v[80:83], a[64:67], v[32:35], 0
    ds_read_b64_tr_b16 a[96:97], v150 offset:16384
    ds_read_b64_tr_b16 a[98:99], v150 offset:18432
    v_mfma_f32_16x16x32_bf16 v[88:91], a[64:67], v[40:43], 0
    v_mfma_f32_16x16x32_bf16 v[84:87], a[68:71], v[32:35], 0
    ds_read_b64_tr_b16 a[100:101], v151 offset:16384
    ds_read_b64_tr_b16 a[102:103], v151 offset:18432
    v_mfma_f32_16x16x32_bf16 v[92:95], a[68:71], v[40:43], 0
    v_mul_f32 v64, v64, v132
    v_mul_f32 v65, v65, v132
    v_mfma_f32_16x16x32_bf16 v[80:83], a[72:75], v[96:99], v[80:83]
    s_add_u32 m0, s76, 16384
    ds_read_b64_tr_b16 a[104:105], v150 offset:20480
    ds_read_b64_tr_b16 a[106:107], v150 offset:22528
    v_mfma_f32_16x16x32_bf16 v[88:91], a[72:75], v[104:107], v[88:91]
    v_mul_f32 v66, v66, v132
    v_mul_f32 v67, v67, v132
    v_mfma_f32_16x16x32_bf16 v[84:87], a[76:79], v[96:99], v[84:87]
    ds_read_b64_tr_b16 a[108:109], v151 offset:20480
    ds_read_b64_tr_b16 a[110:111], v151 offset:22528
    v_mfma_f32_16x16x32_bf16 v[92:95], a[76:79], v[104:107], v[92:95]
    s_waitcnt lgkmcnt(8)
    v_mul_f32 v68, v68, v132
    v_mul_f32 v69, v69, v132
    v_mfma_f32_16x16x32_bf16 v[80:83], a[80:83], v[160:163], v[80:83]
    ds_read_b64_tr_b16 a[112:113], v150 offset:24576
    ds_read_b64_tr_b16 a[114:115], v150 offset:26624
    v_mfma_f32_16x16x32_bf16 v[88:91], a[80:83], v[168:171], v[88:91]
    v_mul_f32 v70, v70, v132
    v_mul_f32 v71, v71, v132
    v_mfma_f32_16x16x32_bf16 v[84:87], a[84:87], v[160:163], v[84:87]
    ds_read_b64_tr_b16 a[116:117], v151 offset:24576
    ds_read_b64_tr_b16 a[118:119], v151 offset:26624
    v_mfma_f32_16x16x32_bf16 v[92:95], a[84:87], v[168:171], v[92:95]
    buffer_load_dwordx4 v10, s[8:11], s31 offen offset:0 lds
    v_cvt_pk_bf16_f32 v112, v64, v65
    v_mfma_f32_16x16x32_bf16 v[80:83], a[88:91], v[176:179], v[80:83]
    ds_read_b64_tr_b16 a[120:121], v150 offset:28672
    ds_read_b64_tr_b16 a[122:123], v150 offset:30720
    v_mfma_f32_16x16x32_bf16 v[88:91], a[88:91], v[184:187], v[88:91]
    v_cvt_pk_bf16_f32 v113, v66, v67
    v_cvt_pk_bf16_f32 v114, v68, v69
    v_cvt_pk_bf16_f32 v115, v70, v71
    v_mfma_f32_16x16x32_bf16 v[84:87], a[92:95], v[176:179], v[84:87]
    s_waitcnt vmcnt(17)
    s_waitcnt lgkmcnt(6)
    ds_read_b64_tr_b16 a[124:125], v151 offset:28672
    ds_read_b64_tr_b16 a[126:127], v151 offset:30720
    v_mfma_f32_16x16x32_bf16 v[92:95], a[92:95], v[184:187], v[92:95]
    s_barrier
    v_mfma_f32_16x16x32_bf16 v[80:83], a[96:99], v[192:195], v[80:83]
    ds_read_b64_tr_b16 a[64:65], v148 offset:32768
    ds_read_b64_tr_b16 a[66:67], v148 offset:34816
    buffer_store_dwordx4 v[112:115], v15, s[16:19], s7 offen sc1
    v_mfma_f32_16x16x32_bf16 v[88:91], a[96:99], v[200:203], v[88:91]
    s_add_u32 s7, s7, 65536
    buffer_load_dwordx4 v11, s[8:11], s31 offen offset:1024 lds
    v_mul_f32 v72, v72, v133
    v_mfma_f32_16x16x32_bf16 v[84:87], a[100:103], v[192:195], v[84:87]
    ds_read_b64_tr_b16 a[68:69], v149 offset:32768
    ds_read_b64_tr_b16 a[70:71], v149 offset:34816
    v_mfma_f32_16x16x32_bf16 v[92:95], a[100:103], v[200:203], v[92:95]
    v_mul_f32 v73, v73, v133
    v_mul_f32 v74, v74, v133
    v_mfma_f32_16x16x32_bf16 v[80:83], a[104:107], v[208:211], v[80:83]
    ds_read_b64_tr_b16 a[72:73], v148 offset:36864
    ds_read_b64_tr_b16 a[74:75], v148 offset:38912
    v_mfma_f32_16x16x32_bf16 v[88:91], a[104:107], v[216:219], v[88:91]
    buffer_load_dwordx4 v12, s[8:11], s31 offen offset:2048 lds
    v_mul_f32 v75, v75, v133
    v_mfma_f32_16x16x32_bf16 v[84:87], a[108:111], v[208:211], v[84:87]
    ds_read_b64_tr_b16 a[76:77], v149 offset:36864
    ds_read_b64_tr_b16 a[78:79], v149 offset:38912
    v_mfma_f32_16x16x32_bf16 v[92:95], a[108:111], v[216:219], v[92:95]
    s_waitcnt lgkmcnt(8)
    v_mul_f32 v76, v76, v133
    v_mul_f32 v77, v77, v133
    v_mfma_f32_16x16x32_bf16 v[80:83], a[112:115], v[224:227], v[80:83]
    ds_read_b64_tr_b16 a[80:81], v148 offset:40960
    ds_read_b64_tr_b16 a[82:83], v148 offset:43008
    v_mfma_f32_16x16x32_bf16 v[88:91], a[112:115], v[232:235], v[88:91]
    buffer_load_dwordx4 v13, s[8:11], s31 offen offset:3072 lds
    v_mul_f32 v78, v78, v133
    v_mul_f32 v79, v79, v133
    v_mfma_f32_16x16x32_bf16 v[84:87], a[116:119], v[224:227], v[84:87]
    ds_read_b64_tr_b16 a[84:85], v149 offset:40960
    ds_read_b64_tr_b16 a[86:87], v149 offset:43008
    v_mfma_f32_16x16x32_bf16 v[92:95], a[116:119], v[232:235], v[92:95]
    v_cvt_pk_bf16_f32 v116, v72, v73
    v_cvt_pk_bf16_f32 v117, v74, v75
    v_mfma_f32_16x16x32_bf16 v[80:83], a[120:123], v[240:243], v[80:83]
    ds_read_b64_tr_b16 a[88:89], v148 offset:45056
    ds_read_b64_tr_b16 a[90:91], v148 offset:47104
    v_mfma_f32_16x16x32_bf16 v[88:91], a[120:123], v[248:251], v[88:91]
    v_cvt_pk_bf16_f32 v118, v76, v77
    v_cvt_pk_bf16_f32 v119, v78, v79
    v_mfma_f32_16x16x32_bf16 v[84:87], a[124:127], v[240:243], v[84:87]
    ds_read_b64_tr_b16 a[92:93], v149 offset:45056
    ds_read_b64_tr_b16 a[94:95], v149 offset:47104
    v_mfma_f32_16x16x32_bf16 v[92:95], a[124:127], v[248:251], v[92:95]
    s_waitcnt lgkmcnt(8)
    buffer_store_dwordx4 v[116:119], v15, s[16:19], s7 offen sc1
    s_add_u32 s7, s7, 65536
    v_mfma_f32_16x16x32_bf16 v[64:67], a[64:67], v[32:35], 0
    s_add_u32 s31, s33, 640
    ds_read_b64_tr_b16 a[96:97], v148 offset:49152
    ds_read_b64_tr_b16 a[98:99], v148 offset:51200
    v_mfma_f32_16x16x32_bf16 v[72:75], a[64:67], v[40:43], 0
    v_mfma_f32_16x16x32_bf16 v[68:71], a[68:71], v[32:35], 0
    ds_read_b64_tr_b16 a[100:101], v149 offset:49152
    ds_read_b64_tr_b16 a[102:103], v149 offset:51200
    v_mfma_f32_16x16x32_bf16 v[76:79], a[68:71], v[40:43], 0
    v_mul_f32 v80, v80, v132
    v_mul_f32 v81, v81, v132
    v_mfma_f32_16x16x32_bf16 v[64:67], a[72:75], v[96:99], v[64:67]
    ds_read_b64_tr_b16 a[104:105], v148 offset:53248
    ds_read_b64_tr_b16 a[106:107], v148 offset:55296
    v_mfma_f32_16x16x32_bf16 v[72:75], a[72:75], v[104:107], v[72:75]
    s_add_u32 m0, s76, 131072
    v_mul_f32 v82, v82, v132
    v_mul_f32 v83, v83, v132
    v_mfma_f32_16x16x32_bf16 v[68:71], a[76:79], v[96:99], v[68:71]
    ds_read_b64_tr_b16 a[108:109], v149 offset:53248
    ds_read_b64_tr_b16 a[110:111], v149 offset:55296
    v_mfma_f32_16x16x32_bf16 v[76:79], a[76:79], v[104:107], v[76:79]
    s_waitcnt lgkmcnt(8)
    v_mul_f32 v84, v84, v132
    v_mul_f32 v85, v85, v132
    v_mfma_f32_16x16x32_bf16 v[64:67], a[80:83], v[160:163], v[64:67]
    ds_read_b64_tr_b16 a[112:113], v148 offset:57344
    ds_read_b64_tr_b16 a[114:115], v148 offset:59392
    v_mfma_f32_16x16x32_bf16 v[72:75], a[80:83], v[168:171], v[72:75]
    v_mul_f32 v86, v86, v132
    v_mul_f32 v87, v87, v132
    v_mfma_f32_16x16x32_bf16 v[68:71], a[84:87], v[160:163], v[68:71]
    ds_read_b64_tr_b16 a[116:117], v149 offset:57344
    ds_read_b64_tr_b16 a[118:119], v149 offset:59392
    v_mfma_f32_16x16x32_bf16 v[76:79], a[84:87], v[168:171], v[76:79]
    buffer_load_dwordx4 v10, s[8:11], s31 offen offset:0 lds
    v_cvt_pk_bf16_f32 v48, v80, v81
    v_mfma_f32_16x16x32_bf16 v[64:67], a[88:91], v[176:179], v[64:67]
    ds_read_b64_tr_b16 a[120:121], v148 offset:61440
    ds_read_b64_tr_b16 a[122:123], v148 offset:63488
    v_mfma_f32_16x16x32_bf16 v[72:75], a[88:91], v[184:187], v[72:75]
    v_cvt_pk_bf16_f32 v49, v82, v83
    v_cvt_pk_bf16_f32 v50, v84, v85
    v_mfma_f32_16x16x32_bf16 v[68:71], a[92:95], v[176:179], v[68:71]
    ds_read_b64_tr_b16 a[124:125], v149 offset:61440
    ds_read_b64_tr_b16 a[126:127], v149 offset:63488
    v_mfma_f32_16x16x32_bf16 v[76:79], a[92:95], v[184:187], v[76:79]
    s_waitcnt lgkmcnt(8)
    buffer_load_dwordx4 v11, s[8:11], s31 offen offset:1024 lds
    v_cvt_pk_bf16_f32 v51, v86, v87
    v_mfma_f32_16x16x32_bf16 v[64:67], a[96:99], v[192:195], v[64:67]
    ds_read_b64_tr_b16 a[64:65], v150 offset:32768
    ds_read_b64_tr_b16 a[66:67], v150 offset:34816
    v_mfma_f32_16x16x32_bf16 v[72:75], a[96:99], v[200:203], v[72:75]
    buffer_store_dwordx4 v[48:51], v15, s[16:19], s7 offen sc1
    v_mfma_f32_16x16x32_bf16 v[68:71], a[100:103], v[192:195], v[68:71]
    s_add_u32 s7, s7, 65536
    ds_read_b64_tr_b16 a[68:69], v151 offset:32768
    ds_read_b64_tr_b16 a[70:71], v151 offset:34816
    v_mfma_f32_16x16x32_bf16 v[76:79], a[100:103], v[200:203], v[76:79]
    v_mul_f32 v88, v88, v133
    v_mul_f32 v89, v89, v133
    v_mfma_f32_16x16x32_bf16 v[64:67], a[104:107], v[208:211], v[64:67]
    ds_read_b64_tr_b16 a[72:73], v150 offset:36864
    ds_read_b64_tr_b16 a[74:75], v150 offset:38912
    v_mfma_f32_16x16x32_bf16 v[72:75], a[104:107], v[216:219], v[72:75]
    buffer_load_dwordx4 v12, s[8:11], s31 offen offset:2048 lds
    v_mul_f32 v90, v90, v133
    v_mfma_f32_16x16x32_bf16 v[68:71], a[108:111], v[208:211], v[68:71]
    ds_read_b64_tr_b16 a[76:77], v151 offset:36864
    ds_read_b64_tr_b16 a[78:79], v151 offset:38912
    v_mfma_f32_16x16x32_bf16 v[76:79], a[108:111], v[216:219], v[76:79]
    s_waitcnt lgkmcnt(8)
    v_mul_f32 v91, v91, v133
    v_mul_f32 v92, v92, v133
    v_mfma_f32_16x16x32_bf16 v[64:67], a[112:115], v[224:227], v[64:67]
    ds_read_b64_tr_b16 a[80:81], v150 offset:40960
    ds_read_b64_tr_b16 a[82:83], v150 offset:43008
    v_mfma_f32_16x16x32_bf16 v[72:75], a[112:115], v[232:235], v[72:75]
    v_mul_f32 v93, v93, v133
    v_mul_f32 v94, v94, v133
    v_mfma_f32_16x16x32_bf16 v[68:71], a[116:119], v[224:227], v[68:71]
    ds_read_b64_tr_b16 a[84:85], v151 offset:40960
    ds_read_b64_tr_b16 a[86:87], v151 offset:43008
    v_mfma_f32_16x16x32_bf16 v[76:79], a[116:119], v[232:235], v[76:79]
    buffer_load_dwordx4 v13, s[8:11], s31 offen offset:3072 lds
    v_mul_f32 v95, v95, v133
    v_mfma_f32_16x16x32_bf16 v[64:67], a[120:123], v[240:243], v[64:67]
    ds_read_b64_tr_b16 a[88:89], v150 offset:45056
    ds_read_b64_tr_b16 a[90:91], v150 offset:47104
    v_cvt_pk_bf16_f32 v52, v88, v89
    v_mfma_f32_16x16x32_bf16 v[72:75], a[120:123], v[248:251], v[72:75]
    v_cvt_pk_bf16_f32 v53, v90, v91
    v_cvt_pk_bf16_f32 v54, v92, v93
    v_mfma_f32_16x16x32_bf16 v[68:71], a[124:127], v[240:243], v[68:71]
    ds_read_b64_tr_b16 a[92:93], v151 offset:45056
    ds_read_b64_tr_b16 a[94:95], v151 offset:47104
    v_mfma_f32_16x16x32_bf16 v[76:79], a[124:127], v[248:251], v[76:79]
    s_waitcnt lgkmcnt(8)
    s_add_u32 s31, s33, 115328
    v_cvt_pk_bf16_f32 v55, v94, v95
    buffer_store_dwordx4 v[52:55], v15, s[16:19], s7 offen sc1
    s_add_u32 s7, s7, 65536
    v_mfma_f32_16x16x32_bf16 v[80:83], a[64:67], v[32:35], 0
    ds_read_b64_tr_b16 a[96:97], v150 offset:49152
    ds_read_b64_tr_b16 a[98:99], v150 offset:51200
    v_mfma_f32_16x16x32_bf16 v[88:91], a[64:67], v[40:43], 0
    v_mfma_f32_16x16x32_bf16 v[84:87], a[68:71], v[32:35], 0
    ds_read_b64_tr_b16 a[100:101], v151 offset:49152
    ds_read_b64_tr_b16 a[102:103], v151 offset:51200
    v_mfma_f32_16x16x32_bf16 v[92:95], a[68:71], v[40:43], 0
    v_mul_f32 v64, v64, v132
    v_mul_f32 v65, v65, v132
    v_mfma_f32_16x16x32_bf16 v[80:83], a[72:75], v[96:99], v[80:83]
    s_add_u32 m0, s76, 147456
    ds_read_b64_tr_b16 a[104:105], v150 offset:53248
    ds_read_b64_tr_b16 a[106:107], v150 offset:55296
    v_mfma_f32_16x16x32_bf16 v[88:91], a[72:75], v[104:107], v[88:91]
    v_mul_f32 v66, v66, v132
    v_mul_f32 v67, v67, v132
    v_mfma_f32_16x16x32_bf16 v[84:87], a[76:79], v[96:99], v[84:87]
    ds_read_b64_tr_b16 a[108:109], v151 offset:53248
    ds_read_b64_tr_b16 a[110:111], v151 offset:55296
    v_mfma_f32_16x16x32_bf16 v[92:95], a[76:79], v[104:107], v[92:95]
    s_waitcnt lgkmcnt(8)
    v_mul_f32 v68, v68, v132
    v_mul_f32 v69, v69, v132
    v_mfma_f32_16x16x32_bf16 v[80:83], a[80:83], v[160:163], v[80:83]
    ds_read_b64_tr_b16 a[112:113], v150 offset:57344
    ds_read_b64_tr_b16 a[114:115], v150 offset:59392
    v_mfma_f32_16x16x32_bf16 v[88:91], a[80:83], v[168:171], v[88:91]
    v_mul_f32 v70, v70, v132
    v_mul_f32 v71, v71, v132
    v_mfma_f32_16x16x32_bf16 v[84:87], a[84:87], v[160:163], v[84:87]
    ds_read_b64_tr_b16 a[116:117], v151 offset:57344
    ds_read_b64_tr_b16 a[118:119], v151 offset:59392
    v_mfma_f32_16x16x32_bf16 v[92:95], a[84:87], v[168:171], v[92:95]
    buffer_load_dwordx4 v10, s[8:11], s31 offen offset:0 lds
    v_cvt_pk_bf16_f32 v112, v64, v65
    v_mfma_f32_16x16x32_bf16 v[80:83], a[88:91], v[176:179], v[80:83]
    ds_read_b64_tr_b16 a[120:121], v150 offset:61440
    ds_read_b64_tr_b16 a[122:123], v150 offset:63488
    v_mfma_f32_16x16x32_bf16 v[88:91], a[88:91], v[184:187], v[88:91]
    v_cvt_pk_bf16_f32 v113, v66, v67
    v_cvt_pk_bf16_f32 v114, v68, v69
    v_cvt_pk_bf16_f32 v115, v70, v71
    v_mfma_f32_16x16x32_bf16 v[84:87], a[92:95], v[176:179], v[84:87]
    s_waitcnt vmcnt(20)
    s_waitcnt lgkmcnt(6)
    ds_read_b64_tr_b16 a[124:125], v151 offset:61440
    ds_read_b64_tr_b16 a[126:127], v151 offset:63488
    v_mfma_f32_16x16x32_bf16 v[92:95], a[92:95], v[184:187], v[92:95]
    s_barrier
    v_mfma_f32_16x16x32_bf16 v[80:83], a[96:99], v[192:195], v[80:83]
    ds_read_b64_tr_b16 a[64:65], v144 offset:32768
    ds_read_b64_tr_b16 a[66:67], v144 offset:34816
    buffer_store_dwordx4 v[112:115], v15, s[16:19], s7 offen sc1
    v_mfma_f32_16x16x32_bf16 v[88:91], a[96:99], v[200:203], v[88:91]
    s_add_u32 s7, s7, 65536
    buffer_load_dwordx4 v11, s[8:11], s31 offen offset:1024 lds
    v_mul_f32 v72, v72, v133
    v_mfma_f32_16x16x32_bf16 v[84:87], a[100:103], v[192:195], v[84:87]
    ds_read_b64_tr_b16 a[68:69], v145 offset:32768
    ds_read_b64_tr_b16 a[70:71], v145 offset:34816
    v_mfma_f32_16x16x32_bf16 v[92:95], a[100:103], v[200:203], v[92:95]
    v_mul_f32 v73, v73, v133
    v_mul_f32 v74, v74, v133
    v_mfma_f32_16x16x32_bf16 v[80:83], a[104:107], v[208:211], v[80:83]
    ds_read_b64_tr_b16 a[72:73], v144 offset:36864
    ds_read_b64_tr_b16 a[74:75], v144 offset:38912
    v_mfma_f32_16x16x32_bf16 v[88:91], a[104:107], v[216:219], v[88:91]
    buffer_load_dwordx4 v12, s[8:11], s31 offen offset:2048 lds
    v_mul_f32 v75, v75, v133
    v_mfma_f32_16x16x32_bf16 v[84:87], a[108:111], v[208:211], v[84:87]
    ds_read_b64_tr_b16 a[76:77], v145 offset:36864
    ds_read_b64_tr_b16 a[78:79], v145 offset:38912
    v_mfma_f32_16x16x32_bf16 v[92:95], a[108:111], v[216:219], v[92:95]
    s_waitcnt lgkmcnt(8)
    v_mul_f32 v76, v76, v133
    v_mul_f32 v77, v77, v133
    v_mfma_f32_16x16x32_bf16 v[80:83], a[112:115], v[224:227], v[80:83]
    ds_read_b64_tr_b16 a[80:81], v144 offset:40960
    ds_read_b64_tr_b16 a[82:83], v144 offset:43008
    v_mfma_f32_16x16x32_bf16 v[88:91], a[112:115], v[232:235], v[88:91]
    buffer_load_dwordx4 v13, s[8:11], s31 offen offset:3072 lds
    v_mul_f32 v78, v78, v133
    v_mul_f32 v79, v79, v133
    v_mfma_f32_16x16x32_bf16 v[84:87], a[116:119], v[224:227], v[84:87]
    ds_read_b64_tr_b16 a[84:85], v145 offset:40960
    ds_read_b64_tr_b16 a[86:87], v145 offset:43008
    v_mfma_f32_16x16x32_bf16 v[92:95], a[116:119], v[232:235], v[92:95]
    v_cvt_pk_bf16_f32 v116, v72, v73
    v_cvt_pk_bf16_f32 v117, v74, v75
    v_mfma_f32_16x16x32_bf16 v[80:83], a[120:123], v[240:243], v[80:83]
    ds_read_b64_tr_b16 a[88:89], v144 offset:45056
    ds_read_b64_tr_b16 a[90:91], v144 offset:47104
    v_mfma_f32_16x16x32_bf16 v[88:91], a[120:123], v[248:251], v[88:91]
    v_cvt_pk_bf16_f32 v118, v76, v77
    v_cvt_pk_bf16_f32 v119, v78, v79
    v_mfma_f32_16x16x32_bf16 v[84:87], a[124:127], v[240:243], v[84:87]
    ds_read_b64_tr_b16 a[92:93], v145 offset:45056
    ds_read_b64_tr_b16 a[94:95], v145 offset:47104
    v_mfma_f32_16x16x32_bf16 v[92:95], a[124:127], v[248:251], v[92:95]
    s_waitcnt lgkmcnt(8)
    buffer_store_dwordx4 v[116:119], v15, s[16:19], s7 offen sc1
    s_add_u32 s7, s7, 65536
    v_mfma_f32_16x16x32_bf16 v[64:67], a[64:67], v[32:35], 0
    s_add_u32 s31, s33, 768
    ds_read_b64_tr_b16 a[96:97], v144 offset:49152
    ds_read_b64_tr_b16 a[98:99], v144 offset:51200
    v_mfma_f32_16x16x32_bf16 v[72:75], a[64:67], v[40:43], 0
    v_mfma_f32_16x16x32_bf16 v[68:71], a[68:71], v[32:35], 0
    ds_read_b64_tr_b16 a[100:101], v145 offset:49152
    ds_read_b64_tr_b16 a[102:103], v145 offset:51200
    v_mfma_f32_16x16x32_bf16 v[76:79], a[68:71], v[40:43], 0
    v_mul_f32 v80, v80, v132
    v_mul_f32 v81, v81, v132
    v_mfma_f32_16x16x32_bf16 v[64:67], a[72:75], v[96:99], v[64:67]
    ds_read_b64_tr_b16 a[104:105], v144 offset:53248
    ds_read_b64_tr_b16 a[106:107], v144 offset:55296
    v_mfma_f32_16x16x32_bf16 v[72:75], a[72:75], v[104:107], v[72:75]
    s_add_u32 m0, s76, 65536
    v_mul_f32 v82, v82, v132
    v_mul_f32 v83, v83, v132
    v_mfma_f32_16x16x32_bf16 v[68:71], a[76:79], v[96:99], v[68:71]
    ds_read_b64_tr_b16 a[108:109], v145 offset:53248
    ds_read_b64_tr_b16 a[110:111], v145 offset:55296
    v_mfma_f32_16x16x32_bf16 v[76:79], a[76:79], v[104:107], v[76:79]
    s_waitcnt lgkmcnt(8)
    v_mul_f32 v84, v84, v132
    v_mul_f32 v85, v85, v132
    v_mfma_f32_16x16x32_bf16 v[64:67], a[80:83], v[160:163], v[64:67]
    ds_read_b64_tr_b16 a[112:113], v144 offset:57344
    ds_read_b64_tr_b16 a[114:115], v144 offset:59392
    v_mfma_f32_16x16x32_bf16 v[72:75], a[80:83], v[168:171], v[72:75]
    v_mul_f32 v86, v86, v132
    v_mul_f32 v87, v87, v132
    v_mfma_f32_16x16x32_bf16 v[68:71], a[84:87], v[160:163], v[68:71]
    ds_read_b64_tr_b16 a[116:117], v145 offset:57344
    ds_read_b64_tr_b16 a[118:119], v145 offset:59392
    v_mfma_f32_16x16x32_bf16 v[76:79], a[84:87], v[168:171], v[76:79]
    buffer_load_dwordx4 v10, s[8:11], s31 offen offset:0 lds
    v_cvt_pk_bf16_f32 v48, v80, v81
    v_mfma_f32_16x16x32_bf16 v[64:67], a[88:91], v[176:179], v[64:67]
    ds_read_b64_tr_b16 a[120:121], v144 offset:61440
    ds_read_b64_tr_b16 a[122:123], v144 offset:63488
    v_mfma_f32_16x16x32_bf16 v[72:75], a[88:91], v[184:187], v[72:75]
    v_cvt_pk_bf16_f32 v49, v82, v83
    v_cvt_pk_bf16_f32 v50, v84, v85
    v_mfma_f32_16x16x32_bf16 v[68:71], a[92:95], v[176:179], v[68:71]
    ds_read_b64_tr_b16 a[124:125], v145 offset:61440
    ds_read_b64_tr_b16 a[126:127], v145 offset:63488
    v_mfma_f32_16x16x32_bf16 v[76:79], a[92:95], v[184:187], v[76:79]
    s_waitcnt lgkmcnt(8)
    buffer_load_dwordx4 v11, s[8:11], s31 offen offset:1024 lds
    v_cvt_pk_bf16_f32 v51, v86, v87
    v_mfma_f32_16x16x32_bf16 v[64:67], a[96:99], v[192:195], v[64:67]
    ds_read_b64_tr_b16 a[64:65], v146 offset:32768
    ds_read_b64_tr_b16 a[66:67], v146 offset:34816
    v_mfma_f32_16x16x32_bf16 v[72:75], a[96:99], v[200:203], v[72:75]
    buffer_store_dwordx4 v[48:51], v15, s[16:19], s7 offen sc1
    v_mfma_f32_16x16x32_bf16 v[68:71], a[100:103], v[192:195], v[68:71]
    s_add_u32 s7, s7, 65536
    ds_read_b64_tr_b16 a[68:69], v147 offset:32768
    ds_read_b64_tr_b16 a[70:71], v147 offset:34816
    v_mfma_f32_16x16x32_bf16 v[76:79], a[100:103], v[200:203], v[76:79]
    v_mul_f32 v88, v88, v133
    v_mul_f32 v89, v89, v133
    v_mfma_f32_16x16x32_bf16 v[64:67], a[104:107], v[208:211], v[64:67]
    ds_read_b64_tr_b16 a[72:73], v146 offset:36864
    ds_read_b64_tr_b16 a[74:75], v146 offset:38912
    v_mfma_f32_16x16x32_bf16 v[72:75], a[104:107], v[216:219], v[72:75]
    buffer_load_dwordx4 v12, s[8:11], s31 offen offset:2048 lds
    v_mul_f32 v90, v90, v133
    v_mfma_f32_16x16x32_bf16 v[68:71], a[108:111], v[208:211], v[68:71]
    ds_read_b64_tr_b16 a[76:77], v147 offset:36864
    ds_read_b64_tr_b16 a[78:79], v147 offset:38912
    v_mfma_f32_16x16x32_bf16 v[76:79], a[108:111], v[216:219], v[76:79]
    s_waitcnt lgkmcnt(8)
    v_mul_f32 v91, v91, v133
    v_mul_f32 v92, v92, v133
    v_mfma_f32_16x16x32_bf16 v[64:67], a[112:115], v[224:227], v[64:67]
    ds_read_b64_tr_b16 a[80:81], v146 offset:40960
    ds_read_b64_tr_b16 a[82:83], v146 offset:43008
    v_mfma_f32_16x16x32_bf16 v[72:75], a[112:115], v[232:235], v[72:75]
    v_mul_f32 v93, v93, v133
    v_mul_f32 v94, v94, v133
    v_mfma_f32_16x16x32_bf16 v[68:71], a[116:119], v[224:227], v[68:71]
    ds_read_b64_tr_b16 a[84:85], v147 offset:40960
    ds_read_b64_tr_b16 a[86:87], v147 offset:43008
    v_mfma_f32_16x16x32_bf16 v[76:79], a[116:119], v[232:235], v[76:79]
    buffer_load_dwordx4 v13, s[8:11], s31 offen offset:3072 lds
    v_mul_f32 v95, v95, v133
    v_mfma_f32_16x16x32_bf16 v[64:67], a[120:123], v[240:243], v[64:67]
    ds_read_b64_tr_b16 a[88:89], v146 offset:45056
    ds_read_b64_tr_b16 a[90:91], v146 offset:47104
    v_cvt_pk_bf16_f32 v52, v88, v89
    v_mfma_f32_16x16x32_bf16 v[72:75], a[120:123], v[248:251], v[72:75]
    v_cvt_pk_bf16_f32 v53, v90, v91
    v_cvt_pk_bf16_f32 v54, v92, v93
    v_mfma_f32_16x16x32_bf16 v[68:71], a[124:127], v[240:243], v[68:71]
    ds_read_b64_tr_b16 a[92:93], v147 offset:45056
    ds_read_b64_tr_b16 a[94:95], v147 offset:47104
    v_mfma_f32_16x16x32_bf16 v[76:79], a[124:127], v[248:251], v[76:79]
    s_waitcnt lgkmcnt(8)
    s_add_u32 s31, s33, 115456
    v_cvt_pk_bf16_f32 v55, v94, v95
    buffer_store_dwordx4 v[52:55], v15, s[16:19], s7 offen sc1
    s_add_u32 s7, s7, 65536
    v_mfma_f32_16x16x32_bf16 v[80:83], a[64:67], v[32:35], 0
    ds_read_b64_tr_b16 a[96:97], v146 offset:49152
    ds_read_b64_tr_b16 a[98:99], v146 offset:51200
    v_mfma_f32_16x16x32_bf16 v[88:91], a[64:67], v[40:43], 0
    v_mfma_f32_16x16x32_bf16 v[84:87], a[68:71], v[32:35], 0
    ds_read_b64_tr_b16 a[100:101], v147 offset:49152
    ds_read_b64_tr_b16 a[102:103], v147 offset:51200
    v_mfma_f32_16x16x32_bf16 v[92:95], a[68:71], v[40:43], 0
    v_mul_f32 v64, v64, v132
    v_mul_f32 v65, v65, v132
    v_mfma_f32_16x16x32_bf16 v[80:83], a[72:75], v[96:99], v[80:83]
    s_add_u32 m0, s76, 81920
    ds_read_b64_tr_b16 a[104:105], v146 offset:53248
    ds_read_b64_tr_b16 a[106:107], v146 offset:55296
    v_mfma_f32_16x16x32_bf16 v[88:91], a[72:75], v[104:107], v[88:91]
    v_mul_f32 v66, v66, v132
    v_mul_f32 v67, v67, v132
    v_mfma_f32_16x16x32_bf16 v[84:87], a[76:79], v[96:99], v[84:87]
    ds_read_b64_tr_b16 a[108:109], v147 offset:53248
    ds_read_b64_tr_b16 a[110:111], v147 offset:55296
    v_mfma_f32_16x16x32_bf16 v[92:95], a[76:79], v[104:107], v[92:95]
    s_waitcnt lgkmcnt(8)
    v_mul_f32 v68, v68, v132
    v_mul_f32 v69, v69, v132
    v_mfma_f32_16x16x32_bf16 v[80:83], a[80:83], v[160:163], v[80:83]
    ds_read_b64_tr_b16 a[112:113], v146 offset:57344
    ds_read_b64_tr_b16 a[114:115], v146 offset:59392
    v_mfma_f32_16x16x32_bf16 v[88:91], a[80:83], v[168:171], v[88:91]
    v_mul_f32 v70, v70, v132
    v_mul_f32 v71, v71, v132
    v_mfma_f32_16x16x32_bf16 v[84:87], a[84:87], v[160:163], v[84:87]
    ds_read_b64_tr_b16 a[116:117], v147 offset:57344
    ds_read_b64_tr_b16 a[118:119], v147 offset:59392
    v_mfma_f32_16x16x32_bf16 v[92:95], a[84:87], v[168:171], v[92:95]
    buffer_load_dwordx4 v10, s[8:11], s31 offen offset:0 lds
    v_cvt_pk_bf16_f32 v112, v64, v65
    v_mfma_f32_16x16x32_bf16 v[80:83], a[88:91], v[176:179], v[80:83]
    ds_read_b64_tr_b16 a[120:121], v146 offset:61440
    ds_read_b64_tr_b16 a[122:123], v146 offset:63488
    v_mfma_f32_16x16x32_bf16 v[88:91], a[88:91], v[184:187], v[88:91]
    v_cvt_pk_bf16_f32 v113, v66, v67
    v_cvt_pk_bf16_f32 v114, v68, v69
    v_cvt_pk_bf16_f32 v115, v70, v71
    v_mfma_f32_16x16x32_bf16 v[84:87], a[92:95], v[176:179], v[84:87]
    s_waitcnt vmcnt(20)
    s_waitcnt lgkmcnt(6)
    ds_read_b64_tr_b16 a[124:125], v147 offset:61440
    ds_read_b64_tr_b16 a[126:127], v147 offset:63488
    v_mfma_f32_16x16x32_bf16 v[92:95], a[92:95], v[184:187], v[92:95]
    s_barrier
    v_mfma_f32_16x16x32_bf16 v[80:83], a[96:99], v[192:195], v[80:83]
    ds_read_b64_tr_b16 a[64:65], v144 offset:0
    ds_read_b64_tr_b16 a[66:67], v144 offset:2048
    buffer_store_dwordx4 v[112:115], v15, s[16:19], s7 offen sc1
    v_mfma_f32_16x16x32_bf16 v[88:91], a[96:99], v[200:203], v[88:91]
    s_add_u32 s7, s7, 65536
    buffer_load_dwordx4 v11, s[8:11], s31 offen offset:1024 lds
    v_mul_f32 v72, v72, v133
    v_mfma_f32_16x16x32_bf16 v[84:87], a[100:103], v[192:195], v[84:87]
    ds_read_b64_tr_b16 a[68:69], v145 offset:0
    ds_read_b64_tr_b16 a[70:71], v145 offset:2048
    v_mfma_f32_16x16x32_bf16 v[92:95], a[100:103], v[200:203], v[92:95]
    v_mul_f32 v73, v73, v133
    v_mul_f32 v74, v74, v133
    v_mfma_f32_16x16x32_bf16 v[80:83], a[104:107], v[208:211], v[80:83]
    ds_read_b64_tr_b16 a[72:73], v144 offset:4096
    ds_read_b64_tr_b16 a[74:75], v144 offset:6144
    v_mfma_f32_16x16x32_bf16 v[88:91], a[104:107], v[216:219], v[88:91]
    buffer_load_dwordx4 v12, s[8:11], s31 offen offset:2048 lds
    v_mul_f32 v75, v75, v133
    v_mfma_f32_16x16x32_bf16 v[84:87], a[108:111], v[208:211], v[84:87]
    ds_read_b64_tr_b16 a[76:77], v145 offset:4096
    ds_read_b64_tr_b16 a[78:79], v145 offset:6144
    v_mfma_f32_16x16x32_bf16 v[92:95], a[108:111], v[216:219], v[92:95]
    s_waitcnt lgkmcnt(8)
    v_mul_f32 v76, v76, v133
    v_mul_f32 v77, v77, v133
    v_mfma_f32_16x16x32_bf16 v[80:83], a[112:115], v[224:227], v[80:83]
    ds_read_b64_tr_b16 a[80:81], v144 offset:8192
    ds_read_b64_tr_b16 a[82:83], v144 offset:10240
    v_mfma_f32_16x16x32_bf16 v[88:91], a[112:115], v[232:235], v[88:91]
    buffer_load_dwordx4 v13, s[8:11], s31 offen offset:3072 lds
    v_mul_f32 v78, v78, v133
    v_mul_f32 v79, v79, v133
    v_mfma_f32_16x16x32_bf16 v[84:87], a[116:119], v[224:227], v[84:87]
    ds_read_b64_tr_b16 a[84:85], v145 offset:8192
    ds_read_b64_tr_b16 a[86:87], v145 offset:10240
    v_mfma_f32_16x16x32_bf16 v[92:95], a[116:119], v[232:235], v[92:95]
    v_cvt_pk_bf16_f32 v116, v72, v73
    v_cvt_pk_bf16_f32 v117, v74, v75
    v_mfma_f32_16x16x32_bf16 v[80:83], a[120:123], v[240:243], v[80:83]
    ds_read_b64_tr_b16 a[88:89], v144 offset:12288
    ds_read_b64_tr_b16 a[90:91], v144 offset:14336
    v_mfma_f32_16x16x32_bf16 v[88:91], a[120:123], v[248:251], v[88:91]
    v_cvt_pk_bf16_f32 v118, v76, v77
    v_cvt_pk_bf16_f32 v119, v78, v79
    v_mfma_f32_16x16x32_bf16 v[84:87], a[124:127], v[240:243], v[84:87]
    ds_read_b64_tr_b16 a[92:93], v145 offset:12288
    ds_read_b64_tr_b16 a[94:95], v145 offset:14336
    v_mfma_f32_16x16x32_bf16 v[92:95], a[124:127], v[248:251], v[92:95]
    s_waitcnt lgkmcnt(8)
    buffer_store_dwordx4 v[116:119], v15, s[16:19], s7 offen sc1
    s_add_u32 s7, s7, 65536
    v_mfma_f32_16x16x32_bf16 v[64:67], a[64:67], v[32:35], 0
    s_lshl_b32 s61, s24, 1
    ds_read_b64_tr_b16 a[96:97], v144 offset:16384
    ds_read_b64_tr_b16 a[98:99], v144 offset:18432
    v_mfma_f32_16x16x32_bf16 v[72:75], a[64:67], v[40:43], 0
    v_mfma_f32_16x16x32_bf16 v[68:71], a[68:71], v[32:35], 0
    ds_read_b64_tr_b16 a[100:101], v145 offset:16384
    ds_read_b64_tr_b16 a[102:103], v145 offset:18432
    v_mfma_f32_16x16x32_bf16 v[76:79], a[68:71], v[40:43], 0
    s_add_u32 s61, s61, s21
    v_mul_f32 v80, v80, v132
    v_mul_f32 v81, v81, v132
    v_mfma_f32_16x16x32_bf16 v[64:67], a[72:75], v[96:99], v[64:67]
    ds_read_b64_tr_b16 a[104:105], v144 offset:20480
    ds_read_b64_tr_b16 a[106:107], v144 offset:22528
    v_mfma_f32_16x16x32_bf16 v[72:75], a[72:75], v[104:107], v[72:75]
    v_mul_f32 v82, v82, v132
    v_mul_f32 v83, v83, v132
    v_mfma_f32_16x16x32_bf16 v[68:71], a[76:79], v[96:99], v[68:71]
    s_lshl_b32 s30, s41, 5
    ds_read_b64_tr_b16 a[108:109], v145 offset:20480
    ds_read_b64_tr_b16 a[110:111], v145 offset:22528
    v_mfma_f32_16x16x32_bf16 v[76:79], a[76:79], v[104:107], v[76:79]
    s_waitcnt lgkmcnt(8)
    v_mul_f32 v84, v84, v132
    v_mul_f32 v85, v85, v132
    v_mfma_f32_16x16x32_bf16 v[64:67], a[80:83], v[160:163], v[64:67]
    ds_read_b64_tr_b16 a[112:113], v144 offset:24576
    ds_read_b64_tr_b16 a[114:115], v144 offset:26624
    v_mfma_f32_16x16x32_bf16 v[72:75], a[80:83], v[168:171], v[72:75]
    s_add_u32 s61, s61, s30
    v_mul_f32 v86, v86, v132
    v_mul_f32 v87, v87, v132
    v_mfma_f32_16x16x32_bf16 v[68:71], a[84:87], v[160:163], v[68:71]
    ds_read_b64_tr_b16 a[116:117], v145 offset:24576
    ds_read_b64_tr_b16 a[118:119], v145 offset:26624
    v_mfma_f32_16x16x32_bf16 v[76:79], a[84:87], v[168:171], v[76:79]
    v_cvt_pk_bf16_f32 v48, v80, v81
    v_cvt_pk_bf16_f32 v49, v82, v83
    v_mfma_f32_16x16x32_bf16 v[64:67], a[88:91], v[176:179], v[64:67]
    s_mul_i32 s61, s61, 3584
    ds_read_b64_tr_b16 a[120:121], v144 offset:28672
    ds_read_b64_tr_b16 a[122:123], v144 offset:30720
    v_mfma_f32_16x16x32_bf16 v[72:75], a[88:91], v[184:187], v[72:75]
    v_cvt_pk_bf16_f32 v50, v84, v85
    v_cvt_pk_bf16_f32 v51, v86, v87
    v_mfma_f32_16x16x32_bf16 v[68:71], a[92:95], v[176:179], v[68:71]
    ds_read_b64_tr_b16 a[124:125], v145 offset:28672
    ds_read_b64_tr_b16 a[126:127], v145 offset:30720
    v_mfma_f32_16x16x32_bf16 v[76:79], a[92:95], v[184:187], v[76:79]
    s_waitcnt lgkmcnt(8)
    s_lshl_b32 s30, s22, 6
    buffer_store_dwordx4 v[48:51], v15, s[16:19], s7 offen sc1
    v_mfma_f32_16x16x32_bf16 v[64:67], a[96:99], v[192:195], v[64:67]
    s_add_u32 s7, s7, 65536
    ds_read_b64_tr_b16 a[64:65], v146 offset:0
    ds_read_b64_tr_b16 a[66:67], v146 offset:2048
    v_mfma_f32_16x16x32_bf16 v[72:75], a[96:99], v[200:203], v[72:75]
    v_mul_f32 v88, v88, v133
    v_mul_f32 v89, v89, v133
    v_mfma_f32_16x16x32_bf16 v[68:71], a[100:103], v[192:195], v[68:71]
    s_add_u32 s61, s61, s30
    ds_read_b64_tr_b16 a[68:69], v147 offset:0
    ds_read_b64_tr_b16 a[70:71], v147 offset:2048
    v_mfma_f32_16x16x32_bf16 v[76:79], a[100:103], v[200:203], v[76:79]
    v_mul_f32 v90, v90, v133
    v_mul_f32 v91, v91, v133
    v_mfma_f32_16x16x32_bf16 v[64:67], a[104:107], v[208:211], v[64:67]
    ds_read_b64_tr_b16 a[72:73], v146 offset:4096
    ds_read_b64_tr_b16 a[74:75], v146 offset:6144
    v_mfma_f32_16x16x32_bf16 v[72:75], a[104:107], v[216:219], v[72:75]
    v_bfe_u32 v6, v14, 6, 2
    v_mul_f32 v92, v92, v133
    v_mfma_f32_16x16x32_bf16 v[68:71], a[108:111], v[208:211], v[68:71]
    ds_read_b64_tr_b16 a[76:77], v147 offset:4096
    ds_read_b64_tr_b16 a[78:79], v147 offset:6144
    v_mfma_f32_16x16x32_bf16 v[76:79], a[108:111], v[216:219], v[76:79]
    s_waitcnt lgkmcnt(8)
    v_mul_f32 v93, v93, v133
    v_mul_f32 v94, v94, v133
    v_mfma_f32_16x16x32_bf16 v[64:67], a[112:115], v[224:227], v[64:67]
    ds_read_b64_tr_b16 a[80:81], v146 offset:8192
    ds_read_b64_tr_b16 a[82:83], v146 offset:10240
    v_mfma_f32_16x16x32_bf16 v[72:75], a[112:115], v[232:235], v[72:75]
    v_mul_u32_u24 v135, 896, v6
    v_mul_f32 v95, v95, v133
    v_mfma_f32_16x16x32_bf16 v[68:71], a[116:119], v[224:227], v[68:71]
    ds_read_b64_tr_b16 a[84:85], v147 offset:8192
    ds_read_b64_tr_b16 a[86:87], v147 offset:10240
    v_cvt_pk_bf16_f32 v52, v88, v89
    v_mfma_f32_16x16x32_bf16 v[76:79], a[116:119], v[232:235], v[76:79]
    v_cvt_pk_bf16_f32 v53, v90, v91
    v_cvt_pk_bf16_f32 v54, v92, v93
    v_bfe_u32 v6, v14, 9, 1
    v_mfma_f32_16x16x32_bf16 v[64:67], a[120:123], v[240:243], v[64:67]
    ds_read_b64_tr_b16 a[88:89], v146 offset:12288
    ds_read_b64_tr_b16 a[90:91], v146 offset:14336
    v_mfma_f32_16x16x32_bf16 v[72:75], a[120:123], v[248:251], v[72:75]
    v_cvt_pk_bf16_f32 v55, v94, v95
    buffer_store_dwordx4 v[52:55], v15, s[16:19], s7 offen sc1
    v_mfma_f32_16x16x32_bf16 v[68:71], a[124:127], v[240:243], v[68:71]
    s_add_u32 s7, s7, 65536
    ds_read_b64_tr_b16 a[92:93], v147 offset:12288
    ds_read_b64_tr_b16 a[94:95], v147 offset:14336
    v_mfma_f32_16x16x32_bf16 v[76:79], a[124:127], v[248:251], v[76:79]
    s_waitcnt lgkmcnt(8)
    v_lshl_add_u32 v135, v6, 7, v135
    v_mfma_f32_16x16x32_bf16 v[80:83], a[64:67], v[32:35], 0
    ds_read_b64_tr_b16 a[96:97], v146 offset:16384
    ds_read_b64_tr_b16 a[98:99], v146 offset:18432
    v_mfma_f32_16x16x32_bf16 v[88:91], a[64:67], v[40:43], 0
    v_bfe_u32 v6, v14, 8, 1
    v_mfma_f32_16x16x32_bf16 v[84:87], a[68:71], v[32:35], 0
    ds_read_b64_tr_b16 a[100:101], v147 offset:16384
    ds_read_b64_tr_b16 a[102:103], v147 offset:18432
    v_mfma_f32_16x16x32_bf16 v[92:95], a[68:71], v[40:43], 0
    v_mul_f32 v64, v64, v132
    v_mul_f32 v65, v65, v132
    v_mfma_f32_16x16x32_bf16 v[80:83], a[72:75], v[96:99], v[80:83]
    ds_read_b64_tr_b16 a[104:105], v146 offset:20480
    ds_read_b64_tr_b16 a[106:107], v146 offset:22528
    v_mfma_f32_16x16x32_bf16 v[88:91], a[72:75], v[104:107], v[88:91]
    v_lshl_add_u32 v135, v6, 5, v135
    v_mul_f32 v66, v66, v132
    v_mfma_f32_16x16x32_bf16 v[84:87], a[76:79], v[96:99], v[84:87]
    ds_read_b64_tr_b16 a[108:109], v147 offset:20480
    ds_read_b64_tr_b16 a[110:111], v147 offset:22528
    v_mfma_f32_16x16x32_bf16 v[92:95], a[76:79], v[104:107], v[92:95]
    s_waitcnt lgkmcnt(8)
    v_bfe_u32 v6, v14, 4, 2
    v_mul_f32 v67, v67, v132
    v_mul_f32 v68, v68, v132
    v_mfma_f32_16x16x32_bf16 v[80:83], a[80:83], v[160:163], v[80:83]
    ds_read_b64_tr_b16 a[112:113], v146 offset:24576
    ds_read_b64_tr_b16 a[114:115], v146 offset:26624
    v_mfma_f32_16x16x32_bf16 v[88:91], a[80:83], v[168:171], v[88:91]
    v_mul_f32 v69, v69, v132
    v_mul_f32 v70, v70, v132
    v_mfma_f32_16x16x32_bf16 v[84:87], a[84:87], v[160:163], v[84:87]
    ds_read_b64_tr_b16 a[116:117], v147 offset:24576
    ds_read_b64_tr_b16 a[118:119], v147 offset:26624
    v_mfma_f32_16x16x32_bf16 v[92:95], a[84:87], v[168:171], v[92:95]
    v_lshl_add_u32 v135, v6, 3, v135
    v_mul_f32 v71, v71, v132
    v_mfma_f32_16x16x32_bf16 v[80:83], a[88:91], v[176:179], v[80:83]
    ds_read_b64_tr_b16 a[120:121], v146 offset:28672
    ds_read_b64_tr_b16 a[122:123], v146 offset:30720
    v_cvt_pk_bf16_f32 v112, v64, v65
    v_mfma_f32_16x16x32_bf16 v[88:91], a[88:91], v[184:187], v[88:91]
    buffer_load_dwordx2 v[156:157], v135, s[48:51], s61 offen offset:0
    v_cvt_pk_bf16_f32 v113, v66, v67
    v_cvt_pk_bf16_f32 v114, v68, v69
    v_cvt_pk_bf16_f32 v115, v70, v71
    v_mfma_f32_16x16x32_bf16 v[84:87], a[92:95], v[176:179], v[84:87]
    s_waitcnt vmcnt(16)
    s_waitcnt lgkmcnt(6)
    ds_read_b64_tr_b16 a[124:125], v147 offset:28672
    ds_read_b64_tr_b16 a[126:127], v147 offset:30720
    v_mfma_f32_16x16x32_bf16 v[92:95], a[92:95], v[184:187], v[92:95]
    s_barrier
    v_mfma_f32_16x16x32_bf16 v[80:83], a[96:99], v[192:195], v[80:83]
    ds_read_b64_tr_b16 a[64:65], v152 offset:0
    ds_read_b64_tr_b16 a[66:67], v152 offset:2048
    buffer_store_dwordx4 v[112:115], v15, s[16:19], s7 offen sc1
    v_mfma_f32_16x16x32_bf16 v[88:91], a[96:99], v[200:203], v[88:91]
    s_add_u32 s7, s7, 65536
    buffer_load_dwordx2 v[158:159], v135, s[48:51], s61 offen offset:256
    v_mul_f32 v72, v72, v133
    v_mfma_f32_16x16x32_bf16 v[84:87], a[100:103], v[192:195], v[84:87]
    ds_read_b64_tr_b16 a[68:69], v153 offset:0
    ds_read_b64_tr_b16 a[70:71], v153 offset:2048
    v_mfma_f32_16x16x32_bf16 v[92:95], a[100:103], v[200:203], v[92:95]
    buffer_load_dwordx2 v[128:129], v135, s[48:51], s61 offen offset:512
    v_mul_f32 v73, v73, v133
    v_mfma_f32_16x16x32_bf16 v[80:83], a[104:107], v[208:211], v[80:83]
    ds_read_b64_tr_b16 a[72:73], v152 offset:4096
    ds_read_b64_tr_b16 a[74:75], v152 offset:6144
    v_mfma_f32_16x16x32_bf16 v[88:91], a[104:107], v[216:219], v[88:91]
    v_mul_f32 v74, v74, v133
    v_mul_f32 v75, v75, v133
    v_mul_f32 v76, v76, v133
    v_mfma_f32_16x16x32_bf16 v[84:87], a[108:111], v[208:211], v[84:87]
    ds_read_b64_tr_b16 a[76:77], v153 offset:4096
    ds_read_b64_tr_b16 a[78:79], v153 offset:6144
    v_mul_f32 v77, v77, v133
    v_mfma_f32_16x16x32_bf16 v[92:95], a[108:111], v[216:219], v[92:95]
    s_waitcnt lgkmcnt(8)
    s_mov_b32 exec_hi, 0
    buffer_load_dwordx2 v[130:131], v135, s[48:51], s61 offen offset:768
    s_mov_b32 exec_hi, -1
    v_mfma_f32_16x16x32_bf16 v[80:83], a[112:115], v[224:227], v[80:83]
    ds_read_b64_tr_b16 a[80:81], v152 offset:8192
    ds_read_b64_tr_b16 a[82:83], v152 offset:10240
    v_mfma_f32_16x16x32_bf16 v[88:91], a[112:115], v[232:235], v[88:91]
    v_mul_f32 v78, v78, v133
    v_mul_f32 v79, v79, v133
    v_mfma_f32_16x16x32_bf16 v[84:87], a[116:119], v[224:227], v[84:87]
    ds_read_b64_tr_b16 a[84:85], v153 offset:8192
    ds_read_b64_tr_b16 a[86:87], v153 offset:10240
    v_mfma_f32_16x16x32_bf16 v[92:95], a[116:119], v[232:235], v[92:95]
    v_cvt_pk_bf16_f32 v116, v72, v73
    v_cvt_pk_bf16_f32 v117, v74, v75
    v_mfma_f32_16x16x32_bf16 v[80:83], a[120:123], v[240:243], v[80:83]
    ds_read_b64_tr_b16 a[88:89], v152 offset:12288
    ds_read_b64_tr_b16 a[90:91], v152 offset:14336
    v_mfma_f32_16x16x32_bf16 v[88:91], a[120:123], v[248:251], v[88:91]
    v_cvt_pk_bf16_f32 v118, v76, v77
    v_cvt_pk_bf16_f32 v119, v78, v79
    v_mfma_f32_16x16x32_bf16 v[84:87], a[124:127], v[240:243], v[84:87]
    ds_read_b64_tr_b16 a[92:93], v153 offset:12288
    ds_read_b64_tr_b16 a[94:95], v153 offset:14336
    v_mfma_f32_16x16x32_bf16 v[92:95], a[124:127], v[248:251], v[92:95]
    s_waitcnt lgkmcnt(8)
    buffer_store_dwordx4 v[116:119], v15, s[16:19], s7 offen sc1
    s_add_u32 s7, s7, 65536
    v_mfma_f32_16x16x32_bf16 v[64:67], a[64:67], v[32:35], 0
    ds_read_b64_tr_b16 a[96:97], v152 offset:16384
    ds_read_b64_tr_b16 a[98:99], v152 offset:18432
    v_mfma_f32_16x16x32_bf16 v[72:75], a[64:67], v[40:43], 0
    v_and_b32 v6, 16, v14
    v_mfma_f32_16x16x32_bf16 v[68:71], a[68:71], v[32:35], 0
    ds_read_b64_tr_b16 a[100:101], v153 offset:16384
    ds_read_b64_tr_b16 a[102:103], v153 offset:18432
    v_mfma_f32_16x16x32_bf16 v[76:79], a[68:71], v[40:43], 0
    v_mov_b32 v7, 0x3f80
    v_mul_f32 v80, v80, v132
    v_mfma_f32_16x16x32_bf16 v[64:67], a[72:75], v[96:99], v[64:67]
    ds_read_b64_tr_b16 a[104:105], v152 offset:20480
    ds_read_b64_tr_b16 a[106:107], v152 offset:22528
    v_mfma_f32_16x16x32_bf16 v[72:75], a[72:75], v[104:107], v[72:75]
    v_mul_f32 v81, v81, v132
    v_mul_f32 v82, v82, v132
    v_mfma_f32_16x16x32_bf16 v[68:71], a[76:79], v[96:99], v[68:71]
    ds_read_b64_tr_b16 a[108:109], v153 offset:20480
    ds_read_b64_tr_b16 a[110:111], v153 offset:22528
    v_mfma_f32_16x16x32_bf16 v[76:79], a[76:79], v[104:107], v[76:79]
    s_waitcnt lgkmcnt(8)
    v_lshlrev_b32 v6, v6, v7
    v_mul_f32 v83, v83, v132
    v_mfma_f32_16x16x32_bf16 v[64:67], a[80:83], v[160:163], v[64:67]
    ds_read_b64_tr_b16 a[112:113], v152 offset:24576
    ds_read_b64_tr_b16 a[114:115], v152 offset:26624
    v_mfma_f32_16x16x32_bf16 v[72:75], a[80:83], v[168:171], v[72:75]
    v_bfe_u32 v7, v14, 5, 3
    v_mul_f32 v84, v84, v132
    v_mfma_f32_16x16x32_bf16 v[68:71], a[84:87], v[160:163], v[68:71]
    ds_read_b64_tr_b16 a[116:117], v153 offset:24576
    ds_read_b64_tr_b16 a[118:119], v153 offset:26624
    v_mfma_f32_16x16x32_bf16 v[76:79], a[84:87], v[168:171], v[76:79]
    v_mul_f32 v85, v85, v132
    v_mul_f32 v86, v86, v132
    v_mfma_f32_16x16x32_bf16 v[64:67], a[88:91], v[176:179], v[64:67]
    ds_read_b64_tr_b16 a[120:121], v152 offset:28672
    ds_read_b64_tr_b16 a[122:123], v152 offset:30720
    v_mfma_f32_16x16x32_bf16 v[72:75], a[88:91], v[184:187], v[72:75]
    v_cmp_eq_u32 vcc, 0, v7
    v_mul_f32 v87, v87, v132
    v_mfma_f32_16x16x32_bf16 v[68:71], a[92:95], v[176:179], v[68:71]
    ds_read_b64_tr_b16 a[124:125], v153 offset:28672
    ds_read_b64_tr_b16 a[126:127], v153 offset:30720
    v_mfma_f32_16x16x32_bf16 v[76:79], a[92:95], v[184:187], v[76:79]
    s_waitcnt lgkmcnt(8)
    v_cvt_pk_bf16_f32 v48, v80, v81
    v_cvt_pk_bf16_f32 v49, v82, v83
    v_mfma_f32_16x16x32_bf16 v[64:67], a[96:99], v[192:195], v[64:67]
    ds_read_b64_tr_b16 a[64:65], v154 offset:0
    ds_read_b64_tr_b16 a[66:67], v154 offset:2048
    v_mfma_f32_16x16x32_bf16 v[72:75], a[96:99], v[200:203], v[72:75]
    v_cvt_pk_bf16_f32 v50, v84, v85
    v_cvt_pk_bf16_f32 v51, v86, v87
    v_cndmask_b32 v24, 0, v6, vcc
    v_mfma_f32_16x16x32_bf16 v[68:71], a[100:103], v[192:195], v[68:71]
    ds_read_b64_tr_b16 a[68:69], v155 offset:0
    ds_read_b64_tr_b16 a[70:71], v155 offset:2048
    v_mfma_f32_16x16x32_bf16 v[76:79], a[100:103], v[200:203], v[76:79]
    buffer_store_dwordx4 v[48:51], v15, s[16:19], s7 offen sc1
    v_cmp_eq_u32 vcc, 1, v7
    v_mfma_f32_16x16x32_bf16 v[64:67], a[104:107], v[208:211], v[64:67]
    s_add_u32 s7, s7, 65536
    ds_read_b64_tr_b16 a[72:73], v154 offset:4096
    ds_read_b64_tr_b16 a[74:75], v154 offset:6144
    v_mfma_f32_16x16x32_bf16 v[72:75], a[104:107], v[216:219], v[72:75]
    v_mul_f32 v88, v88, v133
    v_mul_f32 v89, v89, v133
    v_mfma_f32_16x16x32_bf16 v[68:71], a[108:111], v[208:211], v[68:71]
    ds_read_b64_tr_b16 a[76:77], v155 offset:4096
    ds_read_b64_tr_b16 a[78:79], v155 offset:6144
    v_mfma_f32_16x16x32_bf16 v[76:79], a[108:111], v[216:219], v[76:79]
    s_waitcnt lgkmcnt(8)
    v_cndmask_b32 v25, 0, v6, vcc
    v_mul_f32 v90, v90, v133
    v_mfma_f32_16x16x32_bf16 v[64:67], a[112:115], v[224:227], v[64:67]
    ds_read_b64_tr_b16 a[80:81], v154 offset:8192
    ds_read_b64_tr_b16 a[82:83], v154 offset:10240
    v_mfma_f32_16x16x32_bf16 v[72:75], a[112:115], v[232:235], v[72:75]
    v_cmp_eq_u32 vcc, 2, v7
    v_mul_f32 v91, v91, v133
    v_mul_f32 v92, v92, v133
    v_mfma_f32_16x16x32_bf16 v[68:71], a[116:119], v[224:227], v[68:71]
    ds_read_b64_tr_b16 a[84:85], v155 offset:8192
    ds_read_b64_tr_b16 a[86:87], v155 offset:10240
    v_mfma_f32_16x16x32_bf16 v[76:79], a[116:119], v[232:235], v[76:79]
    v_mul_f32 v93, v93, v133
    v_mul_f32 v94, v94, v133
    v_mfma_f32_16x16x32_bf16 v[64:67], a[120:123], v[240:243], v[64:67]
    ds_read_b64_tr_b16 a[88:89], v154 offset:12288
    ds_read_b64_tr_b16 a[90:91], v154 offset:14336
    v_mfma_f32_16x16x32_bf16 v[72:75], a[120:123], v[248:251], v[72:75]
    v_cndmask_b32 v26, 0, v6, vcc
    v_mul_f32 v95, v95, v133
    v_mfma_f32_16x16x32_bf16 v[68:71], a[124:127], v[240:243], v[68:71]
    ds_read_b64_tr_b16 a[92:93], v155 offset:12288
    ds_read_b64_tr_b16 a[94:95], v155 offset:14336
    v_cvt_pk_bf16_f32 v52, v88, v89
    v_mfma_f32_16x16x32_bf16 v[76:79], a[124:127], v[248:251], v[76:79]
    s_waitcnt lgkmcnt(8)
    v_cvt_pk_bf16_f32 v53, v90, v91
    v_cvt_pk_bf16_f32 v54, v92, v93
    v_cvt_pk_bf16_f32 v55, v94, v95
    buffer_store_dwordx4 v[52:55], v15, s[16:19], s7 offen sc1
    s_add_u32 s7, s7, 65536
    v_mfma_f32_16x16x32_bf16 v[80:83], a[64:67], v[32:35], 0
    ds_read_b64_tr_b16 a[96:97], v154 offset:16384
    ds_read_b64_tr_b16 a[98:99], v154 offset:18432
    v_mfma_f32_16x16x32_bf16 v[88:91], a[64:67], v[40:43], 0
    v_cmp_eq_u32 vcc, 3, v7
    v_mfma_f32_16x16x32_bf16 v[84:87], a[68:71], v[32:35], 0
    ds_read_b64_tr_b16 a[100:101], v155 offset:16384
    ds_read_b64_tr_b16 a[102:103], v155 offset:18432
    v_mfma_f32_16x16x32_bf16 v[92:95], a[68:71], v[40:43], 0
    v_cndmask_b32 v27, 0, v6, vcc
    v_mul_f32 v64, v64, v132
    v_mfma_f32_16x16x32_bf16 v[80:83], a[72:75], v[96:99], v[80:83]
    ds_read_b64_tr_b16 a[104:105], v154 offset:20480
    ds_read_b64_tr_b16 a[106:107], v154 offset:22528
    v_mfma_f32_16x16x32_bf16 v[88:91], a[72:75], v[104:107], v[88:91]
    v_mul_f32 v65, v65, v132
    v_mul_f32 v66, v66, v132
    v_mfma_f32_16x16x32_bf16 v[84:87], a[76:79], v[96:99], v[84:87]
    ds_read_b64_tr_b16 a[108:109], v155 offset:20480
    ds_read_b64_tr_b16 a[110:111], v155 offset:22528
    v_mfma_f32_16x16x32_bf16 v[92:95], a[76:79], v[104:107], v[92:95]
    s_waitcnt lgkmcnt(8)
    v_cmp_eq_u32 vcc, 4, v7
    v_mul_f32 v67, v67, v132
    v_mfma_f32_16x16x32_bf16 v[80:83], a[80:83], v[160:163], v[80:83]
    ds_read_b64_tr_b16 a[112:113], v154 offset:24576
    ds_read_b64_tr_b16 a[114:115], v154 offset:26624
    v_mfma_f32_16x16x32_bf16 v[88:91], a[80:83], v[168:171], v[88:91]
    v_cndmask_b32 v28, 0, v6, vcc
    v_mul_f32 v68, v68, v132
    v_mfma_f32_16x16x32_bf16 v[84:87], a[84:87], v[160:163], v[84:87]
    ds_read_b64_tr_b16 a[116:117], v155 offset:24576
    ds_read_b64_tr_b16 a[118:119], v155 offset:26624
    v_mfma_f32_16x16x32_bf16 v[92:95], a[84:87], v[168:171], v[92:95]
    v_mul_f32 v69, v69, v132
    v_mul_f32 v70, v70, v132
    v_mfma_f32_16x16x32_bf16 v[80:83], a[88:91], v[176:179], v[80:83]
    ds_read_b64_tr_b16 a[120:121], v154 offset:28672
    ds_read_b64_tr_b16 a[122:123], v154 offset:30720
    v_mfma_f32_16x16x32_bf16 v[88:91], a[88:91], v[184:187], v[88:91]
    v_cmp_eq_u32 vcc, 5, v7
    v_mul_f32 v71, v71, v132
    v_cvt_pk_bf16_f32 v112, v64, v65
    v_mfma_f32_16x16x32_bf16 v[84:87], a[92:95], v[176:179], v[84:87]
    s_waitcnt vmcnt(11)
    s_waitcnt lgkmcnt(6)
    ds_read_b64_tr_b16 a[124:125], v155 offset:28672
    ds_read_b64_tr_b16 a[126:127], v155 offset:30720
    v_mfma_f32_16x16x32_bf16 v[92:95], a[92:95], v[184:187], v[92:95]
    s_barrier
    v_mfma_f32_16x16x32_bf16 v[80:83], a[96:99], v[192:195], v[80:83]
    ds_read_b64_tr_b16 a[64:65], v148 offset:0
    ds_read_b64_tr_b16 a[66:67], v148 offset:2048
    v_cvt_pk_bf16_f32 v113, v66, v67
    v_mfma_f32_16x16x32_bf16 v[88:91], a[96:99], v[200:203], v[88:91]
    v_cvt_pk_bf16_f32 v114, v68, v69
    v_cvt_pk_bf16_f32 v115, v70, v71
    v_cndmask_b32 v29, 0, v6, vcc
    v_mfma_f32_16x16x32_bf16 v[84:87], a[100:103], v[192:195], v[84:87]
    ds_read_b64_tr_b16 a[68:69], v149 offset:0
    ds_read_b64_tr_b16 a[70:71], v149 offset:2048
    v_mfma_f32_16x16x32_bf16 v[92:95], a[100:103], v[200:203], v[92:95]
    buffer_store_dwordx4 v[112:115], v15, s[16:19], s7 offen sc1
    v_cmp_eq_u32 vcc, 6, v7
    v_mfma_f32_16x16x32_bf16 v[80:83], a[104:107], v[208:211], v[80:83]
    s_add_u32 s7, s7, 65536
    ds_read_b64_tr_b16 a[72:73], v148 offset:4096
    ds_read_b64_tr_b16 a[74:75], v148 offset:6144
    v_mfma_f32_16x16x32_bf16 v[88:91], a[104:107], v[216:219], v[88:91]
    v_mul_f32 v72, v72, v133
    v_mul_f32 v73, v73, v133
    v_mfma_f32_16x16x32_bf16 v[84:87], a[108:111], v[208:211], v[84:87]
    ds_read_b64_tr_b16 a[76:77], v149 offset:4096
    ds_read_b64_tr_b16 a[78:79], v149 offset:6144
    v_mfma_f32_16x16x32_bf16 v[92:95], a[108:111], v[216:219], v[92:95]
    s_waitcnt lgkmcnt(8)
    v_cndmask_b32 v30, 0, v6, vcc
    v_mul_f32 v74, v74, v133
    v_mfma_f32_16x16x32_bf16 v[80:83], a[112:115], v[224:227], v[80:83]
    ds_read_b64_tr_b16 a[80:81], v148 offset:8192
    ds_read_b64_tr_b16 a[82:83], v148 offset:10240
    v_mfma_f32_16x16x32_bf16 v[88:91], a[112:115], v[232:235], v[88:91]
    v_cmp_eq_u32 vcc, 7, v7
    v_mul_f32 v75, v75, v133
    v_mul_f32 v76, v76, v133
    v_mfma_f32_16x16x32_bf16 v[84:87], a[116:119], v[224:227], v[84:87]
    ds_read_b64_tr_b16 a[84:85], v149 offset:8192
    ds_read_b64_tr_b16 a[86:87], v149 offset:10240
    v_mfma_f32_16x16x32_bf16 v[92:95], a[116:119], v[232:235], v[92:95]
    v_mul_f32 v77, v77, v133
    v_mul_f32 v78, v78, v133
    v_mfma_f32_16x16x32_bf16 v[80:83], a[120:123], v[240:243], v[80:83]
    ds_read_b64_tr_b16 a[88:89], v148 offset:12288
    ds_read_b64_tr_b16 a[90:91], v148 offset:14336
    v_mfma_f32_16x16x32_bf16 v[88:91], a[120:123], v[248:251], v[88:91]
    v_cndmask_b32 v31, 0, v6, vcc
    v_mul_f32 v79, v79, v133
    v_mfma_f32_16x16x32_bf16 v[84:87], a[124:127], v[240:243], v[84:87]
    ds_read_b64_tr_b16 a[92:93], v149 offset:12288
    ds_read_b64_tr_b16 a[94:95], v149 offset:14336
    v_cvt_pk_bf16_f32 v116, v72, v73
    v_mfma_f32_16x16x32_bf16 v[92:95], a[124:127], v[248:251], v[92:95]
    s_waitcnt lgkmcnt(8)
    v_cvt_pk_bf16_f32 v117, v74, v75
    v_cvt_pk_bf16_f32 v118, v76, v77
    v_cvt_pk_bf16_f32 v119, v78, v79
    buffer_store_dwordx4 v[116:119], v15, s[16:19], s7 offen sc1
    s_add_u32 s7, s7, 65536
    v_mfma_f32_16x16x32_bf16 v[64:67], a[64:67], v[32:35], 0
    ds_read_b64_tr_b16 a[96:97], v148 offset:16384
    ds_read_b64_tr_b16 a[98:99], v148 offset:18432
    v_mfma_f32_16x16x32_bf16 v[72:75], a[64:67], v[40:43], 0
    v_mfma_f32_16x16x32_bf16 v[68:71], a[68:71], v[32:35], 0
    ds_read_b64_tr_b16 a[100:101], v149 offset:16384
    ds_read_b64_tr_b16 a[102:103], v149 offset:18432
    v_mfma_f32_16x16x32_bf16 v[76:79], a[68:71], v[40:43], 0
    v_mul_f32 v80, v80, v132
    v_mul_f32 v81, v81, v132
    v_mfma_f32_16x16x32_bf16 v[64:67], a[72:75], v[96:99], v[64:67]
    ds_read_b64_tr_b16 a[104:105], v148 offset:20480
    ds_read_b64_tr_b16 a[106:107], v148 offset:22528
    v_mfma_f32_16x16x32_bf16 v[72:75], a[72:75], v[104:107], v[72:75]
    v_mul_f32 v82, v82, v132
    v_mul_f32 v83, v83, v132
    v_mfma_f32_16x16x32_bf16 v[68:71], a[76:79], v[96:99], v[68:71]
    ds_read_b64_tr_b16 a[108:109], v149 offset:20480
    ds_read_b64_tr_b16 a[110:111], v149 offset:22528
    v_mfma_f32_16x16x32_bf16 v[76:79], a[76:79], v[104:107], v[76:79]
    s_waitcnt lgkmcnt(8)
    v_mul_f32 v84, v84, v132
    v_mul_f32 v85, v85, v132
    v_mfma_f32_16x16x32_bf16 v[64:67], a[80:83], v[160:163], v[64:67]
    ds_read_b64_tr_b16 a[112:113], v148 offset:24576
    ds_read_b64_tr_b16 a[114:115], v148 offset:26624
    v_mfma_f32_16x16x32_bf16 v[72:75], a[80:83], v[168:171], v[72:75]
    v_mul_f32 v86, v86, v132
    v_mul_f32 v87, v87, v132
    v_mfma_f32_16x16x32_bf16 v[68:71], a[84:87], v[160:163], v[68:71]
    ds_read_b64_tr_b16 a[116:117], v149 offset:24576
    ds_read_b64_tr_b16 a[118:119], v149 offset:26624
    v_mfma_f32_16x16x32_bf16 v[76:79], a[84:87], v[168:171], v[76:79]
    v_cvt_pk_bf16_f32 v48, v80, v81
    v_cvt_pk_bf16_f32 v49, v82, v83
    v_mfma_f32_16x16x32_bf16 v[64:67], a[88:91], v[176:179], v[64:67]
    ds_read_b64_tr_b16 a[120:121], v148 offset:28672
    ds_read_b64_tr_b16 a[122:123], v148 offset:30720
    v_mfma_f32_16x16x32_bf16 v[72:75], a[88:91], v[184:187], v[72:75]
    v_cvt_pk_bf16_f32 v50, v84, v85
    v_cvt_pk_bf16_f32 v51, v86, v87
    v_mfma_f32_16x16x32_bf16 v[68:71], a[92:95], v[176:179], v[68:71]
    ds_read_b64_tr_b16 a[124:125], v149 offset:28672
    ds_read_b64_tr_b16 a[126:127], v149 offset:30720
    v_mfma_f32_16x16x32_bf16 v[76:79], a[92:95], v[184:187], v[76:79]
    s_waitcnt lgkmcnt(8)
    buffer_store_dwordx4 v[48:51], v15, s[16:19], s7 offen sc1
    v_mfma_f32_16x16x32_bf16 v[64:67], a[96:99], v[192:195], v[64:67]
    s_add_u32 s7, s7, 65536
    ds_read_b64_tr_b16 a[64:65], v150 offset:0
    ds_read_b64_tr_b16 a[66:67], v150 offset:2048
    v_mfma_f32_16x16x32_bf16 v[72:75], a[96:99], v[200:203], v[72:75]
    v_mul_f32 v88, v88, v133
    v_mul_f32 v89, v89, v133
    v_mfma_f32_16x16x32_bf16 v[68:71], a[100:103], v[192:195], v[68:71]
    ds_read_b64_tr_b16 a[68:69], v151 offset:0
    ds_read_b64_tr_b16 a[70:71], v151 offset:2048
    v_mfma_f32_16x16x32_bf16 v[76:79], a[100:103], v[200:203], v[76:79]
    v_mul_f32 v90, v90, v133
    v_mul_f32 v91, v91, v133
    v_mfma_f32_16x16x32_bf16 v[64:67], a[104:107], v[208:211], v[64:67]
    ds_read_b64_tr_b16 a[72:73], v150 offset:4096
    ds_read_b64_tr_b16 a[74:75], v150 offset:6144
    v_mfma_f32_16x16x32_bf16 v[72:75], a[104:107], v[216:219], v[72:75]
    v_mul_f32 v92, v92, v133
    v_mul_f32 v93, v93, v133
    v_mfma_f32_16x16x32_bf16 v[68:71], a[108:111], v[208:211], v[68:71]
    ds_read_b64_tr_b16 a[76:77], v151 offset:4096
    ds_read_b64_tr_b16 a[78:79], v151 offset:6144
    v_mfma_f32_16x16x32_bf16 v[76:79], a[108:111], v[216:219], v[76:79]
    s_waitcnt lgkmcnt(8)
    v_mul_f32 v94, v94, v133
    v_mul_f32 v95, v95, v133
    v_mfma_f32_16x16x32_bf16 v[64:67], a[112:115], v[224:227], v[64:67]
    ds_read_b64_tr_b16 a[80:81], v150 offset:8192
    ds_read_b64_tr_b16 a[82:83], v150 offset:10240
    v_mfma_f32_16x16x32_bf16 v[72:75], a[112:115], v[232:235], v[72:75]
    v_cvt_pk_bf16_f32 v52, v88, v89
    v_cvt_pk_bf16_f32 v53, v90, v91
    v_mfma_f32_16x16x32_bf16 v[68:71], a[116:119], v[224:227], v[68:71]
    ds_read_b64_tr_b16 a[84:85], v151 offset:8192
    ds_read_b64_tr_b16 a[86:87], v151 offset:10240
    v_mfma_f32_16x16x32_bf16 v[76:79], a[116:119], v[232:235], v[76:79]
    v_cvt_pk_bf16_f32 v54, v92, v93
    v_cvt_pk_bf16_f32 v55, v94, v95
    v_mfma_f32_16x16x32_bf16 v[64:67], a[120:123], v[240:243], v[64:67]
    ds_read_b64_tr_b16 a[88:89], v150 offset:12288
    ds_read_b64_tr_b16 a[90:91], v150 offset:14336
    v_mfma_f32_16x16x32_bf16 v[72:75], a[120:123], v[248:251], v[72:75]
    buffer_store_dwordx4 v[52:55], v15, s[16:19], s7 offen sc1
    v_mfma_f32_16x16x32_bf16 v[68:71], a[124:127], v[240:243], v[68:71]
    s_add_u32 s7, s7, 65536
    ds_read_b64_tr_b16 a[92:93], v151 offset:12288
    ds_read_b64_tr_b16 a[94:95], v151 offset:14336
    v_mfma_f32_16x16x32_bf16 v[76:79], a[124:127], v[248:251], v[76:79]
    s_waitcnt lgkmcnt(8)
    v_mfma_f32_16x16x32_bf16 v[80:83], a[64:67], v[32:35], 0
    ds_read_b64_tr_b16 a[96:97], v150 offset:16384
    ds_read_b64_tr_b16 a[98:99], v150 offset:18432
    v_mfma_f32_16x16x32_bf16 v[88:91], a[64:67], v[40:43], 0
    v_mfma_f32_16x16x32_bf16 v[84:87], a[68:71], v[32:35], 0
    ds_read_b64_tr_b16 a[100:101], v151 offset:16384
    ds_read_b64_tr_b16 a[102:103], v151 offset:18432
    v_mfma_f32_16x16x32_bf16 v[92:95], a[68:71], v[40:43], 0
    v_mul_f32 v64, v64, v132
    v_mul_f32 v65, v65, v132
    v_mfma_f32_16x16x32_bf16 v[80:83], a[72:75], v[96:99], v[80:83]
    ds_read_b64_tr_b16 a[104:105], v150 offset:20480
    ds_read_b64_tr_b16 a[106:107], v150 offset:22528
    v_mfma_f32_16x16x32_bf16 v[88:91], a[72:75], v[104:107], v[88:91]
    v_mul_f32 v66, v66, v132
    v_mul_f32 v67, v67, v132
    v_mfma_f32_16x16x32_bf16 v[84:87], a[76:79], v[96:99], v[84:87]
    ds_read_b64_tr_b16 a[108:109], v151 offset:20480
    ds_read_b64_tr_b16 a[110:111], v151 offset:22528
    v_mfma_f32_16x16x32_bf16 v[92:95], a[76:79], v[104:107], v[92:95]
    s_waitcnt lgkmcnt(8)
    v_mul_f32 v68, v68, v132
    v_mul_f32 v69, v69, v132
    v_mfma_f32_16x16x32_bf16 v[80:83], a[80:83], v[160:163], v[80:83]
    ds_read_b64_tr_b16 a[112:113], v150 offset:24576
    ds_read_b64_tr_b16 a[114:115], v150 offset:26624
    v_mfma_f32_16x16x32_bf16 v[88:91], a[80:83], v[168:171], v[88:91]
    v_mul_f32 v70, v70, v132
    v_mul_f32 v71, v71, v132
    v_mfma_f32_16x16x32_bf16 v[84:87], a[84:87], v[160:163], v[84:87]
    ds_read_b64_tr_b16 a[116:117], v151 offset:24576
    ds_read_b64_tr_b16 a[118:119], v151 offset:26624
    v_mfma_f32_16x16x32_bf16 v[92:95], a[84:87], v[168:171], v[92:95]
    v_cvt_pk_bf16_f32 v112, v64, v65
    v_cvt_pk_bf16_f32 v113, v66, v67
    v_mfma_f32_16x16x32_bf16 v[80:83], a[88:91], v[176:179], v[80:83]
    ds_read_b64_tr_b16 a[120:121], v150 offset:28672
    ds_read_b64_tr_b16 a[122:123], v150 offset:30720
    v_mfma_f32_16x16x32_bf16 v[88:91], a[88:91], v[184:187], v[88:91]
    v_cvt_pk_bf16_f32 v114, v68, v69
    v_cvt_pk_bf16_f32 v115, v70, v71
    v_mfma_f32_16x16x32_bf16 v[84:87], a[92:95], v[176:179], v[84:87]
    ds_read_b64_tr_b16 a[124:125], v151 offset:28672
    ds_read_b64_tr_b16 a[126:127], v151 offset:30720
    v_mfma_f32_16x16x32_bf16 v[92:95], a[92:95], v[184:187], v[92:95]
    s_waitcnt lgkmcnt(8)
    buffer_store_dwordx4 v[112:115], v15, s[16:19], s7 offen sc1
    v_mfma_f32_16x16x32_bf16 v[80:83], a[96:99], v[192:195], v[80:83]
    s_add_u32 s7, s7, 65536
    v_mfma_f32_16x16x32_bf16 v[88:91], a[96:99], v[200:203], v[88:91]
    v_mul_f32 v72, v72, v133
    v_mfma_f32_16x16x32_bf16 v[84:87], a[100:103], v[192:195], v[84:87]
    v_mul_f32 v73, v73, v133
    v_mfma_f32_16x16x32_bf16 v[92:95], a[100:103], v[200:203], v[92:95]
    v_mul_f32 v74, v74, v133
    v_mfma_f32_16x16x32_bf16 v[80:83], a[104:107], v[208:211], v[80:83]
    v_mul_f32 v75, v75, v133
    v_mfma_f32_16x16x32_bf16 v[88:91], a[104:107], v[216:219], v[88:91]
    v_mul_f32 v76, v76, v133
    v_mfma_f32_16x16x32_bf16 v[84:87], a[108:111], v[208:211], v[84:87]
    v_mul_f32 v77, v77, v133
    v_mfma_f32_16x16x32_bf16 v[92:95], a[108:111], v[216:219], v[92:95]
    s_waitcnt lgkmcnt(0)
    v_mul_f32 v78, v78, v133
    v_mfma_f32_16x16x32_bf16 v[80:83], a[112:115], v[224:227], v[80:83]
    v_mul_f32 v79, v79, v133
    v_mfma_f32_16x16x32_bf16 v[88:91], a[112:115], v[232:235], v[88:91]
    v_cvt_pk_bf16_f32 v116, v72, v73
    v_mfma_f32_16x16x32_bf16 v[84:87], a[116:119], v[224:227], v[84:87]
    v_cvt_pk_bf16_f32 v117, v74, v75
    v_mfma_f32_16x16x32_bf16 v[92:95], a[116:119], v[232:235], v[92:95]
    v_cvt_pk_bf16_f32 v118, v76, v77
    v_mfma_f32_16x16x32_bf16 v[80:83], a[120:123], v[240:243], v[80:83]
    v_cvt_pk_bf16_f32 v119, v78, v79
    v_mfma_f32_16x16x32_bf16 v[88:91], a[120:123], v[248:251], v[88:91]
    buffer_store_dwordx4 v[116:119], v15, s[16:19], s7 offen sc1
    v_mfma_f32_16x16x32_bf16 v[84:87], a[124:127], v[240:243], v[84:87]
    v_mfma_f32_16x16x32_bf16 v[92:95], a[124:127], v[248:251], v[92:95]
    s_add_u32 s7, s7, 65536
    s_nop 1
    v_mul_f32 v80, v80, v132
    v_mul_f32 v81, v81, v132
    v_mul_f32 v82, v82, v132
    v_mul_f32 v83, v83, v132
    v_mul_f32 v84, v84, v132
    v_mul_f32 v85, v85, v132
    v_mul_f32 v86, v86, v132
    v_mul_f32 v87, v87, v132
    v_cvt_pk_bf16_f32 v48, v80, v81
    v_cvt_pk_bf16_f32 v49, v82, v83
    v_cvt_pk_bf16_f32 v50, v84, v85
    v_cvt_pk_bf16_f32 v51, v86, v87
    buffer_store_dwordx4 v[48:51], v15, s[16:19], s7 offen sc1
    s_add_u32 s7, s7, 65536
    v_mul_f32 v88, v88, v133
    v_mul_f32 v89, v89, v133
    v_mul_f32 v90, v90, v133
    v_mul_f32 v91, v91, v133
    v_mul_f32 v92, v92, v133
    v_mul_f32 v93, v93, v133
    v_mul_f32 v94, v94, v133
    v_mul_f32 v95, v95, v133
    v_cvt_pk_bf16_f32 v52, v88, v89
    v_cvt_pk_bf16_f32 v53, v90, v91
    v_cvt_pk_bf16_f32 v54, v92, v93
    v_cvt_pk_bf16_f32 v55, v94, v95
    buffer_store_dwordx4 v[52:55], v15, s[16:19], s7 offen sc1
    s_add_u32 s7, s7, 65536
    s_waitcnt vmcnt(0)
    v_mov_b32 v6, 7
    s_mov_b64 exec, 1
    buffer_store_dword v6, off, s[16:19], s25 sc1
    s_mov_b64 exec, -1
    v_and_b32 v1, 0xf0, v14
    v_lshlrev_b32 v1, 10, v1
    buffer_load_dword v1, v1, s[16:19], s35 offen sc1
    v_lshlrev_b32 v112, 16, v156
    v_and_b32 v113, 0xffff0000, v156
    v_lshlrev_b32 v114, 16, v157
    v_and_b32 v115, 0xffff0000, v157
    v_lshlrev_b32 v116, 16, v158
    v_and_b32 v117, 0xffff0000, v158
    v_lshlrev_b32 v118, 16, v159
    v_and_b32 v119, 0xffff0000, v159
    v_lshlrev_b32 v120, 16, v128
    v_and_b32 v121, 0xffff0000, v128
    v_lshlrev_b32 v122, 16, v129
    v_and_b32 v123, 0xffff0000, v129
    v_lshlrev_b32 v124, 16, v130
    v_and_b32 v125, 0xffff0000, v130
    v_lshlrev_b32 v126, 16, v131
    v_and_b32 v127, 0xffff0000, v131
    v_accvgpr_read_b32 v32, a248
    v_accvgpr_read_b32 v33, a249
    v_accvgpr_read_b32 v34, a250
    v_accvgpr_read_b32 v35, a251
    v_accvgpr_read_b32 v40, a252
    v_accvgpr_read_b32 v41, a253
    v_accvgpr_read_b32 v42, a254
    v_accvgpr_read_b32 v43, a255
    s_nop 1
    v_mfma_f32_16x16x32_bf16 v[40:43], v[28:31], a[192:195], v[40:43]
    v_mfma_f32_16x16x32_bf16 v[40:43], v[28:31], a[196:199], v[40:43]
    v_mfma_f32_16x16x32_bf16 v[96:99], v[24:27], a[200:203], 0
    v_mfma_f32_16x16x32_bf16 v[96:99], v[24:27], a[204:207], v[96:99]
    v_mfma_f32_16x16x32_bf16 v[96:99], v[24:27], a[208:211], v[96:99]
    v_mfma_f32_16x16x32_bf16 v[96:99], v[24:27], a[212:215], v[96:99]
    v_mfma_f32_16x16x32_bf16 v[96:99], v[28:31], a[216:219], v[96:99]
    v_mfma_f32_16x16x32_bf16 v[96:99], v[28:31], a[220:223], v[96:99]
    v_mfma_f32_16x16x32_bf16 v[96:99], v[28:31], a[224:227], v[96:99]
    v_mfma_f32_16x16x32_bf16 v[96:99], v[28:31], a[228:231], v[96:99]
    v_mfma_f32_16x16x32_bf16 v[104:107], v[24:27], a[232:235], 0
    v_mfma_f32_16x16x32_bf16 v[104:107], v[24:27], a[236:239], v[104:107]
    v_mfma_f32_16x16x32_bf16 v[104:107], v[24:27], a[240:243], v[104:107]
    v_mfma_f32_16x16x32_bf16 v[104:107], v[24:27], a[244:247], v[104:107]
    s_waitcnt vmcnt(0)
    v_and_b32 v1, 4, v1
    v_cmp_ne_u32 vcc, 4, v1
    s_nop 0
    s_cbranch_vccnz .Lmain_kernel_spin_167
.Lmain_kernel_pok_166:
    s_add_u32 s30, s29, 0
    buffer_load_dwordx4 v[160:163], v14, s[16:19], s30 offen offset:0 sc1
    buffer_load_dwordx4 v[164:167], v14, s[16:19], s30 offen offset:1024 sc1
    buffer_load_dwordx4 v[168:171], v14, s[16:19], s30 offen offset:2048 sc1
    buffer_load_dwordx4 v[172:175], v14, s[16:19], s30 offen offset:3072 sc1
    s_add_u32 s30, s29, 262144
    buffer_load_dwordx4 v[176:179], v14, s[16:19], s30 offen offset:0 sc1
    buffer_load_dwordx4 v[180:183], v14, s[16:19], s30 offen offset:1024 sc1
    buffer_load_dwordx4 v[184:187], v14, s[16:19], s30 offen offset:2048 sc1
    buffer_load_dwordx4 v[188:191], v14, s[16:19], s30 offen offset:3072 sc1
    s_add_u32 s30, s29, 524288
    buffer_load_dwordx4 v[192:195], v14, s[16:19], s30 offen offset:0 sc1
    buffer_load_dwordx4 v[196:199], v14, s[16:19], s30 offen offset:1024 sc1
    buffer_load_dwordx4 v[200:203], v14, s[16:19], s30 offen offset:2048 sc1
    buffer_load_dwordx4 v[204:207], v14, s[16:19], s30 offen offset:3072 sc1
    s_add_u32 s30, s29, 786432
    buffer_load_dwordx4 v[208:211], v14, s[16:19], s30 offen offset:0 sc1
    buffer_load_dwordx4 v[212:215], v14, s[16:19], s30 offen offset:1024 sc1
    buffer_load_dwordx4 v[216:219], v14, s[16:19], s30 offen offset:2048 sc1
    buffer_load_dwordx4 v[220:223], v14, s[16:19], s30 offen offset:3072 sc1
    s_add_u32 s30, s29, 1048576
    buffer_load_dwordx4 v[224:227], v14, s[16:19], s30 offen offset:0 sc1
    buffer_load_dwordx4 v[228:231], v14, s[16:19], s30 offen offset:1024 sc1
    buffer_load_dwordx4 v[232:235], v14, s[16:19], s30 offen offset:2048 sc1
    buffer_load_dwordx4 v[236:239], v14, s[16:19], s30 offen offset:3072 sc1
    s_add_u32 s30, s29, 1310720
    buffer_load_dwordx4 v[240:243], v14, s[16:19], s30 offen offset:0 sc1
    buffer_load_dwordx4 v[244:247], v14, s[16:19], s30 offen offset:1024 sc1
    buffer_load_dwordx4 v[248:251], v14, s[16:19], s30 offen offset:2048 sc1
    buffer_load_dwordx4 v[252:255], v14, s[16:19], s30 offen offset:3072 sc1
    s_add_u32 s30, s29, 1572864
    buffer_load_dwordx4 v[140:143], v14, s[16:19], s30 offen offset:0 sc1
    buffer_load_dwordx4 v[144:147], v14, s[16:19], s30 offen offset:1024 sc1
    buffer_load_dwordx4 v[148:151], v14, s[16:19], s30 offen offset:2048 sc1
    buffer_load_dwordx4 v[152:155], v14, s[16:19], s30 offen offset:3072 sc1
    v_mul_f32 v64, 3216550459, v32
    v_mul_f32 v65, 3216550459, v33
    v_mul_f32 v66, 3216550459, v34
    v_mul_f32 v67, 3216550459, v35
    v_mul_f32 v68, 3216550459, v40
    v_mul_f32 v69, 3216550459, v41
    v_mul_f32 v70, 3216550459, v42
    v_mul_f32 v71, 3216550459, v43
    v_mul_f32 v72, 3216550459, v96
    v_mul_f32 v73, 3216550459, v97
    v_mul_f32 v74, 3216550459, v98
    v_mul_f32 v75, 3216550459, v99
    v_mul_f32 v76, 3216550459, v104
    v_mul_f32 v77, 3216550459, v105
    v_mul_f32 v78, 3216550459, v106
    v_mul_f32 v79, 3216550459, v107
    v_exp_f32 v64, v64
    v_exp_f32 v65, v65
    v_exp_f32 v66, v66
    v_exp_f32 v67, v67
    v_exp_f32 v68, v68
    v_exp_f32 v69, v69
    v_exp_f32 v70, v70
    v_exp_f32 v71, v71
    v_exp_f32 v72, v72
    v_exp_f32 v73, v73
    v_exp_f32 v74, v74
    v_exp_f32 v75, v75
    v_exp_f32 v76, v76
    v_exp_f32 v77, v77
    v_exp_f32 v78, v78
    v_exp_f32 v79, v79
    v_add_f32 v64, 1.0, v64
    v_add_f32 v65, 1.0, v65
    v_add_f32 v66, 1.0, v66
    v_add_f32 v67, 1.0, v67
    v_add_f32 v68, 1.0, v68
    v_add_f32 v69, 1.0, v69
    v_add_f32 v70, 1.0, v70
    v_add_f32 v71, 1.0, v71
    v_add_f32 v72, 1.0, v72
    v_add_f32 v73, 1.0, v73
    v_add_f32 v74, 1.0, v74
    v_add_f32 v75, 1.0, v75
    v_add_f32 v76, 1.0, v76
    v_add_f32 v77, 1.0, v77
    v_add_f32 v78, 1.0, v78
    v_add_f32 v79, 1.0, v79
    v_rcp_f32 v64, v64
    v_rcp_f32 v65, v65
    v_rcp_f32 v66, v66
    v_rcp_f32 v67, v67
    v_rcp_f32 v68, v68
    v_rcp_f32 v69, v69
    v_rcp_f32 v70, v70
    v_rcp_f32 v71, v71
    v_rcp_f32 v72, v72
    v_rcp_f32 v73, v73
    v_rcp_f32 v74, v74
    v_rcp_f32 v75, v75
    v_rcp_f32 v76, v76
    v_rcp_f32 v77, v77
    v_rcp_f32 v78, v78
    v_rcp_f32 v79, v79
    v_mul_f32 v64, v64, v32
    v_mul_f32 v65, v65, v33
    v_mul_f32 v66, v66, v34
    v_mul_f32 v67, v67, v35
    v_mul_f32 v68, v68, v40
    v_mul_f32 v69, v69, v41
    v_mul_f32 v70, v70, v42
    v_mul_f32 v71, v71, v43
    v_mul_f32 v72, v72, v96
    v_mul_f32 v73, v73, v97
    v_mul_f32 v74, v74, v98
    v_mul_f32 v75, v75, v99
    v_mul_f32 v76, v76, v104
    v_mul_f32 v77, v77, v105
    v_mul_f32 v78, v78, v106
    v_mul_f32 v79, v79, v107
    s_waitcnt vmcnt(27)
    v_mfma_f32_16x16x32_bf16 v[36:39], v[24:27], v[160:163], 0
    s_waitcnt vmcnt(26)
    v_mfma_f32_16x16x32_bf16 v[36:39], v[24:27], v[164:167], v[36:39]
    s_waitcnt vmcnt(25)
    v_mfma_f32_16x16x32_bf16 v[36:39], v[24:27], v[168:171], v[36:39]
    s_waitcnt vmcnt(24)
    v_mfma_f32_16x16x32_bf16 v[36:39], v[24:27], v[172:175], v[36:39]
    s_waitcnt vmcnt(23)
    v_mfma_f32_16x16x32_bf16 v[36:39], v[28:31], v[176:179], v[36:39]
    s_waitcnt vmcnt(22)
    v_mfma_f32_16x16x32_bf16 v[36:39], v[28:31], v[180:183], v[36:39]
    s_waitcnt vmcnt(21)
    v_mfma_f32_16x16x32_bf16 v[36:39], v[28:31], v[184:187], v[36:39]
    s_waitcnt vmcnt(20)
    v_mfma_f32_16x16x32_bf16 v[36:39], v[28:31], v[188:191], v[36:39]
    s_waitcnt vmcnt(19)
    v_mfma_f32_16x16x32_bf16 v[44:47], v[24:27], v[192:195], 0
    s_waitcnt vmcnt(18)
    v_mfma_f32_16x16x32_bf16 v[44:47], v[24:27], v[196:199], v[44:47]
    s_waitcnt vmcnt(17)
    v_mfma_f32_16x16x32_bf16 v[44:47], v[24:27], v[200:203], v[44:47]
    s_waitcnt vmcnt(16)
    v_mfma_f32_16x16x32_bf16 v[44:47], v[24:27], v[204:207], v[44:47]
    s_waitcnt vmcnt(15)
    v_mfma_f32_16x16x32_bf16 v[44:47], v[28:31], v[208:211], v[44:47]
    s_waitcnt vmcnt(14)
    v_mfma_f32_16x16x32_bf16 v[44:47], v[28:31], v[212:215], v[44:47]
    s_waitcnt vmcnt(13)
    v_mfma_f32_16x16x32_bf16 v[44:47], v[28:31], v[216:219], v[44:47]
    s_waitcnt vmcnt(12)
    v_mfma_f32_16x16x32_bf16 v[44:47], v[28:31], v[220:223], v[44:47]
    s_waitcnt vmcnt(11)
    v_mfma_f32_16x16x32_bf16 v[100:103], v[24:27], v[224:227], 0
    s_waitcnt vmcnt(10)
    v_mfma_f32_16x16x32_bf16 v[100:103], v[24:27], v[228:231], v[100:103]
    s_waitcnt vmcnt(9)
    v_mfma_f32_16x16x32_bf16 v[100:103], v[24:27], v[232:235], v[100:103]
    s_waitcnt vmcnt(8)
    v_mfma_f32_16x16x32_bf16 v[100:103], v[24:27], v[236:239], v[100:103]
    s_waitcnt vmcnt(7)
    v_mfma_f32_16x16x32_bf16 v[100:103], v[28:31], v[240:243], v[100:103]
    s_waitcnt vmcnt(6)
    v_mfma_f32_16x16x32_bf16 v[100:103], v[28:31], v[244:247], v[100:103]
    s_waitcnt vmcnt(5)
    v_mfma_f32_16x16x32_bf16 v[100:103], v[28:31], v[248:251], v[100:103]
    s_waitcnt vmcnt(4)
    v_mfma_f32_16x16x32_bf16 v[100:103], v[28:31], v[252:255], v[100:103]
    s_waitcnt vmcnt(3)
    v_mfma_f32_16x16x32_bf16 v[108:111], v[24:27], v[140:143], 0
    s_waitcnt vmcnt(2)
    v_mfma_f32_16x16x32_bf16 v[108:111], v[24:27], v[144:147], v[108:111]
    s_waitcnt vmcnt(1)
    v_mfma_f32_16x16x32_bf16 v[108:111], v[24:27], v[148:151], v[108:111]
    s_waitcnt vmcnt(0)
    v_mfma_f32_16x16x32_bf16 v[108:111], v[24:27], v[152:155], v[108:111]
    v_fmac_f32 v112, v36, v64
    v_fmac_f32 v113, v37, v65
    v_fmac_f32 v114, v38, v66
    v_fmac_f32 v115, v39, v67
    v_cvt_pk_bf16_f32 v156, v112, v113
    v_cvt_pk_bf16_f32 v157, v114, v115
    buffer_store_dwordx2 v[156:157], v135, s[68:71], s61 offen offset:0
    v_fmac_f32 v116, v44, v68
    v_fmac_f32 v117, v45, v69
    v_fmac_f32 v118, v46, v70
    v_fmac_f32 v119, v47, v71
    v_cvt_pk_bf16_f32 v158, v116, v117
    v_cvt_pk_bf16_f32 v159, v118, v119
    buffer_store_dwordx2 v[158:159], v135, s[68:71], s61 offen offset:256
    v_fmac_f32 v120, v100, v72
    v_fmac_f32 v121, v101, v73
    v_fmac_f32 v122, v102, v74
    v_fmac_f32 v123, v103, v75
    v_cvt_pk_bf16_f32 v128, v120, v121
    v_cvt_pk_bf16_f32 v129, v122, v123
    buffer_store_dwordx2 v[128:129], v135, s[68:71], s61 offen offset:512
    v_fmac_f32 v124, v108, v76
    v_fmac_f32 v125, v109, v77
    v_fmac_f32 v126, v110, v78
    v_fmac_f32 v127, v111, v79
    v_cvt_pk_bf16_f32 v130, v124, v125
    v_cvt_pk_bf16_f32 v131, v126, v127
    s_mov_b32 exec_hi, 0
    buffer_store_dwordx2 v[130:131], v135, s[68:71], s61 offen offset:768
    s_mov_b32 exec_hi, -1
.Lmain_kernel_done_1:
    s_endpgm
.Lmain_kernel_sd_9:
    v_mov_b32 v2, 1
    s_mov_b64 exec, 1
    buffer_store_byte v2, off, s[48:51], s43 sc1
    s_mov_b64 exec, -1
    s_branch .Lmain_kernel_sdr_10
.Lmain_kernel_spin_13:
    s_mov_b32 s31, 0
.Lmain_kernel_sp2_14:
    s_add_u32 s31, s31, 1
    s_cmp_gt_u32 s31, 0x40000
    s_cbranch_scc1 .Lmain_kernel_pok_12
    s_sleep 2
    v_lshrrev_b32 v30, 2, v14
    buffer_load_dword v30, v30, s[48:51], 0 offen sc1
    s_waitcnt vmcnt(0)
    v_and_b32 v30, 16843009, v30
    v_cmp_ne_u32 vcc, 16843009, v30
    s_nop 0
    s_cbranch_vccnz .Lmain_kernel_sp2_14
    s_branch .Lmain_kernel_pok_12
.Lmain_kernel_sd_16:
    v_mov_b32 v2, 1
    s_mov_b64 exec, 1
    buffer_store_byte v2, off, s[48:51], s43 sc1
    s_mov_b64 exec, -1
    s_branch .Lmain_kernel_sdr_17
.Lmain_kernel_spin_20:
    s_mov_b32 s31, 0
.Lmain_kernel_sp2_21:
    s_add_u32 s31, s31, 1
    s_cmp_gt_u32 s31, 0x40000
    s_cbranch_scc1 .Lmain_kernel_pok_19
    s_sleep 2
    v_lshrrev_b32 v30, 2, v14
    buffer_load_dword v30, v30, s[48:51], 0 offen sc1
    s_waitcnt vmcnt(0)
    v_and_b32 v30, 16843009, v30
    v_cmp_ne_u32 vcc, 16843009, v30
    s_nop 0
    s_cbranch_vccnz .Lmain_kernel_sp2_21
    s_branch .Lmain_kernel_pok_19
.Lmain_kernel_sd_22:
    v_mov_b32 v2, 1
    s_mov_b64 exec, 1
    buffer_store_dword v2, off, s[16:19], s3 offset:0 sc1
    s_mov_b64 exec, -1
    s_branch .Lmain_kernel_sdr_23
.Lmain_kernel_spin_25:
    s_mov_b32 s31, 0
.Lmain_kernel_sp2_26:
    s_add_u32 s31, s31, 1
    s_cmp_gt_u32 s31, 0x40000
    s_cbranch_scc1 .Lmain_kernel_pok_24
    s_sleep 2
    v_and_b32 v1, 0xf0, v14
    v_lshlrev_b32 v1, 6, v1
    s_and_b32 s30, s3, 0xffffc000
    buffer_load_dword v1, v1, s[16:19], s30 offen sc1
    s_waitcnt vmcnt(0)
    v_and_b32 v1, 1, v1
    v_cmp_ne_u32 vcc, 1, v1
    s_nop 0
    s_cbranch_vccnz .Lmain_kernel_sp2_26
    s_branch .Lmain_kernel_pok_24
.Lmain_kernel_mask_27:
    v_subrev_u32 v6, 0, v17
    v_add_u32 v7, 64, v6
    v_cmp_gt_i32 s[52:53], 0, v6
    v_cmp_gt_i32 s[54:55], 1, v6
    v_cmp_gt_i32 s[72:73], 2, v6
    v_cmp_gt_i32 s[74:75], 3, v6
    v_cndmask_b32 v112, v20, v18, s[52:53]
    v_cndmask_b32 v113, v20, v18, s[54:55]
    v_cndmask_b32 v114, v20, v18, s[72:73]
    v_cndmask_b32 v115, v20, v18, s[74:75]
    v_cmp_gt_i32 s[52:53], 16, v6
    v_cmp_gt_i32 s[54:55], 17, v6
    v_cmp_gt_i32 s[72:73], 18, v6
    v_cmp_gt_i32 s[74:75], 19, v6
    v_cndmask_b32 v116, v20, v18, s[52:53]
    v_cndmask_b32 v117, v20, v18, s[54:55]
    v_cndmask_b32 v118, v20, v18, s[72:73]
    v_cndmask_b32 v119, v20, v18, s[74:75]
    v_cmp_gt_i32 s[52:53], 0, v7
    v_cmp_gt_i32 s[54:55], 1, v7
    v_cmp_gt_i32 s[72:73], 2, v7
    v_cmp_gt_i32 s[74:75], 3, v7
    v_cndmask_b32 v120, v21, v18, s[52:53]
    v_cndmask_b32 v121, v21, v18, s[54:55]
    v_cndmask_b32 v122, v21, v18, s[72:73]
    v_cndmask_b32 v123, v21, v18, s[74:75]
    v_cmp_gt_i32 s[52:53], 16, v7
    v_cmp_gt_i32 s[54:55], 17, v7
    v_cmp_gt_i32 s[72:73], 18, v7
    v_cmp_gt_i32 s[74:75], 19, v7
    v_cndmask_b32 v124, v21, v18, s[52:53]
    v_cndmask_b32 v125, v21, v18, s[54:55]
    v_cndmask_b32 v126, v21, v18, s[72:73]
    v_cndmask_b32 v127, v21, v18, s[74:75]
    s_branch .Lmain_kernel_maskr_28
.Lmain_kernel_mask_30:
    v_subrev_u32 v6, 32, v17
    v_add_u32 v7, 64, v6
    v_cmp_gt_i32 s[52:53], 0, v6
    v_cmp_gt_i32 s[54:55], 1, v6
    v_cmp_gt_i32 s[72:73], 2, v6
    v_cmp_gt_i32 s[74:75], 3, v6
    v_cndmask_b32 v112, v20, v18, s[52:53]
    v_cndmask_b32 v113, v20, v18, s[54:55]
    v_cndmask_b32 v114, v20, v18, s[72:73]
    v_cndmask_b32 v115, v20, v18, s[74:75]
    v_cmp_gt_i32 s[52:53], 16, v6
    v_cmp_gt_i32 s[54:55], 17, v6
    v_cmp_gt_i32 s[72:73], 18, v6
    v_cmp_gt_i32 s[74:75], 19, v6
    v_cndmask_b32 v116, v20, v18, s[52:53]
    v_cndmask_b32 v117, v20, v18, s[54:55]
    v_cndmask_b32 v118, v20, v18, s[72:73]
    v_cndmask_b32 v119, v20, v18, s[74:75]
    v_cmp_gt_i32 s[52:53], 0, v7
    v_cmp_gt_i32 s[54:55], 1, v7
    v_cmp_gt_i32 s[72:73], 2, v7
    v_cmp_gt_i32 s[74:75], 3, v7
    v_cndmask_b32 v120, v21, v18, s[52:53]
    v_cndmask_b32 v121, v21, v18, s[54:55]
    v_cndmask_b32 v122, v21, v18, s[72:73]
    v_cndmask_b32 v123, v21, v18, s[74:75]
    v_cmp_gt_i32 s[52:53], 16, v7
    v_cmp_gt_i32 s[54:55], 17, v7
    v_cmp_gt_i32 s[72:73], 18, v7
    v_cmp_gt_i32 s[74:75], 19, v7
    v_cndmask_b32 v124, v21, v18, s[52:53]
    v_cndmask_b32 v125, v21, v18, s[54:55]
    v_cndmask_b32 v126, v21, v18, s[72:73]
    v_cndmask_b32 v127, v21, v18, s[74:75]
    s_branch .Lmain_kernel_maskr_31
.Lmain_kernel_mask_32:
    v_subrev_u32 v6, 64, v17
    v_add_u32 v7, 64, v6
    v_cmp_gt_i32 s[52:53], 0, v6
    v_cmp_gt_i32 s[54:55], 1, v6
    v_cmp_gt_i32 s[72:73], 2, v6
    v_cmp_gt_i32 s[74:75], 3, v6
    v_cndmask_b32 v112, v20, v18, s[52:53]
    v_cndmask_b32 v113, v20, v18, s[54:55]
    v_cndmask_b32 v114, v20, v18, s[72:73]
    v_cndmask_b32 v115, v20, v18, s[74:75]
    v_cmp_gt_i32 s[52:53], 16, v6
    v_cmp_gt_i32 s[54:55], 17, v6
    v_cmp_gt_i32 s[72:73], 18, v6
    v_cmp_gt_i32 s[74:75], 19, v6
    v_cndmask_b32 v116, v20, v18, s[52:53]
    v_cndmask_b32 v117, v20, v18, s[54:55]
    v_cndmask_b32 v118, v20, v18, s[72:73]
    v_cndmask_b32 v119, v20, v18, s[74:75]
    v_cmp_gt_i32 s[52:53], 0, v7
    v_cmp_gt_i32 s[54:55], 1, v7
    v_cmp_gt_i32 s[72:73], 2, v7
    v_cmp_gt_i32 s[74:75], 3, v7
    v_cndmask_b32 v120, v21, v18, s[52:53]
    v_cndmask_b32 v121, v21, v18, s[54:55]
    v_cndmask_b32 v122, v21, v18, s[72:73]
    v_cndmask_b32 v123, v21, v18, s[74:75]
    v_cmp_gt_i32 s[52:53], 16, v7
    v_cmp_gt_i32 s[54:55], 17, v7
    v_cmp_gt_i32 s[72:73], 18, v7
    v_cmp_gt_i32 s[74:75], 19, v7
    v_cndmask_b32 v124, v21, v18, s[52:53]
    v_cndmask_b32 v125, v21, v18, s[54:55]
    v_cndmask_b32 v126, v21, v18, s[72:73]
    v_cndmask_b32 v127, v21, v18, s[74:75]
    s_branch .Lmain_kernel_maskr_33
.Lmain_kernel_rare_34:
    v_max3_f32 v2, v80, v81, v82
    v_max3_f32 v3, v88, v89, v90
    v_max3_f32 v2, v2, v83, v84
    v_max3_f32 v3, v3, v91, v92
    v_max3_f32 v2, v2, v85, v86
    v_max3_f32 v3, v3, v93, v94
    v_max_f32 v2, v2, v87
    v_max_f32 v3, v3, v95
    s_nop 1
    v_permlane32_swap_b32 v2, v3
    v_max_f32 v2, v2, v3
    v_mov_b32 v4, v2
    s_nop 1
    v_permlane16_swap_b32 v2, v4
    v_max_f32 v2, v2, v4
    v_mov_b32 v3, v2
    s_nop 1
    v_permlane32_swap_b32 v2, v3
    v_max_f32 v2, 0, v2
    v_exp_f32 v4, -v2
    v_sub_f32 v20, v20, v2
    v_mul_f32 v22, v22, v4
    v_max_f32 v3, 0, v3
    v_exp_f32 v5, -v3
    v_sub_f32 v21, v21, v3
    v_mul_f32 v23, v23, v5
    v_mul_f32 v32, v32, v4
    v_mul_f32 v33, v33, v4
    v_mul_f32 v34, v34, v4
    v_mul_f32 v35, v35, v4
    v_mul_f32 v36, v36, v4
    v_mul_f32 v37, v37, v4
    v_mul_f32 v38, v38, v4
    v_mul_f32 v39, v39, v4
    v_mul_f32 v40, v40, v5
    v_mul_f32 v41, v41, v5
    v_mul_f32 v42, v42, v5
    v_mul_f32 v43, v43, v5
    v_mul_f32 v44, v44, v5
    v_mul_f32 v45, v45, v5
    v_mul_f32 v46, v46, v5
    v_mul_f32 v47, v47, v5
    v_mul_f32 v96, v96, v4
    v_mul_f32 v97, v97, v4
    v_mul_f32 v98, v98, v4
    v_mul_f32 v99, v99, v4
    v_mul_f32 v100, v100, v4
    v_mul_f32 v101, v101, v4
    v_mul_f32 v102, v102, v4
    v_mul_f32 v103, v103, v4
    v_mul_f32 v104, v104, v5
    v_mul_f32 v105, v105, v5
    v_mul_f32 v106, v106, v5
    v_mul_f32 v107, v107, v5
    v_mul_f32 v108, v108, v5
    v_mul_f32 v109, v109, v5
    v_mul_f32 v110, v110, v5
    v_mul_f32 v111, v111, v5
    v_mul_f32 v160, v160, v4
    v_mul_f32 v161, v161, v4
    v_mul_f32 v162, v162, v4
    v_mul_f32 v163, v163, v4
    v_mul_f32 v164, v164, v4
    v_mul_f32 v165, v165, v4
    v_mul_f32 v166, v166, v4
    v_mul_f32 v167, v167, v4
    v_mul_f32 v168, v168, v5
    v_mul_f32 v169, v169, v5
    v_mul_f32 v170, v170, v5
    v_mul_f32 v171, v171, v5
    v_mul_f32 v172, v172, v5
    v_mul_f32 v173, v173, v5
    v_mul_f32 v174, v174, v5
    v_mul_f32 v175, v175, v5
    v_mul_f32 v176, v176, v4
    v_mul_f32 v177, v177, v4
    v_mul_f32 v178, v178, v4
    v_mul_f32 v179, v179, v4
    v_mul_f32 v180, v180, v4
    v_mul_f32 v181, v181, v4
    v_mul_f32 v182, v182, v4
    v_mul_f32 v183, v183, v4
    v_mul_f32 v184, v184, v5
    v_mul_f32 v185, v185, v5
    v_mul_f32 v186, v186, v5
    v_mul_f32 v187, v187, v5
    v_mul_f32 v188, v188, v5
    v_mul_f32 v189, v189, v5
    v_mul_f32 v190, v190, v5
    v_mul_f32 v191, v191, v5
    v_mul_f32 v192, v192, v4
    v_mul_f32 v193, v193, v4
    v_mul_f32 v194, v194, v4
    v_mul_f32 v195, v195, v4
    v_mul_f32 v196, v196, v4
    v_mul_f32 v197, v197, v4
    v_mul_f32 v198, v198, v4
    v_mul_f32 v199, v199, v4
    v_mul_f32 v200, v200, v5
    v_mul_f32 v201, v201, v5
    v_mul_f32 v202, v202, v5
    v_mul_f32 v203, v203, v5
    v_mul_f32 v204, v204, v5
    v_mul_f32 v205, v205, v5
    v_mul_f32 v206, v206, v5
    v_mul_f32 v207, v207, v5
    v_mul_f32 v208, v208, v4
    v_mul_f32 v209, v209, v4
    v_mul_f32 v210, v210, v4
    v_mul_f32 v211, v211, v4
    v_mul_f32 v212, v212, v4
    v_mul_f32 v213, v213, v4
    v_mul_f32 v214, v214, v4
    v_mul_f32 v215, v215, v4
    v_mul_f32 v216, v216, v5
    v_mul_f32 v217, v217, v5
    v_mul_f32 v218, v218, v5
    v_mul_f32 v219, v219, v5
    v_mul_f32 v220, v220, v5
    v_mul_f32 v221, v221, v5
    v_mul_f32 v222, v222, v5
    v_mul_f32 v223, v223, v5
    v_mul_f32 v224, v224, v4
    v_mul_f32 v225, v225, v4
    v_mul_f32 v226, v226, v4
    v_mul_f32 v227, v227, v4
    v_mul_f32 v228, v228, v4
    v_mul_f32 v229, v229, v4
    v_mul_f32 v230, v230, v4
    v_mul_f32 v231, v231, v4
    v_mul_f32 v232, v232, v5
    v_mul_f32 v233, v233, v5
    v_mul_f32 v234, v234, v5
    v_mul_f32 v235, v235, v5
    v_mul_f32 v236, v236, v5
    v_mul_f32 v237, v237, v5
    v_mul_f32 v238, v238, v5
    v_mul_f32 v239, v239, v5
    v_mul_f32 v240, v240, v4
    v_mul_f32 v241, v241, v4
    v_mul_f32 v242, v242, v4
    v_mul_f32 v243, v243, v4
    v_mul_f32 v244, v244, v4
    v_mul_f32 v245, v245, v4
    v_mul_f32 v246, v246, v4
    v_mul_f32 v247, v247, v4
    v_mul_f32 v248, v248, v5
    v_mul_f32 v249, v249, v5
    v_mul_f32 v250, v250, v5
    v_mul_f32 v251, v251, v5
    v_mul_f32 v252, v252, v5
    v_mul_f32 v253, v253, v5
    v_mul_f32 v254, v254, v5
    v_mul_f32 v255, v255, v5
    v_sub_f32 v112, v112, v2
    v_sub_f32 v64, v64, v2
    v_sub_f32 v113, v113, v2
    v_sub_f32 v65, v65, v2
    v_sub_f32 v114, v114, v2
    v_sub_f32 v66, v66, v2
    v_sub_f32 v115, v115, v2
    v_sub_f32 v67, v67, v2
    v_sub_f32 v116, v116, v2
    v_sub_f32 v68, v68, v2
    v_sub_f32 v117, v117, v2
    v_sub_f32 v69, v69, v2
    v_sub_f32 v118, v118, v2
    v_sub_f32 v70, v70, v2
    v_sub_f32 v119, v119, v2
    v_sub_f32 v71, v71, v2
    v_sub_f32 v120, v120, v3
    v_sub_f32 v72, v72, v3
    v_sub_f32 v121, v121, v3
    v_sub_f32 v73, v73, v3
    v_sub_f32 v122, v122, v3
    v_sub_f32 v74, v74, v3
    v_sub_f32 v123, v123, v3
    v_sub_f32 v75, v75, v3
    v_sub_f32 v124, v124, v3
    v_sub_f32 v76, v76, v3
    v_sub_f32 v125, v125, v3
    v_sub_f32 v77, v77, v3
    v_sub_f32 v126, v126, v3
    v_sub_f32 v78, v78, v3
    v_sub_f32 v127, v127, v3
    v_sub_f32 v79, v79, v3
    v_sub_f32 v48, v80, v2
    v_exp_f32 v48, v48
    v_sub_f32 v49, v81, v2
    v_exp_f32 v49, v49
    v_sub_f32 v50, v82, v2
    v_exp_f32 v50, v50
    v_add_f32 v8, v48, v49
    v_sub_f32 v51, v83, v2
    v_exp_f32 v51, v51
    v_add_f32 v8, v8, v50
    v_sub_f32 v56, v88, v3
    v_exp_f32 v56, v56
    v_add_f32 v8, v8, v51
    v_sub_f32 v57, v89, v3
    v_exp_f32 v57, v57
    v_sub_f32 v58, v90, v3
    v_exp_f32 v58, v58
    v_add_f32 v9, v56, v57
    v_sub_f32 v59, v91, v3
    v_exp_f32 v59, v59
    v_add_f32 v9, v9, v58
    v_sub_f32 v52, v84, v2
    v_exp_f32 v52, v52
    v_add_f32 v9, v9, v59
    v_sub_f32 v53, v85, v2
    v_exp_f32 v53, v53
    v_add_f32 v8, v8, v52
    v_sub_f32 v54, v86, v2
    v_exp_f32 v54, v54
    v_add_f32 v8, v8, v53
    v_sub_f32 v55, v87, v2
    v_exp_f32 v55, v55
    v_add_f32 v8, v8, v54
    v_sub_f32 v60, v92, v3
    v_exp_f32 v60, v60
    v_add_f32 v8, v8, v55
    v_sub_f32 v61, v93, v3
    v_exp_f32 v61, v61
    v_add_f32 v9, v9, v60
    v_sub_f32 v62, v94, v3
    v_exp_f32 v62, v62
    v_add_f32 v9, v9, v61
    v_sub_f32 v63, v95, v3
    v_exp_f32 v63, v63
    v_add_f32 v9, v9, v62
    v_add_f32 v9, v9, v63
    s_branch .Lmain_kernel_rarer_35
.Lmain_kernel_sd_36:
    v_mov_b32 v6, 1
    s_mov_b64 exec, 1
    buffer_store_dword v6, off, s[16:19], s3 offset:128 sc1
    s_mov_b64 exec, -1
    s_branch .Lmain_kernel_sdr_37
.Lmain_kernel_mask_38:
    v_subrev_u32 v6, 96, v17
    v_add_u32 v7, 64, v6
    v_cmp_gt_i32 s[52:53], 0, v6
    v_cmp_gt_i32 s[54:55], 1, v6
    v_cmp_gt_i32 s[72:73], 2, v6
    v_cmp_gt_i32 s[74:75], 3, v6
    v_cndmask_b32 v112, v20, v18, s[52:53]
    v_cndmask_b32 v113, v20, v18, s[54:55]
    v_cndmask_b32 v114, v20, v18, s[72:73]
    v_cndmask_b32 v115, v20, v18, s[74:75]
    v_cmp_gt_i32 s[52:53], 16, v6
    v_cmp_gt_i32 s[54:55], 17, v6
    v_cmp_gt_i32 s[72:73], 18, v6
    v_cmp_gt_i32 s[74:75], 19, v6
    v_cndmask_b32 v116, v20, v18, s[52:53]
    v_cndmask_b32 v117, v20, v18, s[54:55]
    v_cndmask_b32 v118, v20, v18, s[72:73]
    v_cndmask_b32 v119, v20, v18, s[74:75]
    v_cmp_gt_i32 s[52:53], 0, v7
    v_cmp_gt_i32 s[54:55], 1, v7
    v_cmp_gt_i32 s[72:73], 2, v7
    v_cmp_gt_i32 s[74:75], 3, v7
    v_cndmask_b32 v120, v21, v18, s[52:53]
    v_cndmask_b32 v121, v21, v18, s[54:55]
    v_cndmask_b32 v122, v21, v18, s[72:73]
    v_cndmask_b32 v123, v21, v18, s[74:75]
    v_cmp_gt_i32 s[52:53], 16, v7
    v_cmp_gt_i32 s[54:55], 17, v7
    v_cmp_gt_i32 s[72:73], 18, v7
    v_cmp_gt_i32 s[74:75], 19, v7
    v_cndmask_b32 v124, v21, v18, s[52:53]
    v_cndmask_b32 v125, v21, v18, s[54:55]
    v_cndmask_b32 v126, v21, v18, s[72:73]
    v_cndmask_b32 v127, v21, v18, s[74:75]
    s_xor_b32 s30, s3, 0x3c00
    buffer_load_dword v1, off, s[16:19], s30 offset:128 sc1
    s_branch .Lmain_kernel_maskr_39
.Lmain_kernel_rare_40:
    v_max3_f32 v2, v64, v65, v66
    v_max3_f32 v3, v72, v73, v74
    v_max3_f32 v2, v2, v67, v68
    v_max3_f32 v3, v3, v75, v76
    v_max3_f32 v2, v2, v69, v70
    v_max3_f32 v3, v3, v77, v78
    v_max_f32 v2, v2, v71
    v_max_f32 v3, v3, v79
    s_nop 1
    v_permlane32_swap_b32 v2, v3
    v_max_f32 v2, v2, v3
    v_mov_b32 v4, v2
    s_nop 1
    v_permlane16_swap_b32 v2, v4
    v_max_f32 v2, v2, v4
    v_mov_b32 v3, v2
    s_nop 1
    v_permlane32_swap_b32 v2, v3
    v_max_f32 v2, 0, v2
    v_exp_f32 v4, -v2
    v_sub_f32 v20, v20, v2
    v_mul_f32 v22, v22, v4
    v_max_f32 v3, 0, v3
    v_exp_f32 v5, -v3
    v_sub_f32 v21, v21, v3
    v_mul_f32 v23, v23, v5
    v_mul_f32 v32, v32, v4
    v_mul_f32 v33, v33, v4
    v_mul_f32 v34, v34, v4
    v_mul_f32 v35, v35, v4
    v_mul_f32 v36, v36, v4
    v_mul_f32 v37, v37, v4
    v_mul_f32 v38, v38, v4
    v_mul_f32 v39, v39, v4
    v_mul_f32 v40, v40, v5
    v_mul_f32 v41, v41, v5
    v_mul_f32 v42, v42, v5
    v_mul_f32 v43, v43, v5
    v_mul_f32 v44, v44, v5
    v_mul_f32 v45, v45, v5
    v_mul_f32 v46, v46, v5
    v_mul_f32 v47, v47, v5
    v_mul_f32 v96, v96, v4
    v_mul_f32 v97, v97, v4
    v_mul_f32 v98, v98, v4
    v_mul_f32 v99, v99, v4
    v_mul_f32 v100, v100, v4
    v_mul_f32 v101, v101, v4
    v_mul_f32 v102, v102, v4
    v_mul_f32 v103, v103, v4
    v_mul_f32 v104, v104, v5
    v_mul_f32 v105, v105, v5
    v_mul_f32 v106, v106, v5
    v_mul_f32 v107, v107, v5
    v_mul_f32 v108, v108, v5
    v_mul_f32 v109, v109, v5
    v_mul_f32 v110, v110, v5
    v_mul_f32 v111, v111, v5
    v_mul_f32 v160, v160, v4
    v_mul_f32 v161, v161, v4
    v_mul_f32 v162, v162, v4
    v_mul_f32 v163, v163, v4
    v_mul_f32 v164, v164, v4
    v_mul_f32 v165, v165, v4
    v_mul_f32 v166, v166, v4
    v_mul_f32 v167, v167, v4
    v_mul_f32 v168, v168, v5
    v_mul_f32 v169, v169, v5
    v_mul_f32 v170, v170, v5
    v_mul_f32 v171, v171, v5
    v_mul_f32 v172, v172, v5
    v_mul_f32 v173, v173, v5
    v_mul_f32 v174, v174, v5
    v_mul_f32 v175, v175, v5
    v_mul_f32 v176, v176, v4
    v_mul_f32 v177, v177, v4
    v_mul_f32 v178, v178, v4
    v_mul_f32 v179, v179, v4
    v_mul_f32 v180, v180, v4
    v_mul_f32 v181, v181, v4
    v_mul_f32 v182, v182, v4
    v_mul_f32 v183, v183, v4
    v_mul_f32 v184, v184, v5
    v_mul_f32 v185, v185, v5
    v_mul_f32 v186, v186, v5
    v_mul_f32 v187, v187, v5
    v_mul_f32 v188, v188, v5
    v_mul_f32 v189, v189, v5
    v_mul_f32 v190, v190, v5
    v_mul_f32 v191, v191, v5
    v_mul_f32 v192, v192, v4
    v_mul_f32 v193, v193, v4
    v_mul_f32 v194, v194, v4
    v_mul_f32 v195, v195, v4
    v_mul_f32 v196, v196, v4
    v_mul_f32 v197, v197, v4
    v_mul_f32 v198, v198, v4
    v_mul_f32 v199, v199, v4
    v_mul_f32 v200, v200, v5
    v_mul_f32 v201, v201, v5
    v_mul_f32 v202, v202, v5
    v_mul_f32 v203, v203, v5
    v_mul_f32 v204, v204, v5
    v_mul_f32 v205, v205, v5
    v_mul_f32 v206, v206, v5
    v_mul_f32 v207, v207, v5
    v_mul_f32 v208, v208, v4
    v_mul_f32 v209, v209, v4
    v_mul_f32 v210, v210, v4
    v_mul_f32 v211, v211, v4
    v_mul_f32 v212, v212, v4
    v_mul_f32 v213, v213, v4
    v_mul_f32 v214, v214, v4
    v_mul_f32 v215, v215, v4
    v_mul_f32 v216, v216, v5
    v_mul_f32 v217, v217, v5
    v_mul_f32 v218, v218, v5
    v_mul_f32 v219, v219, v5
    v_mul_f32 v220, v220, v5
    v_mul_f32 v221, v221, v5
    v_mul_f32 v222, v222, v5
    v_mul_f32 v223, v223, v5
    v_mul_f32 v224, v224, v4
    v_mul_f32 v225, v225, v4
    v_mul_f32 v226, v226, v4
    v_mul_f32 v227, v227, v4
    v_mul_f32 v228, v228, v4
    v_mul_f32 v229, v229, v4
    v_mul_f32 v230, v230, v4
    v_mul_f32 v231, v231, v4
    v_mul_f32 v232, v232, v5
    v_mul_f32 v233, v233, v5
    v_mul_f32 v234, v234, v5
    v_mul_f32 v235, v235, v5
    v_mul_f32 v236, v236, v5
    v_mul_f32 v237, v237, v5
    v_mul_f32 v238, v238, v5
    v_mul_f32 v239, v239, v5
    v_mul_f32 v240, v240, v4
    v_mul_f32 v241, v241, v4
    v_mul_f32 v242, v242, v4
    v_mul_f32 v243, v243, v4
    v_mul_f32 v244, v244, v4
    v_mul_f32 v245, v245, v4
    v_mul_f32 v246, v246, v4
    v_mul_f32 v247, v247, v4
    v_mul_f32 v248, v248, v5
    v_mul_f32 v249, v249, v5
    v_mul_f32 v250, v250, v5
    v_mul_f32 v251, v251, v5
    v_mul_f32 v252, v252, v5
    v_mul_f32 v253, v253, v5
    v_mul_f32 v254, v254, v5
    v_mul_f32 v255, v255, v5
    v_sub_f32 v112, v112, v2
    v_sub_f32 v80, v80, v2
    v_sub_f32 v113, v113, v2
    v_sub_f32 v81, v81, v2
    v_sub_f32 v114, v114, v2
    v_sub_f32 v82, v82, v2
    v_sub_f32 v115, v115, v2
    v_sub_f32 v83, v83, v2
    v_sub_f32 v116, v116, v2
    v_sub_f32 v84, v84, v2
    v_sub_f32 v117, v117, v2
    v_sub_f32 v85, v85, v2
    v_sub_f32 v118, v118, v2
    v_sub_f32 v86, v86, v2
    v_sub_f32 v119, v119, v2
    v_sub_f32 v87, v87, v2
    v_sub_f32 v120, v120, v3
    v_sub_f32 v88, v88, v3
    v_sub_f32 v121, v121, v3
    v_sub_f32 v89, v89, v3
    v_sub_f32 v122, v122, v3
    v_sub_f32 v90, v90, v3
    v_sub_f32 v123, v123, v3
    v_sub_f32 v91, v91, v3
    v_sub_f32 v124, v124, v3
    v_sub_f32 v92, v92, v3
    v_sub_f32 v125, v125, v3
    v_sub_f32 v93, v93, v3
    v_sub_f32 v126, v126, v3
    v_sub_f32 v94, v94, v3
    v_sub_f32 v127, v127, v3
    v_sub_f32 v95, v95, v3
    v_sub_f32 v48, v64, v2
    v_exp_f32 v48, v48
    v_sub_f32 v49, v65, v2
    v_exp_f32 v49, v49
    v_sub_f32 v50, v66, v2
    v_exp_f32 v50, v50
    v_add_f32 v8, v48, v49
    v_sub_f32 v51, v67, v2
    v_exp_f32 v51, v51
    v_add_f32 v8, v8, v50
    v_sub_f32 v56, v72, v3
    v_exp_f32 v56, v56
    v_add_f32 v8, v8, v51
    v_sub_f32 v57, v73, v3
    v_exp_f32 v57, v57
    v_sub_f32 v58, v74, v3
    v_exp_f32 v58, v58
    v_add_f32 v9, v56, v57
    v_sub_f32 v59, v75, v3
    v_exp_f32 v59, v59
    v_add_f32 v9, v9, v58
    v_sub_f32 v52, v68, v2
    v_exp_f32 v52, v52
    v_add_f32 v9, v9, v59
    v_sub_f32 v53, v69, v2
    v_exp_f32 v53, v53
    v_add_f32 v8, v8, v52
    v_sub_f32 v54, v70, v2
    v_exp_f32 v54, v54
    v_add_f32 v8, v8, v53
    v_sub_f32 v55, v71, v2
    v_exp_f32 v55, v55
    v_add_f32 v8, v8, v54
    v_sub_f32 v60, v76, v3
    v_exp_f32 v60, v60
    v_add_f32 v8, v8, v55
    v_sub_f32 v61, v77, v3
    v_exp_f32 v61, v61
    v_add_f32 v9, v9, v60
    v_sub_f32 v62, v78, v3
    v_exp_f32 v62, v62
    v_add_f32 v9, v9, v61
    v_sub_f32 v63, v79, v3
    v_exp_f32 v63, v63
    v_add_f32 v9, v9, v62
    v_add_f32 v9, v9, v63
    s_branch .Lmain_kernel_rarer_41
.Lmain_kernel_disp_50:
    s_cmp_eq_u32 s26, 1
    s_cbranch_scc1 .Lmain_kernel_it_45
    s_cmp_eq_u32 s26, 2
    s_cbranch_scc1 .Lmain_kernel_it_46
    s_cmp_eq_u32 s26, 3
    s_cbranch_scc1 .Lmain_kernel_it_47
    s_cmp_eq_u32 s26, 4
    s_cbranch_scc1 .Lmain_kernel_it_48
    s_branch .Lmain_kernel_it_49
.Lmain_kernel_mask_52:
    v_subrev_u32 v6, 0, v17
    v_add_u32 v7, 64, v6
    v_cmp_gt_i32 s[52:53], 0, v6
    v_cmp_gt_i32 s[54:55], 1, v6
    v_cmp_gt_i32 s[72:73], 2, v6
    v_cmp_gt_i32 s[74:75], 3, v6
    v_cndmask_b32 v112, v20, v18, s[52:53]
    v_cndmask_b32 v113, v20, v18, s[54:55]
    v_cndmask_b32 v114, v20, v18, s[72:73]
    v_cndmask_b32 v115, v20, v18, s[74:75]
    v_cmp_gt_i32 s[52:53], 16, v6
    v_cmp_gt_i32 s[54:55], 17, v6
    v_cmp_gt_i32 s[72:73], 18, v6
    v_cmp_gt_i32 s[74:75], 19, v6
    v_cndmask_b32 v116, v20, v18, s[52:53]
    v_cndmask_b32 v117, v20, v18, s[54:55]
    v_cndmask_b32 v118, v20, v18, s[72:73]
    v_cndmask_b32 v119, v20, v18, s[74:75]
    v_cmp_gt_i32 s[52:53], 0, v7
    v_cmp_gt_i32 s[54:55], 1, v7
    v_cmp_gt_i32 s[72:73], 2, v7
    v_cmp_gt_i32 s[74:75], 3, v7
    v_cndmask_b32 v120, v21, v18, s[52:53]
    v_cndmask_b32 v121, v21, v18, s[54:55]
    v_cndmask_b32 v122, v21, v18, s[72:73]
    v_cndmask_b32 v123, v21, v18, s[74:75]
    v_cmp_gt_i32 s[52:53], 16, v7
    v_cmp_gt_i32 s[54:55], 17, v7
    v_cmp_gt_i32 s[72:73], 18, v7
    v_cmp_gt_i32 s[74:75], 19, v7
    v_cndmask_b32 v124, v21, v18, s[52:53]
    v_cndmask_b32 v125, v21, v18, s[54:55]
    v_cndmask_b32 v126, v21, v18, s[72:73]
    v_cndmask_b32 v127, v21, v18, s[74:75]
    s_getpc_b64 s[12:13]
.Lmain_kernel_pc_51:
    s_sub_u32 s12, s12, .Lmain_kernel_pc_51-main_kernel
    s_subb_u32 s13, s13, 0
    s_and_b32 s13, s13, 0xffff
    s_mov_b32 s14, .Ltext_end-main_kernel
    s_mov_b32 s15, 0x00020000
    s_and_b32 s30, s2, 56
    s_lshl_b32 s30, s30, 12
    s_waitcnt vmcnt(15)
    v_lshlrev_b32 v1, 3, v14
    s_lshl_b32 s31, s20, 13
    v_add_u32 v1, s31, v1
    buffer_load_dword v1, v1, s[12:15], s30 offen
    s_branch .Lmain_kernel_maskr_53
.Lmain_kernel_rare_54:
    v_max3_f32 v2, v80, v81, v82
    v_max3_f32 v3, v88, v89, v90
    v_max3_f32 v2, v2, v83, v84
    v_max3_f32 v3, v3, v91, v92
    v_max3_f32 v2, v2, v85, v86
    v_max3_f32 v3, v3, v93, v94
    v_max_f32 v2, v2, v87
    v_max_f32 v3, v3, v95
    s_nop 1
    v_permlane32_swap_b32 v2, v3
    v_max_f32 v2, v2, v3
    v_mov_b32 v4, v2
    s_nop 1
    v_permlane16_swap_b32 v2, v4
    v_max_f32 v2, v2, v4
    v_mov_b32 v3, v2
    s_nop 1
    v_permlane32_swap_b32 v2, v3
    v_max_f32 v2, 0, v2
    v_exp_f32 v4, -v2
    v_sub_f32 v20, v20, v2
    v_mul_f32 v22, v22, v4
    v_max_f32 v3, 0, v3
    v_exp_f32 v5, -v3
    v_sub_f32 v21, v21, v3
    v_mul_f32 v23, v23, v5
    v_mul_f32 v32, v32, v4
    v_mul_f32 v33, v33, v4
    v_mul_f32 v34, v34, v4
    v_mul_f32 v35, v35, v4
    v_mul_f32 v36, v36, v4
    v_mul_f32 v37, v37, v4
    v_mul_f32 v38, v38, v4
    v_mul_f32 v39, v39, v4
    v_mul_f32 v40, v40, v5
    v_mul_f32 v41, v41, v5
    v_mul_f32 v42, v42, v5
    v_mul_f32 v43, v43, v5
    v_mul_f32 v44, v44, v5
    v_mul_f32 v45, v45, v5
    v_mul_f32 v46, v46, v5
    v_mul_f32 v47, v47, v5
    v_mul_f32 v96, v96, v4
    v_mul_f32 v97, v97, v4
    v_mul_f32 v98, v98, v4
    v_mul_f32 v99, v99, v4
    v_mul_f32 v100, v100, v4
    v_mul_f32 v101, v101, v4
    v_mul_f32 v102, v102, v4
    v_mul_f32 v103, v103, v4
    v_mul_f32 v104, v104, v5
    v_mul_f32 v105, v105, v5
    v_mul_f32 v106, v106, v5
    v_mul_f32 v107, v107, v5
    v_mul_f32 v108, v108, v5
    v_mul_f32 v109, v109, v5
    v_mul_f32 v110, v110, v5
    v_mul_f32 v111, v111, v5
    v_mul_f32 v160, v160, v4
    v_mul_f32 v161, v161, v4
    v_mul_f32 v162, v162, v4
    v_mul_f32 v163, v163, v4
    v_mul_f32 v164, v164, v4
    v_mul_f32 v165, v165, v4
    v_mul_f32 v166, v166, v4
    v_mul_f32 v167, v167, v4
    v_mul_f32 v168, v168, v5
    v_mul_f32 v169, v169, v5
    v_mul_f32 v170, v170, v5
    v_mul_f32 v171, v171, v5
    v_mul_f32 v172, v172, v5
    v_mul_f32 v173, v173, v5
    v_mul_f32 v174, v174, v5
    v_mul_f32 v175, v175, v5
    v_mul_f32 v176, v176, v4
    v_mul_f32 v177, v177, v4
    v_mul_f32 v178, v178, v4
    v_mul_f32 v179, v179, v4
    v_mul_f32 v180, v180, v4
    v_mul_f32 v181, v181, v4
    v_mul_f32 v182, v182, v4
    v_mul_f32 v183, v183, v4
    v_mul_f32 v184, v184, v5
    v_mul_f32 v185, v185, v5
    v_mul_f32 v186, v186, v5
    v_mul_f32 v187, v187, v5
    v_mul_f32 v188, v188, v5
    v_mul_f32 v189, v189, v5
    v_mul_f32 v190, v190, v5
    v_mul_f32 v191, v191, v5
    v_mul_f32 v192, v192, v4
    v_mul_f32 v193, v193, v4
    v_mul_f32 v194, v194, v4
    v_mul_f32 v195, v195, v4
    v_mul_f32 v196, v196, v4
    v_mul_f32 v197, v197, v4
    v_mul_f32 v198, v198, v4
    v_mul_f32 v199, v199, v4
    v_mul_f32 v200, v200, v5
    v_mul_f32 v201, v201, v5
    v_mul_f32 v202, v202, v5
    v_mul_f32 v203, v203, v5
    v_mul_f32 v204, v204, v5
    v_mul_f32 v205, v205, v5
    v_mul_f32 v206, v206, v5
    v_mul_f32 v207, v207, v5
    v_mul_f32 v208, v208, v4
    v_mul_f32 v209, v209, v4
    v_mul_f32 v210, v210, v4
    v_mul_f32 v211, v211, v4
    v_mul_f32 v212, v212, v4
    v_mul_f32 v213, v213, v4
    v_mul_f32 v214, v214, v4
    v_mul_f32 v215, v215, v4
    v_mul_f32 v216, v216, v5
    v_mul_f32 v217, v217, v5
    v_mul_f32 v218, v218, v5
    v_mul_f32 v219, v219, v5
    v_mul_f32 v220, v220, v5
    v_mul_f32 v221, v221, v5
    v_mul_f32 v222, v222, v5
    v_mul_f32 v223, v223, v5
    v_mul_f32 v224, v224, v4
    v_mul_f32 v225, v225, v4
    v_mul_f32 v226, v226, v4
    v_mul_f32 v227, v227, v4
    v_mul_f32 v228, v228, v4
    v_mul_f32 v229, v229, v4
    v_mul_f32 v230, v230, v4
    v_mul_f32 v231, v231, v4
    v_mul_f32 v232, v232, v5
    v_mul_f32 v233, v233, v5
    v_mul_f32 v234, v234, v5
    v_mul_f32 v235, v235, v5
    v_mul_f32 v236, v236, v5
    v_mul_f32 v237, v237, v5
    v_mul_f32 v238, v238, v5
    v_mul_f32 v239, v239, v5
    v_mul_f32 v240, v240, v4
    v_mul_f32 v241, v241, v4
    v_mul_f32 v242, v242, v4
    v_mul_f32 v243, v243, v4
    v_mul_f32 v244, v244, v4
    v_mul_f32 v245, v245, v4
    v_mul_f32 v246, v246, v4
    v_mul_f32 v247, v247, v4
    v_mul_f32 v248, v248, v5
    v_mul_f32 v249, v249, v5
    v_mul_f32 v250, v250, v5
    v_mul_f32 v251, v251, v5
    v_mul_f32 v252, v252, v5
    v_mul_f32 v253, v253, v5
    v_mul_f32 v254, v254, v5
    v_mul_f32 v255, v255, v5
    v_sub_f32 v112, v112, v2
    v_sub_f32 v64, v64, v2
    v_sub_f32 v113, v113, v2
    v_sub_f32 v65, v65, v2
    v_sub_f32 v114, v114, v2
    v_sub_f32 v66, v66, v2
    v_sub_f32 v115, v115, v2
    v_sub_f32 v67, v67, v2
    v_sub_f32 v116, v116, v2
    v_sub_f32 v68, v68, v2
    v_sub_f32 v117, v117, v2
    v_sub_f32 v69, v69, v2
    v_sub_f32 v118, v118, v2
    v_sub_f32 v70, v70, v2
    v_sub_f32 v119, v119, v2
    v_sub_f32 v71, v71, v2
    v_sub_f32 v120, v120, v3
    v_sub_f32 v72, v72, v3
    v_sub_f32 v121, v121, v3
    v_sub_f32 v73, v73, v3
    v_sub_f32 v122, v122, v3
    v_sub_f32 v74, v74, v3
    v_sub_f32 v123, v123, v3
    v_sub_f32 v75, v75, v3
    v_sub_f32 v124, v124, v3
    v_sub_f32 v76, v76, v3
    v_sub_f32 v125, v125, v3
    v_sub_f32 v77, v77, v3
    v_sub_f32 v126, v126, v3
    v_sub_f32 v78, v78, v3
    v_sub_f32 v127, v127, v3
    v_sub_f32 v79, v79, v3
    v_sub_f32 v48, v80, v2
    v_exp_f32 v48, v48
    v_sub_f32 v49, v81, v2
    v_exp_f32 v49, v49
    v_sub_f32 v50, v82, v2
    v_exp_f32 v50, v50
    v_add_f32 v8, v48, v49
    v_sub_f32 v51, v83, v2
    v_exp_f32 v51, v51
    v_add_f32 v8, v8, v50
    v_sub_f32 v56, v88, v3
    v_exp_f32 v56, v56
    v_add_f32 v8, v8, v51
    v_sub_f32 v57, v89, v3
    v_exp_f32 v57, v57
    v_sub_f32 v58, v90, v3
    v_exp_f32 v58, v58
    v_add_f32 v9, v56, v57
    v_sub_f32 v59, v91, v3
    v_exp_f32 v59, v59
    v_add_f32 v9, v9, v58
    v_sub_f32 v52, v84, v2
    v_exp_f32 v52, v52
    v_add_f32 v9, v9, v59
    v_sub_f32 v53, v85, v2
    v_exp_f32 v53, v53
    v_add_f32 v8, v8, v52
    v_sub_f32 v54, v86, v2
    v_exp_f32 v54, v54
    v_add_f32 v8, v8, v53
    v_sub_f32 v55, v87, v2
    v_exp_f32 v55, v55
    v_add_f32 v8, v8, v54
    v_sub_f32 v60, v92, v3
    v_exp_f32 v60, v60
    v_add_f32 v8, v8, v55
    v_sub_f32 v61, v93, v3
    v_exp_f32 v61, v61
    v_add_f32 v9, v9, v60
    v_sub_f32 v62, v94, v3
    v_exp_f32 v62, v62
    v_add_f32 v9, v9, v61
    v_sub_f32 v63, v95, v3
    v_exp_f32 v63, v63
    v_add_f32 v9, v9, v62
    v_add_f32 v9, v9, v63
    s_waitcnt vmcnt(0)
    s_cmp_eq_u32 s26, 1
    s_cbranch_scc1 .Lmain_kernel_rarer_55
    s_cmp_eq_u32 s26, 2
    s_cbranch_scc1 .Lmain_kernel_rarer_72
    s_cmp_eq_u32 s26, 3
    s_cbranch_scc1 .Lmain_kernel_rarer_85
    s_cmp_eq_u32 s26, 4
    s_cbranch_scc1 .Lmain_kernel_rarer_101
    s_cmp_eq_u32 s26, 5
    s_cbranch_scc1 .Lmain_kernel_rarer_114
    s_cmp_eq_u32 s26, 6
    s_cbranch_scc1 .Lmain_kernel_rarer_127
    s_branch .Lmain_kernel_rarer_140
.Lmain_kernel_mask_57:
    v_subrev_u32 v6, 32, v17
    v_add_u32 v7, 64, v6
    v_cmp_gt_i32 s[52:53], 0, v6
    v_cmp_gt_i32 s[54:55], 1, v6
    v_cmp_gt_i32 s[72:73], 2, v6
    v_cmp_gt_i32 s[74:75], 3, v6
    v_cndmask_b32 v112, v20, v18, s[52:53]
    v_cndmask_b32 v113, v20, v18, s[54:55]
    v_cndmask_b32 v114, v20, v18, s[72:73]
    v_cndmask_b32 v115, v20, v18, s[74:75]
    v_cmp_gt_i32 s[52:53], 16, v6
    v_cmp_gt_i32 s[54:55], 17, v6
    v_cmp_gt_i32 s[72:73], 18, v6
    v_cmp_gt_i32 s[74:75], 19, v6
    v_cndmask_b32 v116, v20, v18, s[52:53]
    v_cndmask_b32 v117, v20, v18, s[54:55]
    v_cndmask_b32 v118, v20, v18, s[72:73]
    v_cndmask_b32 v119, v20, v18, s[74:75]
    v_cmp_gt_i32 s[52:53], 0, v7
    v_cmp_gt_i32 s[54:55], 1, v7
    v_cmp_gt_i32 s[72:73], 2, v7
    v_cmp_gt_i32 s[74:75], 3, v7
    v_cndmask_b32 v120, v21, v18, s[52:53]
    v_cndmask_b32 v121, v21, v18, s[54:55]
    v_cndmask_b32 v122, v21, v18, s[72:73]
    v_cndmask_b32 v123, v21, v18, s[74:75]
    v_cmp_gt_i32 s[52:53], 16, v7
    v_cmp_gt_i32 s[54:55], 17, v7
    v_cmp_gt_i32 s[72:73], 18, v7
    v_cmp_gt_i32 s[74:75], 19, v7
    v_cndmask_b32 v124, v21, v18, s[52:53]
    v_cndmask_b32 v125, v21, v18, s[54:55]
    v_cndmask_b32 v126, v21, v18, s[72:73]
    v_cndmask_b32 v127, v21, v18, s[74:75]
    s_branch .Lmain_kernel_maskr_58
.Lmain_kernel_rare_59:
    v_max3_f32 v2, v64, v65, v66
    v_max3_f32 v3, v72, v73, v74
    v_max3_f32 v2, v2, v67, v68
    v_max3_f32 v3, v3, v75, v76
    v_max3_f32 v2, v2, v69, v70
    v_max3_f32 v3, v3, v77, v78
    v_max_f32 v2, v2, v71
    v_max_f32 v3, v3, v79
    s_nop 1
    v_permlane32_swap_b32 v2, v3
    v_max_f32 v2, v2, v3
    v_mov_b32 v4, v2
    s_nop 1
    v_permlane16_swap_b32 v2, v4
    v_max_f32 v2, v2, v4
    v_mov_b32 v3, v2
    s_nop 1
    v_permlane32_swap_b32 v2, v3
    v_max_f32 v2, 0, v2
    v_exp_f32 v4, -v2
    v_sub_f32 v20, v20, v2
    v_mul_f32 v22, v22, v4
    v_max_f32 v3, 0, v3
    v_exp_f32 v5, -v3
    v_sub_f32 v21, v21, v3
    v_mul_f32 v23, v23, v5
    v_mul_f32 v32, v32, v4
    v_mul_f32 v33, v33, v4
    v_mul_f32 v34, v34, v4
    v_mul_f32 v35, v35, v4
    v_mul_f32 v36, v36, v4
    v_mul_f32 v37, v37, v4
    v_mul_f32 v38, v38, v4
    v_mul_f32 v39, v39, v4
    v_mul_f32 v40, v40, v5
    v_mul_f32 v41, v41, v5
    v_mul_f32 v42, v42, v5
    v_mul_f32 v43, v43, v5
    v_mul_f32 v44, v44, v5
    v_mul_f32 v45, v45, v5
    v_mul_f32 v46, v46, v5
    v_mul_f32 v47, v47, v5
    v_mul_f32 v96, v96, v4
    v_mul_f32 v97, v97, v4
    v_mul_f32 v98, v98, v4
    v_mul_f32 v99, v99, v4
    v_mul_f32 v100, v100, v4
    v_mul_f32 v101, v101, v4
    v_mul_f32 v102, v102, v4
    v_mul_f32 v103, v103, v4
    v_mul_f32 v104, v104, v5
    v_mul_f32 v105, v105, v5
    v_mul_f32 v106, v106, v5
    v_mul_f32 v107, v107, v5
    v_mul_f32 v108, v108, v5
    v_mul_f32 v109, v109, v5
    v_mul_f32 v110, v110, v5
    v_mul_f32 v111, v111, v5
    v_mul_f32 v160, v160, v4
    v_mul_f32 v161, v161, v4
    v_mul_f32 v162, v162, v4
    v_mul_f32 v163, v163, v4
    v_mul_f32 v164, v164, v4
    v_mul_f32 v165, v165, v4
    v_mul_f32 v166, v166, v4
    v_mul_f32 v167, v167, v4
    v_mul_f32 v168, v168, v5
    v_mul_f32 v169, v169, v5
    v_mul_f32 v170, v170, v5
    v_mul_f32 v171, v171, v5
    v_mul_f32 v172, v172, v5
    v_mul_f32 v173, v173, v5
    v_mul_f32 v174, v174, v5
    v_mul_f32 v175, v175, v5
    v_mul_f32 v176, v176, v4
    v_mul_f32 v177, v177, v4
    v_mul_f32 v178, v178, v4
    v_mul_f32 v179, v179, v4
    v_mul_f32 v180, v180, v4
    v_mul_f32 v181, v181, v4
    v_mul_f32 v182, v182, v4
    v_mul_f32 v183, v183, v4
    v_mul_f32 v184, v184, v5
    v_mul_f32 v185, v185, v5
    v_mul_f32 v186, v186, v5
    v_mul_f32 v187, v187, v5
    v_mul_f32 v188, v188, v5
    v_mul_f32 v189, v189, v5
    v_mul_f32 v190, v190, v5
    v_mul_f32 v191, v191, v5
    v_mul_f32 v192, v192, v4
    v_mul_f32 v193, v193, v4
    v_mul_f32 v194, v194, v4
    v_mul_f32 v195, v195, v4
    v_mul_f32 v196, v196, v4
    v_mul_f32 v197, v197, v4
    v_mul_f32 v198, v198, v4
    v_mul_f32 v199, v199, v4
    v_mul_f32 v200, v200, v5
    v_mul_f32 v201, v201, v5
    v_mul_f32 v202, v202, v5
    v_mul_f32 v203, v203, v5
    v_mul_f32 v204, v204, v5
    v_mul_f32 v205, v205, v5
    v_mul_f32 v206, v206, v5
    v_mul_f32 v207, v207, v5
    v_mul_f32 v208, v208, v4
    v_mul_f32 v209, v209, v4
    v_mul_f32 v210, v210, v4
    v_mul_f32 v211, v211, v4
    v_mul_f32 v212, v212, v4
    v_mul_f32 v213, v213, v4
    v_mul_f32 v214, v214, v4
    v_mul_f32 v215, v215, v4
    v_mul_f32 v216, v216, v5
    v_mul_f32 v217, v217, v5
    v_mul_f32 v218, v218, v5
    v_mul_f32 v219, v219, v5
    v_mul_f32 v220, v220, v5
    v_mul_f32 v221, v221, v5
    v_mul_f32 v222, v222, v5
    v_mul_f32 v223, v223, v5
    v_mul_f32 v224, v224, v4
    v_mul_f32 v225, v225, v4
    v_mul_f32 v226, v226, v4
    v_mul_f32 v227, v227, v4
    v_mul_f32 v228, v228, v4
    v_mul_f32 v229, v229, v4
    v_mul_f32 v230, v230, v4
    v_mul_f32 v231, v231, v4
    v_mul_f32 v232, v232, v5
    v_mul_f32 v233, v233, v5
    v_mul_f32 v234, v234, v5
    v_mul_f32 v235, v235, v5
    v_mul_f32 v236, v236, v5
    v_mul_f32 v237, v237, v5
    v_mul_f32 v238, v238, v5
    v_mul_f32 v239, v239, v5
    v_mul_f32 v240, v240, v4
    v_mul_f32 v241, v241, v4
    v_mul_f32 v242, v242, v4
    v_mul_f32 v243, v243, v4
    v_mul_f32 v244, v244, v4
    v_mul_f32 v245, v245, v4
    v_mul_f32 v246, v246, v4
    v_mul_f32 v247, v247, v4
    v_mul_f32 v248, v248, v5
    v_mul_f32 v249, v249, v5
    v_mul_f32 v250, v250, v5
    v_mul_f32 v251, v251, v5
    v_mul_f32 v252, v252, v5
    v_mul_f32 v253, v253, v5
    v_mul_f32 v254, v254, v5
    v_mul_f32 v255, v255, v5
    v_sub_f32 v112, v112, v2
    v_sub_f32 v80, v80, v2
    v_sub_f32 v113, v113, v2
    v_sub_f32 v81, v81, v2
    v_sub_f32 v114, v114, v2
    v_sub_f32 v82, v82, v2
    v_sub_f32 v115, v115, v2
    v_sub_f32 v83, v83, v2
    v_sub_f32 v116, v116, v2
    v_sub_f32 v84, v84, v2
    v_sub_f32 v117, v117, v2
    v_sub_f32 v85, v85, v2
    v_sub_f32 v118, v118, v2
    v_sub_f32 v86, v86, v2
    v_sub_f32 v119, v119, v2
    v_sub_f32 v87, v87, v2
    v_sub_f32 v120, v120, v3
    v_sub_f32 v88, v88, v3
    v_sub_f32 v121, v121, v3
    v_sub_f32 v89, v89, v3
    v_sub_f32 v122, v122, v3
    v_sub_f32 v90, v90, v3
    v_sub_f32 v123, v123, v3
    v_sub_f32 v91, v91, v3
    v_sub_f32 v124, v124, v3
    v_sub_f32 v92, v92, v3
    v_sub_f32 v125, v125, v3
    v_sub_f32 v93, v93, v3
    v_sub_f32 v126, v126, v3
    v_sub_f32 v94, v94, v3
    v_sub_f32 v127, v127, v3
    v_sub_f32 v95, v95, v3
    v_sub_f32 v48, v64, v2
    v_exp_f32 v48, v48
    v_sub_f32 v49, v65, v2
    v_exp_f32 v49, v49
    v_sub_f32 v50, v66, v2
    v_exp_f32 v50, v50
    v_add_f32 v8, v48, v49
    v_sub_f32 v51, v67, v2
    v_exp_f32 v51, v51
    v_add_f32 v8, v8, v50
    v_sub_f32 v56, v72, v3
    v_exp_f32 v56, v56
    v_add_f32 v8, v8, v51
    v_sub_f32 v57, v73, v3
    v_exp_f32 v57, v57
    v_sub_f32 v58, v74, v3
    v_exp_f32 v58, v58
    v_add_f32 v9, v56, v57
    v_sub_f32 v59, v75, v3
    v_exp_f32 v59, v59
    v_add_f32 v9, v9, v58
    v_sub_f32 v52, v68, v2
    v_exp_f32 v52, v52
    v_add_f32 v9, v9, v59
    v_sub_f32 v53, v69, v2
    v_exp_f32 v53, v53
    v_add_f32 v8, v8, v52
    v_sub_f32 v54, v70, v2
    v_exp_f32 v54, v54
    v_add_f32 v8, v8, v53
    v_sub_f32 v55, v71, v2
    v_exp_f32 v55, v55
    v_add_f32 v8, v8, v54
    v_sub_f32 v60, v76, v3
    v_exp_f32 v60, v60
    v_add_f32 v8, v8, v55
    v_sub_f32 v61, v77, v3
    v_exp_f32 v61, v61
    v_add_f32 v9, v9, v60
    v_sub_f32 v62, v78, v3
    v_exp_f32 v62, v62
    v_add_f32 v9, v9, v61
    v_sub_f32 v63, v79, v3
    v_exp_f32 v63, v63
    v_add_f32 v9, v9, v62
    v_add_f32 v9, v9, v63
    s_waitcnt vmcnt(0)
    s_cmp_eq_u32 s26, 1
    s_cbranch_scc1 .Lmain_kernel_rarer_60
    s_cmp_eq_u32 s26, 2
    s_cbranch_scc1 .Lmain_kernel_rarer_75
    s_cmp_eq_u32 s26, 3
    s_cbranch_scc1 .Lmain_kernel_rarer_88
    s_cmp_eq_u32 s26, 4
    s_cbranch_scc1 .Lmain_kernel_rarer_104
    s_cmp_eq_u32 s26, 5
    s_cbranch_scc1 .Lmain_kernel_rarer_117
    s_cmp_eq_u32 s26, 6
    s_cbranch_scc1 .Lmain_kernel_rarer_130
    s_branch .Lmain_kernel_rarer_143
.Lmain_kernel_mask_61:
    v_subrev_u32 v6, 64, v17
    v_add_u32 v7, 64, v6
    v_cmp_gt_i32 s[52:53], 0, v6
    v_cmp_gt_i32 s[54:55], 1, v6
    v_cmp_gt_i32 s[72:73], 2, v6
    v_cmp_gt_i32 s[74:75], 3, v6
    v_cndmask_b32 v112, v20, v18, s[52:53]
    v_cndmask_b32 v113, v20, v18, s[54:55]
    v_cndmask_b32 v114, v20, v18, s[72:73]
    v_cndmask_b32 v115, v20, v18, s[74:75]
    v_cmp_gt_i32 s[52:53], 16, v6
    v_cmp_gt_i32 s[54:55], 17, v6
    v_cmp_gt_i32 s[72:73], 18, v6
    v_cmp_gt_i32 s[74:75], 19, v6
    v_cndmask_b32 v116, v20, v18, s[52:53]
    v_cndmask_b32 v117, v20, v18, s[54:55]
    v_cndmask_b32 v118, v20, v18, s[72:73]
    v_cndmask_b32 v119, v20, v18, s[74:75]
    v_cmp_gt_i32 s[52:53], 0, v7
    v_cmp_gt_i32 s[54:55], 1, v7
    v_cmp_gt_i32 s[72:73], 2, v7
    v_cmp_gt_i32 s[74:75], 3, v7
    v_cndmask_b32 v120, v21, v18, s[52:53]
    v_cndmask_b32 v121, v21, v18, s[54:55]
    v_cndmask_b32 v122, v21, v18, s[72:73]
    v_cndmask_b32 v123, v21, v18, s[74:75]
    v_cmp_gt_i32 s[52:53], 16, v7
    v_cmp_gt_i32 s[54:55], 17, v7
    v_cmp_gt_i32 s[72:73], 18, v7
    v_cmp_gt_i32 s[74:75], 19, v7
    v_cndmask_b32 v124, v21, v18, s[52:53]
    v_cndmask_b32 v125, v21, v18, s[54:55]
    v_cndmask_b32 v126, v21, v18, s[72:73]
    v_cndmask_b32 v127, v21, v18, s[74:75]
    s_branch .Lmain_kernel_maskr_62
.Lmain_kernel_rare_63:
    v_max3_f32 v2, v80, v81, v82
    v_max3_f32 v3, v88, v89, v90
    v_max3_f32 v2, v2, v83, v84
    v_max3_f32 v3, v3, v91, v92
    v_max3_f32 v2, v2, v85, v86
    v_max3_f32 v3, v3, v93, v94
    v_max_f32 v2, v2, v87
    v_max_f32 v3, v3, v95
    s_nop 1
    v_permlane32_swap_b32 v2, v3
    v_max_f32 v2, v2, v3
    v_mov_b32 v4, v2
    s_nop 1
    v_permlane16_swap_b32 v2, v4
    v_max_f32 v2, v2, v4
    v_mov_b32 v3, v2
    s_nop 1
    v_permlane32_swap_b32 v2, v3
    v_max_f32 v2, 0, v2
    v_exp_f32 v4, -v2
    v_sub_f32 v20, v20, v2
    v_mul_f32 v22, v22, v4
    v_max_f32 v3, 0, v3
    v_exp_f32 v5, -v3
    v_sub_f32 v21, v21, v3
    v_mul_f32 v23, v23, v5
    v_mul_f32 v32, v32, v4
    v_mul_f32 v33, v33, v4
    v_mul_f32 v34, v34, v4
    v_mul_f32 v35, v35, v4
    v_mul_f32 v36, v36, v4
    v_mul_f32 v37, v37, v4
    v_mul_f32 v38, v38, v4
    v_mul_f32 v39, v39, v4
    v_mul_f32 v40, v40, v5
    v_mul_f32 v41, v41, v5
    v_mul_f32 v42, v42, v5
    v_mul_f32 v43, v43, v5
    v_mul_f32 v44, v44, v5
    v_mul_f32 v45, v45, v5
    v_mul_f32 v46, v46, v5
    v_mul_f32 v47, v47, v5
    v_mul_f32 v96, v96, v4
    v_mul_f32 v97, v97, v4
    v_mul_f32 v98, v98, v4
    v_mul_f32 v99, v99, v4
    v_mul_f32 v100, v100, v4
    v_mul_f32 v101, v101, v4
    v_mul_f32 v102, v102, v4
    v_mul_f32 v103, v103, v4
    v_mul_f32 v104, v104, v5
    v_mul_f32 v105, v105, v5
    v_mul_f32 v106, v106, v5
    v_mul_f32 v107, v107, v5
    v_mul_f32 v108, v108, v5
    v_mul_f32 v109, v109, v5
    v_mul_f32 v110, v110, v5
    v_mul_f32 v111, v111, v5
    v_mul_f32 v160, v160, v4
    v_mul_f32 v161, v161, v4
    v_mul_f32 v162, v162, v4
    v_mul_f32 v163, v163, v4
    v_mul_f32 v164, v164, v4
    v_mul_f32 v165, v165, v4
    v_mul_f32 v166, v166, v4
    v_mul_f32 v167, v167, v4
    v_mul_f32 v168, v168, v5
    v_mul_f32 v169, v169, v5
    v_mul_f32 v170, v170, v5
    v_mul_f32 v171, v171, v5
    v_mul_f32 v172, v172, v5
    v_mul_f32 v173, v173, v5
    v_mul_f32 v174, v174, v5
    v_mul_f32 v175, v175, v5
    v_mul_f32 v176, v176, v4
    v_mul_f32 v177, v177, v4
    v_mul_f32 v178, v178, v4
    v_mul_f32 v179, v179, v4
    v_mul_f32 v180, v180, v4
    v_mul_f32 v181, v181, v4
    v_mul_f32 v182, v182, v4
    v_mul_f32 v183, v183, v4
    v_mul_f32 v184, v184, v5
    v_mul_f32 v185, v185, v5
    v_mul_f32 v186, v186, v5
    v_mul_f32 v187, v187, v5
    v_mul_f32 v188, v188, v5
    v_mul_f32 v189, v189, v5
    v_mul_f32 v190, v190, v5
    v_mul_f32 v191, v191, v5
    v_mul_f32 v192, v192, v4
    v_mul_f32 v193, v193, v4
    v_mul_f32 v194, v194, v4
    v_mul_f32 v195, v195, v4
    v_mul_f32 v196, v196, v4
    v_mul_f32 v197, v197, v4
    v_mul_f32 v198, v198, v4
    v_mul_f32 v199, v199, v4
    v_mul_f32 v200, v200, v5
    v_mul_f32 v201, v201, v5
    v_mul_f32 v202, v202, v5
    v_mul_f32 v203, v203, v5
    v_mul_f32 v204, v204, v5
    v_mul_f32 v205, v205, v5
    v_mul_f32 v206, v206, v5
    v_mul_f32 v207, v207, v5
    v_mul_f32 v208, v208, v4
    v_mul_f32 v209, v209, v4
    v_mul_f32 v210, v210, v4
    v_mul_f32 v211, v211, v4
    v_mul_f32 v212, v212, v4
    v_mul_f32 v213, v213, v4
    v_mul_f32 v214, v214, v4
    v_mul_f32 v215, v215, v4
    v_mul_f32 v216, v216, v5
    v_mul_f32 v217, v217, v5
    v_mul_f32 v218, v218, v5
    v_mul_f32 v219, v219, v5
    v_mul_f32 v220, v220, v5
    v_mul_f32 v221, v221, v5
    v_mul_f32 v222, v222, v5
    v_mul_f32 v223, v223, v5
    v_mul_f32 v224, v224, v4
    v_mul_f32 v225, v225, v4
    v_mul_f32 v226, v226, v4
    v_mul_f32 v227, v227, v4
    v_mul_f32 v228, v228, v4
    v_mul_f32 v229, v229, v4
    v_mul_f32 v230, v230, v4
    v_mul_f32 v231, v231, v4
    v_mul_f32 v232, v232, v5
    v_mul_f32 v233, v233, v5
    v_mul_f32 v234, v234, v5
    v_mul_f32 v235, v235, v5
    v_mul_f32 v236, v236, v5
    v_mul_f32 v237, v237, v5
    v_mul_f32 v238, v238, v5
    v_mul_f32 v239, v239, v5
    v_mul_f32 v240, v240, v4
    v_mul_f32 v241, v241, v4
    v_mul_f32 v242, v242, v4
    v_mul_f32 v243, v243, v4
    v_mul_f32 v244, v244, v4
    v_mul_f32 v245, v245, v4
    v_mul_f32 v246, v246, v4
    v_mul_f32 v247, v247, v4
    v_mul_f32 v248, v248, v5
    v_mul_f32 v249, v249, v5
    v_mul_f32 v250, v250, v5
    v_mul_f32 v251, v251, v5
    v_mul_f32 v252, v252, v5
    v_mul_f32 v253, v253, v5
    v_mul_f32 v254, v254, v5
    v_mul_f32 v255, v255, v5
    v_sub_f32 v112, v112, v2
    v_sub_f32 v64, v64, v2
    v_sub_f32 v113, v113, v2
    v_sub_f32 v65, v65, v2
    v_sub_f32 v114, v114, v2
    v_sub_f32 v66, v66, v2
    v_sub_f32 v115, v115, v2
    v_sub_f32 v67, v67, v2
    v_sub_f32 v116, v116, v2
    v_sub_f32 v68, v68, v2
    v_sub_f32 v117, v117, v2
    v_sub_f32 v69, v69, v2
    v_sub_f32 v118, v118, v2
    v_sub_f32 v70, v70, v2
    v_sub_f32 v119, v119, v2
    v_sub_f32 v71, v71, v2
    v_sub_f32 v120, v120, v3
    v_sub_f32 v72, v72, v3
    v_sub_f32 v121, v121, v3
    v_sub_f32 v73, v73, v3
    v_sub_f32 v122, v122, v3
    v_sub_f32 v74, v74, v3
    v_sub_f32 v123, v123, v3
    v_sub_f32 v75, v75, v3
    v_sub_f32 v124, v124, v3
    v_sub_f32 v76, v76, v3
    v_sub_f32 v125, v125, v3
    v_sub_f32 v77, v77, v3
    v_sub_f32 v126, v126, v3
    v_sub_f32 v78, v78, v3
    v_sub_f32 v127, v127, v3
    v_sub_f32 v79, v79, v3
    v_sub_f32 v48, v80, v2
    v_exp_f32 v48, v48
    v_sub_f32 v49, v81, v2
    v_exp_f32 v49, v49
    v_sub_f32 v50, v82, v2
    v_exp_f32 v50, v50
    v_add_f32 v8, v48, v49
    v_sub_f32 v51, v83, v2
    v_exp_f32 v51, v51
    v_add_f32 v8, v8, v50
    v_sub_f32 v56, v88, v3
    v_exp_f32 v56, v56
    v_add_f32 v8, v8, v51
    v_sub_f32 v57, v89, v3
    v_exp_f32 v57, v57
    v_sub_f32 v58, v90, v3
    v_exp_f32 v58, v58
    v_add_f32 v9, v56, v57
    v_sub_f32 v59, v91, v3
    v_exp_f32 v59, v59
    v_add_f32 v9, v9, v58
    v_sub_f32 v52, v84, v2
    v_exp_f32 v52, v52
    v_add_f32 v9, v9, v59
    v_sub_f32 v53, v85, v2
    v_exp_f32 v53, v53
    v_add_f32 v8, v8, v52
    v_sub_f32 v54, v86, v2
    v_exp_f32 v54, v54
    v_add_f32 v8, v8, v53
    v_sub_f32 v55, v87, v2
    v_exp_f32 v55, v55
    v_add_f32 v8, v8, v54
    v_sub_f32 v60, v92, v3
    v_exp_f32 v60, v60
    v_add_f32 v8, v8, v55
    v_sub_f32 v61, v93, v3
    v_exp_f32 v61, v61
    v_add_f32 v9, v9, v60
    v_sub_f32 v62, v94, v3
    v_exp_f32 v62, v62
    v_add_f32 v9, v9, v61
    v_sub_f32 v63, v95, v3
    v_exp_f32 v63, v63
    v_add_f32 v9, v9, v62
    v_add_f32 v9, v9, v63
    s_waitcnt vmcnt(0)
    s_cmp_eq_u32 s26, 1
    s_cbranch_scc1 .Lmain_kernel_rarer_64
    s_cmp_eq_u32 s26, 2
    s_cbranch_scc1 .Lmain_kernel_rarer_78
    s_cmp_eq_u32 s26, 3
    s_cbranch_scc1 .Lmain_kernel_rarer_91
    s_cmp_eq_u32 s26, 4
    s_cbranch_scc1 .Lmain_kernel_rarer_107
    s_cmp_eq_u32 s26, 5
    s_cbranch_scc1 .Lmain_kernel_rarer_120
    s_cmp_eq_u32 s26, 6
    s_cbranch_scc1 .Lmain_kernel_rarer_133
    s_branch .Lmain_kernel_rarer_146
.Lmain_kernel_mask_65:
    v_subrev_u32 v6, 96, v17
    v_add_u32 v7, 64, v6
    v_cmp_gt_i32 s[52:53], 0, v6
    v_cmp_gt_i32 s[54:55], 1, v6
    v_cmp_gt_i32 s[72:73], 2, v6
    v_cmp_gt_i32 s[74:75], 3, v6
    v_cndmask_b32 v112, v20, v18, s[52:53]
    v_cndmask_b32 v113, v20, v18, s[54:55]
    v_cndmask_b32 v114, v20, v18, s[72:73]
    v_cndmask_b32 v115, v20, v18, s[74:75]
    v_cmp_gt_i32 s[52:53], 16, v6
    v_cmp_gt_i32 s[54:55], 17, v6
    v_cmp_gt_i32 s[72:73], 18, v6
    v_cmp_gt_i32 s[74:75], 19, v6
    v_cndmask_b32 v116, v20, v18, s[52:53]
    v_cndmask_b32 v117, v20, v18, s[54:55]
    v_cndmask_b32 v118, v20, v18, s[72:73]
    v_cndmask_b32 v119, v20, v18, s[74:75]
    v_cmp_gt_i32 s[52:53], 0, v7
    v_cmp_gt_i32 s[54:55], 1, v7
    v_cmp_gt_i32 s[72:73], 2, v7
    v_cmp_gt_i32 s[74:75], 3, v7
    v_cndmask_b32 v120, v21, v18, s[52:53]
    v_cndmask_b32 v121, v21, v18, s[54:55]
    v_cndmask_b32 v122, v21, v18, s[72:73]
    v_cndmask_b32 v123, v21, v18, s[74:75]
    v_cmp_gt_i32 s[52:53], 16, v7
    v_cmp_gt_i32 s[54:55], 17, v7
    v_cmp_gt_i32 s[72:73], 18, v7
    v_cmp_gt_i32 s[74:75], 19, v7
    v_cndmask_b32 v124, v21, v18, s[52:53]
    v_cndmask_b32 v125, v21, v18, s[54:55]
    v_cndmask_b32 v126, v21, v18, s[72:73]
    v_cndmask_b32 v127, v21, v18, s[74:75]
    s_xor_b32 s30, s3, 0x3c00
    buffer_load_dword v1, off, s[16:19], s30 offset:128 sc1
    s_branch .Lmain_kernel_maskr_66
.Lmain_kernel_rare_67:
    v_max3_f32 v2, v64, v65, v66
    v_max3_f32 v3, v72, v73, v74
    v_max3_f32 v2, v2, v67, v68
    v_max3_f32 v3, v3, v75, v76
    v_max3_f32 v2, v2, v69, v70
    v_max3_f32 v3, v3, v77, v78
    v_max_f32 v2, v2, v71
    v_max_f32 v3, v3, v79
    s_nop 1
    v_permlane32_swap_b32 v2, v3
    v_max_f32 v2, v2, v3
    v_mov_b32 v4, v2
    s_nop 1
    v_permlane16_swap_b32 v2, v4
    v_max_f32 v2, v2, v4
    v_mov_b32 v3, v2
    s_nop 1
    v_permlane32_swap_b32 v2, v3
    v_max_f32 v2, 0, v2
    v_exp_f32 v4, -v2
    v_sub_f32 v20, v20, v2
    v_mul_f32 v22, v22, v4
    v_max_f32 v3, 0, v3
    v_exp_f32 v5, -v3
    v_sub_f32 v21, v21, v3
    v_mul_f32 v23, v23, v5
    v_mul_f32 v32, v32, v4
    v_mul_f32 v33, v33, v4
    v_mul_f32 v34, v34, v4
    v_mul_f32 v35, v35, v4
    v_mul_f32 v36, v36, v4
    v_mul_f32 v37, v37, v4
    v_mul_f32 v38, v38, v4
    v_mul_f32 v39, v39, v4
    v_mul_f32 v40, v40, v5
    v_mul_f32 v41, v41, v5
    v_mul_f32 v42, v42, v5
    v_mul_f32 v43, v43, v5
    v_mul_f32 v44, v44, v5
    v_mul_f32 v45, v45, v5
    v_mul_f32 v46, v46, v5
    v_mul_f32 v47, v47, v5
    v_mul_f32 v96, v96, v4
    v_mul_f32 v97, v97, v4
    v_mul_f32 v98, v98, v4
    v_mul_f32 v99, v99, v4
    v_mul_f32 v100, v100, v4
    v_mul_f32 v101, v101, v4
    v_mul_f32 v102, v102, v4
    v_mul_f32 v103, v103, v4
    v_mul_f32 v104, v104, v5
    v_mul_f32 v105, v105, v5
    v_mul_f32 v106, v106, v5
    v_mul_f32 v107, v107, v5
    v_mul_f32 v108, v108, v5
    v_mul_f32 v109, v109, v5
    v_mul_f32 v110, v110, v5
    v_mul_f32 v111, v111, v5
    v_mul_f32 v160, v160, v4
    v_mul_f32 v161, v161, v4
    v_mul_f32 v162, v162, v4
    v_mul_f32 v163, v163, v4
    v_mul_f32 v164, v164, v4
    v_mul_f32 v165, v165, v4
    v_mul_f32 v166, v166, v4
    v_mul_f32 v167, v167, v4
    v_mul_f32 v168, v168, v5
    v_mul_f32 v169, v169, v5
    v_mul_f32 v170, v170, v5
    v_mul_f32 v171, v171, v5
    v_mul_f32 v172, v172, v5
    v_mul_f32 v173, v173, v5
    v_mul_f32 v174, v174, v5
    v_mul_f32 v175, v175, v5
    v_mul_f32 v176, v176, v4
    v_mul_f32 v177, v177, v4
    v_mul_f32 v178, v178, v4
    v_mul_f32 v179, v179, v4
    v_mul_f32 v180, v180, v4
    v_mul_f32 v181, v181, v4
    v_mul_f32 v182, v182, v4
    v_mul_f32 v183, v183, v4
    v_mul_f32 v184, v184, v5
    v_mul_f32 v185, v185, v5
    v_mul_f32 v186, v186, v5
    v_mul_f32 v187, v187, v5
    v_mul_f32 v188, v188, v5
    v_mul_f32 v189, v189, v5
    v_mul_f32 v190, v190, v5
    v_mul_f32 v191, v191, v5
    v_mul_f32 v192, v192, v4
    v_mul_f32 v193, v193, v4
    v_mul_f32 v194, v194, v4
    v_mul_f32 v195, v195, v4
    v_mul_f32 v196, v196, v4
    v_mul_f32 v197, v197, v4
    v_mul_f32 v198, v198, v4
    v_mul_f32 v199, v199, v4
    v_mul_f32 v200, v200, v5
    v_mul_f32 v201, v201, v5
    v_mul_f32 v202, v202, v5
    v_mul_f32 v203, v203, v5
    v_mul_f32 v204, v204, v5
    v_mul_f32 v205, v205, v5
    v_mul_f32 v206, v206, v5
    v_mul_f32 v207, v207, v5
    v_mul_f32 v208, v208, v4
    v_mul_f32 v209, v209, v4
    v_mul_f32 v210, v210, v4
    v_mul_f32 v211, v211, v4
    v_mul_f32 v212, v212, v4
    v_mul_f32 v213, v213, v4
    v_mul_f32 v214, v214, v4
    v_mul_f32 v215, v215, v4
    v_mul_f32 v216, v216, v5
    v_mul_f32 v217, v217, v5
    v_mul_f32 v218, v218, v5
    v_mul_f32 v219, v219, v5
    v_mul_f32 v220, v220, v5
    v_mul_f32 v221, v221, v5
    v_mul_f32 v222, v222, v5
    v_mul_f32 v223, v223, v5
    v_mul_f32 v224, v224, v4
    v_mul_f32 v225, v225, v4
    v_mul_f32 v226, v226, v4
    v_mul_f32 v227, v227, v4
    v_mul_f32 v228, v228, v4
    v_mul_f32 v229, v229, v4
    v_mul_f32 v230, v230, v4
    v_mul_f32 v231, v231, v4
    v_mul_f32 v232, v232, v5
    v_mul_f32 v233, v233, v5
    v_mul_f32 v234, v234, v5
    v_mul_f32 v235, v235, v5
    v_mul_f32 v236, v236, v5
    v_mul_f32 v237, v237, v5
    v_mul_f32 v238, v238, v5
    v_mul_f32 v239, v239, v5
    v_mul_f32 v240, v240, v4
    v_mul_f32 v241, v241, v4
    v_mul_f32 v242, v242, v4
    v_mul_f32 v243, v243, v4
    v_mul_f32 v244, v244, v4
    v_mul_f32 v245, v245, v4
    v_mul_f32 v246, v246, v4
    v_mul_f32 v247, v247, v4
    v_mul_f32 v248, v248, v5
    v_mul_f32 v249, v249, v5
    v_mul_f32 v250, v250, v5
    v_mul_f32 v251, v251, v5
    v_mul_f32 v252, v252, v5
    v_mul_f32 v253, v253, v5
    v_mul_f32 v254, v254, v5
    v_mul_f32 v255, v255, v5
    v_sub_f32 v112, v112, v2
    v_sub_f32 v80, v80, v2
    v_sub_f32 v113, v113, v2
    v_sub_f32 v81, v81, v2
    v_sub_f32 v114, v114, v2
    v_sub_f32 v82, v82, v2
    v_sub_f32 v115, v115, v2
    v_sub_f32 v83, v83, v2
    v_sub_f32 v116, v116, v2
    v_sub_f32 v84, v84, v2
    v_sub_f32 v117, v117, v2
    v_sub_f32 v85, v85, v2
    v_sub_f32 v118, v118, v2
    v_sub_f32 v86, v86, v2
    v_sub_f32 v119, v119, v2
    v_sub_f32 v87, v87, v2
    v_sub_f32 v120, v120, v3
    v_sub_f32 v88, v88, v3
    v_sub_f32 v121, v121, v3
    v_sub_f32 v89, v89, v3
    v_sub_f32 v122, v122, v3
    v_sub_f32 v90, v90, v3
    v_sub_f32 v123, v123, v3
    v_sub_f32 v91, v91, v3
    v_sub_f32 v124, v124, v3
    v_sub_f32 v92, v92, v3
    v_sub_f32 v125, v125, v3
    v_sub_f32 v93, v93, v3
    v_sub_f32 v126, v126, v3
    v_sub_f32 v94, v94, v3
    v_sub_f32 v127, v127, v3
    v_sub_f32 v95, v95, v3
    v_sub_f32 v48, v64, v2
    v_exp_f32 v48, v48
    v_sub_f32 v49, v65, v2
    v_exp_f32 v49, v49
    v_sub_f32 v50, v66, v2
    v_exp_f32 v50, v50
    v_add_f32 v8, v48, v49
    v_sub_f32 v51, v67, v2
    v_exp_f32 v51, v51
    v_add_f32 v8, v8, v50
    v_sub_f32 v56, v72, v3
    v_exp_f32 v56, v56
    v_add_f32 v8, v8, v51
    v_sub_f32 v57, v73, v3
    v_exp_f32 v57, v57
    v_sub_f32 v58, v74, v3
    v_exp_f32 v58, v58
    v_add_f32 v9, v56, v57
    v_sub_f32 v59, v75, v3
    v_exp_f32 v59, v59
    v_add_f32 v9, v9, v58
    v_sub_f32 v52, v68, v2
    v_exp_f32 v52, v52
    v_add_f32 v9, v9, v59
    v_sub_f32 v53, v69, v2
    v_exp_f32 v53, v53
    v_add_f32 v8, v8, v52
    v_sub_f32 v54, v70, v2
    v_exp_f32 v54, v54
    v_add_f32 v8, v8, v53
    v_sub_f32 v55, v71, v2
    v_exp_f32 v55, v55
    v_add_f32 v8, v8, v54
    v_sub_f32 v60, v76, v3
    v_exp_f32 v60, v60
    v_add_f32 v8, v8, v55
    v_sub_f32 v61, v77, v3
    v_exp_f32 v61, v61
    v_add_f32 v9, v9, v60
    v_sub_f32 v62, v78, v3
    v_exp_f32 v62, v62
    v_add_f32 v9, v9, v61
    v_sub_f32 v63, v79, v3
    v_exp_f32 v63, v63
    v_add_f32 v9, v9, v62
    v_add_f32 v9, v9, v63
    s_waitcnt vmcnt(0)
    s_cmp_eq_u32 s26, 1
    s_cbranch_scc1 .Lmain_kernel_rarer_68
    s_cmp_eq_u32 s26, 2
    s_cbranch_scc1 .Lmain_kernel_rarer_81
    s_cmp_eq_u32 s26, 3
    s_cbranch_scc1 .Lmain_kernel_rarer_97
    s_cmp_eq_u32 s26, 4
    s_cbranch_scc1 .Lmain_kernel_rarer_110
    s_cmp_eq_u32 s26, 5
    s_cbranch_scc1 .Lmain_kernel_rarer_123
    s_cmp_eq_u32 s26, 6
    s_cbranch_scc1 .Lmain_kernel_rarer_136
    s_branch .Lmain_kernel_rarer_149
.Lmain_kernel_mask_70:
    v_subrev_u32 v6, 0, v17
    v_add_u32 v7, 64, v6
    v_cmp_gt_i32 s[52:53], 0, v6
    v_cmp_gt_i32 s[54:55], 1, v6
    v_cmp_gt_i32 s[72:73], 2, v6
    v_cmp_gt_i32 s[74:75], 3, v6
    v_cndmask_b32 v112, v20, v18, s[52:53]
    v_cndmask_b32 v113, v20, v18, s[54:55]
    v_cndmask_b32 v114, v20, v18, s[72:73]
    v_cndmask_b32 v115, v20, v18, s[74:75]
    v_cmp_gt_i32 s[52:53], 16, v6
    v_cmp_gt_i32 s[54:55], 17, v6
    v_cmp_gt_i32 s[72:73], 18, v6
    v_cmp_gt_i32 s[74:75], 19, v6
    v_cndmask_b32 v116, v20, v18, s[52:53]
    v_cndmask_b32 v117, v20, v18, s[54:55]
    v_cndmask_b32 v118, v20, v18, s[72:73]
    v_cndmask_b32 v119, v20, v18, s[74:75]
    v_cmp_gt_i32 s[52:53], 0, v7
    v_cmp_gt_i32 s[54:55], 1, v7
    v_cmp_gt_i32 s[72:73], 2, v7
    v_cmp_gt_i32 s[74:75], 3, v7
    v_cndmask_b32 v120, v21, v18, s[52:53]
    v_cndmask_b32 v121, v21, v18, s[54:55]
    v_cndmask_b32 v122, v21, v18, s[72:73]
    v_cndmask_b32 v123, v21, v18, s[74:75]
    v_cmp_gt_i32 s[52:53], 16, v7
    v_cmp_gt_i32 s[54:55], 17, v7
    v_cmp_gt_i32 s[72:73], 18, v7
    v_cmp_gt_i32 s[74:75], 19, v7
    v_cndmask_b32 v124, v21, v18, s[52:53]
    v_cndmask_b32 v125, v21, v18, s[54:55]
    v_cndmask_b32 v126, v21, v18, s[72:73]
    v_cndmask_b32 v127, v21, v18, s[74:75]
    s_getpc_b64 s[12:13]
.Lmain_kernel_pc_69:
    s_sub_u32 s12, s12, .Lmain_kernel_pc_69-main_kernel
    s_subb_u32 s13, s13, 0
    s_and_b32 s13, s13, 0xffff
    s_mov_b32 s14, .Ltext_end-main_kernel
    s_mov_b32 s15, 0x00020000
    s_and_b32 s30, s2, 56
    s_lshl_b32 s30, s30, 12
    s_waitcnt vmcnt(9)
    v_lshlrev_b32 v1, 3, v14
    s_lshl_b32 s31, s20, 13
    v_add_u32 v1, s31, v1
    buffer_load_dword v1, v1, s[12:15], s30 offen
    s_branch .Lmain_kernel_maskr_71
.Lmain_kernel_mask_73:
    v_subrev_u32 v6, 32, v17
    v_add_u32 v7, 64, v6
    v_cmp_gt_i32 s[52:53], 0, v6
    v_cmp_gt_i32 s[54:55], 1, v6
    v_cmp_gt_i32 s[72:73], 2, v6
    v_cmp_gt_i32 s[74:75], 3, v6
    v_cndmask_b32 v112, v20, v18, s[52:53]
    v_cndmask_b32 v113, v20, v18, s[54:55]
    v_cndmask_b32 v114, v20, v18, s[72:73]
    v_cndmask_b32 v115, v20, v18, s[74:75]
    v_cmp_gt_i32 s[52:53], 16, v6
    v_cmp_gt_i32 s[54:55], 17, v6
    v_cmp_gt_i32 s[72:73], 18, v6
    v_cmp_gt_i32 s[74:75], 19, v6
    v_cndmask_b32 v116, v20, v18, s[52:53]
    v_cndmask_b32 v117, v20, v18, s[54:55]
    v_cndmask_b32 v118, v20, v18, s[72:73]
    v_cndmask_b32 v119, v20, v18, s[74:75]
    v_cmp_gt_i32 s[52:53], 0, v7
    v_cmp_gt_i32 s[54:55], 1, v7
    v_cmp_gt_i32 s[72:73], 2, v7
    v_cmp_gt_i32 s[74:75], 3, v7
    v_cndmask_b32 v120, v21, v18, s[52:53]
    v_cndmask_b32 v121, v21, v18, s[54:55]
    v_cndmask_b32 v122, v21, v18, s[72:73]
    v_cndmask_b32 v123, v21, v18, s[74:75]
    v_cmp_gt_i32 s[52:53], 16, v7
    v_cmp_gt_i32 s[54:55], 17, v7
    v_cmp_gt_i32 s[72:73], 18, v7
    v_cmp_gt_i32 s[74:75], 19, v7
    v_cndmask_b32 v124, v21, v18, s[52:53]
    v_cndmask_b32 v125, v21, v18, s[54:55]
    v_cndmask_b32 v126, v21, v18, s[72:73]
    v_cndmask_b32 v127, v21, v18, s[74:75]
    s_branch .Lmain_kernel_maskr_74
.Lmain_kernel_mask_76:
    v_subrev_u32 v6, 64, v17
    v_add_u32 v7, 64, v6
    v_cmp_gt_i32 s[52:53], 0, v6
    v_cmp_gt_i32 s[54:55], 1, v6
    v_cmp_gt_i32 s[72:73], 2, v6
    v_cmp_gt_i32 s[74:75], 3, v6
    v_cndmask_b32 v112, v20, v18, s[52:53]
    v_cndmask_b32 v113, v20, v18, s[54:55]
    v_cndmask_b32 v114, v20, v18, s[72:73]
    v_cndmask_b32 v115, v20, v18, s[74:75]
    v_cmp_gt_i32 s[52:53], 16, v6
    v_cmp_gt_i32 s[54:55], 17, v6
    v_cmp_gt_i32 s[72:73], 18, v6
    v_cmp_gt_i32 s[74:75], 19, v6
    v_cndmask_b32 v116, v20, v18, s[52:53]
    v_cndmask_b32 v117, v20, v18, s[54:55]
    v_cndmask_b32 v118, v20, v18, s[72:73]
    v_cndmask_b32 v119, v20, v18, s[74:75]
    v_cmp_gt_i32 s[52:53], 0, v7
    v_cmp_gt_i32 s[54:55], 1, v7
    v_cmp_gt_i32 s[72:73], 2, v7
    v_cmp_gt_i32 s[74:75], 3, v7
    v_cndmask_b32 v120, v21, v18, s[52:53]
    v_cndmask_b32 v121, v21, v18, s[54:55]
    v_cndmask_b32 v122, v21, v18, s[72:73]
    v_cndmask_b32 v123, v21, v18, s[74:75]
    v_cmp_gt_i32 s[52:53], 16, v7
    v_cmp_gt_i32 s[54:55], 17, v7
    v_cmp_gt_i32 s[72:73], 18, v7
    v_cmp_gt_i32 s[74:75], 19, v7
    v_cndmask_b32 v124, v21, v18, s[52:53]
    v_cndmask_b32 v125, v21, v18, s[54:55]
    v_cndmask_b32 v126, v21, v18, s[72:73]
    v_cndmask_b32 v127, v21, v18, s[74:75]
    s_branch .Lmain_kernel_maskr_77
.Lmain_kernel_mask_79:
    v_subrev_u32 v6, 96, v17
    v_add_u32 v7, 64, v6
    v_cmp_gt_i32 s[52:53], 0, v6
    v_cmp_gt_i32 s[54:55], 1, v6
    v_cmp_gt_i32 s[72:73], 2, v6
    v_cmp_gt_i32 s[74:75], 3, v6
    v_cndmask_b32 v112, v20, v18, s[52:53]
    v_cndmask_b32 v113, v20, v18, s[54:55]
    v_cndmask_b32 v114, v20, v18, s[72:73]
    v_cndmask_b32 v115, v20, v18, s[74:75]
    v_cmp_gt_i32 s[52:53], 16, v6
    v_cmp_gt_i32 s[54:55], 17, v6
    v_cmp_gt_i32 s[72:73], 18, v6
    v_cmp_gt_i32 s[74:75], 19, v6
    v_cndmask_b32 v116, v20, v18, s[52:53]
    v_cndmask_b32 v117, v20, v18, s[54:55]
    v_cndmask_b32 v118, v20, v18, s[72:73]
    v_cndmask_b32 v119, v20, v18, s[74:75]
    v_cmp_gt_i32 s[52:53], 0, v7
    v_cmp_gt_i32 s[54:55], 1, v7
    v_cmp_gt_i32 s[72:73], 2, v7
    v_cmp_gt_i32 s[74:75], 3, v7
    v_cndmask_b32 v120, v21, v18, s[52:53]
    v_cndmask_b32 v121, v21, v18, s[54:55]
    v_cndmask_b32 v122, v21, v18, s[72:73]
    v_cndmask_b32 v123, v21, v18, s[74:75]
    v_cmp_gt_i32 s[52:53], 16, v7
    v_cmp_gt_i32 s[54:55], 17, v7
    v_cmp_gt_i32 s[72:73], 18, v7
    v_cmp_gt_i32 s[74:75], 19, v7
    v_cndmask_b32 v124, v21, v18, s[52:53]
    v_cndmask_b32 v125, v21, v18, s[54:55]
    v_cndmask_b32 v126, v21, v18, s[72:73]
    v_cndmask_b32 v127, v21, v18, s[74:75]
    s_xor_b32 s30, s3, 0x3c00
    buffer_load_dword v1, off, s[16:19], s30 offset:128 sc1
    s_branch .Lmain_kernel_maskr_80
.Lmain_kernel_mask_83:
    v_subrev_u32 v6, 0, v17
    v_add_u32 v7, 64, v6
    v_cmp_gt_i32 s[52:53], 0, v6
    v_cmp_gt_i32 s[54:55], 1, v6
    v_cmp_gt_i32 s[72:73], 2, v6
    v_cmp_gt_i32 s[74:75], 3, v6
    v_cndmask_b32 v112, v20, v18, s[52:53]
    v_cndmask_b32 v113, v20, v18, s[54:55]
    v_cndmask_b32 v114, v20, v18, s[72:73]
    v_cndmask_b32 v115, v20, v18, s[74:75]
    v_cmp_gt_i32 s[52:53], 16, v6
    v_cmp_gt_i32 s[54:55], 17, v6
    v_cmp_gt_i32 s[72:73], 18, v6
    v_cmp_gt_i32 s[74:75], 19, v6
    v_cndmask_b32 v116, v20, v18, s[52:53]
    v_cndmask_b32 v117, v20, v18, s[54:55]
    v_cndmask_b32 v118, v20, v18, s[72:73]
    v_cndmask_b32 v119, v20, v18, s[74:75]
    v_cmp_gt_i32 s[52:53], 0, v7
    v_cmp_gt_i32 s[54:55], 1, v7
    v_cmp_gt_i32 s[72:73], 2, v7
    v_cmp_gt_i32 s[74:75], 3, v7
    v_cndmask_b32 v120, v21, v18, s[52:53]
    v_cndmask_b32 v121, v21, v18, s[54:55]
    v_cndmask_b32 v122, v21, v18, s[72:73]
    v_cndmask_b32 v123, v21, v18, s[74:75]
    v_cmp_gt_i32 s[52:53], 16, v7
    v_cmp_gt_i32 s[54:55], 17, v7
    v_cmp_gt_i32 s[72:73], 18, v7
    v_cmp_gt_i32 s[74:75], 19, v7
    v_cndmask_b32 v124, v21, v18, s[52:53]
    v_cndmask_b32 v125, v21, v18, s[54:55]
    v_cndmask_b32 v126, v21, v18, s[72:73]
    v_cndmask_b32 v127, v21, v18, s[74:75]
    s_getpc_b64 s[12:13]
.Lmain_kernel_pc_82:
    s_sub_u32 s12, s12, .Lmain_kernel_pc_82-main_kernel
    s_subb_u32 s13, s13, 0
    s_and_b32 s13, s13, 0xffff
    s_mov_b32 s14, .Ltext_end-main_kernel
    s_mov_b32 s15, 0x00020000
    s_and_b32 s30, s2, 56
    s_lshl_b32 s30, s30, 12
    s_waitcnt vmcnt(8)
    v_lshlrev_b32 v1, 3, v14
    s_lshl_b32 s31, s20, 13
    v_add_u32 v1, s31, v1
    buffer_load_dword v1, v1, s[12:15], s30 offen
    s_branch .Lmain_kernel_maskr_84
.Lmain_kernel_mask_86:
    v_subrev_u32 v6, 32, v17
    v_add_u32 v7, 64, v6
    v_cmp_gt_i32 s[52:53], 0, v6
    v_cmp_gt_i32 s[54:55], 1, v6
    v_cmp_gt_i32 s[72:73], 2, v6
    v_cmp_gt_i32 s[74:75], 3, v6
    v_cndmask_b32 v112, v20, v18, s[52:53]
    v_cndmask_b32 v113, v20, v18, s[54:55]
    v_cndmask_b32 v114, v20, v18, s[72:73]
    v_cndmask_b32 v115, v20, v18, s[74:75]
    v_cmp_gt_i32 s[52:53], 16, v6
    v_cmp_gt_i32 s[54:55], 17, v6
    v_cmp_gt_i32 s[72:73], 18, v6
    v_cmp_gt_i32 s[74:75], 19, v6
    v_cndmask_b32 v116, v20, v18, s[52:53]
    v_cndmask_b32 v117, v20, v18, s[54:55]
    v_cndmask_b32 v118, v20, v18, s[72:73]
    v_cndmask_b32 v119, v20, v18, s[74:75]
    v_cmp_gt_i32 s[52:53], 0, v7
    v_cmp_gt_i32 s[54:55], 1, v7
    v_cmp_gt_i32 s[72:73], 2, v7
    v_cmp_gt_i32 s[74:75], 3, v7
    v_cndmask_b32 v120, v21, v18, s[52:53]
    v_cndmask_b32 v121, v21, v18, s[54:55]
    v_cndmask_b32 v122, v21, v18, s[72:73]
    v_cndmask_b32 v123, v21, v18, s[74:75]
    v_cmp_gt_i32 s[52:53], 16, v7
    v_cmp_gt_i32 s[54:55], 17, v7
    v_cmp_gt_i32 s[72:73], 18, v7
    v_cmp_gt_i32 s[74:75], 19, v7
    v_cndmask_b32 v124, v21, v18, s[52:53]
    v_cndmask_b32 v125, v21, v18, s[54:55]
    v_cndmask_b32 v126, v21, v18, s[72:73]
    v_cndmask_b32 v127, v21, v18, s[74:75]
    s_branch .Lmain_kernel_maskr_87
.Lmain_kernel_mask_89:
    v_subrev_u32 v6, 64, v17
    v_add_u32 v7, 64, v6
    v_cmp_gt_i32 s[52:53], 0, v6
    v_cmp_gt_i32 s[54:55], 1, v6
    v_cmp_gt_i32 s[72:73], 2, v6
    v_cmp_gt_i32 s[74:75], 3, v6
    v_cndmask_b32 v112, v20, v18, s[52:53]
    v_cndmask_b32 v113, v20, v18, s[54:55]
    v_cndmask_b32 v114, v20, v18, s[72:73]
    v_cndmask_b32 v115, v20, v18, s[74:75]
    v_cmp_gt_i32 s[52:53], 16, v6
    v_cmp_gt_i32 s[54:55], 17, v6
    v_cmp_gt_i32 s[72:73], 18, v6
    v_cmp_gt_i32 s[74:75], 19, v6
    v_cndmask_b32 v116, v20, v18, s[52:53]
    v_cndmask_b32 v117, v20, v18, s[54:55]
    v_cndmask_b32 v118, v20, v18, s[72:73]
    v_cndmask_b32 v119, v20, v18, s[74:75]
    v_cmp_gt_i32 s[52:53], 0, v7
    v_cmp_gt_i32 s[54:55], 1, v7
    v_cmp_gt_i32 s[72:73], 2, v7
    v_cmp_gt_i32 s[74:75], 3, v7
    v_cndmask_b32 v120, v21, v18, s[52:53]
    v_cndmask_b32 v121, v21, v18, s[54:55]
    v_cndmask_b32 v122, v21, v18, s[72:73]
    v_cndmask_b32 v123, v21, v18, s[74:75]
    v_cmp_gt_i32 s[52:53], 16, v7
    v_cmp_gt_i32 s[54:55], 17, v7
    v_cmp_gt_i32 s[72:73], 18, v7
    v_cmp_gt_i32 s[74:75], 19, v7
    v_cndmask_b32 v124, v21, v18, s[52:53]
    v_cndmask_b32 v125, v21, v18, s[54:55]
    v_cndmask_b32 v126, v21, v18, s[72:73]
    v_cndmask_b32 v127, v21, v18, s[74:75]
    s_branch .Lmain_kernel_maskr_90
.Lmain_kernel_spin_93:
    s_mov_b32 s31, 0
.Lmain_kernel_sp2_94:
    s_add_u32 s31, s31, 1
    s_cmp_gt_u32 s31, 0x40000
    s_cbranch_scc1 .Lmain_kernel_pok_92
    s_sleep 2
    v_and_b32 v131, 0xf0, v14
    v_lshlrev_b32 v131, 10, v131
    buffer_load_dword v131, v131, s[16:19], s35 offen sc1
    s_waitcnt vmcnt(0)
    v_and_b32 v131, 1, v131
    v_cmp_ne_u32 vcc, 1, v131
    s_nop 0
    s_cbranch_vccnz .Lmain_kernel_sp2_94
    s_branch .Lmain_kernel_pok_92
.Lmain_kernel_mask_95:
    v_subrev_u32 v6, 96, v17
    v_add_u32 v7, 64, v6
    v_cmp_gt_i32 s[52:53], 0, v6
    v_cmp_gt_i32 s[54:55], 1, v6
    v_cmp_gt_i32 s[72:73], 2, v6
    v_cmp_gt_i32 s[74:75], 3, v6
    v_cndmask_b32 v112, v20, v18, s[52:53]
    v_cndmask_b32 v113, v20, v18, s[54:55]
    v_cndmask_b32 v114, v20, v18, s[72:73]
    v_cndmask_b32 v115, v20, v18, s[74:75]
    v_cmp_gt_i32 s[52:53], 16, v6
    v_cmp_gt_i32 s[54:55], 17, v6
    v_cmp_gt_i32 s[72:73], 18, v6
    v_cmp_gt_i32 s[74:75], 19, v6
    v_cndmask_b32 v116, v20, v18, s[52:53]
    v_cndmask_b32 v117, v20, v18, s[54:55]
    v_cndmask_b32 v118, v20, v18, s[72:73]
    v_cndmask_b32 v119, v20, v18, s[74:75]
    v_cmp_gt_i32 s[52:53], 0, v7
    v_cmp_gt_i32 s[54:55], 1, v7
    v_cmp_gt_i32 s[72:73], 2, v7
    v_cmp_gt_i32 s[74:75], 3, v7
    v_cndmask_b32 v120, v21, v18, s[52:53]
    v_cndmask_b32 v121, v21, v18, s[54:55]
    v_cndmask_b32 v122, v21, v18, s[72:73]
    v_cndmask_b32 v123, v21, v18, s[74:75]
    v_cmp_gt_i32 s[52:53], 16, v7
    v_cmp_gt_i32 s[54:55], 17, v7
    v_cmp_gt_i32 s[72:73], 18, v7
    v_cmp_gt_i32 s[74:75], 19, v7
    v_cndmask_b32 v124, v21, v18, s[52:53]
    v_cndmask_b32 v125, v21, v18, s[54:55]
    v_cndmask_b32 v126, v21, v18, s[72:73]
    v_cndmask_b32 v127, v21, v18, s[74:75]
    s_xor_b32 s30, s3, 0x3c00
    buffer_load_dword v1, off, s[16:19], s30 offset:128 sc1
    s_branch .Lmain_kernel_maskr_96
.Lmain_kernel_mask_99:
    v_subrev_u32 v6, 0, v17
    v_add_u32 v7, 64, v6
    v_cmp_gt_i32 s[52:53], 0, v6
    v_cmp_gt_i32 s[54:55], 1, v6
    v_cmp_gt_i32 s[72:73], 2, v6
    v_cmp_gt_i32 s[74:75], 3, v6
    v_cndmask_b32 v112, v20, v18, s[52:53]
    v_cndmask_b32 v113, v20, v18, s[54:55]
    v_cndmask_b32 v114, v20, v18, s[72:73]
    v_cndmask_b32 v115, v20, v18, s[74:75]
    v_cmp_gt_i32 s[52:53], 16, v6
    v_cmp_gt_i32 s[54:55], 17, v6
    v_cmp_gt_i32 s[72:73], 18, v6
    v_cmp_gt_i32 s[74:75], 19, v6
    v_cndmask_b32 v116, v20, v18, s[52:53]
    v_cndmask_b32 v117, v20, v18, s[54:55]
    v_cndmask_b32 v118, v20, v18, s[72:73]
    v_cndmask_b32 v119, v20, v18, s[74:75]
    v_cmp_gt_i32 s[52:53], 0, v7
    v_cmp_gt_i32 s[54:55], 1, v7
    v_cmp_gt_i32 s[72:73], 2, v7
    v_cmp_gt_i32 s[74:75], 3, v7
    v_cndmask_b32 v120, v21, v18, s[52:53]
    v_cndmask_b32 v121, v21, v18, s[54:55]
    v_cndmask_b32 v122, v21, v18, s[72:73]
    v_cndmask_b32 v123, v21, v18, s[74:75]
    v_cmp_gt_i32 s[52:53], 16, v7
    v_cmp_gt_i32 s[54:55], 17, v7
    v_cmp_gt_i32 s[72:73], 18, v7
    v_cmp_gt_i32 s[74:75], 19, v7
    v_cndmask_b32 v124, v21, v18, s[52:53]
    v_cndmask_b32 v125, v21, v18, s[54:55]
    v_cndmask_b32 v126, v21, v18, s[72:73]
    v_cndmask_b32 v127, v21, v18, s[74:75]
    s_getpc_b64 s[12:13]
.Lmain_kernel_pc_98:
    s_sub_u32 s12, s12, .Lmain_kernel_pc_98-main_kernel
    s_subb_u32 s13, s13, 0
    s_and_b32 s13, s13, 0xffff
    s_mov_b32 s14, .Ltext_end-main_kernel
    s_mov_b32 s15, 0x00020000
    s_and_b32 s30, s2, 56
    s_lshl_b32 s30, s30, 12
    s_waitcnt vmcnt(9)
    v_lshlrev_b32 v1, 3, v14
    s_lshl_b32 s31, s20, 13
    v_add_u32 v1, s31, v1
    buffer_load_dword v1, v1, s[12:15], s30 offen
    s_branch .Lmain_kernel_maskr_100
.Lmain_kernel_mask_102:
    v_subrev_u32 v6, 32, v17
    v_add_u32 v7, 64, v6
    v_cmp_gt_i32 s[52:53], 0, v6
    v_cmp_gt_i32 s[54:55], 1, v6
    v_cmp_gt_i32 s[72:73], 2, v6
    v_cmp_gt_i32 s[74:75], 3, v6
    v_cndmask_b32 v112, v20, v18, s[52:53]
    v_cndmask_b32 v113, v20, v18, s[54:55]
    v_cndmask_b32 v114, v20, v18, s[72:73]
    v_cndmask_b32 v115, v20, v18, s[74:75]
    v_cmp_gt_i32 s[52:53], 16, v6
    v_cmp_gt_i32 s[54:55], 17, v6
    v_cmp_gt_i32 s[72:73], 18, v6
    v_cmp_gt_i32 s[74:75], 19, v6
    v_cndmask_b32 v116, v20, v18, s[52:53]
    v_cndmask_b32 v117, v20, v18, s[54:55]
    v_cndmask_b32 v118, v20, v18, s[72:73]
    v_cndmask_b32 v119, v20, v18, s[74:75]
    v_cmp_gt_i32 s[52:53], 0, v7
    v_cmp_gt_i32 s[54:55], 1, v7
    v_cmp_gt_i32 s[72:73], 2, v7
    v_cmp_gt_i32 s[74:75], 3, v7
    v_cndmask_b32 v120, v21, v18, s[52:53]
    v_cndmask_b32 v121, v21, v18, s[54:55]
    v_cndmask_b32 v122, v21, v18, s[72:73]
    v_cndmask_b32 v123, v21, v18, s[74:75]
    v_cmp_gt_i32 s[52:53], 16, v7
    v_cmp_gt_i32 s[54:55], 17, v7
    v_cmp_gt_i32 s[72:73], 18, v7
    v_cmp_gt_i32 s[74:75], 19, v7
    v_cndmask_b32 v124, v21, v18, s[52:53]
    v_cndmask_b32 v125, v21, v18, s[54:55]
    v_cndmask_b32 v126, v21, v18, s[72:73]
    v_cndmask_b32 v127, v21, v18, s[74:75]
    s_branch .Lmain_kernel_maskr_103
.Lmain_kernel_mask_105:
    v_subrev_u32 v6, 64, v17
    v_add_u32 v7, 64, v6
    v_cmp_gt_i32 s[52:53], 0, v6
    v_cmp_gt_i32 s[54:55], 1, v6
    v_cmp_gt_i32 s[72:73], 2, v6
    v_cmp_gt_i32 s[74:75], 3, v6
    v_cndmask_b32 v112, v20, v18, s[52:53]
    v_cndmask_b32 v113, v20, v18, s[54:55]
    v_cndmask_b32 v114, v20, v18, s[72:73]
    v_cndmask_b32 v115, v20, v18, s[74:75]
    v_cmp_gt_i32 s[52:53], 16, v6
    v_cmp_gt_i32 s[54:55], 17, v6
    v_cmp_gt_i32 s[72:73], 18, v6
    v_cmp_gt_i32 s[74:75], 19, v6
    v_cndmask_b32 v116, v20, v18, s[52:53]
    v_cndmask_b32 v117, v20, v18, s[54:55]
    v_cndmask_b32 v118, v20, v18, s[72:73]
    v_cndmask_b32 v119, v20, v18, s[74:75]
    v_cmp_gt_i32 s[52:53], 0, v7
    v_cmp_gt_i32 s[54:55], 1, v7
    v_cmp_gt_i32 s[72:73], 2, v7
    v_cmp_gt_i32 s[74:75], 3, v7
    v_cndmask_b32 v120, v21, v18, s[52:53]
    v_cndmask_b32 v121, v21, v18, s[54:55]
    v_cndmask_b32 v122, v21, v18, s[72:73]
    v_cndmask_b32 v123, v21, v18, s[74:75]
    v_cmp_gt_i32 s[52:53], 16, v7
    v_cmp_gt_i32 s[54:55], 17, v7
    v_cmp_gt_i32 s[72:73], 18, v7
    v_cmp_gt_i32 s[74:75], 19, v7
    v_cndmask_b32 v124, v21, v18, s[52:53]
    v_cndmask_b32 v125, v21, v18, s[54:55]
    v_cndmask_b32 v126, v21, v18, s[72:73]
    v_cndmask_b32 v127, v21, v18, s[74:75]
    s_branch .Lmain_kernel_maskr_106
.Lmain_kernel_mask_108:
    v_subrev_u32 v6, 96, v17
    v_add_u32 v7, 64, v6
    v_cmp_gt_i32 s[52:53], 0, v6
    v_cmp_gt_i32 s[54:55], 1, v6
    v_cmp_gt_i32 s[72:73], 2, v6
    v_cmp_gt_i32 s[74:75], 3, v6
    v_cndmask_b32 v112, v20, v18, s[52:53]
    v_cndmask_b32 v113, v20, v18, s[54:55]
    v_cndmask_b32 v114, v20, v18, s[72:73]
    v_cndmask_b32 v115, v20, v18, s[74:75]
    v_cmp_gt_i32 s[52:53], 16, v6
    v_cmp_gt_i32 s[54:55], 17, v6
    v_cmp_gt_i32 s[72:73], 18, v6
    v_cmp_gt_i32 s[74:75], 19, v6
    v_cndmask_b32 v116, v20, v18, s[52:53]
    v_cndmask_b32 v117, v20, v18, s[54:55]
    v_cndmask_b32 v118, v20, v18, s[72:73]
    v_cndmask_b32 v119, v20, v18, s[74:75]
    v_cmp_gt_i32 s[52:53], 0, v7
    v_cmp_gt_i32 s[54:55], 1, v7
    v_cmp_gt_i32 s[72:73], 2, v7
    v_cmp_gt_i32 s[74:75], 3, v7
    v_cndmask_b32 v120, v21, v18, s[52:53]
    v_cndmask_b32 v121, v21, v18, s[54:55]
    v_cndmask_b32 v122, v21, v18, s[72:73]
    v_cndmask_b32 v123, v21, v18, s[74:75]
    v_cmp_gt_i32 s[52:53], 16, v7
    v_cmp_gt_i32 s[54:55], 17, v7
    v_cmp_gt_i32 s[72:73], 18, v7
    v_cmp_gt_i32 s[74:75], 19, v7
    v_cndmask_b32 v124, v21, v18, s[52:53]
    v_cndmask_b32 v125, v21, v18, s[54:55]
    v_cndmask_b32 v126, v21, v18, s[72:73]
    v_cndmask_b32 v127, v21, v18, s[74:75]
    s_xor_b32 s30, s3, 0x3c00
    buffer_load_dword v1, off, s[16:19], s30 offset:128 sc1
    s_branch .Lmain_kernel_maskr_109
.Lmain_kernel_mask_112:
    v_subrev_u32 v6, 0, v17
    v_add_u32 v7, 64, v6
    v_cmp_gt_i32 s[52:53], 0, v6
    v_cmp_gt_i32 s[54:55], 1, v6
    v_cmp_gt_i32 s[72:73], 2, v6
    v_cmp_gt_i32 s[74:75], 3, v6
    v_cndmask_b32 v112, v20, v18, s[52:53]
    v_cndmask_b32 v113, v20, v18, s[54:55]
    v_cndmask_b32 v114, v20, v18, s[72:73]
    v_cndmask_b32 v115, v20, v18, s[74:75]
    v_cmp_gt_i32 s[52:53], 16, v6
    v_cmp_gt_i32 s[54:55], 17, v6
    v_cmp_gt_i32 s[72:73], 18, v6
    v_cmp_gt_i32 s[74:75], 19, v6
    v_cndmask_b32 v116, v20, v18, s[52:53]
    v_cndmask_b32 v117, v20, v18, s[54:55]
    v_cndmask_b32 v118, v20, v18, s[72:73]
    v_cndmask_b32 v119, v20, v18, s[74:75]
    v_cmp_gt_i32 s[52:53], 0, v7
    v_cmp_gt_i32 s[54:55], 1, v7
    v_cmp_gt_i32 s[72:73], 2, v7
    v_cmp_gt_i32 s[74:75], 3, v7
    v_cndmask_b32 v120, v21, v18, s[52:53]
    v_cndmask_b32 v121, v21, v18, s[54:55]
    v_cndmask_b32 v122, v21, v18, s[72:73]
    v_cndmask_b32 v123, v21, v18, s[74:75]
    v_cmp_gt_i32 s[52:53], 16, v7
    v_cmp_gt_i32 s[54:55], 17, v7
    v_cmp_gt_i32 s[72:73], 18, v7
    v_cmp_gt_i32 s[74:75], 19, v7
    v_cndmask_b32 v124, v21, v18, s[52:53]
    v_cndmask_b32 v125, v21, v18, s[54:55]
    v_cndmask_b32 v126, v21, v18, s[72:73]
    v_cndmask_b32 v127, v21, v18, s[74:75]
    s_getpc_b64 s[12:13]
.Lmain_kernel_pc_111:
    s_sub_u32 s12, s12, .Lmain_kernel_pc_111-main_kernel
    s_subb_u32 s13, s13, 0
    s_and_b32 s13, s13, 0xffff
    s_mov_b32 s14, .Ltext_end-main_kernel
    s_mov_b32 s15, 0x00020000
    s_and_b32 s30, s2, 56
    s_lshl_b32 s30, s30, 12
    s_waitcnt vmcnt(9)
    v_lshlrev_b32 v1, 3, v14
    s_lshl_b32 s31, s20, 13
    v_add_u32 v1, s31, v1
    buffer_load_dword v1, v1, s[12:15], s30 offen
    s_branch .Lmain_kernel_maskr_113
.Lmain_kernel_mask_115:
    v_subrev_u32 v6, 32, v17
    v_add_u32 v7, 64, v6
    v_cmp_gt_i32 s[52:53], 0, v6
    v_cmp_gt_i32 s[54:55], 1, v6
    v_cmp_gt_i32 s[72:73], 2, v6
    v_cmp_gt_i32 s[74:75], 3, v6
    v_cndmask_b32 v112, v20, v18, s[52:53]
    v_cndmask_b32 v113, v20, v18, s[54:55]
    v_cndmask_b32 v114, v20, v18, s[72:73]
    v_cndmask_b32 v115, v20, v18, s[74:75]
    v_cmp_gt_i32 s[52:53], 16, v6
    v_cmp_gt_i32 s[54:55], 17, v6
    v_cmp_gt_i32 s[72:73], 18, v6
    v_cmp_gt_i32 s[74:75], 19, v6
    v_cndmask_b32 v116, v20, v18, s[52:53]
    v_cndmask_b32 v117, v20, v18, s[54:55]
    v_cndmask_b32 v118, v20, v18, s[72:73]
    v_cndmask_b32 v119, v20, v18, s[74:75]
    v_cmp_gt_i32 s[52:53], 0, v7
    v_cmp_gt_i32 s[54:55], 1, v7
    v_cmp_gt_i32 s[72:73], 2, v7
    v_cmp_gt_i32 s[74:75], 3, v7
    v_cndmask_b32 v120, v21, v18, s[52:53]
    v_cndmask_b32 v121, v21, v18, s[54:55]
    v_cndmask_b32 v122, v21, v18, s[72:73]
    v_cndmask_b32 v123, v21, v18, s[74:75]
    v_cmp_gt_i32 s[52:53], 16, v7
    v_cmp_gt_i32 s[54:55], 17, v7
    v_cmp_gt_i32 s[72:73], 18, v7
    v_cmp_gt_i32 s[74:75], 19, v7
    v_cndmask_b32 v124, v21, v18, s[52:53]
    v_cndmask_b32 v125, v21, v18, s[54:55]
    v_cndmask_b32 v126, v21, v18, s[72:73]
    v_cndmask_b32 v127, v21, v18, s[74:75]
    s_branch .Lmain_kernel_maskr_116
.Lmain_kernel_mask_118:
    v_subrev_u32 v6, 64, v17
    v_add_u32 v7, 64, v6
    v_cmp_gt_i32 s[52:53], 0, v6
    v_cmp_gt_i32 s[54:55], 1, v6
    v_cmp_gt_i32 s[72:73], 2, v6
    v_cmp_gt_i32 s[74:75], 3, v6
    v_cndmask_b32 v112, v20, v18, s[52:53]
    v_cndmask_b32 v113, v20, v18, s[54:55]
    v_cndmask_b32 v114, v20, v18, s[72:73]
    v_cndmask_b32 v115, v20, v18, s[74:75]
    v_cmp_gt_i32 s[52:53], 16, v6
    v_cmp_gt_i32 s[54:55], 17, v6
    v_cmp_gt_i32 s[72:73], 18, v6
    v_cmp_gt_i32 s[74:75], 19, v6
    v_cndmask_b32 v116, v20, v18, s[52:53]
    v_cndmask_b32 v117, v20, v18, s[54:55]
    v_cndmask_b32 v118, v20, v18, s[72:73]
    v_cndmask_b32 v119, v20, v18, s[74:75]
    v_cmp_gt_i32 s[52:53], 0, v7
    v_cmp_gt_i32 s[54:55], 1, v7
    v_cmp_gt_i32 s[72:73], 2, v7
    v_cmp_gt_i32 s[74:75], 3, v7
    v_cndmask_b32 v120, v21, v18, s[52:53]
    v_cndmask_b32 v121, v21, v18, s[54:55]
    v_cndmask_b32 v122, v21, v18, s[72:73]
    v_cndmask_b32 v123, v21, v18, s[74:75]
    v_cmp_gt_i32 s[52:53], 16, v7
    v_cmp_gt_i32 s[54:55], 17, v7
    v_cmp_gt_i32 s[72:73], 18, v7
    v_cmp_gt_i32 s[74:75], 19, v7
    v_cndmask_b32 v124, v21, v18, s[52:53]
    v_cndmask_b32 v125, v21, v18, s[54:55]
    v_cndmask_b32 v126, v21, v18, s[72:73]
    v_cndmask_b32 v127, v21, v18, s[74:75]
    s_branch .Lmain_kernel_maskr_119
.Lmain_kernel_mask_121:
    v_subrev_u32 v6, 96, v17
    v_add_u32 v7, 64, v6
    v_cmp_gt_i32 s[52:53], 0, v6
    v_cmp_gt_i32 s[54:55], 1, v6
    v_cmp_gt_i32 s[72:73], 2, v6
    v_cmp_gt_i32 s[74:75], 3, v6
    v_cndmask_b32 v112, v20, v18, s[52:53]
    v_cndmask_b32 v113, v20, v18, s[54:55]
    v_cndmask_b32 v114, v20, v18, s[72:73]
    v_cndmask_b32 v115, v20, v18, s[74:75]
    v_cmp_gt_i32 s[52:53], 16, v6
    v_cmp_gt_i32 s[54:55], 17, v6
    v_cmp_gt_i32 s[72:73], 18, v6
    v_cmp_gt_i32 s[74:75], 19, v6
    v_cndmask_b32 v116, v20, v18, s[52:53]
    v_cndmask_b32 v117, v20, v18, s[54:55]
    v_cndmask_b32 v118, v20, v18, s[72:73]
    v_cndmask_b32 v119, v20, v18, s[74:75]
    v_cmp_gt_i32 s[52:53], 0, v7
    v_cmp_gt_i32 s[54:55], 1, v7
    v_cmp_gt_i32 s[72:73], 2, v7
    v_cmp_gt_i32 s[74:75], 3, v7
    v_cndmask_b32 v120, v21, v18, s[52:53]
    v_cndmask_b32 v121, v21, v18, s[54:55]
    v_cndmask_b32 v122, v21, v18, s[72:73]
    v_cndmask_b32 v123, v21, v18, s[74:75]
    v_cmp_gt_i32 s[52:53], 16, v7
    v_cmp_gt_i32 s[54:55], 17, v7
    v_cmp_gt_i32 s[72:73], 18, v7
    v_cmp_gt_i32 s[74:75], 19, v7
    v_cndmask_b32 v124, v21, v18, s[52:53]
    v_cndmask_b32 v125, v21, v18, s[54:55]
    v_cndmask_b32 v126, v21, v18, s[72:73]
    v_cndmask_b32 v127, v21, v18, s[74:75]
    s_xor_b32 s30, s3, 0x3c00
    buffer_load_dword v1, off, s[16:19], s30 offset:128 sc1
    s_branch .Lmain_kernel_maskr_122
.Lmain_kernel_mask_125:
    v_subrev_u32 v6, 0, v17
    v_add_u32 v7, 64, v6
    v_cmp_gt_i32 s[52:53], 0, v6
    v_cmp_gt_i32 s[54:55], 1, v6
    v_cmp_gt_i32 s[72:73], 2, v6
    v_cmp_gt_i32 s[74:75], 3, v6
    v_cndmask_b32 v112, v20, v18, s[52:53]
    v_cndmask_b32 v113, v20, v18, s[54:55]
    v_cndmask_b32 v114, v20, v18, s[72:73]
    v_cndmask_b32 v115, v20, v18, s[74:75]
    v_cmp_gt_i32 s[52:53], 16, v6
    v_cmp_gt_i32 s[54:55], 17, v6
    v_cmp_gt_i32 s[72:73], 18, v6
    v_cmp_gt_i32 s[74:75], 19, v6
    v_cndmask_b32 v116, v20, v18, s[52:53]
    v_cndmask_b32 v117, v20, v18, s[54:55]
    v_cndmask_b32 v118, v20, v18, s[72:73]
    v_cndmask_b32 v119, v20, v18, s[74:75]
    v_cmp_gt_i32 s[52:53], 0, v7
    v_cmp_gt_i32 s[54:55], 1, v7
    v_cmp_gt_i32 s[72:73], 2, v7
    v_cmp_gt_i32 s[74:75], 3, v7
    v_cndmask_b32 v120, v21, v18, s[52:53]
    v_cndmask_b32 v121, v21, v18, s[54:55]
    v_cndmask_b32 v122, v21, v18, s[72:73]
    v_cndmask_b32 v123, v21, v18, s[74:75]
    v_cmp_gt_i32 s[52:53], 16, v7
    v_cmp_gt_i32 s[54:55], 17, v7
    v_cmp_gt_i32 s[72:73], 18, v7
    v_cmp_gt_i32 s[74:75], 19, v7
    v_cndmask_b32 v124, v21, v18, s[52:53]
    v_cndmask_b32 v125, v21, v18, s[54:55]
    v_cndmask_b32 v126, v21, v18, s[72:73]
    v_cndmask_b32 v127, v21, v18, s[74:75]
    s_getpc_b64 s[12:13]
.Lmain_kernel_pc_124:
    s_sub_u32 s12, s12, .Lmain_kernel_pc_124-main_kernel
    s_subb_u32 s13, s13, 0
    s_and_b32 s13, s13, 0xffff
    s_mov_b32 s14, .Ltext_end-main_kernel
    s_mov_b32 s15, 0x00020000
    s_and_b32 s30, s2, 56
    s_lshl_b32 s30, s30, 12
    s_waitcnt vmcnt(10)
    v_lshlrev_b32 v1, 3, v14
    s_lshl_b32 s31, s20, 13
    v_add_u32 v1, s31, v1
    buffer_load_dword v1, v1, s[12:15], s30 offen
    s_branch .Lmain_kernel_maskr_126
.Lmain_kernel_mask_128:
    v_subrev_u32 v6, 32, v17
    v_add_u32 v7, 64, v6
    v_cmp_gt_i32 s[52:53], 0, v6
    v_cmp_gt_i32 s[54:55], 1, v6
    v_cmp_gt_i32 s[72:73], 2, v6
    v_cmp_gt_i32 s[74:75], 3, v6
    v_cndmask_b32 v112, v20, v18, s[52:53]
    v_cndmask_b32 v113, v20, v18, s[54:55]
    v_cndmask_b32 v114, v20, v18, s[72:73]
    v_cndmask_b32 v115, v20, v18, s[74:75]
    v_cmp_gt_i32 s[52:53], 16, v6
    v_cmp_gt_i32 s[54:55], 17, v6
    v_cmp_gt_i32 s[72:73], 18, v6
    v_cmp_gt_i32 s[74:75], 19, v6
    v_cndmask_b32 v116, v20, v18, s[52:53]
    v_cndmask_b32 v117, v20, v18, s[54:55]
    v_cndmask_b32 v118, v20, v18, s[72:73]
    v_cndmask_b32 v119, v20, v18, s[74:75]
    v_cmp_gt_i32 s[52:53], 0, v7
    v_cmp_gt_i32 s[54:55], 1, v7
    v_cmp_gt_i32 s[72:73], 2, v7
    v_cmp_gt_i32 s[74:75], 3, v7
    v_cndmask_b32 v120, v21, v18, s[52:53]
    v_cndmask_b32 v121, v21, v18, s[54:55]
    v_cndmask_b32 v122, v21, v18, s[72:73]
    v_cndmask_b32 v123, v21, v18, s[74:75]
    v_cmp_gt_i32 s[52:53], 16, v7
    v_cmp_gt_i32 s[54:55], 17, v7
    v_cmp_gt_i32 s[72:73], 18, v7
    v_cmp_gt_i32 s[74:75], 19, v7
    v_cndmask_b32 v124, v21, v18, s[52:53]
    v_cndmask_b32 v125, v21, v18, s[54:55]
    v_cndmask_b32 v126, v21, v18, s[72:73]
    v_cndmask_b32 v127, v21, v18, s[74:75]
    s_branch .Lmain_kernel_maskr_129
.Lmain_kernel_mask_131:
    v_subrev_u32 v6, 64, v17
    v_add_u32 v7, 64, v6
    v_cmp_gt_i32 s[52:53], 0, v6
    v_cmp_gt_i32 s[54:55], 1, v6
    v_cmp_gt_i32 s[72:73], 2, v6
    v_cmp_gt_i32 s[74:75], 3, v6
    v_cndmask_b32 v112, v20, v18, s[52:53]
    v_cndmask_b32 v113, v20, v18, s[54:55]
    v_cndmask_b32 v114, v20, v18, s[72:73]
    v_cndmask_b32 v115, v20, v18, s[74:75]
    v_cmp_gt_i32 s[52:53], 16, v6
    v_cmp_gt_i32 s[54:55], 17, v6
    v_cmp_gt_i32 s[72:73], 18, v6
    v_cmp_gt_i32 s[74:75], 19, v6
    v_cndmask_b32 v116, v20, v18, s[52:53]
    v_cndmask_b32 v117, v20, v18, s[54:55]
    v_cndmask_b32 v118, v20, v18, s[72:73]
    v_cndmask_b32 v119, v20, v18, s[74:75]
    v_cmp_gt_i32 s[52:53], 0, v7
    v_cmp_gt_i32 s[54:55], 1, v7
    v_cmp_gt_i32 s[72:73], 2, v7
    v_cmp_gt_i32 s[74:75], 3, v7
    v_cndmask_b32 v120, v21, v18, s[52:53]
    v_cndmask_b32 v121, v21, v18, s[54:55]
    v_cndmask_b32 v122, v21, v18, s[72:73]
    v_cndmask_b32 v123, v21, v18, s[74:75]
    v_cmp_gt_i32 s[52:53], 16, v7
    v_cmp_gt_i32 s[54:55], 17, v7
    v_cmp_gt_i32 s[72:73], 18, v7
    v_cmp_gt_i32 s[74:75], 19, v7
    v_cndmask_b32 v124, v21, v18, s[52:53]
    v_cndmask_b32 v125, v21, v18, s[54:55]
    v_cndmask_b32 v126, v21, v18, s[72:73]
    v_cndmask_b32 v127, v21, v18, s[74:75]
    s_branch .Lmain_kernel_maskr_132
.Lmain_kernel_mask_134:
    v_subrev_u32 v6, 96, v17
    v_add_u32 v7, 64, v6
    v_cmp_gt_i32 s[52:53], 0, v6
    v_cmp_gt_i32 s[54:55], 1, v6
    v_cmp_gt_i32 s[72:73], 2, v6
    v_cmp_gt_i32 s[74:75], 3, v6
    v_cndmask_b32 v112, v20, v18, s[52:53]
    v_cndmask_b32 v113, v20, v18, s[54:55]
    v_cndmask_b32 v114, v20, v18, s[72:73]
    v_cndmask_b32 v115, v20, v18, s[74:75]
    v_cmp_gt_i32 s[52:53], 16, v6
    v_cmp_gt_i32 s[54:55], 17, v6
    v_cmp_gt_i32 s[72:73], 18, v6
    v_cmp_gt_i32 s[74:75], 19, v6
    v_cndmask_b32 v116, v20, v18, s[52:53]
    v_cndmask_b32 v117, v20, v18, s[54:55]
    v_cndmask_b32 v118, v20, v18, s[72:73]
    v_cndmask_b32 v119, v20, v18, s[74:75]
    v_cmp_gt_i32 s[52:53], 0, v7
    v_cmp_gt_i32 s[54:55], 1, v7
    v_cmp_gt_i32 s[72:73], 2, v7
    v_cmp_gt_i32 s[74:75], 3, v7
    v_cndmask_b32 v120, v21, v18, s[52:53]
    v_cndmask_b32 v121, v21, v18, s[54:55]
    v_cndmask_b32 v122, v21, v18, s[72:73]
    v_cndmask_b32 v123, v21, v18, s[74:75]
    v_cmp_gt_i32 s[52:53], 16, v7
    v_cmp_gt_i32 s[54:55], 17, v7
    v_cmp_gt_i32 s[72:73], 18, v7
    v_cmp_gt_i32 s[74:75], 19, v7
    v_cndmask_b32 v124, v21, v18, s[52:53]
    v_cndmask_b32 v125, v21, v18, s[54:55]
    v_cndmask_b32 v126, v21, v18, s[72:73]
    v_cndmask_b32 v127, v21, v18, s[74:75]
    s_xor_b32 s30, s3, 0x3c00
    buffer_load_dword v1, off, s[16:19], s30 offset:128 sc1
    s_branch .Lmain_kernel_maskr_135
.Lmain_kernel_mask_138:
    v_subrev_u32 v6, 0, v17
    v_add_u32 v7, 64, v6
    v_cmp_gt_i32 s[52:53], 0, v6
    v_cmp_gt_i32 s[54:55], 1, v6
    v_cmp_gt_i32 s[72:73], 2, v6
    v_cmp_gt_i32 s[74:75], 3, v6
    v_cndmask_b32 v112, v20, v18, s[52:53]
    v_cndmask_b32 v113, v20, v18, s[54:55]
    v_cndmask_b32 v114, v20, v18, s[72:73]
    v_cndmask_b32 v115, v20, v18, s[74:75]
    v_cmp_gt_i32 s[52:53], 16, v6
    v_cmp_gt_i32 s[54:55], 17, v6
    v_cmp_gt_i32 s[72:73], 18, v6
    v_cmp_gt_i32 s[74:75], 19, v6
    v_cndmask_b32 v116, v20, v18, s[52:53]
    v_cndmask_b32 v117, v20, v18, s[54:55]
    v_cndmask_b32 v118, v20, v18, s[72:73]
    v_cndmask_b32 v119, v20, v18, s[74:75]
    v_cmp_gt_i32 s[52:53], 0, v7
    v_cmp_gt_i32 s[54:55], 1, v7
    v_cmp_gt_i32 s[72:73], 2, v7
    v_cmp_gt_i32 s[74:75], 3, v7
    v_cndmask_b32 v120, v21, v18, s[52:53]
    v_cndmask_b32 v121, v21, v18, s[54:55]
    v_cndmask_b32 v122, v21, v18, s[72:73]
    v_cndmask_b32 v123, v21, v18, s[74:75]
    v_cmp_gt_i32 s[52:53], 16, v7
    v_cmp_gt_i32 s[54:55], 17, v7
    v_cmp_gt_i32 s[72:73], 18, v7
    v_cmp_gt_i32 s[74:75], 19, v7
    v_cndmask_b32 v124, v21, v18, s[52:53]
    v_cndmask_b32 v125, v21, v18, s[54:55]
    v_cndmask_b32 v126, v21, v18, s[72:73]
    v_cndmask_b32 v127, v21, v18, s[74:75]
    s_getpc_b64 s[12:13]
.Lmain_kernel_pc_137:
    s_sub_u32 s12, s12, .Lmain_kernel_pc_137-main_kernel
    s_subb_u32 s13, s13, 0
    s_and_b32 s13, s13, 0xffff
    s_mov_b32 s14, .Ltext_end-main_kernel
    s_mov_b32 s15, 0x00020000
    s_and_b32 s30, s2, 56
    s_lshl_b32 s30, s30, 12
    s_waitcnt vmcnt(8)
    v_lshlrev_b32 v1, 3, v14
    s_lshl_b32 s31, s20, 13
    v_add_u32 v1, s31, v1
    buffer_load_dword v1, v1, s[12:15], s30 offen
    s_branch .Lmain_kernel_maskr_139
.Lmain_kernel_mask_141:
    v_subrev_u32 v6, 32, v17
    v_add_u32 v7, 64, v6
    v_cmp_gt_i32 s[52:53], 0, v6
    v_cmp_gt_i32 s[54:55], 1, v6
    v_cmp_gt_i32 s[72:73], 2, v6
    v_cmp_gt_i32 s[74:75], 3, v6
    v_cndmask_b32 v112, v20, v18, s[52:53]
    v_cndmask_b32 v113, v20, v18, s[54:55]
    v_cndmask_b32 v114, v20, v18, s[72:73]
    v_cndmask_b32 v115, v20, v18, s[74:75]
    v_cmp_gt_i32 s[52:53], 16, v6
    v_cmp_gt_i32 s[54:55], 17, v6
    v_cmp_gt_i32 s[72:73], 18, v6
    v_cmp_gt_i32 s[74:75], 19, v6
    v_cndmask_b32 v116, v20, v18, s[52:53]
    v_cndmask_b32 v117, v20, v18, s[54:55]
    v_cndmask_b32 v118, v20, v18, s[72:73]
    v_cndmask_b32 v119, v20, v18, s[74:75]
    v_cmp_gt_i32 s[52:53], 0, v7
    v_cmp_gt_i32 s[54:55], 1, v7
    v_cmp_gt_i32 s[72:73], 2, v7
    v_cmp_gt_i32 s[74:75], 3, v7
    v_cndmask_b32 v120, v21, v18, s[52:53]
    v_cndmask_b32 v121, v21, v18, s[54:55]
    v_cndmask_b32 v122, v21, v18, s[72:73]
    v_cndmask_b32 v123, v21, v18, s[74:75]
    v_cmp_gt_i32 s[52:53], 16, v7
    v_cmp_gt_i32 s[54:55], 17, v7
    v_cmp_gt_i32 s[72:73], 18, v7
    v_cmp_gt_i32 s[74:75], 19, v7
    v_cndmask_b32 v124, v21, v18, s[52:53]
    v_cndmask_b32 v125, v21, v18, s[54:55]
    v_cndmask_b32 v126, v21, v18, s[72:73]
    v_cndmask_b32 v127, v21, v18, s[74:75]
    s_branch .Lmain_kernel_maskr_142
.Lmain_kernel_mask_144:
    v_subrev_u32 v6, 64, v17
    v_add_u32 v7, 64, v6
    v_cmp_gt_i32 s[52:53], 0, v6
    v_cmp_gt_i32 s[54:55], 1, v6
    v_cmp_gt_i32 s[72:73], 2, v6
    v_cmp_gt_i32 s[74:75], 3, v6
    v_cndmask_b32 v112, v20, v18, s[52:53]
    v_cndmask_b32 v113, v20, v18, s[54:55]
    v_cndmask_b32 v114, v20, v18, s[72:73]
    v_cndmask_b32 v115, v20, v18, s[74:75]
    v_cmp_gt_i32 s[52:53], 16, v6
    v_cmp_gt_i32 s[54:55], 17, v6
    v_cmp_gt_i32 s[72:73], 18, v6
    v_cmp_gt_i32 s[74:75], 19, v6
    v_cndmask_b32 v116, v20, v18, s[52:53]
    v_cndmask_b32 v117, v20, v18, s[54:55]
    v_cndmask_b32 v118, v20, v18, s[72:73]
    v_cndmask_b32 v119, v20, v18, s[74:75]
    v_cmp_gt_i32 s[52:53], 0, v7
    v_cmp_gt_i32 s[54:55], 1, v7
    v_cmp_gt_i32 s[72:73], 2, v7
    v_cmp_gt_i32 s[74:75], 3, v7
    v_cndmask_b32 v120, v21, v18, s[52:53]
    v_cndmask_b32 v121, v21, v18, s[54:55]
    v_cndmask_b32 v122, v21, v18, s[72:73]
    v_cndmask_b32 v123, v21, v18, s[74:75]
    v_cmp_gt_i32 s[52:53], 16, v7
    v_cmp_gt_i32 s[54:55], 17, v7
    v_cmp_gt_i32 s[72:73], 18, v7
    v_cmp_gt_i32 s[74:75], 19, v7
    v_cndmask_b32 v124, v21, v18, s[52:53]
    v_cndmask_b32 v125, v21, v18, s[54:55]
    v_cndmask_b32 v126, v21, v18, s[72:73]
    v_cndmask_b32 v127, v21, v18, s[74:75]
    s_branch .Lmain_kernel_maskr_145
.Lmain_kernel_mask_147:
    v_subrev_u32 v6, 96, v17
    v_add_u32 v7, 64, v6
    v_cmp_gt_i32 s[52:53], 0, v6
    v_cmp_gt_i32 s[54:55], 1, v6
    v_cmp_gt_i32 s[72:73], 2, v6
    v_cmp_gt_i32 s[74:75], 3, v6
    v_cndmask_b32 v112, v20, v18, s[52:53]
    v_cndmask_b32 v113, v20, v18, s[54:55]
    v_cndmask_b32 v114, v20, v18, s[72:73]
    v_cndmask_b32 v115, v20, v18, s[74:75]
    v_cmp_gt_i32 s[52:53], 16, v6
    v_cmp_gt_i32 s[54:55], 17, v6
    v_cmp_gt_i32 s[72:73], 18, v6
    v_cmp_gt_i32 s[74:75], 19, v6
    v_cndmask_b32 v116, v20, v18, s[52:53]
    v_cndmask_b32 v117, v20, v18, s[54:55]
    v_cndmask_b32 v118, v20, v18, s[72:73]
    v_cndmask_b32 v119, v20, v18, s[74:75]
    v_cmp_gt_i32 s[52:53], 0, v7
    v_cmp_gt_i32 s[54:55], 1, v7
    v_cmp_gt_i32 s[72:73], 2, v7
    v_cmp_gt_i32 s[74:75], 3, v7
    v_cndmask_b32 v120, v21, v18, s[52:53]
    v_cndmask_b32 v121, v21, v18, s[54:55]
    v_cndmask_b32 v122, v21, v18, s[72:73]
    v_cndmask_b32 v123, v21, v18, s[74:75]
    v_cmp_gt_i32 s[52:53], 16, v7
    v_cmp_gt_i32 s[54:55], 17, v7
    v_cmp_gt_i32 s[72:73], 18, v7
    v_cmp_gt_i32 s[74:75], 19, v7
    v_cndmask_b32 v124, v21, v18, s[52:53]
    v_cndmask_b32 v125, v21, v18, s[54:55]
    v_cndmask_b32 v126, v21, v18, s[72:73]
    v_cndmask_b32 v127, v21, v18, s[74:75]
    s_xor_b32 s30, s3, 0x3c00
    buffer_load_dword v1, off, s[16:19], s30 offset:128 sc1
    s_branch .Lmain_kernel_maskr_148
.Lmain_kernel_spin_155:
    s_mov_b32 s31, 0
.Lmain_kernel_sp2_156:
    s_add_u32 s31, s31, 1
    s_cmp_gt_u32 s31, 0x40000
    s_cbranch_scc1 .Lmain_kernel_pok_154
    s_sleep 2
    s_xor_b32 s30, s3, 0x3c00
    buffer_load_dword v1, off, s[16:19], s30 offset:128 sc1
    s_waitcnt vmcnt(0)
    v_and_b32 v1, 1, v1
    v_cmp_ne_u32 vcc, 1, v1
    s_nop 0
    s_cbranch_vccnz .Lmain_kernel_sp2_156
    s_branch .Lmain_kernel_pok_154
.Lmain_kernel_rare_157:
    v_max3_f32 v2, v80, v81, v82
    v_max3_f32 v3, v88, v89, v90
    v_max3_f32 v2, v2, v83, v84
    v_max3_f32 v3, v3, v91, v92
    v_max3_f32 v2, v2, v85, v86
    v_max3_f32 v3, v3, v93, v94
    v_max_f32 v2, v2, v87
    v_max_f32 v3, v3, v95
    s_nop 1
    v_permlane32_swap_b32 v2, v3
    v_max_f32 v2, v2, v3
    v_mov_b32 v4, v2
    s_nop 1
    v_permlane16_swap_b32 v2, v4
    v_max_f32 v2, v2, v4
    v_mov_b32 v3, v2
    s_nop 1
    v_permlane32_swap_b32 v2, v3
    v_max_f32 v2, 0, v2
    v_exp_f32 v4, -v2
    v_sub_f32 v20, v20, v2
    v_mul_f32 v22, v22, v4
    v_max_f32 v3, 0, v3
    v_exp_f32 v5, -v3
    v_sub_f32 v21, v21, v3
    v_mul_f32 v23, v23, v5
    v_mul_f32 v32, v32, v4
    v_mul_f32 v33, v33, v4
    v_mul_f32 v34, v34, v4
    v_mul_f32 v35, v35, v4
    v_mul_f32 v36, v36, v4
    v_mul_f32 v37, v37, v4
    v_mul_f32 v38, v38, v4
    v_mul_f32 v39, v39, v4
    v_mul_f32 v40, v40, v5
    v_mul_f32 v41, v41, v5
    v_mul_f32 v42, v42, v5
    v_mul_f32 v43, v43, v5
    v_mul_f32 v44, v44, v5
    v_mul_f32 v45, v45, v5
    v_mul_f32 v46, v46, v5
    v_mul_f32 v47, v47, v5
    v_mul_f32 v96, v96, v4
    v_mul_f32 v97, v97, v4
    v_mul_f32 v98, v98, v4
    v_mul_f32 v99, v99, v4
    v_mul_f32 v100, v100, v4
    v_mul_f32 v101, v101, v4
    v_mul_f32 v102, v102, v4
    v_mul_f32 v103, v103, v4
    v_mul_f32 v104, v104, v5
    v_mul_f32 v105, v105, v5
    v_mul_f32 v106, v106, v5
    v_mul_f32 v107, v107, v5
    v_mul_f32 v108, v108, v5
    v_mul_f32 v109, v109, v5
    v_mul_f32 v110, v110, v5
    v_mul_f32 v111, v111, v5
    v_mul_f32 v160, v160, v4
    v_mul_f32 v161, v161, v4
    v_mul_f32 v162, v162, v4
    v_mul_f32 v163, v163, v4
    v_mul_f32 v164, v164, v4
    v_mul_f32 v165, v165, v4
    v_mul_f32 v166, v166, v4
    v_mul_f32 v167, v167, v4
    v_mul_f32 v168, v168, v5
    v_mul_f32 v169, v169, v5
    v_mul_f32 v170, v170, v5
    v_mul_f32 v171, v171, v5
    v_mul_f32 v172, v172, v5
    v_mul_f32 v173, v173, v5
    v_mul_f32 v174, v174, v5
    v_mul_f32 v175, v175, v5
    v_mul_f32 v176, v176, v4
    v_mul_f32 v177, v177, v4
    v_mul_f32 v178, v178, v4
    v_mul_f32 v179, v179, v4
    v_mul_f32 v180, v180, v4
    v_mul_f32 v181, v181, v4
    v_mul_f32 v182, v182, v4
    v_mul_f32 v183, v183, v4
    v_mul_f32 v184, v184, v5
    v_mul_f32 v185, v185, v5
    v_mul_f32 v186, v186, v5
    v_mul_f32 v187, v187, v5
    v_mul_f32 v188, v188, v5
    v_mul_f32 v189, v189, v5
    v_mul_f32 v190, v190, v5
    v_mul_f32 v191, v191, v5
    v_mul_f32 v192, v192, v4
    v_mul_f32 v193, v193, v4
    v_mul_f32 v194, v194, v4
    v_mul_f32 v195, v195, v4
    v_mul_f32 v196, v196, v4
    v_mul_f32 v197, v197, v4
    v_mul_f32 v198, v198, v4
    v_mul_f32 v199, v199, v4
    v_mul_f32 v200, v200, v5
    v_mul_f32 v201, v201, v5
    v_mul_f32 v202, v202, v5
    v_mul_f32 v203, v203, v5
    v_mul_f32 v204, v204, v5
    v_mul_f32 v205, v205, v5
    v_mul_f32 v206, v206, v5
    v_mul_f32 v207, v207, v5
    v_mul_f32 v208, v208, v4
    v_mul_f32 v209, v209, v4
    v_mul_f32 v210, v210, v4
    v_mul_f32 v211, v211, v4
    v_mul_f32 v212, v212, v4
    v_mul_f32 v213, v213, v4
    v_mul_f32 v214, v214, v4
    v_mul_f32 v215, v215, v4
    v_mul_f32 v216, v216, v5
    v_mul_f32 v217, v217, v5
    v_mul_f32 v218, v218, v5
    v_mul_f32 v219, v219, v5
    v_mul_f32 v220, v220, v5
    v_mul_f32 v221, v221, v5
    v_mul_f32 v222, v222, v5
    v_mul_f32 v223, v223, v5
    v_mul_f32 v224, v224, v4
    v_mul_f32 v225, v225, v4
    v_mul_f32 v226, v226, v4
    v_mul_f32 v227, v227, v4
    v_mul_f32 v228, v228, v4
    v_mul_f32 v229, v229, v4
    v_mul_f32 v230, v230, v4
    v_mul_f32 v231, v231, v4
    v_mul_f32 v232, v232, v5
    v_mul_f32 v233, v233, v5
    v_mul_f32 v234, v234, v5
    v_mul_f32 v235, v235, v5
    v_mul_f32 v236, v236, v5
    v_mul_f32 v237, v237, v5
    v_mul_f32 v238, v238, v5
    v_mul_f32 v239, v239, v5
    v_mul_f32 v240, v240, v4
    v_mul_f32 v241, v241, v4
    v_mul_f32 v242, v242, v4
    v_mul_f32 v243, v243, v4
    v_mul_f32 v244, v244, v4
    v_mul_f32 v245, v245, v4
    v_mul_f32 v246, v246, v4
    v_mul_f32 v247, v247, v4
    v_mul_f32 v248, v248, v5
    v_mul_f32 v249, v249, v5
    v_mul_f32 v250, v250, v5
    v_mul_f32 v251, v251, v5
    v_mul_f32 v252, v252, v5
    v_mul_f32 v253, v253, v5
    v_mul_f32 v254, v254, v5
    v_mul_f32 v255, v255, v5
    v_sub_f32 v48, v80, v2
    v_exp_f32 v48, v48
    v_sub_f32 v49, v81, v2
    v_exp_f32 v49, v49
    v_sub_f32 v50, v82, v2
    v_exp_f32 v50, v50
    v_add_f32 v8, v48, v49
    v_sub_f32 v51, v83, v2
    v_exp_f32 v51, v51
    v_add_f32 v8, v8, v50
    v_sub_f32 v56, v88, v3
    v_exp_f32 v56, v56
    v_add_f32 v8, v8, v51
    v_sub_f32 v57, v89, v3
    v_exp_f32 v57, v57
    v_sub_f32 v58, v90, v3
    v_exp_f32 v58, v58
    v_add_f32 v9, v56, v57
    v_sub_f32 v59, v91, v3
    v_exp_f32 v59, v59
    v_add_f32 v9, v9, v58
    v_sub_f32 v52, v84, v2
    v_exp_f32 v52, v52
    v_add_f32 v9, v9, v59
    v_sub_f32 v53, v85, v2
    v_exp_f32 v53, v53
    v_add_f32 v8, v8, v52
    v_sub_f32 v54, v86, v2
    v_exp_f32 v54, v54
    v_add_f32 v8, v8, v53
    v_sub_f32 v55, v87, v2
    v_exp_f32 v55, v55
    v_add_f32 v8, v8, v54
    v_sub_f32 v60, v92, v3
    v_exp_f32 v60, v60
    v_add_f32 v8, v8, v55
    v_sub_f32 v61, v93, v3
    v_exp_f32 v61, v61
    v_add_f32 v9, v9, v60
    v_sub_f32 v62, v94, v3
    v_exp_f32 v62, v62
    v_add_f32 v9, v9, v61
    v_sub_f32 v63, v95, v3
    v_exp_f32 v63, v63
    v_add_f32 v9, v9, v62
    v_add_f32 v9, v9, v63
    v_cvt_pk_bf16_f32 v64, v48, v49
    v_cvt_pk_bf16_f32 v65, v50, v51
    v_cvt_pk_bf16_f32 v66, v52, v53
    v_cvt_pk_bf16_f32 v67, v54, v55
    v_cvt_pk_bf16_f32 v68, v56, v57
    v_cvt_pk_bf16_f32 v69, v58, v59
    v_cvt_pk_bf16_f32 v70, v60, v61
    v_cvt_pk_bf16_f32 v71, v62, v63
    s_branch .Lmain_kernel_rarer_158
.Lmain_kernel_rare_159:
    v_max3_f32 v2, v80, v81, v82
    v_max3_f32 v3, v88, v89, v90
    v_max3_f32 v2, v2, v83, v84
    v_max3_f32 v3, v3, v91, v92
    v_max3_f32 v2, v2, v85, v86
    v_max3_f32 v3, v3, v93, v94
    v_max_f32 v2, v2, v87
    v_max_f32 v3, v3, v95
    s_nop 1
    v_permlane32_swap_b32 v2, v3
    v_max_f32 v2, v2, v3
    v_mov_b32 v4, v2
    s_nop 1
    v_permlane16_swap_b32 v2, v4
    v_max_f32 v2, v2, v4
    v_mov_b32 v3, v2
    s_nop 1
    v_permlane32_swap_b32 v2, v3
    v_max_f32 v2, 0, v2
    v_exp_f32 v4, -v2
    v_sub_f32 v20, v20, v2
    v_mul_f32 v22, v22, v4
    v_max_f32 v3, 0, v3
    v_exp_f32 v5, -v3
    v_sub_f32 v21, v21, v3
    v_mul_f32 v23, v23, v5
    v_mul_f32 v32, v32, v4
    v_mul_f32 v33, v33, v4
    v_mul_f32 v34, v34, v4
    v_mul_f32 v35, v35, v4
    v_mul_f32 v36, v36, v4
    v_mul_f32 v37, v37, v4
    v_mul_f32 v38, v38, v4
    v_mul_f32 v39, v39, v4
    v_mul_f32 v40, v40, v5
    v_mul_f32 v41, v41, v5
    v_mul_f32 v42, v42, v5
    v_mul_f32 v43, v43, v5
    v_mul_f32 v44, v44, v5
    v_mul_f32 v45, v45, v5
    v_mul_f32 v46, v46, v5
    v_mul_f32 v47, v47, v5
    v_mul_f32 v96, v96, v4
    v_mul_f32 v97, v97, v4
    v_mul_f32 v98, v98, v4
    v_mul_f32 v99, v99, v4
    v_mul_f32 v100, v100, v4
    v_mul_f32 v101, v101, v4
    v_mul_f32 v102, v102, v4
    v_mul_f32 v103, v103, v4
    v_mul_f32 v104, v104, v5
    v_mul_f32 v105, v105, v5
    v_mul_f32 v106, v106, v5
    v_mul_f32 v107, v107, v5
    v_mul_f32 v108, v108, v5
    v_mul_f32 v109, v109, v5
    v_mul_f32 v110, v110, v5
    v_mul_f32 v111, v111, v5
    v_mul_f32 v160, v160, v4
    v_mul_f32 v161, v161, v4
    v_mul_f32 v162, v162, v4
    v_mul_f32 v163, v163, v4
    v_mul_f32 v164, v164, v4
    v_mul_f32 v165, v165, v4
    v_mul_f32 v166, v166, v4
    v_mul_f32 v167, v167, v4
    v_mul_f32 v168, v168, v5
    v_mul_f32 v169, v169, v5
    v_mul_f32 v170, v170, v5
    v_mul_f32 v171, v171, v5
    v_mul_f32 v172, v172, v5
    v_mul_f32 v173, v173, v5
    v_mul_f32 v174, v174, v5
    v_mul_f32 v175, v175, v5
    v_mul_f32 v176, v176, v4
    v_mul_f32 v177, v177, v4
    v_mul_f32 v178, v178, v4
    v_mul_f32 v179, v179, v4
    v_mul_f32 v180, v180, v4
    v_mul_f32 v181, v181, v4
    v_mul_f32 v182, v182, v4
    v_mul_f32 v183, v183, v4
    v_mul_f32 v184, v184, v5
    v_mul_f32 v185, v185, v5
    v_mul_f32 v186, v186, v5
    v_mul_f32 v187, v187, v5
    v_mul_f32 v188, v188, v5
    v_mul_f32 v189, v189, v5
    v_mul_f32 v190, v190, v5
    v_mul_f32 v191, v191, v5
    v_mul_f32 v192, v192, v4
    v_mul_f32 v193, v193, v4
    v_mul_f32 v194, v194, v4
    v_mul_f32 v195, v195, v4
    v_mul_f32 v196, v196, v4
    v_mul_f32 v197, v197, v4
    v_mul_f32 v198, v198, v4
    v_mul_f32 v199, v199, v4
    v_mul_f32 v200, v200, v5
    v_mul_f32 v201, v201, v5
    v_mul_f32 v202, v202, v5
    v_mul_f32 v203, v203, v5
    v_mul_f32 v204, v204, v5
    v_mul_f32 v205, v205, v5
    v_mul_f32 v206, v206, v5
    v_mul_f32 v207, v207, v5
    v_mul_f32 v208, v208, v4
    v_mul_f32 v209, v209, v4
    v_mul_f32 v210, v210, v4
    v_mul_f32 v211, v211, v4
    v_mul_f32 v212, v212, v4
    v_mul_f32 v213, v213, v4
    v_mul_f32 v214, v214, v4
    v_mul_f32 v215, v215, v4
    v_mul_f32 v216, v216, v5
    v_mul_f32 v217, v217, v5
    v_mul_f32 v218, v218, v5
    v_mul_f32 v219, v219, v5
    v_mul_f32 v220, v220, v5
    v_mul_f32 v221, v221, v5
    v_mul_f32 v222, v222, v5
    v_mul_f32 v223, v223, v5
    v_mul_f32 v224, v224, v4
    v_mul_f32 v225, v225, v4
    v_mul_f32 v226, v226, v4
    v_mul_f32 v227, v227, v4
    v_mul_f32 v228, v228, v4
    v_mul_f32 v229, v229, v4
    v_mul_f32 v230, v230, v4
    v_mul_f32 v231, v231, v4
    v_mul_f32 v232, v232, v5
    v_mul_f32 v233, v233, v5
    v_mul_f32 v234, v234, v5
    v_mul_f32 v235, v235, v5
    v_mul_f32 v236, v236, v5
    v_mul_f32 v237, v237, v5
    v_mul_f32 v238, v238, v5
    v_mul_f32 v239, v239, v5
    v_mul_f32 v240, v240, v4
    v_mul_f32 v241, v241, v4
    v_mul_f32 v242, v242, v4
    v_mul_f32 v243, v243, v4
    v_mul_f32 v244, v244, v4
    v_mul_f32 v245, v245, v4
    v_mul_f32 v246, v246, v4
    v_mul_f32 v247, v247, v4
    v_mul_f32 v248, v248, v5
    v_mul_f32 v249, v249, v5
    v_mul_f32 v250, v250, v5
    v_mul_f32 v251, v251, v5
    v_mul_f32 v252, v252, v5
    v_mul_f32 v253, v253, v5
    v_mul_f32 v254, v254, v5
    v_mul_f32 v255, v255, v5
    v_sub_f32 v48, v80, v2
    v_exp_f32 v48, v48
    v_sub_f32 v49, v81, v2
    v_exp_f32 v49, v49
    v_sub_f32 v50, v82, v2
    v_exp_f32 v50, v50
    v_add_f32 v8, v48, v49
    v_sub_f32 v51, v83, v2
    v_exp_f32 v51, v51
    v_add_f32 v8, v8, v50
    v_sub_f32 v56, v88, v3
    v_exp_f32 v56, v56
    v_add_f32 v8, v8, v51
    v_sub_f32 v57, v89, v3
    v_exp_f32 v57, v57
    v_sub_f32 v58, v90, v3
    v_exp_f32 v58, v58
    v_add_f32 v9, v56, v57
    v_sub_f32 v59, v91, v3
    v_exp_f32 v59, v59
    v_add_f32 v9, v9, v58
    v_sub_f32 v52, v84, v2
    v_exp_f32 v52, v52
    v_add_f32 v9, v9, v59
    v_sub_f32 v53, v85, v2
    v_exp_f32 v53, v53
    v_add_f32 v8, v8, v52
    v_sub_f32 v54, v86, v2
    v_exp_f32 v54, v54
    v_add_f32 v8, v8, v53
    v_sub_f32 v55, v87, v2
    v_exp_f32 v55, v55
    v_add_f32 v8, v8, v54
    v_sub_f32 v60, v92, v3
    v_exp_f32 v60, v60
    v_add_f32 v8, v8, v55
    v_sub_f32 v61, v93, v3
    v_exp_f32 v61, v61
    v_add_f32 v9, v9, v60
    v_sub_f32 v62, v94, v3
    v_exp_f32 v62, v62
    v_add_f32 v9, v9, v61
    v_sub_f32 v63, v95, v3
    v_exp_f32 v63, v63
    v_add_f32 v9, v9, v62
    v_add_f32 v9, v9, v63
    v_cvt_pk_bf16_f32 v64, v48, v49
    v_cvt_pk_bf16_f32 v65, v50, v51
    v_cvt_pk_bf16_f32 v66, v52, v53
    v_cvt_pk_bf16_f32 v67, v54, v55
    v_cvt_pk_bf16_f32 v68, v56, v57
    v_cvt_pk_bf16_f32 v69, v58, v59
    v_cvt_pk_bf16_f32 v70, v60, v61
    v_cvt_pk_bf16_f32 v71, v62, v63
    s_branch .Lmain_kernel_rarer_160
.Lmain_kernel_rare_161:
    ds_read_b128 v[120:123], v14 offset:10240
    s_waitcnt lgkmcnt(0)
    v_mfma_f32_16x16x32_bf16 v[208:211], v[120:123], v[24:27], v[208:211]
    v_mfma_f32_16x16x32_bf16 v[216:219], v[120:123], v[28:31], v[216:219]
    ds_read_b128 v[124:127], v14 offset:11264
    s_waitcnt lgkmcnt(0)
    v_mfma_f32_16x16x32_bf16 v[212:215], v[124:127], v[24:27], v[212:215]
    v_mfma_f32_16x16x32_bf16 v[220:223], v[124:127], v[28:31], v[220:223]
    ds_read_b128 v[112:115], v14 offset:12288
    s_waitcnt lgkmcnt(0)
    v_mfma_f32_16x16x32_bf16 v[224:227], v[112:115], v[24:27], v[224:227]
    v_mfma_f32_16x16x32_bf16 v[232:235], v[112:115], v[28:31], v[232:235]
    ds_read_b128 v[116:119], v14 offset:13312
    s_waitcnt lgkmcnt(0)
    v_mfma_f32_16x16x32_bf16 v[228:231], v[116:119], v[24:27], v[228:231]
    v_mfma_f32_16x16x32_bf16 v[236:239], v[116:119], v[28:31], v[236:239]
    ds_read_b128 v[120:123], v14 offset:14336
    s_waitcnt lgkmcnt(0)
    v_mfma_f32_16x16x32_bf16 v[240:243], v[120:123], v[24:27], v[240:243]
    v_mfma_f32_16x16x32_bf16 v[248:251], v[120:123], v[28:31], v[248:251]
    ds_read_b128 v[124:127], v14 offset:15360
    s_waitcnt lgkmcnt(0)
    v_mfma_f32_16x16x32_bf16 v[244:247], v[124:127], v[24:27], v[244:247]
    v_mfma_f32_16x16x32_bf16 v[252:255], v[124:127], v[28:31], v[252:255]
    v_mov_b32 v24, 0
    v_mov_b32 v25, 0
    v_mov_b32 v26, 0
    v_mov_b32 v27, 0
    v_mov_b32 v28, 0
    v_mov_b32 v29, 0
    v_mov_b32 v30, 0
    v_mov_b32 v31, 0
    v_max3_f32 v2, v80, v81, v82
    v_max3_f32 v3, v88, v89, v90
    v_max3_f32 v2, v2, v83, v84
    v_max3_f32 v3, v3, v91, v92
    v_max3_f32 v2, v2, v85, v86
    v_max3_f32 v3, v3, v93, v94
    v_max_f32 v2, v2, v87
    v_max_f32 v3, v3, v95
    s_nop 1
    v_permlane32_swap_b32 v2, v3
    v_max_f32 v2, v2, v3
    v_mov_b32 v4, v2
    s_nop 1
    v_permlane16_swap_b32 v2, v4
    v_max_f32 v2, v2, v4
    v_mov_b32 v3, v2
    s_nop 1
    v_permlane32_swap_b32 v2, v3
    v_max_f32 v2, 0, v2
    v_exp_f32 v4, -v2
    v_sub_f32 v20, v20, v2
    v_mul_f32 v22, v22, v4
    v_max_f32 v3, 0, v3
    v_exp_f32 v5, -v3
    v_sub_f32 v21, v21, v3
    v_mul_f32 v23, v23, v5
    v_mul_f32 v32, v32, v4
    v_mul_f32 v33, v33, v4
    v_mul_f32 v34, v34, v4
    v_mul_f32 v35, v35, v4
    v_mul_f32 v36, v36, v4
    v_mul_f32 v37, v37, v4
    v_mul_f32 v38, v38, v4
    v_mul_f32 v39, v39, v4
    v_mul_f32 v40, v40, v5
    v_mul_f32 v41, v41, v5
    v_mul_f32 v42, v42, v5
    v_mul_f32 v43, v43, v5
    v_mul_f32 v44, v44, v5
    v_mul_f32 v45, v45, v5
    v_mul_f32 v46, v46, v5
    v_mul_f32 v47, v47, v5
    v_mul_f32 v96, v96, v4
    v_mul_f32 v97, v97, v4
    v_mul_f32 v98, v98, v4
    v_mul_f32 v99, v99, v4
    v_mul_f32 v100, v100, v4
    v_mul_f32 v101, v101, v4
    v_mul_f32 v102, v102, v4
    v_mul_f32 v103, v103, v4
    v_mul_f32 v104, v104, v5
    v_mul_f32 v105, v105, v5
    v_mul_f32 v106, v106, v5
    v_mul_f32 v107, v107, v5
    v_mul_f32 v108, v108, v5
    v_mul_f32 v109, v109, v5
    v_mul_f32 v110, v110, v5
    v_mul_f32 v111, v111, v5
    v_mul_f32 v160, v160, v4
    v_mul_f32 v161, v161, v4
    v_mul_f32 v162, v162, v4
    v_mul_f32 v163, v163, v4
    v_mul_f32 v164, v164, v4
    v_mul_f32 v165, v165, v4
    v_mul_f32 v166, v166, v4
    v_mul_f32 v167, v167, v4
    v_mul_f32 v168, v168, v5
    v_mul_f32 v169, v169, v5
    v_mul_f32 v170, v170, v5
    v_mul_f32 v171, v171, v5
    v_mul_f32 v172, v172, v5
    v_mul_f32 v173, v173, v5
    v_mul_f32 v174, v174, v5
    v_mul_f32 v175, v175, v5
    v_mul_f32 v176, v176, v4
    v_mul_f32 v177, v177, v4
    v_mul_f32 v178, v178, v4
    v_mul_f32 v179, v179, v4
    v_mul_f32 v180, v180, v4
    v_mul_f32 v181, v181, v4
    v_mul_f32 v182, v182, v4
    v_mul_f32 v183, v183, v4
    v_mul_f32 v184, v184, v5
    v_mul_f32 v185, v185, v5
    v_mul_f32 v186, v186, v5
    v_mul_f32 v187, v187, v5
    v_mul_f32 v188, v188, v5
    v_mul_f32 v189, v189, v5
    v_mul_f32 v190, v190, v5
    v_mul_f32 v191, v191, v5
    v_mul_f32 v192, v192, v4
    v_mul_f32 v193, v193, v4
    v_mul_f32 v194, v194, v4
    v_mul_f32 v195, v195, v4
    v_mul_f32 v196, v196, v4
    v_mul_f32 v197, v197, v4
    v_mul_f32 v198, v198, v4
    v_mul_f32 v199, v199, v4
    v_mul_f32 v200, v200, v5
    v_mul_f32 v201, v201, v5
    v_mul_f32 v202, v202, v5
    v_mul_f32 v203, v203, v5
    v_mul_f32 v204, v204, v5
    v_mul_f32 v205, v205, v5
    v_mul_f32 v206, v206, v5
    v_mul_f32 v207, v207, v5
    v_mul_f32 v208, v208, v4
    v_mul_f32 v209, v209, v4
    v_mul_f32 v210, v210, v4
    v_mul_f32 v211, v211, v4
    v_mul_f32 v212, v212, v4
    v_mul_f32 v213, v213, v4
    v_mul_f32 v214, v214, v4
    v_mul_f32 v215, v215, v4
    v_mul_f32 v216, v216, v5
    v_mul_f32 v217, v217, v5
    v_mul_f32 v218, v218, v5
    v_mul_f32 v219, v219, v5
    v_mul_f32 v220, v220, v5
    v_mul_f32 v221, v221, v5
    v_mul_f32 v222, v222, v5
    v_mul_f32 v223, v223, v5
    v_mul_f32 v224, v224, v4
    v_mul_f32 v225, v225, v4
    v_mul_f32 v226, v226, v4
    v_mul_f32 v227, v227, v4
    v_mul_f32 v228, v228, v4
    v_mul_f32 v229, v229, v4
    v_mul_f32 v230, v230, v4
    v_mul_f32 v231, v231, v4
    v_mul_f32 v232, v232, v5
    v_mul_f32 v233, v233, v5
    v_mul_f32 v234, v234, v5
    v_mul_f32 v235, v235, v5
    v_mul_f32 v236, v236, v5
    v_mul_f32 v237, v237, v5
    v_mul_f32 v238, v238, v5
    v_mul_f32 v239, v239, v5
    v_mul_f32 v240, v240, v4
    v_mul_f32 v241, v241, v4
    v_mul_f32 v242, v242, v4
    v_mul_f32 v243, v243, v4
    v_mul_f32 v244, v244, v4
    v_mul_f32 v245, v245, v4
    v_mul_f32 v246, v246, v4
    v_mul_f32 v247, v247, v4
    v_mul_f32 v248, v248, v5
    v_mul_f32 v249, v249, v5
    v_mul_f32 v250, v250, v5
    v_mul_f32 v251, v251, v5
    v_mul_f32 v252, v252, v5
    v_mul_f32 v253, v253, v5
    v_mul_f32 v254, v254, v5
    v_mul_f32 v255, v255, v5
    v_sub_f32 v48, v80, v2
    v_exp_f32 v48, v48
    v_sub_f32 v49, v81, v2
    v_exp_f32 v49, v49
    v_sub_f32 v50, v82, v2
    v_exp_f32 v50, v50
    v_add_f32 v8, v48, v49
    v_sub_f32 v51, v83, v2
    v_exp_f32 v51, v51
    v_add_f32 v8, v8, v50
    v_sub_f32 v56, v88, v3
    v_exp_f32 v56, v56
    v_add_f32 v8, v8, v51
    v_sub_f32 v57, v89, v3
    v_exp_f32 v57, v57
    v_sub_f32 v58, v90, v3
    v_exp_f32 v58, v58
    v_add_f32 v9, v56, v57
    v_sub_f32 v59, v91, v3
    v_exp_f32 v59, v59
    v_add_f32 v9, v9, v58
    v_sub_f32 v52, v84, v2
    v_exp_f32 v52, v52
    v_add_f32 v9, v9, v59
    v_sub_f32 v53, v85, v2
    v_exp_f32 v53, v53
    v_add_f32 v8, v8, v52
    v_sub_f32 v54, v86, v2
    v_exp_f32 v54, v54
    v_add_f32 v8, v8, v53
    v_sub_f32 v55, v87, v2
    v_exp_f32 v55, v55
    v_add_f32 v8, v8, v54
    v_sub_f32 v60, v92, v3
    v_exp_f32 v60, v60
    v_add_f32 v8, v8, v55
    v_sub_f32 v61, v93, v3
    v_exp_f32 v61, v61
    v_add_f32 v9, v9, v60
    v_sub_f32 v62, v94, v3
    v_exp_f32 v62, v62
    v_add_f32 v9, v9, v61
    v_sub_f32 v63, v95, v3
    v_exp_f32 v63, v63
    v_add_f32 v9, v9, v62
    v_add_f32 v9, v9, v63
    v_cvt_pk_bf16_f32 v64, v48, v49
    v_cvt_pk_bf16_f32 v65, v50, v51
    v_cvt_pk_bf16_f32 v66, v52, v53
    v_cvt_pk_bf16_f32 v67, v54, v55
    v_cvt_pk_bf16_f32 v68, v56, v57
    v_cvt_pk_bf16_f32 v69, v58, v59
    v_cvt_pk_bf16_f32 v70, v60, v61
    v_cvt_pk_bf16_f32 v71, v62, v63
    s_branch .Lmain_kernel_rarer_162
.Lmain_kernel_spin_167:
    s_mov_b32 s31, 0
.Lmain_kernel_sp2_168:
    s_add_u32 s31, s31, 1
    s_cmp_gt_u32 s31, 0x40000
    s_cbranch_scc1 .Lmain_kernel_pok_166
    s_sleep 2
    v_and_b32 v1, 0xf0, v14
    v_lshlrev_b32 v1, 10, v1
    buffer_load_dword v1, v1, s[16:19], s35 offen sc1
    s_waitcnt vmcnt(0)
    v_and_b32 v1, 4, v1
    v_cmp_ne_u32 vcc, 4, v1
    s_nop 0
    s_cbranch_vccnz .Lmain_kernel_sp2_168
    s_branch .Lmain_kernel_pok_166
.Ltext_end:
.section .rodata,"a"
.p2align 6
.amdhsa_kernel main_kernel
  .amdhsa_next_free_vgpr 512
  .amdhsa_next_free_sgpr 102
  .amdhsa_accum_offset 256
  .amdhsa_group_segment_fixed_size 0
  .amdhsa_kernarg_size 104
  .amdhsa_user_sgpr_count 2
  .amdhsa_user_sgpr_kernarg_segment_ptr 1
  .amdhsa_system_sgpr_workgroup_id_x 1
  .amdhsa_float_denorm_mode_32 3
.end_amdhsa_kernel
```
